```python
import torch

def _softmax(x, axis=-1):
    return torch.softmax(x, dim=axis)
def _gelu(x):
    return torch.nn.functional.gelu(x, approximate="tanh")
def _silu(x):
    return torch.nn.functional.silu(x)
def _sigmoid(x):
    return torch.sigmoid(x)
def _layernorm(x, axis=-1, eps=1e-5):
    m = x.mean(dim=axis, keepdim=True)
    v = x.var(dim=axis, keepdim=True, unbiased=False)
    return (x - m) / torch.sqrt(v + eps)
def _scatter_add(tgt, idx, src, axis=0):
    return tgt.clone().index_add_(axis, idx, src)
def _segment_sum(src, seg, n):
    out = torch.zeros((n,) + src.shape[1:], dtype=src.dtype)
    return out.index_add_(0, seg, src)
def _pad(x, pw):
    flat = tuple(v for pair in reversed(pw) for v in pair)
    return torch.nn.functional.pad(x, flat)

kernel_name = 'concat_heads__mha_block_cached__mha_block_cached__near_ridge'

def setup_inputs():

    _w = (lambda a: (lambda t: t.to(torch.bfloat16) if t.is_floating_point() else t)(torch.as_tensor(a)))
    def _A_setup():
        B, Sq, D = 8, 304, 448
        H, Sk, Dh = 16, 1024, 256
        return {
            "x": _w((lambda *s: torch.randn(*s, dtype=torch.bfloat16) * 0.8)(B, Sq, D)),
            "k_cache": _w((lambda *s: torch.randn(*s, dtype=torch.bfloat16) * 0.8)(B, H, Sk, Dh)),
            "v_cache": _w((lambda *s: torch.randn(*s, dtype=torch.bfloat16) * 0.05)(B, H, Sk, Dh)),
            "wq": _w((lambda *s: torch.randn(*s, dtype=torch.bfloat16) * 0.8)(D, H * Dh) * (D ** -0.5)),
            "wo": _w((lambda *s: torch.randn(*s, dtype=torch.bfloat16) * 0.05)(H * Dh, D) * ((H * Dh) ** -0.5)),
        }
    _A_in = _A_setup()

    def _B_setup():
        B, Sq, D = 8, 304, 448
        H, Sk, Dh = 16, 1024, 256
        return {
            "x": _w((lambda *s: torch.randn(*s, dtype=torch.bfloat16) * 0.8)(B, Sq, D)),
            "k_cache": _w((lambda *s: torch.randn(*s, dtype=torch.bfloat16) * 0.8)(B, H, Sk, Dh)),
            "v_cache": _w((lambda *s: torch.randn(*s, dtype=torch.bfloat16) * 0.05)(B, H, Sk, Dh)),
            "wq": _w((lambda *s: torch.randn(*s, dtype=torch.bfloat16) * 0.8)(D, H * Dh) * (D ** -0.5)),
            "wo": _w((lambda *s: torch.randn(*s, dtype=torch.bfloat16) * 0.05)(H * Dh, D) * ((H * Dh) ** -0.5)),
        }
    _B_in = _B_setup()

    return {
        "A_x": _A_in["x"],
        "A_k_cache": _A_in["k_cache"],
        "A_v_cache": _A_in["v_cache"],
        "A_wq": _A_in["wq"],
        "A_wo": _A_in["wo"],
        "B_x": _B_in["x"],
        "B_k_cache": _B_in["k_cache"],
        "B_v_cache": _B_in["v_cache"],
        "B_wq": _B_in["wq"],
        "B_wo": _B_in["wo"],
    }

def reference(A_x, A_k_cache, A_v_cache, A_wq, A_wo, B_x, B_k_cache, B_v_cache, B_wq, B_wo):
    def _A_ref(x, k_cache, v_cache, wq, wo):
        B, Sq, D = x.shape
        H, Dh = 16, 256
        q = (lambda x, *d: x.permute(*d))((x @ wq).reshape(B, Sq, H, Dh), 0, 2, 1, 3)
        scores = torch.einsum("bhqd,bhkd->bhqk", q, k_cache) * (Dh ** -0.5)
        p = _softmax(scores, axis=-1)
        o = torch.einsum("bhqk,bhkd->bhqd", p, v_cache)
        return (lambda x, *d: x.permute(*d))(o, 0, 2, 1, 3).reshape(B, Sq, H * Dh) @ wo

    def _B_ref(x, k_cache, v_cache, wq, wo):
        B, Sq, D = x.shape
        H, Dh = 16, 256
        q = (lambda x, *d: x.permute(*d))((x @ wq).reshape(B, Sq, H, Dh), 0, 2, 1, 3)
        scores = torch.einsum("bhqd,bhkd->bhqk", q, k_cache) * (Dh ** -0.5)
        p = _softmax(scores, axis=-1)
        o = torch.einsum("bhqk,bhkd->bhqd", p, v_cache)
        return (lambda x, *d: x.permute(*d))(o, 0, 2, 1, 3).reshape(B, Sq, H * Dh) @ wo

    a = _A_ref(A_x, A_k_cache, A_v_cache, A_wq, A_wo)
    b = _B_ref(B_x, B_k_cache, B_v_cache, B_wq, B_wo)
    return torch.concatenate([a, b], axis=-1)
```

```asm
; @launch grid=(256,1,1) block=(256,1,1) lds=163840
.amdgcn_target "amdgcn-amd-amdhsa--gfx950"
.text
.globl concat_heads__mha_block_cached__mha_block_cached__near_ridge_kernel
.p2align 8
.type concat_heads__mha_block_cached__mha_block_cached__near_ridge_kernel,@function
concat_heads__mha_block_cached__mha_block_cached__near_ridge_kernel:
L_k1_entry:
s_cmp_ge_u32 s2, 256
s_cbranch_scc1 L_k1_end
s_load_dwordx8 s[40:47], s[0:1], 0
s_load_dwordx8 s[48:55], s[0:1], 40
s_load_dwordx2 s[56:57], s[0:1], 96
s_load_dwordx2 s[96:97], s[0:1], 32
s_load_dwordx2 s[98:99], s[0:1], 72
v_lshrrev_b32 v100, 6, v0
v_and_b32 v101, 63, v0
v_readfirstlane_b32 s27, v100
s_getpc_b64 s[100:101]
L_k1_pc:
s_lshr_b32 s80, s2, 3
s_lshl_b32 s80, s80, 2
s_add_u32 s80, s80, s27
s_lshl_b32 s80, s80, 10
s_sub_u32 s100, s100, L_k1_pc - L_k1_entry
s_subb_u32 s101, s101, 0
s_cmp_ge_u32 s80, L_k1_hot_end - L_k1_entry - 1024
s_cbranch_scc1 L_k1_nopf
v_lshlrev_b32 v102, 4, v101
v_add_u32 v102, s80, v102
global_load_dwordx4 v[184:187], v102, s[100:101]
L_k1_nopf:
s_and_b32 s82, s2, 7
s_lshr_b32 s72, s2, 3
s_lshr_b32 s73, s82, 2
s_and_b32 s74, s82, 3
s_lshl_b32 s74, s74, 1
s_lshr_b32 s75, s72, 4
s_add_u32 s74, s74, s75
s_and_b32 s75, s72, 15
s_lshl_b32 s76, s74, 4
s_add_u32 s76, s76, s75
s_lshl_b32 s77, s73, 7
s_add_u32 s77, s77, s76
v_lshrrev_b32 v104, 3, v101
v_and_b32 v105, 7, v101
v_and_b32 v106, 6, v104
v_xor_b32 v105, v105, v106
v_lshlrev_b32 v105, 4, v105
s_mul_i32 s80, s27, 80
v_add_u32 v107, s80, v104
v_mul_u32_u24 v107, 896, v107
v_add_u32 v90, v107, v105
s_and_b32 s80, s27, 1
s_lshl_b32 s80, s80, 4
s_lshr_b32 s81, s27, 1
s_lshl_b32 s81, s81, 2
s_add_u32 s80, s80, s81
v_lshrrev_b32 v107, 2, v104
v_lshlrev_b32 v107, 3, v107
v_and_b32 v108, 3, v104
v_add_u32 v107, v107, v108
v_add_u32 v107, s80, v107
v_lshlrev_b32 v107, 13, v107
v_add_u32 v91, v107, v105
s_mov_b32 s24, 2688
s_mov_b32 s25, 1792
s_mov_b32 s26, 896
s_lshl_b32 s71, s27, 12
s_mov_b32 s61, 16384
s_mov_b32 s62, 49152
s_mov_b32 s67, 65536
s_mul_i32 s79, s27, 10240
s_add_u32 s64, s79, 81920
s_add_u32 s80, s64, 38912
s_xor_b32 s70, s64, s80
s_mov_b32 s60, 0
s_mov_b32 s68, 0
s_mov_b32 s14, 272384
s_mov_b32 s15, 0x20000
s_mov_b32 s18, 0x40000
s_mov_b32 s19, 0x20000
s_waitcnt lgkmcnt(0)
s_cmp_eq_u32 s73, 0
s_cselect_b64 s[40:41], s[40:41], s[48:49]
s_cselect_b64 s[46:47], s[46:47], s[54:55]
s_cselect_b64 s[42:43], s[42:43], s[50:51]
s_cselect_b64 s[44:45], s[44:45], s[52:53]
s_mul_i32 s78, s74, 272384
s_add_u32 s12, s40, s78
s_addc_u32 s13, s41, 0
s_lshl_b32 s78, s75, 9
s_add_u32 s16, s46, s78
s_addc_u32 s17, s47, 0
s_sub_u32 s16, s16, 2688
s_subb_u32 s17, s17, 0
s_cmp_eq_u32 s27, 3
s_cbranch_scc1 L_var_r4
s_mov_b32 s75, s64
s_mov_b32 s63, s68
s_mov_b32 m0, s75
s_add_u32 s75, s75, 1024
buffer_load_dwordx4 v90, s[12:15], s63 offen offset:0 lds
s_add_u32 s63, s63, 7168
s_mov_b32 m0, s75
s_add_u32 s75, s75, 1024
buffer_load_dwordx4 v90, s[12:15], s63 offen offset:0 lds
s_add_u32 s63, s63, 7168
s_mov_b32 m0, s75
s_add_u32 s75, s75, 1024
buffer_load_dwordx4 v90, s[12:15], s63 offen offset:0 lds
s_add_u32 s63, s63, 7168
s_mov_b32 m0, s75
s_add_u32 s75, s75, 1024
buffer_load_dwordx4 v90, s[12:15], s63 offen offset:0 lds
s_add_u32 s63, s63, 7168
s_mov_b32 m0, s75
s_add_u32 s75, s75, 1024
buffer_load_dwordx4 v90, s[12:15], s63 offen offset:0 lds
s_add_u32 s63, s63, 7168
s_mov_b32 m0, s75
s_add_u32 s75, s75, 1024
buffer_load_dwordx4 v90, s[12:15], s63 offen offset:0 lds
s_add_u32 s63, s63, 7168
s_mov_b32 m0, s75
s_add_u32 s75, s75, 1024
buffer_load_dwordx4 v90, s[12:15], s63 offen offset:0 lds
s_add_u32 s63, s63, 7168
s_mov_b32 m0, s75
s_add_u32 s75, s75, 1024
buffer_load_dwordx4 v90, s[12:15], s63 offen offset:0 lds
s_add_u32 s63, s63, 7168
s_mov_b32 m0, s75
s_add_u32 s75, s75, 1024
buffer_load_dwordx4 v90, s[12:15], s63 offen offset:0 lds
s_add_u32 s63, s63, 7168
s_mov_b32 m0, s75
s_add_u32 s75, s75, 1024
buffer_load_dwordx4 v90, s[12:15], s63 offen offset:0 lds
s_add_u32 s63, s63, 7168
s_add_u32 s68, s68, 128
s_xor_b32 s64, s64, s70
s_add_u32 m0, s61, s71
s_nop 0
buffer_load_dwordx4 v91, s[16:19], s24 offen offset:0 lds
buffer_load_dwordx4 v91, s[16:19], s25 offen offset:1024 lds
buffer_load_dwordx4 v91, s[16:19], s26 offen offset:2048 lds
buffer_load_dwordx4 v91, s[16:19], 0 offen offset:3072 lds
s_add_u32 s16, s16, 262144
s_addc_u32 s17, s17, 0
s_add_u32 m0, s62, s71
s_nop 0
buffer_load_dwordx4 v91, s[16:19], s24 offen offset:0 lds
buffer_load_dwordx4 v91, s[16:19], s25 offen offset:1024 lds
buffer_load_dwordx4 v91, s[16:19], s26 offen offset:2048 lds
buffer_load_dwordx4 v91, s[16:19], 0 offen offset:3072 lds
s_add_u32 s16, s16, 262144
s_addc_u32 s17, s17, 0
s_lshl_b32 s78, s76, 19
s_add_u32 s36, s42, s78
s_addc_u32 s37, s43, 0
s_sub_u32 s4, s36, 2688
s_subb_u32 s5, s37, 0
s_mov_b32 s6, 19072
s_mov_b32 s7, 0x20000
s_add_u32 s8, s44, s78
s_addc_u32 s9, s45, 0
s_mov_b32 s100, s8
s_mov_b32 s101, s9
s_sub_u32 s8, s8, 2688
s_subb_u32 s9, s9, 0
s_mov_b32 s10, 19072
s_mov_b32 s11, 0x20000
v_lshlrev_b32 v125, 6, v101
v_add_u32 v125, s71, v125
s_mul_i32 s78, s77, 163840
s_add_u32 s20, s56, s78
s_addc_u32 s21, s57, 0
s_mov_b32 s22, 163840
s_mov_b32 s23, 0x20000
s_cmp_lt_u32 s2, 128
s_cselect_b64 s[96:97], s[96:97], s[98:99]
s_and_b32 s78, s2, 127
s_mul_i32 s78, s78, 28672
s_mul_i32 s80, s27, 224
s_add_u32 s78, s78, s80
s_add_u32 s44, s96, s78
s_addc_u32 s45, s97, 0
s_sub_u32 s44, s44, 3072
s_subb_u32 s45, s45, 0
s_mov_b32 s46, 31744
s_mov_b32 s47, 0x20000
s_mul_i32 s78, s2, 28672
s_mul_i32 s80, s27, 7168
s_add_u32 s78, s78, s80
s_add_u32 s78, s78, 42991616
s_add_u32 s48, s56, s78
s_addc_u32 s49, s57, 0
s_mov_b32 s50, 7168
s_mov_b32 s51, 0x20000
s_add_u32 s72, s79, 120832
s_mov_b32 s73, 4096
s_add_u32 s30, s71, 0
s_add_u32 s31, s71, 16384
s_mov_b32 s28, 32768
s_mov_b32 s29, 49152
s_mov_b32 s35, 65536
s_mov_b32 s38, 1317011456
s_mov_b32 s39, 1035512379
s_mov_b32 s34, 0
v_and_b32 v102, 15, v101
v_lshrrev_b32 v103, 4, v101
v_lshlrev_b32 v7, 9, v104
v_add_u32 v7, v7, v105
v_add_u32 v7, s71, v7
s_mov_b32 s80, 4682
v_add_u32 v108, 0, v101
v_mul_lo_u32 v109, v108, s80
v_lshrrev_b32 v109, 16, v109
v_mul_u32_u24 v110, 14, v109
v_sub_u32 v110, v108, v110
v_mul_u32_u24 v109, 896, v109
v_lshlrev_b32 v110, 4, v110
v_add_u32 v109, v109, v110
v_add_u32 v160, 3072, v109
v_add_u32 v108, 64, v101
v_mul_lo_u32 v109, v108, s80
v_lshrrev_b32 v109, 16, v109
v_mul_u32_u24 v110, 14, v109
v_sub_u32 v110, v108, v110
v_mul_u32_u24 v109, 896, v109
v_lshlrev_b32 v110, 4, v110
v_add_u32 v109, v109, v110
v_add_u32 v161, 2048, v109
v_add_u32 v108, 128, v101
v_mul_lo_u32 v109, v108, s80
v_lshrrev_b32 v109, 16, v109
v_mul_u32_u24 v110, 14, v109
v_sub_u32 v110, v108, v110
v_mul_u32_u24 v109, 896, v109
v_lshlrev_b32 v110, 4, v110
v_add_u32 v109, v109, v110
v_add_u32 v162, 1024, v109
v_add_u32 v108, 192, v101
v_mul_lo_u32 v109, v108, s80
v_lshrrev_b32 v109, 16, v109
v_mul_u32_u24 v110, 14, v109
v_sub_u32 v110, v108, v110
v_mul_u32_u24 v109, 896, v109
v_lshlrev_b32 v110, 4, v110
v_add_u32 v109, v109, v110
v_add_u32 v163, 0, v109
v_add_u32 v108, 256, v101
v_mul_lo_u32 v109, v108, s80
v_lshrrev_b32 v109, 16, v109
v_mul_u32_u24 v110, 14, v109
v_sub_u32 v110, v108, v110
v_mul_u32_u24 v109, 896, v109
v_lshlrev_b32 v110, 4, v110
v_add_u32 v109, v109, v110
v_add_u32 v164, 3072, v109
v_add_u32 v108, 320, v101
v_mul_lo_u32 v109, v108, s80
v_lshrrev_b32 v109, 16, v109
v_mul_u32_u24 v110, 14, v109
v_sub_u32 v110, v108, v110
v_mul_u32_u24 v109, 896, v109
v_lshlrev_b32 v110, 4, v110
v_add_u32 v109, v109, v110
v_add_u32 v165, 2048, v109
v_add_u32 v108, 384, v101
v_mul_lo_u32 v109, v108, s80
v_lshrrev_b32 v109, 16, v109
v_mul_u32_u24 v110, 14, v109
v_sub_u32 v110, v108, v110
v_mul_u32_u24 v109, 896, v109
v_lshlrev_b32 v110, 4, v110
v_add_u32 v109, v109, v110
v_add_u32 v166, 1024, v109
v_lshrrev_b32 v108, 2, v101
v_mul_u32_u24 v108, 224, v108
v_and_b32 v109, 3, v101
v_lshlrev_b32 v109, 3, v109
v_add_u32 v108, v108, v109
v_add_u32 v167, s72, v108
v_lshlrev_b32 v168, 4, v101
v_lshrrev_b32 v107, 3, v102
v_and_b32 v108, 7, v102
v_lshlrev_b32 v108, 7, v108
v_and_b32 v109, 6, v102
v_add_u32 v110, 0, v103
v_xor_b32 v110, v110, v109
v_lshlrev_b32 v110, 4, v110
v_add_u32 v110, v110, v108
v_lshlrev_b32 v111, 12, v107
v_add_u32 v0, v110, v111
v_lshlrev_b32 v111, 10, v107
v_add_u32 v110, v110, v111
v_add_u32 v110, s79, v110
v_add_u32 v80, 81920, v110
v_add_u32 v110, 4, v103
v_xor_b32 v110, v110, v109
v_lshlrev_b32 v110, 4, v110
v_add_u32 v110, v110, v108
v_lshlrev_b32 v111, 12, v107
v_add_u32 v1, v110, v111
v_lshlrev_b32 v111, 10, v107
v_add_u32 v110, v110, v111
v_add_u32 v110, s79, v110
v_add_u32 v81, 81920, v110
v_lshrrev_b32 v107, 2, v101
v_and_b32 v107, 3, v107
v_and_b32 v108, 1, v103
v_lshlrev_b32 v108, 2, v108
v_add_u32 v107, v107, v108
v_and_b32 v109, 6, v107
v_lshlrev_b32 v107, 7, v107
v_lshrrev_b32 v108, 1, v103
v_lshlrev_b32 v108, 12, v108
v_add_u32 v107, v107, v108
v_and_b32 v108, 3, v101
v_lshrrev_b32 v110, 1, v108
v_and_b32 v111, 1, v108
v_lshlrev_b32 v111, 3, v111
v_add_u32 v112, 0, v110
v_xor_b32 v112, v112, v109
v_lshlrev_b32 v112, 4, v112
v_add_u32 v112, v112, v111
v_add_u32 v2, v112, v107
v_add_u32 v112, 2, v110
v_xor_b32 v112, v112, v109
v_lshlrev_b32 v112, 4, v112
v_add_u32 v112, v112, v111
v_add_u32 v3, v112, v107
v_add_u32 v112, 4, v110
v_xor_b32 v112, v112, v109
v_lshlrev_b32 v112, 4, v112
v_add_u32 v112, v112, v111
v_add_u32 v4, v112, v107
v_add_u32 v112, 6, v110
v_xor_b32 v112, v112, v109
v_lshlrev_b32 v112, 4, v112
v_add_u32 v112, v112, v111
v_add_u32 v5, v112, v107
v_add_u32 v112, 0, v108
v_xor_b32 v112, v112, v109
v_lshlrev_b32 v112, 4, v112
v_add_u32 v84, v112, v107
v_add_u32 v112, 4, v108
v_xor_b32 v112, v112, v109
v_lshlrev_b32 v112, 4, v112
v_add_u32 v85, v112, v107
v_add_u32 v0, 32768, v0
v_add_u32 v1, 32768, v1
s_mul_i32 s80, s27, 25600
s_add_u32 s80, s80, 81920
v_lshlrev_b32 v6, 4, v101
v_add_u32 v6, s80, v6
s_load_dwordx4 s[40:43], s[0:1], 80
s_and_b32 s58, s2, 7
s_lshr_b32 s59, s58, 2
s_lshl_b32 s59, s59, 3
s_and_b32 s58, s58, 3
s_lshl_b32 s58, s58, 1
s_add_u32 s59, s59, s58
s_lshr_b32 s58, s2, 7
s_add_u32 s59, s59, s58
s_lshl_b32 s59, s59, 13
s_add_u32 s59, s59, 54525952
s_lshr_b32 s58, s2, 5
s_and_b32 s58, s58, 3
s_lshl_b32 s58, s58, 2
s_add_u32 s58, s58, s27
s_lshl_b32 s58, s58, 8
s_add_u32 s74, s58, s59
s_lshr_b32 s58, s2, 3
s_and_b32 s58, s58, 3
s_lshl_b32 s58, s58, 10
s_add_u32 s59, s59, s58
s_add_u32 s59, s59, 4096
s_lshl_b32 s58, s27, 8
s_add_u32 s58, s58, s59
s_add_u32 s76, s56, s58
s_addc_u32 s77, s57, 0
s_lshr_b32 s58, s2, 5
s_and_b32 s58, s58, 3
s_lshl_b32 s58, s58, 8
s_add_u32 s3, s58, s59
s_add_u32 s80, s56, s74
s_addc_u32 s81, s57, 0
v_mov_b32 v102, 0
s_mov_b64 exec, 1
global_store_dword v102, v102, s[80:81] sc0 sc1
global_store_dword v102, v102, s[76:77] sc0 sc1
s_mov_b64 exec, -1
s_waitcnt lgkmcnt(0)
s_mov_b32 s78, s42
s_mov_b32 s79, s43
s_add_u32 s42, s56, s74
s_addc_u32 s43, s57, 0
v_mov_b32 v40, 0
v_mov_b32 v41, 0
v_mov_b32 v42, 0
v_mov_b32 v43, 0
s_nop 1
v_mfma_f32_32x32x16_bf16 a[0:15], v[40:43], v[40:43], 0
v_mfma_f32_32x32x16_bf16 a[16:31], v[40:43], v[40:43], 0
v_mfma_f32_32x32x16_bf16 a[32:47], v[40:43], v[40:43], 0
v_mfma_f32_32x32x16_bf16 a[48:63], v[40:43], v[40:43], 0
v_mfma_f32_32x32x16_bf16 a[64:79], v[40:43], v[40:43], 0
v_mfma_f32_32x32x16_bf16 a[80:95], v[40:43], v[40:43], 0
v_mfma_f32_32x32x16_bf16 a[96:111], v[40:43], v[40:43], 0
v_mfma_f32_32x32x16_bf16 a[112:127], v[40:43], v[40:43], 0
v_mfma_f32_32x32x16_bf16 a[128:143], v[40:43], v[40:43], 0
v_mfma_f32_32x32x16_bf16 a[144:159], v[40:43], v[40:43], 0
v_mfma_f32_32x32x16_bf16 a[160:175], v[40:43], v[40:43], 0
v_mfma_f32_32x32x16_bf16 a[176:191], v[40:43], v[40:43], 0
v_mfma_f32_32x32x16_bf16 a[192:207], v[40:43], v[40:43], 0
v_mfma_f32_32x32x16_bf16 a[208:223], v[40:43], v[40:43], 0
v_mfma_f32_32x32x16_bf16 a[224:239], v[40:43], v[40:43], 0
v_mfma_f32_32x32x16_bf16 a[240:255], v[40:43], v[40:43], 0
v_mfma_f32_32x32x16_bf16 v[192:207], v[40:43], v[40:43], 0
v_mfma_f32_32x32x16_bf16 v[208:223], v[40:43], v[40:43], 0
v_mfma_f32_32x32x16_bf16 v[224:239], v[40:43], v[40:43], 0
v_mfma_f32_32x32x16_bf16 v[240:255], v[40:43], v[40:43], 0
v_add_u32 v86, s61, v84
v_add_u32 v87, s61, v85
v_add_u32 v82, s60, v80
v_add_u32 v83, s60, v81
s_xor_b32 s60, s60, 38912
s_waitcnt vmcnt(6)
s_barrier
ds_read_b64_tr_b16 v[8:9], v86 offset:0
ds_read_b64_tr_b16 v[10:11], v86 offset:8192
ds_read_b64_tr_b16 v[12:13], v86 offset:8
ds_read_b64_tr_b16 v[14:15], v86 offset:8200
ds_read_b64_tr_b16 v[16:17], v87 offset:0
ds_read_b64_tr_b16 v[18:19], v87 offset:8192
ds_read_b64_tr_b16 v[20:21], v87 offset:8
ds_read_b64_tr_b16 v[22:23], v87 offset:8200
ds_read_b128 v[40:43], v82 offset:0
ds_read_b128 v[44:47], v82 offset:2048
ds_read_b128 v[48:51], v82 offset:4096
ds_read_b128 v[52:55], v82 offset:6144
ds_read_b128 v[56:59], v82 offset:8192
s_mov_b32 s32, 4
s_waitcnt lgkmcnt(0)
v_mfma_f32_16x16x32_bf16 a[0:3], v[8:11], v[40:43], a[0:3]
ds_read_b64_tr_b16 v[24:25], v86 offset:1024
v_mfma_f32_16x16x32_bf16 a[4:7], v[8:11], v[44:47], a[4:7]
s_add_u32 m0, s67, s71
v_mfma_f32_16x16x32_bf16 a[8:11], v[8:11], v[48:51], a[8:11]
ds_read_b64_tr_b16 v[26:27], v86 offset:9216
v_mfma_f32_16x16x32_bf16 a[12:15], v[8:11], v[52:55], a[12:15]
buffer_load_dwordx4 v91, s[16:19], s24 offen offset:0 lds
v_mfma_f32_16x16x32_bf16 v[192:195], v[8:11], v[56:59], v[192:195]
ds_read_b64_tr_b16 v[28:29], v86 offset:1032
v_mfma_f32_16x16x32_bf16 a[16:19], v[12:15], v[40:43], a[16:19]
v_mfma_f32_16x16x32_bf16 a[20:23], v[12:15], v[44:47], a[20:23]
ds_read_b64_tr_b16 v[30:31], v86 offset:9224
v_mfma_f32_16x16x32_bf16 a[24:27], v[12:15], v[48:51], a[24:27]
buffer_load_dwordx4 v91, s[16:19], s25 offen offset:1024 lds
v_mfma_f32_16x16x32_bf16 a[28:31], v[12:15], v[52:55], a[28:31]
v_mfma_f32_16x16x32_bf16 v[196:199], v[12:15], v[56:59], v[196:199]
v_mfma_f32_16x16x32_bf16 a[32:35], v[16:19], v[40:43], a[32:35]
ds_read_b64_tr_b16 v[32:33], v87 offset:1024
v_mfma_f32_16x16x32_bf16 a[36:39], v[16:19], v[44:47], a[36:39]
buffer_load_dwordx4 v91, s[16:19], s26 offen offset:2048 lds
v_mfma_f32_16x16x32_bf16 a[40:43], v[16:19], v[48:51], a[40:43]
ds_read_b64_tr_b16 v[34:35], v87 offset:9216
v_mfma_f32_16x16x32_bf16 a[44:47], v[16:19], v[52:55], a[44:47]
v_mfma_f32_16x16x32_bf16 v[200:203], v[16:19], v[56:59], v[200:203]
ds_read_b64_tr_b16 v[36:37], v87 offset:1032
v_mfma_f32_16x16x32_bf16 a[48:51], v[20:23], v[40:43], a[48:51]
buffer_load_dwordx4 v91, s[16:19], 0 offen offset:3072 lds
s_mov_b32 s75, s64
v_mfma_f32_16x16x32_bf16 a[52:55], v[20:23], v[44:47], a[52:55]
ds_read_b64_tr_b16 v[38:39], v87 offset:9224
s_mov_b32 s63, s68
v_mfma_f32_16x16x32_bf16 a[56:59], v[20:23], v[48:51], a[56:59]
s_mov_b32 m0, s75
s_add_u32 s75, s75, 1024
v_mfma_f32_16x16x32_bf16 a[60:63], v[20:23], v[52:55], a[60:63]
s_add_u32 s16, s16, 262144
s_addc_u32 s17, s17, 0
v_mfma_f32_16x16x32_bf16 v[204:207], v[20:23], v[56:59], v[204:207]
s_waitcnt lgkmcnt(4)
buffer_load_dwordx4 v90, s[12:15], s63 offen offset:0 lds
v_mfma_f32_16x16x32_bf16 a[64:67], v[24:27], v[40:43], a[64:67]
ds_read_b64_tr_b16 v[8:9], v86 offset:2048
s_add_u32 s63, s63, 7168
v_mfma_f32_16x16x32_bf16 a[68:71], v[24:27], v[44:47], a[68:71]
s_mov_b32 m0, s75
s_add_u32 s75, s75, 1024
v_mfma_f32_16x16x32_bf16 a[72:75], v[24:27], v[48:51], a[72:75]
ds_read_b64_tr_b16 v[10:11], v86 offset:10240
v_mfma_f32_16x16x32_bf16 a[76:79], v[24:27], v[52:55], a[76:79]
v_mfma_f32_16x16x32_bf16 v[208:211], v[24:27], v[56:59], v[208:211]
ds_read_b64_tr_b16 v[12:13], v86 offset:2056
buffer_load_dwordx4 v90, s[12:15], s63 offen offset:0 lds
v_mfma_f32_16x16x32_bf16 a[80:83], v[28:31], v[40:43], a[80:83]
s_add_u32 s63, s63, 7168
s_mov_b32 m0, s75
v_mfma_f32_16x16x32_bf16 a[84:87], v[28:31], v[44:47], a[84:87]
ds_read_b64_tr_b16 v[14:15], v86 offset:10248
s_add_u32 s75, s75, 1024
v_mfma_f32_16x16x32_bf16 a[88:91], v[28:31], v[48:51], a[88:91]
v_mfma_f32_16x16x32_bf16 a[92:95], v[28:31], v[52:55], a[92:95]
buffer_load_dwordx4 v90, s[12:15], s63 offen offset:0 lds
s_add_u32 s63, s63, 7168
v_mfma_f32_16x16x32_bf16 v[212:215], v[28:31], v[56:59], v[212:215]
s_waitcnt lgkmcnt(4)
s_mov_b32 m0, s75
v_mfma_f32_16x16x32_bf16 a[96:99], v[32:35], v[40:43], a[96:99]
ds_read_b64_tr_b16 v[16:17], v87 offset:2048
s_add_u32 s75, s75, 1024
v_mfma_f32_16x16x32_bf16 a[100:103], v[32:35], v[44:47], a[100:103]
v_mfma_f32_16x16x32_bf16 a[104:107], v[32:35], v[48:51], a[104:107]
ds_read_b64_tr_b16 v[18:19], v87 offset:10240
buffer_load_dwordx4 v90, s[12:15], s63 offen offset:0 lds
v_mfma_f32_16x16x32_bf16 a[108:111], v[32:35], v[52:55], a[108:111]
s_add_u32 s63, s63, 7168
s_mov_b32 m0, s75
v_mfma_f32_16x16x32_bf16 v[216:219], v[32:35], v[56:59], v[216:219]
ds_read_b64_tr_b16 v[20:21], v87 offset:2056
s_add_u32 s75, s75, 1024
v_mfma_f32_16x16x32_bf16 a[112:115], v[36:39], v[40:43], a[112:115]
v_mfma_f32_16x16x32_bf16 a[116:119], v[36:39], v[44:47], a[116:119]
ds_read_b64_tr_b16 v[22:23], v87 offset:10248
buffer_load_dwordx4 v90, s[12:15], s63 offen offset:0 lds
v_mfma_f32_16x16x32_bf16 a[120:123], v[36:39], v[48:51], a[120:123]
s_add_u32 s63, s63, 7168
v_mfma_f32_16x16x32_bf16 a[124:127], v[36:39], v[52:55], a[124:127]
s_mov_b32 m0, s75
s_add_u32 s75, s75, 1024
v_mfma_f32_16x16x32_bf16 v[220:223], v[36:39], v[56:59], v[220:223]
s_waitcnt lgkmcnt(4)
v_mfma_f32_16x16x32_bf16 a[128:131], v[8:11], v[40:43], a[128:131]
ds_read_b64_tr_b16 v[24:25], v86 offset:3072
v_add_u32 v88, s62, v84
v_mfma_f32_16x16x32_bf16 a[132:135], v[8:11], v[44:47], a[132:135]
buffer_load_dwordx4 v90, s[12:15], s63 offen offset:0 lds
s_add_u32 s63, s63, 7168
v_mfma_f32_16x16x32_bf16 a[136:139], v[8:11], v[48:51], a[136:139]
ds_read_b64_tr_b16 v[26:27], v86 offset:11264
s_mov_b32 m0, s75
v_mfma_f32_16x16x32_bf16 a[140:143], v[8:11], v[52:55], a[140:143]
s_add_u32 s75, s75, 1024
v_add_u32 v89, s62, v85
v_mfma_f32_16x16x32_bf16 v[224:227], v[8:11], v[56:59], v[224:227]
ds_read_b64_tr_b16 v[28:29], v86 offset:3080
v_mfma_f32_16x16x32_bf16 a[144:147], v[12:15], v[40:43], a[144:147]
buffer_load_dwordx4 v90, s[12:15], s63 offen offset:0 lds
s_add_u32 s63, s63, 7168
v_mfma_f32_16x16x32_bf16 a[148:151], v[12:15], v[44:47], a[148:151]
ds_read_b64_tr_b16 v[30:31], v86 offset:11272
s_mov_b32 m0, s75
v_mfma_f32_16x16x32_bf16 a[152:155], v[12:15], v[48:51], a[152:155]
s_add_u32 s75, s75, 1024
v_mfma_f32_16x16x32_bf16 a[156:159], v[12:15], v[52:55], a[156:159]
v_mfma_f32_16x16x32_bf16 v[228:231], v[12:15], v[56:59], v[228:231]
s_waitcnt lgkmcnt(4)
buffer_load_dwordx4 v90, s[12:15], s63 offen offset:0 lds
v_mfma_f32_16x16x32_bf16 a[160:163], v[16:19], v[40:43], a[160:163]
ds_read_b64_tr_b16 v[32:33], v87 offset:3072
s_add_u32 s63, s63, 7168
v_mfma_f32_16x16x32_bf16 a[164:167], v[16:19], v[44:47], a[164:167]
s_mov_b32 m0, s75
s_add_u32 s75, s75, 1024
v_mfma_f32_16x16x32_bf16 a[168:171], v[16:19], v[48:51], a[168:171]
ds_read_b64_tr_b16 v[34:35], v87 offset:11264
v_mfma_f32_16x16x32_bf16 a[172:175], v[16:19], v[52:55], a[172:175]
buffer_load_dwordx4 v90, s[12:15], s63 offen offset:0 lds
v_mfma_f32_16x16x32_bf16 v[232:235], v[16:19], v[56:59], v[232:235]
ds_read_b64_tr_b16 v[36:37], v87 offset:3080
s_add_u32 s63, s63, 7168
v_mfma_f32_16x16x32_bf16 a[176:179], v[20:23], v[40:43], a[176:179]
s_mov_b32 m0, s75
s_add_u32 s75, s75, 1024
v_mfma_f32_16x16x32_bf16 a[180:183], v[20:23], v[44:47], a[180:183]
ds_read_b64_tr_b16 v[38:39], v87 offset:11272
v_mfma_f32_16x16x32_bf16 a[184:187], v[20:23], v[48:51], a[184:187]
v_mfma_f32_16x16x32_bf16 a[188:191], v[20:23], v[52:55], a[188:191]
buffer_load_dwordx4 v90, s[12:15], s63 offen offset:0 lds
s_add_u32 s63, s63, 7168
v_mfma_f32_16x16x32_bf16 v[236:239], v[20:23], v[56:59], v[236:239]
s_waitcnt lgkmcnt(4)
s_add_u32 s68, s68, 128
v_mfma_f32_16x16x32_bf16 a[192:195], v[24:27], v[40:43], a[192:195]
s_xor_b32 s64, s64, s70
v_mfma_f32_16x16x32_bf16 a[196:199], v[24:27], v[44:47], a[196:199]
v_mfma_f32_16x16x32_bf16 a[200:203], v[24:27], v[48:51], a[200:203]
v_mfma_f32_16x16x32_bf16 a[204:207], v[24:27], v[52:55], a[204:207]
s_mov_b32 s65, s61
s_mov_b32 s61, s62
v_mfma_f32_16x16x32_bf16 v[240:243], v[24:27], v[56:59], v[240:243]
s_mov_b32 s62, s67
s_mov_b32 s67, s65
v_mfma_f32_16x16x32_bf16 a[208:211], v[28:31], v[40:43], a[208:211]
v_mfma_f32_16x16x32_bf16 a[212:215], v[28:31], v[44:47], a[212:215]
v_mfma_f32_16x16x32_bf16 a[216:219], v[28:31], v[48:51], a[216:219]
v_mfma_f32_16x16x32_bf16 a[220:223], v[28:31], v[52:55], a[220:223]
v_mfma_f32_16x16x32_bf16 v[244:247], v[28:31], v[56:59], v[244:247]
s_waitcnt vmcnt(16) lgkmcnt(0)
s_barrier
v_mfma_f32_16x16x32_bf16 a[224:227], v[32:35], v[40:43], a[224:227]
ds_read_b64_tr_b16 v[8:9], v88 offset:0
ds_read_b64_tr_b16 v[10:11], v88 offset:8192
v_mfma_f32_16x16x32_bf16 a[228:231], v[32:35], v[44:47], a[228:231]
ds_read_b128 v[60:63], v83 offset:0
ds_read_b64_tr_b16 v[12:13], v88 offset:8
v_mfma_f32_16x16x32_bf16 a[232:235], v[32:35], v[48:51], a[232:235]
ds_read_b128 v[64:67], v83 offset:2048
ds_read_b64_tr_b16 v[14:15], v88 offset:8200
v_mfma_f32_16x16x32_bf16 a[236:239], v[32:35], v[52:55], a[236:239]
ds_read_b128 v[68:71], v83 offset:4096
ds_read_b128 v[72:75], v83 offset:6144
v_mfma_f32_16x16x32_bf16 v[248:251], v[32:35], v[56:59], v[248:251]
ds_read_b128 v[76:79], v83 offset:8192
v_mfma_f32_16x16x32_bf16 a[240:243], v[36:39], v[40:43], a[240:243]
ds_read_b64_tr_b16 v[16:17], v89 offset:0
v_mfma_f32_16x16x32_bf16 a[244:247], v[36:39], v[44:47], a[244:247]
ds_read_b64_tr_b16 v[18:19], v89 offset:8192
v_mfma_f32_16x16x32_bf16 a[248:251], v[36:39], v[48:51], a[248:251]
ds_read_b64_tr_b16 v[20:21], v89 offset:8
v_mfma_f32_16x16x32_bf16 a[252:255], v[36:39], v[52:55], a[252:255]
ds_read_b64_tr_b16 v[22:23], v89 offset:8200
v_mfma_f32_16x16x32_bf16 v[252:255], v[36:39], v[56:59], v[252:255]
s_waitcnt lgkmcnt(4)
v_mfma_f32_16x16x32_bf16 a[0:3], v[8:11], v[60:63], a[0:3]
ds_read_b64_tr_b16 v[24:25], v88 offset:1024
v_mfma_f32_16x16x32_bf16 a[4:7], v[8:11], v[64:67], a[4:7]
s_add_u32 m0, s67, s71
v_mfma_f32_16x16x32_bf16 a[8:11], v[8:11], v[68:71], a[8:11]
ds_read_b64_tr_b16 v[26:27], v88 offset:9216
v_mfma_f32_16x16x32_bf16 a[12:15], v[8:11], v[72:75], a[12:15]
buffer_load_dwordx4 v91, s[16:19], s24 offen offset:0 lds
v_mfma_f32_16x16x32_bf16 v[192:195], v[8:11], v[76:79], v[192:195]
ds_read_b64_tr_b16 v[28:29], v88 offset:1032
v_mfma_f32_16x16x32_bf16 a[16:19], v[12:15], v[60:63], a[16:19]
v_mfma_f32_16x16x32_bf16 a[20:23], v[12:15], v[64:67], a[20:23]
ds_read_b64_tr_b16 v[30:31], v88 offset:9224
v_mfma_f32_16x16x32_bf16 a[24:27], v[12:15], v[68:71], a[24:27]
v_mfma_f32_16x16x32_bf16 a[28:31], v[12:15], v[72:75], a[28:31]
v_mfma_f32_16x16x32_bf16 v[196:199], v[12:15], v[76:79], v[196:199]
s_waitcnt lgkmcnt(4)
buffer_load_dwordx4 v91, s[16:19], s25 offen offset:1024 lds
v_mfma_f32_16x16x32_bf16 a[32:35], v[16:19], v[60:63], a[32:35]
ds_read_b64_tr_b16 v[32:33], v89 offset:1024
v_mfma_f32_16x16x32_bf16 a[36:39], v[16:19], v[64:67], a[36:39]
v_mfma_f32_16x16x32_bf16 a[40:43], v[16:19], v[68:71], a[40:43]
ds_read_b64_tr_b16 v[34:35], v89 offset:9216
v_mfma_f32_16x16x32_bf16 a[44:47], v[16:19], v[72:75], a[44:47]
v_mfma_f32_16x16x32_bf16 v[200:203], v[16:19], v[76:79], v[200:203]
ds_read_b64_tr_b16 v[36:37], v89 offset:1032
v_mfma_f32_16x16x32_bf16 a[48:51], v[20:23], v[60:63], a[48:51]
v_mfma_f32_16x16x32_bf16 a[52:55], v[20:23], v[64:67], a[52:55]
ds_read_b64_tr_b16 v[38:39], v89 offset:9224
buffer_load_dwordx4 v91, s[16:19], s26 offen offset:2048 lds
v_mfma_f32_16x16x32_bf16 a[56:59], v[20:23], v[68:71], a[56:59]
v_mfma_f32_16x16x32_bf16 a[60:63], v[20:23], v[72:75], a[60:63]
v_mfma_f32_16x16x32_bf16 v[204:207], v[20:23], v[76:79], v[204:207]
s_waitcnt lgkmcnt(4)
v_mfma_f32_16x16x32_bf16 a[64:67], v[24:27], v[60:63], a[64:67]
ds_read_b64_tr_b16 v[8:9], v88 offset:2048
v_mfma_f32_16x16x32_bf16 a[68:71], v[24:27], v[64:67], a[68:71]
v_mfma_f32_16x16x32_bf16 a[72:75], v[24:27], v[68:71], a[72:75]
ds_read_b64_tr_b16 v[10:11], v88 offset:10240
v_mfma_f32_16x16x32_bf16 a[76:79], v[24:27], v[72:75], a[76:79]
buffer_load_dwordx4 v91, s[16:19], 0 offen offset:3072 lds
v_mfma_f32_16x16x32_bf16 v[208:211], v[24:27], v[76:79], v[208:211]
ds_read_b64_tr_b16 v[12:13], v88 offset:2056
v_mfma_f32_16x16x32_bf16 a[80:83], v[28:31], v[60:63], a[80:83]
s_add_u32 s16, s16, 262144
s_addc_u32 s17, s17, 0
v_mfma_f32_16x16x32_bf16 a[84:87], v[28:31], v[64:67], a[84:87]
ds_read_b64_tr_b16 v[14:15], v88 offset:10248
s_mov_b32 s75, s64
v_mfma_f32_16x16x32_bf16 a[88:91], v[28:31], v[68:71], a[88:91]
s_mov_b32 s63, s68
s_mov_b32 m0, s75
v_mfma_f32_16x16x32_bf16 a[92:95], v[28:31], v[72:75], a[92:95]
s_add_u32 s75, s75, 1024
v_mfma_f32_16x16x32_bf16 v[212:215], v[28:31], v[76:79], v[212:215]
s_waitcnt lgkmcnt(4)
v_mfma_f32_16x16x32_bf16 a[96:99], v[32:35], v[60:63], a[96:99]
ds_read_b64_tr_b16 v[16:17], v89 offset:2048
buffer_load_dwordx4 v90, s[12:15], s63 offen offset:0 lds
v_mfma_f32_16x16x32_bf16 a[100:103], v[32:35], v[64:67], a[100:103]
v_mfma_f32_16x16x32_bf16 a[104:107], v[32:35], v[68:71], a[104:107]
ds_read_b64_tr_b16 v[18:19], v89 offset:10240
v_mfma_f32_16x16x32_bf16 a[108:111], v[32:35], v[72:75], a[108:111]
s_add_u32 s63, s63, 7168
v_mfma_f32_16x16x32_bf16 v[216:219], v[32:35], v[76:79], v[216:219]
ds_read_b64_tr_b16 v[20:21], v89 offset:2056
s_mov_b32 m0, s75
v_mfma_f32_16x16x32_bf16 a[112:115], v[36:39], v[60:63], a[112:115]
s_add_u32 s75, s75, 1024
v_mfma_f32_16x16x32_bf16 a[116:119], v[36:39], v[64:67], a[116:119]
ds_read_b64_tr_b16 v[22:23], v89 offset:10248
v_mfma_f32_16x16x32_bf16 a[120:123], v[36:39], v[68:71], a[120:123]
buffer_load_dwordx4 v90, s[12:15], s63 offen offset:0 lds
v_mfma_f32_16x16x32_bf16 a[124:127], v[36:39], v[72:75], a[124:127]
v_mfma_f32_16x16x32_bf16 v[220:223], v[36:39], v[76:79], v[220:223]
s_waitcnt lgkmcnt(4)
v_mfma_f32_16x16x32_bf16 a[128:131], v[8:11], v[60:63], a[128:131]
ds_read_b64_tr_b16 v[24:25], v88 offset:3072
s_add_u32 s63, s63, 7168
v_mfma_f32_16x16x32_bf16 a[132:135], v[8:11], v[64:67], a[132:135]
s_mov_b32 m0, s75
s_add_u32 s75, s75, 1024
v_mfma_f32_16x16x32_bf16 a[136:139], v[8:11], v[68:71], a[136:139]
ds_read_b64_tr_b16 v[26:27], v88 offset:11264
v_add_u32 v86, s62, v84
v_mfma_f32_16x16x32_bf16 a[140:143], v[8:11], v[72:75], a[140:143]
v_add_u32 v87, s62, v85
v_add_u32 v82, s60, v80
v_mfma_f32_16x16x32_bf16 v[224:227], v[8:11], v[76:79], v[224:227]
ds_read_b64_tr_b16 v[28:29], v88 offset:3080
buffer_load_dwordx4 v90, s[12:15], s63 offen offset:0 lds
v_mfma_f32_16x16x32_bf16 a[144:147], v[12:15], v[60:63], a[144:147]
v_add_u32 v83, s60, v81
s_xor_b32 s60, s60, 38912
v_mfma_f32_16x16x32_bf16 a[148:151], v[12:15], v[64:67], a[148:151]
ds_read_b64_tr_b16 v[30:31], v88 offset:11272
v_mfma_f32_16x16x32_bf16 a[152:155], v[12:15], v[68:71], a[152:155]
s_add_u32 s63, s63, 7168
v_mfma_f32_16x16x32_bf16 a[156:159], v[12:15], v[72:75], a[156:159]
s_mov_b32 m0, s75
s_add_u32 s75, s75, 1024
v_mfma_f32_16x16x32_bf16 v[228:231], v[12:15], v[76:79], v[228:231]
s_waitcnt lgkmcnt(4)
v_mfma_f32_16x16x32_bf16 a[160:163], v[16:19], v[60:63], a[160:163]
ds_read_b64_tr_b16 v[32:33], v89 offset:3072
v_mfma_f32_16x16x32_bf16 a[164:167], v[16:19], v[64:67], a[164:167]
buffer_load_dwordx4 v90, s[12:15], s63 offen offset:0 lds
v_mfma_f32_16x16x32_bf16 a[168:171], v[16:19], v[68:71], a[168:171]
ds_read_b64_tr_b16 v[34:35], v89 offset:11264
v_mfma_f32_16x16x32_bf16 a[172:175], v[16:19], v[72:75], a[172:175]
v_mfma_f32_16x16x32_bf16 v[232:235], v[16:19], v[76:79], v[232:235]
ds_read_b64_tr_b16 v[36:37], v89 offset:3080
s_add_u32 s63, s63, 7168
v_mfma_f32_16x16x32_bf16 a[176:179], v[20:23], v[60:63], a[176:179]
s_mov_b32 m0, s75
s_add_u32 s75, s75, 1024
v_mfma_f32_16x16x32_bf16 a[180:183], v[20:23], v[64:67], a[180:183]
ds_read_b64_tr_b16 v[38:39], v89 offset:11272
v_mfma_f32_16x16x32_bf16 a[184:187], v[20:23], v[68:71], a[184:187]
v_mfma_f32_16x16x32_bf16 a[188:191], v[20:23], v[72:75], a[188:191]
buffer_load_dwordx4 v90, s[12:15], s63 offen offset:0 lds
s_add_u32 s63, s63, 7168
v_mfma_f32_16x16x32_bf16 v[236:239], v[20:23], v[76:79], v[236:239]
s_waitcnt lgkmcnt(4)
v_mfma_f32_16x16x32_bf16 a[192:195], v[24:27], v[60:63], a[192:195]
v_mfma_f32_16x16x32_bf16 a[196:199], v[24:27], v[64:67], a[196:199]
v_mfma_f32_16x16x32_bf16 a[200:203], v[24:27], v[68:71], a[200:203]
v_mfma_f32_16x16x32_bf16 a[204:207], v[24:27], v[72:75], a[204:207]
s_mov_b32 s65, s61
s_mov_b32 s61, s62
v_mfma_f32_16x16x32_bf16 v[240:243], v[24:27], v[76:79], v[240:243]
s_mov_b32 s62, s67
s_mov_b32 s67, s65
v_mfma_f32_16x16x32_bf16 a[208:211], v[28:31], v[60:63], a[208:211]
v_mfma_f32_16x16x32_bf16 a[212:215], v[28:31], v[64:67], a[212:215]
v_mfma_f32_16x16x32_bf16 a[216:219], v[28:31], v[68:71], a[216:219]
v_mfma_f32_16x16x32_bf16 a[220:223], v[28:31], v[72:75], a[220:223]
v_mfma_f32_16x16x32_bf16 v[244:247], v[28:31], v[76:79], v[244:247]
s_waitcnt vmcnt(9) lgkmcnt(0)
s_barrier
v_mfma_f32_16x16x32_bf16 a[224:227], v[32:35], v[60:63], a[224:227]
ds_read_b64_tr_b16 v[8:9], v86 offset:0
ds_read_b64_tr_b16 v[10:11], v86 offset:8192
v_mfma_f32_16x16x32_bf16 a[228:231], v[32:35], v[64:67], a[228:231]
ds_read_b128 v[40:43], v82 offset:0
ds_read_b64_tr_b16 v[12:13], v86 offset:8
v_mfma_f32_16x16x32_bf16 a[232:235], v[32:35], v[68:71], a[232:235]
ds_read_b128 v[44:47], v82 offset:2048
ds_read_b64_tr_b16 v[14:15], v86 offset:8200
v_mfma_f32_16x16x32_bf16 a[236:239], v[32:35], v[72:75], a[236:239]
ds_read_b128 v[48:51], v82 offset:4096
ds_read_b128 v[52:55], v82 offset:6144
v_mfma_f32_16x16x32_bf16 v[248:251], v[32:35], v[76:79], v[248:251]
ds_read_b128 v[56:59], v82 offset:8192
v_mfma_f32_16x16x32_bf16 a[240:243], v[36:39], v[60:63], a[240:243]
ds_read_b64_tr_b16 v[16:17], v87 offset:0
v_mfma_f32_16x16x32_bf16 a[244:247], v[36:39], v[64:67], a[244:247]
ds_read_b64_tr_b16 v[18:19], v87 offset:8192
v_mfma_f32_16x16x32_bf16 a[248:251], v[36:39], v[68:71], a[248:251]
ds_read_b64_tr_b16 v[20:21], v87 offset:8
v_mfma_f32_16x16x32_bf16 a[252:255], v[36:39], v[72:75], a[252:255]
ds_read_b64_tr_b16 v[22:23], v87 offset:8200
v_mfma_f32_16x16x32_bf16 v[252:255], v[36:39], v[76:79], v[252:255]
L_qp_r5:
s_waitcnt lgkmcnt(4)
v_mfma_f32_16x16x32_bf16 a[0:3], v[8:11], v[40:43], a[0:3]
ds_read_b64_tr_b16 v[24:25], v86 offset:1024
v_mfma_f32_16x16x32_bf16 a[4:7], v[8:11], v[44:47], a[4:7]
s_add_u32 m0, s67, s71
v_mfma_f32_16x16x32_bf16 a[8:11], v[8:11], v[48:51], a[8:11]
ds_read_b64_tr_b16 v[26:27], v86 offset:9216
v_mfma_f32_16x16x32_bf16 a[12:15], v[8:11], v[52:55], a[12:15]
buffer_load_dwordx4 v91, s[16:19], s24 offen offset:0 lds
v_mfma_f32_16x16x32_bf16 v[192:195], v[8:11], v[56:59], v[192:195]
ds_read_b64_tr_b16 v[28:29], v86 offset:1032
v_mfma_f32_16x16x32_bf16 a[16:19], v[12:15], v[40:43], a[16:19]
v_mfma_f32_16x16x32_bf16 a[20:23], v[12:15], v[44:47], a[20:23]
ds_read_b64_tr_b16 v[30:31], v86 offset:9224
v_mfma_f32_16x16x32_bf16 a[24:27], v[12:15], v[48:51], a[24:27]
v_mfma_f32_16x16x32_bf16 a[28:31], v[12:15], v[52:55], a[28:31]
v_mfma_f32_16x16x32_bf16 v[196:199], v[12:15], v[56:59], v[196:199]
s_waitcnt lgkmcnt(4)
buffer_load_dwordx4 v91, s[16:19], s25 offen offset:1024 lds
v_mfma_f32_16x16x32_bf16 a[32:35], v[16:19], v[40:43], a[32:35]
ds_read_b64_tr_b16 v[32:33], v87 offset:1024
v_mfma_f32_16x16x32_bf16 a[36:39], v[16:19], v[44:47], a[36:39]
v_mfma_f32_16x16x32_bf16 a[40:43], v[16:19], v[48:51], a[40:43]
ds_read_b64_tr_b16 v[34:35], v87 offset:9216
v_mfma_f32_16x16x32_bf16 a[44:47], v[16:19], v[52:55], a[44:47]
v_mfma_f32_16x16x32_bf16 v[200:203], v[16:19], v[56:59], v[200:203]
ds_read_b64_tr_b16 v[36:37], v87 offset:1032
v_mfma_f32_16x16x32_bf16 a[48:51], v[20:23], v[40:43], a[48:51]
v_mfma_f32_16x16x32_bf16 a[52:55], v[20:23], v[44:47], a[52:55]
ds_read_b64_tr_b16 v[38:39], v87 offset:9224
buffer_load_dwordx4 v91, s[16:19], s26 offen offset:2048 lds
v_mfma_f32_16x16x32_bf16 a[56:59], v[20:23], v[48:51], a[56:59]
v_mfma_f32_16x16x32_bf16 a[60:63], v[20:23], v[52:55], a[60:63]
v_mfma_f32_16x16x32_bf16 v[204:207], v[20:23], v[56:59], v[204:207]
s_waitcnt lgkmcnt(4)
v_mfma_f32_16x16x32_bf16 a[64:67], v[24:27], v[40:43], a[64:67]
ds_read_b64_tr_b16 v[8:9], v86 offset:2048
v_mfma_f32_16x16x32_bf16 a[68:71], v[24:27], v[44:47], a[68:71]
v_mfma_f32_16x16x32_bf16 a[72:75], v[24:27], v[48:51], a[72:75]
ds_read_b64_tr_b16 v[10:11], v86 offset:10240
v_mfma_f32_16x16x32_bf16 a[76:79], v[24:27], v[52:55], a[76:79]
buffer_load_dwordx4 v91, s[16:19], 0 offen offset:3072 lds
v_mfma_f32_16x16x32_bf16 v[208:211], v[24:27], v[56:59], v[208:211]
ds_read_b64_tr_b16 v[12:13], v86 offset:2056
v_mfma_f32_16x16x32_bf16 a[80:83], v[28:31], v[40:43], a[80:83]
s_add_u32 s16, s16, 262144
s_addc_u32 s17, s17, 0
v_mfma_f32_16x16x32_bf16 a[84:87], v[28:31], v[44:47], a[84:87]
ds_read_b64_tr_b16 v[14:15], v86 offset:10248
v_mfma_f32_16x16x32_bf16 a[88:91], v[28:31], v[48:51], a[88:91]
s_mov_b32 m0, s75
s_add_u32 s75, s75, 1024
v_mfma_f32_16x16x32_bf16 a[92:95], v[28:31], v[52:55], a[92:95]
v_mfma_f32_16x16x32_bf16 v[212:215], v[28:31], v[56:59], v[212:215]
s_waitcnt lgkmcnt(4)
v_mfma_f32_16x16x32_bf16 a[96:99], v[32:35], v[40:43], a[96:99]
ds_read_b64_tr_b16 v[16:17], v87 offset:2048
buffer_load_dwordx4 v90, s[12:15], s63 offen offset:0 lds
v_mfma_f32_16x16x32_bf16 a[100:103], v[32:35], v[44:47], a[100:103]
v_mfma_f32_16x16x32_bf16 a[104:107], v[32:35], v[48:51], a[104:107]
ds_read_b64_tr_b16 v[18:19], v87 offset:10240
v_mfma_f32_16x16x32_bf16 a[108:111], v[32:35], v[52:55], a[108:111]
s_add_u32 s63, s63, 7168
v_mfma_f32_16x16x32_bf16 v[216:219], v[32:35], v[56:59], v[216:219]
ds_read_b64_tr_b16 v[20:21], v87 offset:2056
s_mov_b32 m0, s75
v_mfma_f32_16x16x32_bf16 a[112:115], v[36:39], v[40:43], a[112:115]
s_add_u32 s75, s75, 1024
v_mfma_f32_16x16x32_bf16 a[116:119], v[36:39], v[44:47], a[116:119]
ds_read_b64_tr_b16 v[22:23], v87 offset:10248
v_mfma_f32_16x16x32_bf16 a[120:123], v[36:39], v[48:51], a[120:123]
buffer_load_dwordx4 v90, s[12:15], s63 offen offset:0 lds
v_mfma_f32_16x16x32_bf16 a[124:127], v[36:39], v[52:55], a[124:127]
v_mfma_f32_16x16x32_bf16 v[220:223], v[36:39], v[56:59], v[220:223]
s_waitcnt lgkmcnt(4)
v_mfma_f32_16x16x32_bf16 a[128:131], v[8:11], v[40:43], a[128:131]
ds_read_b64_tr_b16 v[24:25], v86 offset:3072
s_add_u32 s63, s63, 7168
v_mfma_f32_16x16x32_bf16 a[132:135], v[8:11], v[44:47], a[132:135]
s_mov_b32 m0, s75
s_add_u32 s75, s75, 1024
v_mfma_f32_16x16x32_bf16 a[136:139], v[8:11], v[48:51], a[136:139]
ds_read_b64_tr_b16 v[26:27], v86 offset:11264
v_add_u32 v88, s62, v84
v_mfma_f32_16x16x32_bf16 a[140:143], v[8:11], v[52:55], a[140:143]
v_add_u32 v89, s62, v85
v_mfma_f32_16x16x32_bf16 v[224:227], v[8:11], v[56:59], v[224:227]
ds_read_b64_tr_b16 v[28:29], v86 offset:3080
buffer_load_dwordx4 v90, s[12:15], s63 offen offset:0 lds
v_mfma_f32_16x16x32_bf16 a[144:147], v[12:15], v[40:43], a[144:147]
v_mfma_f32_16x16x32_bf16 a[148:151], v[12:15], v[44:47], a[148:151]
ds_read_b64_tr_b16 v[30:31], v86 offset:11272
v_mfma_f32_16x16x32_bf16 a[152:155], v[12:15], v[48:51], a[152:155]
s_add_u32 s63, s63, 7168
v_mfma_f32_16x16x32_bf16 a[156:159], v[12:15], v[52:55], a[156:159]
s_mov_b32 m0, s75
s_add_u32 s75, s75, 1024
v_mfma_f32_16x16x32_bf16 v[228:231], v[12:15], v[56:59], v[228:231]
s_waitcnt lgkmcnt(4)
v_mfma_f32_16x16x32_bf16 a[160:163], v[16:19], v[40:43], a[160:163]
ds_read_b64_tr_b16 v[32:33], v87 offset:3072
v_mfma_f32_16x16x32_bf16 a[164:167], v[16:19], v[44:47], a[164:167]
buffer_load_dwordx4 v90, s[12:15], s63 offen offset:0 lds
v_mfma_f32_16x16x32_bf16 a[168:171], v[16:19], v[48:51], a[168:171]
ds_read_b64_tr_b16 v[34:35], v87 offset:11264
v_mfma_f32_16x16x32_bf16 a[172:175], v[16:19], v[52:55], a[172:175]
v_mfma_f32_16x16x32_bf16 v[232:235], v[16:19], v[56:59], v[232:235]
ds_read_b64_tr_b16 v[36:37], v87 offset:3080
s_add_u32 s63, s63, 7168
v_mfma_f32_16x16x32_bf16 a[176:179], v[20:23], v[40:43], a[176:179]
s_mov_b32 m0, s75
s_add_u32 s75, s75, 1024
v_mfma_f32_16x16x32_bf16 a[180:183], v[20:23], v[44:47], a[180:183]
ds_read_b64_tr_b16 v[38:39], v87 offset:11272
v_mfma_f32_16x16x32_bf16 a[184:187], v[20:23], v[48:51], a[184:187]
v_mfma_f32_16x16x32_bf16 a[188:191], v[20:23], v[52:55], a[188:191]
buffer_load_dwordx4 v90, s[12:15], s63 offen offset:0 lds
s_add_u32 s63, s63, 7168
v_mfma_f32_16x16x32_bf16 v[236:239], v[20:23], v[56:59], v[236:239]
s_waitcnt lgkmcnt(4)
s_add_u32 s68, s68, 128
v_mfma_f32_16x16x32_bf16 a[192:195], v[24:27], v[40:43], a[192:195]
s_xor_b32 s64, s64, s70
v_mfma_f32_16x16x32_bf16 a[196:199], v[24:27], v[44:47], a[196:199]
v_mfma_f32_16x16x32_bf16 a[200:203], v[24:27], v[48:51], a[200:203]
v_mfma_f32_16x16x32_bf16 a[204:207], v[24:27], v[52:55], a[204:207]
s_mov_b32 s65, s61
s_mov_b32 s61, s62
v_mfma_f32_16x16x32_bf16 v[240:243], v[24:27], v[56:59], v[240:243]
s_mov_b32 s62, s67
s_mov_b32 s67, s65
v_mfma_f32_16x16x32_bf16 a[208:211], v[28:31], v[40:43], a[208:211]
v_mfma_f32_16x16x32_bf16 a[212:215], v[28:31], v[44:47], a[212:215]
v_mfma_f32_16x16x32_bf16 a[216:219], v[28:31], v[48:51], a[216:219]
v_mfma_f32_16x16x32_bf16 a[220:223], v[28:31], v[52:55], a[220:223]
v_mfma_f32_16x16x32_bf16 v[244:247], v[28:31], v[56:59], v[244:247]
s_waitcnt vmcnt(14) lgkmcnt(0)
s_barrier
v_mfma_f32_16x16x32_bf16 a[224:227], v[32:35], v[40:43], a[224:227]
ds_read_b64_tr_b16 v[8:9], v88 offset:0
ds_read_b64_tr_b16 v[10:11], v88 offset:8192
v_mfma_f32_16x16x32_bf16 a[228:231], v[32:35], v[44:47], a[228:231]
ds_read_b128 v[60:63], v83 offset:0
ds_read_b64_tr_b16 v[12:13], v88 offset:8
v_mfma_f32_16x16x32_bf16 a[232:235], v[32:35], v[48:51], a[232:235]
ds_read_b128 v[64:67], v83 offset:2048
ds_read_b64_tr_b16 v[14:15], v88 offset:8200
v_mfma_f32_16x16x32_bf16 a[236:239], v[32:35], v[52:55], a[236:239]
ds_read_b128 v[68:71], v83 offset:4096
ds_read_b128 v[72:75], v83 offset:6144
v_mfma_f32_16x16x32_bf16 v[248:251], v[32:35], v[56:59], v[248:251]
ds_read_b128 v[76:79], v83 offset:8192
v_mfma_f32_16x16x32_bf16 a[240:243], v[36:39], v[40:43], a[240:243]
ds_read_b64_tr_b16 v[16:17], v89 offset:0
v_mfma_f32_16x16x32_bf16 a[244:247], v[36:39], v[44:47], a[244:247]
ds_read_b64_tr_b16 v[18:19], v89 offset:8192
v_mfma_f32_16x16x32_bf16 a[248:251], v[36:39], v[48:51], a[248:251]
ds_read_b64_tr_b16 v[20:21], v89 offset:8
v_mfma_f32_16x16x32_bf16 a[252:255], v[36:39], v[52:55], a[252:255]
ds_read_b64_tr_b16 v[22:23], v89 offset:8200
v_mfma_f32_16x16x32_bf16 v[252:255], v[36:39], v[56:59], v[252:255]
s_waitcnt lgkmcnt(4)
v_mfma_f32_16x16x32_bf16 a[0:3], v[8:11], v[60:63], a[0:3]
ds_read_b64_tr_b16 v[24:25], v88 offset:1024
v_mfma_f32_16x16x32_bf16 a[4:7], v[8:11], v[64:67], a[4:7]
s_add_u32 m0, s67, s71
v_mfma_f32_16x16x32_bf16 a[8:11], v[8:11], v[68:71], a[8:11]
ds_read_b64_tr_b16 v[26:27], v88 offset:9216
v_mfma_f32_16x16x32_bf16 a[12:15], v[8:11], v[72:75], a[12:15]
buffer_load_dwordx4 v91, s[16:19], s24 offen offset:0 lds
v_mfma_f32_16x16x32_bf16 v[192:195], v[8:11], v[76:79], v[192:195]
ds_read_b64_tr_b16 v[28:29], v88 offset:1032
v_mfma_f32_16x16x32_bf16 a[16:19], v[12:15], v[60:63], a[16:19]
v_mfma_f32_16x16x32_bf16 a[20:23], v[12:15], v[64:67], a[20:23]
ds_read_b64_tr_b16 v[30:31], v88 offset:9224
v_mfma_f32_16x16x32_bf16 a[24:27], v[12:15], v[68:71], a[24:27]
v_mfma_f32_16x16x32_bf16 a[28:31], v[12:15], v[72:75], a[28:31]
v_mfma_f32_16x16x32_bf16 v[196:199], v[12:15], v[76:79], v[196:199]
s_waitcnt lgkmcnt(4)
buffer_load_dwordx4 v91, s[16:19], s25 offen offset:1024 lds
v_mfma_f32_16x16x32_bf16 a[32:35], v[16:19], v[60:63], a[32:35]
ds_read_b64_tr_b16 v[32:33], v89 offset:1024
v_mfma_f32_16x16x32_bf16 a[36:39], v[16:19], v[64:67], a[36:39]
v_mfma_f32_16x16x32_bf16 a[40:43], v[16:19], v[68:71], a[40:43]
ds_read_b64_tr_b16 v[34:35], v89 offset:9216
v_mfma_f32_16x16x32_bf16 a[44:47], v[16:19], v[72:75], a[44:47]
v_mfma_f32_16x16x32_bf16 v[200:203], v[16:19], v[76:79], v[200:203]
ds_read_b64_tr_b16 v[36:37], v89 offset:1032
v_mfma_f32_16x16x32_bf16 a[48:51], v[20:23], v[60:63], a[48:51]
v_mfma_f32_16x16x32_bf16 a[52:55], v[20:23], v[64:67], a[52:55]
ds_read_b64_tr_b16 v[38:39], v89 offset:9224
buffer_load_dwordx4 v91, s[16:19], s26 offen offset:2048 lds
v_mfma_f32_16x16x32_bf16 a[56:59], v[20:23], v[68:71], a[56:59]
v_mfma_f32_16x16x32_bf16 a[60:63], v[20:23], v[72:75], a[60:63]
v_mfma_f32_16x16x32_bf16 v[204:207], v[20:23], v[76:79], v[204:207]
s_waitcnt lgkmcnt(4)
v_mfma_f32_16x16x32_bf16 a[64:67], v[24:27], v[60:63], a[64:67]
ds_read_b64_tr_b16 v[8:9], v88 offset:2048
v_mfma_f32_16x16x32_bf16 a[68:71], v[24:27], v[64:67], a[68:71]
v_mfma_f32_16x16x32_bf16 a[72:75], v[24:27], v[68:71], a[72:75]
ds_read_b64_tr_b16 v[10:11], v88 offset:10240
v_mfma_f32_16x16x32_bf16 a[76:79], v[24:27], v[72:75], a[76:79]
buffer_load_dwordx4 v91, s[16:19], 0 offen offset:3072 lds
v_mfma_f32_16x16x32_bf16 v[208:211], v[24:27], v[76:79], v[208:211]
ds_read_b64_tr_b16 v[12:13], v88 offset:2056
v_mfma_f32_16x16x32_bf16 a[80:83], v[28:31], v[60:63], a[80:83]
s_add_u32 s16, s16, 262144
s_addc_u32 s17, s17, 0
v_mfma_f32_16x16x32_bf16 a[84:87], v[28:31], v[64:67], a[84:87]
ds_read_b64_tr_b16 v[14:15], v88 offset:10248
s_mov_b32 s75, s64
v_mfma_f32_16x16x32_bf16 a[88:91], v[28:31], v[68:71], a[88:91]
s_mov_b32 s63, s68
s_mov_b32 m0, s75
v_mfma_f32_16x16x32_bf16 a[92:95], v[28:31], v[72:75], a[92:95]
s_add_u32 s75, s75, 1024
v_mfma_f32_16x16x32_bf16 v[212:215], v[28:31], v[76:79], v[212:215]
s_waitcnt lgkmcnt(4)
v_mfma_f32_16x16x32_bf16 a[96:99], v[32:35], v[60:63], a[96:99]
ds_read_b64_tr_b16 v[16:17], v89 offset:2048
buffer_load_dwordx4 v90, s[12:15], s63 offen offset:0 lds
v_mfma_f32_16x16x32_bf16 a[100:103], v[32:35], v[64:67], a[100:103]
v_mfma_f32_16x16x32_bf16 a[104:107], v[32:35], v[68:71], a[104:107]
ds_read_b64_tr_b16 v[18:19], v89 offset:10240
v_mfma_f32_16x16x32_bf16 a[108:111], v[32:35], v[72:75], a[108:111]
s_add_u32 s63, s63, 7168
v_mfma_f32_16x16x32_bf16 v[216:219], v[32:35], v[76:79], v[216:219]
ds_read_b64_tr_b16 v[20:21], v89 offset:2056
s_mov_b32 m0, s75
v_mfma_f32_16x16x32_bf16 a[112:115], v[36:39], v[60:63], a[112:115]
s_add_u32 s75, s75, 1024
v_mfma_f32_16x16x32_bf16 a[116:119], v[36:39], v[64:67], a[116:119]
ds_read_b64_tr_b16 v[22:23], v89 offset:10248
v_mfma_f32_16x16x32_bf16 a[120:123], v[36:39], v[68:71], a[120:123]
buffer_load_dwordx4 v90, s[12:15], s63 offen offset:0 lds
v_mfma_f32_16x16x32_bf16 a[124:127], v[36:39], v[72:75], a[124:127]
v_mfma_f32_16x16x32_bf16 v[220:223], v[36:39], v[76:79], v[220:223]
s_waitcnt lgkmcnt(4)
v_mfma_f32_16x16x32_bf16 a[128:131], v[8:11], v[60:63], a[128:131]
ds_read_b64_tr_b16 v[24:25], v88 offset:3072
s_add_u32 s63, s63, 7168
v_mfma_f32_16x16x32_bf16 a[132:135], v[8:11], v[64:67], a[132:135]
s_mov_b32 m0, s75
s_add_u32 s75, s75, 1024
v_mfma_f32_16x16x32_bf16 a[136:139], v[8:11], v[68:71], a[136:139]
ds_read_b64_tr_b16 v[26:27], v88 offset:11264
v_add_u32 v86, s62, v84
v_mfma_f32_16x16x32_bf16 a[140:143], v[8:11], v[72:75], a[140:143]
v_add_u32 v87, s62, v85
v_add_u32 v82, s60, v80
v_mfma_f32_16x16x32_bf16 v[224:227], v[8:11], v[76:79], v[224:227]
ds_read_b64_tr_b16 v[28:29], v88 offset:3080
buffer_load_dwordx4 v90, s[12:15], s63 offen offset:0 lds
v_mfma_f32_16x16x32_bf16 a[144:147], v[12:15], v[60:63], a[144:147]
v_add_u32 v83, s60, v81
s_xor_b32 s60, s60, 38912
v_mfma_f32_16x16x32_bf16 a[148:151], v[12:15], v[64:67], a[148:151]
ds_read_b64_tr_b16 v[30:31], v88 offset:11272
v_mfma_f32_16x16x32_bf16 a[152:155], v[12:15], v[68:71], a[152:155]
s_add_u32 s63, s63, 7168
v_mfma_f32_16x16x32_bf16 a[156:159], v[12:15], v[72:75], a[156:159]
s_mov_b32 m0, s75
s_add_u32 s75, s75, 1024
v_mfma_f32_16x16x32_bf16 v[228:231], v[12:15], v[76:79], v[228:231]
s_waitcnt lgkmcnt(4)
v_mfma_f32_16x16x32_bf16 a[160:163], v[16:19], v[60:63], a[160:163]
ds_read_b64_tr_b16 v[32:33], v89 offset:3072
v_mfma_f32_16x16x32_bf16 a[164:167], v[16:19], v[64:67], a[164:167]
buffer_load_dwordx4 v90, s[12:15], s63 offen offset:0 lds
v_mfma_f32_16x16x32_bf16 a[168:171], v[16:19], v[68:71], a[168:171]
ds_read_b64_tr_b16 v[34:35], v89 offset:11264
v_mfma_f32_16x16x32_bf16 a[172:175], v[16:19], v[72:75], a[172:175]
v_mfma_f32_16x16x32_bf16 v[232:235], v[16:19], v[76:79], v[232:235]
ds_read_b64_tr_b16 v[36:37], v89 offset:3080
s_add_u32 s63, s63, 7168
v_mfma_f32_16x16x32_bf16 a[176:179], v[20:23], v[60:63], a[176:179]
s_mov_b32 m0, s75
s_add_u32 s75, s75, 1024
v_mfma_f32_16x16x32_bf16 a[180:183], v[20:23], v[64:67], a[180:183]
ds_read_b64_tr_b16 v[38:39], v89 offset:11272
v_mfma_f32_16x16x32_bf16 a[184:187], v[20:23], v[68:71], a[184:187]
v_mfma_f32_16x16x32_bf16 a[188:191], v[20:23], v[72:75], a[188:191]
buffer_load_dwordx4 v90, s[12:15], s63 offen offset:0 lds
s_add_u32 s63, s63, 7168
v_mfma_f32_16x16x32_bf16 v[236:239], v[20:23], v[76:79], v[236:239]
s_waitcnt lgkmcnt(4)
v_mfma_f32_16x16x32_bf16 a[192:195], v[24:27], v[60:63], a[192:195]
v_mfma_f32_16x16x32_bf16 a[196:199], v[24:27], v[64:67], a[196:199]
v_mfma_f32_16x16x32_bf16 a[200:203], v[24:27], v[68:71], a[200:203]
v_mfma_f32_16x16x32_bf16 a[204:207], v[24:27], v[72:75], a[204:207]
s_mov_b32 s65, s61
s_mov_b32 s61, s62
v_mfma_f32_16x16x32_bf16 v[240:243], v[24:27], v[76:79], v[240:243]
s_mov_b32 s62, s67
s_mov_b32 s67, s65
v_mfma_f32_16x16x32_bf16 a[208:211], v[28:31], v[60:63], a[208:211]
v_mfma_f32_16x16x32_bf16 a[212:215], v[28:31], v[64:67], a[212:215]
v_mfma_f32_16x16x32_bf16 a[216:219], v[28:31], v[68:71], a[216:219]
v_mfma_f32_16x16x32_bf16 a[220:223], v[28:31], v[72:75], a[220:223]
v_mfma_f32_16x16x32_bf16 v[244:247], v[28:31], v[76:79], v[244:247]
s_waitcnt vmcnt(9) lgkmcnt(0)
s_barrier
v_mfma_f32_16x16x32_bf16 a[224:227], v[32:35], v[60:63], a[224:227]
ds_read_b64_tr_b16 v[8:9], v86 offset:0
ds_read_b64_tr_b16 v[10:11], v86 offset:8192
v_mfma_f32_16x16x32_bf16 a[228:231], v[32:35], v[64:67], a[228:231]
ds_read_b128 v[40:43], v82 offset:0
ds_read_b64_tr_b16 v[12:13], v86 offset:8
v_mfma_f32_16x16x32_bf16 a[232:235], v[32:35], v[68:71], a[232:235]
ds_read_b128 v[44:47], v82 offset:2048
ds_read_b64_tr_b16 v[14:15], v86 offset:8200
v_mfma_f32_16x16x32_bf16 a[236:239], v[32:35], v[72:75], a[236:239]
ds_read_b128 v[48:51], v82 offset:4096
ds_read_b128 v[52:55], v82 offset:6144
v_mfma_f32_16x16x32_bf16 v[248:251], v[32:35], v[76:79], v[248:251]
ds_read_b128 v[56:59], v82 offset:8192
v_mfma_f32_16x16x32_bf16 a[240:243], v[36:39], v[60:63], a[240:243]
ds_read_b64_tr_b16 v[16:17], v87 offset:0
v_mfma_f32_16x16x32_bf16 a[244:247], v[36:39], v[64:67], a[244:247]
ds_read_b64_tr_b16 v[18:19], v87 offset:8192
v_mfma_f32_16x16x32_bf16 a[248:251], v[36:39], v[68:71], a[248:251]
ds_read_b64_tr_b16 v[20:21], v87 offset:8
v_mfma_f32_16x16x32_bf16 a[252:255], v[36:39], v[72:75], a[252:255]
ds_read_b64_tr_b16 v[22:23], v87 offset:8200
v_mfma_f32_16x16x32_bf16 v[252:255], v[36:39], v[76:79], v[252:255]
s_sub_u32 s32, s32, 1
s_cmp_lg_u32 s32, 0
s_cbranch_scc1 L_qp_r5
s_waitcnt lgkmcnt(4)
v_mfma_f32_16x16x32_bf16 a[0:3], v[8:11], v[40:43], a[0:3]
ds_read_b64_tr_b16 v[24:25], v86 offset:1024
v_mfma_f32_16x16x32_bf16 a[4:7], v[8:11], v[44:47], a[4:7]
s_add_u32 m0, s67, s71
v_mfma_f32_16x16x32_bf16 a[8:11], v[8:11], v[48:51], a[8:11]
ds_read_b64_tr_b16 v[26:27], v86 offset:9216
v_mfma_f32_16x16x32_bf16 a[12:15], v[8:11], v[52:55], a[12:15]
buffer_load_dwordx4 v91, s[16:19], s24 offen offset:0 lds
v_mfma_f32_16x16x32_bf16 v[192:195], v[8:11], v[56:59], v[192:195]
ds_read_b64_tr_b16 v[28:29], v86 offset:1032
v_mfma_f32_16x16x32_bf16 a[16:19], v[12:15], v[40:43], a[16:19]
v_mfma_f32_16x16x32_bf16 a[20:23], v[12:15], v[44:47], a[20:23]
ds_read_b64_tr_b16 v[30:31], v86 offset:9224
v_mfma_f32_16x16x32_bf16 a[24:27], v[12:15], v[48:51], a[24:27]
v_mfma_f32_16x16x32_bf16 a[28:31], v[12:15], v[52:55], a[28:31]
v_mfma_f32_16x16x32_bf16 v[196:199], v[12:15], v[56:59], v[196:199]
s_waitcnt lgkmcnt(4)
buffer_load_dwordx4 v91, s[16:19], s25 offen offset:1024 lds
v_mfma_f32_16x16x32_bf16 a[32:35], v[16:19], v[40:43], a[32:35]
ds_read_b64_tr_b16 v[32:33], v87 offset:1024
v_mfma_f32_16x16x32_bf16 a[36:39], v[16:19], v[44:47], a[36:39]
v_mfma_f32_16x16x32_bf16 a[40:43], v[16:19], v[48:51], a[40:43]
ds_read_b64_tr_b16 v[34:35], v87 offset:9216
v_mfma_f32_16x16x32_bf16 a[44:47], v[16:19], v[52:55], a[44:47]
v_mfma_f32_16x16x32_bf16 v[200:203], v[16:19], v[56:59], v[200:203]
ds_read_b64_tr_b16 v[36:37], v87 offset:1032
v_mfma_f32_16x16x32_bf16 a[48:51], v[20:23], v[40:43], a[48:51]
v_mfma_f32_16x16x32_bf16 a[52:55], v[20:23], v[44:47], a[52:55]
ds_read_b64_tr_b16 v[38:39], v87 offset:9224
buffer_load_dwordx4 v91, s[16:19], s26 offen offset:2048 lds
v_mfma_f32_16x16x32_bf16 a[56:59], v[20:23], v[48:51], a[56:59]
v_mfma_f32_16x16x32_bf16 a[60:63], v[20:23], v[52:55], a[60:63]
v_mfma_f32_16x16x32_bf16 v[204:207], v[20:23], v[56:59], v[204:207]
s_waitcnt lgkmcnt(4)
v_mfma_f32_16x16x32_bf16 a[64:67], v[24:27], v[40:43], a[64:67]
ds_read_b64_tr_b16 v[8:9], v86 offset:2048
v_mfma_f32_16x16x32_bf16 a[68:71], v[24:27], v[44:47], a[68:71]
v_mfma_f32_16x16x32_bf16 a[72:75], v[24:27], v[48:51], a[72:75]
ds_read_b64_tr_b16 v[10:11], v86 offset:10240
v_mfma_f32_16x16x32_bf16 a[76:79], v[24:27], v[52:55], a[76:79]
buffer_load_dwordx4 v91, s[16:19], 0 offen offset:3072 lds
v_mfma_f32_16x16x32_bf16 v[208:211], v[24:27], v[56:59], v[208:211]
ds_read_b64_tr_b16 v[12:13], v86 offset:2056
v_mfma_f32_16x16x32_bf16 a[80:83], v[28:31], v[40:43], a[80:83]
s_add_u32 s16, s16, 262144
s_addc_u32 s17, s17, 0
v_mfma_f32_16x16x32_bf16 a[84:87], v[28:31], v[44:47], a[84:87]
ds_read_b64_tr_b16 v[14:15], v86 offset:10248
v_mfma_f32_16x16x32_bf16 a[88:91], v[28:31], v[48:51], a[88:91]
s_mov_b32 m0, s75
s_add_u32 s75, s75, 1024
v_mfma_f32_16x16x32_bf16 a[92:95], v[28:31], v[52:55], a[92:95]
v_mfma_f32_16x16x32_bf16 v[212:215], v[28:31], v[56:59], v[212:215]
s_waitcnt lgkmcnt(4)
v_mfma_f32_16x16x32_bf16 a[96:99], v[32:35], v[40:43], a[96:99]
ds_read_b64_tr_b16 v[16:17], v87 offset:2048
buffer_load_dwordx4 v90, s[12:15], s63 offen offset:0 lds
v_mfma_f32_16x16x32_bf16 a[100:103], v[32:35], v[44:47], a[100:103]
v_mfma_f32_16x16x32_bf16 a[104:107], v[32:35], v[48:51], a[104:107]
ds_read_b64_tr_b16 v[18:19], v87 offset:10240
v_mfma_f32_16x16x32_bf16 a[108:111], v[32:35], v[52:55], a[108:111]
s_add_u32 s63, s63, 7168
v_mfma_f32_16x16x32_bf16 v[216:219], v[32:35], v[56:59], v[216:219]
ds_read_b64_tr_b16 v[20:21], v87 offset:2056
s_mov_b32 m0, s75
v_mfma_f32_16x16x32_bf16 a[112:115], v[36:39], v[40:43], a[112:115]
s_add_u32 s75, s75, 1024
v_mfma_f32_16x16x32_bf16 a[116:119], v[36:39], v[44:47], a[116:119]
ds_read_b64_tr_b16 v[22:23], v87 offset:10248
v_mfma_f32_16x16x32_bf16 a[120:123], v[36:39], v[48:51], a[120:123]
buffer_load_dwordx4 v90, s[12:15], s63 offen offset:0 lds
v_mfma_f32_16x16x32_bf16 a[124:127], v[36:39], v[52:55], a[124:127]
v_mfma_f32_16x16x32_bf16 v[220:223], v[36:39], v[56:59], v[220:223]
s_waitcnt lgkmcnt(4)
v_mfma_f32_16x16x32_bf16 a[128:131], v[8:11], v[40:43], a[128:131]
ds_read_b64_tr_b16 v[24:25], v86 offset:3072
s_add_u32 s63, s63, 7168
v_mfma_f32_16x16x32_bf16 a[132:135], v[8:11], v[44:47], a[132:135]
s_mov_b32 m0, s75
s_add_u32 s75, s75, 1024
v_mfma_f32_16x16x32_bf16 a[136:139], v[8:11], v[48:51], a[136:139]
ds_read_b64_tr_b16 v[26:27], v86 offset:11264
v_add_u32 v88, s62, v84
v_mfma_f32_16x16x32_bf16 a[140:143], v[8:11], v[52:55], a[140:143]
v_add_u32 v89, s62, v85
v_mfma_f32_16x16x32_bf16 v[224:227], v[8:11], v[56:59], v[224:227]
ds_read_b64_tr_b16 v[28:29], v86 offset:3080
buffer_load_dwordx4 v90, s[12:15], s63 offen offset:0 lds
v_mfma_f32_16x16x32_bf16 a[144:147], v[12:15], v[40:43], a[144:147]
v_mfma_f32_16x16x32_bf16 a[148:151], v[12:15], v[44:47], a[148:151]
ds_read_b64_tr_b16 v[30:31], v86 offset:11272
v_mfma_f32_16x16x32_bf16 a[152:155], v[12:15], v[48:51], a[152:155]
s_add_u32 s63, s63, 7168
v_mfma_f32_16x16x32_bf16 a[156:159], v[12:15], v[52:55], a[156:159]
s_mov_b32 m0, s75
s_add_u32 s75, s75, 1024
v_mfma_f32_16x16x32_bf16 v[228:231], v[12:15], v[56:59], v[228:231]
s_waitcnt lgkmcnt(4)
v_mfma_f32_16x16x32_bf16 a[160:163], v[16:19], v[40:43], a[160:163]
ds_read_b64_tr_b16 v[32:33], v87 offset:3072
v_mfma_f32_16x16x32_bf16 a[164:167], v[16:19], v[44:47], a[164:167]
buffer_load_dwordx4 v90, s[12:15], s63 offen offset:0 lds
v_mfma_f32_16x16x32_bf16 a[168:171], v[16:19], v[48:51], a[168:171]
ds_read_b64_tr_b16 v[34:35], v87 offset:11264
v_mfma_f32_16x16x32_bf16 a[172:175], v[16:19], v[52:55], a[172:175]
v_mfma_f32_16x16x32_bf16 v[232:235], v[16:19], v[56:59], v[232:235]
ds_read_b64_tr_b16 v[36:37], v87 offset:3080
s_add_u32 s63, s63, 7168
v_mfma_f32_16x16x32_bf16 a[176:179], v[20:23], v[40:43], a[176:179]
s_mov_b32 m0, s75
s_add_u32 s75, s75, 1024
v_mfma_f32_16x16x32_bf16 a[180:183], v[20:23], v[44:47], a[180:183]
ds_read_b64_tr_b16 v[38:39], v87 offset:11272
v_mfma_f32_16x16x32_bf16 a[184:187], v[20:23], v[48:51], a[184:187]
v_mfma_f32_16x16x32_bf16 a[188:191], v[20:23], v[52:55], a[188:191]
buffer_load_dwordx4 v90, s[12:15], s63 offen offset:0 lds
s_add_u32 s63, s63, 7168
v_mfma_f32_16x16x32_bf16 v[236:239], v[20:23], v[56:59], v[236:239]
s_waitcnt lgkmcnt(4)
s_add_u32 s68, s68, 128
v_mfma_f32_16x16x32_bf16 a[192:195], v[24:27], v[40:43], a[192:195]
s_xor_b32 s64, s64, s70
v_mfma_f32_16x16x32_bf16 a[196:199], v[24:27], v[44:47], a[196:199]
v_mfma_f32_16x16x32_bf16 a[200:203], v[24:27], v[48:51], a[200:203]
v_mfma_f32_16x16x32_bf16 a[204:207], v[24:27], v[52:55], a[204:207]
s_mov_b32 s65, s61
s_mov_b32 s61, s62
v_mfma_f32_16x16x32_bf16 v[240:243], v[24:27], v[56:59], v[240:243]
s_mov_b32 s62, s67
s_mov_b32 s67, s65
v_mfma_f32_16x16x32_bf16 a[208:211], v[28:31], v[40:43], a[208:211]
v_mfma_f32_16x16x32_bf16 a[212:215], v[28:31], v[44:47], a[212:215]
v_mfma_f32_16x16x32_bf16 a[216:219], v[28:31], v[48:51], a[216:219]
v_mfma_f32_16x16x32_bf16 a[220:223], v[28:31], v[52:55], a[220:223]
v_mfma_f32_16x16x32_bf16 v[244:247], v[28:31], v[56:59], v[244:247]
s_waitcnt vmcnt(14) lgkmcnt(0)
s_barrier
v_mfma_f32_16x16x32_bf16 a[224:227], v[32:35], v[40:43], a[224:227]
ds_read_b64_tr_b16 v[8:9], v88 offset:0
ds_read_b64_tr_b16 v[10:11], v88 offset:8192
v_mfma_f32_16x16x32_bf16 a[228:231], v[32:35], v[44:47], a[228:231]
ds_read_b128 v[60:63], v83 offset:0
ds_read_b64_tr_b16 v[12:13], v88 offset:8
v_mfma_f32_16x16x32_bf16 a[232:235], v[32:35], v[48:51], a[232:235]
ds_read_b128 v[64:67], v83 offset:2048
ds_read_b64_tr_b16 v[14:15], v88 offset:8200
v_mfma_f32_16x16x32_bf16 a[236:239], v[32:35], v[52:55], a[236:239]
ds_read_b128 v[68:71], v83 offset:4096
ds_read_b128 v[72:75], v83 offset:6144
v_mfma_f32_16x16x32_bf16 v[248:251], v[32:35], v[56:59], v[248:251]
ds_read_b128 v[76:79], v83 offset:8192
v_mfma_f32_16x16x32_bf16 a[240:243], v[36:39], v[40:43], a[240:243]
ds_read_b64_tr_b16 v[16:17], v89 offset:0
v_mfma_f32_16x16x32_bf16 a[244:247], v[36:39], v[44:47], a[244:247]
ds_read_b64_tr_b16 v[18:19], v89 offset:8192
v_mfma_f32_16x16x32_bf16 a[248:251], v[36:39], v[48:51], a[248:251]
ds_read_b64_tr_b16 v[20:21], v89 offset:8
v_mfma_f32_16x16x32_bf16 a[252:255], v[36:39], v[52:55], a[252:255]
ds_read_b64_tr_b16 v[22:23], v89 offset:8200
v_mfma_f32_16x16x32_bf16 v[252:255], v[36:39], v[56:59], v[252:255]
s_waitcnt lgkmcnt(4)
v_mfma_f32_16x16x32_bf16 a[0:3], v[8:11], v[60:63], a[0:3]
ds_read_b64_tr_b16 v[24:25], v88 offset:1024
v_mfma_f32_16x16x32_bf16 a[4:7], v[8:11], v[64:67], a[4:7]
s_add_u32 m0, s67, s71
v_mfma_f32_16x16x32_bf16 a[8:11], v[8:11], v[68:71], a[8:11]
ds_read_b64_tr_b16 v[26:27], v88 offset:9216
v_mfma_f32_16x16x32_bf16 a[12:15], v[8:11], v[72:75], a[12:15]
buffer_load_dwordx4 v91, s[16:19], s24 offen offset:0 lds
v_mfma_f32_16x16x32_bf16 v[192:195], v[8:11], v[76:79], v[192:195]
ds_read_b64_tr_b16 v[28:29], v88 offset:1032
v_mfma_f32_16x16x32_bf16 a[16:19], v[12:15], v[60:63], a[16:19]
v_mfma_f32_16x16x32_bf16 a[20:23], v[12:15], v[64:67], a[20:23]
ds_read_b64_tr_b16 v[30:31], v88 offset:9224
v_mfma_f32_16x16x32_bf16 a[24:27], v[12:15], v[68:71], a[24:27]
v_mfma_f32_16x16x32_bf16 a[28:31], v[12:15], v[72:75], a[28:31]
v_mfma_f32_16x16x32_bf16 v[196:199], v[12:15], v[76:79], v[196:199]
s_waitcnt lgkmcnt(4)
v_mfma_f32_16x16x32_bf16 a[32:35], v[16:19], v[60:63], a[32:35]
ds_read_b64_tr_b16 v[32:33], v89 offset:1024
v_mfma_f32_16x16x32_bf16 a[36:39], v[16:19], v[64:67], a[36:39]
buffer_load_dwordx4 v91, s[16:19], s25 offen offset:1024 lds
v_mfma_f32_16x16x32_bf16 a[40:43], v[16:19], v[68:71], a[40:43]
ds_read_b64_tr_b16 v[34:35], v89 offset:9216
v_mfma_f32_16x16x32_bf16 a[44:47], v[16:19], v[72:75], a[44:47]
v_mfma_f32_16x16x32_bf16 v[200:203], v[16:19], v[76:79], v[200:203]
ds_read_b64_tr_b16 v[36:37], v89 offset:1032
v_mfma_f32_16x16x32_bf16 a[48:51], v[20:23], v[60:63], a[48:51]
v_mfma_f32_16x16x32_bf16 a[52:55], v[20:23], v[64:67], a[52:55]
ds_read_b64_tr_b16 v[38:39], v89 offset:9224
v_mfma_f32_16x16x32_bf16 a[56:59], v[20:23], v[68:71], a[56:59]
v_mfma_f32_16x16x32_bf16 a[60:63], v[20:23], v[72:75], a[60:63]
v_mfma_f32_16x16x32_bf16 v[204:207], v[20:23], v[76:79], v[204:207]
s_waitcnt lgkmcnt(4)
buffer_load_dwordx4 v91, s[16:19], s26 offen offset:2048 lds
v_mfma_f32_16x16x32_bf16 a[64:67], v[24:27], v[60:63], a[64:67]
ds_read_b64_tr_b16 v[8:9], v88 offset:2048
v_mfma_f32_16x16x32_bf16 a[68:71], v[24:27], v[64:67], a[68:71]
v_mfma_f32_16x16x32_bf16 a[72:75], v[24:27], v[68:71], a[72:75]
ds_read_b64_tr_b16 v[10:11], v88 offset:10240
v_mfma_f32_16x16x32_bf16 a[76:79], v[24:27], v[72:75], a[76:79]
v_mfma_f32_16x16x32_bf16 v[208:211], v[24:27], v[76:79], v[208:211]
ds_read_b64_tr_b16 v[12:13], v88 offset:2056
v_mfma_f32_16x16x32_bf16 a[80:83], v[28:31], v[60:63], a[80:83]
v_mfma_f32_16x16x32_bf16 a[84:87], v[28:31], v[64:67], a[84:87]
ds_read_b64_tr_b16 v[14:15], v88 offset:10248
v_mfma_f32_16x16x32_bf16 a[88:91], v[28:31], v[68:71], a[88:91]
buffer_load_dwordx4 v91, s[16:19], 0 offen offset:3072 lds
v_mfma_f32_16x16x32_bf16 a[92:95], v[28:31], v[72:75], a[92:95]
s_add_u32 m0, s72, 0
v_mfma_f32_16x16x32_bf16 v[212:215], v[28:31], v[76:79], v[212:215]
s_waitcnt lgkmcnt(4)
v_mfma_f32_16x16x32_bf16 a[96:99], v[32:35], v[60:63], a[96:99]
ds_read_b64_tr_b16 v[16:17], v89 offset:2048
buffer_load_dwordx4 v160, s[44:47], 0 offen offset:0 nt lds
v_mfma_f32_16x16x32_bf16 a[100:103], v[32:35], v[64:67], a[100:103]
s_add_u32 s16, s16, 262144
s_addc_u32 s17, s17, 0
v_mfma_f32_16x16x32_bf16 a[104:107], v[32:35], v[68:71], a[104:107]
ds_read_b64_tr_b16 v[18:19], v89 offset:10240
v_mfma_f32_16x16x32_bf16 a[108:111], v[32:35], v[72:75], a[108:111]
v_mfma_f32_16x16x32_bf16 v[216:219], v[32:35], v[76:79], v[216:219]
ds_read_b64_tr_b16 v[20:21], v89 offset:2056
buffer_load_dwordx4 v161, s[44:47], 0 offen offset:1024 nt lds
v_mfma_f32_16x16x32_bf16 a[112:115], v[36:39], v[60:63], a[112:115]
v_mfma_f32_16x16x32_bf16 a[116:119], v[36:39], v[64:67], a[116:119]
ds_read_b64_tr_b16 v[22:23], v89 offset:10248
v_mfma_f32_16x16x32_bf16 a[120:123], v[36:39], v[68:71], a[120:123]
v_mfma_f32_16x16x32_bf16 a[124:127], v[36:39], v[72:75], a[124:127]
buffer_load_dwordx4 v162, s[44:47], 0 offen offset:2048 nt lds
v_mfma_f32_16x16x32_bf16 v[220:223], v[36:39], v[76:79], v[220:223]
s_waitcnt lgkmcnt(4)
v_mfma_f32_16x16x32_bf16 a[128:131], v[8:11], v[60:63], a[128:131]
ds_read_b64_tr_b16 v[24:25], v88 offset:3072
v_add_u32 v86, s62, v84
v_mfma_f32_16x16x32_bf16 a[132:135], v[8:11], v[64:67], a[132:135]
v_add_u32 v87, s62, v85
v_add_u32 v82, s60, v80
v_mfma_f32_16x16x32_bf16 a[136:139], v[8:11], v[68:71], a[136:139]
ds_read_b64_tr_b16 v[26:27], v88 offset:11264
buffer_load_dwordx4 v163, s[44:47], 0 offen offset:3072 nt lds
v_mfma_f32_16x16x32_bf16 a[140:143], v[8:11], v[72:75], a[140:143]
v_add_u32 v83, s60, v81
s_xor_b32 s60, s60, 38912
v_mfma_f32_16x16x32_bf16 v[224:227], v[8:11], v[76:79], v[224:227]
ds_read_b64_tr_b16 v[28:29], v88 offset:3080
s_add_u32 m0, s72, 4096
v_mfma_f32_16x16x32_bf16 a[144:147], v[12:15], v[60:63], a[144:147]
v_mfma_f32_16x16x32_bf16 a[148:151], v[12:15], v[64:67], a[148:151]
ds_read_b64_tr_b16 v[30:31], v88 offset:11272
buffer_load_dwordx4 v164, s[44:47], 0 offen offset:0 nt lds
v_mfma_f32_16x16x32_bf16 a[152:155], v[12:15], v[68:71], a[152:155]
v_mfma_f32_16x16x32_bf16 a[156:159], v[12:15], v[72:75], a[156:159]
v_mfma_f32_16x16x32_bf16 v[228:231], v[12:15], v[76:79], v[228:231]
s_waitcnt lgkmcnt(4)
v_mfma_f32_16x16x32_bf16 a[160:163], v[16:19], v[60:63], a[160:163]
ds_read_b64_tr_b16 v[32:33], v89 offset:3072
buffer_load_dwordx4 v165, s[44:47], 0 offen offset:1024 nt lds
v_mfma_f32_16x16x32_bf16 a[164:167], v[16:19], v[64:67], a[164:167]
v_mfma_f32_16x16x32_bf16 a[168:171], v[16:19], v[68:71], a[168:171]
ds_read_b64_tr_b16 v[34:35], v89 offset:11264
v_mfma_f32_16x16x32_bf16 a[172:175], v[16:19], v[72:75], a[172:175]
v_mfma_f32_16x16x32_bf16 v[232:235], v[16:19], v[76:79], v[232:235]
ds_read_b64_tr_b16 v[36:37], v89 offset:3080
buffer_load_dwordx4 v166, s[44:47], 0 offen offset:2048 nt lds
v_mfma_f32_16x16x32_bf16 a[176:179], v[20:23], v[60:63], a[176:179]
v_mfma_f32_16x16x32_bf16 a[180:183], v[20:23], v[64:67], a[180:183]
ds_read_b64_tr_b16 v[38:39], v89 offset:11272
v_mfma_f32_16x16x32_bf16 a[184:187], v[20:23], v[68:71], a[184:187]
v_mfma_f32_16x16x32_bf16 a[188:191], v[20:23], v[72:75], a[188:191]
v_mfma_f32_16x16x32_bf16 v[236:239], v[20:23], v[76:79], v[236:239]
s_waitcnt lgkmcnt(4)
v_mfma_f32_16x16x32_bf16 a[192:195], v[24:27], v[60:63], a[192:195]
v_mfma_f32_16x16x32_bf16 a[196:199], v[24:27], v[64:67], a[196:199]
v_mfma_f32_16x16x32_bf16 a[200:203], v[24:27], v[68:71], a[200:203]
v_mfma_f32_16x16x32_bf16 a[204:207], v[24:27], v[72:75], a[204:207]
s_mov_b32 s65, s61
s_mov_b32 s61, s62
v_mfma_f32_16x16x32_bf16 v[240:243], v[24:27], v[76:79], v[240:243]
s_mov_b32 s62, s67
s_mov_b32 s67, s65
v_mfma_f32_16x16x32_bf16 a[208:211], v[28:31], v[60:63], a[208:211]
v_mfma_f32_16x16x32_bf16 a[212:215], v[28:31], v[64:67], a[212:215]
v_mfma_f32_16x16x32_bf16 a[216:219], v[28:31], v[68:71], a[216:219]
v_mfma_f32_16x16x32_bf16 a[220:223], v[28:31], v[72:75], a[220:223]
v_mfma_f32_16x16x32_bf16 v[244:247], v[28:31], v[76:79], v[244:247]
s_waitcnt vmcnt(11) lgkmcnt(0)
s_barrier
v_mfma_f32_16x16x32_bf16 a[224:227], v[32:35], v[60:63], a[224:227]
ds_read_b64_tr_b16 v[8:9], v86 offset:0
ds_read_b64_tr_b16 v[10:11], v86 offset:8192
v_mfma_f32_16x16x32_bf16 a[228:231], v[32:35], v[64:67], a[228:231]
ds_read_b128 v[40:43], v82 offset:0
ds_read_b64_tr_b16 v[12:13], v86 offset:8
v_mfma_f32_16x16x32_bf16 a[232:235], v[32:35], v[68:71], a[232:235]
ds_read_b128 v[44:47], v82 offset:2048
ds_read_b64_tr_b16 v[14:15], v86 offset:8200
v_mfma_f32_16x16x32_bf16 a[236:239], v[32:35], v[72:75], a[236:239]
ds_read_b128 v[48:51], v82 offset:4096
ds_read_b128 v[52:55], v82 offset:6144
v_mfma_f32_16x16x32_bf16 v[248:251], v[32:35], v[76:79], v[248:251]
ds_read_b128 v[56:59], v82 offset:8192
v_mfma_f32_16x16x32_bf16 a[240:243], v[36:39], v[60:63], a[240:243]
ds_read_b64_tr_b16 v[16:17], v87 offset:0
v_mfma_f32_16x16x32_bf16 a[244:247], v[36:39], v[64:67], a[244:247]
ds_read_b64_tr_b16 v[18:19], v87 offset:8192
v_mfma_f32_16x16x32_bf16 a[248:251], v[36:39], v[68:71], a[248:251]
ds_read_b64_tr_b16 v[20:21], v87 offset:8
v_mfma_f32_16x16x32_bf16 a[252:255], v[36:39], v[72:75], a[252:255]
ds_read_b64_tr_b16 v[22:23], v87 offset:8200
v_mfma_f32_16x16x32_bf16 v[252:255], v[36:39], v[76:79], v[252:255]
s_waitcnt lgkmcnt(4)
v_mfma_f32_16x16x32_bf16 a[0:3], v[8:11], v[40:43], a[0:3]
ds_read_b64_tr_b16 v[24:25], v86 offset:1024
v_mfma_f32_16x16x32_bf16 a[4:7], v[8:11], v[44:47], a[4:7]
s_add_u32 m0, s28, s71
v_mfma_f32_16x16x32_bf16 a[8:11], v[8:11], v[48:51], a[8:11]
ds_read_b64_tr_b16 v[26:27], v86 offset:9216
v_mfma_f32_16x16x32_bf16 a[12:15], v[8:11], v[52:55], a[12:15]
buffer_load_dwordx4 v7, s[4:7], s24 offen offset:0 nt lds
v_mfma_f32_16x16x32_bf16 v[192:195], v[8:11], v[56:59], v[192:195]
ds_read_b64_tr_b16 v[28:29], v86 offset:1032
v_mfma_f32_16x16x32_bf16 a[16:19], v[12:15], v[40:43], a[16:19]
v_mfma_f32_16x16x32_bf16 a[20:23], v[12:15], v[44:47], a[20:23]
ds_read_b64_tr_b16 v[30:31], v86 offset:9224
v_mfma_f32_16x16x32_bf16 a[24:27], v[12:15], v[48:51], a[24:27]
v_mfma_f32_16x16x32_bf16 a[28:31], v[12:15], v[52:55], a[28:31]
v_mfma_f32_16x16x32_bf16 v[196:199], v[12:15], v[56:59], v[196:199]
s_waitcnt lgkmcnt(4)
v_mfma_f32_16x16x32_bf16 a[32:35], v[16:19], v[40:43], a[32:35]
ds_read_b64_tr_b16 v[32:33], v87 offset:1024
v_mfma_f32_16x16x32_bf16 a[36:39], v[16:19], v[44:47], a[36:39]
v_mfma_f32_16x16x32_bf16 a[40:43], v[16:19], v[48:51], a[40:43]
ds_read_b64_tr_b16 v[34:35], v87 offset:9216
v_mfma_f32_16x16x32_bf16 a[44:47], v[16:19], v[52:55], a[44:47]
v_mfma_f32_16x16x32_bf16 v[200:203], v[16:19], v[56:59], v[200:203]
ds_read_b64_tr_b16 v[36:37], v87 offset:1032
v_mfma_f32_16x16x32_bf16 a[48:51], v[20:23], v[40:43], a[48:51]
v_mfma_f32_16x16x32_bf16 a[52:55], v[20:23], v[44:47], a[52:55]
ds_read_b64_tr_b16 v[38:39], v87 offset:9224
v_mfma_f32_16x16x32_bf16 a[56:59], v[20:23], v[48:51], a[56:59]
v_mfma_f32_16x16x32_bf16 a[60:63], v[20:23], v[52:55], a[60:63]
v_mfma_f32_16x16x32_bf16 v[204:207], v[20:23], v[56:59], v[204:207]
s_waitcnt lgkmcnt(4)
v_mfma_f32_16x16x32_bf16 a[64:67], v[24:27], v[40:43], a[64:67]
ds_read_b64_tr_b16 v[8:9], v86 offset:2048
v_mfma_f32_16x16x32_bf16 a[68:71], v[24:27], v[44:47], a[68:71]
buffer_load_dwordx4 v7, s[4:7], s25 offen offset:1024 nt lds
v_mfma_f32_16x16x32_bf16 a[72:75], v[24:27], v[48:51], a[72:75]
ds_read_b64_tr_b16 v[10:11], v86 offset:10240
v_mfma_f32_16x16x32_bf16 a[76:79], v[24:27], v[52:55], a[76:79]
v_mfma_f32_16x16x32_bf16 v[208:211], v[24:27], v[56:59], v[208:211]
ds_read_b64_tr_b16 v[12:13], v86 offset:2056
v_mfma_f32_16x16x32_bf16 a[80:83], v[28:31], v[40:43], a[80:83]
v_mfma_f32_16x16x32_bf16 a[84:87], v[28:31], v[44:47], a[84:87]
ds_read_b64_tr_b16 v[14:15], v86 offset:10248
v_mfma_f32_16x16x32_bf16 a[88:91], v[28:31], v[48:51], a[88:91]
v_mfma_f32_16x16x32_bf16 a[92:95], v[28:31], v[52:55], a[92:95]
v_mfma_f32_16x16x32_bf16 v[212:215], v[28:31], v[56:59], v[212:215]
s_waitcnt lgkmcnt(4)
v_mfma_f32_16x16x32_bf16 a[96:99], v[32:35], v[40:43], a[96:99]
ds_read_b64_tr_b16 v[16:17], v87 offset:2048
v_mfma_f32_16x16x32_bf16 a[100:103], v[32:35], v[44:47], a[100:103]
v_mfma_f32_16x16x32_bf16 a[104:107], v[32:35], v[48:51], a[104:107]
ds_read_b64_tr_b16 v[18:19], v87 offset:10240
v_mfma_f32_16x16x32_bf16 a[108:111], v[32:35], v[52:55], a[108:111]
v_mfma_f32_16x16x32_bf16 v[216:219], v[32:35], v[56:59], v[216:219]
ds_read_b64_tr_b16 v[20:21], v87 offset:2056
v_mfma_f32_16x16x32_bf16 a[112:115], v[36:39], v[40:43], a[112:115]
v_mfma_f32_16x16x32_bf16 a[116:119], v[36:39], v[44:47], a[116:119]
ds_read_b64_tr_b16 v[22:23], v87 offset:10248
v_mfma_f32_16x16x32_bf16 a[120:123], v[36:39], v[48:51], a[120:123]
v_mfma_f32_16x16x32_bf16 a[124:127], v[36:39], v[52:55], a[124:127]
v_mfma_f32_16x16x32_bf16 v[220:223], v[36:39], v[56:59], v[220:223]
s_waitcnt lgkmcnt(4)
buffer_load_dwordx4 v7, s[4:7], s26 offen offset:2048 nt lds
v_mfma_f32_16x16x32_bf16 a[128:131], v[8:11], v[40:43], a[128:131]
ds_read_b64_tr_b16 v[24:25], v86 offset:3072
v_add_u32 v88, s62, v84
v_mfma_f32_16x16x32_bf16 a[132:135], v[8:11], v[44:47], a[132:135]
v_add_u32 v89, s62, v85
v_mfma_f32_16x16x32_bf16 a[136:139], v[8:11], v[48:51], a[136:139]
ds_read_b64_tr_b16 v[26:27], v86 offset:11264
v_mfma_f32_16x16x32_bf16 a[140:143], v[8:11], v[52:55], a[140:143]
v_mfma_f32_16x16x32_bf16 v[224:227], v[8:11], v[56:59], v[224:227]
ds_read_b64_tr_b16 v[28:29], v86 offset:3080
v_mfma_f32_16x16x32_bf16 a[144:147], v[12:15], v[40:43], a[144:147]
v_mfma_f32_16x16x32_bf16 a[148:151], v[12:15], v[44:47], a[148:151]
ds_read_b64_tr_b16 v[30:31], v86 offset:11272
v_mfma_f32_16x16x32_bf16 a[152:155], v[12:15], v[48:51], a[152:155]
v_mfma_f32_16x16x32_bf16 a[156:159], v[12:15], v[52:55], a[156:159]
v_mfma_f32_16x16x32_bf16 v[228:231], v[12:15], v[56:59], v[228:231]
s_waitcnt lgkmcnt(4)
v_mfma_f32_16x16x32_bf16 a[160:163], v[16:19], v[40:43], a[160:163]
ds_read_b64_tr_b16 v[32:33], v87 offset:3072
v_mfma_f32_16x16x32_bf16 a[164:167], v[16:19], v[44:47], a[164:167]
v_mfma_f32_16x16x32_bf16 a[168:171], v[16:19], v[48:51], a[168:171]
ds_read_b64_tr_b16 v[34:35], v87 offset:11264
v_mfma_f32_16x16x32_bf16 a[172:175], v[16:19], v[52:55], a[172:175]
v_mfma_f32_16x16x32_bf16 v[232:235], v[16:19], v[56:59], v[232:235]
ds_read_b64_tr_b16 v[36:37], v87 offset:3080
v_mfma_f32_16x16x32_bf16 a[176:179], v[20:23], v[40:43], a[176:179]
v_mfma_f32_16x16x32_bf16 a[180:183], v[20:23], v[44:47], a[180:183]
ds_read_b64_tr_b16 v[38:39], v87 offset:11272
v_mfma_f32_16x16x32_bf16 a[184:187], v[20:23], v[48:51], a[184:187]
v_mfma_f32_16x16x32_bf16 a[188:191], v[20:23], v[52:55], a[188:191]
buffer_load_dwordx4 v7, s[4:7], 0 offen offset:3072 nt lds
v_mfma_f32_16x16x32_bf16 v[236:239], v[20:23], v[56:59], v[236:239]
s_waitcnt lgkmcnt(4)
v_mfma_f32_16x16x32_bf16 a[192:195], v[24:27], v[40:43], a[192:195]
s_add_u32 s4, s4, 16384
s_addc_u32 s5, s5, 0
v_mfma_f32_16x16x32_bf16 a[196:199], v[24:27], v[44:47], a[196:199]
v_mfma_f32_16x16x32_bf16 a[200:203], v[24:27], v[48:51], a[200:203]
v_mfma_f32_16x16x32_bf16 a[204:207], v[24:27], v[52:55], a[204:207]
s_mov_b32 s65, s61
s_mov_b32 s61, s62
v_mfma_f32_16x16x32_bf16 v[240:243], v[24:27], v[56:59], v[240:243]
s_mov_b32 s62, s67
s_mov_b32 s67, s65
v_mfma_f32_16x16x32_bf16 a[208:211], v[28:31], v[40:43], a[208:211]
v_mfma_f32_16x16x32_bf16 a[212:215], v[28:31], v[44:47], a[212:215]
v_mfma_f32_16x16x32_bf16 a[216:219], v[28:31], v[48:51], a[216:219]
v_mfma_f32_16x16x32_bf16 a[220:223], v[28:31], v[52:55], a[220:223]
v_mfma_f32_16x16x32_bf16 v[244:247], v[28:31], v[56:59], v[244:247]
s_waitcnt vmcnt(11) lgkmcnt(0)
s_barrier
v_mfma_f32_16x16x32_bf16 a[224:227], v[32:35], v[40:43], a[224:227]
ds_read_b64_tr_b16 v[8:9], v88 offset:0
ds_read_b64_tr_b16 v[10:11], v88 offset:8192
v_mfma_f32_16x16x32_bf16 a[228:231], v[32:35], v[44:47], a[228:231]
ds_read_b128 v[60:63], v83 offset:0
ds_read_b64_tr_b16 v[12:13], v88 offset:8
v_mfma_f32_16x16x32_bf16 a[232:235], v[32:35], v[48:51], a[232:235]
ds_read_b128 v[64:67], v83 offset:2048
ds_read_b64_tr_b16 v[14:15], v88 offset:8200
v_mfma_f32_16x16x32_bf16 a[236:239], v[32:35], v[52:55], a[236:239]
ds_read_b128 v[68:71], v83 offset:4096
ds_read_b128 v[72:75], v83 offset:6144
v_mfma_f32_16x16x32_bf16 v[248:251], v[32:35], v[56:59], v[248:251]
ds_read_b128 v[76:79], v83 offset:8192
v_mfma_f32_16x16x32_bf16 a[240:243], v[36:39], v[40:43], a[240:243]
ds_read_b64_tr_b16 v[16:17], v89 offset:0
v_mfma_f32_16x16x32_bf16 a[244:247], v[36:39], v[44:47], a[244:247]
ds_read_b64_tr_b16 v[18:19], v89 offset:8192
v_mfma_f32_16x16x32_bf16 a[248:251], v[36:39], v[48:51], a[248:251]
ds_read_b64_tr_b16 v[20:21], v89 offset:8
v_mfma_f32_16x16x32_bf16 a[252:255], v[36:39], v[52:55], a[252:255]
ds_read_b64_tr_b16 v[22:23], v89 offset:8200
v_mfma_f32_16x16x32_bf16 v[252:255], v[36:39], v[56:59], v[252:255]
s_waitcnt lgkmcnt(4)
v_mfma_f32_16x16x32_bf16 a[0:3], v[8:11], v[60:63], a[0:3]
ds_read_b64_tr_b16 v[24:25], v88 offset:1024
v_mfma_f32_16x16x32_bf16 a[4:7], v[8:11], v[64:67], a[4:7]
s_mov_b32 m0, s30
v_mfma_f32_16x16x32_bf16 a[8:11], v[8:11], v[68:71], a[8:11]
s_waitcnt vmcnt(4)
ds_read_b64_tr_b16 v[26:27], v88 offset:9216
v_mfma_f32_16x16x32_bf16 a[12:15], v[8:11], v[72:75], a[12:15]
buffer_load_dwordx4 v7, s[8:11], s24 offen offset:0 nt lds
ds_read_b64_tr_b16 v[132:133], v167 offset:0
v_mfma_f32_16x16x32_bf16 v[192:195], v[8:11], v[76:79], v[192:195]
ds_read_b64_tr_b16 v[28:29], v88 offset:1032
v_mfma_f32_16x16x32_bf16 a[16:19], v[12:15], v[60:63], a[16:19]
v_mfma_f32_16x16x32_bf16 a[20:23], v[12:15], v[64:67], a[20:23]
ds_read_b64_tr_b16 v[30:31], v88 offset:9224
ds_read_b64_tr_b16 v[134:135], v167 offset:3584
v_mfma_f32_16x16x32_bf16 a[24:27], v[12:15], v[68:71], a[24:27]
v_mfma_f32_16x16x32_bf16 a[28:31], v[12:15], v[72:75], a[28:31]
v_mfma_f32_16x16x32_bf16 v[196:199], v[12:15], v[76:79], v[196:199]
s_waitcnt lgkmcnt(6)
v_mfma_f32_16x16x32_bf16 a[32:35], v[16:19], v[60:63], a[32:35]
ds_read_b64_tr_b16 v[32:33], v89 offset:1024
ds_read_b64_tr_b16 v[136:137], v167 offset:32
v_mfma_f32_16x16x32_bf16 a[36:39], v[16:19], v[64:67], a[36:39]
v_mfma_f32_16x16x32_bf16 a[40:43], v[16:19], v[68:71], a[40:43]
ds_read_b64_tr_b16 v[34:35], v89 offset:9216
v_mfma_f32_16x16x32_bf16 a[44:47], v[16:19], v[72:75], a[44:47]
v_mfma_f32_16x16x32_bf16 v[200:203], v[16:19], v[76:79], v[200:203]
ds_read_b64_tr_b16 v[36:37], v89 offset:1032
ds_read_b64_tr_b16 v[138:139], v167 offset:3616
v_mfma_f32_16x16x32_bf16 a[48:51], v[20:23], v[60:63], a[48:51]
v_mfma_f32_16x16x32_bf16 a[52:55], v[20:23], v[64:67], a[52:55]
ds_read_b64_tr_b16 v[38:39], v89 offset:9224
v_mfma_f32_16x16x32_bf16 a[56:59], v[20:23], v[68:71], a[56:59]
v_mfma_f32_16x16x32_bf16 a[60:63], v[20:23], v[72:75], a[60:63]
ds_read_b64_tr_b16 v[140:141], v167 offset:64
v_mfma_f32_16x16x32_bf16 v[204:207], v[20:23], v[76:79], v[204:207]
s_waitcnt lgkmcnt(8)
v_mfma_f32_16x16x32_bf16 a[64:67], v[24:27], v[60:63], a[64:67]
ds_read_b64_tr_b16 v[8:9], v88 offset:2048
v_mfma_f32_16x16x32_bf16 a[68:71], v[24:27], v[64:67], a[68:71]
buffer_load_dwordx4 v7, s[8:11], s25 offen offset:1024 nt lds
v_mfma_f32_16x16x32_bf16 a[72:75], v[24:27], v[68:71], a[72:75]
ds_read_b64_tr_b16 v[10:11], v88 offset:10240
ds_read_b64_tr_b16 v[142:143], v167 offset:3648
v_mfma_f32_16x16x32_bf16 a[76:79], v[24:27], v[72:75], a[76:79]
v_mfma_f32_16x16x32_bf16 v[208:211], v[24:27], v[76:79], v[208:211]
ds_read_b64_tr_b16 v[12:13], v88 offset:2056
v_mfma_f32_16x16x32_bf16 a[80:83], v[28:31], v[60:63], a[80:83]
v_mfma_f32_16x16x32_bf16 a[84:87], v[28:31], v[64:67], a[84:87]
ds_read_b64_tr_b16 v[14:15], v88 offset:10248
ds_read_b64_tr_b16 v[144:145], v167 offset:96
v_mfma_f32_16x16x32_bf16 a[88:91], v[28:31], v[68:71], a[88:91]
v_mfma_f32_16x16x32_bf16 a[92:95], v[28:31], v[72:75], a[92:95]
v_mfma_f32_16x16x32_bf16 v[212:215], v[28:31], v[76:79], v[212:215]
s_waitcnt lgkmcnt(7)
v_mfma_f32_16x16x32_bf16 a[96:99], v[32:35], v[60:63], a[96:99]
ds_read_b64_tr_b16 v[16:17], v89 offset:2048
ds_read_b64_tr_b16 v[146:147], v167 offset:3680
v_mfma_f32_16x16x32_bf16 a[100:103], v[32:35], v[64:67], a[100:103]
v_mfma_f32_16x16x32_bf16 a[104:107], v[32:35], v[68:71], a[104:107]
ds_read_b64_tr_b16 v[18:19], v89 offset:10240
v_mfma_f32_16x16x32_bf16 a[108:111], v[32:35], v[72:75], a[108:111]
v_mfma_f32_16x16x32_bf16 v[216:219], v[32:35], v[76:79], v[216:219]
ds_read_b64_tr_b16 v[20:21], v89 offset:2056
ds_read_b64_tr_b16 v[148:149], v167 offset:128
v_mfma_f32_16x16x32_bf16 a[112:115], v[36:39], v[60:63], a[112:115]
v_mfma_f32_16x16x32_bf16 a[116:119], v[36:39], v[64:67], a[116:119]
ds_read_b64_tr_b16 v[22:23], v89 offset:10248
v_mfma_f32_16x16x32_bf16 a[120:123], v[36:39], v[68:71], a[120:123]
v_mfma_f32_16x16x32_bf16 a[124:127], v[36:39], v[72:75], a[124:127]
s_waitcnt lgkmcnt(4)
ds_read_b64_tr_b16 v[150:151], v167 offset:3712
v_mfma_f32_16x16x32_bf16 v[220:223], v[36:39], v[76:79], v[220:223]
buffer_load_dwordx4 v7, s[8:11], s26 offen offset:2048 nt lds
v_mfma_f32_16x16x32_bf16 a[128:131], v[8:11], v[60:63], a[128:131]
ds_read_b64_tr_b16 v[24:25], v88 offset:3072
v_mfma_f32_16x16x32_bf16 a[132:135], v[8:11], v[64:67], a[132:135]
v_mfma_f32_16x16x32_bf16 a[136:139], v[8:11], v[68:71], a[136:139]
ds_read_b64_tr_b16 v[26:27], v88 offset:11264
ds_read_b64_tr_b16 v[152:153], v167 offset:160
v_mfma_f32_16x16x32_bf16 a[140:143], v[8:11], v[72:75], a[140:143]
v_mfma_f32_16x16x32_bf16 v[224:227], v[8:11], v[76:79], v[224:227]
ds_read_b64_tr_b16 v[28:29], v88 offset:3080
v_mfma_f32_16x16x32_bf16 a[144:147], v[12:15], v[60:63], a[144:147]
v_mfma_f32_16x16x32_bf16 a[148:151], v[12:15], v[64:67], a[148:151]
ds_read_b64_tr_b16 v[30:31], v88 offset:11272
ds_read_b64_tr_b16 v[154:155], v167 offset:3744
v_mfma_f32_16x16x32_bf16 a[152:155], v[12:15], v[68:71], a[152:155]
v_mfma_f32_16x16x32_bf16 a[156:159], v[12:15], v[72:75], a[156:159]
v_mfma_f32_16x16x32_bf16 v[228:231], v[12:15], v[76:79], v[228:231]
s_waitcnt lgkmcnt(7)
v_mfma_f32_16x16x32_bf16 a[160:163], v[16:19], v[60:63], a[160:163]
ds_read_b64_tr_b16 v[32:33], v89 offset:3072
v_mfma_f32_16x16x32_bf16 a[164:167], v[16:19], v[64:67], a[164:167]
ds_read_b64_tr_b16 v[156:157], v167 offset:192
v_mfma_f32_16x16x32_bf16 a[168:171], v[16:19], v[68:71], a[168:171]
ds_read_b64_tr_b16 v[34:35], v89 offset:11264
v_mfma_f32_16x16x32_bf16 a[172:175], v[16:19], v[72:75], a[172:175]
v_mfma_f32_16x16x32_bf16 v[232:235], v[16:19], v[76:79], v[232:235]
ds_read_b64_tr_b16 v[36:37], v89 offset:3080
ds_read_b64_tr_b16 v[158:159], v167 offset:3776
v_mfma_f32_16x16x32_bf16 a[176:179], v[20:23], v[60:63], a[176:179]
v_mfma_f32_16x16x32_bf16 a[180:183], v[20:23], v[64:67], a[180:183]
ds_read_b64_tr_b16 v[38:39], v89 offset:11272
v_mfma_f32_16x16x32_bf16 a[184:187], v[20:23], v[68:71], a[184:187]
v_mfma_f32_16x16x32_bf16 a[188:191], v[20:23], v[72:75], a[188:191]
buffer_load_dwordx4 v7, s[8:11], 0 offen offset:3072 nt lds
v_mfma_f32_16x16x32_bf16 v[236:239], v[20:23], v[76:79], v[236:239]
s_waitcnt lgkmcnt(7)
v_mfma_f32_16x16x32_bf16 a[192:195], v[24:27], v[60:63], a[192:195]
s_waitcnt lgkmcnt(1)
v_mfma_f32_16x16x32_bf16 a[196:199], v[24:27], v[64:67], a[196:199]
s_add_u32 s8, s8, 16384
s_addc_u32 s9, s9, 0
v_mfma_f32_16x16x32_bf16 a[200:203], v[24:27], v[68:71], a[200:203]
v_mfma_f32_16x16x32_bf16 a[204:207], v[24:27], v[72:75], a[204:207]
v_mfma_f32_16x16x32_bf16 v[240:243], v[24:27], v[76:79], v[240:243]
v_mfma_f32_16x16x32_bf16 a[208:211], v[28:31], v[60:63], a[208:211]
v_mfma_f32_16x16x32_bf16 a[212:215], v[28:31], v[64:67], a[212:215]
v_mfma_f32_16x16x32_bf16 a[216:219], v[28:31], v[68:71], a[216:219]
v_mfma_f32_16x16x32_bf16 a[220:223], v[28:31], v[72:75], a[220:223]
v_mfma_f32_16x16x32_bf16 v[244:247], v[28:31], v[76:79], v[244:247]
s_waitcnt lgkmcnt(0)
s_barrier
v_mfma_f32_16x16x32_bf16 a[224:227], v[32:35], v[60:63], a[224:227]
s_add_u32 m0, s29, s71
s_nop 0
v_mfma_f32_16x16x32_bf16 a[228:231], v[32:35], v[64:67], a[228:231]
buffer_load_dwordx4 v7, s[4:7], s24 offen offset:0 nt lds
buffer_load_dwordx4 v7, s[4:7], s25 offen offset:1024 nt lds
v_mfma_f32_16x16x32_bf16 a[232:235], v[32:35], v[68:71], a[232:235]
buffer_load_dwordx4 v7, s[4:7], s26 offen offset:2048 nt lds
buffer_load_dwordx4 v7, s[4:7], 0 offen offset:3072 nt lds
v_mfma_f32_16x16x32_bf16 a[236:239], v[32:35], v[72:75], a[236:239]
s_add_u32 s4, s4, 16384
s_addc_u32 s5, s5, 0
v_mfma_f32_16x16x32_bf16 v[248:251], v[32:35], v[76:79], v[248:251]
v_mfma_f32_16x16x32_bf16 a[240:243], v[36:39], v[60:63], a[240:243]
v_mfma_f32_16x16x32_bf16 a[244:247], v[36:39], v[64:67], a[244:247]
v_mfma_f32_16x16x32_bf16 a[248:251], v[36:39], v[68:71], a[248:251]
v_mfma_f32_16x16x32_bf16 a[252:255], v[36:39], v[72:75], a[252:255]
v_mfma_f32_16x16x32_bf16 v[252:255], v[36:39], v[76:79], v[252:255]
s_nop 7
v_mov_b32 v100, 0
v_mov_b32 v101, 0
v_mov_b32 v102, 0
v_mov_b32 v103, 0
v_mov_b32 v104, 0
v_mov_b32 v105, 0
v_mov_b32 v106, 0
v_mov_b32 v107, 0
v_mov_b32 v108, 0
v_mov_b32 v109, 0
v_mov_b32 v110, 0
v_mov_b32 v111, 0
v_mov_b32 v112, 0
v_mov_b32 v113, 0
v_mov_b32 v114, 0
v_mov_b32 v115, 0
v_mov_b32 v116, 0
v_mov_b32 v117, 0
v_mov_b32 v118, 0
v_mov_b32 v119, 0
v_mov_b32 v56, s39
v_mov_b32 v57, s39
v_accvgpr_read_b32 v40, a64
v_accvgpr_read_b32 v41, a65
v_accvgpr_read_b32 v42, a66
v_accvgpr_read_b32 v43, a67
v_accvgpr_read_b32 v44, a80
v_accvgpr_read_b32 v45, a81
v_accvgpr_read_b32 v46, a82
v_accvgpr_read_b32 v47, a83
buffer_store_dwordx4 v[132:135], v168, s[48:51], 0 offen offset:0 sc0 sc1
v_pk_mul_f32 v[40:41], v[40:41], v[56:57]
v_pk_mul_f32 v[42:43], v[42:43], v[56:57]
v_pk_mul_f32 v[44:45], v[44:45], v[56:57]
v_pk_mul_f32 v[46:47], v[46:47], v[56:57]
v_cvt_pk_bf16_f32 v60, v40, v41
v_cvt_pk_bf16_f32 v61, v42, v43
v_cvt_pk_bf16_f32 v62, v44, v45
v_cvt_pk_bf16_f32 v63, v46, v47
ds_write_b128 v6, v[60:63] offset:0
v_accvgpr_read_b32 v48, a68
v_accvgpr_read_b32 v49, a69
v_accvgpr_read_b32 v50, a70
v_accvgpr_read_b32 v51, a71
v_accvgpr_read_b32 v52, a84
v_accvgpr_read_b32 v53, a85
v_accvgpr_read_b32 v54, a86
v_accvgpr_read_b32 v55, a87
v_pk_mul_f32 v[48:49], v[48:49], v[56:57]
v_pk_mul_f32 v[50:51], v[50:51], v[56:57]
v_pk_mul_f32 v[52:53], v[52:53], v[56:57]
v_pk_mul_f32 v[54:55], v[54:55], v[56:57]
v_cvt_pk_bf16_f32 v64, v48, v49
v_cvt_pk_bf16_f32 v65, v50, v51
v_cvt_pk_bf16_f32 v66, v52, v53
v_cvt_pk_bf16_f32 v67, v54, v55
ds_write_b128 v6, v[64:67] offset:1024
v_accvgpr_read_b32 v40, a72
v_accvgpr_read_b32 v41, a73
v_accvgpr_read_b32 v42, a74
v_accvgpr_read_b32 v43, a75
v_accvgpr_read_b32 v44, a88
v_accvgpr_read_b32 v45, a89
v_accvgpr_read_b32 v46, a90
v_accvgpr_read_b32 v47, a91
v_pk_mul_f32 v[40:41], v[40:41], v[56:57]
v_pk_mul_f32 v[42:43], v[42:43], v[56:57]
v_pk_mul_f32 v[44:45], v[44:45], v[56:57]
v_pk_mul_f32 v[46:47], v[46:47], v[56:57]
v_cvt_pk_bf16_f32 v68, v40, v41
v_cvt_pk_bf16_f32 v69, v42, v43
v_cvt_pk_bf16_f32 v70, v44, v45
v_cvt_pk_bf16_f32 v71, v46, v47
ds_write_b128 v6, v[68:71] offset:2048
v_accvgpr_read_b32 v48, a76
v_accvgpr_read_b32 v49, a77
v_accvgpr_read_b32 v50, a78
v_accvgpr_read_b32 v51, a79
v_accvgpr_read_b32 v52, a92
v_accvgpr_read_b32 v53, a93
v_accvgpr_read_b32 v54, a94
v_accvgpr_read_b32 v55, a95
buffer_store_dwordx4 v[136:139], v168, s[48:51], 0 offen offset:1024 sc0 sc1
v_pk_mul_f32 v[48:49], v[48:49], v[56:57]
v_pk_mul_f32 v[50:51], v[50:51], v[56:57]
v_pk_mul_f32 v[52:53], v[52:53], v[56:57]
v_pk_mul_f32 v[54:55], v[54:55], v[56:57]
v_cvt_pk_bf16_f32 v72, v48, v49
v_cvt_pk_bf16_f32 v73, v50, v51
v_cvt_pk_bf16_f32 v74, v52, v53
v_cvt_pk_bf16_f32 v75, v54, v55
ds_write_b128 v6, v[72:75] offset:3072
v_pk_mul_f32 v[40:41], v[208:209], v[56:57]
v_pk_mul_f32 v[42:43], v[210:211], v[56:57]
v_pk_mul_f32 v[44:45], v[212:213], v[56:57]
v_pk_mul_f32 v[46:47], v[214:215], v[56:57]
v_cvt_pk_bf16_f32 v60, v40, v41
v_cvt_pk_bf16_f32 v61, v42, v43
v_cvt_pk_bf16_f32 v62, v44, v45
v_cvt_pk_bf16_f32 v63, v46, v47
ds_write_b128 v6, v[60:63] offset:4096
v_mfma_f32_32x32x16_bf16 a[64:79], v[100:103], v[100:103], 0
v_accvgpr_read_b32 v48, a96
v_accvgpr_read_b32 v49, a97
v_accvgpr_read_b32 v50, a98
v_accvgpr_read_b32 v51, a99
v_accvgpr_read_b32 v52, a112
v_accvgpr_read_b32 v53, a113
v_accvgpr_read_b32 v54, a114
v_accvgpr_read_b32 v55, a115
v_pk_mul_f32 v[48:49], v[48:49], v[56:57]
v_pk_mul_f32 v[50:51], v[50:51], v[56:57]
v_pk_mul_f32 v[52:53], v[52:53], v[56:57]
v_pk_mul_f32 v[54:55], v[54:55], v[56:57]
v_cvt_pk_bf16_f32 v64, v48, v49
v_cvt_pk_bf16_f32 v65, v50, v51
v_cvt_pk_bf16_f32 v66, v52, v53
v_cvt_pk_bf16_f32 v67, v54, v55
ds_write_b128 v6, v[64:67] offset:5120
v_mfma_f32_32x32x16_bf16 a[80:95], v[100:103], v[100:103], 0
v_accvgpr_read_b32 v40, a100
v_accvgpr_read_b32 v41, a101
v_accvgpr_read_b32 v42, a102
v_accvgpr_read_b32 v43, a103
v_accvgpr_read_b32 v44, a116
v_accvgpr_read_b32 v45, a117
v_accvgpr_read_b32 v46, a118
v_accvgpr_read_b32 v47, a119
buffer_store_dwordx4 v[140:143], v168, s[48:51], 0 offen offset:2048 sc0 sc1
v_pk_mul_f32 v[40:41], v[40:41], v[56:57]
v_pk_mul_f32 v[42:43], v[42:43], v[56:57]
v_pk_mul_f32 v[44:45], v[44:45], v[56:57]
v_pk_mul_f32 v[46:47], v[46:47], v[56:57]
v_cvt_pk_bf16_f32 v68, v40, v41
v_cvt_pk_bf16_f32 v69, v42, v43
v_cvt_pk_bf16_f32 v70, v44, v45
v_cvt_pk_bf16_f32 v71, v46, v47
ds_write_b128 v6, v[68:71] offset:6144
v_accvgpr_read_b32 v48, a104
v_accvgpr_read_b32 v49, a105
v_accvgpr_read_b32 v50, a106
v_accvgpr_read_b32 v51, a107
v_accvgpr_read_b32 v52, a120
v_accvgpr_read_b32 v53, a121
v_accvgpr_read_b32 v54, a122
v_accvgpr_read_b32 v55, a123
v_pk_mul_f32 v[48:49], v[48:49], v[56:57]
v_pk_mul_f32 v[50:51], v[50:51], v[56:57]
v_pk_mul_f32 v[52:53], v[52:53], v[56:57]
v_pk_mul_f32 v[54:55], v[54:55], v[56:57]
v_cvt_pk_bf16_f32 v72, v48, v49
v_cvt_pk_bf16_f32 v73, v50, v51
v_cvt_pk_bf16_f32 v74, v52, v53
v_cvt_pk_bf16_f32 v75, v54, v55
ds_write_b128 v6, v[72:75] offset:7168
v_accvgpr_read_b32 v40, a108
v_accvgpr_read_b32 v41, a109
v_accvgpr_read_b32 v42, a110
v_accvgpr_read_b32 v43, a111
v_accvgpr_read_b32 v44, a124
v_accvgpr_read_b32 v45, a125
v_accvgpr_read_b32 v46, a126
v_accvgpr_read_b32 v47, a127
v_pk_mul_f32 v[40:41], v[40:41], v[56:57]
v_pk_mul_f32 v[42:43], v[42:43], v[56:57]
v_pk_mul_f32 v[44:45], v[44:45], v[56:57]
v_pk_mul_f32 v[46:47], v[46:47], v[56:57]
v_cvt_pk_bf16_f32 v60, v40, v41
v_cvt_pk_bf16_f32 v61, v42, v43
v_cvt_pk_bf16_f32 v62, v44, v45
v_cvt_pk_bf16_f32 v63, v46, v47
ds_write_b128 v6, v[60:63] offset:8192
buffer_store_dwordx4 v[144:147], v168, s[48:51], 0 offen offset:3072 sc0 sc1
v_pk_mul_f32 v[48:49], v[216:217], v[56:57]
v_pk_mul_f32 v[50:51], v[218:219], v[56:57]
v_pk_mul_f32 v[52:53], v[220:221], v[56:57]
v_pk_mul_f32 v[54:55], v[222:223], v[56:57]
v_cvt_pk_bf16_f32 v64, v48, v49
v_cvt_pk_bf16_f32 v65, v50, v51
v_cvt_pk_bf16_f32 v66, v52, v53
v_cvt_pk_bf16_f32 v67, v54, v55
ds_write_b128 v6, v[64:67] offset:9216
v_mfma_f32_32x32x16_bf16 a[96:111], v[100:103], v[100:103], 0
v_accvgpr_read_b32 v40, a128
v_accvgpr_read_b32 v41, a129
v_accvgpr_read_b32 v42, a130
v_accvgpr_read_b32 v43, a131
v_accvgpr_read_b32 v44, a144
v_accvgpr_read_b32 v45, a145
v_accvgpr_read_b32 v46, a146
v_accvgpr_read_b32 v47, a147
v_pk_mul_f32 v[40:41], v[40:41], v[56:57]
v_pk_mul_f32 v[42:43], v[42:43], v[56:57]
v_pk_mul_f32 v[44:45], v[44:45], v[56:57]
v_pk_mul_f32 v[46:47], v[46:47], v[56:57]
v_cvt_pk_bf16_f32 v68, v40, v41
v_cvt_pk_bf16_f32 v69, v42, v43
v_cvt_pk_bf16_f32 v70, v44, v45
v_cvt_pk_bf16_f32 v71, v46, v47
ds_write_b128 v6, v[68:71] offset:10240
v_mfma_f32_32x32x16_bf16 a[112:127], v[100:103], v[100:103], 0
v_accvgpr_read_b32 v48, a132
v_accvgpr_read_b32 v49, a133
v_accvgpr_read_b32 v50, a134
v_accvgpr_read_b32 v51, a135
v_accvgpr_read_b32 v52, a148
v_accvgpr_read_b32 v53, a149
v_accvgpr_read_b32 v54, a150
v_accvgpr_read_b32 v55, a151
v_pk_mul_f32 v[48:49], v[48:49], v[56:57]
v_pk_mul_f32 v[50:51], v[50:51], v[56:57]
v_pk_mul_f32 v[52:53], v[52:53], v[56:57]
v_pk_mul_f32 v[54:55], v[54:55], v[56:57]
v_cvt_pk_bf16_f32 v72, v48, v49
v_cvt_pk_bf16_f32 v73, v50, v51
v_cvt_pk_bf16_f32 v74, v52, v53
v_cvt_pk_bf16_f32 v75, v54, v55
ds_write_b128 v6, v[72:75] offset:11264
v_mfma_f32_32x32x16_bf16 v[208:223], v[100:103], v[100:103], 0
v_accvgpr_read_b32 v40, a136
v_accvgpr_read_b32 v41, a137
v_accvgpr_read_b32 v42, a138
v_accvgpr_read_b32 v43, a139
v_accvgpr_read_b32 v44, a152
v_accvgpr_read_b32 v45, a153
v_accvgpr_read_b32 v46, a154
v_accvgpr_read_b32 v47, a155
buffer_store_dwordx4 v[148:151], v168, s[48:51], s73 offen offset:0 sc0 sc1
v_pk_mul_f32 v[40:41], v[40:41], v[56:57]
v_pk_mul_f32 v[42:43], v[42:43], v[56:57]
v_pk_mul_f32 v[44:45], v[44:45], v[56:57]
v_pk_mul_f32 v[46:47], v[46:47], v[56:57]
v_cvt_pk_bf16_f32 v60, v40, v41
v_cvt_pk_bf16_f32 v61, v42, v43
v_cvt_pk_bf16_f32 v62, v44, v45
v_cvt_pk_bf16_f32 v63, v46, v47
ds_write_b128 v6, v[60:63] offset:12288
v_accvgpr_read_b32 v48, a140
v_accvgpr_read_b32 v49, a141
v_accvgpr_read_b32 v50, a142
v_accvgpr_read_b32 v51, a143
v_accvgpr_read_b32 v52, a156
v_accvgpr_read_b32 v53, a157
v_accvgpr_read_b32 v54, a158
v_accvgpr_read_b32 v55, a159
v_pk_mul_f32 v[48:49], v[48:49], v[56:57]
v_pk_mul_f32 v[50:51], v[50:51], v[56:57]
v_pk_mul_f32 v[52:53], v[52:53], v[56:57]
v_pk_mul_f32 v[54:55], v[54:55], v[56:57]
v_cvt_pk_bf16_f32 v64, v48, v49
v_cvt_pk_bf16_f32 v65, v50, v51
v_cvt_pk_bf16_f32 v66, v52, v53
v_cvt_pk_bf16_f32 v67, v54, v55
ds_write_b128 v6, v[64:67] offset:13312
v_pk_mul_f32 v[40:41], v[224:225], v[56:57]
v_pk_mul_f32 v[42:43], v[226:227], v[56:57]
v_pk_mul_f32 v[44:45], v[228:229], v[56:57]
v_pk_mul_f32 v[46:47], v[230:231], v[56:57]
v_cvt_pk_bf16_f32 v68, v40, v41
v_cvt_pk_bf16_f32 v69, v42, v43
v_cvt_pk_bf16_f32 v70, v44, v45
v_cvt_pk_bf16_f32 v71, v46, v47
ds_write_b128 v6, v[68:71] offset:14336
v_mfma_f32_32x32x16_bf16 a[128:143], v[100:103], v[100:103], 0
v_accvgpr_read_b32 v48, a160
v_accvgpr_read_b32 v49, a161
v_accvgpr_read_b32 v50, a162
v_accvgpr_read_b32 v51, a163
v_accvgpr_read_b32 v52, a176
v_accvgpr_read_b32 v53, a177
v_accvgpr_read_b32 v54, a178
v_accvgpr_read_b32 v55, a179
buffer_store_dwordx4 v[152:155], v168, s[48:51], s73 offen offset:1024 sc0 sc1
v_pk_mul_f32 v[48:49], v[48:49], v[56:57]
v_pk_mul_f32 v[50:51], v[50:51], v[56:57]
v_pk_mul_f32 v[52:53], v[52:53], v[56:57]
v_pk_mul_f32 v[54:55], v[54:55], v[56:57]
v_cvt_pk_bf16_f32 v72, v48, v49
v_cvt_pk_bf16_f32 v73, v50, v51
v_cvt_pk_bf16_f32 v74, v52, v53
v_cvt_pk_bf16_f32 v75, v54, v55
ds_write_b128 v6, v[72:75] offset:15360
v_mfma_f32_32x32x16_bf16 a[144:159], v[100:103], v[100:103], 0
v_accvgpr_read_b32 v40, a164
v_accvgpr_read_b32 v41, a165
v_accvgpr_read_b32 v42, a166
v_accvgpr_read_b32 v43, a167
v_accvgpr_read_b32 v44, a180
v_accvgpr_read_b32 v45, a181
v_accvgpr_read_b32 v46, a182
v_accvgpr_read_b32 v47, a183
v_pk_mul_f32 v[40:41], v[40:41], v[56:57]
v_pk_mul_f32 v[42:43], v[42:43], v[56:57]
v_pk_mul_f32 v[44:45], v[44:45], v[56:57]
v_pk_mul_f32 v[46:47], v[46:47], v[56:57]
v_cvt_pk_bf16_f32 v60, v40, v41
v_cvt_pk_bf16_f32 v61, v42, v43
v_cvt_pk_bf16_f32 v62, v44, v45
v_cvt_pk_bf16_f32 v63, v46, v47
ds_write_b128 v6, v[60:63] offset:16384
v_accvgpr_read_b32 v48, a168
v_accvgpr_read_b32 v49, a169
v_accvgpr_read_b32 v50, a170
v_accvgpr_read_b32 v51, a171
v_accvgpr_read_b32 v52, a184
v_accvgpr_read_b32 v53, a185
v_accvgpr_read_b32 v54, a186
v_accvgpr_read_b32 v55, a187
v_pk_mul_f32 v[48:49], v[48:49], v[56:57]
v_pk_mul_f32 v[50:51], v[50:51], v[56:57]
v_pk_mul_f32 v[52:53], v[52:53], v[56:57]
v_pk_mul_f32 v[54:55], v[54:55], v[56:57]
v_cvt_pk_bf16_f32 v64, v48, v49
v_cvt_pk_bf16_f32 v65, v50, v51
v_cvt_pk_bf16_f32 v66, v52, v53
v_cvt_pk_bf16_f32 v67, v54, v55
ds_write_b128 v6, v[64:67] offset:17408
v_accvgpr_read_b32 v40, a172
v_accvgpr_read_b32 v41, a173
v_accvgpr_read_b32 v42, a174
v_accvgpr_read_b32 v43, a175
v_accvgpr_read_b32 v44, a188
v_accvgpr_read_b32 v45, a189
v_accvgpr_read_b32 v46, a190
v_accvgpr_read_b32 v47, a191
buffer_store_dwordx4 v[156:159], v168, s[48:51], s73 offen offset:2048 sc0 sc1
v_pk_mul_f32 v[40:41], v[40:41], v[56:57]
v_pk_mul_f32 v[42:43], v[42:43], v[56:57]
v_pk_mul_f32 v[44:45], v[44:45], v[56:57]
v_pk_mul_f32 v[46:47], v[46:47], v[56:57]
v_cvt_pk_bf16_f32 v68, v40, v41
v_cvt_pk_bf16_f32 v69, v42, v43
v_cvt_pk_bf16_f32 v70, v44, v45
v_cvt_pk_bf16_f32 v71, v46, v47
ds_write_b128 v6, v[68:71] offset:18432
v_pk_mul_f32 v[48:49], v[232:233], v[56:57]
v_pk_mul_f32 v[50:51], v[234:235], v[56:57]
v_pk_mul_f32 v[52:53], v[236:237], v[56:57]
v_pk_mul_f32 v[54:55], v[238:239], v[56:57]
v_cvt_pk_bf16_f32 v72, v48, v49
v_cvt_pk_bf16_f32 v73, v50, v51
v_cvt_pk_bf16_f32 v74, v52, v53
v_cvt_pk_bf16_f32 v75, v54, v55
ds_write_b128 v6, v[72:75] offset:19456
v_mfma_f32_32x32x16_bf16 a[160:175], v[100:103], v[100:103], 0
v_accvgpr_read_b32 v40, a192
v_accvgpr_read_b32 v41, a193
v_accvgpr_read_b32 v42, a194
v_accvgpr_read_b32 v43, a195
v_accvgpr_read_b32 v44, a208
v_accvgpr_read_b32 v45, a209
v_accvgpr_read_b32 v46, a210
v_accvgpr_read_b32 v47, a211
v_pk_mul_f32 v[40:41], v[40:41], v[56:57]
v_pk_mul_f32 v[42:43], v[42:43], v[56:57]
v_pk_mul_f32 v[44:45], v[44:45], v[56:57]
v_pk_mul_f32 v[46:47], v[46:47], v[56:57]
v_cvt_pk_bf16_f32 v60, v40, v41
v_cvt_pk_bf16_f32 v61, v42, v43
v_cvt_pk_bf16_f32 v62, v44, v45
v_cvt_pk_bf16_f32 v63, v46, v47
ds_write_b128 v6, v[60:63] offset:20480
v_mfma_f32_32x32x16_bf16 a[176:191], v[100:103], v[100:103], 0
v_accvgpr_read_b32 v48, a196
v_accvgpr_read_b32 v49, a197
v_accvgpr_read_b32 v50, a198
v_accvgpr_read_b32 v51, a199
v_accvgpr_read_b32 v52, a212
v_accvgpr_read_b32 v53, a213
v_accvgpr_read_b32 v54, a214
v_accvgpr_read_b32 v55, a215
v_pk_mul_f32 v[48:49], v[48:49], v[56:57]
v_pk_mul_f32 v[50:51], v[50:51], v[56:57]
v_pk_mul_f32 v[52:53], v[52:53], v[56:57]
v_pk_mul_f32 v[54:55], v[54:55], v[56:57]
v_cvt_pk_bf16_f32 v64, v48, v49
v_cvt_pk_bf16_f32 v65, v50, v51
v_cvt_pk_bf16_f32 v66, v52, v53
v_cvt_pk_bf16_f32 v67, v54, v55
ds_write_b128 v6, v[64:67] offset:21504
v_mfma_f32_32x32x16_bf16 v[224:239], v[100:103], v[100:103], 0
v_accvgpr_read_b32 v40, a200
v_accvgpr_read_b32 v41, a201
v_accvgpr_read_b32 v42, a202
v_accvgpr_read_b32 v43, a203
v_accvgpr_read_b32 v44, a216
v_accvgpr_read_b32 v45, a217
v_accvgpr_read_b32 v46, a218
v_accvgpr_read_b32 v47, a219
v_pk_mul_f32 v[40:41], v[40:41], v[56:57]
v_pk_mul_f32 v[42:43], v[42:43], v[56:57]
v_pk_mul_f32 v[44:45], v[44:45], v[56:57]
v_pk_mul_f32 v[46:47], v[46:47], v[56:57]
v_cvt_pk_bf16_f32 v68, v40, v41
v_cvt_pk_bf16_f32 v69, v42, v43
v_cvt_pk_bf16_f32 v70, v44, v45
v_cvt_pk_bf16_f32 v71, v46, v47
ds_write_b128 v6, v[68:71] offset:22528
v_accvgpr_read_b32 v48, a204
v_accvgpr_read_b32 v49, a205
v_accvgpr_read_b32 v50, a206
v_accvgpr_read_b32 v51, a207
v_accvgpr_read_b32 v52, a220
v_accvgpr_read_b32 v53, a221
v_accvgpr_read_b32 v54, a222
v_accvgpr_read_b32 v55, a223
v_pk_mul_f32 v[48:49], v[48:49], v[56:57]
v_pk_mul_f32 v[50:51], v[50:51], v[56:57]
v_pk_mul_f32 v[52:53], v[52:53], v[56:57]
v_pk_mul_f32 v[54:55], v[54:55], v[56:57]
v_cvt_pk_bf16_f32 v72, v48, v49
v_cvt_pk_bf16_f32 v73, v50, v51
v_cvt_pk_bf16_f32 v74, v52, v53
v_cvt_pk_bf16_f32 v75, v54, v55
ds_write_b128 v6, v[72:75] offset:23552
v_pk_mul_f32 v[40:41], v[240:241], v[56:57]
v_pk_mul_f32 v[42:43], v[242:243], v[56:57]
v_pk_mul_f32 v[44:45], v[244:245], v[56:57]
v_pk_mul_f32 v[46:47], v[246:247], v[56:57]
v_cvt_pk_bf16_f32 v60, v40, v41
v_cvt_pk_bf16_f32 v61, v42, v43
v_cvt_pk_bf16_f32 v62, v44, v45
v_cvt_pk_bf16_f32 v63, v46, v47
ds_write_b128 v6, v[60:63] offset:24576
v_mfma_f32_32x32x16_bf16 a[192:207], v[100:103], v[100:103], 0
v_accvgpr_read_b32 v48, a224
v_accvgpr_read_b32 v49, a225
v_accvgpr_read_b32 v50, a226
v_accvgpr_read_b32 v51, a227
v_accvgpr_read_b32 v52, a240
v_accvgpr_read_b32 v53, a241
v_accvgpr_read_b32 v54, a242
v_accvgpr_read_b32 v55, a243
v_pk_mul_f32 v[48:49], v[48:49], v[56:57]
v_pk_mul_f32 v[50:51], v[50:51], v[56:57]
v_pk_mul_f32 v[52:53], v[52:53], v[56:57]
v_pk_mul_f32 v[54:55], v[54:55], v[56:57]
v_cvt_pk_bf16_f32 v170, v48, v49
v_cvt_pk_bf16_f32 v171, v50, v51
v_cvt_pk_bf16_f32 v172, v52, v53
v_cvt_pk_bf16_f32 v173, v54, v55
v_mfma_f32_32x32x16_bf16 a[208:223], v[100:103], v[100:103], 0
v_accvgpr_read_b32 v40, a228
v_accvgpr_read_b32 v41, a229
v_accvgpr_read_b32 v42, a230
v_accvgpr_read_b32 v43, a231
v_accvgpr_read_b32 v44, a244
v_accvgpr_read_b32 v45, a245
v_accvgpr_read_b32 v46, a246
v_accvgpr_read_b32 v47, a247
v_pk_mul_f32 v[40:41], v[40:41], v[56:57]
v_pk_mul_f32 v[42:43], v[42:43], v[56:57]
v_pk_mul_f32 v[44:45], v[44:45], v[56:57]
v_pk_mul_f32 v[46:47], v[46:47], v[56:57]
v_cvt_pk_bf16_f32 v174, v40, v41
v_cvt_pk_bf16_f32 v175, v42, v43
v_cvt_pk_bf16_f32 v176, v44, v45
v_cvt_pk_bf16_f32 v177, v46, v47
v_accvgpr_read_b32 v48, a232
v_accvgpr_read_b32 v49, a233
v_accvgpr_read_b32 v50, a234
v_accvgpr_read_b32 v51, a235
v_accvgpr_read_b32 v52, a248
v_accvgpr_read_b32 v53, a249
v_accvgpr_read_b32 v54, a250
v_accvgpr_read_b32 v55, a251
v_pk_mul_f32 v[48:49], v[48:49], v[56:57]
v_pk_mul_f32 v[50:51], v[50:51], v[56:57]
v_pk_mul_f32 v[52:53], v[52:53], v[56:57]
v_pk_mul_f32 v[54:55], v[54:55], v[56:57]
v_cvt_pk_bf16_f32 v178, v48, v49
v_cvt_pk_bf16_f32 v179, v50, v51
v_cvt_pk_bf16_f32 v180, v52, v53
v_cvt_pk_bf16_f32 v181, v54, v55
v_accvgpr_read_b32 v40, a236
v_accvgpr_read_b32 v41, a237
v_accvgpr_read_b32 v42, a238
v_accvgpr_read_b32 v43, a239
v_accvgpr_read_b32 v44, a252
v_accvgpr_read_b32 v45, a253
v_accvgpr_read_b32 v46, a254
v_accvgpr_read_b32 v47, a255
v_pk_mul_f32 v[40:41], v[40:41], v[56:57]
v_pk_mul_f32 v[42:43], v[42:43], v[56:57]
v_pk_mul_f32 v[44:45], v[44:45], v[56:57]
v_pk_mul_f32 v[46:47], v[46:47], v[56:57]
v_cvt_pk_bf16_f32 v182, v40, v41
v_cvt_pk_bf16_f32 v183, v42, v43
v_cvt_pk_bf16_f32 v184, v44, v45
v_cvt_pk_bf16_f32 v185, v46, v47
v_pk_mul_f32 v[48:49], v[248:249], v[56:57]
v_pk_mul_f32 v[50:51], v[250:251], v[56:57]
v_pk_mul_f32 v[52:53], v[252:253], v[56:57]
v_pk_mul_f32 v[54:55], v[254:255], v[56:57]
v_cvt_pk_bf16_f32 v186, v48, v49
v_cvt_pk_bf16_f32 v187, v50, v51
v_cvt_pk_bf16_f32 v188, v52, v53
v_cvt_pk_bf16_f32 v189, v54, v55
v_mfma_f32_32x32x16_bf16 a[224:239], v[100:103], v[100:103], 0
v_accvgpr_read_b32 v40, a32
v_accvgpr_read_b32 v41, a33
v_accvgpr_read_b32 v42, a34
v_accvgpr_read_b32 v43, a35
v_accvgpr_read_b32 v44, a48
v_accvgpr_read_b32 v45, a49
v_accvgpr_read_b32 v46, a50
v_accvgpr_read_b32 v47, a51
v_pk_mul_f32 v[40:41], v[40:41], v[56:57]
v_pk_mul_f32 v[42:43], v[42:43], v[56:57]
v_pk_mul_f32 v[44:45], v[44:45], v[56:57]
v_pk_mul_f32 v[46:47], v[46:47], v[56:57]
v_cvt_pk_bf16_f32 v150, v40, v41
v_cvt_pk_bf16_f32 v151, v42, v43
v_cvt_pk_bf16_f32 v152, v44, v45
v_cvt_pk_bf16_f32 v153, v46, v47
v_mfma_f32_32x32x16_bf16 a[240:255], v[100:103], v[100:103], 0
v_accvgpr_read_b32 v48, a36
v_accvgpr_read_b32 v49, a37
v_accvgpr_read_b32 v50, a38
v_accvgpr_read_b32 v51, a39
v_accvgpr_read_b32 v52, a52
v_accvgpr_read_b32 v53, a53
v_accvgpr_read_b32 v54, a54
v_accvgpr_read_b32 v55, a55
v_pk_mul_f32 v[48:49], v[48:49], v[56:57]
v_pk_mul_f32 v[50:51], v[50:51], v[56:57]
v_pk_mul_f32 v[52:53], v[52:53], v[56:57]
v_pk_mul_f32 v[54:55], v[54:55], v[56:57]
v_cvt_pk_bf16_f32 v154, v48, v49
v_cvt_pk_bf16_f32 v155, v50, v51
v_cvt_pk_bf16_f32 v156, v52, v53
v_cvt_pk_bf16_f32 v157, v54, v55
v_mfma_f32_32x32x16_bf16 v[240:255], v[100:103], v[100:103], 0
v_accvgpr_read_b32 v40, a40
v_accvgpr_read_b32 v41, a41
v_accvgpr_read_b32 v42, a42
v_accvgpr_read_b32 v43, a43
v_accvgpr_read_b32 v44, a56
v_accvgpr_read_b32 v45, a57
v_accvgpr_read_b32 v46, a58
v_accvgpr_read_b32 v47, a59
v_pk_mul_f32 v[40:41], v[40:41], v[56:57]
v_pk_mul_f32 v[42:43], v[42:43], v[56:57]
v_pk_mul_f32 v[44:45], v[44:45], v[56:57]
v_pk_mul_f32 v[46:47], v[46:47], v[56:57]
v_cvt_pk_bf16_f32 v158, v40, v41
v_cvt_pk_bf16_f32 v159, v42, v43
v_cvt_pk_bf16_f32 v160, v44, v45
v_cvt_pk_bf16_f32 v161, v46, v47
v_accvgpr_read_b32 v48, a44
v_accvgpr_read_b32 v49, a45
v_accvgpr_read_b32 v50, a46
v_accvgpr_read_b32 v51, a47
v_accvgpr_read_b32 v52, a60
v_accvgpr_read_b32 v53, a61
v_accvgpr_read_b32 v54, a62
v_accvgpr_read_b32 v55, a63
v_pk_mul_f32 v[48:49], v[48:49], v[56:57]
v_pk_mul_f32 v[50:51], v[50:51], v[56:57]
v_pk_mul_f32 v[52:53], v[52:53], v[56:57]
v_pk_mul_f32 v[54:55], v[54:55], v[56:57]
v_cvt_pk_bf16_f32 v162, v48, v49
v_cvt_pk_bf16_f32 v163, v50, v51
v_cvt_pk_bf16_f32 v164, v52, v53
v_cvt_pk_bf16_f32 v165, v54, v55
v_pk_mul_f32 v[40:41], v[200:201], v[56:57]
v_pk_mul_f32 v[42:43], v[202:203], v[56:57]
v_pk_mul_f32 v[44:45], v[204:205], v[56:57]
v_pk_mul_f32 v[46:47], v[206:207], v[56:57]
v_cvt_pk_bf16_f32 v166, v40, v41
v_cvt_pk_bf16_f32 v167, v42, v43
v_cvt_pk_bf16_f32 v168, v44, v45
v_cvt_pk_bf16_f32 v169, v46, v47
v_mfma_f32_32x32x16_bf16 a[32:47], v[100:103], v[100:103], 0
v_accvgpr_read_b32 v48, a0
v_accvgpr_read_b32 v49, a1
v_accvgpr_read_b32 v50, a2
v_accvgpr_read_b32 v51, a3
v_accvgpr_read_b32 v52, a16
v_accvgpr_read_b32 v53, a17
v_accvgpr_read_b32 v54, a18
v_accvgpr_read_b32 v55, a19
v_pk_mul_f32 v[48:49], v[48:49], v[56:57]
v_pk_mul_f32 v[50:51], v[50:51], v[56:57]
v_pk_mul_f32 v[52:53], v[52:53], v[56:57]
v_pk_mul_f32 v[54:55], v[54:55], v[56:57]
v_cvt_pk_bf16_f32 v130, v48, v49
v_cvt_pk_bf16_f32 v131, v50, v51
v_cvt_pk_bf16_f32 v132, v52, v53
v_cvt_pk_bf16_f32 v133, v54, v55
v_mfma_f32_32x32x16_bf16 a[48:63], v[100:103], v[100:103], 0
v_accvgpr_read_b32 v40, a4
v_accvgpr_read_b32 v41, a5
v_accvgpr_read_b32 v42, a6
v_accvgpr_read_b32 v43, a7
v_accvgpr_read_b32 v44, a20
v_accvgpr_read_b32 v45, a21
v_accvgpr_read_b32 v46, a22
v_accvgpr_read_b32 v47, a23
v_pk_mul_f32 v[40:41], v[40:41], v[56:57]
v_pk_mul_f32 v[42:43], v[42:43], v[56:57]
v_pk_mul_f32 v[44:45], v[44:45], v[56:57]
v_pk_mul_f32 v[46:47], v[46:47], v[56:57]
v_cvt_pk_bf16_f32 v134, v40, v41
v_cvt_pk_bf16_f32 v135, v42, v43
v_cvt_pk_bf16_f32 v136, v44, v45
v_cvt_pk_bf16_f32 v137, v46, v47
v_accvgpr_read_b32 v48, a8
v_accvgpr_read_b32 v49, a9
v_accvgpr_read_b32 v50, a10
v_accvgpr_read_b32 v51, a11
v_accvgpr_read_b32 v52, a24
v_accvgpr_read_b32 v53, a25
v_accvgpr_read_b32 v54, a26
v_accvgpr_read_b32 v55, a27
v_pk_mul_f32 v[48:49], v[48:49], v[56:57]
v_pk_mul_f32 v[50:51], v[50:51], v[56:57]
v_pk_mul_f32 v[52:53], v[52:53], v[56:57]
v_pk_mul_f32 v[54:55], v[54:55], v[56:57]
v_cvt_pk_bf16_f32 v138, v48, v49
v_cvt_pk_bf16_f32 v139, v50, v51
v_cvt_pk_bf16_f32 v140, v52, v53
v_cvt_pk_bf16_f32 v141, v54, v55
v_accvgpr_read_b32 v40, a12
v_accvgpr_read_b32 v41, a13
v_accvgpr_read_b32 v42, a14
v_accvgpr_read_b32 v43, a15
v_accvgpr_read_b32 v44, a28
v_accvgpr_read_b32 v45, a29
v_accvgpr_read_b32 v46, a30
v_accvgpr_read_b32 v47, a31
v_pk_mul_f32 v[40:41], v[40:41], v[56:57]
v_pk_mul_f32 v[42:43], v[42:43], v[56:57]
v_pk_mul_f32 v[44:45], v[44:45], v[56:57]
v_pk_mul_f32 v[46:47], v[46:47], v[56:57]
v_cvt_pk_bf16_f32 v142, v40, v41
v_cvt_pk_bf16_f32 v143, v42, v43
v_cvt_pk_bf16_f32 v144, v44, v45
v_cvt_pk_bf16_f32 v145, v46, v47
v_pk_mul_f32 v[48:49], v[192:193], v[56:57]
v_pk_mul_f32 v[50:51], v[194:195], v[56:57]
v_pk_mul_f32 v[52:53], v[196:197], v[56:57]
v_pk_mul_f32 v[54:55], v[198:199], v[56:57]
v_cvt_pk_bf16_f32 v146, v48, v49
v_cvt_pk_bf16_f32 v147, v50, v51
v_cvt_pk_bf16_f32 v148, v52, v53
v_cvt_pk_bf16_f32 v149, v54, v55
v_mfma_f32_32x32x16_bf16 a[0:15], v[100:103], v[100:103], 0
v_mfma_f32_32x32x16_bf16 a[16:31], v[100:103], v[100:103], 0
v_mfma_f32_32x32x16_bf16 v[192:207], v[100:103], v[100:103], 0
s_waitcnt vmcnt(0) lgkmcnt(0)
s_barrier
s_cmp_lg_u32 s27, 0
s_cbranch_scc1 L_arr_r5
v_mov_b32 v90, 0
v_mov_b32 v91, 1
s_mov_b64 exec, 1
global_atomic_add v90, v91, s[78:79]
s_mov_b64 exec, -1
L_arr_r5:
ds_read_b128 v[8:11], v0 offset:0
ds_read_b128 v[12:15], v0 offset:8192
ds_read_b128 v[16:19], v1 offset:0
ds_read_b128 v[20:23], v1 offset:8192
s_waitcnt lgkmcnt(2)
v_mfma_f32_16x16x32_bf16 v[40:43], v[8:11], v[130:133], v[100:103]
s_nop 0
v_mfma_f32_16x16x32_bf16 v[44:47], v[12:15], v[130:133], v[100:103]
v_mfma_f32_16x16x32_bf16 v[48:51], v[8:11], v[134:137], v[104:107]
v_mfma_f32_16x16x32_bf16 v[52:55], v[12:15], v[134:137], v[104:107]
v_mfma_f32_16x16x32_bf16 v[56:59], v[8:11], v[138:141], v[108:111]
v_mfma_f32_16x16x32_bf16 v[60:63], v[12:15], v[138:141], v[108:111]
v_mfma_f32_16x16x32_bf16 v[64:67], v[8:11], v[142:145], v[112:115]
v_mfma_f32_16x16x32_bf16 v[68:71], v[12:15], v[142:145], v[112:115]
v_mfma_f32_16x16x32_bf16 v[72:75], v[8:11], v[146:149], v[116:119]
v_mfma_f32_16x16x32_bf16 v[76:79], v[12:15], v[146:149], v[116:119]
s_waitcnt lgkmcnt(0)
v_mfma_f32_16x16x32_bf16 v[40:43], v[16:19], v[150:153], v[40:43]
s_add_u32 m0, s35, s71
ds_read_b128 v[24:27], v6 offset:0
v_mfma_f32_16x16x32_bf16 v[44:47], v[20:23], v[150:153], v[44:47]
ds_read_b128 v[8:11], v0 offset:1024
ds_read_b128 v[28:31], v6 offset:1024
v_mfma_f32_16x16x32_bf16 v[48:51], v[16:19], v[154:157], v[48:51]
ds_read_b128 v[32:35], v6 offset:2048
buffer_load_dwordx4 v7, s[4:7], s24 offen offset:0 nt lds
v_mfma_f32_16x16x32_bf16 v[52:55], v[20:23], v[154:157], v[52:55]
ds_read_b128 v[12:15], v0 offset:9216
ds_read_b128 v[36:39], v6 offset:3072
v_mfma_f32_16x16x32_bf16 v[56:59], v[16:19], v[158:161], v[56:59]
v_mfma_f32_16x16x32_bf16 v[60:63], v[20:23], v[158:161], v[60:63]
v_mfma_f32_16x16x32_bf16 v[64:67], v[16:19], v[162:165], v[64:67]
v_mfma_f32_16x16x32_bf16 v[68:71], v[20:23], v[162:165], v[68:71]
v_mfma_f32_16x16x32_bf16 v[72:75], v[16:19], v[166:169], v[72:75]
v_mfma_f32_16x16x32_bf16 v[76:79], v[20:23], v[166:169], v[76:79]
s_waitcnt lgkmcnt(1)
v_mfma_f32_16x16x32_bf16 v[40:43], v[8:11], v[24:27], v[40:43]
v_mfma_f32_16x16x32_bf16 v[44:47], v[12:15], v[24:27], v[44:47]
ds_read_b128 v[24:27], v6 offset:4096
v_mfma_f32_16x16x32_bf16 v[48:51], v[8:11], v[28:31], v[48:51]
ds_read_b128 v[16:19], v1 offset:1024
v_mfma_f32_16x16x32_bf16 v[52:55], v[12:15], v[28:31], v[52:55]
ds_read_b128 v[28:31], v6 offset:5120
v_mfma_f32_16x16x32_bf16 v[56:59], v[8:11], v[32:35], v[56:59]
ds_read_b128 v[20:23], v1 offset:9216
v_mfma_f32_16x16x32_bf16 v[60:63], v[12:15], v[32:35], v[60:63]
s_waitcnt lgkmcnt(4)
ds_read_b128 v[32:35], v6 offset:6144
v_mfma_f32_16x16x32_bf16 v[64:67], v[8:11], v[36:39], v[64:67]
v_mfma_f32_16x16x32_bf16 v[68:71], v[12:15], v[36:39], v[68:71]
s_waitcnt lgkmcnt(4)
ds_read_b128 v[36:39], v6 offset:7168
v_mfma_f32_16x16x32_bf16 v[72:75], v[8:11], v[24:27], v[72:75]
v_mfma_f32_16x16x32_bf16 v[76:79], v[12:15], v[24:27], v[76:79]
s_waitcnt lgkmcnt(2)
ds_read_b128 v[24:27], v6 offset:8192
v_mfma_f32_16x16x32_bf16 v[40:43], v[16:19], v[28:31], v[40:43]
buffer_load_dwordx4 v7, s[4:7], s25 offen offset:1024 nt lds
v_mfma_f32_16x16x32_bf16 v[44:47], v[20:23], v[28:31], v[44:47]
s_waitcnt lgkmcnt(2)
ds_read_b128 v[28:31], v6 offset:9216
v_mfma_f32_16x16x32_bf16 v[48:51], v[16:19], v[32:35], v[48:51]
ds_read_b128 v[8:11], v0 offset:2048
v_mfma_f32_16x16x32_bf16 v[52:55], v[20:23], v[32:35], v[52:55]
s_waitcnt lgkmcnt(3)
ds_read_b128 v[32:35], v6 offset:10240
v_mfma_f32_16x16x32_bf16 v[56:59], v[16:19], v[36:39], v[56:59]
ds_read_b128 v[12:15], v0 offset:10240
v_mfma_f32_16x16x32_bf16 v[60:63], v[20:23], v[36:39], v[60:63]
s_waitcnt lgkmcnt(4)
ds_read_b128 v[36:39], v6 offset:11264
v_mfma_f32_16x16x32_bf16 v[64:67], v[16:19], v[24:27], v[64:67]
v_mfma_f32_16x16x32_bf16 v[68:71], v[20:23], v[24:27], v[68:71]
s_waitcnt lgkmcnt(4)
ds_read_b128 v[24:27], v6 offset:12288
v_mfma_f32_16x16x32_bf16 v[72:75], v[16:19], v[28:31], v[72:75]
v_mfma_f32_16x16x32_bf16 v[76:79], v[20:23], v[28:31], v[76:79]
s_waitcnt lgkmcnt(2)
ds_read_b128 v[28:31], v6 offset:13312
v_mfma_f32_16x16x32_bf16 v[40:43], v[8:11], v[32:35], v[40:43]
v_mfma_f32_16x16x32_bf16 v[44:47], v[12:15], v[32:35], v[44:47]
s_waitcnt lgkmcnt(2)
ds_read_b128 v[32:35], v6 offset:14336
v_mfma_f32_16x16x32_bf16 v[48:51], v[8:11], v[36:39], v[48:51]
ds_read_b128 v[16:19], v1 offset:2048
v_mfma_f32_16x16x32_bf16 v[52:55], v[12:15], v[36:39], v[52:55]
s_waitcnt lgkmcnt(3)
ds_read_b128 v[36:39], v6 offset:15360
v_mfma_f32_16x16x32_bf16 v[56:59], v[8:11], v[24:27], v[56:59]
ds_read_b128 v[20:23], v1 offset:10240
v_mfma_f32_16x16x32_bf16 v[60:63], v[12:15], v[24:27], v[60:63]
s_waitcnt lgkmcnt(4)
ds_read_b128 v[24:27], v6 offset:16384
v_mfma_f32_16x16x32_bf16 v[64:67], v[8:11], v[28:31], v[64:67]
v_mfma_f32_16x16x32_bf16 v[68:71], v[12:15], v[28:31], v[68:71]
s_waitcnt lgkmcnt(4)
ds_read_b128 v[28:31], v6 offset:17408
v_mfma_f32_16x16x32_bf16 v[72:75], v[8:11], v[32:35], v[72:75]
buffer_load_dwordx4 v7, s[4:7], s26 offen offset:2048 nt lds
v_mfma_f32_16x16x32_bf16 v[76:79], v[12:15], v[32:35], v[76:79]
s_waitcnt lgkmcnt(2)
ds_read_b128 v[32:35], v6 offset:18432
v_mfma_f32_16x16x32_bf16 v[40:43], v[16:19], v[36:39], v[40:43]
v_mfma_f32_16x16x32_bf16 v[44:47], v[20:23], v[36:39], v[44:47]
s_waitcnt lgkmcnt(2)
ds_read_b128 v[36:39], v6 offset:19456
v_mfma_f32_16x16x32_bf16 v[48:51], v[16:19], v[24:27], v[48:51]
ds_read_b128 v[8:11], v0 offset:3072
v_mfma_f32_16x16x32_bf16 v[52:55], v[20:23], v[24:27], v[52:55]
s_waitcnt lgkmcnt(3)
ds_read_b128 v[24:27], v6 offset:20480
v_mfma_f32_16x16x32_bf16 v[56:59], v[16:19], v[28:31], v[56:59]
ds_read_b128 v[12:15], v0 offset:11264
v_mfma_f32_16x16x32_bf16 v[60:63], v[20:23], v[28:31], v[60:63]
s_waitcnt lgkmcnt(4)
ds_read_b128 v[28:31], v6 offset:21504
v_mfma_f32_16x16x32_bf16 v[64:67], v[16:19], v[32:35], v[64:67]
v_mfma_f32_16x16x32_bf16 v[68:71], v[20:23], v[32:35], v[68:71]
s_waitcnt lgkmcnt(4)
ds_read_b128 v[32:35], v6 offset:22528
v_mfma_f32_16x16x32_bf16 v[72:75], v[16:19], v[36:39], v[72:75]
v_mfma_f32_16x16x32_bf16 v[76:79], v[20:23], v[36:39], v[76:79]
s_waitcnt lgkmcnt(2)
ds_read_b128 v[36:39], v6 offset:23552
v_mfma_f32_16x16x32_bf16 v[40:43], v[8:11], v[24:27], v[40:43]
v_mfma_f32_16x16x32_bf16 v[44:47], v[12:15], v[24:27], v[44:47]
s_waitcnt lgkmcnt(2)
ds_read_b128 v[24:27], v6 offset:24576
v_mfma_f32_16x16x32_bf16 v[48:51], v[8:11], v[28:31], v[48:51]
ds_read_b128 v[16:19], v1 offset:3072
v_mfma_f32_16x16x32_bf16 v[52:55], v[12:15], v[28:31], v[52:55]
s_waitcnt lgkmcnt(3)
ds_read_b128 v[20:23], v1 offset:11264
v_mfma_f32_16x16x32_bf16 v[56:59], v[8:11], v[32:35], v[56:59]
s_sub_u32 s69, s29, s28
v_add_u32 v0, s69, v0
v_mfma_f32_16x16x32_bf16 v[60:63], v[12:15], v[32:35], v[60:63]
s_waitcnt lgkmcnt(3)
v_add_u32 v1, s69, v1
v_mfma_f32_16x16x32_bf16 v[64:67], v[8:11], v[36:39], v[64:67]
buffer_load_dwordx4 v7, s[4:7], 0 offen offset:3072 nt lds
s_mov_b32 s65, s28
v_mfma_f32_16x16x32_bf16 v[68:71], v[12:15], v[36:39], v[68:71]
s_waitcnt lgkmcnt(2)
s_mov_b32 s28, s29
v_mfma_f32_16x16x32_bf16 v[72:75], v[8:11], v[24:27], v[72:75]
s_add_u32 s4, s4, 16384
s_addc_u32 s5, s5, 0
v_mfma_f32_16x16x32_bf16 v[76:79], v[12:15], v[24:27], v[76:79]
s_waitcnt vmcnt(8) lgkmcnt(0)
s_barrier
v_mfma_f32_16x16x32_bf16 v[40:43], v[16:19], v[170:173], v[40:43]
s_mov_b32 s29, s35
s_mov_b32 s35, s65
v_mfma_f32_16x16x32_bf16 v[44:47], v[20:23], v[170:173], v[44:47]
v_mfma_f32_16x16x32_bf16 v[48:51], v[16:19], v[174:177], v[48:51]
v_mfma_f32_16x16x32_bf16 v[52:55], v[20:23], v[174:177], v[52:55]
v_mfma_f32_16x16x32_bf16 v[56:59], v[16:19], v[178:181], v[56:59]
v_mfma_f32_16x16x32_bf16 v[60:63], v[20:23], v[178:181], v[60:63]
v_mfma_f32_16x16x32_bf16 v[64:67], v[16:19], v[182:185], v[64:67]
v_mfma_f32_16x16x32_bf16 v[68:71], v[20:23], v[182:185], v[68:71]
v_mfma_f32_16x16x32_bf16 v[72:75], v[16:19], v[186:189], v[72:75]
v_mfma_f32_16x16x32_bf16 v[76:79], v[20:23], v[186:189], v[76:79]
ds_read_b128 v[8:11], v0 offset:0
ds_read_b128 v[12:15], v0 offset:8192
ds_read_b128 v[16:19], v1 offset:0
ds_read_b128 v[20:23], v1 offset:8192
s_nop 7
v_max3_f32 v84, v40, v41, v42
v_max3_f32 v84, v84, v43, v44
v_max3_f32 v84, v84, v45, v46
v_max_f32 v84, v84, v47
v_max3_f32 v85, v48, v49, v50
v_max3_f32 v85, v85, v51, v52
v_max3_f32 v85, v85, v53, v54
v_max_f32 v85, v85, v55
v_max3_f32 v86, v56, v57, v58
v_max3_f32 v86, v86, v59, v60
v_max3_f32 v86, v86, v61, v62
v_max_f32 v86, v86, v63
v_max3_f32 v87, v64, v65, v66
v_max3_f32 v87, v87, v67, v68
v_max3_f32 v87, v87, v69, v70
v_max_f32 v87, v87, v71
v_max3_f32 v88, v72, v73, v74
v_max3_f32 v88, v88, v75, v76
v_max3_f32 v88, v88, v77, v78
v_max_f32 v88, v88, v79
v_mbcnt_lo_u32_b32 v190, -1, 0
v_mbcnt_hi_u32_b32 v190, -1, v190
v_xor_b32 v191, 32, v190
v_xor_b32 v190, 16, v190
v_lshlrev_b32 v191, 2, v191
v_lshlrev_b32 v190, 2, v190
ds_bpermute_b32 v90, v190, v84
ds_bpermute_b32 v91, v190, v85
ds_bpermute_b32 v92, v190, v86
ds_bpermute_b32 v93, v190, v87
ds_bpermute_b32 v94, v190, v88
s_waitcnt lgkmcnt(0)
v_max_f32 v84, v84, v90
v_max_f32 v85, v85, v91
v_max_f32 v86, v86, v92
v_max_f32 v87, v87, v93
v_max_f32 v88, v88, v94
ds_bpermute_b32 v90, v191, v84
ds_bpermute_b32 v91, v191, v85
ds_bpermute_b32 v92, v191, v86
ds_bpermute_b32 v93, v191, v87
ds_bpermute_b32 v94, v191, v88
s_waitcnt lgkmcnt(0)
v_max_f32 v84, v84, v90
v_max_f32 v85, v85, v91
v_max_f32 v86, v86, v92
v_max_f32 v87, v87, v93
v_max_f32 v88, v88, v94
v_sub_f32 v100, 0, v84
v_sub_f32 v101, 0, v84
v_sub_f32 v102, 0, v84
v_sub_f32 v103, 0, v84
v_sub_f32 v104, 0, v85
v_sub_f32 v105, 0, v85
v_sub_f32 v106, 0, v85
v_sub_f32 v107, 0, v85
v_sub_f32 v108, 0, v86
v_sub_f32 v109, 0, v86
v_sub_f32 v110, 0, v86
v_sub_f32 v111, 0, v86
v_sub_f32 v112, 0, v87
v_sub_f32 v113, 0, v87
v_sub_f32 v114, 0, v87
v_sub_f32 v115, 0, v87
v_sub_f32 v116, 0, v88
v_sub_f32 v117, 0, v88
v_sub_f32 v118, 0, v88
v_sub_f32 v119, 0, v88
v_sub_f32 v40, v40, v84
v_sub_f32 v41, v41, v84
v_sub_f32 v42, v42, v84
v_sub_f32 v43, v43, v84
v_sub_f32 v44, v44, v84
v_sub_f32 v45, v45, v84
v_sub_f32 v46, v46, v84
v_sub_f32 v47, v47, v84
v_sub_f32 v48, v48, v85
v_sub_f32 v49, v49, v85
v_sub_f32 v50, v50, v85
v_sub_f32 v51, v51, v85
v_sub_f32 v52, v52, v85
v_sub_f32 v53, v53, v85
v_sub_f32 v54, v54, v85
v_sub_f32 v55, v55, v85
v_sub_f32 v56, v56, v86
v_sub_f32 v57, v57, v86
v_sub_f32 v58, v58, v86
v_sub_f32 v59, v59, v86
v_sub_f32 v60, v60, v86
v_sub_f32 v61, v61, v86
v_sub_f32 v62, v62, v86
v_sub_f32 v63, v63, v86
v_sub_f32 v64, v64, v87
v_sub_f32 v65, v65, v87
v_sub_f32 v66, v66, v87
v_sub_f32 v67, v67, v87
v_sub_f32 v68, v68, v87
v_sub_f32 v69, v69, v87
v_sub_f32 v70, v70, v87
v_sub_f32 v71, v71, v87
v_sub_f32 v72, v72, v88
v_sub_f32 v73, v73, v88
v_sub_f32 v74, v74, v88
v_sub_f32 v75, v75, v88
v_sub_f32 v76, v76, v88
v_sub_f32 v77, v77, v88
v_sub_f32 v78, v78, v88
v_sub_f32 v79, v79, v88
v_exp_f32 v40, v40
v_exp_f32 v41, v41
v_exp_f32 v42, v42
v_exp_f32 v43, v43
v_exp_f32 v44, v44
v_exp_f32 v45, v45
v_exp_f32 v46, v46
v_exp_f32 v47, v47
v_exp_f32 v48, v48
v_exp_f32 v49, v49
v_exp_f32 v50, v50
v_exp_f32 v51, v51
v_exp_f32 v52, v52
v_exp_f32 v53, v53
v_exp_f32 v54, v54
v_exp_f32 v55, v55
v_exp_f32 v56, v56
v_exp_f32 v57, v57
v_exp_f32 v58, v58
v_exp_f32 v59, v59
v_exp_f32 v60, v60
v_exp_f32 v61, v61
v_exp_f32 v62, v62
v_exp_f32 v63, v63
v_exp_f32 v64, v64
v_exp_f32 v65, v65
v_exp_f32 v66, v66
v_exp_f32 v67, v67
v_exp_f32 v68, v68
v_exp_f32 v69, v69
v_exp_f32 v70, v70
v_exp_f32 v71, v71
v_exp_f32 v72, v72
v_exp_f32 v73, v73
v_exp_f32 v74, v74
v_exp_f32 v75, v75
v_exp_f32 v76, v76
v_exp_f32 v77, v77
v_exp_f32 v78, v78
v_exp_f32 v79, v79
s_nop 0
v_mov_b32 v120, v40
v_add_f32 v120, v120, v41
v_add_f32 v120, v120, v42
v_add_f32 v120, v120, v43
v_add_f32 v120, v120, v44
v_add_f32 v120, v120, v45
v_add_f32 v120, v120, v46
v_add_f32 v120, v120, v47
v_mov_b32 v121, v48
v_add_f32 v121, v121, v49
v_add_f32 v121, v121, v50
v_add_f32 v121, v121, v51
v_add_f32 v121, v121, v52
v_add_f32 v121, v121, v53
v_add_f32 v121, v121, v54
v_add_f32 v121, v121, v55
v_mov_b32 v122, v56
v_add_f32 v122, v122, v57
v_add_f32 v122, v122, v58
v_add_f32 v122, v122, v59
v_add_f32 v122, v122, v60
v_add_f32 v122, v122, v61
v_add_f32 v122, v122, v62
v_add_f32 v122, v122, v63
v_mov_b32 v123, v64
v_add_f32 v123, v123, v65
v_add_f32 v123, v123, v66
v_add_f32 v123, v123, v67
v_add_f32 v123, v123, v68
v_add_f32 v123, v123, v69
v_add_f32 v123, v123, v70
v_add_f32 v123, v123, v71
v_mov_b32 v124, v72
v_add_f32 v124, v124, v73
v_add_f32 v124, v124, v74
v_add_f32 v124, v124, v75
v_add_f32 v124, v124, v76
v_add_f32 v124, v124, v77
v_add_f32 v124, v124, v78
v_add_f32 v124, v124, v79
v_cvt_pk_bf16_f32 v80, v40, v41
v_cvt_pk_bf16_f32 v81, v42, v43
v_cvt_pk_bf16_f32 v82, v44, v45
v_cvt_pk_bf16_f32 v83, v46, v47
s_mov_b32 s80, s56
s_mov_b32 s81, s57
s_mov_b32 s44, s40
s_mov_b32 s45, s41
s_and_b32 s58, s2, 7
s_lshr_b32 s64, s58, 2
s_and_b32 s67, s58, 3
s_lshl_b32 s67, s67, 1
s_lshr_b32 s58, s2, 7
s_add_u32 s67, s67, s58
s_lshr_b32 s58, s2, 3
s_and_b32 s58, s58, 15
s_lshr_b32 s60, s58, 2
s_and_b32 s61, s58, 3
s_lshl_b32 s68, s64, 3
s_add_u32 s68, s68, s67
s_lshl_b32 s58, s68, 4
s_lshl_b32 s59, s60, 2
s_add_u32 s58, s58, s59
s_mul_i32 s58, s58, 163840
s_mul_i32 s59, s27, 40960
s_add_u32 s58, s58, s59
s_add_u32 s12, s80, s58
s_addc_u32 s13, s81, 0
s_mov_b32 s14, 655360
s_mov_b32 s15, 0x20000
s_lshl_b32 s58, s64, 7
s_lshl_b32 s59, s60, 5
s_add_u32 s58, s58, s59
s_mul_i32 s58, s58, 28
s_mul_i32 s59, s61, 7
s_add_u32 s58, s58, s59
s_lshl_b32 s58, s58, 10
s_add_u32 s58, s58, 42991616
s_add_u32 s16, s80, s58
s_addc_u32 s17, s81, 0
s_mov_b32 s18, 917504
s_mov_b32 s19, 0x20000
s_mov_b32 s58, s61
s_lshl_b32 s58, s58, 3
s_add_u32 s58, s58, s27
s_mul_i32 s55, s58, 28672
s_cmp_le_u32 s61, 0
s_cselect_b32 s58, 1, 0
s_mul_i32 s52, s58, 163840
s_lshl_b32 s58, s58, 3
s_add_u32 s58, s58, s27
s_mul_i32 s56, s58, 28672
s_cmp_le_u32 s61, 1
s_cselect_b32 s58, 2, 1
s_mul_i32 s53, s58, 163840
s_lshl_b32 s58, s58, 3
s_add_u32 s58, s58, s27
s_mul_i32 s57, s58, 28672
s_cmp_le_u32 s61, 2
s_cselect_b32 s58, 3, 2
s_mul_i32 s54, s58, 163840
s_lshl_b32 s58, s58, 3
s_add_u32 s58, s58, s27
s_mul_i32 s62, s58, 28672
s_mul_i32 s63, s27, 7168
s_add_u32 s63, s63, 32768
s_mul_i32 s58, s67, 544768
s_mul_i32 s59, s60, 143360
s_add_u32 s58, s58, s59
s_mul_i32 s59, s64, 896
s_add_u32 s58, s58, s59
s_mul_i32 s59, s61, 224
s_add_u32 s58, s58, s59
s_add_u32 s44, s44, s58
s_addc_u32 s45, s45, 0
s_sub_u32 s46, 4358144, s58
s_mov_b32 s47, 0x20000
s_lshl_b32 s58, s68, 2
s_add_u32 s58, s58, s61
s_lshl_b32 s70, s58, 2
s_add_u32 s58, s70, s27
s_lshl_b32 s58, s58, 2
s_add_u32 s58, s58, s60
s_mul_i32 s58, s58, 18432
s_add_u32 s58, s58, 58720256
s_add_u32 s48, s80, s58
s_addc_u32 s49, s81, 0
s_mov_b32 s50, 18432
s_mov_b32 s51, 0x20000
s_add_u32 s58, s70, s60
s_lshl_b32 s58, s58, 2
s_mul_i32 s58, s58, 18432
s_add_u32 s70, s58, 58720256
s_mov_b32 s32, 15
s_mov_b32 s34, 0
L_att_r5:
s_cmp_eq_u32 s32, 1
s_cselect_b32 s33, 0, 16384
s_waitcnt lgkmcnt(2)
v_mfma_f32_16x16x32_bf16 v[40:43], v[8:11], v[130:133], v[100:103]
v_cvt_pk_bf16_f32 v84, v48, v49
v_cvt_pk_bf16_f32 v85, v50, v51
v_mfma_f32_16x16x32_bf16 v[44:47], v[12:15], v[130:133], v[100:103]
v_cvt_pk_bf16_f32 v86, v52, v53
v_cvt_pk_bf16_f32 v87, v54, v55
v_mfma_f32_16x16x32_bf16 v[48:51], v[8:11], v[134:137], v[104:107]
v_cvt_pk_bf16_f32 v88, v56, v57
v_cvt_pk_bf16_f32 v89, v58, v59
v_mfma_f32_16x16x32_bf16 v[52:55], v[12:15], v[134:137], v[104:107]
v_cvt_pk_bf16_f32 v90, v60, v61
v_cvt_pk_bf16_f32 v91, v62, v63
v_mfma_f32_16x16x32_bf16 v[56:59], v[8:11], v[138:141], v[108:111]
v_cvt_pk_bf16_f32 v92, v64, v65
v_cvt_pk_bf16_f32 v93, v66, v67
v_mfma_f32_16x16x32_bf16 v[60:63], v[12:15], v[138:141], v[108:111]
v_cvt_pk_bf16_f32 v94, v68, v69
v_cvt_pk_bf16_f32 v95, v70, v71
v_mfma_f32_16x16x32_bf16 v[64:67], v[8:11], v[142:145], v[112:115]
v_cvt_pk_bf16_f32 v96, v72, v73
v_cvt_pk_bf16_f32 v97, v74, v75
v_mfma_f32_16x16x32_bf16 v[68:71], v[12:15], v[142:145], v[112:115]
v_cvt_pk_bf16_f32 v98, v76, v77
v_cvt_pk_bf16_f32 v99, v78, v79
v_mfma_f32_16x16x32_bf16 v[72:75], v[8:11], v[146:149], v[116:119]
v_mfma_f32_16x16x32_bf16 v[76:79], v[12:15], v[146:149], v[116:119]
s_waitcnt lgkmcnt(0)
v_mfma_f32_16x16x32_bf16 v[40:43], v[16:19], v[150:153], v[40:43]
s_mov_b32 m0, s31
ds_read_b128 v[24:27], v6 offset:0
v_mfma_f32_16x16x32_bf16 v[44:47], v[20:23], v[150:153], v[44:47]
ds_read_b128 v[8:11], v0 offset:1024
ds_read_b128 v[28:31], v6 offset:1024
v_mfma_f32_16x16x32_bf16 v[48:51], v[16:19], v[154:157], v[48:51]
ds_read_b128 v[32:35], v6 offset:2048
buffer_load_dwordx4 v7, s[8:11], s24 offen offset:0 nt lds
v_mfma_f32_16x16x32_bf16 v[52:55], v[20:23], v[154:157], v[52:55]
ds_read_b128 v[12:15], v0 offset:9216
ds_read_b128 v[36:39], v6 offset:3072
v_mfma_f32_16x16x32_bf16 v[56:59], v[16:19], v[158:161], v[56:59]
s_add_u32 s34, s34, 16384
v_mfma_f32_16x16x32_bf16 v[60:63], v[20:23], v[158:161], v[60:63]
v_mfma_f32_16x16x32_bf16 v[64:67], v[16:19], v[162:165], v[64:67]
v_mfma_f32_16x16x32_bf16 v[68:71], v[20:23], v[162:165], v[68:71]
v_mfma_f32_16x16x32_bf16 v[72:75], v[16:19], v[166:169], v[72:75]
v_mfma_f32_16x16x32_bf16 v[76:79], v[20:23], v[166:169], v[76:79]
s_waitcnt lgkmcnt(1)
buffer_load_dwordx4 v7, s[8:11], s25 offen offset:1024 nt lds
v_mfma_f32_16x16x32_bf16 v[40:43], v[8:11], v[24:27], v[40:43]
v_mfma_f32_16x16x32_bf16 v[44:47], v[12:15], v[24:27], v[44:47]
ds_read_b128 v[24:27], v6 offset:4096
v_mfma_f32_16x16x32_bf16 v[48:51], v[8:11], v[28:31], v[48:51]
ds_read_b128 v[16:19], v1 offset:1024
v_mfma_f32_16x16x32_bf16 v[52:55], v[12:15], v[28:31], v[52:55]
ds_read_b128 v[28:31], v6 offset:5120
v_mfma_f32_16x16x32_bf16 v[56:59], v[8:11], v[32:35], v[56:59]
ds_read_b128 v[20:23], v1 offset:9216
v_mfma_f32_16x16x32_bf16 v[60:63], v[12:15], v[32:35], v[60:63]
s_waitcnt lgkmcnt(4)
ds_read_b128 v[32:35], v6 offset:6144
v_mfma_f32_16x16x32_bf16 v[64:67], v[8:11], v[36:39], v[64:67]
v_mfma_f32_16x16x32_bf16 v[68:71], v[12:15], v[36:39], v[68:71]
s_waitcnt lgkmcnt(4)
ds_read_b128 v[36:39], v6 offset:7168
v_mfma_f32_16x16x32_bf16 v[72:75], v[8:11], v[24:27], v[72:75]
buffer_load_dwordx4 v7, s[8:11], s26 offen offset:2048 nt lds
v_mfma_f32_16x16x32_bf16 v[76:79], v[12:15], v[24:27], v[76:79]
s_waitcnt lgkmcnt(2)
ds_read_b128 v[24:27], v6 offset:8192
v_mfma_f32_16x16x32_bf16 v[40:43], v[16:19], v[28:31], v[40:43]
v_mfma_f32_16x16x32_bf16 v[44:47], v[20:23], v[28:31], v[44:47]
s_waitcnt lgkmcnt(2)
ds_read_b128 v[28:31], v6 offset:9216
v_mfma_f32_16x16x32_bf16 v[48:51], v[16:19], v[32:35], v[48:51]
ds_read_b128 v[8:11], v0 offset:2048
v_mfma_f32_16x16x32_bf16 v[52:55], v[20:23], v[32:35], v[52:55]
s_waitcnt lgkmcnt(3)
ds_read_b128 v[32:35], v6 offset:10240
v_mfma_f32_16x16x32_bf16 v[56:59], v[16:19], v[36:39], v[56:59]
ds_read_b128 v[12:15], v0 offset:10240
v_mfma_f32_16x16x32_bf16 v[60:63], v[20:23], v[36:39], v[60:63]
s_waitcnt lgkmcnt(4)
ds_read_b128 v[36:39], v6 offset:11264
v_mfma_f32_16x16x32_bf16 v[64:67], v[16:19], v[24:27], v[64:67]
buffer_load_dwordx4 v7, s[8:11], 0 offen offset:3072 nt lds
v_mfma_f32_16x16x32_bf16 v[68:71], v[20:23], v[24:27], v[68:71]
s_waitcnt lgkmcnt(4)
ds_read_b128 v[24:27], v6 offset:12288
v_mfma_f32_16x16x32_bf16 v[72:75], v[16:19], v[28:31], v[72:75]
s_add_u32 s8, s8, 16384
s_addc_u32 s9, s9, 0
v_mfma_f32_16x16x32_bf16 v[76:79], v[20:23], v[28:31], v[76:79]
s_waitcnt lgkmcnt(2)
ds_read_b128 v[28:31], v6 offset:13312
v_mfma_f32_16x16x32_bf16 v[40:43], v[8:11], v[32:35], v[40:43]
s_add_u32 m0, s35, s71
v_mfma_f32_16x16x32_bf16 v[44:47], v[12:15], v[32:35], v[44:47]
s_waitcnt lgkmcnt(2)
ds_read_b128 v[32:35], v6 offset:14336
v_mfma_f32_16x16x32_bf16 v[48:51], v[8:11], v[36:39], v[48:51]
ds_read_b128 v[16:19], v1 offset:2048
buffer_load_dwordx4 v7, s[4:7], s24 offen offset:0 nt lds
v_mfma_f32_16x16x32_bf16 v[52:55], v[12:15], v[36:39], v[52:55]
s_waitcnt lgkmcnt(3)
ds_read_b128 v[36:39], v6 offset:15360
v_mfma_f32_16x16x32_bf16 v[56:59], v[8:11], v[24:27], v[56:59]
ds_read_b128 v[20:23], v1 offset:10240
v_mfma_f32_16x16x32_bf16 v[60:63], v[12:15], v[24:27], v[60:63]
s_waitcnt lgkmcnt(4)
ds_read_b128 v[24:27], v6 offset:16384
v_mfma_f32_16x16x32_bf16 v[64:67], v[8:11], v[28:31], v[64:67]
v_mfma_f32_16x16x32_bf16 v[68:71], v[12:15], v[28:31], v[68:71]
s_waitcnt lgkmcnt(4)
ds_read_b128 v[28:31], v6 offset:17408
v_mfma_f32_16x16x32_bf16 v[72:75], v[8:11], v[32:35], v[72:75]
v_mfma_f32_16x16x32_bf16 v[76:79], v[12:15], v[32:35], v[76:79]
s_waitcnt lgkmcnt(2)
ds_read_b128 v[32:35], v6 offset:18432
v_mfma_f32_16x16x32_bf16 v[40:43], v[16:19], v[36:39], v[40:43]
buffer_load_dwordx4 v7, s[4:7], s25 offen offset:1024 nt lds
v_mfma_f32_16x16x32_bf16 v[44:47], v[20:23], v[36:39], v[44:47]
s_waitcnt lgkmcnt(2)
ds_read_b128 v[36:39], v6 offset:19456
v_mfma_f32_16x16x32_bf16 v[48:51], v[16:19], v[24:27], v[48:51]
ds_read_b128 v[8:11], v0 offset:3072
v_mfma_f32_16x16x32_bf16 v[52:55], v[20:23], v[24:27], v[52:55]
s_waitcnt lgkmcnt(3)
ds_read_b128 v[24:27], v6 offset:20480
v_mfma_f32_16x16x32_bf16 v[56:59], v[16:19], v[28:31], v[56:59]
ds_read_b128 v[12:15], v0 offset:11264
v_mfma_f32_16x16x32_bf16 v[60:63], v[20:23], v[28:31], v[60:63]
s_waitcnt lgkmcnt(4)
ds_read_b128 v[28:31], v6 offset:21504
v_mfma_f32_16x16x32_bf16 v[64:67], v[16:19], v[32:35], v[64:67]
v_mfma_f32_16x16x32_bf16 v[68:71], v[20:23], v[32:35], v[68:71]
s_waitcnt lgkmcnt(4)
ds_read_b128 v[32:35], v6 offset:22528
v_mfma_f32_16x16x32_bf16 v[72:75], v[16:19], v[36:39], v[72:75]
buffer_load_dwordx4 v7, s[4:7], s26 offen offset:2048 nt lds
v_mfma_f32_16x16x32_bf16 v[76:79], v[20:23], v[36:39], v[76:79]
s_waitcnt lgkmcnt(2)
ds_read_b128 v[36:39], v6 offset:23552
v_mfma_f32_16x16x32_bf16 v[40:43], v[8:11], v[24:27], v[40:43]
v_mfma_f32_16x16x32_bf16 v[44:47], v[12:15], v[24:27], v[44:47]
s_waitcnt lgkmcnt(2)
ds_read_b128 v[24:27], v6 offset:24576
v_mfma_f32_16x16x32_bf16 v[48:51], v[8:11], v[28:31], v[48:51]
ds_read_b128 v[16:19], v1 offset:3072
v_mfma_f32_16x16x32_bf16 v[52:55], v[12:15], v[28:31], v[52:55]
s_waitcnt lgkmcnt(3)
ds_read_b128 v[20:23], v1 offset:11264
v_mfma_f32_16x16x32_bf16 v[56:59], v[8:11], v[32:35], v[56:59]
s_sub_u32 s69, s29, s28
v_add_u32 v0, s69, v0
v_mfma_f32_16x16x32_bf16 v[60:63], v[12:15], v[32:35], v[60:63]
s_waitcnt lgkmcnt(3)
v_add_u32 v1, s69, v1
v_mfma_f32_16x16x32_bf16 v[64:67], v[8:11], v[36:39], v[64:67]
buffer_load_dwordx4 v7, s[4:7], 0 offen offset:3072 nt lds
s_mov_b32 s65, s28
v_mfma_f32_16x16x32_bf16 v[68:71], v[12:15], v[36:39], v[68:71]
s_waitcnt lgkmcnt(2)
s_mov_b32 s28, s29
v_mfma_f32_16x16x32_bf16 v[72:75], v[8:11], v[24:27], v[72:75]
s_add_u32 s4, s4, s33
s_addc_u32 s5, s5, 0
v_mfma_f32_16x16x32_bf16 v[76:79], v[12:15], v[24:27], v[76:79]
s_waitcnt vmcnt(12) lgkmcnt(0)
s_barrier
v_mfma_f32_16x16x32_bf16 v[40:43], v[16:19], v[170:173], v[40:43]
ds_read_b64_tr_b16 v[24:25], v2 offset:0
s_mov_b32 s29, s35
v_mfma_f32_16x16x32_bf16 v[44:47], v[20:23], v[170:173], v[44:47]
ds_read_b64_tr_b16 v[26:27], v2 offset:8192
s_mov_b32 s35, s65
v_mfma_f32_16x16x32_bf16 v[48:51], v[16:19], v[174:177], v[48:51]
ds_read_b64_tr_b16 v[28:29], v3 offset:0
v_mfma_f32_16x16x32_bf16 v[52:55], v[20:23], v[174:177], v[52:55]
ds_read_b64_tr_b16 v[30:31], v3 offset:8192
v_mfma_f32_16x16x32_bf16 v[56:59], v[16:19], v[178:181], v[56:59]
ds_read_b64_tr_b16 v[32:33], v4 offset:0
v_mfma_f32_16x16x32_bf16 v[60:63], v[20:23], v[178:181], v[60:63]
ds_read_b64_tr_b16 v[34:35], v4 offset:8192
v_mfma_f32_16x16x32_bf16 v[64:67], v[16:19], v[182:185], v[64:67]
ds_read_b64_tr_b16 v[36:37], v5 offset:0
v_mfma_f32_16x16x32_bf16 v[68:71], v[20:23], v[182:185], v[68:71]
ds_read_b64_tr_b16 v[38:39], v5 offset:8192
v_mfma_f32_16x16x32_bf16 v[72:75], v[16:19], v[186:189], v[72:75]
v_mfma_f32_16x16x32_bf16 v[76:79], v[20:23], v[186:189], v[76:79]
s_waitcnt lgkmcnt(4)
v_mfma_f32_16x16x32_bf16 a[0:3], v[24:27], v[80:83], a[0:3]
ds_read_b64_tr_b16 v[16:17], v2 offset:1024
ds_read_b64_tr_b16 v[18:19], v2 offset:9216
v_mfma_f32_16x16x32_bf16 a[4:7], v[24:27], v[84:87], a[4:7]
v_exp_f32 v40, v40
v_mfma_f32_16x16x32_bf16 a[8:11], v[24:27], v[88:91], a[8:11]
ds_read_b64_tr_b16 v[20:21], v3 offset:1024
ds_read_b64_tr_b16 v[22:23], v3 offset:9216
v_mfma_f32_16x16x32_bf16 a[12:15], v[24:27], v[92:95], a[12:15]
v_exp_f32 v41, v41
v_mfma_f32_16x16x32_bf16 v[192:195], v[24:27], v[96:99], v[192:195]
v_exp_f32 v42, v42
v_mfma_f32_16x16x32_bf16 a[16:19], v[28:31], v[80:83], a[16:19]
v_exp_f32 v43, v43
v_mfma_f32_16x16x32_bf16 a[20:23], v[28:31], v[84:87], a[20:23]
v_add_f32 v125, v120, v40
v_add_f32 v125, v125, v41
v_mfma_f32_16x16x32_bf16 a[24:27], v[28:31], v[88:91], a[24:27]
v_exp_f32 v44, v44
v_mfma_f32_16x16x32_bf16 a[28:31], v[28:31], v[92:95], a[28:31]
v_add_f32 v125, v125, v42
v_add_f32 v125, v125, v43
v_mfma_f32_16x16x32_bf16 v[196:199], v[28:31], v[96:99], v[196:199]
s_waitcnt lgkmcnt(4)
v_add_f32 v125, v125, v44
v_mfma_f32_16x16x32_bf16 a[32:35], v[32:35], v[80:83], a[32:35]
ds_read_b64_tr_b16 v[24:25], v4 offset:1024
ds_read_b64_tr_b16 v[26:27], v4 offset:9216
v_mfma_f32_16x16x32_bf16 a[36:39], v[32:35], v[84:87], a[36:39]
v_exp_f32 v45, v45
v_mfma_f32_16x16x32_bf16 a[40:43], v[32:35], v[88:91], a[40:43]
v_exp_f32 v46, v46
v_mfma_f32_16x16x32_bf16 a[44:47], v[32:35], v[92:95], a[44:47]
ds_read_b64_tr_b16 v[28:29], v5 offset:1024
ds_read_b64_tr_b16 v[30:31], v5 offset:9216
v_mfma_f32_16x16x32_bf16 v[200:203], v[32:35], v[96:99], v[200:203]
v_exp_f32 v47, v47
v_mfma_f32_16x16x32_bf16 a[48:51], v[36:39], v[80:83], a[48:51]
v_exp_f32 v48, v48
v_mfma_f32_16x16x32_bf16 a[52:55], v[36:39], v[84:87], a[52:55]
v_add_f32 v125, v125, v45
v_add_f32 v125, v125, v46
v_mfma_f32_16x16x32_bf16 a[56:59], v[36:39], v[88:91], a[56:59]
v_exp_f32 v49, v49
v_mfma_f32_16x16x32_bf16 a[60:63], v[36:39], v[92:95], a[60:63]
v_add_f32 v125, v125, v47
v_add_f32 v126, v121, v48
v_mfma_f32_16x16x32_bf16 v[204:207], v[36:39], v[96:99], v[204:207]
s_waitcnt lgkmcnt(4)
v_add_f32 v126, v126, v49
v_mfma_f32_16x16x32_bf16 a[64:67], v[16:19], v[80:83], a[64:67]
v_exp_f32 v50, v50
v_mfma_f32_16x16x32_bf16 a[68:71], v[16:19], v[84:87], a[68:71]
ds_read_b64_tr_b16 v[32:33], v2 offset:2048
ds_read_b64_tr_b16 v[34:35], v2 offset:10240
v_mfma_f32_16x16x32_bf16 a[72:75], v[16:19], v[88:91], a[72:75]
v_exp_f32 v51, v51
v_mfma_f32_16x16x32_bf16 a[76:79], v[16:19], v[92:95], a[76:79]
ds_read_b64_tr_b16 v[36:37], v3 offset:2048
ds_read_b64_tr_b16 v[38:39], v3 offset:10240
v_mfma_f32_16x16x32_bf16 v[208:211], v[16:19], v[96:99], v[208:211]
v_exp_f32 v52, v52
v_mfma_f32_16x16x32_bf16 a[80:83], v[20:23], v[80:83], a[80:83]
v_exp_f32 v53, v53
v_mfma_f32_16x16x32_bf16 a[84:87], v[20:23], v[84:87], a[84:87]
v_add_f32 v126, v126, v50
v_add_f32 v126, v126, v51
v_mfma_f32_16x16x32_bf16 a[88:91], v[20:23], v[88:91], a[88:91]
v_exp_f32 v54, v54
v_mfma_f32_16x16x32_bf16 a[92:95], v[20:23], v[92:95], a[92:95]
v_add_f32 v126, v126, v52
v_add_f32 v126, v126, v53
v_mfma_f32_16x16x32_bf16 v[212:215], v[20:23], v[96:99], v[212:215]
s_waitcnt lgkmcnt(4)
v_add_f32 v126, v126, v54
v_mfma_f32_16x16x32_bf16 a[96:99], v[24:27], v[80:83], a[96:99]
v_exp_f32 v55, v55
v_mfma_f32_16x16x32_bf16 a[100:103], v[24:27], v[84:87], a[100:103]
v_exp_f32 v56, v56
v_mfma_f32_16x16x32_bf16 a[104:107], v[24:27], v[88:91], a[104:107]
ds_read_b64_tr_b16 v[16:17], v4 offset:2048
ds_read_b64_tr_b16 v[18:19], v4 offset:10240
v_mfma_f32_16x16x32_bf16 a[108:111], v[24:27], v[92:95], a[108:111]
v_exp_f32 v57, v57
v_mfma_f32_16x16x32_bf16 v[216:219], v[24:27], v[96:99], v[216:219]
ds_read_b64_tr_b16 v[20:21], v5 offset:2048
ds_read_b64_tr_b16 v[22:23], v5 offset:10240
v_mfma_f32_16x16x32_bf16 a[112:115], v[28:31], v[80:83], a[112:115]
v_exp_f32 v58, v58
v_add_f32 v126, v126, v55
v_mfma_f32_16x16x32_bf16 a[116:119], v[28:31], v[84:87], a[116:119]
v_add_f32 v127, v122, v56
v_add_f32 v127, v127, v57
v_mfma_f32_16x16x32_bf16 a[120:123], v[28:31], v[88:91], a[120:123]
v_exp_f32 v59, v59
v_mfma_f32_16x16x32_bf16 a[124:127], v[28:31], v[92:95], a[124:127]
v_exp_f32 v60, v60
v_mfma_f32_16x16x32_bf16 v[220:223], v[28:31], v[96:99], v[220:223]
s_waitcnt lgkmcnt(4)
v_add_f32 v127, v127, v58
v_mfma_f32_16x16x32_bf16 a[128:131], v[32:35], v[80:83], a[128:131]
v_exp_f32 v61, v61
v_mfma_f32_16x16x32_bf16 a[132:135], v[32:35], v[84:87], a[132:135]
ds_read_b64_tr_b16 v[24:25], v2 offset:3072
v_add_f32 v127, v127, v59
v_mfma_f32_16x16x32_bf16 a[136:139], v[32:35], v[88:91], a[136:139]
v_exp_f32 v62, v62
v_mfma_f32_16x16x32_bf16 a[140:143], v[32:35], v[92:95], a[140:143]
ds_read_b64_tr_b16 v[26:27], v2 offset:11264
ds_read_b64_tr_b16 v[28:29], v3 offset:3072
v_mfma_f32_16x16x32_bf16 v[224:227], v[32:35], v[96:99], v[224:227]
v_exp_f32 v63, v63
v_add_f32 v127, v127, v60
v_mfma_f32_16x16x32_bf16 a[144:147], v[36:39], v[80:83], a[144:147]
ds_read_b64_tr_b16 v[30:31], v3 offset:11264
v_add_f32 v127, v127, v61
v_mfma_f32_16x16x32_bf16 a[148:151], v[36:39], v[84:87], a[148:151]
v_exp_f32 v64, v64
v_mfma_f32_16x16x32_bf16 a[152:155], v[36:39], v[88:91], a[152:155]
v_add_f32 v127, v127, v62
v_add_f32 v127, v127, v63
v_mfma_f32_16x16x32_bf16 a[156:159], v[36:39], v[92:95], a[156:159]
v_exp_f32 v65, v65
v_mfma_f32_16x16x32_bf16 v[228:231], v[36:39], v[96:99], v[228:231]
s_waitcnt lgkmcnt(4)
v_exp_f32 v66, v66
v_mfma_f32_16x16x32_bf16 a[160:163], v[16:19], v[80:83], a[160:163]
v_exp_f32 v67, v67
v_mfma_f32_16x16x32_bf16 a[164:167], v[16:19], v[84:87], a[164:167]
v_add_f32 v128, v123, v64
ds_read_b64_tr_b16 v[32:33], v4 offset:3072
v_mfma_f32_16x16x32_bf16 a[168:171], v[16:19], v[88:91], a[168:171]
ds_read_b64_tr_b16 v[34:35], v4 offset:11264
v_add_f32 v128, v128, v65
v_mfma_f32_16x16x32_bf16 a[172:175], v[16:19], v[92:95], a[172:175]
v_exp_f32 v68, v68
v_mfma_f32_16x16x32_bf16 v[232:235], v[16:19], v[96:99], v[232:235]
ds_read_b64_tr_b16 v[36:37], v5 offset:3072
v_add_f32 v128, v128, v66
v_mfma_f32_16x16x32_bf16 a[176:179], v[20:23], v[80:83], a[176:179]
ds_read_b64_tr_b16 v[38:39], v5 offset:11264
v_exp_f32 v69, v69
v_mfma_f32_16x16x32_bf16 a[180:183], v[20:23], v[84:87], a[180:183]
v_add_f32 v128, v128, v67
v_add_f32 v128, v128, v68
v_mfma_f32_16x16x32_bf16 a[184:187], v[20:23], v[88:91], a[184:187]
v_exp_f32 v70, v70
v_mfma_f32_16x16x32_bf16 a[188:191], v[20:23], v[92:95], a[188:191]
v_exp_f32 v71, v71
v_mfma_f32_16x16x32_bf16 v[236:239], v[20:23], v[96:99], v[236:239]
s_waitcnt lgkmcnt(4)
v_add_f32 v128, v128, v69
v_mfma_f32_16x16x32_bf16 a[192:195], v[24:27], v[80:83], a[192:195]
v_exp_f32 v72, v72
v_mfma_f32_16x16x32_bf16 a[196:199], v[24:27], v[84:87], a[196:199]
v_exp_f32 v73, v73
v_mfma_f32_16x16x32_bf16 a[200:203], v[24:27], v[88:91], a[200:203]
v_add_f32 v128, v128, v70
v_add_f32 v128, v128, v71
v_mfma_f32_16x16x32_bf16 a[204:207], v[24:27], v[92:95], a[204:207]
v_exp_f32 v74, v74
v_mfma_f32_16x16x32_bf16 v[240:243], v[24:27], v[96:99], v[240:243]
v_add_f32 v129, v124, v72
v_add_f32 v129, v129, v73
v_mfma_f32_16x16x32_bf16 a[208:211], v[28:31], v[80:83], a[208:211]
v_exp_f32 v75, v75
v_mfma_f32_16x16x32_bf16 a[212:215], v[28:31], v[84:87], a[212:215]
v_exp_f32 v76, v76
v_mfma_f32_16x16x32_bf16 a[216:219], v[28:31], v[88:91], a[216:219]
v_exp_f32 v77, v77
v_mfma_f32_16x16x32_bf16 a[220:223], v[28:31], v[92:95], a[220:223]
v_add_f32 v129, v129, v74
v_add_f32 v129, v129, v75
v_mfma_f32_16x16x32_bf16 v[244:247], v[28:31], v[96:99], v[244:247]
s_waitcnt vmcnt(8) lgkmcnt(0)
s_barrier
v_mfma_f32_16x16x32_bf16 a[224:227], v[32:35], v[80:83], a[224:227]
ds_read_b128 v[8:11], v0 offset:0
ds_read_b128 v[12:15], v0 offset:8192
v_mfma_f32_16x16x32_bf16 a[228:231], v[32:35], v[84:87], a[228:231]
v_exp_f32 v78, v78
v_mfma_f32_16x16x32_bf16 a[232:235], v[32:35], v[88:91], a[232:235]
ds_read_b128 v[16:19], v1 offset:0
v_add_f32 v129, v129, v76
v_mfma_f32_16x16x32_bf16 a[236:239], v[32:35], v[92:95], a[236:239]
ds_read_b128 v[20:23], v1 offset:8192
v_exp_f32 v79, v79
v_mfma_f32_16x16x32_bf16 v[248:251], v[32:35], v[96:99], v[248:251]
v_add_f32 v129, v129, v77
v_add_f32 v129, v129, v78
v_mfma_f32_16x16x32_bf16 a[240:243], v[36:39], v[80:83], a[240:243]
v_add_f32 v129, v129, v79
v_max3_f32 v190, v125, v126, v127
v_mfma_f32_16x16x32_bf16 a[244:247], v[36:39], v[84:87], a[244:247]
v_max3_f32 v190, v190, v128, v129
v_cmp_nge_f32 vcc, s38, v190
v_mfma_f32_16x16x32_bf16 a[248:251], v[36:39], v[88:91], a[248:251]
v_cvt_pk_bf16_f32 v80, v40, v41
v_cvt_pk_bf16_f32 v81, v42, v43
v_mfma_f32_16x16x32_bf16 a[252:255], v[36:39], v[92:95], a[252:255]
v_cvt_pk_bf16_f32 v82, v44, v45
v_cvt_pk_bf16_f32 v83, v46, v47
v_mfma_f32_16x16x32_bf16 v[252:255], v[36:39], v[96:99], v[252:255]
s_cbranch_vccnz L_sp1_r5
L_sp1_r5_ret:
s_waitcnt lgkmcnt(2)
v_mfma_f32_16x16x32_bf16 v[40:43], v[8:11], v[130:133], v[100:103]
v_cvt_pk_bf16_f32 v84, v48, v49
v_cvt_pk_bf16_f32 v85, v50, v51
v_mfma_f32_16x16x32_bf16 v[44:47], v[12:15], v[130:133], v[100:103]
v_cvt_pk_bf16_f32 v86, v52, v53
v_cvt_pk_bf16_f32 v87, v54, v55
v_mfma_f32_16x16x32_bf16 v[48:51], v[8:11], v[134:137], v[104:107]
v_cvt_pk_bf16_f32 v88, v56, v57
v_cvt_pk_bf16_f32 v89, v58, v59
v_mfma_f32_16x16x32_bf16 v[52:55], v[12:15], v[134:137], v[104:107]
v_cvt_pk_bf16_f32 v90, v60, v61
v_cvt_pk_bf16_f32 v91, v62, v63
v_mfma_f32_16x16x32_bf16 v[56:59], v[8:11], v[138:141], v[108:111]
v_cvt_pk_bf16_f32 v92, v64, v65
v_cvt_pk_bf16_f32 v93, v66, v67
v_mfma_f32_16x16x32_bf16 v[60:63], v[12:15], v[138:141], v[108:111]
v_cvt_pk_bf16_f32 v94, v68, v69
v_cvt_pk_bf16_f32 v95, v70, v71
v_mfma_f32_16x16x32_bf16 v[64:67], v[8:11], v[142:145], v[112:115]
v_cvt_pk_bf16_f32 v96, v72, v73
v_cvt_pk_bf16_f32 v97, v74, v75
v_mfma_f32_16x16x32_bf16 v[68:71], v[12:15], v[142:145], v[112:115]
v_cvt_pk_bf16_f32 v98, v76, v77
v_cvt_pk_bf16_f32 v99, v78, v79
v_mfma_f32_16x16x32_bf16 v[72:75], v[8:11], v[146:149], v[116:119]
v_mfma_f32_16x16x32_bf16 v[76:79], v[12:15], v[146:149], v[116:119]
s_waitcnt lgkmcnt(0)
v_mfma_f32_16x16x32_bf16 v[40:43], v[16:19], v[150:153], v[40:43]
s_mov_b32 m0, s30
ds_read_b128 v[24:27], v6 offset:0
v_mfma_f32_16x16x32_bf16 v[44:47], v[20:23], v[150:153], v[44:47]
ds_read_b128 v[8:11], v0 offset:1024
ds_read_b128 v[28:31], v6 offset:1024
v_mfma_f32_16x16x32_bf16 v[48:51], v[16:19], v[154:157], v[48:51]
ds_read_b128 v[32:35], v6 offset:2048
buffer_load_dwordx4 v7, s[8:11], s24 offen offset:0 nt lds
v_mfma_f32_16x16x32_bf16 v[52:55], v[20:23], v[154:157], v[52:55]
ds_read_b128 v[12:15], v0 offset:9216
ds_read_b128 v[36:39], v6 offset:3072
v_mfma_f32_16x16x32_bf16 v[56:59], v[16:19], v[158:161], v[56:59]
s_add_u32 s34, s34, 16384
v_mfma_f32_16x16x32_bf16 v[60:63], v[20:23], v[158:161], v[60:63]
v_mfma_f32_16x16x32_bf16 v[64:67], v[16:19], v[162:165], v[64:67]
v_mfma_f32_16x16x32_bf16 v[68:71], v[20:23], v[162:165], v[68:71]
v_mfma_f32_16x16x32_bf16 v[72:75], v[16:19], v[166:169], v[72:75]
v_mfma_f32_16x16x32_bf16 v[76:79], v[20:23], v[166:169], v[76:79]
s_waitcnt lgkmcnt(1)
buffer_load_dwordx4 v7, s[8:11], s25 offen offset:1024 nt lds
v_mfma_f32_16x16x32_bf16 v[40:43], v[8:11], v[24:27], v[40:43]
v_mfma_f32_16x16x32_bf16 v[44:47], v[12:15], v[24:27], v[44:47]
ds_read_b128 v[24:27], v6 offset:4096
v_mfma_f32_16x16x32_bf16 v[48:51], v[8:11], v[28:31], v[48:51]
ds_read_b128 v[16:19], v1 offset:1024
v_mfma_f32_16x16x32_bf16 v[52:55], v[12:15], v[28:31], v[52:55]
ds_read_b128 v[28:31], v6 offset:5120
v_mfma_f32_16x16x32_bf16 v[56:59], v[8:11], v[32:35], v[56:59]
ds_read_b128 v[20:23], v1 offset:9216
v_mfma_f32_16x16x32_bf16 v[60:63], v[12:15], v[32:35], v[60:63]
s_waitcnt lgkmcnt(4)
ds_read_b128 v[32:35], v6 offset:6144
v_mfma_f32_16x16x32_bf16 v[64:67], v[8:11], v[36:39], v[64:67]
v_mfma_f32_16x16x32_bf16 v[68:71], v[12:15], v[36:39], v[68:71]
s_waitcnt lgkmcnt(4)
ds_read_b128 v[36:39], v6 offset:7168
v_mfma_f32_16x16x32_bf16 v[72:75], v[8:11], v[24:27], v[72:75]
buffer_load_dwordx4 v7, s[8:11], s26 offen offset:2048 nt lds
v_mfma_f32_16x16x32_bf16 v[76:79], v[12:15], v[24:27], v[76:79]
s_waitcnt lgkmcnt(2)
ds_read_b128 v[24:27], v6 offset:8192
v_mfma_f32_16x16x32_bf16 v[40:43], v[16:19], v[28:31], v[40:43]
v_mfma_f32_16x16x32_bf16 v[44:47], v[20:23], v[28:31], v[44:47]
s_waitcnt lgkmcnt(2)
ds_read_b128 v[28:31], v6 offset:9216
v_mfma_f32_16x16x32_bf16 v[48:51], v[16:19], v[32:35], v[48:51]
ds_read_b128 v[8:11], v0 offset:2048
v_mfma_f32_16x16x32_bf16 v[52:55], v[20:23], v[32:35], v[52:55]
s_waitcnt lgkmcnt(3)
ds_read_b128 v[32:35], v6 offset:10240
v_mfma_f32_16x16x32_bf16 v[56:59], v[16:19], v[36:39], v[56:59]
ds_read_b128 v[12:15], v0 offset:10240
v_mfma_f32_16x16x32_bf16 v[60:63], v[20:23], v[36:39], v[60:63]
s_waitcnt lgkmcnt(4)
ds_read_b128 v[36:39], v6 offset:11264
v_mfma_f32_16x16x32_bf16 v[64:67], v[16:19], v[24:27], v[64:67]
buffer_load_dwordx4 v7, s[8:11], 0 offen offset:3072 nt lds
v_mfma_f32_16x16x32_bf16 v[68:71], v[20:23], v[24:27], v[68:71]
s_waitcnt lgkmcnt(4)
ds_read_b128 v[24:27], v6 offset:12288
v_mfma_f32_16x16x32_bf16 v[72:75], v[16:19], v[28:31], v[72:75]
s_add_u32 s8, s8, 16384
s_addc_u32 s9, s9, 0
v_mfma_f32_16x16x32_bf16 v[76:79], v[20:23], v[28:31], v[76:79]
s_waitcnt lgkmcnt(2)
ds_read_b128 v[28:31], v6 offset:13312
v_mfma_f32_16x16x32_bf16 v[40:43], v[8:11], v[32:35], v[40:43]
s_add_u32 m0, s35, s71
v_mfma_f32_16x16x32_bf16 v[44:47], v[12:15], v[32:35], v[44:47]
s_waitcnt lgkmcnt(2)
ds_read_b128 v[32:35], v6 offset:14336
v_mfma_f32_16x16x32_bf16 v[48:51], v[8:11], v[36:39], v[48:51]
ds_read_b128 v[16:19], v1 offset:2048
buffer_load_dwordx4 v7, s[4:7], s24 offen offset:0 nt lds
v_mfma_f32_16x16x32_bf16 v[52:55], v[12:15], v[36:39], v[52:55]
s_waitcnt lgkmcnt(3)
ds_read_b128 v[36:39], v6 offset:15360
v_mfma_f32_16x16x32_bf16 v[56:59], v[8:11], v[24:27], v[56:59]
ds_read_b128 v[20:23], v1 offset:10240
v_mfma_f32_16x16x32_bf16 v[60:63], v[12:15], v[24:27], v[60:63]
s_waitcnt lgkmcnt(4)
ds_read_b128 v[24:27], v6 offset:16384
v_mfma_f32_16x16x32_bf16 v[64:67], v[8:11], v[28:31], v[64:67]
v_mfma_f32_16x16x32_bf16 v[68:71], v[12:15], v[28:31], v[68:71]
s_waitcnt lgkmcnt(4)
ds_read_b128 v[28:31], v6 offset:17408
v_mfma_f32_16x16x32_bf16 v[72:75], v[8:11], v[32:35], v[72:75]
v_mfma_f32_16x16x32_bf16 v[76:79], v[12:15], v[32:35], v[76:79]
s_waitcnt lgkmcnt(2)
ds_read_b128 v[32:35], v6 offset:18432
v_mfma_f32_16x16x32_bf16 v[40:43], v[16:19], v[36:39], v[40:43]
buffer_load_dwordx4 v7, s[4:7], s25 offen offset:1024 nt lds
v_mfma_f32_16x16x32_bf16 v[44:47], v[20:23], v[36:39], v[44:47]
s_waitcnt lgkmcnt(2)
ds_read_b128 v[36:39], v6 offset:19456
v_mfma_f32_16x16x32_bf16 v[48:51], v[16:19], v[24:27], v[48:51]
ds_read_b128 v[8:11], v0 offset:3072
v_mfma_f32_16x16x32_bf16 v[52:55], v[20:23], v[24:27], v[52:55]
s_waitcnt lgkmcnt(3)
ds_read_b128 v[24:27], v6 offset:20480
v_mfma_f32_16x16x32_bf16 v[56:59], v[16:19], v[28:31], v[56:59]
ds_read_b128 v[12:15], v0 offset:11264
v_mfma_f32_16x16x32_bf16 v[60:63], v[20:23], v[28:31], v[60:63]
s_waitcnt lgkmcnt(4)
ds_read_b128 v[28:31], v6 offset:21504
v_mfma_f32_16x16x32_bf16 v[64:67], v[16:19], v[32:35], v[64:67]
v_mfma_f32_16x16x32_bf16 v[68:71], v[20:23], v[32:35], v[68:71]
s_waitcnt lgkmcnt(4)
ds_read_b128 v[32:35], v6 offset:22528
v_mfma_f32_16x16x32_bf16 v[72:75], v[16:19], v[36:39], v[72:75]
buffer_load_dwordx4 v7, s[4:7], s26 offen offset:2048 nt lds
v_mfma_f32_16x16x32_bf16 v[76:79], v[20:23], v[36:39], v[76:79]
s_waitcnt lgkmcnt(2)
ds_read_b128 v[36:39], v6 offset:23552
v_mfma_f32_16x16x32_bf16 v[40:43], v[8:11], v[24:27], v[40:43]
v_mfma_f32_16x16x32_bf16 v[44:47], v[12:15], v[24:27], v[44:47]
s_waitcnt lgkmcnt(2)
ds_read_b128 v[24:27], v6 offset:24576
v_mfma_f32_16x16x32_bf16 v[48:51], v[8:11], v[28:31], v[48:51]
ds_read_b128 v[16:19], v1 offset:3072
v_mfma_f32_16x16x32_bf16 v[52:55], v[12:15], v[28:31], v[52:55]
s_waitcnt lgkmcnt(3)
ds_read_b128 v[20:23], v1 offset:11264
v_mfma_f32_16x16x32_bf16 v[56:59], v[8:11], v[32:35], v[56:59]
s_sub_u32 s69, s29, s28
v_add_u32 v0, s69, v0
v_mfma_f32_16x16x32_bf16 v[60:63], v[12:15], v[32:35], v[60:63]
s_waitcnt lgkmcnt(3)
v_add_u32 v1, s69, v1
v_mfma_f32_16x16x32_bf16 v[64:67], v[8:11], v[36:39], v[64:67]
buffer_load_dwordx4 v7, s[4:7], 0 offen offset:3072 nt lds
s_mov_b32 s65, s28
v_mfma_f32_16x16x32_bf16 v[68:71], v[12:15], v[36:39], v[68:71]
s_waitcnt lgkmcnt(2)
s_mov_b32 s28, s29
v_mfma_f32_16x16x32_bf16 v[72:75], v[8:11], v[24:27], v[72:75]
s_add_u32 s4, s4, s33
s_addc_u32 s5, s5, 0
v_mfma_f32_16x16x32_bf16 v[76:79], v[12:15], v[24:27], v[76:79]
s_waitcnt vmcnt(12) lgkmcnt(0)
s_barrier
v_mfma_f32_16x16x32_bf16 v[40:43], v[16:19], v[170:173], v[40:43]
ds_read_b64_tr_b16 v[24:25], v2 offset:16384
s_mov_b32 s29, s35
v_mfma_f32_16x16x32_bf16 v[44:47], v[20:23], v[170:173], v[44:47]
ds_read_b64_tr_b16 v[26:27], v2 offset:24576
s_mov_b32 s35, s65
v_mfma_f32_16x16x32_bf16 v[48:51], v[16:19], v[174:177], v[48:51]
ds_read_b64_tr_b16 v[28:29], v3 offset:16384
v_mfma_f32_16x16x32_bf16 v[52:55], v[20:23], v[174:177], v[52:55]
ds_read_b64_tr_b16 v[30:31], v3 offset:24576
v_mfma_f32_16x16x32_bf16 v[56:59], v[16:19], v[178:181], v[56:59]
ds_read_b64_tr_b16 v[32:33], v4 offset:16384
v_mfma_f32_16x16x32_bf16 v[60:63], v[20:23], v[178:181], v[60:63]
ds_read_b64_tr_b16 v[34:35], v4 offset:24576
v_mfma_f32_16x16x32_bf16 v[64:67], v[16:19], v[182:185], v[64:67]
ds_read_b64_tr_b16 v[36:37], v5 offset:16384
v_mfma_f32_16x16x32_bf16 v[68:71], v[20:23], v[182:185], v[68:71]
ds_read_b64_tr_b16 v[38:39], v5 offset:24576
v_mfma_f32_16x16x32_bf16 v[72:75], v[16:19], v[186:189], v[72:75]
v_mfma_f32_16x16x32_bf16 v[76:79], v[20:23], v[186:189], v[76:79]
s_waitcnt lgkmcnt(4)
v_mfma_f32_16x16x32_bf16 a[0:3], v[24:27], v[80:83], a[0:3]
ds_read_b64_tr_b16 v[16:17], v2 offset:17408
ds_read_b64_tr_b16 v[18:19], v2 offset:25600
v_mfma_f32_16x16x32_bf16 a[4:7], v[24:27], v[84:87], a[4:7]
v_exp_f32 v40, v40
v_mfma_f32_16x16x32_bf16 a[8:11], v[24:27], v[88:91], a[8:11]
ds_read_b64_tr_b16 v[20:21], v3 offset:17408
ds_read_b64_tr_b16 v[22:23], v3 offset:25600
v_mfma_f32_16x16x32_bf16 a[12:15], v[24:27], v[92:95], a[12:15]
v_exp_f32 v41, v41
v_mfma_f32_16x16x32_bf16 v[192:195], v[24:27], v[96:99], v[192:195]
v_exp_f32 v42, v42
v_mfma_f32_16x16x32_bf16 a[16:19], v[28:31], v[80:83], a[16:19]
v_exp_f32 v43, v43
v_mfma_f32_16x16x32_bf16 a[20:23], v[28:31], v[84:87], a[20:23]
v_add_f32 v120, v125, v40
v_add_f32 v120, v120, v41
v_mfma_f32_16x16x32_bf16 a[24:27], v[28:31], v[88:91], a[24:27]
v_exp_f32 v44, v44
v_mfma_f32_16x16x32_bf16 a[28:31], v[28:31], v[92:95], a[28:31]
v_add_f32 v120, v120, v42
v_add_f32 v120, v120, v43
v_mfma_f32_16x16x32_bf16 v[196:199], v[28:31], v[96:99], v[196:199]
s_waitcnt lgkmcnt(4)
v_add_f32 v120, v120, v44
v_mfma_f32_16x16x32_bf16 a[32:35], v[32:35], v[80:83], a[32:35]
ds_read_b64_tr_b16 v[24:25], v4 offset:17408
ds_read_b64_tr_b16 v[26:27], v4 offset:25600
v_mfma_f32_16x16x32_bf16 a[36:39], v[32:35], v[84:87], a[36:39]
v_exp_f32 v45, v45
v_mfma_f32_16x16x32_bf16 a[40:43], v[32:35], v[88:91], a[40:43]
v_exp_f32 v46, v46
v_mfma_f32_16x16x32_bf16 a[44:47], v[32:35], v[92:95], a[44:47]
ds_read_b64_tr_b16 v[28:29], v5 offset:17408
ds_read_b64_tr_b16 v[30:31], v5 offset:25600
v_mfma_f32_16x16x32_bf16 v[200:203], v[32:35], v[96:99], v[200:203]
v_exp_f32 v47, v47
v_mfma_f32_16x16x32_bf16 a[48:51], v[36:39], v[80:83], a[48:51]
v_exp_f32 v48, v48
v_mfma_f32_16x16x32_bf16 a[52:55], v[36:39], v[84:87], a[52:55]
v_add_f32 v120, v120, v45
v_add_f32 v120, v120, v46
v_mfma_f32_16x16x32_bf16 a[56:59], v[36:39], v[88:91], a[56:59]
v_exp_f32 v49, v49
v_mfma_f32_16x16x32_bf16 a[60:63], v[36:39], v[92:95], a[60:63]
v_add_f32 v120, v120, v47
v_add_f32 v121, v126, v48
v_mfma_f32_16x16x32_bf16 v[204:207], v[36:39], v[96:99], v[204:207]
s_waitcnt lgkmcnt(4)
v_add_f32 v121, v121, v49
v_mfma_f32_16x16x32_bf16 a[64:67], v[16:19], v[80:83], a[64:67]
v_exp_f32 v50, v50
v_mfma_f32_16x16x32_bf16 a[68:71], v[16:19], v[84:87], a[68:71]
ds_read_b64_tr_b16 v[32:33], v2 offset:18432
ds_read_b64_tr_b16 v[34:35], v2 offset:26624
v_mfma_f32_16x16x32_bf16 a[72:75], v[16:19], v[88:91], a[72:75]
v_exp_f32 v51, v51
v_mfma_f32_16x16x32_bf16 a[76:79], v[16:19], v[92:95], a[76:79]
ds_read_b64_tr_b16 v[36:37], v3 offset:18432
ds_read_b64_tr_b16 v[38:39], v3 offset:26624
v_mfma_f32_16x16x32_bf16 v[208:211], v[16:19], v[96:99], v[208:211]
v_exp_f32 v52, v52
v_mfma_f32_16x16x32_bf16 a[80:83], v[20:23], v[80:83], a[80:83]
v_exp_f32 v53, v53
v_mfma_f32_16x16x32_bf16 a[84:87], v[20:23], v[84:87], a[84:87]
v_add_f32 v121, v121, v50
v_add_f32 v121, v121, v51
v_mfma_f32_16x16x32_bf16 a[88:91], v[20:23], v[88:91], a[88:91]
v_exp_f32 v54, v54
v_mfma_f32_16x16x32_bf16 a[92:95], v[20:23], v[92:95], a[92:95]
v_add_f32 v121, v121, v52
v_add_f32 v121, v121, v53
v_mfma_f32_16x16x32_bf16 v[212:215], v[20:23], v[96:99], v[212:215]
s_waitcnt lgkmcnt(4)
v_add_f32 v121, v121, v54
v_mfma_f32_16x16x32_bf16 a[96:99], v[24:27], v[80:83], a[96:99]
v_exp_f32 v55, v55
v_mfma_f32_16x16x32_bf16 a[100:103], v[24:27], v[84:87], a[100:103]
v_exp_f32 v56, v56
v_mfma_f32_16x16x32_bf16 a[104:107], v[24:27], v[88:91], a[104:107]
ds_read_b64_tr_b16 v[16:17], v4 offset:18432
ds_read_b64_tr_b16 v[18:19], v4 offset:26624
v_mfma_f32_16x16x32_bf16 a[108:111], v[24:27], v[92:95], a[108:111]
v_exp_f32 v57, v57
v_mfma_f32_16x16x32_bf16 v[216:219], v[24:27], v[96:99], v[216:219]
ds_read_b64_tr_b16 v[20:21], v5 offset:18432
ds_read_b64_tr_b16 v[22:23], v5 offset:26624
v_mfma_f32_16x16x32_bf16 a[112:115], v[28:31], v[80:83], a[112:115]
v_exp_f32 v58, v58
v_add_f32 v121, v121, v55
v_mfma_f32_16x16x32_bf16 a[116:119], v[28:31], v[84:87], a[116:119]
v_add_f32 v122, v127, v56
v_add_f32 v122, v122, v57
v_mfma_f32_16x16x32_bf16 a[120:123], v[28:31], v[88:91], a[120:123]
v_exp_f32 v59, v59
v_mfma_f32_16x16x32_bf16 a[124:127], v[28:31], v[92:95], a[124:127]
v_exp_f32 v60, v60
v_mfma_f32_16x16x32_bf16 v[220:223], v[28:31], v[96:99], v[220:223]
s_waitcnt lgkmcnt(4)
v_add_f32 v122, v122, v58
v_mfma_f32_16x16x32_bf16 a[128:131], v[32:35], v[80:83], a[128:131]
v_exp_f32 v61, v61
v_mfma_f32_16x16x32_bf16 a[132:135], v[32:35], v[84:87], a[132:135]
ds_read_b64_tr_b16 v[24:25], v2 offset:19456
v_add_f32 v122, v122, v59
v_mfma_f32_16x16x32_bf16 a[136:139], v[32:35], v[88:91], a[136:139]
v_exp_f32 v62, v62
v_mfma_f32_16x16x32_bf16 a[140:143], v[32:35], v[92:95], a[140:143]
ds_read_b64_tr_b16 v[26:27], v2 offset:27648
ds_read_b64_tr_b16 v[28:29], v3 offset:19456
v_mfma_f32_16x16x32_bf16 v[224:227], v[32:35], v[96:99], v[224:227]
v_exp_f32 v63, v63
v_add_f32 v122, v122, v60
v_mfma_f32_16x16x32_bf16 a[144:147], v[36:39], v[80:83], a[144:147]
ds_read_b64_tr_b16 v[30:31], v3 offset:27648
v_add_f32 v122, v122, v61
v_mfma_f32_16x16x32_bf16 a[148:151], v[36:39], v[84:87], a[148:151]
v_exp_f32 v64, v64
v_mfma_f32_16x16x32_bf16 a[152:155], v[36:39], v[88:91], a[152:155]
v_add_f32 v122, v122, v62
v_add_f32 v122, v122, v63
v_mfma_f32_16x16x32_bf16 a[156:159], v[36:39], v[92:95], a[156:159]
v_exp_f32 v65, v65
v_mfma_f32_16x16x32_bf16 v[228:231], v[36:39], v[96:99], v[228:231]
s_waitcnt lgkmcnt(4)
v_exp_f32 v66, v66
v_mfma_f32_16x16x32_bf16 a[160:163], v[16:19], v[80:83], a[160:163]
v_exp_f32 v67, v67
v_mfma_f32_16x16x32_bf16 a[164:167], v[16:19], v[84:87], a[164:167]
v_add_f32 v123, v128, v64
ds_read_b64_tr_b16 v[32:33], v4 offset:19456
v_mfma_f32_16x16x32_bf16 a[168:171], v[16:19], v[88:91], a[168:171]
ds_read_b64_tr_b16 v[34:35], v4 offset:27648
v_add_f32 v123, v123, v65
v_mfma_f32_16x16x32_bf16 a[172:175], v[16:19], v[92:95], a[172:175]
v_exp_f32 v68, v68
v_mfma_f32_16x16x32_bf16 v[232:235], v[16:19], v[96:99], v[232:235]
ds_read_b64_tr_b16 v[36:37], v5 offset:19456
v_add_f32 v123, v123, v66
v_mfma_f32_16x16x32_bf16 a[176:179], v[20:23], v[80:83], a[176:179]
ds_read_b64_tr_b16 v[38:39], v5 offset:27648
v_exp_f32 v69, v69
v_mfma_f32_16x16x32_bf16 a[180:183], v[20:23], v[84:87], a[180:183]
v_add_f32 v123, v123, v67
v_add_f32 v123, v123, v68
v_mfma_f32_16x16x32_bf16 a[184:187], v[20:23], v[88:91], a[184:187]
v_exp_f32 v70, v70
v_mfma_f32_16x16x32_bf16 a[188:191], v[20:23], v[92:95], a[188:191]
v_exp_f32 v71, v71
v_mfma_f32_16x16x32_bf16 v[236:239], v[20:23], v[96:99], v[236:239]
s_waitcnt lgkmcnt(4)
v_add_f32 v123, v123, v69
v_mfma_f32_16x16x32_bf16 a[192:195], v[24:27], v[80:83], a[192:195]
v_exp_f32 v72, v72
v_mfma_f32_16x16x32_bf16 a[196:199], v[24:27], v[84:87], a[196:199]
v_exp_f32 v73, v73
v_mfma_f32_16x16x32_bf16 a[200:203], v[24:27], v[88:91], a[200:203]
v_add_f32 v123, v123, v70
v_add_f32 v123, v123, v71
v_mfma_f32_16x16x32_bf16 a[204:207], v[24:27], v[92:95], a[204:207]
v_exp_f32 v74, v74
v_mfma_f32_16x16x32_bf16 v[240:243], v[24:27], v[96:99], v[240:243]
v_add_f32 v124, v129, v72
v_add_f32 v124, v124, v73
v_mfma_f32_16x16x32_bf16 a[208:211], v[28:31], v[80:83], a[208:211]
v_exp_f32 v75, v75
v_mfma_f32_16x16x32_bf16 a[212:215], v[28:31], v[84:87], a[212:215]
v_exp_f32 v76, v76
v_mfma_f32_16x16x32_bf16 a[216:219], v[28:31], v[88:91], a[216:219]
v_exp_f32 v77, v77
v_mfma_f32_16x16x32_bf16 a[220:223], v[28:31], v[92:95], a[220:223]
v_add_f32 v124, v124, v74
v_add_f32 v124, v124, v75
v_mfma_f32_16x16x32_bf16 v[244:247], v[28:31], v[96:99], v[244:247]
s_waitcnt vmcnt(8) lgkmcnt(0)
s_barrier
v_mfma_f32_16x16x32_bf16 a[224:227], v[32:35], v[80:83], a[224:227]
ds_read_b128 v[8:11], v0 offset:0
ds_read_b128 v[12:15], v0 offset:8192
v_mfma_f32_16x16x32_bf16 a[228:231], v[32:35], v[84:87], a[228:231]
v_exp_f32 v78, v78
v_mfma_f32_16x16x32_bf16 a[232:235], v[32:35], v[88:91], a[232:235]
ds_read_b128 v[16:19], v1 offset:0
v_add_f32 v124, v124, v76
v_mfma_f32_16x16x32_bf16 a[236:239], v[32:35], v[92:95], a[236:239]
ds_read_b128 v[20:23], v1 offset:8192
v_exp_f32 v79, v79
v_mfma_f32_16x16x32_bf16 v[248:251], v[32:35], v[96:99], v[248:251]
v_add_f32 v124, v124, v77
v_add_f32 v124, v124, v78
v_mfma_f32_16x16x32_bf16 a[240:243], v[36:39], v[80:83], a[240:243]
v_add_f32 v124, v124, v79
v_max3_f32 v190, v120, v121, v122
v_mfma_f32_16x16x32_bf16 a[244:247], v[36:39], v[84:87], a[244:247]
v_max3_f32 v190, v190, v123, v124
v_cmp_nge_f32 vcc, s38, v190
v_mfma_f32_16x16x32_bf16 a[248:251], v[36:39], v[88:91], a[248:251]
v_cvt_pk_bf16_f32 v80, v40, v41
v_cvt_pk_bf16_f32 v81, v42, v43
v_mfma_f32_16x16x32_bf16 a[252:255], v[36:39], v[92:95], a[252:255]
v_cvt_pk_bf16_f32 v82, v44, v45
v_cvt_pk_bf16_f32 v83, v46, v47
v_mfma_f32_16x16x32_bf16 v[252:255], v[36:39], v[96:99], v[252:255]
s_cbranch_vccnz L_sp0_r5
L_sp0_r5_ret:
s_sub_u32 s32, s32, 1
s_cmp_lg_u32 s32, 0
s_cbranch_scc1 L_att_r5
s_cmp_lg_u32 s27, 0
s_cbranch_scc1 L_lda
v_mov_b32 v191, 0
s_nop 0
global_load_dword v191, v191, s[78:79] sc1
L_lda:
s_waitcnt lgkmcnt(2)
v_mfma_f32_16x16x32_bf16 v[40:43], v[8:11], v[130:133], v[100:103]
v_cvt_pk_bf16_f32 v84, v48, v49
v_cvt_pk_bf16_f32 v85, v50, v51
v_mfma_f32_16x16x32_bf16 v[44:47], v[12:15], v[130:133], v[100:103]
v_cvt_pk_bf16_f32 v86, v52, v53
v_cvt_pk_bf16_f32 v87, v54, v55
v_mfma_f32_16x16x32_bf16 v[48:51], v[8:11], v[134:137], v[104:107]
v_cvt_pk_bf16_f32 v88, v56, v57
v_cvt_pk_bf16_f32 v89, v58, v59
v_mfma_f32_16x16x32_bf16 v[52:55], v[12:15], v[134:137], v[104:107]
v_cvt_pk_bf16_f32 v90, v60, v61
v_cvt_pk_bf16_f32 v91, v62, v63
v_mfma_f32_16x16x32_bf16 v[56:59], v[8:11], v[138:141], v[108:111]
v_cvt_pk_bf16_f32 v92, v64, v65
v_cvt_pk_bf16_f32 v93, v66, v67
v_mfma_f32_16x16x32_bf16 v[60:63], v[12:15], v[138:141], v[108:111]
v_cvt_pk_bf16_f32 v94, v68, v69
v_cvt_pk_bf16_f32 v95, v70, v71
v_mfma_f32_16x16x32_bf16 v[64:67], v[8:11], v[142:145], v[112:115]
v_cvt_pk_bf16_f32 v96, v72, v73
v_cvt_pk_bf16_f32 v97, v74, v75
v_mfma_f32_16x16x32_bf16 v[68:71], v[12:15], v[142:145], v[112:115]
v_cvt_pk_bf16_f32 v98, v76, v77
v_cvt_pk_bf16_f32 v99, v78, v79
v_mfma_f32_16x16x32_bf16 v[72:75], v[8:11], v[146:149], v[116:119]
v_mfma_f32_16x16x32_bf16 v[76:79], v[12:15], v[146:149], v[116:119]
s_waitcnt lgkmcnt(0)
v_mfma_f32_16x16x32_bf16 v[40:43], v[16:19], v[150:153], v[40:43]
s_mov_b32 m0, s31
ds_read_b128 v[24:27], v6 offset:0
v_mfma_f32_16x16x32_bf16 v[44:47], v[20:23], v[150:153], v[44:47]
ds_read_b128 v[8:11], v0 offset:1024
ds_read_b128 v[28:31], v6 offset:1024
v_mfma_f32_16x16x32_bf16 v[48:51], v[16:19], v[154:157], v[48:51]
ds_read_b128 v[32:35], v6 offset:2048
buffer_load_dwordx4 v7, s[8:11], s24 offen offset:0 nt lds
v_mfma_f32_16x16x32_bf16 v[52:55], v[20:23], v[154:157], v[52:55]
ds_read_b128 v[12:15], v0 offset:9216
ds_read_b128 v[36:39], v6 offset:3072
v_mfma_f32_16x16x32_bf16 v[56:59], v[16:19], v[158:161], v[56:59]
s_add_u32 s34, s34, 16384
v_mfma_f32_16x16x32_bf16 v[60:63], v[20:23], v[158:161], v[60:63]
v_mfma_f32_16x16x32_bf16 v[64:67], v[16:19], v[162:165], v[64:67]
v_mfma_f32_16x16x32_bf16 v[68:71], v[20:23], v[162:165], v[68:71]
v_mfma_f32_16x16x32_bf16 v[72:75], v[16:19], v[166:169], v[72:75]
v_mfma_f32_16x16x32_bf16 v[76:79], v[20:23], v[166:169], v[76:79]
s_waitcnt lgkmcnt(1)
v_mfma_f32_16x16x32_bf16 v[40:43], v[8:11], v[24:27], v[40:43]
v_mfma_f32_16x16x32_bf16 v[44:47], v[12:15], v[24:27], v[44:47]
ds_read_b128 v[24:27], v6 offset:4096
v_mfma_f32_16x16x32_bf16 v[48:51], v[8:11], v[28:31], v[48:51]
ds_read_b128 v[16:19], v1 offset:1024
v_mfma_f32_16x16x32_bf16 v[52:55], v[12:15], v[28:31], v[52:55]
ds_read_b128 v[28:31], v6 offset:5120
v_mfma_f32_16x16x32_bf16 v[56:59], v[8:11], v[32:35], v[56:59]
ds_read_b128 v[20:23], v1 offset:9216
v_mfma_f32_16x16x32_bf16 v[60:63], v[12:15], v[32:35], v[60:63]
s_waitcnt lgkmcnt(4)
ds_read_b128 v[32:35], v6 offset:6144
v_mfma_f32_16x16x32_bf16 v[64:67], v[8:11], v[36:39], v[64:67]
v_mfma_f32_16x16x32_bf16 v[68:71], v[12:15], v[36:39], v[68:71]
s_waitcnt lgkmcnt(4)
ds_read_b128 v[36:39], v6 offset:7168
v_mfma_f32_16x16x32_bf16 v[72:75], v[8:11], v[24:27], v[72:75]
v_mfma_f32_16x16x32_bf16 v[76:79], v[12:15], v[24:27], v[76:79]
s_waitcnt lgkmcnt(2)
ds_read_b128 v[24:27], v6 offset:8192
v_mfma_f32_16x16x32_bf16 v[40:43], v[16:19], v[28:31], v[40:43]
buffer_load_dwordx4 v7, s[8:11], s25 offen offset:1024 nt lds
v_mfma_f32_16x16x32_bf16 v[44:47], v[20:23], v[28:31], v[44:47]
s_waitcnt lgkmcnt(2)
ds_read_b128 v[28:31], v6 offset:9216
v_mfma_f32_16x16x32_bf16 v[48:51], v[16:19], v[32:35], v[48:51]
ds_read_b128 v[8:11], v0 offset:2048
v_mfma_f32_16x16x32_bf16 v[52:55], v[20:23], v[32:35], v[52:55]
s_waitcnt lgkmcnt(3)
ds_read_b128 v[32:35], v6 offset:10240
v_mfma_f32_16x16x32_bf16 v[56:59], v[16:19], v[36:39], v[56:59]
ds_read_b128 v[12:15], v0 offset:10240
v_mfma_f32_16x16x32_bf16 v[60:63], v[20:23], v[36:39], v[60:63]
s_waitcnt lgkmcnt(4)
ds_read_b128 v[36:39], v6 offset:11264
v_mfma_f32_16x16x32_bf16 v[64:67], v[16:19], v[24:27], v[64:67]
v_mfma_f32_16x16x32_bf16 v[68:71], v[20:23], v[24:27], v[68:71]
s_waitcnt lgkmcnt(4)
ds_read_b128 v[24:27], v6 offset:12288
v_mfma_f32_16x16x32_bf16 v[72:75], v[16:19], v[28:31], v[72:75]
v_mfma_f32_16x16x32_bf16 v[76:79], v[20:23], v[28:31], v[76:79]
s_waitcnt lgkmcnt(2)
ds_read_b128 v[28:31], v6 offset:13312
v_mfma_f32_16x16x32_bf16 v[40:43], v[8:11], v[32:35], v[40:43]
v_mfma_f32_16x16x32_bf16 v[44:47], v[12:15], v[32:35], v[44:47]
s_waitcnt lgkmcnt(2)
ds_read_b128 v[32:35], v6 offset:14336
v_mfma_f32_16x16x32_bf16 v[48:51], v[8:11], v[36:39], v[48:51]
ds_read_b128 v[16:19], v1 offset:2048
v_mfma_f32_16x16x32_bf16 v[52:55], v[12:15], v[36:39], v[52:55]
s_waitcnt lgkmcnt(3)
ds_read_b128 v[36:39], v6 offset:15360
v_mfma_f32_16x16x32_bf16 v[56:59], v[8:11], v[24:27], v[56:59]
ds_read_b128 v[20:23], v1 offset:10240
v_mfma_f32_16x16x32_bf16 v[60:63], v[12:15], v[24:27], v[60:63]
s_waitcnt lgkmcnt(4)
ds_read_b128 v[24:27], v6 offset:16384
v_mfma_f32_16x16x32_bf16 v[64:67], v[8:11], v[28:31], v[64:67]
v_mfma_f32_16x16x32_bf16 v[68:71], v[12:15], v[28:31], v[68:71]
s_waitcnt lgkmcnt(4)
ds_read_b128 v[28:31], v6 offset:17408
v_mfma_f32_16x16x32_bf16 v[72:75], v[8:11], v[32:35], v[72:75]
buffer_load_dwordx4 v7, s[8:11], s26 offen offset:2048 nt lds
v_mfma_f32_16x16x32_bf16 v[76:79], v[12:15], v[32:35], v[76:79]
s_waitcnt lgkmcnt(2)
ds_read_b128 v[32:35], v6 offset:18432
v_mfma_f32_16x16x32_bf16 v[40:43], v[16:19], v[36:39], v[40:43]
v_mfma_f32_16x16x32_bf16 v[44:47], v[20:23], v[36:39], v[44:47]
s_waitcnt lgkmcnt(2)
ds_read_b128 v[36:39], v6 offset:19456
v_mfma_f32_16x16x32_bf16 v[48:51], v[16:19], v[24:27], v[48:51]
ds_read_b128 v[8:11], v0 offset:3072
v_mfma_f32_16x16x32_bf16 v[52:55], v[20:23], v[24:27], v[52:55]
s_waitcnt lgkmcnt(3)
ds_read_b128 v[24:27], v6 offset:20480
v_mfma_f32_16x16x32_bf16 v[56:59], v[16:19], v[28:31], v[56:59]
ds_read_b128 v[12:15], v0 offset:11264
v_mfma_f32_16x16x32_bf16 v[60:63], v[20:23], v[28:31], v[60:63]
s_waitcnt lgkmcnt(4)
ds_read_b128 v[28:31], v6 offset:21504
v_mfma_f32_16x16x32_bf16 v[64:67], v[16:19], v[32:35], v[64:67]
v_mfma_f32_16x16x32_bf16 v[68:71], v[20:23], v[32:35], v[68:71]
s_waitcnt lgkmcnt(4)
ds_read_b128 v[32:35], v6 offset:22528
v_mfma_f32_16x16x32_bf16 v[72:75], v[16:19], v[36:39], v[72:75]
v_mfma_f32_16x16x32_bf16 v[76:79], v[20:23], v[36:39], v[76:79]
s_waitcnt lgkmcnt(2)
ds_read_b128 v[36:39], v6 offset:23552
v_mfma_f32_16x16x32_bf16 v[40:43], v[8:11], v[24:27], v[40:43]
v_mfma_f32_16x16x32_bf16 v[44:47], v[12:15], v[24:27], v[44:47]
s_waitcnt lgkmcnt(2)
ds_read_b128 v[24:27], v6 offset:24576
v_mfma_f32_16x16x32_bf16 v[48:51], v[8:11], v[28:31], v[48:51]
ds_read_b128 v[16:19], v1 offset:3072
v_mfma_f32_16x16x32_bf16 v[52:55], v[12:15], v[28:31], v[52:55]
s_waitcnt lgkmcnt(3)
ds_read_b128 v[20:23], v1 offset:11264
v_mfma_f32_16x16x32_bf16 v[56:59], v[8:11], v[32:35], v[56:59]
s_sub_u32 s69, s29, s28
v_add_u32 v0, s69, v0
v_mfma_f32_16x16x32_bf16 v[60:63], v[12:15], v[32:35], v[60:63]
s_waitcnt lgkmcnt(3)
v_add_u32 v1, s69, v1
v_mfma_f32_16x16x32_bf16 v[64:67], v[8:11], v[36:39], v[64:67]
buffer_load_dwordx4 v7, s[8:11], 0 offen offset:3072 nt lds
s_mov_b32 s65, s28
v_mfma_f32_16x16x32_bf16 v[68:71], v[12:15], v[36:39], v[68:71]
s_waitcnt lgkmcnt(2)
s_mov_b32 s28, s29
v_mfma_f32_16x16x32_bf16 v[72:75], v[8:11], v[24:27], v[72:75]
s_add_u32 s8, s8, 16384
s_addc_u32 s9, s9, 0
v_mfma_f32_16x16x32_bf16 v[76:79], v[12:15], v[24:27], v[76:79]
s_waitcnt vmcnt(8) lgkmcnt(0)
s_barrier
v_mfma_f32_16x16x32_bf16 v[40:43], v[16:19], v[170:173], v[40:43]
ds_read_b64_tr_b16 v[24:25], v2 offset:0
s_mov_b32 s29, s35
v_mfma_f32_16x16x32_bf16 v[44:47], v[20:23], v[170:173], v[44:47]
ds_read_b64_tr_b16 v[26:27], v2 offset:8192
s_mov_b32 s35, s65
v_mfma_f32_16x16x32_bf16 v[48:51], v[16:19], v[174:177], v[48:51]
ds_read_b64_tr_b16 v[28:29], v3 offset:0
v_mfma_f32_16x16x32_bf16 v[52:55], v[20:23], v[174:177], v[52:55]
ds_read_b64_tr_b16 v[30:31], v3 offset:8192
v_mfma_f32_16x16x32_bf16 v[56:59], v[16:19], v[178:181], v[56:59]
ds_read_b64_tr_b16 v[32:33], v4 offset:0
v_mfma_f32_16x16x32_bf16 v[60:63], v[20:23], v[178:181], v[60:63]
ds_read_b64_tr_b16 v[34:35], v4 offset:8192
v_mfma_f32_16x16x32_bf16 v[64:67], v[16:19], v[182:185], v[64:67]
ds_read_b64_tr_b16 v[36:37], v5 offset:0
v_mfma_f32_16x16x32_bf16 v[68:71], v[20:23], v[182:185], v[68:71]
ds_read_b64_tr_b16 v[38:39], v5 offset:8192
v_mfma_f32_16x16x32_bf16 v[72:75], v[16:19], v[186:189], v[72:75]
v_mfma_f32_16x16x32_bf16 v[76:79], v[20:23], v[186:189], v[76:79]
s_waitcnt lgkmcnt(4)
v_mfma_f32_16x16x32_bf16 a[0:3], v[24:27], v[80:83], a[0:3]
ds_read_b64_tr_b16 v[16:17], v2 offset:1024
ds_read_b64_tr_b16 v[18:19], v2 offset:9216
v_mfma_f32_16x16x32_bf16 a[4:7], v[24:27], v[84:87], a[4:7]
v_exp_f32 v40, v40
v_mfma_f32_16x16x32_bf16 a[8:11], v[24:27], v[88:91], a[8:11]
ds_read_b64_tr_b16 v[20:21], v3 offset:1024
ds_read_b64_tr_b16 v[22:23], v3 offset:9216
v_mfma_f32_16x16x32_bf16 a[12:15], v[24:27], v[92:95], a[12:15]
v_exp_f32 v41, v41
v_mfma_f32_16x16x32_bf16 v[192:195], v[24:27], v[96:99], v[192:195]
v_exp_f32 v42, v42
v_mfma_f32_16x16x32_bf16 a[16:19], v[28:31], v[80:83], a[16:19]
v_exp_f32 v43, v43
v_mfma_f32_16x16x32_bf16 a[20:23], v[28:31], v[84:87], a[20:23]
v_add_f32 v125, v120, v40
v_add_f32 v125, v125, v41
v_mfma_f32_16x16x32_bf16 a[24:27], v[28:31], v[88:91], a[24:27]
v_exp_f32 v44, v44
v_mfma_f32_16x16x32_bf16 a[28:31], v[28:31], v[92:95], a[28:31]
v_add_f32 v125, v125, v42
v_add_f32 v125, v125, v43
v_mfma_f32_16x16x32_bf16 v[196:199], v[28:31], v[96:99], v[196:199]
s_waitcnt lgkmcnt(4)
v_add_f32 v125, v125, v44
v_mfma_f32_16x16x32_bf16 a[32:35], v[32:35], v[80:83], a[32:35]
ds_read_b64_tr_b16 v[24:25], v4 offset:1024
ds_read_b64_tr_b16 v[26:27], v4 offset:9216
v_mfma_f32_16x16x32_bf16 a[36:39], v[32:35], v[84:87], a[36:39]
v_exp_f32 v45, v45
v_mfma_f32_16x16x32_bf16 a[40:43], v[32:35], v[88:91], a[40:43]
v_exp_f32 v46, v46
v_mfma_f32_16x16x32_bf16 a[44:47], v[32:35], v[92:95], a[44:47]
ds_read_b64_tr_b16 v[28:29], v5 offset:1024
ds_read_b64_tr_b16 v[30:31], v5 offset:9216
v_mfma_f32_16x16x32_bf16 v[200:203], v[32:35], v[96:99], v[200:203]
v_exp_f32 v47, v47
v_mfma_f32_16x16x32_bf16 a[48:51], v[36:39], v[80:83], a[48:51]
v_exp_f32 v48, v48
v_mfma_f32_16x16x32_bf16 a[52:55], v[36:39], v[84:87], a[52:55]
v_add_f32 v125, v125, v45
v_add_f32 v125, v125, v46
v_mfma_f32_16x16x32_bf16 a[56:59], v[36:39], v[88:91], a[56:59]
v_exp_f32 v49, v49
v_mfma_f32_16x16x32_bf16 a[60:63], v[36:39], v[92:95], a[60:63]
v_add_f32 v125, v125, v47
v_add_f32 v126, v121, v48
v_mfma_f32_16x16x32_bf16 v[204:207], v[36:39], v[96:99], v[204:207]
s_waitcnt lgkmcnt(4)
v_add_f32 v126, v126, v49
v_mfma_f32_16x16x32_bf16 a[64:67], v[16:19], v[80:83], a[64:67]
v_exp_f32 v50, v50
v_mfma_f32_16x16x32_bf16 a[68:71], v[16:19], v[84:87], a[68:71]
ds_read_b64_tr_b16 v[32:33], v2 offset:2048
ds_read_b64_tr_b16 v[34:35], v2 offset:10240
v_mfma_f32_16x16x32_bf16 a[72:75], v[16:19], v[88:91], a[72:75]
v_exp_f32 v51, v51
v_mfma_f32_16x16x32_bf16 a[76:79], v[16:19], v[92:95], a[76:79]
ds_read_b64_tr_b16 v[36:37], v3 offset:2048
ds_read_b64_tr_b16 v[38:39], v3 offset:10240
v_mfma_f32_16x16x32_bf16 v[208:211], v[16:19], v[96:99], v[208:211]
v_exp_f32 v52, v52
v_mfma_f32_16x16x32_bf16 a[80:83], v[20:23], v[80:83], a[80:83]
v_exp_f32 v53, v53
v_mfma_f32_16x16x32_bf16 a[84:87], v[20:23], v[84:87], a[84:87]
v_add_f32 v126, v126, v50
v_add_f32 v126, v126, v51
v_mfma_f32_16x16x32_bf16 a[88:91], v[20:23], v[88:91], a[88:91]
v_exp_f32 v54, v54
v_mfma_f32_16x16x32_bf16 a[92:95], v[20:23], v[92:95], a[92:95]
v_add_f32 v126, v126, v52
v_add_f32 v126, v126, v53
v_mfma_f32_16x16x32_bf16 v[212:215], v[20:23], v[96:99], v[212:215]
s_waitcnt lgkmcnt(4)
v_add_f32 v126, v126, v54
v_mfma_f32_16x16x32_bf16 a[96:99], v[24:27], v[80:83], a[96:99]
v_exp_f32 v55, v55
v_mfma_f32_16x16x32_bf16 a[100:103], v[24:27], v[84:87], a[100:103]
v_exp_f32 v56, v56
v_mfma_f32_16x16x32_bf16 a[104:107], v[24:27], v[88:91], a[104:107]
ds_read_b64_tr_b16 v[16:17], v4 offset:2048
ds_read_b64_tr_b16 v[18:19], v4 offset:10240
v_mfma_f32_16x16x32_bf16 a[108:111], v[24:27], v[92:95], a[108:111]
v_exp_f32 v57, v57
v_mfma_f32_16x16x32_bf16 v[216:219], v[24:27], v[96:99], v[216:219]
ds_read_b64_tr_b16 v[20:21], v5 offset:2048
ds_read_b64_tr_b16 v[22:23], v5 offset:10240
v_mfma_f32_16x16x32_bf16 a[112:115], v[28:31], v[80:83], a[112:115]
v_exp_f32 v58, v58
v_add_f32 v126, v126, v55
v_mfma_f32_16x16x32_bf16 a[116:119], v[28:31], v[84:87], a[116:119]
v_add_f32 v127, v122, v56
v_add_f32 v127, v127, v57
v_mfma_f32_16x16x32_bf16 a[120:123], v[28:31], v[88:91], a[120:123]
v_exp_f32 v59, v59
v_mfma_f32_16x16x32_bf16 a[124:127], v[28:31], v[92:95], a[124:127]
v_exp_f32 v60, v60
v_mfma_f32_16x16x32_bf16 v[220:223], v[28:31], v[96:99], v[220:223]
s_waitcnt lgkmcnt(4)
v_add_f32 v127, v127, v58
v_mfma_f32_16x16x32_bf16 a[128:131], v[32:35], v[80:83], a[128:131]
v_exp_f32 v61, v61
v_mfma_f32_16x16x32_bf16 a[132:135], v[32:35], v[84:87], a[132:135]
ds_read_b64_tr_b16 v[24:25], v2 offset:3072
v_add_f32 v127, v127, v59
v_mfma_f32_16x16x32_bf16 a[136:139], v[32:35], v[88:91], a[136:139]
v_exp_f32 v62, v62
v_mfma_f32_16x16x32_bf16 a[140:143], v[32:35], v[92:95], a[140:143]
ds_read_b64_tr_b16 v[26:27], v2 offset:11264
ds_read_b64_tr_b16 v[28:29], v3 offset:3072
v_mfma_f32_16x16x32_bf16 v[224:227], v[32:35], v[96:99], v[224:227]
v_exp_f32 v63, v63
v_add_f32 v127, v127, v60
v_mfma_f32_16x16x32_bf16 a[144:147], v[36:39], v[80:83], a[144:147]
ds_read_b64_tr_b16 v[30:31], v3 offset:11264
v_add_f32 v127, v127, v61
v_mfma_f32_16x16x32_bf16 a[148:151], v[36:39], v[84:87], a[148:151]
v_exp_f32 v64, v64
v_mfma_f32_16x16x32_bf16 a[152:155], v[36:39], v[88:91], a[152:155]
v_add_f32 v127, v127, v62
v_add_f32 v127, v127, v63
v_mfma_f32_16x16x32_bf16 a[156:159], v[36:39], v[92:95], a[156:159]
v_exp_f32 v65, v65
v_mfma_f32_16x16x32_bf16 v[228:231], v[36:39], v[96:99], v[228:231]
s_waitcnt lgkmcnt(4)
v_exp_f32 v66, v66
v_mfma_f32_16x16x32_bf16 a[160:163], v[16:19], v[80:83], a[160:163]
v_exp_f32 v67, v67
v_mfma_f32_16x16x32_bf16 a[164:167], v[16:19], v[84:87], a[164:167]
v_add_f32 v128, v123, v64
ds_read_b64_tr_b16 v[32:33], v4 offset:3072
v_mfma_f32_16x16x32_bf16 a[168:171], v[16:19], v[88:91], a[168:171]
ds_read_b64_tr_b16 v[34:35], v4 offset:11264
v_add_f32 v128, v128, v65
v_mfma_f32_16x16x32_bf16 a[172:175], v[16:19], v[92:95], a[172:175]
v_exp_f32 v68, v68
v_mfma_f32_16x16x32_bf16 v[232:235], v[16:19], v[96:99], v[232:235]
ds_read_b64_tr_b16 v[36:37], v5 offset:3072
v_add_f32 v128, v128, v66
v_mfma_f32_16x16x32_bf16 a[176:179], v[20:23], v[80:83], a[176:179]
ds_read_b64_tr_b16 v[38:39], v5 offset:11264
v_exp_f32 v69, v69
v_mfma_f32_16x16x32_bf16 a[180:183], v[20:23], v[84:87], a[180:183]
v_add_f32 v128, v128, v67
v_add_f32 v128, v128, v68
v_mfma_f32_16x16x32_bf16 a[184:187], v[20:23], v[88:91], a[184:187]
v_exp_f32 v70, v70
v_mfma_f32_16x16x32_bf16 a[188:191], v[20:23], v[92:95], a[188:191]
v_exp_f32 v71, v71
v_mfma_f32_16x16x32_bf16 v[236:239], v[20:23], v[96:99], v[236:239]
s_waitcnt lgkmcnt(4)
v_add_f32 v128, v128, v69
v_mfma_f32_16x16x32_bf16 a[192:195], v[24:27], v[80:83], a[192:195]
v_exp_f32 v72, v72
v_mfma_f32_16x16x32_bf16 a[196:199], v[24:27], v[84:87], a[196:199]
v_exp_f32 v73, v73
v_mfma_f32_16x16x32_bf16 a[200:203], v[24:27], v[88:91], a[200:203]
v_add_f32 v128, v128, v70
v_add_f32 v128, v128, v71
v_mfma_f32_16x16x32_bf16 a[204:207], v[24:27], v[92:95], a[204:207]
v_exp_f32 v74, v74
v_mfma_f32_16x16x32_bf16 v[240:243], v[24:27], v[96:99], v[240:243]
v_add_f32 v129, v124, v72
v_add_f32 v129, v129, v73
v_mfma_f32_16x16x32_bf16 a[208:211], v[28:31], v[80:83], a[208:211]
v_exp_f32 v75, v75
v_mfma_f32_16x16x32_bf16 a[212:215], v[28:31], v[84:87], a[212:215]
v_exp_f32 v76, v76
v_mfma_f32_16x16x32_bf16 a[216:219], v[28:31], v[88:91], a[216:219]
v_exp_f32 v77, v77
v_mfma_f32_16x16x32_bf16 a[220:223], v[28:31], v[92:95], a[220:223]
v_add_f32 v129, v129, v74
v_add_f32 v129, v129, v75
v_mfma_f32_16x16x32_bf16 v[244:247], v[28:31], v[96:99], v[244:247]
s_waitcnt vmcnt(0) lgkmcnt(0)
s_cmp_lg_u32 s27, 0
s_cbranch_scc1 L_cka_ok
s_mov_b32 s58, 0x20000
L_cka_loop:
v_readfirstlane_b32 s59, v191
s_nop 3
s_cmp_ge_u32 s59, 256
s_cbranch_scc1 L_cka_ok
v_mov_b32 v191, 0
s_nop 0
global_load_dword v191, v191, s[78:79] sc1
s_waitcnt vmcnt(0)
s_sub_u32 s58, s58, 1
s_cmp_lg_u32 s58, 0
s_cbranch_scc1 L_cka_loop
L_cka_ok:
s_barrier
v_mfma_f32_16x16x32_bf16 a[224:227], v[32:35], v[80:83], a[224:227]
ds_read_b64_tr_b16 v[8:9], v2 offset:16384
ds_read_b64_tr_b16 v[10:11], v2 offset:24576
v_mfma_f32_16x16x32_bf16 a[228:231], v[32:35], v[84:87], a[228:231]
ds_read_b64_tr_b16 v[12:13], v3 offset:16384
ds_read_b64_tr_b16 v[14:15], v3 offset:24576
v_exp_f32 v78, v78
v_mfma_f32_16x16x32_bf16 a[232:235], v[32:35], v[88:91], a[232:235]
ds_read_b64_tr_b16 v[16:17], v4 offset:16384
ds_read_b64_tr_b16 v[18:19], v4 offset:24576
v_add_f32 v129, v129, v76
v_mfma_f32_16x16x32_bf16 a[236:239], v[32:35], v[92:95], a[236:239]
ds_read_b64_tr_b16 v[20:21], v5 offset:16384
ds_read_b64_tr_b16 v[22:23], v5 offset:24576
v_exp_f32 v79, v79
v_mfma_f32_16x16x32_bf16 v[248:251], v[32:35], v[96:99], v[248:251]
v_add_f32 v129, v129, v77
v_add_f32 v129, v129, v78
v_mfma_f32_16x16x32_bf16 a[240:243], v[36:39], v[80:83], a[240:243]
v_add_f32 v129, v129, v79
v_max3_f32 v190, v125, v126, v127
v_mfma_f32_16x16x32_bf16 a[244:247], v[36:39], v[84:87], a[244:247]
v_max3_f32 v190, v190, v128, v129
v_cmp_nge_f32 vcc, s38, v190
v_mfma_f32_16x16x32_bf16 a[248:251], v[36:39], v[88:91], a[248:251]
v_cvt_pk_bf16_f32 v80, v40, v41
v_cvt_pk_bf16_f32 v81, v42, v43
v_mfma_f32_16x16x32_bf16 a[252:255], v[36:39], v[92:95], a[252:255]
v_cvt_pk_bf16_f32 v82, v44, v45
v_cvt_pk_bf16_f32 v83, v46, v47
v_mfma_f32_16x16x32_bf16 v[252:255], v[36:39], v[96:99], v[252:255]
s_cbranch_vccnz L_sp2_r5
L_sp2_r5_ret:
s_barrier
v_mbcnt_lo_u32_b32 v6, -1, 0
v_mbcnt_hi_u32_b32 v6, -1, v6
v_lshlrev_b32 v6, 4, v6
s_waitcnt lgkmcnt(4)
v_cvt_pk_bf16_f32 v84, v48, v49
v_cvt_pk_bf16_f32 v85, v50, v51
v_cvt_pk_bf16_f32 v86, v52, v53
v_cvt_pk_bf16_f32 v87, v54, v55
v_mfma_f32_16x16x32_bf16 a[0:3], v[8:11], v[80:83], a[0:3]
v_cvt_pk_bf16_f32 v88, v56, v57
v_cvt_pk_bf16_f32 v89, v58, v59
v_cvt_pk_bf16_f32 v90, v60, v61
v_cvt_pk_bf16_f32 v91, v62, v63
v_mfma_f32_16x16x32_bf16 a[4:7], v[8:11], v[84:87], a[4:7]
v_cvt_pk_bf16_f32 v92, v64, v65
v_cvt_pk_bf16_f32 v93, v66, v67
v_cvt_pk_bf16_f32 v94, v68, v69
v_cvt_pk_bf16_f32 v95, v70, v71
v_mfma_f32_16x16x32_bf16 a[8:11], v[8:11], v[88:91], a[8:11]
v_cvt_pk_bf16_f32 v96, v72, v73
v_cvt_pk_bf16_f32 v97, v74, v75
v_cvt_pk_bf16_f32 v98, v76, v77
v_cvt_pk_bf16_f32 v99, v78, v79
ds_read_b64_tr_b16 v[24:25], v2 offset:17408
v_mfma_f32_16x16x32_bf16 a[12:15], v[8:11], v[92:95], a[12:15]
ds_read_b64_tr_b16 v[26:27], v2 offset:25600
ds_read_b64_tr_b16 v[28:29], v3 offset:17408
v_mfma_f32_16x16x32_bf16 v[192:195], v[8:11], v[96:99], v[192:195]
ds_read_b64_tr_b16 v[30:31], v3 offset:25600
s_add_u32 m0, s63, 0
v_mfma_f32_16x16x32_bf16 a[16:19], v[12:15], v[80:83], a[16:19]
s_add_u32 s58, s55, 0
v_mfma_f32_16x16x32_bf16 a[20:23], v[12:15], v[84:87], a[20:23]
buffer_load_dwordx4 v6, s[16:19], s58 offen offset:0 sc1 lds
v_mfma_f32_16x16x32_bf16 a[24:27], v[12:15], v[88:91], a[24:27]
v_mfma_f32_16x16x32_bf16 a[28:31], v[12:15], v[92:95], a[28:31]
buffer_load_dwordx4 v6, s[16:19], s58 offen offset:1024 sc1 lds
v_mfma_f32_16x16x32_bf16 v[196:199], v[12:15], v[96:99], v[196:199]
s_waitcnt lgkmcnt(4)
v_mfma_f32_16x16x32_bf16 a[32:35], v[16:19], v[80:83], a[32:35]
ds_read_b64_tr_b16 v[8:9], v4 offset:17408
ds_read_b64_tr_b16 v[10:11], v4 offset:25600
v_mfma_f32_16x16x32_bf16 a[36:39], v[16:19], v[84:87], a[36:39]
buffer_load_dwordx4 v6, s[16:19], s58 offen offset:2048 sc1 lds
ds_read_b64_tr_b16 v[12:13], v5 offset:17408
v_mfma_f32_16x16x32_bf16 a[40:43], v[16:19], v[88:91], a[40:43]
ds_read_b64_tr_b16 v[14:15], v5 offset:25600
v_mfma_f32_16x16x32_bf16 a[44:47], v[16:19], v[92:95], a[44:47]
buffer_load_dwordx4 v6, s[16:19], s58 offen offset:3072 sc1 lds
v_mfma_f32_16x16x32_bf16 v[200:203], v[16:19], v[96:99], v[200:203]
s_add_u32 m0, s63, 4096
s_add_u32 s58, s55, 4096
v_mfma_f32_16x16x32_bf16 a[48:51], v[20:23], v[80:83], a[48:51]
v_mfma_f32_16x16x32_bf16 a[52:55], v[20:23], v[84:87], a[52:55]
buffer_load_dwordx4 v6, s[16:19], s58 offen offset:0 sc1 lds
v_mfma_f32_16x16x32_bf16 a[56:59], v[20:23], v[88:91], a[56:59]
v_mfma_f32_16x16x32_bf16 a[60:63], v[20:23], v[92:95], a[60:63]
buffer_load_dwordx4 v6, s[16:19], s58 offen offset:1024 sc1 lds
v_mfma_f32_16x16x32_bf16 v[204:207], v[20:23], v[96:99], v[204:207]
s_waitcnt lgkmcnt(4)
v_mfma_f32_16x16x32_bf16 a[64:67], v[24:27], v[80:83], a[64:67]
ds_read_b64_tr_b16 v[16:17], v2 offset:18432
ds_read_b64_tr_b16 v[18:19], v2 offset:26624
v_mfma_f32_16x16x32_bf16 a[68:71], v[24:27], v[84:87], a[68:71]
buffer_load_dwordx4 v6, s[16:19], s58 offen offset:2048 sc1 lds
ds_read_b64_tr_b16 v[20:21], v3 offset:18432
v_mfma_f32_16x16x32_bf16 a[72:75], v[24:27], v[88:91], a[72:75]
s_add_u32 m0, s63, 28672
s_add_u32 s58, s55, 114688
v_mfma_f32_16x16x32_bf16 a[76:79], v[24:27], v[92:95], a[76:79]
ds_read_b64_tr_b16 v[22:23], v3 offset:26624
buffer_load_dwordx4 v6, s[16:19], s58 offen offset:0 sc1 lds
v_mfma_f32_16x16x32_bf16 v[208:211], v[24:27], v[96:99], v[208:211]
v_mfma_f32_16x16x32_bf16 a[80:83], v[28:31], v[80:83], a[80:83]
v_mfma_f32_16x16x32_bf16 a[84:87], v[28:31], v[84:87], a[84:87]
buffer_load_dwordx4 v6, s[16:19], s58 offen offset:1024 sc1 lds
v_mfma_f32_16x16x32_bf16 a[88:91], v[28:31], v[88:91], a[88:91]
v_mfma_f32_16x16x32_bf16 a[92:95], v[28:31], v[92:95], a[92:95]
buffer_load_dwordx4 v6, s[16:19], s58 offen offset:2048 sc1 lds
v_mfma_f32_16x16x32_bf16 v[212:215], v[28:31], v[96:99], v[212:215]
s_waitcnt lgkmcnt(4)
v_mfma_f32_16x16x32_bf16 a[96:99], v[8:11], v[80:83], a[96:99]
ds_read_b64_tr_b16 v[24:25], v4 offset:18432
ds_read_b64_tr_b16 v[26:27], v4 offset:26624
v_mfma_f32_16x16x32_bf16 a[100:103], v[8:11], v[84:87], a[100:103]
buffer_load_dwordx4 v6, s[16:19], s58 offen offset:3072 sc1 lds
ds_read_b64_tr_b16 v[28:29], v5 offset:18432
v_mfma_f32_16x16x32_bf16 a[104:107], v[8:11], v[88:91], a[104:107]
s_add_u32 m0, s63, 32768
s_add_u32 s58, s55, 118784
v_mfma_f32_16x16x32_bf16 a[108:111], v[8:11], v[92:95], a[108:111]
ds_read_b64_tr_b16 v[30:31], v5 offset:26624
buffer_load_dwordx4 v6, s[16:19], s58 offen offset:0 sc1 lds
v_mfma_f32_16x16x32_bf16 v[216:219], v[8:11], v[96:99], v[216:219]
v_mfma_f32_16x16x32_bf16 a[112:115], v[12:15], v[80:83], a[112:115]
v_mfma_f32_16x16x32_bf16 a[116:119], v[12:15], v[84:87], a[116:119]
buffer_load_dwordx4 v6, s[16:19], s58 offen offset:1024 sc1 lds
v_mfma_f32_16x16x32_bf16 a[120:123], v[12:15], v[88:91], a[120:123]
v_mfma_f32_16x16x32_bf16 a[124:127], v[12:15], v[92:95], a[124:127]
buffer_load_dwordx4 v6, s[16:19], s58 offen offset:2048 sc1 lds
v_mfma_f32_16x16x32_bf16 v[220:223], v[12:15], v[96:99], v[220:223]
s_waitcnt lgkmcnt(4)
s_add_u32 m0, s63, 57344
v_mfma_f32_16x16x32_bf16 a[128:131], v[16:19], v[80:83], a[128:131]
ds_read_b64_tr_b16 v[8:9], v2 offset:19456
s_add_u32 s58, s56, 0
v_mfma_f32_16x16x32_bf16 a[132:135], v[16:19], v[84:87], a[132:135]
ds_read_b64_tr_b16 v[10:11], v2 offset:27648
buffer_load_dwordx4 v6, s[16:19], s58 offen offset:0 sc1 lds
v_mfma_f32_16x16x32_bf16 a[136:139], v[16:19], v[88:91], a[136:139]
ds_read_b64_tr_b16 v[12:13], v3 offset:19456
ds_read_b64_tr_b16 v[14:15], v3 offset:27648
v_mfma_f32_16x16x32_bf16 a[140:143], v[16:19], v[92:95], a[140:143]
v_mfma_f32_16x16x32_bf16 v[224:227], v[16:19], v[96:99], v[224:227]
buffer_load_dwordx4 v6, s[16:19], s58 offen offset:1024 sc1 lds
v_mfma_f32_16x16x32_bf16 a[144:147], v[20:23], v[80:83], a[144:147]
v_mfma_f32_16x16x32_bf16 a[148:151], v[20:23], v[84:87], a[148:151]
buffer_load_dwordx4 v6, s[16:19], s58 offen offset:2048 sc1 lds
v_mfma_f32_16x16x32_bf16 a[152:155], v[20:23], v[88:91], a[152:155]
v_mfma_f32_16x16x32_bf16 a[156:159], v[20:23], v[92:95], a[156:159]
v_mfma_f32_16x16x32_bf16 v[228:231], v[20:23], v[96:99], v[228:231]
s_waitcnt lgkmcnt(4)
buffer_load_dwordx4 v6, s[16:19], s58 offen offset:3072 sc1 lds
v_mfma_f32_16x16x32_bf16 a[160:163], v[24:27], v[80:83], a[160:163]
ds_read_b64_tr_b16 v[16:17], v4 offset:19456
s_add_u32 m0, s63, 61440
v_mfma_f32_16x16x32_bf16 a[164:167], v[24:27], v[84:87], a[164:167]
s_add_u32 s58, s56, 4096
ds_read_b64_tr_b16 v[18:19], v4 offset:27648
v_mfma_f32_16x16x32_bf16 a[168:171], v[24:27], v[88:91], a[168:171]
buffer_load_dwordx4 v6, s[16:19], s58 offen offset:0 sc1 lds
ds_read_b64_tr_b16 v[20:21], v5 offset:19456
v_mfma_f32_16x16x32_bf16 a[172:175], v[24:27], v[92:95], a[172:175]
ds_read_b64_tr_b16 v[22:23], v5 offset:27648
v_mfma_f32_16x16x32_bf16 v[232:235], v[24:27], v[96:99], v[232:235]
buffer_load_dwordx4 v6, s[16:19], s58 offen offset:1024 sc1 lds
v_mfma_f32_16x16x32_bf16 a[176:179], v[28:31], v[80:83], a[176:179]
v_mfma_f32_16x16x32_bf16 a[180:183], v[28:31], v[84:87], a[180:183]
buffer_load_dwordx4 v6, s[16:19], s58 offen offset:2048 sc1 lds
v_mfma_f32_16x16x32_bf16 a[184:187], v[28:31], v[88:91], a[184:187]
s_add_u32 m0, s63, 86016
s_add_u32 s58, s56, 114688
v_mfma_f32_16x16x32_bf16 a[188:191], v[28:31], v[92:95], a[188:191]
v_mfma_f32_16x16x32_bf16 v[236:239], v[28:31], v[96:99], v[236:239]
s_waitcnt lgkmcnt(4)
buffer_load_dwordx4 v6, s[16:19], s58 offen offset:0 sc1 lds
v_mfma_f32_16x16x32_bf16 a[192:195], v[8:11], v[80:83], a[192:195]
v_mfma_f32_16x16x32_bf16 a[196:199], v[8:11], v[84:87], a[196:199]
buffer_load_dwordx4 v6, s[16:19], s58 offen offset:1024 sc1 lds
v_mfma_f32_16x16x32_bf16 a[200:203], v[8:11], v[88:91], a[200:203]
v_mfma_f32_16x16x32_bf16 a[204:207], v[8:11], v[92:95], a[204:207]
v_mfma_f32_16x16x32_bf16 v[240:243], v[8:11], v[96:99], v[240:243]
buffer_load_dwordx4 v6, s[16:19], s58 offen offset:2048 sc1 lds
v_mfma_f32_16x16x32_bf16 a[208:211], v[12:15], v[80:83], a[208:211]
v_mfma_f32_16x16x32_bf16 a[212:215], v[12:15], v[84:87], a[212:215]
buffer_load_dwordx4 v6, s[16:19], s58 offen offset:3072 sc1 lds
v_mfma_f32_16x16x32_bf16 a[216:219], v[12:15], v[88:91], a[216:219]
s_add_u32 m0, s63, 90112
s_add_u32 s58, s56, 118784
v_mfma_f32_16x16x32_bf16 a[220:223], v[12:15], v[92:95], a[220:223]
v_mfma_f32_16x16x32_bf16 v[244:247], v[12:15], v[96:99], v[244:247]
s_waitcnt lgkmcnt(0)
buffer_load_dwordx4 v6, s[16:19], s58 offen offset:0 sc1 lds
v_mfma_f32_16x16x32_bf16 a[224:227], v[16:19], v[80:83], a[224:227]
v_mfma_f32_16x16x32_bf16 a[228:231], v[16:19], v[84:87], a[228:231]
buffer_load_dwordx4 v6, s[16:19], s58 offen offset:1024 sc1 lds
v_mfma_f32_16x16x32_bf16 a[232:235], v[16:19], v[88:91], a[232:235]
v_mfma_f32_16x16x32_bf16 a[236:239], v[16:19], v[92:95], a[236:239]
v_mfma_f32_16x16x32_bf16 v[248:251], v[16:19], v[96:99], v[248:251]
buffer_load_dwordx4 v6, s[16:19], s58 offen offset:2048 sc1 lds
v_mfma_f32_16x16x32_bf16 a[240:243], v[20:23], v[80:83], a[240:243]
v_mfma_f32_16x16x32_bf16 a[244:247], v[20:23], v[84:87], a[244:247]
v_mfma_f32_16x16x32_bf16 a[248:251], v[20:23], v[88:91], a[248:251]
v_mfma_f32_16x16x32_bf16 a[252:255], v[20:23], v[92:95], a[252:255]
v_mfma_f32_16x16x32_bf16 v[252:255], v[20:23], v[96:99], v[252:255]
s_nop 7
v_lshrrev_b32 v190, 4, v6
v_xor_b32 v191, 32, v190
v_xor_b32 v190, 16, v190
v_lshlrev_b32 v191, 2, v191
v_lshlrev_b32 v190, 2, v190
ds_bpermute_b32 v168, v190, v125
ds_bpermute_b32 v169, v190, v126
ds_bpermute_b32 v170, v190, v127
ds_bpermute_b32 v171, v190, v128
ds_bpermute_b32 v172, v190, v129
s_waitcnt lgkmcnt(0)
v_add_f32 v125, v125, v168
v_add_f32 v126, v126, v169
v_add_f32 v127, v127, v170
v_add_f32 v128, v128, v171
v_add_f32 v129, v129, v172
ds_bpermute_b32 v168, v191, v125
ds_bpermute_b32 v169, v191, v126
ds_bpermute_b32 v170, v191, v127
ds_bpermute_b32 v171, v191, v128
ds_bpermute_b32 v172, v191, v129
s_waitcnt lgkmcnt(0)
v_add_f32 v125, v125, v168
v_add_f32 v126, v126, v169
v_add_f32 v127, v127, v170
v_add_f32 v128, v128, v171
v_add_f32 v129, v129, v172
v_rcp_f32 v125, v125
v_rcp_f32 v126, v126
v_rcp_f32 v127, v127
v_rcp_f32 v128, v128
v_rcp_f32 v129, v129
v_mov_b32 v176, v125
v_mov_b32 v177, v125
v_mov_b32 v178, v126
v_mov_b32 v179, v126
v_mov_b32 v180, v127
v_mov_b32 v181, v127
v_mov_b32 v182, v128
v_mov_b32 v183, v128
v_mov_b32 v184, v129
v_mov_b32 v185, v129
s_mul_i32 s65, s27, 40960
v_add_u32 v190, s65, v6
v_mov_b32 v0, v6
v_add_u32 v1, 8192, v6
v_add_u32 v2, 16384, v6
v_add_u32 v3, 24576, v6
v_add_u32 v4, 32768, v6
v_add_u32 v5, 32768, v6
v_add_u32 v7, 90112, v6
v_accvgpr_read_b32 v168, a0
v_accvgpr_read_b32 v169, a1
v_accvgpr_read_b32 v170, a2
v_accvgpr_read_b32 v171, a3
v_accvgpr_read_b32 v172, a16
v_accvgpr_read_b32 v173, a17
v_accvgpr_read_b32 v174, a18
v_accvgpr_read_b32 v175, a19
v_pk_mul_f32 v[168:169], v[168:169], v[176:177]
v_pk_mul_f32 v[170:171], v[170:171], v[176:177]
v_pk_mul_f32 v[172:173], v[172:173], v[176:177]
v_pk_mul_f32 v[174:175], v[174:175], v[176:177]
v_cvt_pk_bf16_f32 v8, v168, v169
v_cvt_pk_bf16_f32 v9, v170, v171
v_cvt_pk_bf16_f32 v10, v172, v173
v_cvt_pk_bf16_f32 v11, v174, v175
s_mov_b32 s66, 0
buffer_store_dwordx4 v[8:11], v190, s[20:23], s66 offen offset:0 sc0 sc1
v_accvgpr_read_b32 v168, a4
v_accvgpr_read_b32 v169, a5
v_accvgpr_read_b32 v170, a6
v_accvgpr_read_b32 v171, a7
v_accvgpr_read_b32 v172, a20
v_accvgpr_read_b32 v173, a21
v_accvgpr_read_b32 v174, a22
v_accvgpr_read_b32 v175, a23
v_pk_mul_f32 v[168:169], v[168:169], v[178:179]
v_pk_mul_f32 v[170:171], v[170:171], v[178:179]
v_pk_mul_f32 v[172:173], v[172:173], v[178:179]
v_pk_mul_f32 v[174:175], v[174:175], v[178:179]
v_cvt_pk_bf16_f32 v12, v168, v169
v_cvt_pk_bf16_f32 v13, v170, v171
v_cvt_pk_bf16_f32 v14, v172, v173
v_cvt_pk_bf16_f32 v15, v174, v175
s_mov_b32 s66, 8192
buffer_store_dwordx4 v[12:15], v190, s[20:23], s66 offen offset:0 sc0 sc1
v_accvgpr_read_b32 v168, a8
v_accvgpr_read_b32 v169, a9
v_accvgpr_read_b32 v170, a10
v_accvgpr_read_b32 v171, a11
v_accvgpr_read_b32 v172, a24
v_accvgpr_read_b32 v173, a25
v_accvgpr_read_b32 v174, a26
v_accvgpr_read_b32 v175, a27
v_pk_mul_f32 v[168:169], v[168:169], v[180:181]
v_pk_mul_f32 v[170:171], v[170:171], v[180:181]
v_pk_mul_f32 v[172:173], v[172:173], v[180:181]
v_pk_mul_f32 v[174:175], v[174:175], v[180:181]
v_cvt_pk_bf16_f32 v16, v168, v169
v_cvt_pk_bf16_f32 v17, v170, v171
v_cvt_pk_bf16_f32 v18, v172, v173
v_cvt_pk_bf16_f32 v19, v174, v175
s_mov_b32 s66, 16384
buffer_store_dwordx4 v[16:19], v190, s[20:23], s66 offen offset:0 sc0 sc1
v_accvgpr_read_b32 v168, a12
v_accvgpr_read_b32 v169, a13
v_accvgpr_read_b32 v170, a14
v_accvgpr_read_b32 v171, a15
v_accvgpr_read_b32 v172, a28
v_accvgpr_read_b32 v173, a29
v_accvgpr_read_b32 v174, a30
v_accvgpr_read_b32 v175, a31
v_pk_mul_f32 v[168:169], v[168:169], v[182:183]
v_pk_mul_f32 v[170:171], v[170:171], v[182:183]
v_pk_mul_f32 v[172:173], v[172:173], v[182:183]
v_pk_mul_f32 v[174:175], v[174:175], v[182:183]
v_cvt_pk_bf16_f32 v20, v168, v169
v_cvt_pk_bf16_f32 v21, v170, v171
v_cvt_pk_bf16_f32 v22, v172, v173
v_cvt_pk_bf16_f32 v23, v174, v175
s_mov_b32 s66, 24576
buffer_store_dwordx4 v[20:23], v190, s[20:23], s66 offen offset:0 sc0 sc1
v_pk_mul_f32 v[168:169], v[192:193], v[184:185]
v_pk_mul_f32 v[170:171], v[194:195], v[184:185]
v_pk_mul_f32 v[172:173], v[196:197], v[184:185]
v_pk_mul_f32 v[174:175], v[198:199], v[184:185]
v_cvt_pk_bf16_f32 v24, v168, v169
v_cvt_pk_bf16_f32 v25, v170, v171
v_cvt_pk_bf16_f32 v26, v172, v173
v_cvt_pk_bf16_f32 v27, v174, v175
s_mov_b32 s66, 32768
buffer_store_dwordx4 v[24:27], v190, s[20:23], s66 offen offset:0 sc0 sc1
v_accvgpr_read_b32 v168, a32
v_accvgpr_read_b32 v169, a33
v_accvgpr_read_b32 v170, a34
v_accvgpr_read_b32 v171, a35
v_accvgpr_read_b32 v172, a48
v_accvgpr_read_b32 v173, a49
v_accvgpr_read_b32 v174, a50
v_accvgpr_read_b32 v175, a51
v_pk_mul_f32 v[168:169], v[168:169], v[176:177]
v_pk_mul_f32 v[170:171], v[170:171], v[176:177]
v_pk_mul_f32 v[172:173], v[172:173], v[176:177]
v_pk_mul_f32 v[174:175], v[174:175], v[176:177]
v_cvt_pk_bf16_f32 v28, v168, v169
v_cvt_pk_bf16_f32 v29, v170, v171
v_cvt_pk_bf16_f32 v30, v172, v173
v_cvt_pk_bf16_f32 v31, v174, v175
s_mov_b32 s66, 0
buffer_store_dwordx4 v[28:31], v190, s[20:23], s66 offen offset:1024 sc0 sc1
v_accvgpr_read_b32 v168, a36
v_accvgpr_read_b32 v169, a37
v_accvgpr_read_b32 v170, a38
v_accvgpr_read_b32 v171, a39
v_accvgpr_read_b32 v172, a52
v_accvgpr_read_b32 v173, a53
v_accvgpr_read_b32 v174, a54
v_accvgpr_read_b32 v175, a55
v_pk_mul_f32 v[168:169], v[168:169], v[178:179]
v_pk_mul_f32 v[170:171], v[170:171], v[178:179]
v_pk_mul_f32 v[172:173], v[172:173], v[178:179]
v_pk_mul_f32 v[174:175], v[174:175], v[178:179]
v_cvt_pk_bf16_f32 v32, v168, v169
v_cvt_pk_bf16_f32 v33, v170, v171
v_cvt_pk_bf16_f32 v34, v172, v173
v_cvt_pk_bf16_f32 v35, v174, v175
s_mov_b32 s66, 8192
buffer_store_dwordx4 v[32:35], v190, s[20:23], s66 offen offset:1024 sc0 sc1
v_accvgpr_read_b32 v168, a40
v_accvgpr_read_b32 v169, a41
v_accvgpr_read_b32 v170, a42
v_accvgpr_read_b32 v171, a43
v_accvgpr_read_b32 v172, a56
v_accvgpr_read_b32 v173, a57
v_accvgpr_read_b32 v174, a58
v_accvgpr_read_b32 v175, a59
v_pk_mul_f32 v[168:169], v[168:169], v[180:181]
v_pk_mul_f32 v[170:171], v[170:171], v[180:181]
v_pk_mul_f32 v[172:173], v[172:173], v[180:181]
v_pk_mul_f32 v[174:175], v[174:175], v[180:181]
v_cvt_pk_bf16_f32 v36, v168, v169
v_cvt_pk_bf16_f32 v37, v170, v171
v_cvt_pk_bf16_f32 v38, v172, v173
v_cvt_pk_bf16_f32 v39, v174, v175
s_mov_b32 s66, 16384
buffer_store_dwordx4 v[36:39], v190, s[20:23], s66 offen offset:1024 sc0 sc1
v_accvgpr_read_b32 v168, a44
v_accvgpr_read_b32 v169, a45
v_accvgpr_read_b32 v170, a46
v_accvgpr_read_b32 v171, a47
v_accvgpr_read_b32 v172, a60
v_accvgpr_read_b32 v173, a61
v_accvgpr_read_b32 v174, a62
v_accvgpr_read_b32 v175, a63
v_pk_mul_f32 v[168:169], v[168:169], v[182:183]
v_pk_mul_f32 v[170:171], v[170:171], v[182:183]
v_pk_mul_f32 v[172:173], v[172:173], v[182:183]
v_pk_mul_f32 v[174:175], v[174:175], v[182:183]
v_cvt_pk_bf16_f32 v40, v168, v169
v_cvt_pk_bf16_f32 v41, v170, v171
v_cvt_pk_bf16_f32 v42, v172, v173
v_cvt_pk_bf16_f32 v43, v174, v175
s_mov_b32 s66, 24576
buffer_store_dwordx4 v[40:43], v190, s[20:23], s66 offen offset:1024 sc0 sc1
v_pk_mul_f32 v[168:169], v[200:201], v[184:185]
v_pk_mul_f32 v[170:171], v[202:203], v[184:185]
v_pk_mul_f32 v[172:173], v[204:205], v[184:185]
v_pk_mul_f32 v[174:175], v[206:207], v[184:185]
v_cvt_pk_bf16_f32 v44, v168, v169
v_cvt_pk_bf16_f32 v45, v170, v171
v_cvt_pk_bf16_f32 v46, v172, v173
v_cvt_pk_bf16_f32 v47, v174, v175
s_mov_b32 s66, 32768
buffer_store_dwordx4 v[44:47], v190, s[20:23], s66 offen offset:1024 sc0 sc1
v_accvgpr_read_b32 v168, a64
v_accvgpr_read_b32 v169, a65
v_accvgpr_read_b32 v170, a66
v_accvgpr_read_b32 v171, a67
v_accvgpr_read_b32 v172, a80
v_accvgpr_read_b32 v173, a81
v_accvgpr_read_b32 v174, a82
v_accvgpr_read_b32 v175, a83
v_pk_mul_f32 v[168:169], v[168:169], v[176:177]
v_pk_mul_f32 v[170:171], v[170:171], v[176:177]
v_pk_mul_f32 v[172:173], v[172:173], v[176:177]
v_pk_mul_f32 v[174:175], v[174:175], v[176:177]
v_cvt_pk_bf16_f32 v48, v168, v169
v_cvt_pk_bf16_f32 v49, v170, v171
v_cvt_pk_bf16_f32 v50, v172, v173
v_cvt_pk_bf16_f32 v51, v174, v175
s_mov_b32 s66, 0
buffer_store_dwordx4 v[48:51], v190, s[20:23], s66 offen offset:2048 sc0 sc1
v_accvgpr_read_b32 v168, a68
v_accvgpr_read_b32 v169, a69
v_accvgpr_read_b32 v170, a70
v_accvgpr_read_b32 v171, a71
v_accvgpr_read_b32 v172, a84
v_accvgpr_read_b32 v173, a85
v_accvgpr_read_b32 v174, a86
v_accvgpr_read_b32 v175, a87
v_pk_mul_f32 v[168:169], v[168:169], v[178:179]
v_pk_mul_f32 v[170:171], v[170:171], v[178:179]
v_pk_mul_f32 v[172:173], v[172:173], v[178:179]
v_pk_mul_f32 v[174:175], v[174:175], v[178:179]
v_cvt_pk_bf16_f32 v52, v168, v169
v_cvt_pk_bf16_f32 v53, v170, v171
v_cvt_pk_bf16_f32 v54, v172, v173
v_cvt_pk_bf16_f32 v55, v174, v175
s_mov_b32 s66, 8192
buffer_store_dwordx4 v[52:55], v190, s[20:23], s66 offen offset:2048 sc0 sc1
v_accvgpr_read_b32 v168, a72
v_accvgpr_read_b32 v169, a73
v_accvgpr_read_b32 v170, a74
v_accvgpr_read_b32 v171, a75
v_accvgpr_read_b32 v172, a88
v_accvgpr_read_b32 v173, a89
v_accvgpr_read_b32 v174, a90
v_accvgpr_read_b32 v175, a91
v_pk_mul_f32 v[168:169], v[168:169], v[180:181]
v_pk_mul_f32 v[170:171], v[170:171], v[180:181]
v_pk_mul_f32 v[172:173], v[172:173], v[180:181]
v_pk_mul_f32 v[174:175], v[174:175], v[180:181]
v_cvt_pk_bf16_f32 v56, v168, v169
v_cvt_pk_bf16_f32 v57, v170, v171
v_cvt_pk_bf16_f32 v58, v172, v173
v_cvt_pk_bf16_f32 v59, v174, v175
s_mov_b32 s66, 16384
buffer_store_dwordx4 v[56:59], v190, s[20:23], s66 offen offset:2048 sc0 sc1
v_accvgpr_read_b32 v168, a76
v_accvgpr_read_b32 v169, a77
v_accvgpr_read_b32 v170, a78
v_accvgpr_read_b32 v171, a79
v_accvgpr_read_b32 v172, a92
v_accvgpr_read_b32 v173, a93
v_accvgpr_read_b32 v174, a94
v_accvgpr_read_b32 v175, a95
v_pk_mul_f32 v[168:169], v[168:169], v[182:183]
v_pk_mul_f32 v[170:171], v[170:171], v[182:183]
v_pk_mul_f32 v[172:173], v[172:173], v[182:183]
v_pk_mul_f32 v[174:175], v[174:175], v[182:183]
v_cvt_pk_bf16_f32 v60, v168, v169
v_cvt_pk_bf16_f32 v61, v170, v171
v_cvt_pk_bf16_f32 v62, v172, v173
v_cvt_pk_bf16_f32 v63, v174, v175
s_mov_b32 s66, 24576
buffer_store_dwordx4 v[60:63], v190, s[20:23], s66 offen offset:2048 sc0 sc1
v_pk_mul_f32 v[168:169], v[208:209], v[184:185]
v_pk_mul_f32 v[170:171], v[210:211], v[184:185]
v_pk_mul_f32 v[172:173], v[212:213], v[184:185]
v_pk_mul_f32 v[174:175], v[214:215], v[184:185]
v_cvt_pk_bf16_f32 v64, v168, v169
v_cvt_pk_bf16_f32 v65, v170, v171
v_cvt_pk_bf16_f32 v66, v172, v173
v_cvt_pk_bf16_f32 v67, v174, v175
s_mov_b32 s66, 32768
buffer_store_dwordx4 v[64:67], v190, s[20:23], s66 offen offset:2048 sc0 sc1
v_accvgpr_read_b32 v168, a96
v_accvgpr_read_b32 v169, a97
v_accvgpr_read_b32 v170, a98
v_accvgpr_read_b32 v171, a99
v_accvgpr_read_b32 v172, a112
v_accvgpr_read_b32 v173, a113
v_accvgpr_read_b32 v174, a114
v_accvgpr_read_b32 v175, a115
v_pk_mul_f32 v[168:169], v[168:169], v[176:177]
v_pk_mul_f32 v[170:171], v[170:171], v[176:177]
v_pk_mul_f32 v[172:173], v[172:173], v[176:177]
v_pk_mul_f32 v[174:175], v[174:175], v[176:177]
v_cvt_pk_bf16_f32 v68, v168, v169
v_cvt_pk_bf16_f32 v69, v170, v171
v_cvt_pk_bf16_f32 v70, v172, v173
v_cvt_pk_bf16_f32 v71, v174, v175
s_mov_b32 s66, 0
buffer_store_dwordx4 v[68:71], v190, s[20:23], s66 offen offset:3072 sc0 sc1
s_waitcnt vmcnt(16)
v_accvgpr_read_b32 v168, a100
v_accvgpr_read_b32 v169, a101
v_accvgpr_read_b32 v170, a102
v_accvgpr_read_b32 v171, a103
v_accvgpr_read_b32 v172, a116
v_accvgpr_read_b32 v173, a117
v_accvgpr_read_b32 v174, a118
v_accvgpr_read_b32 v175, a119
v_pk_mul_f32 v[168:169], v[168:169], v[178:179]
v_pk_mul_f32 v[170:171], v[170:171], v[178:179]
v_pk_mul_f32 v[172:173], v[172:173], v[178:179]
v_pk_mul_f32 v[174:175], v[174:175], v[178:179]
v_cvt_pk_bf16_f32 v72, v168, v169
v_cvt_pk_bf16_f32 v73, v170, v171
v_cvt_pk_bf16_f32 v74, v172, v173
v_cvt_pk_bf16_f32 v75, v174, v175
s_mov_b32 s66, 8192
buffer_store_dwordx4 v[72:75], v190, s[20:23], s66 offen offset:3072 sc0 sc1
v_accvgpr_read_b32 v168, a104
v_accvgpr_read_b32 v169, a105
v_accvgpr_read_b32 v170, a106
v_accvgpr_read_b32 v171, a107
v_accvgpr_read_b32 v172, a120
v_accvgpr_read_b32 v173, a121
v_accvgpr_read_b32 v174, a122
v_accvgpr_read_b32 v175, a123
v_pk_mul_f32 v[168:169], v[168:169], v[180:181]
v_pk_mul_f32 v[170:171], v[170:171], v[180:181]
v_pk_mul_f32 v[172:173], v[172:173], v[180:181]
v_pk_mul_f32 v[174:175], v[174:175], v[180:181]
v_cvt_pk_bf16_f32 v76, v168, v169
v_cvt_pk_bf16_f32 v77, v170, v171
v_cvt_pk_bf16_f32 v78, v172, v173
v_cvt_pk_bf16_f32 v79, v174, v175
s_mov_b32 s66, 16384
buffer_store_dwordx4 v[76:79], v190, s[20:23], s66 offen offset:3072 sc0 sc1
v_accvgpr_read_b32 v168, a108
v_accvgpr_read_b32 v169, a109
v_accvgpr_read_b32 v170, a110
v_accvgpr_read_b32 v171, a111
v_accvgpr_read_b32 v172, a124
v_accvgpr_read_b32 v173, a125
v_accvgpr_read_b32 v174, a126
v_accvgpr_read_b32 v175, a127
v_pk_mul_f32 v[168:169], v[168:169], v[182:183]
v_pk_mul_f32 v[170:171], v[170:171], v[182:183]
v_pk_mul_f32 v[172:173], v[172:173], v[182:183]
v_pk_mul_f32 v[174:175], v[174:175], v[182:183]
v_cvt_pk_bf16_f32 v80, v168, v169
v_cvt_pk_bf16_f32 v81, v170, v171
v_cvt_pk_bf16_f32 v82, v172, v173
v_cvt_pk_bf16_f32 v83, v174, v175
s_mov_b32 s66, 24576
buffer_store_dwordx4 v[80:83], v190, s[20:23], s66 offen offset:3072 sc0 sc1
v_pk_mul_f32 v[168:169], v[216:217], v[184:185]
v_pk_mul_f32 v[170:171], v[218:219], v[184:185]
v_pk_mul_f32 v[172:173], v[220:221], v[184:185]
v_pk_mul_f32 v[174:175], v[222:223], v[184:185]
v_cvt_pk_bf16_f32 v84, v168, v169
v_cvt_pk_bf16_f32 v85, v170, v171
v_cvt_pk_bf16_f32 v86, v172, v173
v_cvt_pk_bf16_f32 v87, v174, v175
s_mov_b32 s66, 32768
buffer_store_dwordx4 v[84:87], v190, s[20:23], s66 offen offset:3072 sc0 sc1
v_accvgpr_read_b32 v168, a128
v_accvgpr_read_b32 v169, a129
v_accvgpr_read_b32 v170, a130
v_accvgpr_read_b32 v171, a131
v_accvgpr_read_b32 v172, a144
v_accvgpr_read_b32 v173, a145
v_accvgpr_read_b32 v174, a146
v_accvgpr_read_b32 v175, a147
v_pk_mul_f32 v[168:169], v[168:169], v[176:177]
v_pk_mul_f32 v[170:171], v[170:171], v[176:177]
v_pk_mul_f32 v[172:173], v[172:173], v[176:177]
v_pk_mul_f32 v[174:175], v[174:175], v[176:177]
v_cvt_pk_bf16_f32 v88, v168, v169
v_cvt_pk_bf16_f32 v89, v170, v171
v_cvt_pk_bf16_f32 v90, v172, v173
v_cvt_pk_bf16_f32 v91, v174, v175
s_mov_b32 s66, 4096
buffer_store_dwordx4 v[88:91], v190, s[20:23], s66 offen offset:0 sc0 sc1
v_accvgpr_read_b32 v168, a132
v_accvgpr_read_b32 v169, a133
v_accvgpr_read_b32 v170, a134
v_accvgpr_read_b32 v171, a135
v_accvgpr_read_b32 v172, a148
v_accvgpr_read_b32 v173, a149
v_accvgpr_read_b32 v174, a150
v_accvgpr_read_b32 v175, a151
v_pk_mul_f32 v[168:169], v[168:169], v[178:179]
v_pk_mul_f32 v[170:171], v[170:171], v[178:179]
v_pk_mul_f32 v[172:173], v[172:173], v[178:179]
v_pk_mul_f32 v[174:175], v[174:175], v[178:179]
v_cvt_pk_bf16_f32 v92, v168, v169
v_cvt_pk_bf16_f32 v93, v170, v171
v_cvt_pk_bf16_f32 v94, v172, v173
v_cvt_pk_bf16_f32 v95, v174, v175
s_mov_b32 s66, 12288
buffer_store_dwordx4 v[92:95], v190, s[20:23], s66 offen offset:0 sc0 sc1
v_accvgpr_read_b32 v168, a136
v_accvgpr_read_b32 v169, a137
v_accvgpr_read_b32 v170, a138
v_accvgpr_read_b32 v171, a139
v_accvgpr_read_b32 v172, a152
v_accvgpr_read_b32 v173, a153
v_accvgpr_read_b32 v174, a154
v_accvgpr_read_b32 v175, a155
v_pk_mul_f32 v[168:169], v[168:169], v[180:181]
v_pk_mul_f32 v[170:171], v[170:171], v[180:181]
v_pk_mul_f32 v[172:173], v[172:173], v[180:181]
v_pk_mul_f32 v[174:175], v[174:175], v[180:181]
v_cvt_pk_bf16_f32 v96, v168, v169
v_cvt_pk_bf16_f32 v97, v170, v171
v_cvt_pk_bf16_f32 v98, v172, v173
v_cvt_pk_bf16_f32 v99, v174, v175
s_mov_b32 s66, 20480
buffer_store_dwordx4 v[96:99], v190, s[20:23], s66 offen offset:0 sc0 sc1
v_accvgpr_read_b32 v168, a140
v_accvgpr_read_b32 v169, a141
v_accvgpr_read_b32 v170, a142
v_accvgpr_read_b32 v171, a143
v_accvgpr_read_b32 v172, a156
v_accvgpr_read_b32 v173, a157
v_accvgpr_read_b32 v174, a158
v_accvgpr_read_b32 v175, a159
v_pk_mul_f32 v[168:169], v[168:169], v[182:183]
v_pk_mul_f32 v[170:171], v[170:171], v[182:183]
v_pk_mul_f32 v[172:173], v[172:173], v[182:183]
v_pk_mul_f32 v[174:175], v[174:175], v[182:183]
v_cvt_pk_bf16_f32 v100, v168, v169
v_cvt_pk_bf16_f32 v101, v170, v171
v_cvt_pk_bf16_f32 v102, v172, v173
v_cvt_pk_bf16_f32 v103, v174, v175
s_mov_b32 s66, 28672
buffer_store_dwordx4 v[100:103], v190, s[20:23], s66 offen offset:0 sc0 sc1
v_pk_mul_f32 v[168:169], v[224:225], v[184:185]
v_pk_mul_f32 v[170:171], v[226:227], v[184:185]
v_pk_mul_f32 v[172:173], v[228:229], v[184:185]
v_pk_mul_f32 v[174:175], v[230:231], v[184:185]
v_cvt_pk_bf16_f32 v104, v168, v169
v_cvt_pk_bf16_f32 v105, v170, v171
v_cvt_pk_bf16_f32 v106, v172, v173
v_cvt_pk_bf16_f32 v107, v174, v175
s_mov_b32 s66, 36864
buffer_store_dwordx4 v[104:107], v190, s[20:23], s66 offen offset:0 sc0 sc1
v_accvgpr_read_b32 v168, a160
v_accvgpr_read_b32 v169, a161
v_accvgpr_read_b32 v170, a162
v_accvgpr_read_b32 v171, a163
v_accvgpr_read_b32 v172, a176
v_accvgpr_read_b32 v173, a177
v_accvgpr_read_b32 v174, a178
v_accvgpr_read_b32 v175, a179
v_pk_mul_f32 v[168:169], v[168:169], v[176:177]
v_pk_mul_f32 v[170:171], v[170:171], v[176:177]
v_pk_mul_f32 v[172:173], v[172:173], v[176:177]
v_pk_mul_f32 v[174:175], v[174:175], v[176:177]
v_cvt_pk_bf16_f32 v108, v168, v169
v_cvt_pk_bf16_f32 v109, v170, v171
v_cvt_pk_bf16_f32 v110, v172, v173
v_cvt_pk_bf16_f32 v111, v174, v175
s_mov_b32 s66, 4096
buffer_store_dwordx4 v[108:111], v190, s[20:23], s66 offen offset:1024 sc0 sc1
v_accvgpr_read_b32 v168, a164
v_accvgpr_read_b32 v169, a165
v_accvgpr_read_b32 v170, a166
v_accvgpr_read_b32 v171, a167
v_accvgpr_read_b32 v172, a180
v_accvgpr_read_b32 v173, a181
v_accvgpr_read_b32 v174, a182
v_accvgpr_read_b32 v175, a183
v_pk_mul_f32 v[168:169], v[168:169], v[178:179]
v_pk_mul_f32 v[170:171], v[170:171], v[178:179]
v_pk_mul_f32 v[172:173], v[172:173], v[178:179]
v_pk_mul_f32 v[174:175], v[174:175], v[178:179]
v_cvt_pk_bf16_f32 v112, v168, v169
v_cvt_pk_bf16_f32 v113, v170, v171
v_cvt_pk_bf16_f32 v114, v172, v173
v_cvt_pk_bf16_f32 v115, v174, v175
s_mov_b32 s66, 12288
buffer_store_dwordx4 v[112:115], v190, s[20:23], s66 offen offset:1024 sc0 sc1
v_accvgpr_read_b32 v168, a168
v_accvgpr_read_b32 v169, a169
v_accvgpr_read_b32 v170, a170
v_accvgpr_read_b32 v171, a171
v_accvgpr_read_b32 v172, a184
v_accvgpr_read_b32 v173, a185
v_accvgpr_read_b32 v174, a186
v_accvgpr_read_b32 v175, a187
v_pk_mul_f32 v[168:169], v[168:169], v[180:181]
v_pk_mul_f32 v[170:171], v[170:171], v[180:181]
v_pk_mul_f32 v[172:173], v[172:173], v[180:181]
v_pk_mul_f32 v[174:175], v[174:175], v[180:181]
v_cvt_pk_bf16_f32 v116, v168, v169
v_cvt_pk_bf16_f32 v117, v170, v171
v_cvt_pk_bf16_f32 v118, v172, v173
v_cvt_pk_bf16_f32 v119, v174, v175
s_mov_b32 s66, 20480
buffer_store_dwordx4 v[116:119], v190, s[20:23], s66 offen offset:1024 sc0 sc1
v_accvgpr_read_b32 v168, a172
v_accvgpr_read_b32 v169, a173
v_accvgpr_read_b32 v170, a174
v_accvgpr_read_b32 v171, a175
v_accvgpr_read_b32 v172, a188
v_accvgpr_read_b32 v173, a189
v_accvgpr_read_b32 v174, a190
v_accvgpr_read_b32 v175, a191
v_pk_mul_f32 v[168:169], v[168:169], v[182:183]
v_pk_mul_f32 v[170:171], v[170:171], v[182:183]
v_pk_mul_f32 v[172:173], v[172:173], v[182:183]
v_pk_mul_f32 v[174:175], v[174:175], v[182:183]
v_cvt_pk_bf16_f32 v120, v168, v169
v_cvt_pk_bf16_f32 v121, v170, v171
v_cvt_pk_bf16_f32 v122, v172, v173
v_cvt_pk_bf16_f32 v123, v174, v175
s_mov_b32 s66, 28672
buffer_store_dwordx4 v[120:123], v190, s[20:23], s66 offen offset:1024 sc0 sc1
v_pk_mul_f32 v[168:169], v[232:233], v[184:185]
v_pk_mul_f32 v[170:171], v[234:235], v[184:185]
v_pk_mul_f32 v[172:173], v[236:237], v[184:185]
v_pk_mul_f32 v[174:175], v[238:239], v[184:185]
v_cvt_pk_bf16_f32 v124, v168, v169
v_cvt_pk_bf16_f32 v125, v170, v171
v_cvt_pk_bf16_f32 v126, v172, v173
v_cvt_pk_bf16_f32 v127, v174, v175
s_mov_b32 s66, 36864
buffer_store_dwordx4 v[124:127], v190, s[20:23], s66 offen offset:1024 sc0 sc1
v_accvgpr_read_b32 v168, a192
v_accvgpr_read_b32 v169, a193
v_accvgpr_read_b32 v170, a194
v_accvgpr_read_b32 v171, a195
v_accvgpr_read_b32 v172, a208
v_accvgpr_read_b32 v173, a209
v_accvgpr_read_b32 v174, a210
v_accvgpr_read_b32 v175, a211
v_pk_mul_f32 v[168:169], v[168:169], v[176:177]
v_pk_mul_f32 v[170:171], v[170:171], v[176:177]
v_pk_mul_f32 v[172:173], v[172:173], v[176:177]
v_pk_mul_f32 v[174:175], v[174:175], v[176:177]
v_cvt_pk_bf16_f32 v128, v168, v169
v_cvt_pk_bf16_f32 v129, v170, v171
v_cvt_pk_bf16_f32 v130, v172, v173
v_cvt_pk_bf16_f32 v131, v174, v175
s_mov_b32 s66, 4096
buffer_store_dwordx4 v[128:131], v190, s[20:23], s66 offen offset:2048 sc0 sc1
v_accvgpr_read_b32 v168, a196
v_accvgpr_read_b32 v169, a197
v_accvgpr_read_b32 v170, a198
v_accvgpr_read_b32 v171, a199
v_accvgpr_read_b32 v172, a212
v_accvgpr_read_b32 v173, a213
v_accvgpr_read_b32 v174, a214
v_accvgpr_read_b32 v175, a215
v_pk_mul_f32 v[168:169], v[168:169], v[178:179]
v_pk_mul_f32 v[170:171], v[170:171], v[178:179]
v_pk_mul_f32 v[172:173], v[172:173], v[178:179]
v_pk_mul_f32 v[174:175], v[174:175], v[178:179]
v_cvt_pk_bf16_f32 v132, v168, v169
v_cvt_pk_bf16_f32 v133, v170, v171
v_cvt_pk_bf16_f32 v134, v172, v173
v_cvt_pk_bf16_f32 v135, v174, v175
s_mov_b32 s66, 12288
buffer_store_dwordx4 v[132:135], v190, s[20:23], s66 offen offset:2048 sc0 sc1
v_accvgpr_read_b32 v168, a200
v_accvgpr_read_b32 v169, a201
v_accvgpr_read_b32 v170, a202
v_accvgpr_read_b32 v171, a203
v_accvgpr_read_b32 v172, a216
v_accvgpr_read_b32 v173, a217
v_accvgpr_read_b32 v174, a218
v_accvgpr_read_b32 v175, a219
v_pk_mul_f32 v[168:169], v[168:169], v[180:181]
v_pk_mul_f32 v[170:171], v[170:171], v[180:181]
v_pk_mul_f32 v[172:173], v[172:173], v[180:181]
v_pk_mul_f32 v[174:175], v[174:175], v[180:181]
v_cvt_pk_bf16_f32 v136, v168, v169
v_cvt_pk_bf16_f32 v137, v170, v171
v_cvt_pk_bf16_f32 v138, v172, v173
v_cvt_pk_bf16_f32 v139, v174, v175
s_mov_b32 s66, 20480
buffer_store_dwordx4 v[136:139], v190, s[20:23], s66 offen offset:2048 sc0 sc1
v_accvgpr_read_b32 v168, a204
v_accvgpr_read_b32 v169, a205
v_accvgpr_read_b32 v170, a206
v_accvgpr_read_b32 v171, a207
v_accvgpr_read_b32 v172, a220
v_accvgpr_read_b32 v173, a221
v_accvgpr_read_b32 v174, a222
v_accvgpr_read_b32 v175, a223
v_pk_mul_f32 v[168:169], v[168:169], v[182:183]
v_pk_mul_f32 v[170:171], v[170:171], v[182:183]
v_pk_mul_f32 v[172:173], v[172:173], v[182:183]
v_pk_mul_f32 v[174:175], v[174:175], v[182:183]
v_cvt_pk_bf16_f32 v140, v168, v169
v_cvt_pk_bf16_f32 v141, v170, v171
v_cvt_pk_bf16_f32 v142, v172, v173
v_cvt_pk_bf16_f32 v143, v174, v175
s_mov_b32 s66, 28672
buffer_store_dwordx4 v[140:143], v190, s[20:23], s66 offen offset:2048 sc0 sc1
v_pk_mul_f32 v[168:169], v[240:241], v[184:185]
v_pk_mul_f32 v[170:171], v[242:243], v[184:185]
v_pk_mul_f32 v[172:173], v[244:245], v[184:185]
v_pk_mul_f32 v[174:175], v[246:247], v[184:185]
v_cvt_pk_bf16_f32 v144, v168, v169
v_cvt_pk_bf16_f32 v145, v170, v171
v_cvt_pk_bf16_f32 v146, v172, v173
v_cvt_pk_bf16_f32 v147, v174, v175
s_mov_b32 s66, 36864
buffer_store_dwordx4 v[144:147], v190, s[20:23], s66 offen offset:2048 sc0 sc1
v_accvgpr_read_b32 v168, a224
v_accvgpr_read_b32 v169, a225
v_accvgpr_read_b32 v170, a226
v_accvgpr_read_b32 v171, a227
v_accvgpr_read_b32 v172, a240
v_accvgpr_read_b32 v173, a241
v_accvgpr_read_b32 v174, a242
v_accvgpr_read_b32 v175, a243
v_pk_mul_f32 v[168:169], v[168:169], v[176:177]
v_pk_mul_f32 v[170:171], v[170:171], v[176:177]
v_pk_mul_f32 v[172:173], v[172:173], v[176:177]
v_pk_mul_f32 v[174:175], v[174:175], v[176:177]
v_cvt_pk_bf16_f32 v148, v168, v169
v_cvt_pk_bf16_f32 v149, v170, v171
v_cvt_pk_bf16_f32 v150, v172, v173
v_cvt_pk_bf16_f32 v151, v174, v175
s_mov_b32 s66, 4096
buffer_store_dwordx4 v[148:151], v190, s[20:23], s66 offen offset:3072 sc0 sc1
v_accvgpr_read_b32 v168, a228
v_accvgpr_read_b32 v169, a229
v_accvgpr_read_b32 v170, a230
v_accvgpr_read_b32 v171, a231
v_accvgpr_read_b32 v172, a244
v_accvgpr_read_b32 v173, a245
v_accvgpr_read_b32 v174, a246
v_accvgpr_read_b32 v175, a247
v_pk_mul_f32 v[168:169], v[168:169], v[178:179]
v_pk_mul_f32 v[170:171], v[170:171], v[178:179]
v_pk_mul_f32 v[172:173], v[172:173], v[178:179]
v_pk_mul_f32 v[174:175], v[174:175], v[178:179]
v_cvt_pk_bf16_f32 v152, v168, v169
v_cvt_pk_bf16_f32 v153, v170, v171
v_cvt_pk_bf16_f32 v154, v172, v173
v_cvt_pk_bf16_f32 v155, v174, v175
s_mov_b32 s66, 12288
buffer_store_dwordx4 v[152:155], v190, s[20:23], s66 offen offset:3072 sc0 sc1
v_accvgpr_read_b32 v168, a232
v_accvgpr_read_b32 v169, a233
v_accvgpr_read_b32 v170, a234
v_accvgpr_read_b32 v171, a235
v_accvgpr_read_b32 v172, a248
v_accvgpr_read_b32 v173, a249
v_accvgpr_read_b32 v174, a250
v_accvgpr_read_b32 v175, a251
v_pk_mul_f32 v[168:169], v[168:169], v[180:181]
v_pk_mul_f32 v[170:171], v[170:171], v[180:181]
v_pk_mul_f32 v[172:173], v[172:173], v[180:181]
v_pk_mul_f32 v[174:175], v[174:175], v[180:181]
v_cvt_pk_bf16_f32 v156, v168, v169
v_cvt_pk_bf16_f32 v157, v170, v171
v_cvt_pk_bf16_f32 v158, v172, v173
v_cvt_pk_bf16_f32 v159, v174, v175
s_mov_b32 s66, 20480
buffer_store_dwordx4 v[156:159], v190, s[20:23], s66 offen offset:3072 sc0 sc1
v_accvgpr_read_b32 v168, a236
v_accvgpr_read_b32 v169, a237
v_accvgpr_read_b32 v170, a238
v_accvgpr_read_b32 v171, a239
v_accvgpr_read_b32 v172, a252
v_accvgpr_read_b32 v173, a253
v_accvgpr_read_b32 v174, a254
v_accvgpr_read_b32 v175, a255
v_pk_mul_f32 v[168:169], v[168:169], v[182:183]
v_pk_mul_f32 v[170:171], v[170:171], v[182:183]
v_pk_mul_f32 v[172:173], v[172:173], v[182:183]
v_pk_mul_f32 v[174:175], v[174:175], v[182:183]
v_cvt_pk_bf16_f32 v160, v168, v169
v_cvt_pk_bf16_f32 v161, v170, v171
v_cvt_pk_bf16_f32 v162, v172, v173
v_cvt_pk_bf16_f32 v163, v174, v175
s_mov_b32 s66, 28672
buffer_store_dwordx4 v[160:163], v190, s[20:23], s66 offen offset:3072 sc0 sc1
v_pk_mul_f32 v[168:169], v[248:249], v[184:185]
v_pk_mul_f32 v[170:171], v[250:251], v[184:185]
v_pk_mul_f32 v[172:173], v[252:253], v[184:185]
v_pk_mul_f32 v[174:175], v[254:255], v[184:185]
v_cvt_pk_bf16_f32 v164, v168, v169
v_cvt_pk_bf16_f32 v165, v170, v171
v_cvt_pk_bf16_f32 v166, v172, v173
v_cvt_pk_bf16_f32 v167, v174, v175
s_mov_b32 s66, 36864
buffer_store_dwordx4 v[164:167], v190, s[20:23], s66 offen offset:3072 sc0 sc1
s_waitcnt vmcnt(0)
v_mov_b32 v186, 0
v_mov_b32 v187, 1
s_mov_b64 exec, 1
global_atomic_add v186, v187, s[42:43]
s_mov_b64 exec, -1
s_barrier
ds_read_b128 a[140:143], v5 offset:0
ds_read_b128 a[144:147], v5 offset:1024
ds_read_b128 a[148:151], v5 offset:2048
ds_read_b128 a[152:155], v5 offset:3072
ds_read_b128 a[156:159], v5 offset:4096
ds_read_b128 a[160:163], v5 offset:5120
ds_read_b128 a[164:167], v5 offset:6144
s_waitcnt lgkmcnt(0)
v_mfma_f32_16x16x32_bf16 a[0:3], a[140:143], v[8:11], 0
v_mfma_f32_16x16x32_bf16 a[28:31], a[140:143], v[12:15], 0
ds_read_b128 a[168:171], v5 offset:7168
v_mfma_f32_16x16x32_bf16 a[56:59], a[140:143], v[16:19], 0
v_mfma_f32_16x16x32_bf16 a[84:87], a[140:143], v[20:23], 0
v_mfma_f32_16x16x32_bf16 a[112:115], a[140:143], v[24:27], 0
ds_read_b128 a[172:175], v5 offset:8192
v_mfma_f32_16x16x32_bf16 a[4:7], a[144:147], v[8:11], 0
v_mfma_f32_16x16x32_bf16 a[32:35], a[144:147], v[12:15], 0
v_mfma_f32_16x16x32_bf16 a[60:63], a[144:147], v[16:19], 0
v_mfma_f32_16x16x32_bf16 a[88:91], a[144:147], v[20:23], 0
ds_read_b128 a[176:179], v5 offset:9216
v_mfma_f32_16x16x32_bf16 a[116:119], a[144:147], v[24:27], 0
v_mfma_f32_16x16x32_bf16 a[8:11], a[148:151], v[8:11], 0
v_mfma_f32_16x16x32_bf16 a[36:39], a[148:151], v[12:15], 0
ds_read_b128 a[180:183], v5 offset:10240
v_mfma_f32_16x16x32_bf16 a[64:67], a[148:151], v[16:19], 0
v_mfma_f32_16x16x32_bf16 a[92:95], a[148:151], v[20:23], 0
v_mfma_f32_16x16x32_bf16 a[120:123], a[148:151], v[24:27], 0
v_mfma_f32_16x16x32_bf16 a[12:15], a[152:155], v[8:11], 0
ds_read_b128 a[184:187], v5 offset:11264
v_mfma_f32_16x16x32_bf16 a[40:43], a[152:155], v[12:15], 0
v_mfma_f32_16x16x32_bf16 a[68:71], a[152:155], v[16:19], 0
v_mfma_f32_16x16x32_bf16 a[96:99], a[152:155], v[20:23], 0
ds_read_b128 a[188:191], v5 offset:12288
v_mfma_f32_16x16x32_bf16 a[124:127], a[152:155], v[24:27], 0
v_mfma_f32_16x16x32_bf16 a[16:19], a[156:159], v[8:11], 0
v_mfma_f32_16x16x32_bf16 a[44:47], a[156:159], v[12:15], 0
v_mfma_f32_16x16x32_bf16 a[72:75], a[156:159], v[16:19], 0
ds_read_b128 a[192:195], v5 offset:13312
v_mfma_f32_16x16x32_bf16 a[100:103], a[156:159], v[20:23], 0
v_mfma_f32_16x16x32_bf16 a[128:131], a[156:159], v[24:27], 0
v_mfma_f32_16x16x32_bf16 a[20:23], a[160:163], v[8:11], 0
v_mfma_f32_16x16x32_bf16 a[48:51], a[160:163], v[12:15], 0
v_mfma_f32_16x16x32_bf16 a[76:79], a[160:163], v[16:19], 0
v_mfma_f32_16x16x32_bf16 a[104:107], a[160:163], v[20:23], 0
v_mfma_f32_16x16x32_bf16 a[132:135], a[160:163], v[24:27], 0
v_mfma_f32_16x16x32_bf16 a[24:27], a[164:167], v[8:11], 0
v_mfma_f32_16x16x32_bf16 a[52:55], a[164:167], v[12:15], 0
v_mfma_f32_16x16x32_bf16 a[80:83], a[164:167], v[16:19], 0
v_mfma_f32_16x16x32_bf16 a[108:111], a[164:167], v[20:23], 0
v_mfma_f32_16x16x32_bf16 a[136:139], a[164:167], v[24:27], 0
s_waitcnt lgkmcnt(0)
v_mfma_f32_16x16x32_bf16 a[0:3], a[168:171], v[28:31], a[0:3]
v_mfma_f32_16x16x32_bf16 a[28:31], a[168:171], v[32:35], a[28:31]
ds_read_b128 a[140:143], v5 offset:14336
v_mfma_f32_16x16x32_bf16 a[56:59], a[168:171], v[36:39], a[56:59]
v_mfma_f32_16x16x32_bf16 a[84:87], a[168:171], v[40:43], a[84:87]
v_mfma_f32_16x16x32_bf16 a[112:115], a[168:171], v[44:47], a[112:115]
ds_read_b128 a[144:147], v5 offset:15360
v_mfma_f32_16x16x32_bf16 a[4:7], a[172:175], v[28:31], a[4:7]
v_mfma_f32_16x16x32_bf16 a[32:35], a[172:175], v[32:35], a[32:35]
v_mfma_f32_16x16x32_bf16 a[60:63], a[172:175], v[36:39], a[60:63]
v_mfma_f32_16x16x32_bf16 a[88:91], a[172:175], v[40:43], a[88:91]
ds_read_b128 a[148:151], v5 offset:16384
v_mfma_f32_16x16x32_bf16 a[116:119], a[172:175], v[44:47], a[116:119]
v_mfma_f32_16x16x32_bf16 a[8:11], a[176:179], v[28:31], a[8:11]
v_mfma_f32_16x16x32_bf16 a[36:39], a[176:179], v[32:35], a[36:39]
ds_read_b128 a[152:155], v5 offset:17408
v_mfma_f32_16x16x32_bf16 a[64:67], a[176:179], v[36:39], a[64:67]
v_mfma_f32_16x16x32_bf16 a[92:95], a[176:179], v[40:43], a[92:95]
v_mfma_f32_16x16x32_bf16 a[120:123], a[176:179], v[44:47], a[120:123]
v_mfma_f32_16x16x32_bf16 a[12:15], a[180:183], v[28:31], a[12:15]
ds_read_b128 a[156:159], v5 offset:18432
v_mfma_f32_16x16x32_bf16 a[40:43], a[180:183], v[32:35], a[40:43]
v_mfma_f32_16x16x32_bf16 a[68:71], a[180:183], v[36:39], a[68:71]
v_mfma_f32_16x16x32_bf16 a[96:99], a[180:183], v[40:43], a[96:99]
ds_read_b128 a[160:163], v5 offset:19456
v_mfma_f32_16x16x32_bf16 a[124:127], a[180:183], v[44:47], a[124:127]
v_mfma_f32_16x16x32_bf16 a[16:19], a[184:187], v[28:31], a[16:19]
v_mfma_f32_16x16x32_bf16 a[44:47], a[184:187], v[32:35], a[44:47]
v_mfma_f32_16x16x32_bf16 a[72:75], a[184:187], v[36:39], a[72:75]
ds_read_b128 a[164:167], v5 offset:20480
v_mfma_f32_16x16x32_bf16 a[100:103], a[184:187], v[40:43], a[100:103]
v_mfma_f32_16x16x32_bf16 a[128:131], a[184:187], v[44:47], a[128:131]
v_mfma_f32_16x16x32_bf16 a[20:23], a[188:191], v[28:31], a[20:23]
v_mfma_f32_16x16x32_bf16 a[48:51], a[188:191], v[32:35], a[48:51]
v_mfma_f32_16x16x32_bf16 a[76:79], a[188:191], v[36:39], a[76:79]
v_mfma_f32_16x16x32_bf16 a[104:107], a[188:191], v[40:43], a[104:107]
v_mfma_f32_16x16x32_bf16 a[132:135], a[188:191], v[44:47], a[132:135]
v_mfma_f32_16x16x32_bf16 a[24:27], a[192:195], v[28:31], a[24:27]
v_mfma_f32_16x16x32_bf16 a[52:55], a[192:195], v[32:35], a[52:55]
v_mfma_f32_16x16x32_bf16 a[80:83], a[192:195], v[36:39], a[80:83]
v_mfma_f32_16x16x32_bf16 a[108:111], a[192:195], v[40:43], a[108:111]
v_mfma_f32_16x16x32_bf16 a[136:139], a[192:195], v[44:47], a[136:139]
s_waitcnt lgkmcnt(0)
v_mfma_f32_16x16x32_bf16 a[0:3], a[140:143], v[48:51], a[0:3]
v_mfma_f32_16x16x32_bf16 a[28:31], a[140:143], v[52:55], a[28:31]
ds_read_b128 a[168:171], v5 offset:21504
v_mfma_f32_16x16x32_bf16 a[56:59], a[140:143], v[56:59], a[56:59]
v_mfma_f32_16x16x32_bf16 a[84:87], a[140:143], v[60:63], a[84:87]
v_mfma_f32_16x16x32_bf16 a[112:115], a[140:143], v[64:67], a[112:115]
ds_read_b128 a[172:175], v5 offset:22528
v_mfma_f32_16x16x32_bf16 a[4:7], a[144:147], v[48:51], a[4:7]
v_mfma_f32_16x16x32_bf16 a[32:35], a[144:147], v[52:55], a[32:35]
v_mfma_f32_16x16x32_bf16 a[60:63], a[144:147], v[56:59], a[60:63]
v_mfma_f32_16x16x32_bf16 a[88:91], a[144:147], v[60:63], a[88:91]
ds_read_b128 a[176:179], v5 offset:23552
v_mfma_f32_16x16x32_bf16 a[116:119], a[144:147], v[64:67], a[116:119]
v_mfma_f32_16x16x32_bf16 a[8:11], a[148:151], v[48:51], a[8:11]
v_mfma_f32_16x16x32_bf16 a[36:39], a[148:151], v[52:55], a[36:39]
ds_read_b128 a[180:183], v5 offset:24576
v_mfma_f32_16x16x32_bf16 a[64:67], a[148:151], v[56:59], a[64:67]
v_mfma_f32_16x16x32_bf16 a[92:95], a[148:151], v[60:63], a[92:95]
v_mfma_f32_16x16x32_bf16 a[120:123], a[148:151], v[64:67], a[120:123]
v_mfma_f32_16x16x32_bf16 a[12:15], a[152:155], v[48:51], a[12:15]
ds_read_b128 a[184:187], v5 offset:25600
v_mfma_f32_16x16x32_bf16 a[40:43], a[152:155], v[52:55], a[40:43]
v_mfma_f32_16x16x32_bf16 a[68:71], a[152:155], v[56:59], a[68:71]
v_mfma_f32_16x16x32_bf16 a[96:99], a[152:155], v[60:63], a[96:99]
ds_read_b128 a[188:191], v5 offset:26624
v_mfma_f32_16x16x32_bf16 a[124:127], a[152:155], v[64:67], a[124:127]
v_mfma_f32_16x16x32_bf16 a[16:19], a[156:159], v[48:51], a[16:19]
v_mfma_f32_16x16x32_bf16 a[44:47], a[156:159], v[52:55], a[44:47]
v_mfma_f32_16x16x32_bf16 a[72:75], a[156:159], v[56:59], a[72:75]
ds_read_b128 a[192:195], v5 offset:27648
v_mfma_f32_16x16x32_bf16 a[100:103], a[156:159], v[60:63], a[100:103]
v_mfma_f32_16x16x32_bf16 a[128:131], a[156:159], v[64:67], a[128:131]
v_mfma_f32_16x16x32_bf16 a[20:23], a[160:163], v[48:51], a[20:23]
v_mfma_f32_16x16x32_bf16 a[48:51], a[160:163], v[52:55], a[48:51]
v_mfma_f32_16x16x32_bf16 a[76:79], a[160:163], v[56:59], a[76:79]
v_mfma_f32_16x16x32_bf16 a[104:107], a[160:163], v[60:63], a[104:107]
v_mfma_f32_16x16x32_bf16 a[132:135], a[160:163], v[64:67], a[132:135]
v_mfma_f32_16x16x32_bf16 a[24:27], a[164:167], v[48:51], a[24:27]
v_mfma_f32_16x16x32_bf16 a[52:55], a[164:167], v[52:55], a[52:55]
v_mfma_f32_16x16x32_bf16 a[80:83], a[164:167], v[56:59], a[80:83]
v_mfma_f32_16x16x32_bf16 a[108:111], a[164:167], v[60:63], a[108:111]
v_mfma_f32_16x16x32_bf16 a[136:139], a[164:167], v[64:67], a[136:139]
s_waitcnt lgkmcnt(0)
v_mfma_f32_16x16x32_bf16 a[0:3], a[168:171], v[68:71], a[0:3]
v_mfma_f32_16x16x32_bf16 a[28:31], a[168:171], v[72:75], a[28:31]
ds_read_b128 a[140:143], v5 offset:28672
v_mfma_f32_16x16x32_bf16 a[56:59], a[168:171], v[76:79], a[56:59]
v_mfma_f32_16x16x32_bf16 a[84:87], a[168:171], v[80:83], a[84:87]
v_mfma_f32_16x16x32_bf16 a[112:115], a[168:171], v[84:87], a[112:115]
ds_read_b128 a[144:147], v5 offset:29696
v_mfma_f32_16x16x32_bf16 a[4:7], a[172:175], v[68:71], a[4:7]
v_mfma_f32_16x16x32_bf16 a[32:35], a[172:175], v[72:75], a[32:35]
v_mfma_f32_16x16x32_bf16 a[60:63], a[172:175], v[76:79], a[60:63]
v_mfma_f32_16x16x32_bf16 a[88:91], a[172:175], v[80:83], a[88:91]
ds_read_b128 a[148:151], v5 offset:30720
v_mfma_f32_16x16x32_bf16 a[116:119], a[172:175], v[84:87], a[116:119]
v_mfma_f32_16x16x32_bf16 a[8:11], a[176:179], v[68:71], a[8:11]
v_mfma_f32_16x16x32_bf16 a[36:39], a[176:179], v[72:75], a[36:39]
ds_read_b128 a[152:155], v5 offset:31744
v_mfma_f32_16x16x32_bf16 a[64:67], a[176:179], v[76:79], a[64:67]
v_mfma_f32_16x16x32_bf16 a[92:95], a[176:179], v[80:83], a[92:95]
v_mfma_f32_16x16x32_bf16 a[120:123], a[176:179], v[84:87], a[120:123]
v_mfma_f32_16x16x32_bf16 a[12:15], a[180:183], v[68:71], a[12:15]
ds_read_b128 a[156:159], v5 offset:32768
v_mfma_f32_16x16x32_bf16 a[40:43], a[180:183], v[72:75], a[40:43]
v_mfma_f32_16x16x32_bf16 a[68:71], a[180:183], v[76:79], a[68:71]
v_mfma_f32_16x16x32_bf16 a[96:99], a[180:183], v[80:83], a[96:99]
ds_read_b128 a[160:163], v5 offset:33792
v_mfma_f32_16x16x32_bf16 a[124:127], a[180:183], v[84:87], a[124:127]
v_mfma_f32_16x16x32_bf16 a[16:19], a[184:187], v[68:71], a[16:19]
v_mfma_f32_16x16x32_bf16 a[44:47], a[184:187], v[72:75], a[44:47]
v_mfma_f32_16x16x32_bf16 a[72:75], a[184:187], v[76:79], a[72:75]
ds_read_b128 a[164:167], v5 offset:34816
v_mfma_f32_16x16x32_bf16 a[100:103], a[184:187], v[80:83], a[100:103]
v_mfma_f32_16x16x32_bf16 a[128:131], a[184:187], v[84:87], a[128:131]
v_mfma_f32_16x16x32_bf16 a[20:23], a[188:191], v[68:71], a[20:23]
v_mfma_f32_16x16x32_bf16 a[48:51], a[188:191], v[72:75], a[48:51]
v_mfma_f32_16x16x32_bf16 a[76:79], a[188:191], v[76:79], a[76:79]
v_mfma_f32_16x16x32_bf16 a[104:107], a[188:191], v[80:83], a[104:107]
v_mfma_f32_16x16x32_bf16 a[132:135], a[188:191], v[84:87], a[132:135]
v_mfma_f32_16x16x32_bf16 a[24:27], a[192:195], v[68:71], a[24:27]
v_mfma_f32_16x16x32_bf16 a[52:55], a[192:195], v[72:75], a[52:55]
v_mfma_f32_16x16x32_bf16 a[80:83], a[192:195], v[76:79], a[80:83]
v_mfma_f32_16x16x32_bf16 a[108:111], a[192:195], v[80:83], a[108:111]
v_mfma_f32_16x16x32_bf16 a[136:139], a[192:195], v[84:87], a[136:139]
s_waitcnt lgkmcnt(0)
v_mfma_f32_16x16x32_bf16 a[0:3], a[140:143], v[88:91], a[0:3]
v_mfma_f32_16x16x32_bf16 a[28:31], a[140:143], v[92:95], a[28:31]
ds_read_b128 a[168:171], v5 offset:35840
v_mfma_f32_16x16x32_bf16 a[56:59], a[140:143], v[96:99], a[56:59]
v_mfma_f32_16x16x32_bf16 a[84:87], a[140:143], v[100:103], a[84:87]
v_mfma_f32_16x16x32_bf16 a[112:115], a[140:143], v[104:107], a[112:115]
ds_read_b128 a[172:175], v5 offset:36864
v_mfma_f32_16x16x32_bf16 a[4:7], a[144:147], v[88:91], a[4:7]
v_mfma_f32_16x16x32_bf16 a[32:35], a[144:147], v[92:95], a[32:35]
v_mfma_f32_16x16x32_bf16 a[60:63], a[144:147], v[96:99], a[60:63]
v_mfma_f32_16x16x32_bf16 a[88:91], a[144:147], v[100:103], a[88:91]
ds_read_b128 a[176:179], v5 offset:37888
v_mfma_f32_16x16x32_bf16 a[116:119], a[144:147], v[104:107], a[116:119]
v_mfma_f32_16x16x32_bf16 a[8:11], a[148:151], v[88:91], a[8:11]
v_mfma_f32_16x16x32_bf16 a[36:39], a[148:151], v[92:95], a[36:39]
ds_read_b128 a[180:183], v5 offset:38912
v_mfma_f32_16x16x32_bf16 a[64:67], a[148:151], v[96:99], a[64:67]
v_mfma_f32_16x16x32_bf16 a[92:95], a[148:151], v[100:103], a[92:95]
v_mfma_f32_16x16x32_bf16 a[120:123], a[148:151], v[104:107], a[120:123]
v_mfma_f32_16x16x32_bf16 a[12:15], a[152:155], v[88:91], a[12:15]
ds_read_b128 a[184:187], v5 offset:39936
v_mfma_f32_16x16x32_bf16 a[40:43], a[152:155], v[92:95], a[40:43]
v_mfma_f32_16x16x32_bf16 a[68:71], a[152:155], v[96:99], a[68:71]
v_mfma_f32_16x16x32_bf16 a[96:99], a[152:155], v[100:103], a[96:99]
ds_read_b128 a[188:191], v5 offset:40960
v_mfma_f32_16x16x32_bf16 a[124:127], a[152:155], v[104:107], a[124:127]
v_mfma_f32_16x16x32_bf16 a[16:19], a[156:159], v[88:91], a[16:19]
v_mfma_f32_16x16x32_bf16 a[44:47], a[156:159], v[92:95], a[44:47]
v_mfma_f32_16x16x32_bf16 a[72:75], a[156:159], v[96:99], a[72:75]
ds_read_b128 a[192:195], v5 offset:41984
v_mfma_f32_16x16x32_bf16 a[100:103], a[156:159], v[100:103], a[100:103]
v_mfma_f32_16x16x32_bf16 a[128:131], a[156:159], v[104:107], a[128:131]
v_mfma_f32_16x16x32_bf16 a[20:23], a[160:163], v[88:91], a[20:23]
v_mfma_f32_16x16x32_bf16 a[48:51], a[160:163], v[92:95], a[48:51]
v_mfma_f32_16x16x32_bf16 a[76:79], a[160:163], v[96:99], a[76:79]
v_mfma_f32_16x16x32_bf16 a[104:107], a[160:163], v[100:103], a[104:107]
v_mfma_f32_16x16x32_bf16 a[132:135], a[160:163], v[104:107], a[132:135]
v_mfma_f32_16x16x32_bf16 a[24:27], a[164:167], v[88:91], a[24:27]
v_mfma_f32_16x16x32_bf16 a[52:55], a[164:167], v[92:95], a[52:55]
v_mfma_f32_16x16x32_bf16 a[80:83], a[164:167], v[96:99], a[80:83]
v_mfma_f32_16x16x32_bf16 a[108:111], a[164:167], v[100:103], a[108:111]
v_mfma_f32_16x16x32_bf16 a[136:139], a[164:167], v[104:107], a[136:139]
v_mov_b32 v186, 0
s_mov_b32 s58, 0x20000
L_p1r5:
global_load_dword v187, v186, s[42:43] sc1
s_waitcnt vmcnt(0)
v_readfirstlane_b32 s59, v187
s_nop 3
s_cmp_ge_u32 s59, 4
s_cbranch_scc1 L_pd1r5
s_sub_u32 s58, s58, 1
s_cmp_lg_u32 s58, 0
s_cbranch_scc1 L_p1r5
L_pd1r5:
s_waitcnt vmcnt(0)
buffer_load_dwordx4 v[8:11], v0, s[12:15], s52 offen offset:0 sc1
buffer_load_dwordx4 v[12:15], v1, s[12:15], s52 offen offset:0 sc1
buffer_load_dwordx4 v[16:19], v2, s[12:15], s52 offen offset:0 sc1
buffer_load_dwordx4 v[20:23], v3, s[12:15], s52 offen offset:0 sc1
buffer_load_dwordx4 v[24:27], v4, s[12:15], s52 offen offset:0 sc1
buffer_load_dwordx4 v[28:31], v0, s[12:15], s52 offen offset:1024 sc1
buffer_load_dwordx4 v[32:35], v1, s[12:15], s52 offen offset:1024 sc1
buffer_load_dwordx4 v[36:39], v2, s[12:15], s52 offen offset:1024 sc1
buffer_load_dwordx4 v[40:43], v3, s[12:15], s52 offen offset:1024 sc1
buffer_load_dwordx4 v[44:47], v4, s[12:15], s52 offen offset:1024 sc1
buffer_load_dwordx4 v[48:51], v0, s[12:15], s52 offen offset:2048 sc1
buffer_load_dwordx4 v[52:55], v1, s[12:15], s52 offen offset:2048 sc1
buffer_load_dwordx4 v[56:59], v2, s[12:15], s52 offen offset:2048 sc1
buffer_load_dwordx4 v[60:63], v3, s[12:15], s52 offen offset:2048 sc1
buffer_load_dwordx4 v[64:67], v4, s[12:15], s52 offen offset:2048 sc1
buffer_load_dwordx4 v[68:71], v0, s[12:15], s52 offen offset:3072 sc1
buffer_load_dwordx4 v[72:75], v1, s[12:15], s52 offen offset:3072 sc1
buffer_load_dwordx4 v[76:79], v2, s[12:15], s52 offen offset:3072 sc1
buffer_load_dwordx4 v[80:83], v3, s[12:15], s52 offen offset:3072 sc1
buffer_load_dwordx4 v[84:87], v4, s[12:15], s52 offen offset:3072 sc1
s_add_u32 s59, s52, 4096
buffer_load_dwordx4 v[88:91], v0, s[12:15], s59 offen offset:0 sc1
buffer_load_dwordx4 v[92:95], v1, s[12:15], s59 offen offset:0 sc1
buffer_load_dwordx4 v[96:99], v2, s[12:15], s59 offen offset:0 sc1
buffer_load_dwordx4 v[100:103], v3, s[12:15], s59 offen offset:0 sc1
buffer_load_dwordx4 v[104:107], v4, s[12:15], s59 offen offset:0 sc1
s_waitcnt lgkmcnt(0)
v_mfma_f32_16x16x32_bf16 a[0:3], a[168:171], v[108:111], a[0:3]
v_mfma_f32_16x16x32_bf16 a[28:31], a[168:171], v[112:115], a[28:31]
ds_read_b128 a[140:143], v5 offset:43008
v_mfma_f32_16x16x32_bf16 a[56:59], a[168:171], v[116:119], a[56:59]
v_mfma_f32_16x16x32_bf16 a[84:87], a[168:171], v[120:123], a[84:87]
v_mfma_f32_16x16x32_bf16 a[112:115], a[168:171], v[124:127], a[112:115]
ds_read_b128 a[144:147], v5 offset:44032
v_mfma_f32_16x16x32_bf16 a[4:7], a[172:175], v[108:111], a[4:7]
v_mfma_f32_16x16x32_bf16 a[32:35], a[172:175], v[112:115], a[32:35]
v_mfma_f32_16x16x32_bf16 a[60:63], a[172:175], v[116:119], a[60:63]
v_mfma_f32_16x16x32_bf16 a[88:91], a[172:175], v[120:123], a[88:91]
ds_read_b128 a[148:151], v5 offset:45056
v_mfma_f32_16x16x32_bf16 a[116:119], a[172:175], v[124:127], a[116:119]
v_mfma_f32_16x16x32_bf16 a[8:11], a[176:179], v[108:111], a[8:11]
v_mfma_f32_16x16x32_bf16 a[36:39], a[176:179], v[112:115], a[36:39]
ds_read_b128 a[152:155], v5 offset:46080
v_mfma_f32_16x16x32_bf16 a[64:67], a[176:179], v[116:119], a[64:67]
v_mfma_f32_16x16x32_bf16 a[92:95], a[176:179], v[120:123], a[92:95]
v_mfma_f32_16x16x32_bf16 a[120:123], a[176:179], v[124:127], a[120:123]
v_mfma_f32_16x16x32_bf16 a[12:15], a[180:183], v[108:111], a[12:15]
ds_read_b128 a[156:159], v5 offset:47104
v_mfma_f32_16x16x32_bf16 a[40:43], a[180:183], v[112:115], a[40:43]
v_mfma_f32_16x16x32_bf16 a[68:71], a[180:183], v[116:119], a[68:71]
v_mfma_f32_16x16x32_bf16 a[96:99], a[180:183], v[120:123], a[96:99]
ds_read_b128 a[160:163], v5 offset:48128
v_mfma_f32_16x16x32_bf16 a[124:127], a[180:183], v[124:127], a[124:127]
v_mfma_f32_16x16x32_bf16 a[16:19], a[184:187], v[108:111], a[16:19]
v_mfma_f32_16x16x32_bf16 a[44:47], a[184:187], v[112:115], a[44:47]
v_mfma_f32_16x16x32_bf16 a[72:75], a[184:187], v[116:119], a[72:75]
ds_read_b128 a[164:167], v5 offset:49152
v_mfma_f32_16x16x32_bf16 a[100:103], a[184:187], v[120:123], a[100:103]
v_mfma_f32_16x16x32_bf16 a[128:131], a[184:187], v[124:127], a[128:131]
v_mfma_f32_16x16x32_bf16 a[20:23], a[188:191], v[108:111], a[20:23]
v_mfma_f32_16x16x32_bf16 a[48:51], a[188:191], v[112:115], a[48:51]
v_mfma_f32_16x16x32_bf16 a[76:79], a[188:191], v[116:119], a[76:79]
v_mfma_f32_16x16x32_bf16 a[104:107], a[188:191], v[120:123], a[104:107]
v_mfma_f32_16x16x32_bf16 a[132:135], a[188:191], v[124:127], a[132:135]
v_mfma_f32_16x16x32_bf16 a[24:27], a[192:195], v[108:111], a[24:27]
v_mfma_f32_16x16x32_bf16 a[52:55], a[192:195], v[112:115], a[52:55]
v_mfma_f32_16x16x32_bf16 a[80:83], a[192:195], v[116:119], a[80:83]
v_mfma_f32_16x16x32_bf16 a[108:111], a[192:195], v[120:123], a[108:111]
v_mfma_f32_16x16x32_bf16 a[136:139], a[192:195], v[124:127], a[136:139]
s_waitcnt lgkmcnt(0)
v_mfma_f32_16x16x32_bf16 a[0:3], a[140:143], v[128:131], a[0:3]
s_add_u32 s59, s52, 4096
v_mfma_f32_16x16x32_bf16 a[28:31], a[140:143], v[132:135], a[28:31]
ds_read_b128 a[168:171], v5 offset:50176
v_mfma_f32_16x16x32_bf16 a[56:59], a[140:143], v[136:139], a[56:59]
buffer_load_dwordx4 v[108:111], v0, s[12:15], s59 offen offset:1024 sc1
v_mfma_f32_16x16x32_bf16 a[84:87], a[140:143], v[140:143], a[84:87]
v_mfma_f32_16x16x32_bf16 a[112:115], a[140:143], v[144:147], a[112:115]
ds_read_b128 a[172:175], v5 offset:51200
v_mfma_f32_16x16x32_bf16 a[4:7], a[144:147], v[128:131], a[4:7]
v_mfma_f32_16x16x32_bf16 a[32:35], a[144:147], v[132:135], a[32:35]
v_mfma_f32_16x16x32_bf16 a[60:63], a[144:147], v[136:139], a[60:63]
v_mfma_f32_16x16x32_bf16 a[88:91], a[144:147], v[140:143], a[88:91]
ds_read_b128 a[176:179], v5 offset:52224
buffer_load_dwordx4 v[112:115], v1, s[12:15], s59 offen offset:1024 sc1
v_mfma_f32_16x16x32_bf16 a[116:119], a[144:147], v[144:147], a[116:119]
v_mfma_f32_16x16x32_bf16 a[8:11], a[148:151], v[128:131], a[8:11]
v_mfma_f32_16x16x32_bf16 a[36:39], a[148:151], v[132:135], a[36:39]
ds_read_b128 a[180:183], v5 offset:53248
v_mfma_f32_16x16x32_bf16 a[64:67], a[148:151], v[136:139], a[64:67]
v_mfma_f32_16x16x32_bf16 a[92:95], a[148:151], v[140:143], a[92:95]
v_mfma_f32_16x16x32_bf16 a[120:123], a[148:151], v[144:147], a[120:123]
buffer_load_dwordx4 v[116:119], v2, s[12:15], s59 offen offset:1024 sc1
v_mfma_f32_16x16x32_bf16 a[12:15], a[152:155], v[128:131], a[12:15]
ds_read_b128 a[184:187], v5 offset:54272
v_mfma_f32_16x16x32_bf16 a[40:43], a[152:155], v[132:135], a[40:43]
v_mfma_f32_16x16x32_bf16 a[68:71], a[152:155], v[136:139], a[68:71]
v_mfma_f32_16x16x32_bf16 a[96:99], a[152:155], v[140:143], a[96:99]
ds_read_b128 a[188:191], v5 offset:55296
v_mfma_f32_16x16x32_bf16 a[124:127], a[152:155], v[144:147], a[124:127]
v_mfma_f32_16x16x32_bf16 a[16:19], a[156:159], v[128:131], a[16:19]
buffer_load_dwordx4 v[120:123], v3, s[12:15], s59 offen offset:1024 sc1
v_mfma_f32_16x16x32_bf16 a[44:47], a[156:159], v[132:135], a[44:47]
v_mfma_f32_16x16x32_bf16 a[72:75], a[156:159], v[136:139], a[72:75]
ds_read_b128 a[192:195], v5 offset:56320
v_mfma_f32_16x16x32_bf16 a[100:103], a[156:159], v[140:143], a[100:103]
v_mfma_f32_16x16x32_bf16 a[128:131], a[156:159], v[144:147], a[128:131]
v_mfma_f32_16x16x32_bf16 a[20:23], a[160:163], v[128:131], a[20:23]
v_mfma_f32_16x16x32_bf16 a[48:51], a[160:163], v[132:135], a[48:51]
buffer_load_dwordx4 v[124:127], v4, s[12:15], s59 offen offset:1024 sc1
v_mfma_f32_16x16x32_bf16 a[76:79], a[160:163], v[136:139], a[76:79]
v_mfma_f32_16x16x32_bf16 a[104:107], a[160:163], v[140:143], a[104:107]
v_mfma_f32_16x16x32_bf16 a[132:135], a[160:163], v[144:147], a[132:135]
v_mfma_f32_16x16x32_bf16 a[24:27], a[164:167], v[128:131], a[24:27]
v_mfma_f32_16x16x32_bf16 a[52:55], a[164:167], v[132:135], a[52:55]
v_mfma_f32_16x16x32_bf16 a[80:83], a[164:167], v[136:139], a[80:83]
v_mfma_f32_16x16x32_bf16 a[108:111], a[164:167], v[140:143], a[108:111]
v_mfma_f32_16x16x32_bf16 a[136:139], a[164:167], v[144:147], a[136:139]
s_waitcnt lgkmcnt(0)
v_mfma_f32_16x16x32_bf16 a[0:3], a[168:171], v[148:151], a[0:3]
s_add_u32 s59, s52, 4096
v_mfma_f32_16x16x32_bf16 a[28:31], a[168:171], v[152:155], a[28:31]
ds_read_b128 a[140:143], v7 offset:0
v_mfma_f32_16x16x32_bf16 a[56:59], a[168:171], v[156:159], a[56:59]
buffer_load_dwordx4 v[128:131], v0, s[12:15], s59 offen offset:2048 sc1
v_mfma_f32_16x16x32_bf16 a[84:87], a[168:171], v[160:163], a[84:87]
v_mfma_f32_16x16x32_bf16 a[112:115], a[168:171], v[164:167], a[112:115]
ds_read_b128 a[144:147], v7 offset:1024
v_mfma_f32_16x16x32_bf16 a[4:7], a[172:175], v[148:151], a[4:7]
v_mfma_f32_16x16x32_bf16 a[32:35], a[172:175], v[152:155], a[32:35]
v_mfma_f32_16x16x32_bf16 a[60:63], a[172:175], v[156:159], a[60:63]
v_mfma_f32_16x16x32_bf16 a[88:91], a[172:175], v[160:163], a[88:91]
ds_read_b128 a[148:151], v7 offset:2048
buffer_load_dwordx4 v[132:135], v1, s[12:15], s59 offen offset:2048 sc1
v_mfma_f32_16x16x32_bf16 a[116:119], a[172:175], v[164:167], a[116:119]
v_mfma_f32_16x16x32_bf16 a[8:11], a[176:179], v[148:151], a[8:11]
v_mfma_f32_16x16x32_bf16 a[36:39], a[176:179], v[152:155], a[36:39]
ds_read_b128 a[152:155], v7 offset:3072
v_mfma_f32_16x16x32_bf16 a[64:67], a[176:179], v[156:159], a[64:67]
v_mfma_f32_16x16x32_bf16 a[92:95], a[176:179], v[160:163], a[92:95]
v_mfma_f32_16x16x32_bf16 a[120:123], a[176:179], v[164:167], a[120:123]
buffer_load_dwordx4 v[136:139], v2, s[12:15], s59 offen offset:2048 sc1
v_mfma_f32_16x16x32_bf16 a[12:15], a[180:183], v[148:151], a[12:15]
ds_read_b128 a[156:159], v7 offset:4096
v_mfma_f32_16x16x32_bf16 a[40:43], a[180:183], v[152:155], a[40:43]
v_mfma_f32_16x16x32_bf16 a[68:71], a[180:183], v[156:159], a[68:71]
v_mfma_f32_16x16x32_bf16 a[96:99], a[180:183], v[160:163], a[96:99]
ds_read_b128 a[160:163], v7 offset:5120
v_mfma_f32_16x16x32_bf16 a[124:127], a[180:183], v[164:167], a[124:127]
v_mfma_f32_16x16x32_bf16 a[16:19], a[184:187], v[148:151], a[16:19]
buffer_load_dwordx4 v[140:143], v3, s[12:15], s59 offen offset:2048 sc1
v_mfma_f32_16x16x32_bf16 a[44:47], a[184:187], v[152:155], a[44:47]
v_mfma_f32_16x16x32_bf16 a[72:75], a[184:187], v[156:159], a[72:75]
ds_read_b128 a[164:167], v7 offset:6144
v_mfma_f32_16x16x32_bf16 a[100:103], a[184:187], v[160:163], a[100:103]
v_mfma_f32_16x16x32_bf16 a[128:131], a[184:187], v[164:167], a[128:131]
v_mfma_f32_16x16x32_bf16 a[20:23], a[188:191], v[148:151], a[20:23]
v_mfma_f32_16x16x32_bf16 a[48:51], a[188:191], v[152:155], a[48:51]
buffer_load_dwordx4 v[144:147], v4, s[12:15], s59 offen offset:2048 sc1
v_mfma_f32_16x16x32_bf16 a[76:79], a[188:191], v[156:159], a[76:79]
v_mfma_f32_16x16x32_bf16 a[104:107], a[188:191], v[160:163], a[104:107]
v_mfma_f32_16x16x32_bf16 a[132:135], a[188:191], v[164:167], a[132:135]
v_mfma_f32_16x16x32_bf16 a[24:27], a[192:195], v[148:151], a[24:27]
v_mfma_f32_16x16x32_bf16 a[52:55], a[192:195], v[152:155], a[52:55]
v_mfma_f32_16x16x32_bf16 a[80:83], a[192:195], v[156:159], a[80:83]
v_mfma_f32_16x16x32_bf16 a[108:111], a[192:195], v[160:163], a[108:111]
v_mfma_f32_16x16x32_bf16 a[136:139], a[192:195], v[164:167], a[136:139]
s_waitcnt vmcnt(30) lgkmcnt(0)
v_mfma_f32_16x16x32_bf16 a[0:3], a[140:143], v[8:11], a[0:3]
s_barrier
s_add_u32 s59, s52, 4096
v_mfma_f32_16x16x32_bf16 a[28:31], a[140:143], v[12:15], a[28:31]
ds_read_b128 a[168:171], v7 offset:7168
v_mfma_f32_16x16x32_bf16 a[56:59], a[140:143], v[16:19], a[56:59]
buffer_load_dwordx4 v[148:151], v0, s[12:15], s59 offen offset:3072 sc1
v_mfma_f32_16x16x32_bf16 a[84:87], a[140:143], v[20:23], a[84:87]
v_mfma_f32_16x16x32_bf16 a[112:115], a[140:143], v[24:27], a[112:115]
ds_read_b128 a[172:175], v7 offset:8192
v_mfma_f32_16x16x32_bf16 a[4:7], a[144:147], v[8:11], a[4:7]
buffer_load_dwordx4 v[152:155], v1, s[12:15], s59 offen offset:3072 sc1
v_mfma_f32_16x16x32_bf16 a[32:35], a[144:147], v[12:15], a[32:35]
v_mfma_f32_16x16x32_bf16 a[60:63], a[144:147], v[16:19], a[60:63]
v_mfma_f32_16x16x32_bf16 a[88:91], a[144:147], v[20:23], a[88:91]
ds_read_b128 a[176:179], v7 offset:9216
buffer_load_dwordx4 v[156:159], v2, s[12:15], s59 offen offset:3072 sc1
v_mfma_f32_16x16x32_bf16 a[116:119], a[144:147], v[24:27], a[116:119]
v_mfma_f32_16x16x32_bf16 a[8:11], a[148:151], v[8:11], a[8:11]
v_mfma_f32_16x16x32_bf16 a[36:39], a[148:151], v[12:15], a[36:39]
ds_read_b128 a[180:183], v7 offset:10240
v_mfma_f32_16x16x32_bf16 a[64:67], a[148:151], v[16:19], a[64:67]
buffer_load_dwordx4 v[160:163], v3, s[12:15], s59 offen offset:3072 sc1
v_mfma_f32_16x16x32_bf16 a[92:95], a[148:151], v[20:23], a[92:95]
v_mfma_f32_16x16x32_bf16 a[120:123], a[148:151], v[24:27], a[120:123]
v_mfma_f32_16x16x32_bf16 a[12:15], a[152:155], v[8:11], a[12:15]
ds_read_b128 a[184:187], v7 offset:11264
buffer_load_dwordx4 v[164:167], v4, s[12:15], s59 offen offset:3072 sc1
v_mfma_f32_16x16x32_bf16 a[40:43], a[152:155], v[12:15], a[40:43]
v_mfma_f32_16x16x32_bf16 a[68:71], a[152:155], v[16:19], a[68:71]
s_add_u32 m0, s63, 0
s_add_u32 s58, s57, 0
v_mfma_f32_16x16x32_bf16 a[96:99], a[152:155], v[20:23], a[96:99]
ds_read_b128 a[188:191], v7 offset:12288
v_mfma_f32_16x16x32_bf16 a[124:127], a[152:155], v[24:27], a[124:127]
buffer_load_dwordx4 v6, s[16:19], s58 offen offset:0 sc1 lds
v_mfma_f32_16x16x32_bf16 a[16:19], a[156:159], v[8:11], a[16:19]
v_mfma_f32_16x16x32_bf16 a[44:47], a[156:159], v[12:15], a[44:47]
v_mfma_f32_16x16x32_bf16 a[72:75], a[156:159], v[16:19], a[72:75]
ds_read_b128 a[192:195], v7 offset:13312
buffer_load_dwordx4 v6, s[16:19], s58 offen offset:1024 sc1 lds
v_mfma_f32_16x16x32_bf16 a[100:103], a[156:159], v[20:23], a[100:103]
v_mfma_f32_16x16x32_bf16 a[128:131], a[156:159], v[24:27], a[128:131]
v_mfma_f32_16x16x32_bf16 a[20:23], a[160:163], v[8:11], a[20:23]
v_mfma_f32_16x16x32_bf16 a[48:51], a[160:163], v[12:15], a[48:51]
buffer_load_dwordx4 v6, s[16:19], s58 offen offset:2048 sc1 lds
v_mfma_f32_16x16x32_bf16 a[76:79], a[160:163], v[16:19], a[76:79]
v_mfma_f32_16x16x32_bf16 a[104:107], a[160:163], v[20:23], a[104:107]
v_mfma_f32_16x16x32_bf16 a[132:135], a[160:163], v[24:27], a[132:135]
buffer_load_dwordx4 v6, s[16:19], s58 offen offset:3072 sc1 lds
v_mfma_f32_16x16x32_bf16 a[24:27], a[164:167], v[8:11], a[24:27]
v_mfma_f32_16x16x32_bf16 a[52:55], a[164:167], v[12:15], a[52:55]
v_mfma_f32_16x16x32_bf16 a[80:83], a[164:167], v[16:19], a[80:83]
v_mfma_f32_16x16x32_bf16 a[108:111], a[164:167], v[20:23], a[108:111]
v_mfma_f32_16x16x32_bf16 a[136:139], a[164:167], v[24:27], a[136:139]
s_waitcnt vmcnt(34) lgkmcnt(0)
v_mfma_f32_16x16x32_bf16 a[0:3], a[168:171], v[28:31], a[0:3]
v_mfma_f32_16x16x32_bf16 a[28:31], a[168:171], v[32:35], a[28:31]
ds_read_b128 a[140:143], v7 offset:14336
v_mfma_f32_16x16x32_bf16 a[56:59], a[168:171], v[36:39], a[56:59]
buffer_load_dwordx4 v[8:11], v0, s[12:15], s53 offen offset:0 sc1
v_mfma_f32_16x16x32_bf16 a[84:87], a[168:171], v[40:43], a[84:87]
v_mfma_f32_16x16x32_bf16 a[112:115], a[168:171], v[44:47], a[112:115]
ds_read_b128 a[144:147], v7 offset:15360
v_mfma_f32_16x16x32_bf16 a[4:7], a[172:175], v[28:31], a[4:7]
buffer_load_dwordx4 v[12:15], v1, s[12:15], s53 offen offset:0 sc1
v_mfma_f32_16x16x32_bf16 a[32:35], a[172:175], v[32:35], a[32:35]
v_mfma_f32_16x16x32_bf16 a[60:63], a[172:175], v[36:39], a[60:63]
v_mfma_f32_16x16x32_bf16 a[88:91], a[172:175], v[40:43], a[88:91]
ds_read_b128 a[148:151], v7 offset:16384
v_mfma_f32_16x16x32_bf16 a[116:119], a[172:175], v[44:47], a[116:119]
buffer_load_dwordx4 v[16:19], v2, s[12:15], s53 offen offset:0 sc1
v_mfma_f32_16x16x32_bf16 a[8:11], a[176:179], v[28:31], a[8:11]
v_mfma_f32_16x16x32_bf16 a[36:39], a[176:179], v[32:35], a[36:39]
ds_read_b128 a[152:155], v7 offset:17408
v_mfma_f32_16x16x32_bf16 a[64:67], a[176:179], v[36:39], a[64:67]
v_mfma_f32_16x16x32_bf16 a[92:95], a[176:179], v[40:43], a[92:95]
buffer_load_dwordx4 v[20:23], v3, s[12:15], s53 offen offset:0 sc1
v_mfma_f32_16x16x32_bf16 a[120:123], a[176:179], v[44:47], a[120:123]
v_mfma_f32_16x16x32_bf16 a[12:15], a[180:183], v[28:31], a[12:15]
ds_read_b128 a[156:159], v7 offset:18432
v_mfma_f32_16x16x32_bf16 a[40:43], a[180:183], v[32:35], a[40:43]
v_mfma_f32_16x16x32_bf16 a[68:71], a[180:183], v[36:39], a[68:71]
buffer_load_dwordx4 v[24:27], v4, s[12:15], s53 offen offset:0 sc1
v_mfma_f32_16x16x32_bf16 a[96:99], a[180:183], v[40:43], a[96:99]
ds_read_b128 a[160:163], v7 offset:19456
v_mfma_f32_16x16x32_bf16 a[124:127], a[180:183], v[44:47], a[124:127]
s_add_u32 m0, s63, 4096
s_add_u32 s58, s57, 4096
v_mfma_f32_16x16x32_bf16 a[16:19], a[184:187], v[28:31], a[16:19]
v_mfma_f32_16x16x32_bf16 a[44:47], a[184:187], v[32:35], a[44:47]
buffer_load_dwordx4 v6, s[16:19], s58 offen offset:0 sc1 lds
v_mfma_f32_16x16x32_bf16 a[72:75], a[184:187], v[36:39], a[72:75]
ds_read_b128 a[164:167], v7 offset:20480
v_mfma_f32_16x16x32_bf16 a[100:103], a[184:187], v[40:43], a[100:103]
v_mfma_f32_16x16x32_bf16 a[128:131], a[184:187], v[44:47], a[128:131]
v_mfma_f32_16x16x32_bf16 a[20:23], a[188:191], v[28:31], a[20:23]
buffer_load_dwordx4 v6, s[16:19], s58 offen offset:1024 sc1 lds
v_mfma_f32_16x16x32_bf16 a[48:51], a[188:191], v[32:35], a[48:51]
v_mfma_f32_16x16x32_bf16 a[76:79], a[188:191], v[36:39], a[76:79]
v_mfma_f32_16x16x32_bf16 a[104:107], a[188:191], v[40:43], a[104:107]
v_mfma_f32_16x16x32_bf16 a[132:135], a[188:191], v[44:47], a[132:135]
buffer_load_dwordx4 v6, s[16:19], s58 offen offset:2048 sc1 lds
v_mfma_f32_16x16x32_bf16 a[24:27], a[192:195], v[28:31], a[24:27]
v_mfma_f32_16x16x32_bf16 a[52:55], a[192:195], v[32:35], a[52:55]
v_mfma_f32_16x16x32_bf16 a[80:83], a[192:195], v[36:39], a[80:83]
v_mfma_f32_16x16x32_bf16 a[108:111], a[192:195], v[40:43], a[108:111]
v_mfma_f32_16x16x32_bf16 a[136:139], a[192:195], v[44:47], a[136:139]
s_waitcnt vmcnt(37) lgkmcnt(0)
v_mfma_f32_16x16x32_bf16 a[0:3], a[140:143], v[48:51], a[0:3]
v_mfma_f32_16x16x32_bf16 a[28:31], a[140:143], v[52:55], a[28:31]
ds_read_b128 a[168:171], v7 offset:21504
v_mfma_f32_16x16x32_bf16 a[56:59], a[140:143], v[56:59], a[56:59]
buffer_load_dwordx4 v[28:31], v0, s[12:15], s53 offen offset:1024 sc1
v_mfma_f32_16x16x32_bf16 a[84:87], a[140:143], v[60:63], a[84:87]
v_mfma_f32_16x16x32_bf16 a[112:115], a[140:143], v[64:67], a[112:115]
ds_read_b128 a[172:175], v7 offset:22528
v_mfma_f32_16x16x32_bf16 a[4:7], a[144:147], v[48:51], a[4:7]
buffer_load_dwordx4 v[32:35], v1, s[12:15], s53 offen offset:1024 sc1
v_mfma_f32_16x16x32_bf16 a[32:35], a[144:147], v[52:55], a[32:35]
v_mfma_f32_16x16x32_bf16 a[60:63], a[144:147], v[56:59], a[60:63]
v_mfma_f32_16x16x32_bf16 a[88:91], a[144:147], v[60:63], a[88:91]
ds_read_b128 a[176:179], v7 offset:23552
buffer_load_dwordx4 v[36:39], v2, s[12:15], s53 offen offset:1024 sc1
v_mfma_f32_16x16x32_bf16 a[116:119], a[144:147], v[64:67], a[116:119]
v_mfma_f32_16x16x32_bf16 a[8:11], a[148:151], v[48:51], a[8:11]
v_mfma_f32_16x16x32_bf16 a[36:39], a[148:151], v[52:55], a[36:39]
ds_read_b128 a[180:183], v7 offset:24576
v_mfma_f32_16x16x32_bf16 a[64:67], a[148:151], v[56:59], a[64:67]
buffer_load_dwordx4 v[40:43], v3, s[12:15], s53 offen offset:1024 sc1
v_mfma_f32_16x16x32_bf16 a[92:95], a[148:151], v[60:63], a[92:95]
v_mfma_f32_16x16x32_bf16 a[120:123], a[148:151], v[64:67], a[120:123]
v_mfma_f32_16x16x32_bf16 a[12:15], a[152:155], v[48:51], a[12:15]
ds_read_b128 a[184:187], v7 offset:25600
buffer_load_dwordx4 v[44:47], v4, s[12:15], s53 offen offset:1024 sc1
v_mfma_f32_16x16x32_bf16 a[40:43], a[152:155], v[52:55], a[40:43]
v_mfma_f32_16x16x32_bf16 a[68:71], a[152:155], v[56:59], a[68:71]
s_add_u32 m0, s63, 28672
s_add_u32 s58, s57, 114688
v_mfma_f32_16x16x32_bf16 a[96:99], a[152:155], v[60:63], a[96:99]
ds_read_b128 a[188:191], v7 offset:26624
v_mfma_f32_16x16x32_bf16 a[124:127], a[152:155], v[64:67], a[124:127]
buffer_load_dwordx4 v6, s[16:19], s58 offen offset:0 sc1 lds
v_mfma_f32_16x16x32_bf16 a[16:19], a[156:159], v[48:51], a[16:19]
v_mfma_f32_16x16x32_bf16 a[44:47], a[156:159], v[52:55], a[44:47]
v_mfma_f32_16x16x32_bf16 a[72:75], a[156:159], v[56:59], a[72:75]
ds_read_b128 a[192:195], v7 offset:27648
buffer_load_dwordx4 v6, s[16:19], s58 offen offset:1024 sc1 lds
v_mfma_f32_16x16x32_bf16 a[100:103], a[156:159], v[60:63], a[100:103]
v_mfma_f32_16x16x32_bf16 a[128:131], a[156:159], v[64:67], a[128:131]
v_mfma_f32_16x16x32_bf16 a[20:23], a[160:163], v[48:51], a[20:23]
v_mfma_f32_16x16x32_bf16 a[48:51], a[160:163], v[52:55], a[48:51]
buffer_load_dwordx4 v6, s[16:19], s58 offen offset:2048 sc1 lds
v_mfma_f32_16x16x32_bf16 a[76:79], a[160:163], v[56:59], a[76:79]
v_mfma_f32_16x16x32_bf16 a[104:107], a[160:163], v[60:63], a[104:107]
v_mfma_f32_16x16x32_bf16 a[132:135], a[160:163], v[64:67], a[132:135]
buffer_load_dwordx4 v6, s[16:19], s58 offen offset:3072 sc1 lds
v_mfma_f32_16x16x32_bf16 a[24:27], a[164:167], v[48:51], a[24:27]
v_mfma_f32_16x16x32_bf16 a[52:55], a[164:167], v[52:55], a[52:55]
v_mfma_f32_16x16x32_bf16 a[80:83], a[164:167], v[56:59], a[80:83]
v_mfma_f32_16x16x32_bf16 a[108:111], a[164:167], v[60:63], a[108:111]
v_mfma_f32_16x16x32_bf16 a[136:139], a[164:167], v[64:67], a[136:139]
s_waitcnt vmcnt(41) lgkmcnt(0)
v_mfma_f32_16x16x32_bf16 a[0:3], a[168:171], v[68:71], a[0:3]
v_mfma_f32_16x16x32_bf16 a[28:31], a[168:171], v[72:75], a[28:31]
ds_read_b128 a[140:143], v7 offset:28672
v_mfma_f32_16x16x32_bf16 a[56:59], a[168:171], v[76:79], a[56:59]
buffer_load_dwordx4 v[48:51], v0, s[12:15], s53 offen offset:2048 sc1
v_mfma_f32_16x16x32_bf16 a[84:87], a[168:171], v[80:83], a[84:87]
v_mfma_f32_16x16x32_bf16 a[112:115], a[168:171], v[84:87], a[112:115]
ds_read_b128 a[144:147], v7 offset:29696
v_mfma_f32_16x16x32_bf16 a[4:7], a[172:175], v[68:71], a[4:7]
buffer_load_dwordx4 v[52:55], v1, s[12:15], s53 offen offset:2048 sc1
v_mfma_f32_16x16x32_bf16 a[32:35], a[172:175], v[72:75], a[32:35]
v_mfma_f32_16x16x32_bf16 a[60:63], a[172:175], v[76:79], a[60:63]
v_mfma_f32_16x16x32_bf16 a[88:91], a[172:175], v[80:83], a[88:91]
ds_read_b128 a[148:151], v7 offset:30720
v_mfma_f32_16x16x32_bf16 a[116:119], a[172:175], v[84:87], a[116:119]
buffer_load_dwordx4 v[56:59], v2, s[12:15], s53 offen offset:2048 sc1
v_mfma_f32_16x16x32_bf16 a[8:11], a[176:179], v[68:71], a[8:11]
v_mfma_f32_16x16x32_bf16 a[36:39], a[176:179], v[72:75], a[36:39]
ds_read_b128 a[152:155], v7 offset:31744
v_mfma_f32_16x16x32_bf16 a[64:67], a[176:179], v[76:79], a[64:67]
v_mfma_f32_16x16x32_bf16 a[92:95], a[176:179], v[80:83], a[92:95]
buffer_load_dwordx4 v[60:63], v3, s[12:15], s53 offen offset:2048 sc1
v_mfma_f32_16x16x32_bf16 a[120:123], a[176:179], v[84:87], a[120:123]
v_mfma_f32_16x16x32_bf16 a[12:15], a[180:183], v[68:71], a[12:15]
ds_read_b128 a[156:159], v7 offset:32768
v_mfma_f32_16x16x32_bf16 a[40:43], a[180:183], v[72:75], a[40:43]
v_mfma_f32_16x16x32_bf16 a[68:71], a[180:183], v[76:79], a[68:71]
buffer_load_dwordx4 v[64:67], v4, s[12:15], s53 offen offset:2048 sc1
v_mfma_f32_16x16x32_bf16 a[96:99], a[180:183], v[80:83], a[96:99]
ds_read_b128 a[160:163], v7 offset:33792
v_mfma_f32_16x16x32_bf16 a[124:127], a[180:183], v[84:87], a[124:127]
s_add_u32 m0, s63, 32768
s_add_u32 s58, s57, 118784
v_mfma_f32_16x16x32_bf16 a[16:19], a[184:187], v[68:71], a[16:19]
v_mfma_f32_16x16x32_bf16 a[44:47], a[184:187], v[72:75], a[44:47]
buffer_load_dwordx4 v6, s[16:19], s58 offen offset:0 sc1 lds
v_mfma_f32_16x16x32_bf16 a[72:75], a[184:187], v[76:79], a[72:75]
ds_read_b128 a[164:167], v7 offset:34816
v_mfma_f32_16x16x32_bf16 a[100:103], a[184:187], v[80:83], a[100:103]
v_mfma_f32_16x16x32_bf16 a[128:131], a[184:187], v[84:87], a[128:131]
v_mfma_f32_16x16x32_bf16 a[20:23], a[188:191], v[68:71], a[20:23]
buffer_load_dwordx4 v6, s[16:19], s58 offen offset:1024 sc1 lds
v_mfma_f32_16x16x32_bf16 a[48:51], a[188:191], v[72:75], a[48:51]
v_mfma_f32_16x16x32_bf16 a[76:79], a[188:191], v[76:79], a[76:79]
v_mfma_f32_16x16x32_bf16 a[104:107], a[188:191], v[80:83], a[104:107]
v_mfma_f32_16x16x32_bf16 a[132:135], a[188:191], v[84:87], a[132:135]
buffer_load_dwordx4 v6, s[16:19], s58 offen offset:2048 sc1 lds
v_mfma_f32_16x16x32_bf16 a[24:27], a[192:195], v[68:71], a[24:27]
v_mfma_f32_16x16x32_bf16 a[52:55], a[192:195], v[72:75], a[52:55]
v_mfma_f32_16x16x32_bf16 a[80:83], a[192:195], v[76:79], a[80:83]
v_mfma_f32_16x16x32_bf16 a[108:111], a[192:195], v[80:83], a[108:111]
v_mfma_f32_16x16x32_bf16 a[136:139], a[192:195], v[84:87], a[136:139]
s_waitcnt vmcnt(44) lgkmcnt(0)
v_mfma_f32_16x16x32_bf16 a[0:3], a[140:143], v[88:91], a[0:3]
v_mfma_f32_16x16x32_bf16 a[28:31], a[140:143], v[92:95], a[28:31]
ds_read_b128 a[168:171], v7 offset:35840
v_mfma_f32_16x16x32_bf16 a[56:59], a[140:143], v[96:99], a[56:59]
buffer_load_dwordx4 v[68:71], v0, s[12:15], s53 offen offset:3072 sc1
v_mfma_f32_16x16x32_bf16 a[84:87], a[140:143], v[100:103], a[84:87]
v_mfma_f32_16x16x32_bf16 a[112:115], a[140:143], v[104:107], a[112:115]
ds_read_b128 a[172:175], v7 offset:36864
v_mfma_f32_16x16x32_bf16 a[4:7], a[144:147], v[88:91], a[4:7]
v_mfma_f32_16x16x32_bf16 a[32:35], a[144:147], v[92:95], a[32:35]
v_mfma_f32_16x16x32_bf16 a[60:63], a[144:147], v[96:99], a[60:63]
v_mfma_f32_16x16x32_bf16 a[88:91], a[144:147], v[100:103], a[88:91]
ds_read_b128 a[176:179], v7 offset:37888
buffer_load_dwordx4 v[72:75], v1, s[12:15], s53 offen offset:3072 sc1
v_mfma_f32_16x16x32_bf16 a[116:119], a[144:147], v[104:107], a[116:119]
v_mfma_f32_16x16x32_bf16 a[8:11], a[148:151], v[88:91], a[8:11]
v_mfma_f32_16x16x32_bf16 a[36:39], a[148:151], v[92:95], a[36:39]
ds_read_b128 a[180:183], v7 offset:38912
v_mfma_f32_16x16x32_bf16 a[64:67], a[148:151], v[96:99], a[64:67]
v_mfma_f32_16x16x32_bf16 a[92:95], a[148:151], v[100:103], a[92:95]
v_mfma_f32_16x16x32_bf16 a[120:123], a[148:151], v[104:107], a[120:123]
buffer_load_dwordx4 v[76:79], v2, s[12:15], s53 offen offset:3072 sc1
v_mfma_f32_16x16x32_bf16 a[12:15], a[152:155], v[88:91], a[12:15]
ds_read_b128 a[184:187], v7 offset:39936
v_mfma_f32_16x16x32_bf16 a[40:43], a[152:155], v[92:95], a[40:43]
v_mfma_f32_16x16x32_bf16 a[68:71], a[152:155], v[96:99], a[68:71]
v_mfma_f32_16x16x32_bf16 a[96:99], a[152:155], v[100:103], a[96:99]
ds_read_b128 a[188:191], v7 offset:40960
v_mfma_f32_16x16x32_bf16 a[124:127], a[152:155], v[104:107], a[124:127]
v_mfma_f32_16x16x32_bf16 a[16:19], a[156:159], v[88:91], a[16:19]
buffer_load_dwordx4 v[80:83], v3, s[12:15], s53 offen offset:3072 sc1
v_mfma_f32_16x16x32_bf16 a[44:47], a[156:159], v[92:95], a[44:47]
v_mfma_f32_16x16x32_bf16 a[72:75], a[156:159], v[96:99], a[72:75]
ds_read_b128 a[192:195], v7 offset:41984
v_mfma_f32_16x16x32_bf16 a[100:103], a[156:159], v[100:103], a[100:103]
v_mfma_f32_16x16x32_bf16 a[128:131], a[156:159], v[104:107], a[128:131]
v_mfma_f32_16x16x32_bf16 a[20:23], a[160:163], v[88:91], a[20:23]
v_mfma_f32_16x16x32_bf16 a[48:51], a[160:163], v[92:95], a[48:51]
buffer_load_dwordx4 v[84:87], v4, s[12:15], s53 offen offset:3072 sc1
v_mfma_f32_16x16x32_bf16 a[76:79], a[160:163], v[96:99], a[76:79]
v_mfma_f32_16x16x32_bf16 a[104:107], a[160:163], v[100:103], a[104:107]
v_mfma_f32_16x16x32_bf16 a[132:135], a[160:163], v[104:107], a[132:135]
v_mfma_f32_16x16x32_bf16 a[24:27], a[164:167], v[88:91], a[24:27]
v_mfma_f32_16x16x32_bf16 a[52:55], a[164:167], v[92:95], a[52:55]
v_mfma_f32_16x16x32_bf16 a[80:83], a[164:167], v[96:99], a[80:83]
v_mfma_f32_16x16x32_bf16 a[108:111], a[164:167], v[100:103], a[108:111]
v_mfma_f32_16x16x32_bf16 a[136:139], a[164:167], v[104:107], a[136:139]
s_waitcnt vmcnt(44) lgkmcnt(0)
v_mfma_f32_16x16x32_bf16 a[0:3], a[168:171], v[108:111], a[0:3]
s_add_u32 s59, s53, 4096
v_mfma_f32_16x16x32_bf16 a[28:31], a[168:171], v[112:115], a[28:31]
ds_read_b128 a[140:143], v7 offset:43008
v_mfma_f32_16x16x32_bf16 a[56:59], a[168:171], v[116:119], a[56:59]
buffer_load_dwordx4 v[88:91], v0, s[12:15], s59 offen offset:0 sc1
v_mfma_f32_16x16x32_bf16 a[84:87], a[168:171], v[120:123], a[84:87]
v_mfma_f32_16x16x32_bf16 a[112:115], a[168:171], v[124:127], a[112:115]
ds_read_b128 a[144:147], v7 offset:44032
v_mfma_f32_16x16x32_bf16 a[4:7], a[172:175], v[108:111], a[4:7]
v_mfma_f32_16x16x32_bf16 a[32:35], a[172:175], v[112:115], a[32:35]
v_mfma_f32_16x16x32_bf16 a[60:63], a[172:175], v[116:119], a[60:63]
v_mfma_f32_16x16x32_bf16 a[88:91], a[172:175], v[120:123], a[88:91]
ds_read_b128 a[148:151], v7 offset:45056
buffer_load_dwordx4 v[92:95], v1, s[12:15], s59 offen offset:0 sc1
v_mfma_f32_16x16x32_bf16 a[116:119], a[172:175], v[124:127], a[116:119]
v_mfma_f32_16x16x32_bf16 a[8:11], a[176:179], v[108:111], a[8:11]
v_mfma_f32_16x16x32_bf16 a[36:39], a[176:179], v[112:115], a[36:39]
ds_read_b128 a[152:155], v7 offset:46080
v_mfma_f32_16x16x32_bf16 a[64:67], a[176:179], v[116:119], a[64:67]
v_mfma_f32_16x16x32_bf16 a[92:95], a[176:179], v[120:123], a[92:95]
v_mfma_f32_16x16x32_bf16 a[120:123], a[176:179], v[124:127], a[120:123]
buffer_load_dwordx4 v[96:99], v2, s[12:15], s59 offen offset:0 sc1
v_mfma_f32_16x16x32_bf16 a[12:15], a[180:183], v[108:111], a[12:15]
ds_read_b128 a[156:159], v7 offset:47104
v_mfma_f32_16x16x32_bf16 a[40:43], a[180:183], v[112:115], a[40:43]
v_mfma_f32_16x16x32_bf16 a[68:71], a[180:183], v[116:119], a[68:71]
v_mfma_f32_16x16x32_bf16 a[96:99], a[180:183], v[120:123], a[96:99]
ds_read_b128 a[160:163], v7 offset:48128
v_mfma_f32_16x16x32_bf16 a[124:127], a[180:183], v[124:127], a[124:127]
v_mfma_f32_16x16x32_bf16 a[16:19], a[184:187], v[108:111], a[16:19]
buffer_load_dwordx4 v[100:103], v3, s[12:15], s59 offen offset:0 sc1
v_mfma_f32_16x16x32_bf16 a[44:47], a[184:187], v[112:115], a[44:47]
v_mfma_f32_16x16x32_bf16 a[72:75], a[184:187], v[116:119], a[72:75]
ds_read_b128 a[164:167], v7 offset:49152
v_mfma_f32_16x16x32_bf16 a[100:103], a[184:187], v[120:123], a[100:103]
v_mfma_f32_16x16x32_bf16 a[128:131], a[184:187], v[124:127], a[128:131]
v_mfma_f32_16x16x32_bf16 a[20:23], a[188:191], v[108:111], a[20:23]
v_mfma_f32_16x16x32_bf16 a[48:51], a[188:191], v[112:115], a[48:51]
buffer_load_dwordx4 v[104:107], v4, s[12:15], s59 offen offset:0 sc1
v_mfma_f32_16x16x32_bf16 a[76:79], a[188:191], v[116:119], a[76:79]
v_mfma_f32_16x16x32_bf16 a[104:107], a[188:191], v[120:123], a[104:107]
v_mfma_f32_16x16x32_bf16 a[132:135], a[188:191], v[124:127], a[132:135]
v_mfma_f32_16x16x32_bf16 a[24:27], a[192:195], v[108:111], a[24:27]
v_mfma_f32_16x16x32_bf16 a[52:55], a[192:195], v[112:115], a[52:55]
v_mfma_f32_16x16x32_bf16 a[80:83], a[192:195], v[116:119], a[80:83]
v_mfma_f32_16x16x32_bf16 a[108:111], a[192:195], v[120:123], a[108:111]
v_mfma_f32_16x16x32_bf16 a[136:139], a[192:195], v[124:127], a[136:139]
s_waitcnt vmcnt(44) lgkmcnt(0)
v_mfma_f32_16x16x32_bf16 a[0:3], a[140:143], v[128:131], a[0:3]
s_add_u32 s59, s53, 4096
v_mfma_f32_16x16x32_bf16 a[28:31], a[140:143], v[132:135], a[28:31]
ds_read_b128 a[168:171], v7 offset:50176
v_mfma_f32_16x16x32_bf16 a[56:59], a[140:143], v[136:139], a[56:59]
buffer_load_dwordx4 v[108:111], v0, s[12:15], s59 offen offset:1024 sc1
v_mfma_f32_16x16x32_bf16 a[84:87], a[140:143], v[140:143], a[84:87]
v_mfma_f32_16x16x32_bf16 a[112:115], a[140:143], v[144:147], a[112:115]
ds_read_b128 a[172:175], v7 offset:51200
v_mfma_f32_16x16x32_bf16 a[4:7], a[144:147], v[128:131], a[4:7]
v_mfma_f32_16x16x32_bf16 a[32:35], a[144:147], v[132:135], a[32:35]
v_mfma_f32_16x16x32_bf16 a[60:63], a[144:147], v[136:139], a[60:63]
v_mfma_f32_16x16x32_bf16 a[88:91], a[144:147], v[140:143], a[88:91]
ds_read_b128 a[176:179], v7 offset:52224
buffer_load_dwordx4 v[112:115], v1, s[12:15], s59 offen offset:1024 sc1
v_mfma_f32_16x16x32_bf16 a[116:119], a[144:147], v[144:147], a[116:119]
v_mfma_f32_16x16x32_bf16 a[8:11], a[148:151], v[128:131], a[8:11]
v_mfma_f32_16x16x32_bf16 a[36:39], a[148:151], v[132:135], a[36:39]
ds_read_b128 a[180:183], v7 offset:53248
v_mfma_f32_16x16x32_bf16 a[64:67], a[148:151], v[136:139], a[64:67]
v_mfma_f32_16x16x32_bf16 a[92:95], a[148:151], v[140:143], a[92:95]
v_mfma_f32_16x16x32_bf16 a[120:123], a[148:151], v[144:147], a[120:123]
buffer_load_dwordx4 v[116:119], v2, s[12:15], s59 offen offset:1024 sc1
v_mfma_f32_16x16x32_bf16 a[12:15], a[152:155], v[128:131], a[12:15]
ds_read_b128 a[184:187], v7 offset:54272
v_mfma_f32_16x16x32_bf16 a[40:43], a[152:155], v[132:135], a[40:43]
v_mfma_f32_16x16x32_bf16 a[68:71], a[152:155], v[136:139], a[68:71]
v_mfma_f32_16x16x32_bf16 a[96:99], a[152:155], v[140:143], a[96:99]
ds_read_b128 a[188:191], v7 offset:55296
v_mfma_f32_16x16x32_bf16 a[124:127], a[152:155], v[144:147], a[124:127]
v_mfma_f32_16x16x32_bf16 a[16:19], a[156:159], v[128:131], a[16:19]
buffer_load_dwordx4 v[120:123], v3, s[12:15], s59 offen offset:1024 sc1
v_mfma_f32_16x16x32_bf16 a[44:47], a[156:159], v[132:135], a[44:47]
v_mfma_f32_16x16x32_bf16 a[72:75], a[156:159], v[136:139], a[72:75]
ds_read_b128 a[192:195], v7 offset:56320
v_mfma_f32_16x16x32_bf16 a[100:103], a[156:159], v[140:143], a[100:103]
v_mfma_f32_16x16x32_bf16 a[128:131], a[156:159], v[144:147], a[128:131]
v_mfma_f32_16x16x32_bf16 a[20:23], a[160:163], v[128:131], a[20:23]
v_mfma_f32_16x16x32_bf16 a[48:51], a[160:163], v[132:135], a[48:51]
buffer_load_dwordx4 v[124:127], v4, s[12:15], s59 offen offset:1024 sc1
v_mfma_f32_16x16x32_bf16 a[76:79], a[160:163], v[136:139], a[76:79]
v_mfma_f32_16x16x32_bf16 a[104:107], a[160:163], v[140:143], a[104:107]
v_mfma_f32_16x16x32_bf16 a[132:135], a[160:163], v[144:147], a[132:135]
v_mfma_f32_16x16x32_bf16 a[24:27], a[164:167], v[128:131], a[24:27]
v_mfma_f32_16x16x32_bf16 a[52:55], a[164:167], v[132:135], a[52:55]
v_mfma_f32_16x16x32_bf16 a[80:83], a[164:167], v[136:139], a[80:83]
v_mfma_f32_16x16x32_bf16 a[108:111], a[164:167], v[140:143], a[108:111]
v_mfma_f32_16x16x32_bf16 a[136:139], a[164:167], v[144:147], a[136:139]
s_waitcnt vmcnt(44) lgkmcnt(0)
v_mfma_f32_16x16x32_bf16 a[0:3], a[168:171], v[148:151], a[0:3]
s_waitcnt vmcnt(15)
s_barrier
v_mfma_f32_16x16x32_bf16 a[28:31], a[168:171], v[152:155], a[28:31]
ds_read_b128 a[140:143], v5 offset:0
s_add_u32 s59, s53, 4096
v_mfma_f32_16x16x32_bf16 a[56:59], a[168:171], v[156:159], a[56:59]
buffer_load_dwordx4 v[128:131], v0, s[12:15], s59 offen offset:2048 sc1
v_mfma_f32_16x16x32_bf16 a[84:87], a[168:171], v[160:163], a[84:87]
v_mfma_f32_16x16x32_bf16 a[112:115], a[168:171], v[164:167], a[112:115]
ds_read_b128 a[144:147], v5 offset:1024
v_mfma_f32_16x16x32_bf16 a[4:7], a[172:175], v[148:151], a[4:7]
buffer_load_dwordx4 v[132:135], v1, s[12:15], s59 offen offset:2048 sc1
v_mfma_f32_16x16x32_bf16 a[32:35], a[172:175], v[152:155], a[32:35]
v_mfma_f32_16x16x32_bf16 a[60:63], a[172:175], v[156:159], a[60:63]
v_mfma_f32_16x16x32_bf16 a[88:91], a[172:175], v[160:163], a[88:91]
ds_read_b128 a[148:151], v5 offset:2048
buffer_load_dwordx4 v[136:139], v2, s[12:15], s59 offen offset:2048 sc1
v_mfma_f32_16x16x32_bf16 a[116:119], a[172:175], v[164:167], a[116:119]
v_mfma_f32_16x16x32_bf16 a[8:11], a[176:179], v[148:151], a[8:11]
v_mfma_f32_16x16x32_bf16 a[36:39], a[176:179], v[152:155], a[36:39]
ds_read_b128 a[152:155], v5 offset:3072
v_mfma_f32_16x16x32_bf16 a[64:67], a[176:179], v[156:159], a[64:67]
buffer_load_dwordx4 v[140:143], v3, s[12:15], s59 offen offset:2048 sc1
v_mfma_f32_16x16x32_bf16 a[92:95], a[176:179], v[160:163], a[92:95]
v_mfma_f32_16x16x32_bf16 a[120:123], a[176:179], v[164:167], a[120:123]
v_mfma_f32_16x16x32_bf16 a[12:15], a[180:183], v[148:151], a[12:15]
ds_read_b128 a[156:159], v5 offset:4096
buffer_load_dwordx4 v[144:147], v4, s[12:15], s59 offen offset:2048 sc1
v_mfma_f32_16x16x32_bf16 a[40:43], a[180:183], v[152:155], a[40:43]
v_mfma_f32_16x16x32_bf16 a[68:71], a[180:183], v[156:159], a[68:71]
s_add_u32 m0, s63, 57344
s_add_u32 s58, s62, 0
v_mfma_f32_16x16x32_bf16 a[96:99], a[180:183], v[160:163], a[96:99]
ds_read_b128 a[160:163], v5 offset:5120
v_mfma_f32_16x16x32_bf16 a[124:127], a[180:183], v[164:167], a[124:127]
buffer_load_dwordx4 v6, s[16:19], s58 offen offset:0 sc1 lds
v_mfma_f32_16x16x32_bf16 a[16:19], a[184:187], v[148:151], a[16:19]
v_mfma_f32_16x16x32_bf16 a[44:47], a[184:187], v[152:155], a[44:47]
v_mfma_f32_16x16x32_bf16 a[72:75], a[184:187], v[156:159], a[72:75]
ds_read_b128 a[164:167], v5 offset:6144
buffer_load_dwordx4 v6, s[16:19], s58 offen offset:1024 sc1 lds
v_mfma_f32_16x16x32_bf16 a[100:103], a[184:187], v[160:163], a[100:103]
v_mfma_f32_16x16x32_bf16 a[128:131], a[184:187], v[164:167], a[128:131]
v_mfma_f32_16x16x32_bf16 a[20:23], a[188:191], v[148:151], a[20:23]
v_mfma_f32_16x16x32_bf16 a[48:51], a[188:191], v[152:155], a[48:51]
buffer_load_dwordx4 v6, s[16:19], s58 offen offset:2048 sc1 lds
v_mfma_f32_16x16x32_bf16 a[76:79], a[188:191], v[156:159], a[76:79]
v_mfma_f32_16x16x32_bf16 a[104:107], a[188:191], v[160:163], a[104:107]
v_mfma_f32_16x16x32_bf16 a[132:135], a[188:191], v[164:167], a[132:135]
buffer_load_dwordx4 v6, s[16:19], s58 offen offset:3072 sc1 lds
v_mfma_f32_16x16x32_bf16 a[24:27], a[192:195], v[148:151], a[24:27]
v_mfma_f32_16x16x32_bf16 a[52:55], a[192:195], v[152:155], a[52:55]
v_mfma_f32_16x16x32_bf16 a[80:83], a[192:195], v[156:159], a[80:83]
v_mfma_f32_16x16x32_bf16 a[108:111], a[192:195], v[160:163], a[108:111]
v_mfma_f32_16x16x32_bf16 a[136:139], a[192:195], v[164:167], a[136:139]
s_waitcnt vmcnt(63) lgkmcnt(0)
v_mfma_f32_16x16x32_bf16 a[0:3], a[140:143], v[8:11], a[0:3]
s_add_u32 s59, s53, 4096
v_mfma_f32_16x16x32_bf16 a[28:31], a[140:143], v[12:15], a[28:31]
ds_read_b128 a[168:171], v5 offset:7168
v_mfma_f32_16x16x32_bf16 a[56:59], a[140:143], v[16:19], a[56:59]
buffer_load_dwordx4 v[148:151], v0, s[12:15], s59 offen offset:3072 sc1
v_mfma_f32_16x16x32_bf16 a[84:87], a[140:143], v[20:23], a[84:87]
v_mfma_f32_16x16x32_bf16 a[112:115], a[140:143], v[24:27], a[112:115]
ds_read_b128 a[172:175], v5 offset:8192
v_mfma_f32_16x16x32_bf16 a[4:7], a[144:147], v[8:11], a[4:7]
buffer_load_dwordx4 v[152:155], v1, s[12:15], s59 offen offset:3072 sc1
v_mfma_f32_16x16x32_bf16 a[32:35], a[144:147], v[12:15], a[32:35]
v_mfma_f32_16x16x32_bf16 a[60:63], a[144:147], v[16:19], a[60:63]
v_mfma_f32_16x16x32_bf16 a[88:91], a[144:147], v[20:23], a[88:91]
ds_read_b128 a[176:179], v5 offset:9216
v_mfma_f32_16x16x32_bf16 a[116:119], a[144:147], v[24:27], a[116:119]
buffer_load_dwordx4 v[156:159], v2, s[12:15], s59 offen offset:3072 sc1
v_mfma_f32_16x16x32_bf16 a[8:11], a[148:151], v[8:11], a[8:11]
v_mfma_f32_16x16x32_bf16 a[36:39], a[148:151], v[12:15], a[36:39]
ds_read_b128 a[180:183], v5 offset:10240
v_mfma_f32_16x16x32_bf16 a[64:67], a[148:151], v[16:19], a[64:67]
v_mfma_f32_16x16x32_bf16 a[92:95], a[148:151], v[20:23], a[92:95]
buffer_load_dwordx4 v[160:163], v3, s[12:15], s59 offen offset:3072 sc1
v_mfma_f32_16x16x32_bf16 a[120:123], a[148:151], v[24:27], a[120:123]
v_mfma_f32_16x16x32_bf16 a[12:15], a[152:155], v[8:11], a[12:15]
ds_read_b128 a[184:187], v5 offset:11264
v_mfma_f32_16x16x32_bf16 a[40:43], a[152:155], v[12:15], a[40:43]
v_mfma_f32_16x16x32_bf16 a[68:71], a[152:155], v[16:19], a[68:71]
buffer_load_dwordx4 v[164:167], v4, s[12:15], s59 offen offset:3072 sc1
v_mfma_f32_16x16x32_bf16 a[96:99], a[152:155], v[20:23], a[96:99]
ds_read_b128 a[188:191], v5 offset:12288
v_mfma_f32_16x16x32_bf16 a[124:127], a[152:155], v[24:27], a[124:127]
s_add_u32 m0, s63, 61440
s_add_u32 s58, s62, 4096
v_mfma_f32_16x16x32_bf16 a[16:19], a[156:159], v[8:11], a[16:19]
v_mfma_f32_16x16x32_bf16 a[44:47], a[156:159], v[12:15], a[44:47]
buffer_load_dwordx4 v6, s[16:19], s58 offen offset:0 sc1 lds
v_mfma_f32_16x16x32_bf16 a[72:75], a[156:159], v[16:19], a[72:75]
ds_read_b128 a[192:195], v5 offset:13312
v_mfma_f32_16x16x32_bf16 a[100:103], a[156:159], v[20:23], a[100:103]
v_mfma_f32_16x16x32_bf16 a[128:131], a[156:159], v[24:27], a[128:131]
v_mfma_f32_16x16x32_bf16 a[20:23], a[160:163], v[8:11], a[20:23]
buffer_load_dwordx4 v6, s[16:19], s58 offen offset:1024 sc1 lds
v_mfma_f32_16x16x32_bf16 a[48:51], a[160:163], v[12:15], a[48:51]
v_mfma_f32_16x16x32_bf16 a[76:79], a[160:163], v[16:19], a[76:79]
v_mfma_f32_16x16x32_bf16 a[104:107], a[160:163], v[20:23], a[104:107]
v_mfma_f32_16x16x32_bf16 a[132:135], a[160:163], v[24:27], a[132:135]
buffer_load_dwordx4 v6, s[16:19], s58 offen offset:2048 sc1 lds
v_mfma_f32_16x16x32_bf16 a[24:27], a[164:167], v[8:11], a[24:27]
v_mfma_f32_16x16x32_bf16 a[52:55], a[164:167], v[12:15], a[52:55]
v_mfma_f32_16x16x32_bf16 a[80:83], a[164:167], v[16:19], a[80:83]
v_mfma_f32_16x16x32_bf16 a[108:111], a[164:167], v[20:23], a[108:111]
v_mfma_f32_16x16x32_bf16 a[136:139], a[164:167], v[24:27], a[136:139]
s_waitcnt vmcnt(63) lgkmcnt(0)
v_mfma_f32_16x16x32_bf16 a[0:3], a[168:171], v[28:31], a[0:3]
v_mfma_f32_16x16x32_bf16 a[28:31], a[168:171], v[32:35], a[28:31]
ds_read_b128 a[140:143], v5 offset:14336
v_mfma_f32_16x16x32_bf16 a[56:59], a[168:171], v[36:39], a[56:59]
buffer_load_dwordx4 v[8:11], v0, s[12:15], s54 offen offset:0 sc1
v_mfma_f32_16x16x32_bf16 a[84:87], a[168:171], v[40:43], a[84:87]
v_mfma_f32_16x16x32_bf16 a[112:115], a[168:171], v[44:47], a[112:115]
ds_read_b128 a[144:147], v5 offset:15360
v_mfma_f32_16x16x32_bf16 a[4:7], a[172:175], v[28:31], a[4:7]
buffer_load_dwordx4 v[12:15], v1, s[12:15], s54 offen offset:0 sc1
v_mfma_f32_16x16x32_bf16 a[32:35], a[172:175], v[32:35], a[32:35]
v_mfma_f32_16x16x32_bf16 a[60:63], a[172:175], v[36:39], a[60:63]
v_mfma_f32_16x16x32_bf16 a[88:91], a[172:175], v[40:43], a[88:91]
ds_read_b128 a[148:151], v5 offset:16384
buffer_load_dwordx4 v[16:19], v2, s[12:15], s54 offen offset:0 sc1
v_mfma_f32_16x16x32_bf16 a[116:119], a[172:175], v[44:47], a[116:119]
v_mfma_f32_16x16x32_bf16 a[8:11], a[176:179], v[28:31], a[8:11]
v_mfma_f32_16x16x32_bf16 a[36:39], a[176:179], v[32:35], a[36:39]
ds_read_b128 a[152:155], v5 offset:17408
v_mfma_f32_16x16x32_bf16 a[64:67], a[176:179], v[36:39], a[64:67]
buffer_load_dwordx4 v[20:23], v3, s[12:15], s54 offen offset:0 sc1
v_mfma_f32_16x16x32_bf16 a[92:95], a[176:179], v[40:43], a[92:95]
v_mfma_f32_16x16x32_bf16 a[120:123], a[176:179], v[44:47], a[120:123]
v_mfma_f32_16x16x32_bf16 a[12:15], a[180:183], v[28:31], a[12:15]
ds_read_b128 a[156:159], v5 offset:18432
buffer_load_dwordx4 v[24:27], v4, s[12:15], s54 offen offset:0 sc1
v_mfma_f32_16x16x32_bf16 a[40:43], a[180:183], v[32:35], a[40:43]
v_mfma_f32_16x16x32_bf16 a[68:71], a[180:183], v[36:39], a[68:71]
s_add_u32 m0, s63, 86016
s_add_u32 s58, s62, 114688
v_mfma_f32_16x16x32_bf16 a[96:99], a[180:183], v[40:43], a[96:99]
ds_read_b128 a[160:163], v5 offset:19456
v_mfma_f32_16x16x32_bf16 a[124:127], a[180:183], v[44:47], a[124:127]
buffer_load_dwordx4 v6, s[16:19], s58 offen offset:0 sc1 lds
v_mfma_f32_16x16x32_bf16 a[16:19], a[184:187], v[28:31], a[16:19]
v_mfma_f32_16x16x32_bf16 a[44:47], a[184:187], v[32:35], a[44:47]
v_mfma_f32_16x16x32_bf16 a[72:75], a[184:187], v[36:39], a[72:75]
ds_read_b128 a[164:167], v5 offset:20480
buffer_load_dwordx4 v6, s[16:19], s58 offen offset:1024 sc1 lds
v_mfma_f32_16x16x32_bf16 a[100:103], a[184:187], v[40:43], a[100:103]
v_mfma_f32_16x16x32_bf16 a[128:131], a[184:187], v[44:47], a[128:131]
v_mfma_f32_16x16x32_bf16 a[20:23], a[188:191], v[28:31], a[20:23]
v_mfma_f32_16x16x32_bf16 a[48:51], a[188:191], v[32:35], a[48:51]
buffer_load_dwordx4 v6, s[16:19], s58 offen offset:2048 sc1 lds
v_mfma_f32_16x16x32_bf16 a[76:79], a[188:191], v[36:39], a[76:79]
v_mfma_f32_16x16x32_bf16 a[104:107], a[188:191], v[40:43], a[104:107]
v_mfma_f32_16x16x32_bf16 a[132:135], a[188:191], v[44:47], a[132:135]
buffer_load_dwordx4 v6, s[16:19], s58 offen offset:3072 sc1 lds
v_mfma_f32_16x16x32_bf16 a[24:27], a[192:195], v[28:31], a[24:27]
v_mfma_f32_16x16x32_bf16 a[52:55], a[192:195], v[32:35], a[52:55]
v_mfma_f32_16x16x32_bf16 a[80:83], a[192:195], v[36:39], a[80:83]
v_mfma_f32_16x16x32_bf16 a[108:111], a[192:195], v[40:43], a[108:111]
v_mfma_f32_16x16x32_bf16 a[136:139], a[192:195], v[44:47], a[136:139]
s_waitcnt vmcnt(63) lgkmcnt(0)
v_mfma_f32_16x16x32_bf16 a[0:3], a[140:143], v[48:51], a[0:3]
v_mfma_f32_16x16x32_bf16 a[28:31], a[140:143], v[52:55], a[28:31]
ds_read_b128 a[168:171], v5 offset:21504
v_mfma_f32_16x16x32_bf16 a[56:59], a[140:143], v[56:59], a[56:59]
buffer_load_dwordx4 v[28:31], v0, s[12:15], s54 offen offset:1024 sc1
v_mfma_f32_16x16x32_bf16 a[84:87], a[140:143], v[60:63], a[84:87]
v_mfma_f32_16x16x32_bf16 a[112:115], a[140:143], v[64:67], a[112:115]
ds_read_b128 a[172:175], v5 offset:22528
v_mfma_f32_16x16x32_bf16 a[4:7], a[144:147], v[48:51], a[4:7]
buffer_load_dwordx4 v[32:35], v1, s[12:15], s54 offen offset:1024 sc1
v_mfma_f32_16x16x32_bf16 a[32:35], a[144:147], v[52:55], a[32:35]
v_mfma_f32_16x16x32_bf16 a[60:63], a[144:147], v[56:59], a[60:63]
v_mfma_f32_16x16x32_bf16 a[88:91], a[144:147], v[60:63], a[88:91]
ds_read_b128 a[176:179], v5 offset:23552
v_mfma_f32_16x16x32_bf16 a[116:119], a[144:147], v[64:67], a[116:119]
buffer_load_dwordx4 v[36:39], v2, s[12:15], s54 offen offset:1024 sc1
v_mfma_f32_16x16x32_bf16 a[8:11], a[148:151], v[48:51], a[8:11]
v_mfma_f32_16x16x32_bf16 a[36:39], a[148:151], v[52:55], a[36:39]
ds_read_b128 a[180:183], v5 offset:24576
v_mfma_f32_16x16x32_bf16 a[64:67], a[148:151], v[56:59], a[64:67]
v_mfma_f32_16x16x32_bf16 a[92:95], a[148:151], v[60:63], a[92:95]
buffer_load_dwordx4 v[40:43], v3, s[12:15], s54 offen offset:1024 sc1
v_mfma_f32_16x16x32_bf16 a[120:123], a[148:151], v[64:67], a[120:123]
v_mfma_f32_16x16x32_bf16 a[12:15], a[152:155], v[48:51], a[12:15]
ds_read_b128 a[184:187], v5 offset:25600
v_mfma_f32_16x16x32_bf16 a[40:43], a[152:155], v[52:55], a[40:43]
v_mfma_f32_16x16x32_bf16 a[68:71], a[152:155], v[56:59], a[68:71]
buffer_load_dwordx4 v[44:47], v4, s[12:15], s54 offen offset:1024 sc1
v_mfma_f32_16x16x32_bf16 a[96:99], a[152:155], v[60:63], a[96:99]
ds_read_b128 a[188:191], v5 offset:26624
v_mfma_f32_16x16x32_bf16 a[124:127], a[152:155], v[64:67], a[124:127]
s_add_u32 m0, s63, 90112
s_add_u32 s58, s62, 118784
v_mfma_f32_16x16x32_bf16 a[16:19], a[156:159], v[48:51], a[16:19]
v_mfma_f32_16x16x32_bf16 a[44:47], a[156:159], v[52:55], a[44:47]
buffer_load_dwordx4 v6, s[16:19], s58 offen offset:0 sc1 lds
v_mfma_f32_16x16x32_bf16 a[72:75], a[156:159], v[56:59], a[72:75]
ds_read_b128 a[192:195], v5 offset:27648
v_mfma_f32_16x16x32_bf16 a[100:103], a[156:159], v[60:63], a[100:103]
v_mfma_f32_16x16x32_bf16 a[128:131], a[156:159], v[64:67], a[128:131]
v_mfma_f32_16x16x32_bf16 a[20:23], a[160:163], v[48:51], a[20:23]
buffer_load_dwordx4 v6, s[16:19], s58 offen offset:1024 sc1 lds
v_mfma_f32_16x16x32_bf16 a[48:51], a[160:163], v[52:55], a[48:51]
v_mfma_f32_16x16x32_bf16 a[76:79], a[160:163], v[56:59], a[76:79]
v_mfma_f32_16x16x32_bf16 a[104:107], a[160:163], v[60:63], a[104:107]
v_mfma_f32_16x16x32_bf16 a[132:135], a[160:163], v[64:67], a[132:135]
buffer_load_dwordx4 v6, s[16:19], s58 offen offset:2048 sc1 lds
v_mfma_f32_16x16x32_bf16 a[24:27], a[164:167], v[48:51], a[24:27]
v_mfma_f32_16x16x32_bf16 a[52:55], a[164:167], v[52:55], a[52:55]
v_mfma_f32_16x16x32_bf16 a[80:83], a[164:167], v[56:59], a[80:83]
v_mfma_f32_16x16x32_bf16 a[108:111], a[164:167], v[60:63], a[108:111]
v_mfma_f32_16x16x32_bf16 a[136:139], a[164:167], v[64:67], a[136:139]
s_waitcnt vmcnt(44) lgkmcnt(0)
v_mfma_f32_16x16x32_bf16 a[0:3], a[168:171], v[68:71], a[0:3]
v_mfma_f32_16x16x32_bf16 a[28:31], a[168:171], v[72:75], a[28:31]
ds_read_b128 a[140:143], v5 offset:28672
v_mfma_f32_16x16x32_bf16 a[56:59], a[168:171], v[76:79], a[56:59]
buffer_load_dwordx4 v[48:51], v0, s[12:15], s54 offen offset:2048 sc1
v_mfma_f32_16x16x32_bf16 a[84:87], a[168:171], v[80:83], a[84:87]
v_mfma_f32_16x16x32_bf16 a[112:115], a[168:171], v[84:87], a[112:115]
ds_read_b128 a[144:147], v5 offset:29696
v_mfma_f32_16x16x32_bf16 a[4:7], a[172:175], v[68:71], a[4:7]
v_mfma_f32_16x16x32_bf16 a[32:35], a[172:175], v[72:75], a[32:35]
v_mfma_f32_16x16x32_bf16 a[60:63], a[172:175], v[76:79], a[60:63]
v_mfma_f32_16x16x32_bf16 a[88:91], a[172:175], v[80:83], a[88:91]
ds_read_b128 a[148:151], v5 offset:30720
buffer_load_dwordx4 v[52:55], v1, s[12:15], s54 offen offset:2048 sc1
v_mfma_f32_16x16x32_bf16 a[116:119], a[172:175], v[84:87], a[116:119]
v_mfma_f32_16x16x32_bf16 a[8:11], a[176:179], v[68:71], a[8:11]
v_mfma_f32_16x16x32_bf16 a[36:39], a[176:179], v[72:75], a[36:39]
ds_read_b128 a[152:155], v5 offset:31744
v_mfma_f32_16x16x32_bf16 a[64:67], a[176:179], v[76:79], a[64:67]
v_mfma_f32_16x16x32_bf16 a[92:95], a[176:179], v[80:83], a[92:95]
v_mfma_f32_16x16x32_bf16 a[120:123], a[176:179], v[84:87], a[120:123]
buffer_load_dwordx4 v[56:59], v2, s[12:15], s54 offen offset:2048 sc1
v_mfma_f32_16x16x32_bf16 a[12:15], a[180:183], v[68:71], a[12:15]
ds_read_b128 a[156:159], v5 offset:32768
v_mfma_f32_16x16x32_bf16 a[40:43], a[180:183], v[72:75], a[40:43]
v_mfma_f32_16x16x32_bf16 a[68:71], a[180:183], v[76:79], a[68:71]
v_mfma_f32_16x16x32_bf16 a[96:99], a[180:183], v[80:83], a[96:99]
ds_read_b128 a[160:163], v5 offset:33792
v_mfma_f32_16x16x32_bf16 a[124:127], a[180:183], v[84:87], a[124:127]
v_mfma_f32_16x16x32_bf16 a[16:19], a[184:187], v[68:71], a[16:19]
buffer_load_dwordx4 v[60:63], v3, s[12:15], s54 offen offset:2048 sc1
v_mfma_f32_16x16x32_bf16 a[44:47], a[184:187], v[72:75], a[44:47]
v_mfma_f32_16x16x32_bf16 a[72:75], a[184:187], v[76:79], a[72:75]
ds_read_b128 a[164:167], v5 offset:34816
v_mfma_f32_16x16x32_bf16 a[100:103], a[184:187], v[80:83], a[100:103]
v_mfma_f32_16x16x32_bf16 a[128:131], a[184:187], v[84:87], a[128:131]
v_mfma_f32_16x16x32_bf16 a[20:23], a[188:191], v[68:71], a[20:23]
v_mfma_f32_16x16x32_bf16 a[48:51], a[188:191], v[72:75], a[48:51]
buffer_load_dwordx4 v[64:67], v4, s[12:15], s54 offen offset:2048 sc1
v_mfma_f32_16x16x32_bf16 a[76:79], a[188:191], v[76:79], a[76:79]
v_mfma_f32_16x16x32_bf16 a[104:107], a[188:191], v[80:83], a[104:107]
v_mfma_f32_16x16x32_bf16 a[132:135], a[188:191], v[84:87], a[132:135]
v_mfma_f32_16x16x32_bf16 a[24:27], a[192:195], v[68:71], a[24:27]
v_mfma_f32_16x16x32_bf16 a[52:55], a[192:195], v[72:75], a[52:55]
v_mfma_f32_16x16x32_bf16 a[80:83], a[192:195], v[76:79], a[80:83]
v_mfma_f32_16x16x32_bf16 a[108:111], a[192:195], v[80:83], a[108:111]
v_mfma_f32_16x16x32_bf16 a[136:139], a[192:195], v[84:87], a[136:139]
s_waitcnt vmcnt(44) lgkmcnt(0)
v_mfma_f32_16x16x32_bf16 a[0:3], a[140:143], v[88:91], a[0:3]
v_mfma_f32_16x16x32_bf16 a[28:31], a[140:143], v[92:95], a[28:31]
ds_read_b128 a[168:171], v5 offset:35840
v_mfma_f32_16x16x32_bf16 a[56:59], a[140:143], v[96:99], a[56:59]
buffer_load_dwordx4 v[68:71], v0, s[12:15], s54 offen offset:3072 sc1
v_mfma_f32_16x16x32_bf16 a[84:87], a[140:143], v[100:103], a[84:87]
v_mfma_f32_16x16x32_bf16 a[112:115], a[140:143], v[104:107], a[112:115]
ds_read_b128 a[172:175], v5 offset:36864
v_mfma_f32_16x16x32_bf16 a[4:7], a[144:147], v[88:91], a[4:7]
v_mfma_f32_16x16x32_bf16 a[32:35], a[144:147], v[92:95], a[32:35]
v_mfma_f32_16x16x32_bf16 a[60:63], a[144:147], v[96:99], a[60:63]
v_mfma_f32_16x16x32_bf16 a[88:91], a[144:147], v[100:103], a[88:91]
ds_read_b128 a[176:179], v5 offset:37888
buffer_load_dwordx4 v[72:75], v1, s[12:15], s54 offen offset:3072 sc1
v_mfma_f32_16x16x32_bf16 a[116:119], a[144:147], v[104:107], a[116:119]
v_mfma_f32_16x16x32_bf16 a[8:11], a[148:151], v[88:91], a[8:11]
v_mfma_f32_16x16x32_bf16 a[36:39], a[148:151], v[92:95], a[36:39]
ds_read_b128 a[180:183], v5 offset:38912
v_mfma_f32_16x16x32_bf16 a[64:67], a[148:151], v[96:99], a[64:67]
v_mfma_f32_16x16x32_bf16 a[92:95], a[148:151], v[100:103], a[92:95]
v_mfma_f32_16x16x32_bf16 a[120:123], a[148:151], v[104:107], a[120:123]
buffer_load_dwordx4 v[76:79], v2, s[12:15], s54 offen offset:3072 sc1
v_mfma_f32_16x16x32_bf16 a[12:15], a[152:155], v[88:91], a[12:15]
ds_read_b128 a[184:187], v5 offset:39936
v_mfma_f32_16x16x32_bf16 a[40:43], a[152:155], v[92:95], a[40:43]
v_mfma_f32_16x16x32_bf16 a[68:71], a[152:155], v[96:99], a[68:71]
v_mfma_f32_16x16x32_bf16 a[96:99], a[152:155], v[100:103], a[96:99]
ds_read_b128 a[188:191], v5 offset:40960
v_mfma_f32_16x16x32_bf16 a[124:127], a[152:155], v[104:107], a[124:127]
v_mfma_f32_16x16x32_bf16 a[16:19], a[156:159], v[88:91], a[16:19]
buffer_load_dwordx4 v[80:83], v3, s[12:15], s54 offen offset:3072 sc1
v_mfma_f32_16x16x32_bf16 a[44:47], a[156:159], v[92:95], a[44:47]
v_mfma_f32_16x16x32_bf16 a[72:75], a[156:159], v[96:99], a[72:75]
ds_read_b128 a[192:195], v5 offset:41984
v_mfma_f32_16x16x32_bf16 a[100:103], a[156:159], v[100:103], a[100:103]
v_mfma_f32_16x16x32_bf16 a[128:131], a[156:159], v[104:107], a[128:131]
v_mfma_f32_16x16x32_bf16 a[20:23], a[160:163], v[88:91], a[20:23]
v_mfma_f32_16x16x32_bf16 a[48:51], a[160:163], v[92:95], a[48:51]
buffer_load_dwordx4 v[84:87], v4, s[12:15], s54 offen offset:3072 sc1
v_mfma_f32_16x16x32_bf16 a[76:79], a[160:163], v[96:99], a[76:79]
v_mfma_f32_16x16x32_bf16 a[104:107], a[160:163], v[100:103], a[104:107]
v_mfma_f32_16x16x32_bf16 a[132:135], a[160:163], v[104:107], a[132:135]
v_mfma_f32_16x16x32_bf16 a[24:27], a[164:167], v[88:91], a[24:27]
v_mfma_f32_16x16x32_bf16 a[52:55], a[164:167], v[92:95], a[52:55]
v_mfma_f32_16x16x32_bf16 a[80:83], a[164:167], v[96:99], a[80:83]
v_mfma_f32_16x16x32_bf16 a[108:111], a[164:167], v[100:103], a[108:111]
v_mfma_f32_16x16x32_bf16 a[136:139], a[164:167], v[104:107], a[136:139]
s_waitcnt vmcnt(44) lgkmcnt(0)
v_mfma_f32_16x16x32_bf16 a[0:3], a[168:171], v[108:111], a[0:3]
s_add_u32 s59, s54, 4096
v_mfma_f32_16x16x32_bf16 a[28:31], a[168:171], v[112:115], a[28:31]
ds_read_b128 a[140:143], v5 offset:43008
v_mfma_f32_16x16x32_bf16 a[56:59], a[168:171], v[116:119], a[56:59]
buffer_load_dwordx4 v[88:91], v0, s[12:15], s59 offen offset:0 sc1
v_mfma_f32_16x16x32_bf16 a[84:87], a[168:171], v[120:123], a[84:87]
v_mfma_f32_16x16x32_bf16 a[112:115], a[168:171], v[124:127], a[112:115]
ds_read_b128 a[144:147], v5 offset:44032
v_mfma_f32_16x16x32_bf16 a[4:7], a[172:175], v[108:111], a[4:7]
v_mfma_f32_16x16x32_bf16 a[32:35], a[172:175], v[112:115], a[32:35]
v_mfma_f32_16x16x32_bf16 a[60:63], a[172:175], v[116:119], a[60:63]
v_mfma_f32_16x16x32_bf16 a[88:91], a[172:175], v[120:123], a[88:91]
ds_read_b128 a[148:151], v5 offset:45056
buffer_load_dwordx4 v[92:95], v1, s[12:15], s59 offen offset:0 sc1
v_mfma_f32_16x16x32_bf16 a[116:119], a[172:175], v[124:127], a[116:119]
v_mfma_f32_16x16x32_bf16 a[8:11], a[176:179], v[108:111], a[8:11]
v_mfma_f32_16x16x32_bf16 a[36:39], a[176:179], v[112:115], a[36:39]
ds_read_b128 a[152:155], v5 offset:46080
v_mfma_f32_16x16x32_bf16 a[64:67], a[176:179], v[116:119], a[64:67]
v_mfma_f32_16x16x32_bf16 a[92:95], a[176:179], v[120:123], a[92:95]
v_mfma_f32_16x16x32_bf16 a[120:123], a[176:179], v[124:127], a[120:123]
buffer_load_dwordx4 v[96:99], v2, s[12:15], s59 offen offset:0 sc1
v_mfma_f32_16x16x32_bf16 a[12:15], a[180:183], v[108:111], a[12:15]
ds_read_b128 a[156:159], v5 offset:47104
v_mfma_f32_16x16x32_bf16 a[40:43], a[180:183], v[112:115], a[40:43]
v_mfma_f32_16x16x32_bf16 a[68:71], a[180:183], v[116:119], a[68:71]
v_mfma_f32_16x16x32_bf16 a[96:99], a[180:183], v[120:123], a[96:99]
ds_read_b128 a[160:163], v5 offset:48128
v_mfma_f32_16x16x32_bf16 a[124:127], a[180:183], v[124:127], a[124:127]
v_mfma_f32_16x16x32_bf16 a[16:19], a[184:187], v[108:111], a[16:19]
buffer_load_dwordx4 v[100:103], v3, s[12:15], s59 offen offset:0 sc1
v_mfma_f32_16x16x32_bf16 a[44:47], a[184:187], v[112:115], a[44:47]
v_mfma_f32_16x16x32_bf16 a[72:75], a[184:187], v[116:119], a[72:75]
ds_read_b128 a[164:167], v5 offset:49152
v_mfma_f32_16x16x32_bf16 a[100:103], a[184:187], v[120:123], a[100:103]
v_mfma_f32_16x16x32_bf16 a[128:131], a[184:187], v[124:127], a[128:131]
v_mfma_f32_16x16x32_bf16 a[20:23], a[188:191], v[108:111], a[20:23]
v_mfma_f32_16x16x32_bf16 a[48:51], a[188:191], v[112:115], a[48:51]
buffer_load_dwordx4 v[104:107], v4, s[12:15], s59 offen offset:0 sc1
v_mfma_f32_16x16x32_bf16 a[76:79], a[188:191], v[116:119], a[76:79]
v_mfma_f32_16x16x32_bf16 a[104:107], a[188:191], v[120:123], a[104:107]
v_mfma_f32_16x16x32_bf16 a[132:135], a[188:191], v[124:127], a[132:135]
v_mfma_f32_16x16x32_bf16 a[24:27], a[192:195], v[108:111], a[24:27]
v_mfma_f32_16x16x32_bf16 a[52:55], a[192:195], v[112:115], a[52:55]
v_mfma_f32_16x16x32_bf16 a[80:83], a[192:195], v[116:119], a[80:83]
v_mfma_f32_16x16x32_bf16 a[108:111], a[192:195], v[120:123], a[108:111]
v_mfma_f32_16x16x32_bf16 a[136:139], a[192:195], v[124:127], a[136:139]
s_waitcnt vmcnt(44) lgkmcnt(0)
v_mfma_f32_16x16x32_bf16 a[0:3], a[140:143], v[128:131], a[0:3]
s_add_u32 s59, s54, 4096
v_mfma_f32_16x16x32_bf16 a[28:31], a[140:143], v[132:135], a[28:31]
ds_read_b128 a[168:171], v5 offset:50176
v_mfma_f32_16x16x32_bf16 a[56:59], a[140:143], v[136:139], a[56:59]
buffer_load_dwordx4 v[108:111], v0, s[12:15], s59 offen offset:1024 sc1
v_mfma_f32_16x16x32_bf16 a[84:87], a[140:143], v[140:143], a[84:87]
v_mfma_f32_16x16x32_bf16 a[112:115], a[140:143], v[144:147], a[112:115]
ds_read_b128 a[172:175], v5 offset:51200
v_mfma_f32_16x16x32_bf16 a[4:7], a[144:147], v[128:131], a[4:7]
v_mfma_f32_16x16x32_bf16 a[32:35], a[144:147], v[132:135], a[32:35]
v_mfma_f32_16x16x32_bf16 a[60:63], a[144:147], v[136:139], a[60:63]
v_mfma_f32_16x16x32_bf16 a[88:91], a[144:147], v[140:143], a[88:91]
ds_read_b128 a[176:179], v5 offset:52224
buffer_load_dwordx4 v[112:115], v1, s[12:15], s59 offen offset:1024 sc1
v_mfma_f32_16x16x32_bf16 a[116:119], a[144:147], v[144:147], a[116:119]
v_mfma_f32_16x16x32_bf16 a[8:11], a[148:151], v[128:131], a[8:11]
v_mfma_f32_16x16x32_bf16 a[36:39], a[148:151], v[132:135], a[36:39]
ds_read_b128 a[180:183], v5 offset:53248
v_mfma_f32_16x16x32_bf16 a[64:67], a[148:151], v[136:139], a[64:67]
v_mfma_f32_16x16x32_bf16 a[92:95], a[148:151], v[140:143], a[92:95]
v_mfma_f32_16x16x32_bf16 a[120:123], a[148:151], v[144:147], a[120:123]
buffer_load_dwordx4 v[116:119], v2, s[12:15], s59 offen offset:1024 sc1
v_mfma_f32_16x16x32_bf16 a[12:15], a[152:155], v[128:131], a[12:15]
ds_read_b128 a[184:187], v5 offset:54272
v_mfma_f32_16x16x32_bf16 a[40:43], a[152:155], v[132:135], a[40:43]
v_mfma_f32_16x16x32_bf16 a[68:71], a[152:155], v[136:139], a[68:71]
v_mfma_f32_16x16x32_bf16 a[96:99], a[152:155], v[140:143], a[96:99]
ds_read_b128 a[188:191], v5 offset:55296
v_mfma_f32_16x16x32_bf16 a[124:127], a[152:155], v[144:147], a[124:127]
v_mfma_f32_16x16x32_bf16 a[16:19], a[156:159], v[128:131], a[16:19]
buffer_load_dwordx4 v[120:123], v3, s[12:15], s59 offen offset:1024 sc1
v_mfma_f32_16x16x32_bf16 a[44:47], a[156:159], v[132:135], a[44:47]
v_mfma_f32_16x16x32_bf16 a[72:75], a[156:159], v[136:139], a[72:75]
ds_read_b128 a[192:195], v5 offset:56320
v_mfma_f32_16x16x32_bf16 a[100:103], a[156:159], v[140:143], a[100:103]
v_mfma_f32_16x16x32_bf16 a[128:131], a[156:159], v[144:147], a[128:131]
v_mfma_f32_16x16x32_bf16 a[20:23], a[160:163], v[128:131], a[20:23]
v_mfma_f32_16x16x32_bf16 a[48:51], a[160:163], v[132:135], a[48:51]
buffer_load_dwordx4 v[124:127], v4, s[12:15], s59 offen offset:1024 sc1
v_mfma_f32_16x16x32_bf16 a[76:79], a[160:163], v[136:139], a[76:79]
v_mfma_f32_16x16x32_bf16 a[104:107], a[160:163], v[140:143], a[104:107]
v_mfma_f32_16x16x32_bf16 a[132:135], a[160:163], v[144:147], a[132:135]
v_mfma_f32_16x16x32_bf16 a[24:27], a[164:167], v[128:131], a[24:27]
v_mfma_f32_16x16x32_bf16 a[52:55], a[164:167], v[132:135], a[52:55]
v_mfma_f32_16x16x32_bf16 a[80:83], a[164:167], v[136:139], a[80:83]
v_mfma_f32_16x16x32_bf16 a[108:111], a[164:167], v[140:143], a[108:111]
v_mfma_f32_16x16x32_bf16 a[136:139], a[164:167], v[144:147], a[136:139]
s_waitcnt vmcnt(40) lgkmcnt(0)
v_mfma_f32_16x16x32_bf16 a[0:3], a[168:171], v[148:151], a[0:3]
s_waitcnt vmcnt(20)
s_barrier
v_mfma_f32_16x16x32_bf16 a[28:31], a[168:171], v[152:155], a[28:31]
ds_read_b128 a[140:143], v7 offset:0
s_add_u32 s59, s54, 4096
v_mfma_f32_16x16x32_bf16 a[56:59], a[168:171], v[156:159], a[56:59]
buffer_load_dwordx4 v[128:131], v0, s[12:15], s59 offen offset:2048 sc1
v_mfma_f32_16x16x32_bf16 a[84:87], a[168:171], v[160:163], a[84:87]
v_mfma_f32_16x16x32_bf16 a[112:115], a[168:171], v[164:167], a[112:115]
v_mfma_f32_16x16x32_bf16 a[4:7], a[172:175], v[148:151], a[4:7]
v_mfma_f32_16x16x32_bf16 a[32:35], a[172:175], v[152:155], a[32:35]
v_mfma_f32_16x16x32_bf16 a[60:63], a[172:175], v[156:159], a[60:63]
ds_read_b128 a[144:147], v7 offset:1024
v_mfma_f32_16x16x32_bf16 a[88:91], a[172:175], v[160:163], a[88:91]
buffer_load_dwordx4 v[132:135], v1, s[12:15], s59 offen offset:2048 sc1
v_mfma_f32_16x16x32_bf16 a[116:119], a[172:175], v[164:167], a[116:119]
v_mfma_f32_16x16x32_bf16 a[8:11], a[176:179], v[148:151], a[8:11]
v_mfma_f32_16x16x32_bf16 a[36:39], a[176:179], v[152:155], a[36:39]
v_mfma_f32_16x16x32_bf16 a[64:67], a[176:179], v[156:159], a[64:67]
v_mfma_f32_16x16x32_bf16 a[92:95], a[176:179], v[160:163], a[92:95]
ds_read_b128 a[148:151], v7 offset:2048
v_mfma_f32_16x16x32_bf16 a[120:123], a[176:179], v[164:167], a[120:123]
buffer_load_dwordx4 v[136:139], v2, s[12:15], s59 offen offset:2048 sc1
v_mfma_f32_16x16x32_bf16 a[12:15], a[180:183], v[148:151], a[12:15]
v_mfma_f32_16x16x32_bf16 a[40:43], a[180:183], v[152:155], a[40:43]
v_mfma_f32_16x16x32_bf16 a[68:71], a[180:183], v[156:159], a[68:71]
v_mfma_f32_16x16x32_bf16 a[96:99], a[180:183], v[160:163], a[96:99]
v_mfma_f32_16x16x32_bf16 a[124:127], a[180:183], v[164:167], a[124:127]
ds_read_b128 a[152:155], v7 offset:3072
v_mfma_f32_16x16x32_bf16 a[16:19], a[184:187], v[148:151], a[16:19]
buffer_load_dwordx4 v[140:143], v3, s[12:15], s59 offen offset:2048 sc1
v_mfma_f32_16x16x32_bf16 a[44:47], a[184:187], v[152:155], a[44:47]
v_mfma_f32_16x16x32_bf16 a[72:75], a[184:187], v[156:159], a[72:75]
v_mfma_f32_16x16x32_bf16 a[100:103], a[184:187], v[160:163], a[100:103]
v_mfma_f32_16x16x32_bf16 a[128:131], a[184:187], v[164:167], a[128:131]
v_mfma_f32_16x16x32_bf16 a[20:23], a[188:191], v[148:151], a[20:23]
v_mfma_f32_16x16x32_bf16 a[48:51], a[188:191], v[152:155], a[48:51]
buffer_load_dwordx4 v[144:147], v4, s[12:15], s59 offen offset:2048 sc1
v_mfma_f32_16x16x32_bf16 a[76:79], a[188:191], v[156:159], a[76:79]
v_mfma_f32_16x16x32_bf16 a[104:107], a[188:191], v[160:163], a[104:107]
v_mfma_f32_16x16x32_bf16 a[132:135], a[188:191], v[164:167], a[132:135]
v_mfma_f32_16x16x32_bf16 a[24:27], a[192:195], v[148:151], a[24:27]
v_mfma_f32_16x16x32_bf16 a[52:55], a[192:195], v[152:155], a[52:55]
v_mfma_f32_16x16x32_bf16 a[80:83], a[192:195], v[156:159], a[80:83]
v_mfma_f32_16x16x32_bf16 a[108:111], a[192:195], v[160:163], a[108:111]
v_mfma_f32_16x16x32_bf16 a[136:139], a[192:195], v[164:167], a[136:139]
s_waitcnt vmcnt(63) lgkmcnt(0)
v_mfma_f32_16x16x32_bf16 a[0:3], a[140:143], v[8:11], a[0:3]
s_add_u32 s59, s54, 4096
v_mfma_f32_16x16x32_bf16 a[28:31], a[140:143], v[12:15], a[28:31]
ds_read_b128 a[168:171], v7 offset:7168
v_mfma_f32_16x16x32_bf16 a[56:59], a[140:143], v[16:19], a[56:59]
buffer_load_dwordx4 v[148:151], v0, s[12:15], s59 offen offset:3072 sc1
v_mfma_f32_16x16x32_bf16 a[84:87], a[140:143], v[20:23], a[84:87]
ds_read_b128 a[172:175], v7 offset:8192
v_mfma_f32_16x16x32_bf16 a[112:115], a[140:143], v[24:27], a[112:115]
v_mfma_f32_16x16x32_bf16 a[4:7], a[144:147], v[8:11], a[4:7]
buffer_load_dwordx4 v[152:155], v1, s[12:15], s59 offen offset:3072 sc1
v_mfma_f32_16x16x32_bf16 a[32:35], a[144:147], v[12:15], a[32:35]
ds_read_b128 a[176:179], v7 offset:9216
v_mfma_f32_16x16x32_bf16 a[60:63], a[144:147], v[16:19], a[60:63]
v_mfma_f32_16x16x32_bf16 a[88:91], a[144:147], v[20:23], a[88:91]
ds_read_b128 a[180:183], v7 offset:10240
buffer_load_dwordx4 v[156:159], v2, s[12:15], s59 offen offset:3072 sc1
v_mfma_f32_16x16x32_bf16 a[116:119], a[144:147], v[24:27], a[116:119]
v_mfma_f32_16x16x32_bf16 a[8:11], a[148:151], v[8:11], a[8:11]
v_mfma_f32_16x16x32_bf16 a[36:39], a[148:151], v[12:15], a[36:39]
buffer_load_dwordx4 v[160:163], v3, s[12:15], s59 offen offset:3072 sc1
v_mfma_f32_16x16x32_bf16 a[64:67], a[148:151], v[16:19], a[64:67]
v_mfma_f32_16x16x32_bf16 a[92:95], a[148:151], v[20:23], a[92:95]
v_mfma_f32_16x16x32_bf16 a[120:123], a[148:151], v[24:27], a[120:123]
buffer_load_dwordx4 v[164:167], v4, s[12:15], s59 offen offset:3072 sc1
v_mfma_f32_16x16x32_bf16 a[12:15], a[152:155], v[8:11], a[12:15]
v_mfma_f32_16x16x32_bf16 a[40:43], a[152:155], v[12:15], a[40:43]
v_mfma_f32_16x16x32_bf16 a[68:71], a[152:155], v[16:19], a[68:71]
v_mfma_f32_16x16x32_bf16 a[96:99], a[152:155], v[20:23], a[96:99]
v_mfma_f32_16x16x32_bf16 a[124:127], a[152:155], v[24:27], a[124:127]
s_waitcnt vmcnt(63) lgkmcnt(0)
v_mfma_f32_16x16x32_bf16 a[0:3], a[168:171], v[28:31], a[0:3]
v_mfma_f32_16x16x32_bf16 a[28:31], a[168:171], v[32:35], a[28:31]
ds_read_b128 a[140:143], v7 offset:14336
v_mfma_f32_16x16x32_bf16 a[56:59], a[168:171], v[36:39], a[56:59]
v_mfma_f32_16x16x32_bf16 a[84:87], a[168:171], v[40:43], a[84:87]
ds_read_b128 a[144:147], v7 offset:15360
v_mfma_f32_16x16x32_bf16 a[112:115], a[168:171], v[44:47], a[112:115]
v_mfma_f32_16x16x32_bf16 a[4:7], a[172:175], v[28:31], a[4:7]
v_mfma_f32_16x16x32_bf16 a[32:35], a[172:175], v[32:35], a[32:35]
ds_read_b128 a[148:151], v7 offset:16384
v_mfma_f32_16x16x32_bf16 a[60:63], a[172:175], v[36:39], a[60:63]
v_mfma_f32_16x16x32_bf16 a[88:91], a[172:175], v[40:43], a[88:91]
ds_read_b128 a[152:155], v7 offset:17408
v_mfma_f32_16x16x32_bf16 a[116:119], a[172:175], v[44:47], a[116:119]
v_mfma_f32_16x16x32_bf16 a[8:11], a[176:179], v[28:31], a[8:11]
v_mfma_f32_16x16x32_bf16 a[36:39], a[176:179], v[32:35], a[36:39]
v_mfma_f32_16x16x32_bf16 a[64:67], a[176:179], v[36:39], a[64:67]
v_mfma_f32_16x16x32_bf16 a[92:95], a[176:179], v[40:43], a[92:95]
v_mfma_f32_16x16x32_bf16 a[120:123], a[176:179], v[44:47], a[120:123]
v_mfma_f32_16x16x32_bf16 a[12:15], a[180:183], v[28:31], a[12:15]
v_mfma_f32_16x16x32_bf16 a[40:43], a[180:183], v[32:35], a[40:43]
v_mfma_f32_16x16x32_bf16 a[68:71], a[180:183], v[36:39], a[68:71]
v_mfma_f32_16x16x32_bf16 a[96:99], a[180:183], v[40:43], a[96:99]
v_mfma_f32_16x16x32_bf16 a[124:127], a[180:183], v[44:47], a[124:127]
s_waitcnt vmcnt(25) lgkmcnt(0)
v_mfma_f32_16x16x32_bf16 a[0:3], a[140:143], v[48:51], a[0:3]
v_mfma_f32_16x16x32_bf16 a[28:31], a[140:143], v[52:55], a[28:31]
ds_read_b128 a[168:171], v7 offset:21504
v_mfma_f32_16x16x32_bf16 a[56:59], a[140:143], v[56:59], a[56:59]
v_mfma_f32_16x16x32_bf16 a[84:87], a[140:143], v[60:63], a[84:87]
ds_read_b128 a[172:175], v7 offset:22528
v_mfma_f32_16x16x32_bf16 a[112:115], a[140:143], v[64:67], a[112:115]
v_mfma_f32_16x16x32_bf16 a[4:7], a[144:147], v[48:51], a[4:7]
v_mfma_f32_16x16x32_bf16 a[32:35], a[144:147], v[52:55], a[32:35]
ds_read_b128 a[176:179], v7 offset:23552
v_mfma_f32_16x16x32_bf16 a[60:63], a[144:147], v[56:59], a[60:63]
v_mfma_f32_16x16x32_bf16 a[88:91], a[144:147], v[60:63], a[88:91]
ds_read_b128 a[180:183], v7 offset:24576
v_mfma_f32_16x16x32_bf16 a[116:119], a[144:147], v[64:67], a[116:119]
v_mfma_f32_16x16x32_bf16 a[8:11], a[148:151], v[48:51], a[8:11]
v_mfma_f32_16x16x32_bf16 a[36:39], a[148:151], v[52:55], a[36:39]
v_mfma_f32_16x16x32_bf16 a[64:67], a[148:151], v[56:59], a[64:67]
v_mfma_f32_16x16x32_bf16 a[92:95], a[148:151], v[60:63], a[92:95]
v_mfma_f32_16x16x32_bf16 a[120:123], a[148:151], v[64:67], a[120:123]
v_mfma_f32_16x16x32_bf16 a[12:15], a[152:155], v[48:51], a[12:15]
v_mfma_f32_16x16x32_bf16 a[40:43], a[152:155], v[52:55], a[40:43]
v_mfma_f32_16x16x32_bf16 a[68:71], a[152:155], v[56:59], a[68:71]
v_mfma_f32_16x16x32_bf16 a[96:99], a[152:155], v[60:63], a[96:99]
v_mfma_f32_16x16x32_bf16 a[124:127], a[152:155], v[64:67], a[124:127]
s_waitcnt vmcnt(20) lgkmcnt(0)
v_mfma_f32_16x16x32_bf16 a[0:3], a[168:171], v[68:71], a[0:3]
v_mfma_f32_16x16x32_bf16 a[28:31], a[168:171], v[72:75], a[28:31]
ds_read_b128 a[140:143], v7 offset:28672
v_mfma_f32_16x16x32_bf16 a[56:59], a[168:171], v[76:79], a[56:59]
v_mfma_f32_16x16x32_bf16 a[84:87], a[168:171], v[80:83], a[84:87]
ds_read_b128 a[144:147], v7 offset:29696
v_mfma_f32_16x16x32_bf16 a[112:115], a[168:171], v[84:87], a[112:115]
v_mfma_f32_16x16x32_bf16 a[4:7], a[172:175], v[68:71], a[4:7]
v_mfma_f32_16x16x32_bf16 a[32:35], a[172:175], v[72:75], a[32:35]
ds_read_b128 a[148:151], v7 offset:30720
v_mfma_f32_16x16x32_bf16 a[60:63], a[172:175], v[76:79], a[60:63]
v_mfma_f32_16x16x32_bf16 a[88:91], a[172:175], v[80:83], a[88:91]
ds_read_b128 a[152:155], v7 offset:31744
v_mfma_f32_16x16x32_bf16 a[116:119], a[172:175], v[84:87], a[116:119]
v_mfma_f32_16x16x32_bf16 a[8:11], a[176:179], v[68:71], a[8:11]
v_mfma_f32_16x16x32_bf16 a[36:39], a[176:179], v[72:75], a[36:39]
v_mfma_f32_16x16x32_bf16 a[64:67], a[176:179], v[76:79], a[64:67]
v_mfma_f32_16x16x32_bf16 a[92:95], a[176:179], v[80:83], a[92:95]
v_mfma_f32_16x16x32_bf16 a[120:123], a[176:179], v[84:87], a[120:123]
v_mfma_f32_16x16x32_bf16 a[12:15], a[180:183], v[68:71], a[12:15]
v_mfma_f32_16x16x32_bf16 a[40:43], a[180:183], v[72:75], a[40:43]
v_mfma_f32_16x16x32_bf16 a[68:71], a[180:183], v[76:79], a[68:71]
v_mfma_f32_16x16x32_bf16 a[96:99], a[180:183], v[80:83], a[96:99]
v_mfma_f32_16x16x32_bf16 a[124:127], a[180:183], v[84:87], a[124:127]
s_waitcnt vmcnt(15) lgkmcnt(0)
v_mfma_f32_16x16x32_bf16 a[0:3], a[140:143], v[88:91], a[0:3]
v_mfma_f32_16x16x32_bf16 a[28:31], a[140:143], v[92:95], a[28:31]
ds_read_b128 a[168:171], v7 offset:35840
v_mfma_f32_16x16x32_bf16 a[56:59], a[140:143], v[96:99], a[56:59]
v_mfma_f32_16x16x32_bf16 a[84:87], a[140:143], v[100:103], a[84:87]
ds_read_b128 a[172:175], v7 offset:36864
v_mfma_f32_16x16x32_bf16 a[112:115], a[140:143], v[104:107], a[112:115]
v_mfma_f32_16x16x32_bf16 a[4:7], a[144:147], v[88:91], a[4:7]
v_mfma_f32_16x16x32_bf16 a[32:35], a[144:147], v[92:95], a[32:35]
ds_read_b128 a[176:179], v7 offset:37888
v_mfma_f32_16x16x32_bf16 a[60:63], a[144:147], v[96:99], a[60:63]
v_mfma_f32_16x16x32_bf16 a[88:91], a[144:147], v[100:103], a[88:91]
ds_read_b128 a[180:183], v7 offset:38912
v_mfma_f32_16x16x32_bf16 a[116:119], a[144:147], v[104:107], a[116:119]
v_mfma_f32_16x16x32_bf16 a[8:11], a[148:151], v[88:91], a[8:11]
v_mfma_f32_16x16x32_bf16 a[36:39], a[148:151], v[92:95], a[36:39]
v_mfma_f32_16x16x32_bf16 a[64:67], a[148:151], v[96:99], a[64:67]
v_mfma_f32_16x16x32_bf16 a[92:95], a[148:151], v[100:103], a[92:95]
v_mfma_f32_16x16x32_bf16 a[120:123], a[148:151], v[104:107], a[120:123]
v_mfma_f32_16x16x32_bf16 a[12:15], a[152:155], v[88:91], a[12:15]
v_mfma_f32_16x16x32_bf16 a[40:43], a[152:155], v[92:95], a[40:43]
v_mfma_f32_16x16x32_bf16 a[68:71], a[152:155], v[96:99], a[68:71]
v_mfma_f32_16x16x32_bf16 a[96:99], a[152:155], v[100:103], a[96:99]
v_mfma_f32_16x16x32_bf16 a[124:127], a[152:155], v[104:107], a[124:127]
s_waitcnt vmcnt(10) lgkmcnt(0)
v_mfma_f32_16x16x32_bf16 a[0:3], a[168:171], v[108:111], a[0:3]
v_mfma_f32_16x16x32_bf16 a[28:31], a[168:171], v[112:115], a[28:31]
ds_read_b128 a[140:143], v7 offset:43008
v_mfma_f32_16x16x32_bf16 a[56:59], a[168:171], v[116:119], a[56:59]
v_mfma_f32_16x16x32_bf16 a[84:87], a[168:171], v[120:123], a[84:87]
ds_read_b128 a[144:147], v7 offset:44032
v_mfma_f32_16x16x32_bf16 a[112:115], a[168:171], v[124:127], a[112:115]
v_mfma_f32_16x16x32_bf16 a[4:7], a[172:175], v[108:111], a[4:7]
v_mfma_f32_16x16x32_bf16 a[32:35], a[172:175], v[112:115], a[32:35]
ds_read_b128 a[148:151], v7 offset:45056
v_mfma_f32_16x16x32_bf16 a[60:63], a[172:175], v[116:119], a[60:63]
v_mfma_f32_16x16x32_bf16 a[88:91], a[172:175], v[120:123], a[88:91]
ds_read_b128 a[152:155], v7 offset:46080
v_mfma_f32_16x16x32_bf16 a[116:119], a[172:175], v[124:127], a[116:119]
v_mfma_f32_16x16x32_bf16 a[8:11], a[176:179], v[108:111], a[8:11]
v_mfma_f32_16x16x32_bf16 a[36:39], a[176:179], v[112:115], a[36:39]
v_mfma_f32_16x16x32_bf16 a[64:67], a[176:179], v[116:119], a[64:67]
v_mfma_f32_16x16x32_bf16 a[92:95], a[176:179], v[120:123], a[92:95]
v_mfma_f32_16x16x32_bf16 a[120:123], a[176:179], v[124:127], a[120:123]
v_mfma_f32_16x16x32_bf16 a[12:15], a[180:183], v[108:111], a[12:15]
v_mfma_f32_16x16x32_bf16 a[40:43], a[180:183], v[112:115], a[40:43]
v_mfma_f32_16x16x32_bf16 a[68:71], a[180:183], v[116:119], a[68:71]
v_mfma_f32_16x16x32_bf16 a[96:99], a[180:183], v[120:123], a[96:99]
v_mfma_f32_16x16x32_bf16 a[124:127], a[180:183], v[124:127], a[124:127]
s_waitcnt vmcnt(5) lgkmcnt(0)
v_mfma_f32_16x16x32_bf16 a[0:3], a[140:143], v[128:131], a[0:3]
v_mfma_f32_16x16x32_bf16 a[28:31], a[140:143], v[132:135], a[28:31]
ds_read_b128 a[168:171], v7 offset:50176
v_mfma_f32_16x16x32_bf16 a[56:59], a[140:143], v[136:139], a[56:59]
v_mfma_f32_16x16x32_bf16 a[84:87], a[140:143], v[140:143], a[84:87]
ds_read_b128 a[172:175], v7 offset:51200
v_mfma_f32_16x16x32_bf16 a[112:115], a[140:143], v[144:147], a[112:115]
v_mfma_f32_16x16x32_bf16 a[4:7], a[144:147], v[128:131], a[4:7]
v_mfma_f32_16x16x32_bf16 a[32:35], a[144:147], v[132:135], a[32:35]
ds_read_b128 a[176:179], v7 offset:52224
v_mfma_f32_16x16x32_bf16 a[60:63], a[144:147], v[136:139], a[60:63]
v_mfma_f32_16x16x32_bf16 a[88:91], a[144:147], v[140:143], a[88:91]
ds_read_b128 a[180:183], v7 offset:53248
v_mfma_f32_16x16x32_bf16 a[116:119], a[144:147], v[144:147], a[116:119]
v_mfma_f32_16x16x32_bf16 a[8:11], a[148:151], v[128:131], a[8:11]
v_mfma_f32_16x16x32_bf16 a[36:39], a[148:151], v[132:135], a[36:39]
v_mfma_f32_16x16x32_bf16 a[64:67], a[148:151], v[136:139], a[64:67]
v_mfma_f32_16x16x32_bf16 a[92:95], a[148:151], v[140:143], a[92:95]
v_mfma_f32_16x16x32_bf16 a[120:123], a[148:151], v[144:147], a[120:123]
v_mfma_f32_16x16x32_bf16 a[12:15], a[152:155], v[128:131], a[12:15]
v_mfma_f32_16x16x32_bf16 a[40:43], a[152:155], v[132:135], a[40:43]
v_mfma_f32_16x16x32_bf16 a[68:71], a[152:155], v[136:139], a[68:71]
v_mfma_f32_16x16x32_bf16 a[96:99], a[152:155], v[140:143], a[96:99]
v_mfma_f32_16x16x32_bf16 a[124:127], a[152:155], v[144:147], a[124:127]
s_waitcnt vmcnt(0) lgkmcnt(0)
v_mfma_f32_16x16x32_bf16 a[0:3], a[168:171], v[148:151], a[0:3]
v_mfma_f32_16x16x32_bf16 a[28:31], a[168:171], v[152:155], a[28:31]
ds_read_b128 a[156:159], v7 offset:4096
v_mfma_f32_16x16x32_bf16 a[56:59], a[168:171], v[156:159], a[56:59]
v_mfma_f32_16x16x32_bf16 a[84:87], a[168:171], v[160:163], a[84:87]
v_mfma_f32_16x16x32_bf16 a[112:115], a[168:171], v[164:167], a[112:115]
ds_read_b128 a[160:163], v7 offset:5120
v_mfma_f32_16x16x32_bf16 a[4:7], a[172:175], v[148:151], a[4:7]
v_mfma_f32_16x16x32_bf16 a[32:35], a[172:175], v[152:155], a[32:35]
v_mfma_f32_16x16x32_bf16 a[60:63], a[172:175], v[156:159], a[60:63]
ds_read_b128 a[164:167], v7 offset:6144
v_mfma_f32_16x16x32_bf16 a[88:91], a[172:175], v[160:163], a[88:91]
v_mfma_f32_16x16x32_bf16 a[116:119], a[172:175], v[164:167], a[116:119]
v_mfma_f32_16x16x32_bf16 a[8:11], a[176:179], v[148:151], a[8:11]
v_mfma_f32_16x16x32_bf16 a[36:39], a[176:179], v[152:155], a[36:39]
v_mfma_f32_16x16x32_bf16 a[64:67], a[176:179], v[156:159], a[64:67]
v_mfma_f32_16x16x32_bf16 a[92:95], a[176:179], v[160:163], a[92:95]
v_mfma_f32_16x16x32_bf16 a[120:123], a[176:179], v[164:167], a[120:123]
v_mfma_f32_16x16x32_bf16 a[12:15], a[180:183], v[148:151], a[12:15]
v_mfma_f32_16x16x32_bf16 a[40:43], a[180:183], v[152:155], a[40:43]
v_mfma_f32_16x16x32_bf16 a[68:71], a[180:183], v[156:159], a[68:71]
v_mfma_f32_16x16x32_bf16 a[96:99], a[180:183], v[160:163], a[96:99]
v_mfma_f32_16x16x32_bf16 a[124:127], a[180:183], v[164:167], a[124:127]
s_nop 3
s_waitcnt lgkmcnt(0)
v_mfma_f32_16x16x32_bf16 a[16:19], a[156:159], v[8:11], a[16:19]
v_mfma_f32_16x16x32_bf16 a[44:47], a[156:159], v[12:15], a[44:47]
ds_read_b128 a[184:187], v7 offset:11264
v_mfma_f32_16x16x32_bf16 a[72:75], a[156:159], v[16:19], a[72:75]
ds_read_b128 a[188:191], v7 offset:12288
v_mfma_f32_16x16x32_bf16 a[100:103], a[156:159], v[20:23], a[100:103]
v_mfma_f32_16x16x32_bf16 a[128:131], a[156:159], v[24:27], a[128:131]
ds_read_b128 a[192:195], v7 offset:13312
v_mfma_f32_16x16x32_bf16 a[20:23], a[160:163], v[8:11], a[20:23]
v_mfma_f32_16x16x32_bf16 a[48:51], a[160:163], v[12:15], a[48:51]
v_mfma_f32_16x16x32_bf16 a[76:79], a[160:163], v[16:19], a[76:79]
v_mfma_f32_16x16x32_bf16 a[104:107], a[160:163], v[20:23], a[104:107]
v_mfma_f32_16x16x32_bf16 a[132:135], a[160:163], v[24:27], a[132:135]
v_mfma_f32_16x16x32_bf16 a[24:27], a[164:167], v[8:11], a[24:27]
v_mfma_f32_16x16x32_bf16 a[52:55], a[164:167], v[12:15], a[52:55]
v_mfma_f32_16x16x32_bf16 a[80:83], a[164:167], v[16:19], a[80:83]
v_mfma_f32_16x16x32_bf16 a[108:111], a[164:167], v[20:23], a[108:111]
v_mfma_f32_16x16x32_bf16 a[136:139], a[164:167], v[24:27], a[136:139]
s_waitcnt lgkmcnt(0)
v_mfma_f32_16x16x32_bf16 a[16:19], a[184:187], v[28:31], a[16:19]
v_accvgpr_read_b32 v192, a0
v_accvgpr_read_b32 v193, a1
v_mfma_f32_16x16x32_bf16 a[44:47], a[184:187], v[32:35], a[44:47]
ds_read_b128 a[156:159], v7 offset:18432
v_accvgpr_read_b32 v194, a2
v_mfma_f32_16x16x32_bf16 a[72:75], a[184:187], v[36:39], a[72:75]
ds_read_b128 a[160:163], v7 offset:19456
v_accvgpr_read_b32 v195, a3
v_mfma_f32_16x16x32_bf16 a[100:103], a[184:187], v[40:43], a[100:103]
v_accvgpr_read_b32 v196, a4
v_accvgpr_read_b32 v197, a5
v_mfma_f32_16x16x32_bf16 a[128:131], a[184:187], v[44:47], a[128:131]
ds_read_b128 a[164:167], v7 offset:20480
v_accvgpr_read_b32 v198, a6
v_mfma_f32_16x16x32_bf16 a[20:23], a[188:191], v[28:31], a[20:23]
v_accvgpr_read_b32 v199, a7
v_cvt_pk_bf16_f32 v208, v192, v193
v_mfma_f32_16x16x32_bf16 a[48:51], a[188:191], v[32:35], a[48:51]
v_cvt_pk_bf16_f32 v209, v194, v195
v_cvt_pk_bf16_f32 v210, v196, v197
v_mfma_f32_16x16x32_bf16 a[76:79], a[188:191], v[36:39], a[76:79]
v_cvt_pk_bf16_f32 v211, v198, v199
s_mov_b32 s66, 0
v_mfma_f32_16x16x32_bf16 a[104:107], a[188:191], v[40:43], a[104:107]
buffer_store_dwordx4 v[208:211], v6, s[48:51], s66 offen offset:0 sc0 sc1
v_accvgpr_read_b32 v200, a8
v_mfma_f32_16x16x32_bf16 a[132:135], a[188:191], v[44:47], a[132:135]
v_accvgpr_read_b32 v201, a9
v_accvgpr_read_b32 v202, a10
v_mfma_f32_16x16x32_bf16 a[24:27], a[192:195], v[28:31], a[24:27]
v_accvgpr_read_b32 v203, a11
v_accvgpr_read_b32 v204, a12
v_mfma_f32_16x16x32_bf16 a[52:55], a[192:195], v[32:35], a[52:55]
v_accvgpr_read_b32 v205, a13
v_accvgpr_read_b32 v206, a14
v_mfma_f32_16x16x32_bf16 a[80:83], a[192:195], v[36:39], a[80:83]
v_accvgpr_read_b32 v207, a15
v_cvt_pk_bf16_f32 v212, v200, v201
v_mfma_f32_16x16x32_bf16 a[108:111], a[192:195], v[40:43], a[108:111]
v_cvt_pk_bf16_f32 v213, v202, v203
v_cvt_pk_bf16_f32 v214, v204, v205
v_mfma_f32_16x16x32_bf16 a[136:139], a[192:195], v[44:47], a[136:139]
v_cvt_pk_bf16_f32 v215, v206, v207
s_mov_b32 s66, 0
buffer_store_dwordx4 v[212:215], v6, s[48:51], s66 offen offset:1024 sc0 sc1
s_waitcnt lgkmcnt(0)
v_mfma_f32_16x16x32_bf16 a[16:19], a[156:159], v[48:51], a[16:19]
v_accvgpr_read_b32 v192, a28
v_accvgpr_read_b32 v193, a29
v_mfma_f32_16x16x32_bf16 a[44:47], a[156:159], v[52:55], a[44:47]
ds_read_b128 a[184:187], v7 offset:25600
v_accvgpr_read_b32 v194, a30
v_mfma_f32_16x16x32_bf16 a[72:75], a[156:159], v[56:59], a[72:75]
ds_read_b128 a[188:191], v7 offset:26624
v_accvgpr_read_b32 v195, a31
v_mfma_f32_16x16x32_bf16 a[100:103], a[156:159], v[60:63], a[100:103]
v_accvgpr_read_b32 v196, a32
v_accvgpr_read_b32 v197, a33
v_mfma_f32_16x16x32_bf16 a[128:131], a[156:159], v[64:67], a[128:131]
ds_read_b128 a[192:195], v7 offset:27648
v_accvgpr_read_b32 v198, a34
v_mfma_f32_16x16x32_bf16 a[20:23], a[160:163], v[48:51], a[20:23]
v_accvgpr_read_b32 v199, a35
v_cvt_pk_bf16_f32 v216, v192, v193
v_mfma_f32_16x16x32_bf16 a[48:51], a[160:163], v[52:55], a[48:51]
v_cvt_pk_bf16_f32 v217, v194, v195
v_cvt_pk_bf16_f32 v218, v196, v197
v_mfma_f32_16x16x32_bf16 a[76:79], a[160:163], v[56:59], a[76:79]
v_cvt_pk_bf16_f32 v219, v198, v199
s_mov_b32 s66, 0
v_mfma_f32_16x16x32_bf16 a[104:107], a[160:163], v[60:63], a[104:107]
buffer_store_dwordx4 v[216:219], v6, s[48:51], s66 offen offset:2048 sc0 sc1
v_accvgpr_read_b32 v200, a36
v_mfma_f32_16x16x32_bf16 a[132:135], a[160:163], v[64:67], a[132:135]
v_accvgpr_read_b32 v201, a37
v_accvgpr_read_b32 v202, a38
v_mfma_f32_16x16x32_bf16 a[24:27], a[164:167], v[48:51], a[24:27]
v_accvgpr_read_b32 v203, a39
v_accvgpr_read_b32 v204, a40
v_mfma_f32_16x16x32_bf16 a[52:55], a[164:167], v[52:55], a[52:55]
v_accvgpr_read_b32 v205, a41
v_accvgpr_read_b32 v206, a42
v_mfma_f32_16x16x32_bf16 a[80:83], a[164:167], v[56:59], a[80:83]
v_accvgpr_read_b32 v207, a43
v_cvt_pk_bf16_f32 v220, v200, v201
v_mfma_f32_16x16x32_bf16 a[108:111], a[164:167], v[60:63], a[108:111]
v_cvt_pk_bf16_f32 v221, v202, v203
v_cvt_pk_bf16_f32 v222, v204, v205
v_mfma_f32_16x16x32_bf16 a[136:139], a[164:167], v[64:67], a[136:139]
v_cvt_pk_bf16_f32 v223, v206, v207
s_mov_b32 s66, 0
buffer_store_dwordx4 v[220:223], v6, s[48:51], s66 offen offset:3072 sc0 sc1
s_waitcnt lgkmcnt(0)
v_mfma_f32_16x16x32_bf16 a[16:19], a[184:187], v[68:71], a[16:19]
v_accvgpr_read_b32 v192, a56
v_accvgpr_read_b32 v193, a57
v_mfma_f32_16x16x32_bf16 a[44:47], a[184:187], v[72:75], a[44:47]
ds_read_b128 a[156:159], v7 offset:32768
v_accvgpr_read_b32 v194, a58
v_mfma_f32_16x16x32_bf16 a[72:75], a[184:187], v[76:79], a[72:75]
ds_read_b128 a[160:163], v7 offset:33792
v_accvgpr_read_b32 v195, a59
v_mfma_f32_16x16x32_bf16 a[100:103], a[184:187], v[80:83], a[100:103]
v_accvgpr_read_b32 v196, a60
v_accvgpr_read_b32 v197, a61
v_mfma_f32_16x16x32_bf16 a[128:131], a[184:187], v[84:87], a[128:131]
ds_read_b128 a[164:167], v7 offset:34816
v_accvgpr_read_b32 v198, a62
v_mfma_f32_16x16x32_bf16 a[20:23], a[188:191], v[68:71], a[20:23]
v_accvgpr_read_b32 v199, a63
v_cvt_pk_bf16_f32 v208, v192, v193
v_mfma_f32_16x16x32_bf16 a[48:51], a[188:191], v[72:75], a[48:51]
v_cvt_pk_bf16_f32 v209, v194, v195
v_cvt_pk_bf16_f32 v210, v196, v197
v_mfma_f32_16x16x32_bf16 a[76:79], a[188:191], v[76:79], a[76:79]
v_cvt_pk_bf16_f32 v211, v198, v199
s_mov_b32 s66, 4096
v_mfma_f32_16x16x32_bf16 a[104:107], a[188:191], v[80:83], a[104:107]
buffer_store_dwordx4 v[208:211], v6, s[48:51], s66 offen offset:0 sc0 sc1
v_accvgpr_read_b32 v200, a64
v_mfma_f32_16x16x32_bf16 a[132:135], a[188:191], v[84:87], a[132:135]
v_accvgpr_read_b32 v201, a65
v_accvgpr_read_b32 v202, a66
v_mfma_f32_16x16x32_bf16 a[24:27], a[192:195], v[68:71], a[24:27]
v_accvgpr_read_b32 v203, a67
v_accvgpr_read_b32 v204, a68
v_mfma_f32_16x16x32_bf16 a[52:55], a[192:195], v[72:75], a[52:55]
v_accvgpr_read_b32 v205, a69
v_accvgpr_read_b32 v206, a70
v_mfma_f32_16x16x32_bf16 a[80:83], a[192:195], v[76:79], a[80:83]
v_accvgpr_read_b32 v207, a71
v_cvt_pk_bf16_f32 v212, v200, v201
v_mfma_f32_16x16x32_bf16 a[108:111], a[192:195], v[80:83], a[108:111]
v_cvt_pk_bf16_f32 v213, v202, v203
v_cvt_pk_bf16_f32 v214, v204, v205
v_mfma_f32_16x16x32_bf16 a[136:139], a[192:195], v[84:87], a[136:139]
v_cvt_pk_bf16_f32 v215, v206, v207
s_mov_b32 s66, 4096
buffer_store_dwordx4 v[212:215], v6, s[48:51], s66 offen offset:1024 sc0 sc1
s_waitcnt lgkmcnt(0)
v_mfma_f32_16x16x32_bf16 a[16:19], a[156:159], v[88:91], a[16:19]
v_accvgpr_read_b32 v192, a84
v_accvgpr_read_b32 v193, a85
v_mfma_f32_16x16x32_bf16 a[44:47], a[156:159], v[92:95], a[44:47]
ds_read_b128 a[184:187], v7 offset:39936
v_accvgpr_read_b32 v194, a86
v_mfma_f32_16x16x32_bf16 a[72:75], a[156:159], v[96:99], a[72:75]
ds_read_b128 a[188:191], v7 offset:40960
v_accvgpr_read_b32 v195, a87
v_mfma_f32_16x16x32_bf16 a[100:103], a[156:159], v[100:103], a[100:103]
v_accvgpr_read_b32 v196, a88
v_accvgpr_read_b32 v197, a89
v_mfma_f32_16x16x32_bf16 a[128:131], a[156:159], v[104:107], a[128:131]
ds_read_b128 a[192:195], v7 offset:41984
v_accvgpr_read_b32 v198, a90
v_mfma_f32_16x16x32_bf16 a[20:23], a[160:163], v[88:91], a[20:23]
v_accvgpr_read_b32 v199, a91
v_cvt_pk_bf16_f32 v216, v192, v193
v_mfma_f32_16x16x32_bf16 a[48:51], a[160:163], v[92:95], a[48:51]
v_cvt_pk_bf16_f32 v217, v194, v195
v_cvt_pk_bf16_f32 v218, v196, v197
v_mfma_f32_16x16x32_bf16 a[76:79], a[160:163], v[96:99], a[76:79]
v_cvt_pk_bf16_f32 v219, v198, v199
s_mov_b32 s66, 4096
v_mfma_f32_16x16x32_bf16 a[104:107], a[160:163], v[100:103], a[104:107]
buffer_store_dwordx4 v[216:219], v6, s[48:51], s66 offen offset:2048 sc0 sc1
v_accvgpr_read_b32 v200, a92
v_mfma_f32_16x16x32_bf16 a[132:135], a[160:163], v[104:107], a[132:135]
v_accvgpr_read_b32 v201, a93
v_accvgpr_read_b32 v202, a94
v_mfma_f32_16x16x32_bf16 a[24:27], a[164:167], v[88:91], a[24:27]
v_accvgpr_read_b32 v203, a95
v_accvgpr_read_b32 v204, a96
v_mfma_f32_16x16x32_bf16 a[52:55], a[164:167], v[92:95], a[52:55]
v_accvgpr_read_b32 v205, a97
v_accvgpr_read_b32 v206, a98
v_mfma_f32_16x16x32_bf16 a[80:83], a[164:167], v[96:99], a[80:83]
v_accvgpr_read_b32 v207, a99
v_cvt_pk_bf16_f32 v220, v200, v201
v_mfma_f32_16x16x32_bf16 a[108:111], a[164:167], v[100:103], a[108:111]
v_cvt_pk_bf16_f32 v221, v202, v203
v_cvt_pk_bf16_f32 v222, v204, v205
v_mfma_f32_16x16x32_bf16 a[136:139], a[164:167], v[104:107], a[136:139]
v_cvt_pk_bf16_f32 v223, v206, v207
s_mov_b32 s66, 4096
buffer_store_dwordx4 v[220:223], v6, s[48:51], s66 offen offset:3072 sc0 sc1
s_waitcnt lgkmcnt(0)
v_mfma_f32_16x16x32_bf16 a[16:19], a[184:187], v[108:111], a[16:19]
v_accvgpr_read_b32 v192, a112
v_accvgpr_read_b32 v193, a113
v_mfma_f32_16x16x32_bf16 a[44:47], a[184:187], v[112:115], a[44:47]
ds_read_b128 a[156:159], v7 offset:47104
v_accvgpr_read_b32 v194, a114
v_mfma_f32_16x16x32_bf16 a[72:75], a[184:187], v[116:119], a[72:75]
ds_read_b128 a[160:163], v7 offset:48128
v_accvgpr_read_b32 v195, a115
v_mfma_f32_16x16x32_bf16 a[100:103], a[184:187], v[120:123], a[100:103]
v_accvgpr_read_b32 v196, a116
v_accvgpr_read_b32 v197, a117
v_mfma_f32_16x16x32_bf16 a[128:131], a[184:187], v[124:127], a[128:131]
ds_read_b128 a[164:167], v7 offset:49152
v_accvgpr_read_b32 v198, a118
v_mfma_f32_16x16x32_bf16 a[20:23], a[188:191], v[108:111], a[20:23]
v_accvgpr_read_b32 v199, a119
v_cvt_pk_bf16_f32 v208, v192, v193
v_mfma_f32_16x16x32_bf16 a[48:51], a[188:191], v[112:115], a[48:51]
v_cvt_pk_bf16_f32 v209, v194, v195
v_cvt_pk_bf16_f32 v210, v196, v197
v_mfma_f32_16x16x32_bf16 a[76:79], a[188:191], v[116:119], a[76:79]
v_cvt_pk_bf16_f32 v211, v198, v199
s_mov_b32 s66, 8192
v_mfma_f32_16x16x32_bf16 a[104:107], a[188:191], v[120:123], a[104:107]
buffer_store_dwordx4 v[208:211], v6, s[48:51], s66 offen offset:0 sc0 sc1
v_accvgpr_read_b32 v200, a120
v_mfma_f32_16x16x32_bf16 a[132:135], a[188:191], v[124:127], a[132:135]
v_accvgpr_read_b32 v201, a121
v_accvgpr_read_b32 v202, a122
v_mfma_f32_16x16x32_bf16 a[24:27], a[192:195], v[108:111], a[24:27]
v_accvgpr_read_b32 v203, a123
v_accvgpr_read_b32 v204, a124
v_mfma_f32_16x16x32_bf16 a[52:55], a[192:195], v[112:115], a[52:55]
v_accvgpr_read_b32 v205, a125
v_accvgpr_read_b32 v206, a126
v_mfma_f32_16x16x32_bf16 a[80:83], a[192:195], v[116:119], a[80:83]
v_accvgpr_read_b32 v207, a127
v_cvt_pk_bf16_f32 v212, v200, v201
v_mfma_f32_16x16x32_bf16 a[108:111], a[192:195], v[120:123], a[108:111]
v_cvt_pk_bf16_f32 v213, v202, v203
v_cvt_pk_bf16_f32 v214, v204, v205
v_mfma_f32_16x16x32_bf16 a[136:139], a[192:195], v[124:127], a[136:139]
v_cvt_pk_bf16_f32 v215, v206, v207
s_mov_b32 s66, 8192
buffer_store_dwordx4 v[212:215], v6, s[48:51], s66 offen offset:1024 sc0 sc1
s_waitcnt lgkmcnt(0)
v_mfma_f32_16x16x32_bf16 a[16:19], a[156:159], v[128:131], a[16:19]
v_mfma_f32_16x16x32_bf16 a[44:47], a[156:159], v[132:135], a[44:47]
ds_read_b128 a[184:187], v7 offset:54272
v_mfma_f32_16x16x32_bf16 a[72:75], a[156:159], v[136:139], a[72:75]
ds_read_b128 a[188:191], v7 offset:55296
v_mfma_f32_16x16x32_bf16 a[100:103], a[156:159], v[140:143], a[100:103]
v_mfma_f32_16x16x32_bf16 a[128:131], a[156:159], v[144:147], a[128:131]
ds_read_b128 a[192:195], v7 offset:56320
v_mfma_f32_16x16x32_bf16 a[20:23], a[160:163], v[128:131], a[20:23]
v_mfma_f32_16x16x32_bf16 a[48:51], a[160:163], v[132:135], a[48:51]
v_mfma_f32_16x16x32_bf16 a[76:79], a[160:163], v[136:139], a[76:79]
v_mfma_f32_16x16x32_bf16 a[104:107], a[160:163], v[140:143], a[104:107]
v_mfma_f32_16x16x32_bf16 a[132:135], a[160:163], v[144:147], a[132:135]
v_mfma_f32_16x16x32_bf16 a[24:27], a[164:167], v[128:131], a[24:27]
v_mfma_f32_16x16x32_bf16 a[52:55], a[164:167], v[132:135], a[52:55]
v_mfma_f32_16x16x32_bf16 a[80:83], a[164:167], v[136:139], a[80:83]
v_mfma_f32_16x16x32_bf16 a[108:111], a[164:167], v[140:143], a[108:111]
v_mfma_f32_16x16x32_bf16 a[136:139], a[164:167], v[144:147], a[136:139]
s_waitcnt lgkmcnt(0)
v_mfma_f32_16x16x32_bf16 a[16:19], a[184:187], v[148:151], a[16:19]
v_mfma_f32_16x16x32_bf16 a[44:47], a[184:187], v[152:155], a[44:47]
v_mfma_f32_16x16x32_bf16 a[72:75], a[184:187], v[156:159], a[72:75]
v_mfma_f32_16x16x32_bf16 a[100:103], a[184:187], v[160:163], a[100:103]
v_mfma_f32_16x16x32_bf16 a[128:131], a[184:187], v[164:167], a[128:131]
v_mfma_f32_16x16x32_bf16 a[20:23], a[188:191], v[148:151], a[20:23]
v_mfma_f32_16x16x32_bf16 a[48:51], a[188:191], v[152:155], a[48:51]
v_mfma_f32_16x16x32_bf16 a[76:79], a[188:191], v[156:159], a[76:79]
v_mfma_f32_16x16x32_bf16 a[104:107], a[188:191], v[160:163], a[104:107]
v_mfma_f32_16x16x32_bf16 a[132:135], a[188:191], v[164:167], a[132:135]
v_mfma_f32_16x16x32_bf16 a[24:27], a[192:195], v[148:151], a[24:27]
v_mfma_f32_16x16x32_bf16 a[52:55], a[192:195], v[152:155], a[52:55]
v_mfma_f32_16x16x32_bf16 a[80:83], a[192:195], v[156:159], a[80:83]
v_mfma_f32_16x16x32_bf16 a[108:111], a[192:195], v[160:163], a[108:111]
v_mfma_f32_16x16x32_bf16 a[136:139], a[192:195], v[164:167], a[136:139]
s_nop 7
v_accvgpr_read_b32 v192, a16
v_accvgpr_read_b32 v193, a17
v_accvgpr_read_b32 v194, a18
v_accvgpr_read_b32 v195, a19
v_accvgpr_read_b32 v196, a20
v_accvgpr_read_b32 v197, a21
v_accvgpr_read_b32 v198, a22
v_accvgpr_read_b32 v199, a23
v_cvt_pk_bf16_f32 v216, v192, v193
v_cvt_pk_bf16_f32 v217, v194, v195
v_cvt_pk_bf16_f32 v218, v196, v197
v_cvt_pk_bf16_f32 v219, v198, v199
s_mov_b32 s66, 8192
buffer_store_dwordx4 v[216:219], v6, s[48:51], s66 offen offset:2048 sc0 sc1
v_accvgpr_read_b32 v200, a44
v_accvgpr_read_b32 v201, a45
v_accvgpr_read_b32 v202, a46
v_accvgpr_read_b32 v203, a47
v_accvgpr_read_b32 v204, a48
v_accvgpr_read_b32 v205, a49
v_accvgpr_read_b32 v206, a50
v_accvgpr_read_b32 v207, a51
v_cvt_pk_bf16_f32 v220, v200, v201
v_cvt_pk_bf16_f32 v221, v202, v203
v_cvt_pk_bf16_f32 v222, v204, v205
v_cvt_pk_bf16_f32 v223, v206, v207
s_mov_b32 s66, 8192
buffer_store_dwordx4 v[220:223], v6, s[48:51], s66 offen offset:3072 sc0 sc1
v_accvgpr_read_b32 v192, a72
v_accvgpr_read_b32 v193, a73
v_accvgpr_read_b32 v194, a74
v_accvgpr_read_b32 v195, a75
v_accvgpr_read_b32 v196, a76
v_accvgpr_read_b32 v197, a77
v_accvgpr_read_b32 v198, a78
v_accvgpr_read_b32 v199, a79
v_cvt_pk_bf16_f32 v208, v192, v193
v_cvt_pk_bf16_f32 v209, v194, v195
v_cvt_pk_bf16_f32 v210, v196, v197
v_cvt_pk_bf16_f32 v211, v198, v199
s_mov_b32 s66, 12288
buffer_store_dwordx4 v[208:211], v6, s[48:51], s66 offen offset:0 sc0 sc1
v_accvgpr_read_b32 v200, a100
v_accvgpr_read_b32 v201, a101
v_accvgpr_read_b32 v202, a102
v_accvgpr_read_b32 v203, a103
v_accvgpr_read_b32 v204, a104
v_accvgpr_read_b32 v205, a105
v_accvgpr_read_b32 v206, a106
v_accvgpr_read_b32 v207, a107
v_cvt_pk_bf16_f32 v212, v200, v201
v_cvt_pk_bf16_f32 v213, v202, v203
v_cvt_pk_bf16_f32 v214, v204, v205
v_cvt_pk_bf16_f32 v215, v206, v207
s_mov_b32 s66, 12288
buffer_store_dwordx4 v[212:215], v6, s[48:51], s66 offen offset:1024 sc0 sc1
v_accvgpr_read_b32 v192, a128
v_accvgpr_read_b32 v193, a129
v_accvgpr_read_b32 v194, a130
v_accvgpr_read_b32 v195, a131
v_accvgpr_read_b32 v196, a132
v_accvgpr_read_b32 v197, a133
v_accvgpr_read_b32 v198, a134
v_accvgpr_read_b32 v199, a135
v_cvt_pk_bf16_f32 v216, v192, v193
v_cvt_pk_bf16_f32 v217, v194, v195
v_cvt_pk_bf16_f32 v218, v196, v197
v_cvt_pk_bf16_f32 v219, v198, v199
s_mov_b32 s66, 12288
buffer_store_dwordx4 v[216:219], v6, s[48:51], s66 offen offset:2048 sc0 sc1
v_accvgpr_read_b32 v200, a24
v_accvgpr_read_b32 v201, a25
v_accvgpr_read_b32 v202, a26
v_accvgpr_read_b32 v203, a27
v_accvgpr_read_b32 v204, a52
v_accvgpr_read_b32 v205, a53
v_accvgpr_read_b32 v206, a54
v_accvgpr_read_b32 v207, a55
v_cvt_pk_bf16_f32 v220, v200, v201
v_cvt_pk_bf16_f32 v221, v202, v203
v_cvt_pk_bf16_f32 v222, v204, v205
v_cvt_pk_bf16_f32 v223, v206, v207
s_mov_b32 s66, 12288
buffer_store_dwordx4 v[220:223], v6, s[48:51], s66 offen offset:3072 sc0 sc1
v_accvgpr_read_b32 v192, a80
v_accvgpr_read_b32 v193, a81
v_accvgpr_read_b32 v194, a82
v_accvgpr_read_b32 v195, a83
v_accvgpr_read_b32 v196, a108
v_accvgpr_read_b32 v197, a109
v_accvgpr_read_b32 v198, a110
v_accvgpr_read_b32 v199, a111
v_cvt_pk_bf16_f32 v208, v192, v193
v_cvt_pk_bf16_f32 v209, v194, v195
v_cvt_pk_bf16_f32 v210, v196, v197
v_cvt_pk_bf16_f32 v211, v198, v199
s_mov_b32 s66, 16384
buffer_store_dwordx4 v[208:211], v6, s[48:51], s66 offen offset:0 sc0 sc1
v_accvgpr_read_b32 v200, a136
v_accvgpr_read_b32 v201, a137
v_accvgpr_read_b32 v202, a138
v_accvgpr_read_b32 v203, a139
v_accvgpr_read_b32 v204, a136
v_accvgpr_read_b32 v205, a137
v_accvgpr_read_b32 v206, a138
v_accvgpr_read_b32 v207, a139
v_cvt_pk_bf16_f32 v212, v200, v201
v_cvt_pk_bf16_f32 v213, v202, v203
v_cvt_pk_bf16_f32 v214, v204, v205
v_cvt_pk_bf16_f32 v215, v206, v207
s_mov_b32 s66, 16384
buffer_store_dwordx4 v[212:215], v6, s[48:51], s66 offen offset:1024 sc0 sc1
s_add_u32 s20, s80, s70
s_addc_u32 s21, s81, 0
s_mov_b32 s22, 73728
s_mov_b32 s23, 0x20000
s_cmp_eq_u32 s60, 3
s_cselect_b32 s64, 4, 5
s_cselect_b32 s65, 14, 18
v_lshrrev_b32 v40, 4, v6
v_and_b32 v41, 15, v40
v_lshrrev_b32 v42, 4, v40
v_mul_u32_u24 v41, 1792, v41
v_lshlrev_b32 v42, 3, v42
v_add_u32 v43, v41, v42
v_and_b32 v134, 15, v40
v_lshrrev_b32 v135, 4, v40
v_lshlrev_b32 v135, 2, v135
v_sub_u32 v134, v134, v135
s_mov_b32 s52, 0x3f80
s_mov_b32 s53, 0x3f800000
v_mov_b32 v130, 0
v_mov_b32 v136, s52
v_cmp_eq_u32 vcc, 0, v134
s_nop 1
v_cndmask_b32 v130, v130, v136, vcc
v_mov_b32 v136, s53
v_cmp_eq_u32 vcc, 1, v134
s_nop 1
v_cndmask_b32 v130, v130, v136, vcc
v_mov_b32 v131, 0
v_mov_b32 v136, s52
v_cmp_eq_u32 vcc, 2, v134
s_nop 1
v_cndmask_b32 v131, v131, v136, vcc
v_mov_b32 v136, s53
v_cmp_eq_u32 vcc, 3, v134
s_nop 1
v_cndmask_b32 v131, v131, v136, vcc
v_mov_b32 v128, 0
v_mov_b32 v129, 0
v_mov_b32 v132, 0
v_mov_b32 v133, 0
s_lshl_b32 s54, s64, 1
s_mul_i32 s55, s64, 3
s_add_u32 s66, s27, 0
s_sub_u32 s58, s66, s54
s_sub_u32 s59, s66, s55
s_lshl_b32 s59, s59, 1
s_cmp_lt_u32 s66, s55
s_cselect_b32 s67, s58, s59
s_cselect_b32 s68, 4, 6
s_cselect_b32 s62, 0, 1
s_cselect_b32 s63, 1, 0
s_lshr_b32 s58, s66, 1
s_and_b32 s59, s66, 1
s_lshl_b32 s59, s59, 1
s_cmp_lt_u32 s66, s54
s_cselect_b32 s67, s58, s67
s_cselect_b32 s68, s59, s68
s_cselect_b32 s62, 0, s62
s_cselect_b32 s63, 1, s63
s_mul_i32 s58, s67, 28672
s_lshl_b32 s59, s68, 5
s_add_u32 s4, s58, s59
s_add_u32 s14, s67, s62
s_add_u32 s68, s68, s63
s_mul_i32 s58, s14, 28672
s_lshl_b32 s59, s68, 5
s_add_u32 s9, s58, s59
s_add_u32 s66, s27, 4
s_sub_u32 s58, s66, s54
s_sub_u32 s59, s66, s55
s_lshl_b32 s59, s59, 1
s_cmp_lt_u32 s66, s55
s_cselect_b32 s67, s58, s59
s_cselect_b32 s68, 4, 6
s_cselect_b32 s62, 0, 1
s_cselect_b32 s63, 1, 0
s_lshr_b32 s58, s66, 1
s_and_b32 s59, s66, 1
s_lshl_b32 s59, s59, 1
s_cmp_lt_u32 s66, s54
s_cselect_b32 s67, s58, s67
s_cselect_b32 s68, s59, s68
s_cselect_b32 s62, 0, s62
s_cselect_b32 s63, 1, s63
s_mul_i32 s58, s67, 28672
s_lshl_b32 s59, s68, 5
s_add_u32 s5, s58, s59
s_add_u32 s15, s67, s62
s_add_u32 s68, s68, s63
s_mul_i32 s58, s15, 28672
s_lshl_b32 s59, s68, 5
s_add_u32 s10, s58, s59
s_add_u32 s66, s27, 8
s_sub_u32 s58, s66, s54
s_sub_u32 s59, s66, s55
s_lshl_b32 s59, s59, 1
s_cmp_lt_u32 s66, s55
s_cselect_b32 s67, s58, s59
s_cselect_b32 s68, 4, 6
s_cselect_b32 s62, 0, 1
s_cselect_b32 s63, 1, 0
s_lshr_b32 s58, s66, 1
s_and_b32 s59, s66, 1
s_lshl_b32 s59, s59, 1
s_cmp_lt_u32 s66, s54
s_cselect_b32 s67, s58, s67
s_cselect_b32 s68, s59, s68
s_cselect_b32 s62, 0, s62
s_cselect_b32 s63, 1, s63
s_mul_i32 s58, s67, 28672
s_lshl_b32 s59, s68, 5
s_add_u32 s6, s58, s59
s_add_u32 s16, s67, s62
s_add_u32 s68, s68, s63
s_mul_i32 s58, s16, 28672
s_lshl_b32 s59, s68, 5
s_add_u32 s11, s58, s59
s_add_u32 s66, s27, 12
s_sub_u32 s58, s66, s54
s_sub_u32 s59, s66, s55
s_lshl_b32 s59, s59, 1
s_cmp_lt_u32 s66, s55
s_cselect_b32 s67, s58, s59
s_cselect_b32 s68, 4, 6
s_cselect_b32 s62, 0, 1
s_cselect_b32 s63, 1, 0
s_lshr_b32 s58, s66, 1
s_and_b32 s59, s66, 1
s_lshl_b32 s59, s59, 1
s_cmp_lt_u32 s66, s54
s_cselect_b32 s67, s58, s67
s_cselect_b32 s68, s59, s68
s_cselect_b32 s62, 0, s62
s_cselect_b32 s63, 1, s63
s_mul_i32 s58, s67, 28672
s_lshl_b32 s59, s68, 5
s_add_u32 s7, s58, s59
s_add_u32 s17, s67, s62
s_add_u32 s68, s68, s63
s_mul_i32 s58, s17, 28672
s_lshl_b32 s59, s68, 5
s_add_u32 s12, s58, s59
s_add_u32 s66, s27, 16
s_sub_u32 s58, s66, s54
s_sub_u32 s59, s66, s55
s_lshl_b32 s59, s59, 1
s_cmp_lt_u32 s66, s55
s_cselect_b32 s67, s58, s59
s_cselect_b32 s68, 4, 6
s_cselect_b32 s62, 0, 1
s_cselect_b32 s63, 1, 0
s_lshr_b32 s58, s66, 1
s_and_b32 s59, s66, 1
s_lshl_b32 s59, s59, 1
s_cmp_lt_u32 s66, s54
s_cselect_b32 s67, s58, s67
s_cselect_b32 s68, s59, s68
s_cselect_b32 s62, 0, s62
s_cselect_b32 s63, 1, s63
s_mul_i32 s58, s67, 28672
s_lshl_b32 s59, s68, 5
s_add_u32 s8, s58, s59
s_add_u32 s18, s67, s62
s_add_u32 s68, s68, s63
s_mul_i32 s58, s18, 28672
s_lshl_b32 s59, s68, 5
s_add_u32 s13, s58, s59
s_waitcnt vmcnt(0)
v_mov_b32 v186, 0
v_mov_b32 v187, 1
s_mov_b64 exec, 1
global_atomic_add v186, v187, s[76:77]
s_mov_b64 exec, -1
s_add_u32 s76, s80, s3
s_addc_u32 s77, s81, 0
v_mov_b32 v186, 0
s_mov_b32 s58, 0x20000
L_p2r5:
global_load_dword v187, v186, s[76:77] sc1
s_waitcnt vmcnt(0)
v_readfirstlane_b32 s59, v187
s_nop 3
s_cmp_ge_u32 s59, 4
s_cbranch_scc1 L_pd2r5
s_sub_u32 s58, s58, 1
s_cmp_lg_u32 s58, 0
s_cbranch_scc1 L_p2r5
L_pd2r5:
s_waitcnt vmcnt(0)
s_add_u32 s58, s27, 0
s_lshl_b32 s58, s58, 10
buffer_load_dwordx4 v[48:51], v6, s[20:23], s58 offen sc1
s_add_u32 s58, s58, 18432
buffer_load_dwordx4 v[52:55], v6, s[20:23], s58 offen sc1
s_add_u32 s58, s58, 18432
buffer_load_dwordx4 v[56:59], v6, s[20:23], s58 offen sc1
s_add_u32 s58, s58, 18432
buffer_load_dwordx4 v[60:63], v6, s[20:23], s58 offen sc1
s_add_u32 s58, s27, 4
s_lshl_b32 s58, s58, 10
buffer_load_dwordx4 v[64:67], v6, s[20:23], s58 offen sc1
s_add_u32 s58, s58, 18432
buffer_load_dwordx4 v[68:71], v6, s[20:23], s58 offen sc1
s_add_u32 s58, s58, 18432
buffer_load_dwordx4 v[72:75], v6, s[20:23], s58 offen sc1
s_add_u32 s58, s58, 18432
buffer_load_dwordx4 v[76:79], v6, s[20:23], s58 offen sc1
s_add_u32 s58, s27, 8
s_lshl_b32 s58, s58, 10
buffer_load_dwordx4 v[80:83], v6, s[20:23], s58 offen sc1
s_add_u32 s58, s58, 18432
buffer_load_dwordx4 v[84:87], v6, s[20:23], s58 offen sc1
s_add_u32 s58, s58, 18432
buffer_load_dwordx4 v[88:91], v6, s[20:23], s58 offen sc1
s_add_u32 s58, s58, 18432
buffer_load_dwordx4 v[92:95], v6, s[20:23], s58 offen sc1
s_add_u32 s58, s27, 12
s_lshl_b32 s58, s58, 10
buffer_load_dwordx4 v[96:99], v6, s[20:23], s58 offen sc1
s_add_u32 s58, s58, 18432
buffer_load_dwordx4 v[100:103], v6, s[20:23], s58 offen sc1
s_add_u32 s58, s58, 18432
buffer_load_dwordx4 v[104:107], v6, s[20:23], s58 offen sc1
s_add_u32 s58, s58, 18432
buffer_load_dwordx4 v[108:111], v6, s[20:23], s58 offen sc1
s_add_u32 s58, s27, 16
s_lshl_b32 s58, s58, 10
buffer_load_dwordx4 v[112:115], v6, s[20:23], s58 offen sc1
s_add_u32 s58, s58, 18432
buffer_load_dwordx4 v[116:119], v6, s[20:23], s58 offen sc1
s_add_u32 s58, s58, 18432
buffer_load_dwordx4 v[120:123], v6, s[20:23], s58 offen sc1
s_add_u32 s58, s58, 18432
buffer_load_dwordx4 v[124:127], v6, s[20:23], s58 offen sc1
s_add_u32 s66, s27, 0
s_waitcnt vmcnt(16)
s_cmp_ge_u32 s66, s65
s_cbranch_scc1 L_fin_r5_0
v_mfma_f32_16x16x32_bf16 v[140:143], v[130:133], v[48:51], 0
v_mfma_f32_16x16x32_bf16 v[144:147], v[128:131], v[48:51], 0
v_mfma_f32_16x16x32_bf16 v[140:143], v[130:133], v[52:55], v[140:143]
v_mfma_f32_16x16x32_bf16 v[144:147], v[128:131], v[52:55], v[144:147]
v_mfma_f32_16x16x32_bf16 v[140:143], v[130:133], v[56:59], v[140:143]
v_mfma_f32_16x16x32_bf16 v[144:147], v[128:131], v[56:59], v[144:147]
v_mfma_f32_16x16x32_bf16 v[140:143], v[130:133], v[60:63], v[140:143]
v_mfma_f32_16x16x32_bf16 v[144:147], v[128:131], v[60:63], v[144:147]
s_nop 7
v_cvt_pk_bf16_f32 v156, v140, v141
v_cvt_pk_bf16_f32 v157, v142, v143
v_cvt_pk_bf16_f32 v158, v144, v145
v_cvt_pk_bf16_f32 v159, v146, v147
buffer_store_dwordx2 v[156:157], v43, s[44:47], s4 offen
s_cmp_ge_u32 s14, s64
s_cbranch_scc1 L_fin_r5_0
buffer_store_dwordx2 v[158:159], v43, s[44:47], s9 offen
L_fin_r5_0:
s_add_u32 s66, s27, 4
s_waitcnt vmcnt(14)
s_cmp_ge_u32 s66, s65
s_cbranch_scc1 L_fin_r5_1
v_mfma_f32_16x16x32_bf16 v[148:151], v[130:133], v[64:67], 0
v_mfma_f32_16x16x32_bf16 v[152:155], v[128:131], v[64:67], 0
v_mfma_f32_16x16x32_bf16 v[148:151], v[130:133], v[68:71], v[148:151]
v_mfma_f32_16x16x32_bf16 v[152:155], v[128:131], v[68:71], v[152:155]
v_mfma_f32_16x16x32_bf16 v[148:151], v[130:133], v[72:75], v[148:151]
v_mfma_f32_16x16x32_bf16 v[152:155], v[128:131], v[72:75], v[152:155]
v_mfma_f32_16x16x32_bf16 v[148:151], v[130:133], v[76:79], v[148:151]
v_mfma_f32_16x16x32_bf16 v[152:155], v[128:131], v[76:79], v[152:155]
s_nop 7
v_cvt_pk_bf16_f32 v160, v148, v149
v_cvt_pk_bf16_f32 v161, v150, v151
v_cvt_pk_bf16_f32 v162, v152, v153
v_cvt_pk_bf16_f32 v163, v154, v155
buffer_store_dwordx2 v[160:161], v43, s[44:47], s5 offen
s_cmp_ge_u32 s15, s64
s_cbranch_scc1 L_fin_r5_1
buffer_store_dwordx2 v[162:163], v43, s[44:47], s10 offen
L_fin_r5_1:
s_add_u32 s66, s27, 8
s_waitcnt vmcnt(12)
s_cmp_ge_u32 s66, s65
s_cbranch_scc1 L_fin_r5_2
v_mfma_f32_16x16x32_bf16 v[140:143], v[130:133], v[80:83], 0
v_mfma_f32_16x16x32_bf16 v[144:147], v[128:131], v[80:83], 0
v_mfma_f32_16x16x32_bf16 v[140:143], v[130:133], v[84:87], v[140:143]
v_mfma_f32_16x16x32_bf16 v[144:147], v[128:131], v[84:87], v[144:147]
v_mfma_f32_16x16x32_bf16 v[140:143], v[130:133], v[88:91], v[140:143]
v_mfma_f32_16x16x32_bf16 v[144:147], v[128:131], v[88:91], v[144:147]
v_mfma_f32_16x16x32_bf16 v[140:143], v[130:133], v[92:95], v[140:143]
v_mfma_f32_16x16x32_bf16 v[144:147], v[128:131], v[92:95], v[144:147]
s_nop 7
v_cvt_pk_bf16_f32 v156, v140, v141
v_cvt_pk_bf16_f32 v157, v142, v143
v_cvt_pk_bf16_f32 v158, v144, v145
v_cvt_pk_bf16_f32 v159, v146, v147
buffer_store_dwordx2 v[156:157], v43, s[44:47], s6 offen
s_cmp_ge_u32 s16, s64
s_cbranch_scc1 L_fin_r5_2
buffer_store_dwordx2 v[158:159], v43, s[44:47], s11 offen
L_fin_r5_2:
s_add_u32 s66, s27, 12
s_waitcnt vmcnt(10)
s_cmp_ge_u32 s66, s65
s_cbranch_scc1 L_fin_r5_3
v_mfma_f32_16x16x32_bf16 v[148:151], v[130:133], v[96:99], 0
v_mfma_f32_16x16x32_bf16 v[152:155], v[128:131], v[96:99], 0
v_mfma_f32_16x16x32_bf16 v[148:151], v[130:133], v[100:103], v[148:151]
v_mfma_f32_16x16x32_bf16 v[152:155], v[128:131], v[100:103], v[152:155]
v_mfma_f32_16x16x32_bf16 v[148:151], v[130:133], v[104:107], v[148:151]
v_mfma_f32_16x16x32_bf16 v[152:155], v[128:131], v[104:107], v[152:155]
v_mfma_f32_16x16x32_bf16 v[148:151], v[130:133], v[108:111], v[148:151]
v_mfma_f32_16x16x32_bf16 v[152:155], v[128:131], v[108:111], v[152:155]
s_nop 7
v_cvt_pk_bf16_f32 v160, v148, v149
v_cvt_pk_bf16_f32 v161, v150, v151
v_cvt_pk_bf16_f32 v162, v152, v153
v_cvt_pk_bf16_f32 v163, v154, v155
buffer_store_dwordx2 v[160:161], v43, s[44:47], s7 offen
s_cmp_ge_u32 s17, s64
s_cbranch_scc1 L_fin_r5_3
buffer_store_dwordx2 v[162:163], v43, s[44:47], s12 offen
L_fin_r5_3:
s_add_u32 s66, s27, 16
s_waitcnt vmcnt(8)
s_cmp_ge_u32 s66, s65
s_cbranch_scc1 L_fin_r5_4
v_mfma_f32_16x16x32_bf16 v[140:143], v[130:133], v[112:115], 0
v_mfma_f32_16x16x32_bf16 v[144:147], v[128:131], v[112:115], 0
v_mfma_f32_16x16x32_bf16 v[140:143], v[130:133], v[116:119], v[140:143]
v_mfma_f32_16x16x32_bf16 v[144:147], v[128:131], v[116:119], v[144:147]
v_mfma_f32_16x16x32_bf16 v[140:143], v[130:133], v[120:123], v[140:143]
v_mfma_f32_16x16x32_bf16 v[144:147], v[128:131], v[120:123], v[144:147]
v_mfma_f32_16x16x32_bf16 v[140:143], v[130:133], v[124:127], v[140:143]
v_mfma_f32_16x16x32_bf16 v[144:147], v[128:131], v[124:127], v[144:147]
s_nop 7
v_cvt_pk_bf16_f32 v156, v140, v141
v_cvt_pk_bf16_f32 v157, v142, v143
v_cvt_pk_bf16_f32 v158, v144, v145
v_cvt_pk_bf16_f32 v159, v146, v147
buffer_store_dwordx2 v[156:157], v43, s[44:47], s8 offen
s_cmp_ge_u32 s18, s64
s_cbranch_scc1 L_fin_r5_4
buffer_store_dwordx2 v[158:159], v43, s[44:47], s13 offen
L_fin_r5_4:
s_endpgm
L_var_r4:
s_mov_b32 s75, s64
s_mov_b32 s63, s68
s_mov_b32 m0, s75
s_add_u32 s75, s75, 1024
buffer_load_dwordx4 v90, s[12:15], s63 offen offset:0 lds
s_add_u32 s63, s63, 7168
s_mov_b32 m0, s75
s_add_u32 s75, s75, 1024
buffer_load_dwordx4 v90, s[12:15], s63 offen offset:0 lds
s_add_u32 s63, s63, 7168
s_mov_b32 m0, s75
s_add_u32 s75, s75, 1024
buffer_load_dwordx4 v90, s[12:15], s63 offen offset:0 lds
s_add_u32 s63, s63, 7168
s_mov_b32 m0, s75
s_add_u32 s75, s75, 1024
buffer_load_dwordx4 v90, s[12:15], s63 offen offset:0 lds
s_add_u32 s63, s63, 7168
s_mov_b32 m0, s75
s_add_u32 s75, s75, 1024
buffer_load_dwordx4 v90, s[12:15], s63 offen offset:0 lds
s_add_u32 s63, s63, 7168
s_mov_b32 m0, s75
s_add_u32 s75, s75, 1024
buffer_load_dwordx4 v90, s[12:15], s63 offen offset:0 lds
s_add_u32 s63, s63, 7168
s_mov_b32 m0, s75
s_add_u32 s75, s75, 1024
buffer_load_dwordx4 v90, s[12:15], s63 offen offset:0 lds
s_add_u32 s63, s63, 7168
s_mov_b32 m0, s75
s_add_u32 s75, s75, 1024
buffer_load_dwordx4 v90, s[12:15], s63 offen offset:0 lds
s_add_u32 s63, s63, 7168
s_add_u32 s68, s68, 128
s_xor_b32 s64, s64, s70
s_add_u32 m0, s61, s71
s_nop 0
buffer_load_dwordx4 v91, s[16:19], s24 offen offset:0 lds
buffer_load_dwordx4 v91, s[16:19], s25 offen offset:1024 lds
buffer_load_dwordx4 v91, s[16:19], s26 offen offset:2048 lds
buffer_load_dwordx4 v91, s[16:19], 0 offen offset:3072 lds
s_add_u32 s16, s16, 262144
s_addc_u32 s17, s17, 0
s_add_u32 m0, s62, s71
s_nop 0
buffer_load_dwordx4 v91, s[16:19], s24 offen offset:0 lds
buffer_load_dwordx4 v91, s[16:19], s25 offen offset:1024 lds
buffer_load_dwordx4 v91, s[16:19], s26 offen offset:2048 lds
buffer_load_dwordx4 v91, s[16:19], 0 offen offset:3072 lds
s_add_u32 s16, s16, 262144
s_addc_u32 s17, s17, 0
s_lshl_b32 s78, s76, 19
s_add_u32 s36, s42, s78
s_addc_u32 s37, s43, 0
s_sub_u32 s4, s36, 2688
s_subb_u32 s5, s37, 0
s_mov_b32 s6, 19072
s_mov_b32 s7, 0x20000
s_add_u32 s8, s44, s78
s_addc_u32 s9, s45, 0
s_mov_b32 s100, s8
s_mov_b32 s101, s9
s_sub_u32 s8, s8, 2688
s_subb_u32 s9, s9, 0
s_mov_b32 s10, 19072
s_mov_b32 s11, 0x20000
v_lshlrev_b32 v125, 6, v101
v_add_u32 v125, s71, v125
s_mul_i32 s78, s77, 163840
s_add_u32 s20, s56, s78
s_addc_u32 s21, s57, 0
s_mov_b32 s22, 163840
s_mov_b32 s23, 0x20000
s_cmp_lt_u32 s2, 128
s_cselect_b64 s[96:97], s[96:97], s[98:99]
s_and_b32 s78, s2, 127
s_mul_i32 s78, s78, 28672
s_mul_i32 s80, s27, 224
s_add_u32 s78, s78, s80
s_add_u32 s44, s96, s78
s_addc_u32 s45, s97, 0
s_sub_u32 s44, s44, 3072
s_subb_u32 s45, s45, 0
s_mov_b32 s46, 31744
s_mov_b32 s47, 0x20000
s_mul_i32 s78, s2, 28672
s_mul_i32 s80, s27, 7168
s_add_u32 s78, s78, s80
s_add_u32 s78, s78, 42991616
s_add_u32 s48, s56, s78
s_addc_u32 s49, s57, 0
s_mov_b32 s50, 7168
s_mov_b32 s51, 0x20000
s_add_u32 s72, s79, 120832
s_mov_b32 s73, 4096
s_add_u32 s30, s71, 0
s_add_u32 s31, s71, 16384
s_mov_b32 s28, 32768
s_mov_b32 s29, 49152
s_mov_b32 s35, 65536
s_mov_b32 s38, 1317011456
s_mov_b32 s39, 1035512379
s_mov_b32 s34, 0
v_and_b32 v102, 15, v101
v_lshrrev_b32 v103, 4, v101
v_lshlrev_b32 v7, 9, v104
v_add_u32 v7, v7, v105
v_add_u32 v7, s71, v7
s_mov_b32 s80, 4682
v_add_u32 v108, 0, v101
v_mul_lo_u32 v109, v108, s80
v_lshrrev_b32 v109, 16, v109
v_mul_u32_u24 v110, 14, v109
v_sub_u32 v110, v108, v110
v_mul_u32_u24 v109, 896, v109
v_lshlrev_b32 v110, 4, v110
v_add_u32 v109, v109, v110
v_add_u32 v160, 3072, v109
v_add_u32 v108, 64, v101
v_mul_lo_u32 v109, v108, s80
v_lshrrev_b32 v109, 16, v109
v_mul_u32_u24 v110, 14, v109
v_sub_u32 v110, v108, v110
v_mul_u32_u24 v109, 896, v109
v_lshlrev_b32 v110, 4, v110
v_add_u32 v109, v109, v110
v_add_u32 v161, 2048, v109
v_add_u32 v108, 128, v101
v_mul_lo_u32 v109, v108, s80
v_lshrrev_b32 v109, 16, v109
v_mul_u32_u24 v110, 14, v109
v_sub_u32 v110, v108, v110
v_mul_u32_u24 v109, 896, v109
v_lshlrev_b32 v110, 4, v110
v_add_u32 v109, v109, v110
v_add_u32 v162, 1024, v109
v_add_u32 v108, 192, v101
v_mul_lo_u32 v109, v108, s80
v_lshrrev_b32 v109, 16, v109
v_mul_u32_u24 v110, 14, v109
v_sub_u32 v110, v108, v110
v_mul_u32_u24 v109, 896, v109
v_lshlrev_b32 v110, 4, v110
v_add_u32 v109, v109, v110
v_add_u32 v163, 0, v109
v_add_u32 v108, 256, v101
v_mul_lo_u32 v109, v108, s80
v_lshrrev_b32 v109, 16, v109
v_mul_u32_u24 v110, 14, v109
v_sub_u32 v110, v108, v110
v_mul_u32_u24 v109, 896, v109
v_lshlrev_b32 v110, 4, v110
v_add_u32 v109, v109, v110
v_add_u32 v164, 3072, v109
v_add_u32 v108, 320, v101
v_mul_lo_u32 v109, v108, s80
v_lshrrev_b32 v109, 16, v109
v_mul_u32_u24 v110, 14, v109
v_sub_u32 v110, v108, v110
v_mul_u32_u24 v109, 896, v109
v_lshlrev_b32 v110, 4, v110
v_add_u32 v109, v109, v110
v_add_u32 v165, 2048, v109
v_add_u32 v108, 384, v101
v_mul_lo_u32 v109, v108, s80
v_lshrrev_b32 v109, 16, v109
v_mul_u32_u24 v110, 14, v109
v_sub_u32 v110, v108, v110
v_mul_u32_u24 v109, 896, v109
v_lshlrev_b32 v110, 4, v110
v_add_u32 v109, v109, v110
v_add_u32 v166, 1024, v109
v_lshrrev_b32 v108, 2, v101
v_mul_u32_u24 v108, 224, v108
v_and_b32 v109, 3, v101
v_lshlrev_b32 v109, 3, v109
v_add_u32 v108, v108, v109
v_add_u32 v167, s72, v108
v_lshlrev_b32 v168, 4, v101
v_lshrrev_b32 v107, 3, v102
v_and_b32 v108, 7, v102
v_lshlrev_b32 v108, 7, v108
v_and_b32 v109, 6, v102
v_add_u32 v110, 0, v103
v_xor_b32 v110, v110, v109
v_lshlrev_b32 v110, 4, v110
v_add_u32 v110, v110, v108
v_lshlrev_b32 v111, 12, v107
v_add_u32 v0, v110, v111
v_lshlrev_b32 v111, 10, v107
v_add_u32 v110, v110, v111
v_add_u32 v110, s79, v110
v_add_u32 v80, 81920, v110
v_add_u32 v110, 4, v103
v_xor_b32 v110, v110, v109
v_lshlrev_b32 v110, 4, v110
v_add_u32 v110, v110, v108
v_lshlrev_b32 v111, 12, v107
v_add_u32 v1, v110, v111
v_lshlrev_b32 v111, 10, v107
v_add_u32 v110, v110, v111
v_add_u32 v110, s79, v110
v_add_u32 v81, 81920, v110
v_lshrrev_b32 v107, 2, v101
v_and_b32 v107, 3, v107
v_and_b32 v108, 1, v103
v_lshlrev_b32 v108, 2, v108
v_add_u32 v107, v107, v108
v_and_b32 v109, 6, v107
v_lshlrev_b32 v107, 7, v107
v_lshrrev_b32 v108, 1, v103
v_lshlrev_b32 v108, 12, v108
v_add_u32 v107, v107, v108
v_and_b32 v108, 3, v101
v_lshrrev_b32 v110, 1, v108
v_and_b32 v111, 1, v108
v_lshlrev_b32 v111, 3, v111
v_add_u32 v112, 0, v110
v_xor_b32 v112, v112, v109
v_lshlrev_b32 v112, 4, v112
v_add_u32 v112, v112, v111
v_add_u32 v2, v112, v107
v_add_u32 v112, 2, v110
v_xor_b32 v112, v112, v109
v_lshlrev_b32 v112, 4, v112
v_add_u32 v112, v112, v111
v_add_u32 v3, v112, v107
v_add_u32 v112, 4, v110
v_xor_b32 v112, v112, v109
v_lshlrev_b32 v112, 4, v112
v_add_u32 v112, v112, v111
v_add_u32 v4, v112, v107
v_add_u32 v112, 6, v110
v_xor_b32 v112, v112, v109
v_lshlrev_b32 v112, 4, v112
v_add_u32 v112, v112, v111
v_add_u32 v5, v112, v107
v_add_u32 v112, 0, v108
v_xor_b32 v112, v112, v109
v_lshlrev_b32 v112, 4, v112
v_add_u32 v84, v112, v107
v_add_u32 v112, 4, v108
v_xor_b32 v112, v112, v109
v_lshlrev_b32 v112, 4, v112
v_add_u32 v85, v112, v107
v_add_u32 v0, 32768, v0
v_add_u32 v1, 32768, v1
s_mul_i32 s80, s27, 25600
s_add_u32 s80, s80, 81920
v_lshlrev_b32 v6, 4, v101
v_add_u32 v6, s80, v6
s_load_dwordx4 s[40:43], s[0:1], 80
s_and_b32 s58, s2, 7
s_lshr_b32 s59, s58, 2
s_lshl_b32 s59, s59, 3
s_and_b32 s58, s58, 3
s_lshl_b32 s58, s58, 1
s_add_u32 s59, s59, s58
s_lshr_b32 s58, s2, 7
s_add_u32 s59, s59, s58
s_lshl_b32 s59, s59, 13
s_add_u32 s59, s59, 54525952
s_lshr_b32 s58, s2, 5
s_and_b32 s58, s58, 3
s_lshl_b32 s58, s58, 2
s_add_u32 s58, s58, s27
s_lshl_b32 s58, s58, 8
s_add_u32 s74, s58, s59
s_lshr_b32 s58, s2, 3
s_and_b32 s58, s58, 3
s_lshl_b32 s58, s58, 10
s_add_u32 s59, s59, s58
s_add_u32 s59, s59, 4096
s_lshl_b32 s58, s27, 8
s_add_u32 s58, s58, s59
s_add_u32 s76, s56, s58
s_addc_u32 s77, s57, 0
s_lshr_b32 s58, s2, 5
s_and_b32 s58, s58, 3
s_lshl_b32 s58, s58, 8
s_add_u32 s3, s58, s59
s_add_u32 s80, s56, s74
s_addc_u32 s81, s57, 0
v_mov_b32 v102, 0
s_mov_b64 exec, 1
global_store_dword v102, v102, s[80:81] sc0 sc1
global_store_dword v102, v102, s[76:77] sc0 sc1
s_mov_b64 exec, -1
s_waitcnt lgkmcnt(0)
s_mov_b32 s78, s42
s_mov_b32 s79, s43
s_add_u32 s42, s56, s74
s_addc_u32 s43, s57, 0
v_mov_b32 v40, 0
v_mov_b32 v41, 0
v_mov_b32 v42, 0
v_mov_b32 v43, 0
s_nop 1
v_mfma_f32_32x32x16_bf16 a[0:15], v[40:43], v[40:43], 0
v_mfma_f32_32x32x16_bf16 a[16:31], v[40:43], v[40:43], 0
v_mfma_f32_32x32x16_bf16 a[32:47], v[40:43], v[40:43], 0
v_mfma_f32_32x32x16_bf16 a[48:63], v[40:43], v[40:43], 0
v_mfma_f32_32x32x16_bf16 a[64:79], v[40:43], v[40:43], 0
v_mfma_f32_32x32x16_bf16 a[80:95], v[40:43], v[40:43], 0
v_mfma_f32_32x32x16_bf16 a[96:111], v[40:43], v[40:43], 0
v_mfma_f32_32x32x16_bf16 a[112:127], v[40:43], v[40:43], 0
v_mfma_f32_32x32x16_bf16 a[128:143], v[40:43], v[40:43], 0
v_mfma_f32_32x32x16_bf16 a[144:159], v[40:43], v[40:43], 0
v_mfma_f32_32x32x16_bf16 a[160:175], v[40:43], v[40:43], 0
v_mfma_f32_32x32x16_bf16 a[176:191], v[40:43], v[40:43], 0
v_mfma_f32_32x32x16_bf16 a[192:207], v[40:43], v[40:43], 0
v_mfma_f32_32x32x16_bf16 a[208:223], v[40:43], v[40:43], 0
v_mfma_f32_32x32x16_bf16 a[224:239], v[40:43], v[40:43], 0
v_mfma_f32_32x32x16_bf16 a[240:255], v[40:43], v[40:43], 0
v_add_u32 v86, s61, v84
v_add_u32 v87, s61, v85
v_add_u32 v82, s60, v80
v_add_u32 v83, s60, v81
s_xor_b32 s60, s60, 38912
s_waitcnt vmcnt(6)
s_barrier
ds_read_b64_tr_b16 v[8:9], v86 offset:0
ds_read_b64_tr_b16 v[10:11], v86 offset:8192
ds_read_b64_tr_b16 v[12:13], v86 offset:8
ds_read_b64_tr_b16 v[14:15], v86 offset:8200
ds_read_b64_tr_b16 v[16:17], v87 offset:0
ds_read_b64_tr_b16 v[18:19], v87 offset:8192
ds_read_b64_tr_b16 v[20:21], v87 offset:8
ds_read_b64_tr_b16 v[22:23], v87 offset:8200
ds_read_b128 v[40:43], v82 offset:0
ds_read_b128 v[44:47], v82 offset:2048
ds_read_b128 v[48:51], v82 offset:4096
ds_read_b128 v[52:55], v82 offset:6144
s_mov_b32 s32, 4
s_waitcnt lgkmcnt(0)
v_mfma_f32_16x16x32_bf16 a[0:3], v[8:11], v[40:43], a[0:3]
ds_read_b64_tr_b16 v[24:25], v86 offset:1024
v_mfma_f32_16x16x32_bf16 a[4:7], v[8:11], v[44:47], a[4:7]
ds_read_b64_tr_b16 v[26:27], v86 offset:9216
s_add_u32 m0, s67, s71
v_mfma_f32_16x16x32_bf16 a[8:11], v[8:11], v[48:51], a[8:11]
v_mfma_f32_16x16x32_bf16 a[12:15], v[8:11], v[52:55], a[12:15]
ds_read_b64_tr_b16 v[28:29], v86 offset:1032
buffer_load_dwordx4 v91, s[16:19], s24 offen offset:0 lds
v_mfma_f32_16x16x32_bf16 a[16:19], v[12:15], v[40:43], a[16:19]
ds_read_b64_tr_b16 v[30:31], v86 offset:9224
v_mfma_f32_16x16x32_bf16 a[20:23], v[12:15], v[44:47], a[20:23]
v_mfma_f32_16x16x32_bf16 a[24:27], v[12:15], v[48:51], a[24:27]
buffer_load_dwordx4 v91, s[16:19], s25 offen offset:1024 lds
v_mfma_f32_16x16x32_bf16 a[28:31], v[12:15], v[52:55], a[28:31]
v_mfma_f32_16x16x32_bf16 a[32:35], v[16:19], v[40:43], a[32:35]
ds_read_b64_tr_b16 v[32:33], v87 offset:1024
v_mfma_f32_16x16x32_bf16 a[36:39], v[16:19], v[44:47], a[36:39]
ds_read_b64_tr_b16 v[34:35], v87 offset:9216
v_mfma_f32_16x16x32_bf16 a[40:43], v[16:19], v[48:51], a[40:43]
buffer_load_dwordx4 v91, s[16:19], s26 offen offset:2048 lds
v_mfma_f32_16x16x32_bf16 a[44:47], v[16:19], v[52:55], a[44:47]
ds_read_b64_tr_b16 v[36:37], v87 offset:1032
v_mfma_f32_16x16x32_bf16 a[48:51], v[20:23], v[40:43], a[48:51]
ds_read_b64_tr_b16 v[38:39], v87 offset:9224
v_mfma_f32_16x16x32_bf16 a[52:55], v[20:23], v[44:47], a[52:55]
v_mfma_f32_16x16x32_bf16 a[56:59], v[20:23], v[48:51], a[56:59]
buffer_load_dwordx4 v91, s[16:19], 0 offen offset:3072 lds
s_mov_b32 s75, s64
v_mfma_f32_16x16x32_bf16 a[60:63], v[20:23], v[52:55], a[60:63]
s_waitcnt lgkmcnt(4)
s_mov_b32 s63, s68
v_mfma_f32_16x16x32_bf16 a[64:67], v[24:27], v[40:43], a[64:67]
s_mov_b32 m0, s75
ds_read_b64_tr_b16 v[8:9], v86 offset:2048
v_mfma_f32_16x16x32_bf16 a[68:71], v[24:27], v[44:47], a[68:71]
ds_read_b64_tr_b16 v[10:11], v86 offset:10240
s_add_u32 s75, s75, 1024
v_mfma_f32_16x16x32_bf16 a[72:75], v[24:27], v[48:51], a[72:75]
s_add_u32 s16, s16, 262144
s_addc_u32 s17, s17, 0
v_mfma_f32_16x16x32_bf16 a[76:79], v[24:27], v[52:55], a[76:79]
ds_read_b64_tr_b16 v[12:13], v86 offset:2056
buffer_load_dwordx4 v90, s[12:15], s63 offen offset:0 lds
v_mfma_f32_16x16x32_bf16 a[80:83], v[28:31], v[40:43], a[80:83]
ds_read_b64_tr_b16 v[14:15], v86 offset:10248
s_add_u32 s63, s63, 7168
v_mfma_f32_16x16x32_bf16 a[84:87], v[28:31], v[44:47], a[84:87]
s_mov_b32 m0, s75
s_add_u32 s75, s75, 1024
v_mfma_f32_16x16x32_bf16 a[88:91], v[28:31], v[48:51], a[88:91]
buffer_load_dwordx4 v90, s[12:15], s63 offen offset:0 lds
s_add_u32 s63, s63, 7168
v_mfma_f32_16x16x32_bf16 a[92:95], v[28:31], v[52:55], a[92:95]
s_waitcnt lgkmcnt(4)
s_mov_b32 m0, s75
v_mfma_f32_16x16x32_bf16 a[96:99], v[32:35], v[40:43], a[96:99]
ds_read_b64_tr_b16 v[16:17], v87 offset:2048
s_add_u32 s75, s75, 1024
v_mfma_f32_16x16x32_bf16 a[100:103], v[32:35], v[44:47], a[100:103]
ds_read_b64_tr_b16 v[18:19], v87 offset:10240
v_mfma_f32_16x16x32_bf16 a[104:107], v[32:35], v[48:51], a[104:107]
buffer_load_dwordx4 v90, s[12:15], s63 offen offset:0 lds
s_add_u32 s63, s63, 7168
v_mfma_f32_16x16x32_bf16 a[108:111], v[32:35], v[52:55], a[108:111]
ds_read_b64_tr_b16 v[20:21], v87 offset:2056
s_mov_b32 m0, s75
v_mfma_f32_16x16x32_bf16 a[112:115], v[36:39], v[40:43], a[112:115]
ds_read_b64_tr_b16 v[22:23], v87 offset:10248
s_add_u32 s75, s75, 1024
v_mfma_f32_16x16x32_bf16 a[116:119], v[36:39], v[44:47], a[116:119]
v_mfma_f32_16x16x32_bf16 a[120:123], v[36:39], v[48:51], a[120:123]
buffer_load_dwordx4 v90, s[12:15], s63 offen offset:0 lds
s_add_u32 s63, s63, 7168
v_mfma_f32_16x16x32_bf16 a[124:127], v[36:39], v[52:55], a[124:127]
s_waitcnt lgkmcnt(4)
s_mov_b32 m0, s75
v_mfma_f32_16x16x32_bf16 a[128:131], v[8:11], v[40:43], a[128:131]
ds_read_b64_tr_b16 v[24:25], v86 offset:3072
s_add_u32 s75, s75, 1024
v_mfma_f32_16x16x32_bf16 a[132:135], v[8:11], v[44:47], a[132:135]
ds_read_b64_tr_b16 v[26:27], v86 offset:11264
v_add_u32 v88, s62, v84
v_mfma_f32_16x16x32_bf16 a[136:139], v[8:11], v[48:51], a[136:139]
buffer_load_dwordx4 v90, s[12:15], s63 offen offset:0 lds
s_add_u32 s63, s63, 7168
v_mfma_f32_16x16x32_bf16 a[140:143], v[8:11], v[52:55], a[140:143]
ds_read_b64_tr_b16 v[28:29], v86 offset:3080
s_mov_b32 m0, s75
v_mfma_f32_16x16x32_bf16 a[144:147], v[12:15], v[40:43], a[144:147]
ds_read_b64_tr_b16 v[30:31], v86 offset:11272
s_add_u32 s75, s75, 1024
v_mfma_f32_16x16x32_bf16 a[148:151], v[12:15], v[44:47], a[148:151]
v_add_u32 v89, s62, v85
v_mfma_f32_16x16x32_bf16 a[152:155], v[12:15], v[48:51], a[152:155]
buffer_load_dwordx4 v90, s[12:15], s63 offen offset:0 lds
s_add_u32 s63, s63, 7168
v_mfma_f32_16x16x32_bf16 a[156:159], v[12:15], v[52:55], a[156:159]
s_waitcnt lgkmcnt(4)
s_mov_b32 m0, s75
v_mfma_f32_16x16x32_bf16 a[160:163], v[16:19], v[40:43], a[160:163]
ds_read_b64_tr_b16 v[32:33], v87 offset:3072
s_add_u32 s75, s75, 1024
v_mfma_f32_16x16x32_bf16 a[164:167], v[16:19], v[44:47], a[164:167]
ds_read_b64_tr_b16 v[34:35], v87 offset:11264
v_mfma_f32_16x16x32_bf16 a[168:171], v[16:19], v[48:51], a[168:171]
buffer_load_dwordx4 v90, s[12:15], s63 offen offset:0 lds
s_add_u32 s63, s63, 7168
v_mfma_f32_16x16x32_bf16 a[172:175], v[16:19], v[52:55], a[172:175]
ds_read_b64_tr_b16 v[36:37], v87 offset:3080
s_mov_b32 m0, s75
v_mfma_f32_16x16x32_bf16 a[176:179], v[20:23], v[40:43], a[176:179]
ds_read_b64_tr_b16 v[38:39], v87 offset:11272
s_add_u32 s75, s75, 1024
v_mfma_f32_16x16x32_bf16 a[180:183], v[20:23], v[44:47], a[180:183]
v_mfma_f32_16x16x32_bf16 a[184:187], v[20:23], v[48:51], a[184:187]
buffer_load_dwordx4 v90, s[12:15], s63 offen offset:0 lds
s_add_u32 s63, s63, 7168
v_mfma_f32_16x16x32_bf16 a[188:191], v[20:23], v[52:55], a[188:191]
s_waitcnt lgkmcnt(4)
s_add_u32 s68, s68, 128
v_mfma_f32_16x16x32_bf16 a[192:195], v[24:27], v[40:43], a[192:195]
s_xor_b32 s64, s64, s70
v_mfma_f32_16x16x32_bf16 a[196:199], v[24:27], v[44:47], a[196:199]
v_mfma_f32_16x16x32_bf16 a[200:203], v[24:27], v[48:51], a[200:203]
v_mfma_f32_16x16x32_bf16 a[204:207], v[24:27], v[52:55], a[204:207]
s_mov_b32 s65, s61
s_mov_b32 s61, s62
v_mfma_f32_16x16x32_bf16 a[208:211], v[28:31], v[40:43], a[208:211]
s_mov_b32 s62, s67
s_mov_b32 s67, s65
v_mfma_f32_16x16x32_bf16 a[212:215], v[28:31], v[44:47], a[212:215]
v_mfma_f32_16x16x32_bf16 a[216:219], v[28:31], v[48:51], a[216:219]
v_mfma_f32_16x16x32_bf16 a[220:223], v[28:31], v[52:55], a[220:223]
s_waitcnt vmcnt(14) lgkmcnt(0)
s_barrier
v_mfma_f32_16x16x32_bf16 a[224:227], v[32:35], v[40:43], a[224:227]
ds_read_b64_tr_b16 v[8:9], v88 offset:0
ds_read_b64_tr_b16 v[10:11], v88 offset:8192
v_mfma_f32_16x16x32_bf16 a[228:231], v[32:35], v[44:47], a[228:231]
ds_read_b128 v[60:63], v83 offset:0
ds_read_b64_tr_b16 v[12:13], v88 offset:8
v_mfma_f32_16x16x32_bf16 a[232:235], v[32:35], v[48:51], a[232:235]
ds_read_b128 v[64:67], v83 offset:2048
ds_read_b64_tr_b16 v[14:15], v88 offset:8200
v_mfma_f32_16x16x32_bf16 a[236:239], v[32:35], v[52:55], a[236:239]
ds_read_b128 v[68:71], v83 offset:4096
ds_read_b128 v[72:75], v83 offset:6144
v_mfma_f32_16x16x32_bf16 a[240:243], v[36:39], v[40:43], a[240:243]
ds_read_b64_tr_b16 v[16:17], v89 offset:0
ds_read_b64_tr_b16 v[18:19], v89 offset:8192
v_mfma_f32_16x16x32_bf16 a[244:247], v[36:39], v[44:47], a[244:247]
ds_read_b64_tr_b16 v[20:21], v89 offset:8
v_mfma_f32_16x16x32_bf16 a[248:251], v[36:39], v[48:51], a[248:251]
ds_read_b64_tr_b16 v[22:23], v89 offset:8200
v_mfma_f32_16x16x32_bf16 a[252:255], v[36:39], v[52:55], a[252:255]
s_waitcnt lgkmcnt(4)
v_mfma_f32_16x16x32_bf16 a[0:3], v[8:11], v[60:63], a[0:3]
ds_read_b64_tr_b16 v[24:25], v88 offset:1024
v_mfma_f32_16x16x32_bf16 a[4:7], v[8:11], v[64:67], a[4:7]
ds_read_b64_tr_b16 v[26:27], v88 offset:9216
s_add_u32 m0, s67, s71
v_mfma_f32_16x16x32_bf16 a[8:11], v[8:11], v[68:71], a[8:11]
v_mfma_f32_16x16x32_bf16 a[12:15], v[8:11], v[72:75], a[12:15]
ds_read_b64_tr_b16 v[28:29], v88 offset:1032
buffer_load_dwordx4 v91, s[16:19], s24 offen offset:0 lds
v_mfma_f32_16x16x32_bf16 a[16:19], v[12:15], v[60:63], a[16:19]
ds_read_b64_tr_b16 v[30:31], v88 offset:9224
v_mfma_f32_16x16x32_bf16 a[20:23], v[12:15], v[64:67], a[20:23]
v_mfma_f32_16x16x32_bf16 a[24:27], v[12:15], v[68:71], a[24:27]
v_mfma_f32_16x16x32_bf16 a[28:31], v[12:15], v[72:75], a[28:31]
s_waitcnt lgkmcnt(4)
v_mfma_f32_16x16x32_bf16 a[32:35], v[16:19], v[60:63], a[32:35]
ds_read_b64_tr_b16 v[32:33], v89 offset:1024
v_mfma_f32_16x16x32_bf16 a[36:39], v[16:19], v[64:67], a[36:39]
ds_read_b64_tr_b16 v[34:35], v89 offset:9216
buffer_load_dwordx4 v91, s[16:19], s25 offen offset:1024 lds
v_mfma_f32_16x16x32_bf16 a[40:43], v[16:19], v[68:71], a[40:43]
v_mfma_f32_16x16x32_bf16 a[44:47], v[16:19], v[72:75], a[44:47]
ds_read_b64_tr_b16 v[36:37], v89 offset:1032
v_mfma_f32_16x16x32_bf16 a[48:51], v[20:23], v[60:63], a[48:51]
ds_read_b64_tr_b16 v[38:39], v89 offset:9224
v_mfma_f32_16x16x32_bf16 a[52:55], v[20:23], v[64:67], a[52:55]
v_mfma_f32_16x16x32_bf16 a[56:59], v[20:23], v[68:71], a[56:59]
v_mfma_f32_16x16x32_bf16 a[60:63], v[20:23], v[72:75], a[60:63]
s_waitcnt lgkmcnt(4)
buffer_load_dwordx4 v91, s[16:19], s26 offen offset:2048 lds
v_mfma_f32_16x16x32_bf16 a[64:67], v[24:27], v[60:63], a[64:67]
ds_read_b64_tr_b16 v[8:9], v88 offset:2048
v_mfma_f32_16x16x32_bf16 a[68:71], v[24:27], v[64:67], a[68:71]
ds_read_b64_tr_b16 v[10:11], v88 offset:10240
v_mfma_f32_16x16x32_bf16 a[72:75], v[24:27], v[68:71], a[72:75]
v_mfma_f32_16x16x32_bf16 a[76:79], v[24:27], v[72:75], a[76:79]
ds_read_b64_tr_b16 v[12:13], v88 offset:2056
v_mfma_f32_16x16x32_bf16 a[80:83], v[28:31], v[60:63], a[80:83]
ds_read_b64_tr_b16 v[14:15], v88 offset:10248
v_mfma_f32_16x16x32_bf16 a[84:87], v[28:31], v[64:67], a[84:87]
buffer_load_dwordx4 v91, s[16:19], 0 offen offset:3072 lds
v_mfma_f32_16x16x32_bf16 a[88:91], v[28:31], v[68:71], a[88:91]
s_add_u32 s16, s16, 262144
s_addc_u32 s17, s17, 0
v_mfma_f32_16x16x32_bf16 a[92:95], v[28:31], v[72:75], a[92:95]
s_waitcnt lgkmcnt(4)
s_mov_b32 s75, s64
v_mfma_f32_16x16x32_bf16 a[96:99], v[32:35], v[60:63], a[96:99]
ds_read_b64_tr_b16 v[16:17], v89 offset:2048
s_mov_b32 s63, s68
v_mfma_f32_16x16x32_bf16 a[100:103], v[32:35], v[64:67], a[100:103]
s_mov_b32 m0, s75
ds_read_b64_tr_b16 v[18:19], v89 offset:10240
v_mfma_f32_16x16x32_bf16 a[104:107], v[32:35], v[68:71], a[104:107]
s_add_u32 s75, s75, 1024
v_mfma_f32_16x16x32_bf16 a[108:111], v[32:35], v[72:75], a[108:111]
ds_read_b64_tr_b16 v[20:21], v89 offset:2056
buffer_load_dwordx4 v90, s[12:15], s63 offen offset:0 lds
v_mfma_f32_16x16x32_bf16 a[112:115], v[36:39], v[60:63], a[112:115]
ds_read_b64_tr_b16 v[22:23], v89 offset:10248
v_mfma_f32_16x16x32_bf16 a[116:119], v[36:39], v[64:67], a[116:119]
s_add_u32 s63, s63, 7168
v_mfma_f32_16x16x32_bf16 a[120:123], v[36:39], v[68:71], a[120:123]
s_mov_b32 m0, s75
s_add_u32 s75, s75, 1024
v_mfma_f32_16x16x32_bf16 a[124:127], v[36:39], v[72:75], a[124:127]
s_waitcnt lgkmcnt(4)
v_mfma_f32_16x16x32_bf16 a[128:131], v[8:11], v[60:63], a[128:131]
ds_read_b64_tr_b16 v[24:25], v88 offset:3072
v_add_u32 v86, s62, v84
v_mfma_f32_16x16x32_bf16 a[132:135], v[8:11], v[64:67], a[132:135]
ds_read_b64_tr_b16 v[26:27], v88 offset:11264
buffer_load_dwordx4 v90, s[12:15], s63 offen offset:0 lds
v_mfma_f32_16x16x32_bf16 a[136:139], v[8:11], v[68:71], a[136:139]
v_add_u32 v87, s62, v85
v_add_u32 v82, s60, v80
v_mfma_f32_16x16x32_bf16 a[140:143], v[8:11], v[72:75], a[140:143]
ds_read_b64_tr_b16 v[28:29], v88 offset:3080
s_add_u32 s63, s63, 7168
v_mfma_f32_16x16x32_bf16 a[144:147], v[12:15], v[60:63], a[144:147]
ds_read_b64_tr_b16 v[30:31], v88 offset:11272
s_mov_b32 m0, s75
v_mfma_f32_16x16x32_bf16 a[148:151], v[12:15], v[64:67], a[148:151]
s_add_u32 s75, s75, 1024
v_add_u32 v83, s60, v81
v_mfma_f32_16x16x32_bf16 a[152:155], v[12:15], v[68:71], a[152:155]
s_xor_b32 s60, s60, 38912
v_mfma_f32_16x16x32_bf16 a[156:159], v[12:15], v[72:75], a[156:159]
s_waitcnt lgkmcnt(4)
buffer_load_dwordx4 v90, s[12:15], s63 offen offset:0 lds
v_mfma_f32_16x16x32_bf16 a[160:163], v[16:19], v[60:63], a[160:163]
ds_read_b64_tr_b16 v[32:33], v89 offset:3072
v_mfma_f32_16x16x32_bf16 a[164:167], v[16:19], v[64:67], a[164:167]
ds_read_b64_tr_b16 v[34:35], v89 offset:11264
v_mfma_f32_16x16x32_bf16 a[168:171], v[16:19], v[68:71], a[168:171]
s_add_u32 s63, s63, 7168
v_mfma_f32_16x16x32_bf16 a[172:175], v[16:19], v[72:75], a[172:175]
ds_read_b64_tr_b16 v[36:37], v89 offset:3080
s_mov_b32 m0, s75
v_mfma_f32_16x16x32_bf16 a[176:179], v[20:23], v[60:63], a[176:179]
ds_read_b64_tr_b16 v[38:39], v89 offset:11272
s_add_u32 s75, s75, 1024
v_mfma_f32_16x16x32_bf16 a[180:183], v[20:23], v[64:67], a[180:183]
v_mfma_f32_16x16x32_bf16 a[184:187], v[20:23], v[68:71], a[184:187]
buffer_load_dwordx4 v90, s[12:15], s63 offen offset:0 lds
s_add_u32 s63, s63, 7168
v_mfma_f32_16x16x32_bf16 a[188:191], v[20:23], v[72:75], a[188:191]
s_waitcnt lgkmcnt(4)
v_mfma_f32_16x16x32_bf16 a[192:195], v[24:27], v[60:63], a[192:195]
v_mfma_f32_16x16x32_bf16 a[196:199], v[24:27], v[64:67], a[196:199]
v_mfma_f32_16x16x32_bf16 a[200:203], v[24:27], v[68:71], a[200:203]
v_mfma_f32_16x16x32_bf16 a[204:207], v[24:27], v[72:75], a[204:207]
s_mov_b32 s65, s61
s_mov_b32 s61, s62
v_mfma_f32_16x16x32_bf16 a[208:211], v[28:31], v[60:63], a[208:211]
s_mov_b32 s62, s67
s_mov_b32 s67, s65
v_mfma_f32_16x16x32_bf16 a[212:215], v[28:31], v[64:67], a[212:215]
v_mfma_f32_16x16x32_bf16 a[216:219], v[28:31], v[68:71], a[216:219]
v_mfma_f32_16x16x32_bf16 a[220:223], v[28:31], v[72:75], a[220:223]
s_waitcnt vmcnt(8) lgkmcnt(0)
s_barrier
v_mfma_f32_16x16x32_bf16 a[224:227], v[32:35], v[60:63], a[224:227]
ds_read_b64_tr_b16 v[8:9], v86 offset:0
ds_read_b64_tr_b16 v[10:11], v86 offset:8192
v_mfma_f32_16x16x32_bf16 a[228:231], v[32:35], v[64:67], a[228:231]
ds_read_b128 v[40:43], v82 offset:0
ds_read_b64_tr_b16 v[12:13], v86 offset:8
v_mfma_f32_16x16x32_bf16 a[232:235], v[32:35], v[68:71], a[232:235]
ds_read_b128 v[44:47], v82 offset:2048
ds_read_b64_tr_b16 v[14:15], v86 offset:8200
v_mfma_f32_16x16x32_bf16 a[236:239], v[32:35], v[72:75], a[236:239]
ds_read_b128 v[48:51], v82 offset:4096
ds_read_b128 v[52:55], v82 offset:6144
v_mfma_f32_16x16x32_bf16 a[240:243], v[36:39], v[60:63], a[240:243]
ds_read_b64_tr_b16 v[16:17], v87 offset:0
ds_read_b64_tr_b16 v[18:19], v87 offset:8192
v_mfma_f32_16x16x32_bf16 a[244:247], v[36:39], v[64:67], a[244:247]
ds_read_b64_tr_b16 v[20:21], v87 offset:8
v_mfma_f32_16x16x32_bf16 a[248:251], v[36:39], v[68:71], a[248:251]
ds_read_b64_tr_b16 v[22:23], v87 offset:8200
v_mfma_f32_16x16x32_bf16 a[252:255], v[36:39], v[72:75], a[252:255]
L_qp_r4:
s_waitcnt lgkmcnt(4)
v_mfma_f32_16x16x32_bf16 a[0:3], v[8:11], v[40:43], a[0:3]
ds_read_b64_tr_b16 v[24:25], v86 offset:1024
v_mfma_f32_16x16x32_bf16 a[4:7], v[8:11], v[44:47], a[4:7]
ds_read_b64_tr_b16 v[26:27], v86 offset:9216
s_add_u32 m0, s67, s71
v_mfma_f32_16x16x32_bf16 a[8:11], v[8:11], v[48:51], a[8:11]
v_mfma_f32_16x16x32_bf16 a[12:15], v[8:11], v[52:55], a[12:15]
ds_read_b64_tr_b16 v[28:29], v86 offset:1032
buffer_load_dwordx4 v91, s[16:19], s24 offen offset:0 lds
v_mfma_f32_16x16x32_bf16 a[16:19], v[12:15], v[40:43], a[16:19]
ds_read_b64_tr_b16 v[30:31], v86 offset:9224
v_mfma_f32_16x16x32_bf16 a[20:23], v[12:15], v[44:47], a[20:23]
v_mfma_f32_16x16x32_bf16 a[24:27], v[12:15], v[48:51], a[24:27]
v_mfma_f32_16x16x32_bf16 a[28:31], v[12:15], v[52:55], a[28:31]
s_waitcnt lgkmcnt(4)
v_mfma_f32_16x16x32_bf16 a[32:35], v[16:19], v[40:43], a[32:35]
ds_read_b64_tr_b16 v[32:33], v87 offset:1024
v_mfma_f32_16x16x32_bf16 a[36:39], v[16:19], v[44:47], a[36:39]
ds_read_b64_tr_b16 v[34:35], v87 offset:9216
buffer_load_dwordx4 v91, s[16:19], s25 offen offset:1024 lds
v_mfma_f32_16x16x32_bf16 a[40:43], v[16:19], v[48:51], a[40:43]
v_mfma_f32_16x16x32_bf16 a[44:47], v[16:19], v[52:55], a[44:47]
ds_read_b64_tr_b16 v[36:37], v87 offset:1032
v_mfma_f32_16x16x32_bf16 a[48:51], v[20:23], v[40:43], a[48:51]
ds_read_b64_tr_b16 v[38:39], v87 offset:9224
v_mfma_f32_16x16x32_bf16 a[52:55], v[20:23], v[44:47], a[52:55]
v_mfma_f32_16x16x32_bf16 a[56:59], v[20:23], v[48:51], a[56:59]
v_mfma_f32_16x16x32_bf16 a[60:63], v[20:23], v[52:55], a[60:63]
s_waitcnt lgkmcnt(4)
buffer_load_dwordx4 v91, s[16:19], s26 offen offset:2048 lds
v_mfma_f32_16x16x32_bf16 a[64:67], v[24:27], v[40:43], a[64:67]
ds_read_b64_tr_b16 v[8:9], v86 offset:2048
v_mfma_f32_16x16x32_bf16 a[68:71], v[24:27], v[44:47], a[68:71]
ds_read_b64_tr_b16 v[10:11], v86 offset:10240
v_mfma_f32_16x16x32_bf16 a[72:75], v[24:27], v[48:51], a[72:75]
v_mfma_f32_16x16x32_bf16 a[76:79], v[24:27], v[52:55], a[76:79]
ds_read_b64_tr_b16 v[12:13], v86 offset:2056
v_mfma_f32_16x16x32_bf16 a[80:83], v[28:31], v[40:43], a[80:83]
ds_read_b64_tr_b16 v[14:15], v86 offset:10248
v_mfma_f32_16x16x32_bf16 a[84:87], v[28:31], v[44:47], a[84:87]
buffer_load_dwordx4 v91, s[16:19], 0 offen offset:3072 lds
v_mfma_f32_16x16x32_bf16 a[88:91], v[28:31], v[48:51], a[88:91]
s_add_u32 s16, s16, 262144
s_addc_u32 s17, s17, 0
v_mfma_f32_16x16x32_bf16 a[92:95], v[28:31], v[52:55], a[92:95]
s_waitcnt lgkmcnt(4)
v_mfma_f32_16x16x32_bf16 a[96:99], v[32:35], v[40:43], a[96:99]
ds_read_b64_tr_b16 v[16:17], v87 offset:2048
s_mov_b32 m0, s75
v_mfma_f32_16x16x32_bf16 a[100:103], v[32:35], v[44:47], a[100:103]
ds_read_b64_tr_b16 v[18:19], v87 offset:10240
s_add_u32 s75, s75, 1024
v_mfma_f32_16x16x32_bf16 a[104:107], v[32:35], v[48:51], a[104:107]
v_mfma_f32_16x16x32_bf16 a[108:111], v[32:35], v[52:55], a[108:111]
ds_read_b64_tr_b16 v[20:21], v87 offset:2056
buffer_load_dwordx4 v90, s[12:15], s63 offen offset:0 lds
v_mfma_f32_16x16x32_bf16 a[112:115], v[36:39], v[40:43], a[112:115]
ds_read_b64_tr_b16 v[22:23], v87 offset:10248
v_mfma_f32_16x16x32_bf16 a[116:119], v[36:39], v[44:47], a[116:119]
s_add_u32 s63, s63, 7168
v_mfma_f32_16x16x32_bf16 a[120:123], v[36:39], v[48:51], a[120:123]
s_mov_b32 m0, s75
s_add_u32 s75, s75, 1024
v_mfma_f32_16x16x32_bf16 a[124:127], v[36:39], v[52:55], a[124:127]
s_waitcnt lgkmcnt(4)
v_mfma_f32_16x16x32_bf16 a[128:131], v[8:11], v[40:43], a[128:131]
ds_read_b64_tr_b16 v[24:25], v86 offset:3072
v_add_u32 v88, s62, v84
v_mfma_f32_16x16x32_bf16 a[132:135], v[8:11], v[44:47], a[132:135]
ds_read_b64_tr_b16 v[26:27], v86 offset:11264
buffer_load_dwordx4 v90, s[12:15], s63 offen offset:0 lds
v_mfma_f32_16x16x32_bf16 a[136:139], v[8:11], v[48:51], a[136:139]
v_add_u32 v89, s62, v85
v_mfma_f32_16x16x32_bf16 a[140:143], v[8:11], v[52:55], a[140:143]
ds_read_b64_tr_b16 v[28:29], v86 offset:3080
s_add_u32 s63, s63, 7168
v_mfma_f32_16x16x32_bf16 a[144:147], v[12:15], v[40:43], a[144:147]
ds_read_b64_tr_b16 v[30:31], v86 offset:11272
s_mov_b32 m0, s75
v_mfma_f32_16x16x32_bf16 a[148:151], v[12:15], v[44:47], a[148:151]
s_add_u32 s75, s75, 1024
v_mfma_f32_16x16x32_bf16 a[152:155], v[12:15], v[48:51], a[152:155]
v_mfma_f32_16x16x32_bf16 a[156:159], v[12:15], v[52:55], a[156:159]
s_waitcnt lgkmcnt(4)
buffer_load_dwordx4 v90, s[12:15], s63 offen offset:0 lds
v_mfma_f32_16x16x32_bf16 a[160:163], v[16:19], v[40:43], a[160:163]
ds_read_b64_tr_b16 v[32:33], v87 offset:3072
v_mfma_f32_16x16x32_bf16 a[164:167], v[16:19], v[44:47], a[164:167]
ds_read_b64_tr_b16 v[34:35], v87 offset:11264
v_mfma_f32_16x16x32_bf16 a[168:171], v[16:19], v[48:51], a[168:171]
s_add_u32 s63, s63, 7168
v_mfma_f32_16x16x32_bf16 a[172:175], v[16:19], v[52:55], a[172:175]
ds_read_b64_tr_b16 v[36:37], v87 offset:3080
s_mov_b32 m0, s75
v_mfma_f32_16x16x32_bf16 a[176:179], v[20:23], v[40:43], a[176:179]
ds_read_b64_tr_b16 v[38:39], v87 offset:11272
s_add_u32 s75, s75, 1024
v_mfma_f32_16x16x32_bf16 a[180:183], v[20:23], v[44:47], a[180:183]
v_mfma_f32_16x16x32_bf16 a[184:187], v[20:23], v[48:51], a[184:187]
buffer_load_dwordx4 v90, s[12:15], s63 offen offset:0 lds
s_add_u32 s63, s63, 7168
v_mfma_f32_16x16x32_bf16 a[188:191], v[20:23], v[52:55], a[188:191]
s_waitcnt lgkmcnt(4)
s_add_u32 s68, s68, 128
v_mfma_f32_16x16x32_bf16 a[192:195], v[24:27], v[40:43], a[192:195]
s_xor_b32 s64, s64, s70
v_mfma_f32_16x16x32_bf16 a[196:199], v[24:27], v[44:47], a[196:199]
v_mfma_f32_16x16x32_bf16 a[200:203], v[24:27], v[48:51], a[200:203]
v_mfma_f32_16x16x32_bf16 a[204:207], v[24:27], v[52:55], a[204:207]
s_mov_b32 s65, s61
s_mov_b32 s61, s62
v_mfma_f32_16x16x32_bf16 a[208:211], v[28:31], v[40:43], a[208:211]
s_mov_b32 s62, s67
s_mov_b32 s67, s65
v_mfma_f32_16x16x32_bf16 a[212:215], v[28:31], v[44:47], a[212:215]
v_mfma_f32_16x16x32_bf16 a[216:219], v[28:31], v[48:51], a[216:219]
v_mfma_f32_16x16x32_bf16 a[220:223], v[28:31], v[52:55], a[220:223]
s_waitcnt vmcnt(12) lgkmcnt(0)
s_barrier
v_mfma_f32_16x16x32_bf16 a[224:227], v[32:35], v[40:43], a[224:227]
ds_read_b64_tr_b16 v[8:9], v88 offset:0
ds_read_b64_tr_b16 v[10:11], v88 offset:8192
v_mfma_f32_16x16x32_bf16 a[228:231], v[32:35], v[44:47], a[228:231]
ds_read_b128 v[60:63], v83 offset:0
ds_read_b64_tr_b16 v[12:13], v88 offset:8
v_mfma_f32_16x16x32_bf16 a[232:235], v[32:35], v[48:51], a[232:235]
ds_read_b128 v[64:67], v83 offset:2048
ds_read_b64_tr_b16 v[14:15], v88 offset:8200
v_mfma_f32_16x16x32_bf16 a[236:239], v[32:35], v[52:55], a[236:239]
ds_read_b128 v[68:71], v83 offset:4096
ds_read_b128 v[72:75], v83 offset:6144
v_mfma_f32_16x16x32_bf16 a[240:243], v[36:39], v[40:43], a[240:243]
ds_read_b64_tr_b16 v[16:17], v89 offset:0
ds_read_b64_tr_b16 v[18:19], v89 offset:8192
v_mfma_f32_16x16x32_bf16 a[244:247], v[36:39], v[44:47], a[244:247]
ds_read_b64_tr_b16 v[20:21], v89 offset:8
v_mfma_f32_16x16x32_bf16 a[248:251], v[36:39], v[48:51], a[248:251]
ds_read_b64_tr_b16 v[22:23], v89 offset:8200
v_mfma_f32_16x16x32_bf16 a[252:255], v[36:39], v[52:55], a[252:255]
s_waitcnt lgkmcnt(4)
v_mfma_f32_16x16x32_bf16 a[0:3], v[8:11], v[60:63], a[0:3]
ds_read_b64_tr_b16 v[24:25], v88 offset:1024
v_mfma_f32_16x16x32_bf16 a[4:7], v[8:11], v[64:67], a[4:7]
ds_read_b64_tr_b16 v[26:27], v88 offset:9216
s_add_u32 m0, s67, s71
v_mfma_f32_16x16x32_bf16 a[8:11], v[8:11], v[68:71], a[8:11]
v_mfma_f32_16x16x32_bf16 a[12:15], v[8:11], v[72:75], a[12:15]
ds_read_b64_tr_b16 v[28:29], v88 offset:1032
buffer_load_dwordx4 v91, s[16:19], s24 offen offset:0 lds
v_mfma_f32_16x16x32_bf16 a[16:19], v[12:15], v[60:63], a[16:19]
ds_read_b64_tr_b16 v[30:31], v88 offset:9224
v_mfma_f32_16x16x32_bf16 a[20:23], v[12:15], v[64:67], a[20:23]
v_mfma_f32_16x16x32_bf16 a[24:27], v[12:15], v[68:71], a[24:27]
v_mfma_f32_16x16x32_bf16 a[28:31], v[12:15], v[72:75], a[28:31]
s_waitcnt lgkmcnt(4)
v_mfma_f32_16x16x32_bf16 a[32:35], v[16:19], v[60:63], a[32:35]
ds_read_b64_tr_b16 v[32:33], v89 offset:1024
v_mfma_f32_16x16x32_bf16 a[36:39], v[16:19], v[64:67], a[36:39]
ds_read_b64_tr_b16 v[34:35], v89 offset:9216
buffer_load_dwordx4 v91, s[16:19], s25 offen offset:1024 lds
v_mfma_f32_16x16x32_bf16 a[40:43], v[16:19], v[68:71], a[40:43]
v_mfma_f32_16x16x32_bf16 a[44:47], v[16:19], v[72:75], a[44:47]
ds_read_b64_tr_b16 v[36:37], v89 offset:1032
v_mfma_f32_16x16x32_bf16 a[48:51], v[20:23], v[60:63], a[48:51]
ds_read_b64_tr_b16 v[38:39], v89 offset:9224
v_mfma_f32_16x16x32_bf16 a[52:55], v[20:23], v[64:67], a[52:55]
v_mfma_f32_16x16x32_bf16 a[56:59], v[20:23], v[68:71], a[56:59]
v_mfma_f32_16x16x32_bf16 a[60:63], v[20:23], v[72:75], a[60:63]
s_waitcnt lgkmcnt(4)
buffer_load_dwordx4 v91, s[16:19], s26 offen offset:2048 lds
v_mfma_f32_16x16x32_bf16 a[64:67], v[24:27], v[60:63], a[64:67]
ds_read_b64_tr_b16 v[8:9], v88 offset:2048
v_mfma_f32_16x16x32_bf16 a[68:71], v[24:27], v[64:67], a[68:71]
ds_read_b64_tr_b16 v[10:11], v88 offset:10240
v_mfma_f32_16x16x32_bf16 a[72:75], v[24:27], v[68:71], a[72:75]
v_mfma_f32_16x16x32_bf16 a[76:79], v[24:27], v[72:75], a[76:79]
ds_read_b64_tr_b16 v[12:13], v88 offset:2056
v_mfma_f32_16x16x32_bf16 a[80:83], v[28:31], v[60:63], a[80:83]
ds_read_b64_tr_b16 v[14:15], v88 offset:10248
v_mfma_f32_16x16x32_bf16 a[84:87], v[28:31], v[64:67], a[84:87]
buffer_load_dwordx4 v91, s[16:19], 0 offen offset:3072 lds
v_mfma_f32_16x16x32_bf16 a[88:91], v[28:31], v[68:71], a[88:91]
s_add_u32 s16, s16, 262144
s_addc_u32 s17, s17, 0
v_mfma_f32_16x16x32_bf16 a[92:95], v[28:31], v[72:75], a[92:95]
s_waitcnt lgkmcnt(4)
s_mov_b32 s75, s64
v_mfma_f32_16x16x32_bf16 a[96:99], v[32:35], v[60:63], a[96:99]
ds_read_b64_tr_b16 v[16:17], v89 offset:2048
s_mov_b32 s63, s68
v_mfma_f32_16x16x32_bf16 a[100:103], v[32:35], v[64:67], a[100:103]
s_mov_b32 m0, s75
ds_read_b64_tr_b16 v[18:19], v89 offset:10240
v_mfma_f32_16x16x32_bf16 a[104:107], v[32:35], v[68:71], a[104:107]
s_add_u32 s75, s75, 1024
v_mfma_f32_16x16x32_bf16 a[108:111], v[32:35], v[72:75], a[108:111]
ds_read_b64_tr_b16 v[20:21], v89 offset:2056
buffer_load_dwordx4 v90, s[12:15], s63 offen offset:0 lds
v_mfma_f32_16x16x32_bf16 a[112:115], v[36:39], v[60:63], a[112:115]
ds_read_b64_tr_b16 v[22:23], v89 offset:10248
v_mfma_f32_16x16x32_bf16 a[116:119], v[36:39], v[64:67], a[116:119]
s_add_u32 s63, s63, 7168
v_mfma_f32_16x16x32_bf16 a[120:123], v[36:39], v[68:71], a[120:123]
s_mov_b32 m0, s75
s_add_u32 s75, s75, 1024
v_mfma_f32_16x16x32_bf16 a[124:127], v[36:39], v[72:75], a[124:127]
s_waitcnt lgkmcnt(4)
v_mfma_f32_16x16x32_bf16 a[128:131], v[8:11], v[60:63], a[128:131]
ds_read_b64_tr_b16 v[24:25], v88 offset:3072
v_add_u32 v86, s62, v84
v_mfma_f32_16x16x32_bf16 a[132:135], v[8:11], v[64:67], a[132:135]
ds_read_b64_tr_b16 v[26:27], v88 offset:11264
buffer_load_dwordx4 v90, s[12:15], s63 offen offset:0 lds
v_mfma_f32_16x16x32_bf16 a[136:139], v[8:11], v[68:71], a[136:139]
v_add_u32 v87, s62, v85
v_add_u32 v82, s60, v80
v_mfma_f32_16x16x32_bf16 a[140:143], v[8:11], v[72:75], a[140:143]
ds_read_b64_tr_b16 v[28:29], v88 offset:3080
s_add_u32 s63, s63, 7168
v_mfma_f32_16x16x32_bf16 a[144:147], v[12:15], v[60:63], a[144:147]
ds_read_b64_tr_b16 v[30:31], v88 offset:11272
s_mov_b32 m0, s75
v_mfma_f32_16x16x32_bf16 a[148:151], v[12:15], v[64:67], a[148:151]
s_add_u32 s75, s75, 1024
v_add_u32 v83, s60, v81
v_mfma_f32_16x16x32_bf16 a[152:155], v[12:15], v[68:71], a[152:155]
s_xor_b32 s60, s60, 38912
v_mfma_f32_16x16x32_bf16 a[156:159], v[12:15], v[72:75], a[156:159]
s_waitcnt lgkmcnt(4)
buffer_load_dwordx4 v90, s[12:15], s63 offen offset:0 lds
v_mfma_f32_16x16x32_bf16 a[160:163], v[16:19], v[60:63], a[160:163]
ds_read_b64_tr_b16 v[32:33], v89 offset:3072
v_mfma_f32_16x16x32_bf16 a[164:167], v[16:19], v[64:67], a[164:167]
ds_read_b64_tr_b16 v[34:35], v89 offset:11264
v_mfma_f32_16x16x32_bf16 a[168:171], v[16:19], v[68:71], a[168:171]
s_add_u32 s63, s63, 7168
v_mfma_f32_16x16x32_bf16 a[172:175], v[16:19], v[72:75], a[172:175]
ds_read_b64_tr_b16 v[36:37], v89 offset:3080
s_mov_b32 m0, s75
v_mfma_f32_16x16x32_bf16 a[176:179], v[20:23], v[60:63], a[176:179]
ds_read_b64_tr_b16 v[38:39], v89 offset:11272
s_add_u32 s75, s75, 1024
v_mfma_f32_16x16x32_bf16 a[180:183], v[20:23], v[64:67], a[180:183]
v_mfma_f32_16x16x32_bf16 a[184:187], v[20:23], v[68:71], a[184:187]
buffer_load_dwordx4 v90, s[12:15], s63 offen offset:0 lds
s_add_u32 s63, s63, 7168
v_mfma_f32_16x16x32_bf16 a[188:191], v[20:23], v[72:75], a[188:191]
s_waitcnt lgkmcnt(4)
v_mfma_f32_16x16x32_bf16 a[192:195], v[24:27], v[60:63], a[192:195]
v_mfma_f32_16x16x32_bf16 a[196:199], v[24:27], v[64:67], a[196:199]
v_mfma_f32_16x16x32_bf16 a[200:203], v[24:27], v[68:71], a[200:203]
v_mfma_f32_16x16x32_bf16 a[204:207], v[24:27], v[72:75], a[204:207]
s_mov_b32 s65, s61
s_mov_b32 s61, s62
v_mfma_f32_16x16x32_bf16 a[208:211], v[28:31], v[60:63], a[208:211]
s_mov_b32 s62, s67
s_mov_b32 s67, s65
v_mfma_f32_16x16x32_bf16 a[212:215], v[28:31], v[64:67], a[212:215]
v_mfma_f32_16x16x32_bf16 a[216:219], v[28:31], v[68:71], a[216:219]
v_mfma_f32_16x16x32_bf16 a[220:223], v[28:31], v[72:75], a[220:223]
s_waitcnt vmcnt(8) lgkmcnt(0)
s_barrier
v_mfma_f32_16x16x32_bf16 a[224:227], v[32:35], v[60:63], a[224:227]
ds_read_b64_tr_b16 v[8:9], v86 offset:0
ds_read_b64_tr_b16 v[10:11], v86 offset:8192
v_mfma_f32_16x16x32_bf16 a[228:231], v[32:35], v[64:67], a[228:231]
ds_read_b128 v[40:43], v82 offset:0
ds_read_b64_tr_b16 v[12:13], v86 offset:8
v_mfma_f32_16x16x32_bf16 a[232:235], v[32:35], v[68:71], a[232:235]
ds_read_b128 v[44:47], v82 offset:2048
ds_read_b64_tr_b16 v[14:15], v86 offset:8200
v_mfma_f32_16x16x32_bf16 a[236:239], v[32:35], v[72:75], a[236:239]
ds_read_b128 v[48:51], v82 offset:4096
ds_read_b128 v[52:55], v82 offset:6144
v_mfma_f32_16x16x32_bf16 a[240:243], v[36:39], v[60:63], a[240:243]
ds_read_b64_tr_b16 v[16:17], v87 offset:0
ds_read_b64_tr_b16 v[18:19], v87 offset:8192
v_mfma_f32_16x16x32_bf16 a[244:247], v[36:39], v[64:67], a[244:247]
ds_read_b64_tr_b16 v[20:21], v87 offset:8
v_mfma_f32_16x16x32_bf16 a[248:251], v[36:39], v[68:71], a[248:251]
ds_read_b64_tr_b16 v[22:23], v87 offset:8200
v_mfma_f32_16x16x32_bf16 a[252:255], v[36:39], v[72:75], a[252:255]
s_sub_u32 s32, s32, 1
s_cmp_lg_u32 s32, 0
s_cbranch_scc1 L_qp_r4
s_waitcnt lgkmcnt(4)
v_mfma_f32_16x16x32_bf16 a[0:3], v[8:11], v[40:43], a[0:3]
ds_read_b64_tr_b16 v[24:25], v86 offset:1024
v_mfma_f32_16x16x32_bf16 a[4:7], v[8:11], v[44:47], a[4:7]
ds_read_b64_tr_b16 v[26:27], v86 offset:9216
s_add_u32 m0, s67, s71
v_mfma_f32_16x16x32_bf16 a[8:11], v[8:11], v[48:51], a[8:11]
v_mfma_f32_16x16x32_bf16 a[12:15], v[8:11], v[52:55], a[12:15]
ds_read_b64_tr_b16 v[28:29], v86 offset:1032
buffer_load_dwordx4 v91, s[16:19], s24 offen offset:0 lds
v_mfma_f32_16x16x32_bf16 a[16:19], v[12:15], v[40:43], a[16:19]
ds_read_b64_tr_b16 v[30:31], v86 offset:9224
v_mfma_f32_16x16x32_bf16 a[20:23], v[12:15], v[44:47], a[20:23]
v_mfma_f32_16x16x32_bf16 a[24:27], v[12:15], v[48:51], a[24:27]
v_mfma_f32_16x16x32_bf16 a[28:31], v[12:15], v[52:55], a[28:31]
s_waitcnt lgkmcnt(4)
v_mfma_f32_16x16x32_bf16 a[32:35], v[16:19], v[40:43], a[32:35]
ds_read_b64_tr_b16 v[32:33], v87 offset:1024
v_mfma_f32_16x16x32_bf16 a[36:39], v[16:19], v[44:47], a[36:39]
ds_read_b64_tr_b16 v[34:35], v87 offset:9216
buffer_load_dwordx4 v91, s[16:19], s25 offen offset:1024 lds
v_mfma_f32_16x16x32_bf16 a[40:43], v[16:19], v[48:51], a[40:43]
v_mfma_f32_16x16x32_bf16 a[44:47], v[16:19], v[52:55], a[44:47]
ds_read_b64_tr_b16 v[36:37], v87 offset:1032
v_mfma_f32_16x16x32_bf16 a[48:51], v[20:23], v[40:43], a[48:51]
ds_read_b64_tr_b16 v[38:39], v87 offset:9224
v_mfma_f32_16x16x32_bf16 a[52:55], v[20:23], v[44:47], a[52:55]
v_mfma_f32_16x16x32_bf16 a[56:59], v[20:23], v[48:51], a[56:59]
v_mfma_f32_16x16x32_bf16 a[60:63], v[20:23], v[52:55], a[60:63]
s_waitcnt lgkmcnt(4)
buffer_load_dwordx4 v91, s[16:19], s26 offen offset:2048 lds
v_mfma_f32_16x16x32_bf16 a[64:67], v[24:27], v[40:43], a[64:67]
ds_read_b64_tr_b16 v[8:9], v86 offset:2048
v_mfma_f32_16x16x32_bf16 a[68:71], v[24:27], v[44:47], a[68:71]
ds_read_b64_tr_b16 v[10:11], v86 offset:10240
v_mfma_f32_16x16x32_bf16 a[72:75], v[24:27], v[48:51], a[72:75]
v_mfma_f32_16x16x32_bf16 a[76:79], v[24:27], v[52:55], a[76:79]
ds_read_b64_tr_b16 v[12:13], v86 offset:2056
v_mfma_f32_16x16x32_bf16 a[80:83], v[28:31], v[40:43], a[80:83]
ds_read_b64_tr_b16 v[14:15], v86 offset:10248
v_mfma_f32_16x16x32_bf16 a[84:87], v[28:31], v[44:47], a[84:87]
buffer_load_dwordx4 v91, s[16:19], 0 offen offset:3072 lds
v_mfma_f32_16x16x32_bf16 a[88:91], v[28:31], v[48:51], a[88:91]
s_add_u32 s16, s16, 262144
s_addc_u32 s17, s17, 0
v_mfma_f32_16x16x32_bf16 a[92:95], v[28:31], v[52:55], a[92:95]
s_waitcnt lgkmcnt(4)
v_mfma_f32_16x16x32_bf16 a[96:99], v[32:35], v[40:43], a[96:99]
ds_read_b64_tr_b16 v[16:17], v87 offset:2048
s_mov_b32 m0, s75
v_mfma_f32_16x16x32_bf16 a[100:103], v[32:35], v[44:47], a[100:103]
ds_read_b64_tr_b16 v[18:19], v87 offset:10240
s_add_u32 s75, s75, 1024
v_mfma_f32_16x16x32_bf16 a[104:107], v[32:35], v[48:51], a[104:107]
v_mfma_f32_16x16x32_bf16 a[108:111], v[32:35], v[52:55], a[108:111]
ds_read_b64_tr_b16 v[20:21], v87 offset:2056
buffer_load_dwordx4 v90, s[12:15], s63 offen offset:0 lds
v_mfma_f32_16x16x32_bf16 a[112:115], v[36:39], v[40:43], a[112:115]
ds_read_b64_tr_b16 v[22:23], v87 offset:10248
v_mfma_f32_16x16x32_bf16 a[116:119], v[36:39], v[44:47], a[116:119]
s_add_u32 s63, s63, 7168
v_mfma_f32_16x16x32_bf16 a[120:123], v[36:39], v[48:51], a[120:123]
s_mov_b32 m0, s75
s_add_u32 s75, s75, 1024
v_mfma_f32_16x16x32_bf16 a[124:127], v[36:39], v[52:55], a[124:127]
s_waitcnt lgkmcnt(4)
v_mfma_f32_16x16x32_bf16 a[128:131], v[8:11], v[40:43], a[128:131]
ds_read_b64_tr_b16 v[24:25], v86 offset:3072
v_add_u32 v88, s62, v84
v_mfma_f32_16x16x32_bf16 a[132:135], v[8:11], v[44:47], a[132:135]
ds_read_b64_tr_b16 v[26:27], v86 offset:11264
buffer_load_dwordx4 v90, s[12:15], s63 offen offset:0 lds
v_mfma_f32_16x16x32_bf16 a[136:139], v[8:11], v[48:51], a[136:139]
v_add_u32 v89, s62, v85
v_mfma_f32_16x16x32_bf16 a[140:143], v[8:11], v[52:55], a[140:143]
ds_read_b64_tr_b16 v[28:29], v86 offset:3080
s_add_u32 s63, s63, 7168
v_mfma_f32_16x16x32_bf16 a[144:147], v[12:15], v[40:43], a[144:147]
ds_read_b64_tr_b16 v[30:31], v86 offset:11272
s_mov_b32 m0, s75
v_mfma_f32_16x16x32_bf16 a[148:151], v[12:15], v[44:47], a[148:151]
s_add_u32 s75, s75, 1024
v_mfma_f32_16x16x32_bf16 a[152:155], v[12:15], v[48:51], a[152:155]
v_mfma_f32_16x16x32_bf16 a[156:159], v[12:15], v[52:55], a[156:159]
s_waitcnt lgkmcnt(4)
buffer_load_dwordx4 v90, s[12:15], s63 offen offset:0 lds
v_mfma_f32_16x16x32_bf16 a[160:163], v[16:19], v[40:43], a[160:163]
ds_read_b64_tr_b16 v[32:33], v87 offset:3072
v_mfma_f32_16x16x32_bf16 a[164:167], v[16:19], v[44:47], a[164:167]
ds_read_b64_tr_b16 v[34:35], v87 offset:11264
v_mfma_f32_16x16x32_bf16 a[168:171], v[16:19], v[48:51], a[168:171]
s_add_u32 s63, s63, 7168
v_mfma_f32_16x16x32_bf16 a[172:175], v[16:19], v[52:55], a[172:175]
ds_read_b64_tr_b16 v[36:37], v87 offset:3080
s_mov_b32 m0, s75
v_mfma_f32_16x16x32_bf16 a[176:179], v[20:23], v[40:43], a[176:179]
ds_read_b64_tr_b16 v[38:39], v87 offset:11272
s_add_u32 s75, s75, 1024
v_mfma_f32_16x16x32_bf16 a[180:183], v[20:23], v[44:47], a[180:183]
v_mfma_f32_16x16x32_bf16 a[184:187], v[20:23], v[48:51], a[184:187]
buffer_load_dwordx4 v90, s[12:15], s63 offen offset:0 lds
s_add_u32 s63, s63, 7168
v_mfma_f32_16x16x32_bf16 a[188:191], v[20:23], v[52:55], a[188:191]
s_waitcnt lgkmcnt(4)
s_add_u32 s68, s68, 128
v_mfma_f32_16x16x32_bf16 a[192:195], v[24:27], v[40:43], a[192:195]
s_xor_b32 s64, s64, s70
v_mfma_f32_16x16x32_bf16 a[196:199], v[24:27], v[44:47], a[196:199]
v_mfma_f32_16x16x32_bf16 a[200:203], v[24:27], v[48:51], a[200:203]
v_mfma_f32_16x16x32_bf16 a[204:207], v[24:27], v[52:55], a[204:207]
s_mov_b32 s65, s61
s_mov_b32 s61, s62
v_mfma_f32_16x16x32_bf16 a[208:211], v[28:31], v[40:43], a[208:211]
s_mov_b32 s62, s67
s_mov_b32 s67, s65
v_mfma_f32_16x16x32_bf16 a[212:215], v[28:31], v[44:47], a[212:215]
v_mfma_f32_16x16x32_bf16 a[216:219], v[28:31], v[48:51], a[216:219]
v_mfma_f32_16x16x32_bf16 a[220:223], v[28:31], v[52:55], a[220:223]
s_waitcnt vmcnt(12) lgkmcnt(0)
s_barrier
v_mfma_f32_16x16x32_bf16 a[224:227], v[32:35], v[40:43], a[224:227]
ds_read_b64_tr_b16 v[8:9], v88 offset:0
ds_read_b64_tr_b16 v[10:11], v88 offset:8192
v_mfma_f32_16x16x32_bf16 a[228:231], v[32:35], v[44:47], a[228:231]
ds_read_b128 v[60:63], v83 offset:0
ds_read_b64_tr_b16 v[12:13], v88 offset:8
v_mfma_f32_16x16x32_bf16 a[232:235], v[32:35], v[48:51], a[232:235]
ds_read_b128 v[64:67], v83 offset:2048
ds_read_b64_tr_b16 v[14:15], v88 offset:8200
v_mfma_f32_16x16x32_bf16 a[236:239], v[32:35], v[52:55], a[236:239]
ds_read_b128 v[68:71], v83 offset:4096
ds_read_b128 v[72:75], v83 offset:6144
v_mfma_f32_16x16x32_bf16 a[240:243], v[36:39], v[40:43], a[240:243]
ds_read_b64_tr_b16 v[16:17], v89 offset:0
ds_read_b64_tr_b16 v[18:19], v89 offset:8192
v_mfma_f32_16x16x32_bf16 a[244:247], v[36:39], v[44:47], a[244:247]
ds_read_b64_tr_b16 v[20:21], v89 offset:8
v_mfma_f32_16x16x32_bf16 a[248:251], v[36:39], v[48:51], a[248:251]
ds_read_b64_tr_b16 v[22:23], v89 offset:8200
v_mfma_f32_16x16x32_bf16 a[252:255], v[36:39], v[52:55], a[252:255]
s_waitcnt lgkmcnt(4)
v_mfma_f32_16x16x32_bf16 a[0:3], v[8:11], v[60:63], a[0:3]
ds_read_b64_tr_b16 v[24:25], v88 offset:1024
v_mfma_f32_16x16x32_bf16 a[4:7], v[8:11], v[64:67], a[4:7]
ds_read_b64_tr_b16 v[26:27], v88 offset:9216
s_add_u32 m0, s67, s71
v_mfma_f32_16x16x32_bf16 a[8:11], v[8:11], v[68:71], a[8:11]
v_mfma_f32_16x16x32_bf16 a[12:15], v[8:11], v[72:75], a[12:15]
ds_read_b64_tr_b16 v[28:29], v88 offset:1032
buffer_load_dwordx4 v91, s[16:19], s24 offen offset:0 lds
v_mfma_f32_16x16x32_bf16 a[16:19], v[12:15], v[60:63], a[16:19]
ds_read_b64_tr_b16 v[30:31], v88 offset:9224
v_mfma_f32_16x16x32_bf16 a[20:23], v[12:15], v[64:67], a[20:23]
v_mfma_f32_16x16x32_bf16 a[24:27], v[12:15], v[68:71], a[24:27]
v_mfma_f32_16x16x32_bf16 a[28:31], v[12:15], v[72:75], a[28:31]
s_waitcnt lgkmcnt(4)
v_mfma_f32_16x16x32_bf16 a[32:35], v[16:19], v[60:63], a[32:35]
ds_read_b64_tr_b16 v[32:33], v89 offset:1024
v_mfma_f32_16x16x32_bf16 a[36:39], v[16:19], v[64:67], a[36:39]
ds_read_b64_tr_b16 v[34:35], v89 offset:9216
buffer_load_dwordx4 v91, s[16:19], s25 offen offset:1024 lds
v_mfma_f32_16x16x32_bf16 a[40:43], v[16:19], v[68:71], a[40:43]
v_mfma_f32_16x16x32_bf16 a[44:47], v[16:19], v[72:75], a[44:47]
ds_read_b64_tr_b16 v[36:37], v89 offset:1032
v_mfma_f32_16x16x32_bf16 a[48:51], v[20:23], v[60:63], a[48:51]
ds_read_b64_tr_b16 v[38:39], v89 offset:9224
v_mfma_f32_16x16x32_bf16 a[52:55], v[20:23], v[64:67], a[52:55]
v_mfma_f32_16x16x32_bf16 a[56:59], v[20:23], v[68:71], a[56:59]
v_mfma_f32_16x16x32_bf16 a[60:63], v[20:23], v[72:75], a[60:63]
s_waitcnt lgkmcnt(4)
buffer_load_dwordx4 v91, s[16:19], s26 offen offset:2048 lds
v_mfma_f32_16x16x32_bf16 a[64:67], v[24:27], v[60:63], a[64:67]
ds_read_b64_tr_b16 v[8:9], v88 offset:2048
v_mfma_f32_16x16x32_bf16 a[68:71], v[24:27], v[64:67], a[68:71]
ds_read_b64_tr_b16 v[10:11], v88 offset:10240
v_mfma_f32_16x16x32_bf16 a[72:75], v[24:27], v[68:71], a[72:75]
v_mfma_f32_16x16x32_bf16 a[76:79], v[24:27], v[72:75], a[76:79]
ds_read_b64_tr_b16 v[12:13], v88 offset:2056
v_mfma_f32_16x16x32_bf16 a[80:83], v[28:31], v[60:63], a[80:83]
ds_read_b64_tr_b16 v[14:15], v88 offset:10248
v_mfma_f32_16x16x32_bf16 a[84:87], v[28:31], v[64:67], a[84:87]
buffer_load_dwordx4 v91, s[16:19], 0 offen offset:3072 lds
v_mfma_f32_16x16x32_bf16 a[88:91], v[28:31], v[68:71], a[88:91]
s_add_u32 m0, s72, 0
v_mfma_f32_16x16x32_bf16 a[92:95], v[28:31], v[72:75], a[92:95]
s_waitcnt lgkmcnt(4)
v_mfma_f32_16x16x32_bf16 a[96:99], v[32:35], v[60:63], a[96:99]
ds_read_b64_tr_b16 v[16:17], v89 offset:2048
buffer_load_dwordx4 v160, s[44:47], 0 offen offset:0 nt lds
v_mfma_f32_16x16x32_bf16 a[100:103], v[32:35], v[64:67], a[100:103]
s_add_u32 s16, s16, 262144
s_addc_u32 s17, s17, 0
v_mfma_f32_16x16x32_bf16 a[104:107], v[32:35], v[68:71], a[104:107]
ds_read_b64_tr_b16 v[18:19], v89 offset:10240
v_mfma_f32_16x16x32_bf16 a[108:111], v[32:35], v[72:75], a[108:111]
ds_read_b64_tr_b16 v[20:21], v89 offset:2056
buffer_load_dwordx4 v161, s[44:47], 0 offen offset:1024 nt lds
v_mfma_f32_16x16x32_bf16 a[112:115], v[36:39], v[60:63], a[112:115]
ds_read_b64_tr_b16 v[22:23], v89 offset:10248
v_mfma_f32_16x16x32_bf16 a[116:119], v[36:39], v[64:67], a[116:119]
v_mfma_f32_16x16x32_bf16 a[120:123], v[36:39], v[68:71], a[120:123]
buffer_load_dwordx4 v162, s[44:47], 0 offen offset:2048 nt lds
v_mfma_f32_16x16x32_bf16 a[124:127], v[36:39], v[72:75], a[124:127]
s_waitcnt lgkmcnt(4)
v_mfma_f32_16x16x32_bf16 a[128:131], v[8:11], v[60:63], a[128:131]
ds_read_b64_tr_b16 v[24:25], v88 offset:3072
v_add_u32 v86, s62, v84
v_mfma_f32_16x16x32_bf16 a[132:135], v[8:11], v[64:67], a[132:135]
ds_read_b64_tr_b16 v[26:27], v88 offset:11264
buffer_load_dwordx4 v163, s[44:47], 0 offen offset:3072 nt lds
v_mfma_f32_16x16x32_bf16 a[136:139], v[8:11], v[68:71], a[136:139]
s_add_u32 m0, s72, 4096
v_add_u32 v87, s62, v85
v_mfma_f32_16x16x32_bf16 a[140:143], v[8:11], v[72:75], a[140:143]
ds_read_b64_tr_b16 v[28:29], v88 offset:3080
v_add_u32 v82, s60, v80
v_mfma_f32_16x16x32_bf16 a[144:147], v[12:15], v[60:63], a[144:147]
ds_read_b64_tr_b16 v[30:31], v88 offset:11272
buffer_load_dwordx4 v164, s[44:47], 0 offen offset:0 nt lds
v_mfma_f32_16x16x32_bf16 a[148:151], v[12:15], v[64:67], a[148:151]
v_add_u32 v83, s60, v81
s_xor_b32 s60, s60, 38912
v_mfma_f32_16x16x32_bf16 a[152:155], v[12:15], v[68:71], a[152:155]
v_mfma_f32_16x16x32_bf16 a[156:159], v[12:15], v[72:75], a[156:159]
s_waitcnt lgkmcnt(4)
buffer_load_dwordx4 v165, s[44:47], 0 offen offset:1024 nt lds
v_mfma_f32_16x16x32_bf16 a[160:163], v[16:19], v[60:63], a[160:163]
ds_read_b64_tr_b16 v[32:33], v89 offset:3072
v_mfma_f32_16x16x32_bf16 a[164:167], v[16:19], v[64:67], a[164:167]
ds_read_b64_tr_b16 v[34:35], v89 offset:11264
v_mfma_f32_16x16x32_bf16 a[168:171], v[16:19], v[68:71], a[168:171]
buffer_load_dwordx4 v166, s[44:47], 0 offen offset:2048 nt lds
v_mfma_f32_16x16x32_bf16 a[172:175], v[16:19], v[72:75], a[172:175]
ds_read_b64_tr_b16 v[36:37], v89 offset:3080
v_mfma_f32_16x16x32_bf16 a[176:179], v[20:23], v[60:63], a[176:179]
ds_read_b64_tr_b16 v[38:39], v89 offset:11272
v_mfma_f32_16x16x32_bf16 a[180:183], v[20:23], v[64:67], a[180:183]
v_mfma_f32_16x16x32_bf16 a[184:187], v[20:23], v[68:71], a[184:187]
v_mfma_f32_16x16x32_bf16 a[188:191], v[20:23], v[72:75], a[188:191]
s_waitcnt lgkmcnt(4)
v_mfma_f32_16x16x32_bf16 a[192:195], v[24:27], v[60:63], a[192:195]
v_mfma_f32_16x16x32_bf16 a[196:199], v[24:27], v[64:67], a[196:199]
v_mfma_f32_16x16x32_bf16 a[200:203], v[24:27], v[68:71], a[200:203]
v_mfma_f32_16x16x32_bf16 a[204:207], v[24:27], v[72:75], a[204:207]
s_mov_b32 s65, s61
s_mov_b32 s61, s62
v_mfma_f32_16x16x32_bf16 a[208:211], v[28:31], v[60:63], a[208:211]
s_mov_b32 s62, s67
s_mov_b32 s67, s65
v_mfma_f32_16x16x32_bf16 a[212:215], v[28:31], v[64:67], a[212:215]
v_mfma_f32_16x16x32_bf16 a[216:219], v[28:31], v[68:71], a[216:219]
v_mfma_f32_16x16x32_bf16 a[220:223], v[28:31], v[72:75], a[220:223]
s_waitcnt vmcnt(11) lgkmcnt(0)
s_barrier
v_mfma_f32_16x16x32_bf16 a[224:227], v[32:35], v[60:63], a[224:227]
ds_read_b64_tr_b16 v[8:9], v86 offset:0
ds_read_b64_tr_b16 v[10:11], v86 offset:8192
v_mfma_f32_16x16x32_bf16 a[228:231], v[32:35], v[64:67], a[228:231]
ds_read_b128 v[40:43], v82 offset:0
ds_read_b64_tr_b16 v[12:13], v86 offset:8
v_mfma_f32_16x16x32_bf16 a[232:235], v[32:35], v[68:71], a[232:235]
ds_read_b128 v[44:47], v82 offset:2048
ds_read_b64_tr_b16 v[14:15], v86 offset:8200
v_mfma_f32_16x16x32_bf16 a[236:239], v[32:35], v[72:75], a[236:239]
ds_read_b128 v[48:51], v82 offset:4096
ds_read_b128 v[52:55], v82 offset:6144
v_mfma_f32_16x16x32_bf16 a[240:243], v[36:39], v[60:63], a[240:243]
ds_read_b64_tr_b16 v[16:17], v87 offset:0
ds_read_b64_tr_b16 v[18:19], v87 offset:8192
v_mfma_f32_16x16x32_bf16 a[244:247], v[36:39], v[64:67], a[244:247]
ds_read_b64_tr_b16 v[20:21], v87 offset:8
v_mfma_f32_16x16x32_bf16 a[248:251], v[36:39], v[68:71], a[248:251]
ds_read_b64_tr_b16 v[22:23], v87 offset:8200
v_mfma_f32_16x16x32_bf16 a[252:255], v[36:39], v[72:75], a[252:255]
s_waitcnt lgkmcnt(4)
v_mfma_f32_16x16x32_bf16 a[0:3], v[8:11], v[40:43], a[0:3]
ds_read_b64_tr_b16 v[24:25], v86 offset:1024
v_mfma_f32_16x16x32_bf16 a[4:7], v[8:11], v[44:47], a[4:7]
ds_read_b64_tr_b16 v[26:27], v86 offset:9216
s_add_u32 m0, s28, s71
v_mfma_f32_16x16x32_bf16 a[8:11], v[8:11], v[48:51], a[8:11]
v_mfma_f32_16x16x32_bf16 a[12:15], v[8:11], v[52:55], a[12:15]
ds_read_b64_tr_b16 v[28:29], v86 offset:1032
buffer_load_dwordx4 v7, s[4:7], s24 offen offset:0 nt lds
v_mfma_f32_16x16x32_bf16 a[16:19], v[12:15], v[40:43], a[16:19]
ds_read_b64_tr_b16 v[30:31], v86 offset:9224
v_mfma_f32_16x16x32_bf16 a[20:23], v[12:15], v[44:47], a[20:23]
v_mfma_f32_16x16x32_bf16 a[24:27], v[12:15], v[48:51], a[24:27]
v_mfma_f32_16x16x32_bf16 a[28:31], v[12:15], v[52:55], a[28:31]
s_waitcnt lgkmcnt(4)
v_mfma_f32_16x16x32_bf16 a[32:35], v[16:19], v[40:43], a[32:35]
ds_read_b64_tr_b16 v[32:33], v87 offset:1024
v_mfma_f32_16x16x32_bf16 a[36:39], v[16:19], v[44:47], a[36:39]
ds_read_b64_tr_b16 v[34:35], v87 offset:9216
v_mfma_f32_16x16x32_bf16 a[40:43], v[16:19], v[48:51], a[40:43]
v_mfma_f32_16x16x32_bf16 a[44:47], v[16:19], v[52:55], a[44:47]
ds_read_b64_tr_b16 v[36:37], v87 offset:1032
v_mfma_f32_16x16x32_bf16 a[48:51], v[20:23], v[40:43], a[48:51]
ds_read_b64_tr_b16 v[38:39], v87 offset:9224
v_mfma_f32_16x16x32_bf16 a[52:55], v[20:23], v[44:47], a[52:55]
v_mfma_f32_16x16x32_bf16 a[56:59], v[20:23], v[48:51], a[56:59]
v_mfma_f32_16x16x32_bf16 a[60:63], v[20:23], v[52:55], a[60:63]
s_waitcnt lgkmcnt(4)
v_mfma_f32_16x16x32_bf16 a[64:67], v[24:27], v[40:43], a[64:67]
ds_read_b64_tr_b16 v[8:9], v86 offset:2048
v_mfma_f32_16x16x32_bf16 a[68:71], v[24:27], v[44:47], a[68:71]
ds_read_b64_tr_b16 v[10:11], v86 offset:10240
buffer_load_dwordx4 v7, s[4:7], s25 offen offset:1024 nt lds
v_mfma_f32_16x16x32_bf16 a[72:75], v[24:27], v[48:51], a[72:75]
v_mfma_f32_16x16x32_bf16 a[76:79], v[24:27], v[52:55], a[76:79]
ds_read_b64_tr_b16 v[12:13], v86 offset:2056
v_mfma_f32_16x16x32_bf16 a[80:83], v[28:31], v[40:43], a[80:83]
ds_read_b64_tr_b16 v[14:15], v86 offset:10248
v_mfma_f32_16x16x32_bf16 a[84:87], v[28:31], v[44:47], a[84:87]
v_mfma_f32_16x16x32_bf16 a[88:91], v[28:31], v[48:51], a[88:91]
v_mfma_f32_16x16x32_bf16 a[92:95], v[28:31], v[52:55], a[92:95]
s_waitcnt lgkmcnt(4)
v_mfma_f32_16x16x32_bf16 a[96:99], v[32:35], v[40:43], a[96:99]
ds_read_b64_tr_b16 v[16:17], v87 offset:2048
v_mfma_f32_16x16x32_bf16 a[100:103], v[32:35], v[44:47], a[100:103]
ds_read_b64_tr_b16 v[18:19], v87 offset:10240
v_mfma_f32_16x16x32_bf16 a[104:107], v[32:35], v[48:51], a[104:107]
v_mfma_f32_16x16x32_bf16 a[108:111], v[32:35], v[52:55], a[108:111]
ds_read_b64_tr_b16 v[20:21], v87 offset:2056
v_mfma_f32_16x16x32_bf16 a[112:115], v[36:39], v[40:43], a[112:115]
ds_read_b64_tr_b16 v[22:23], v87 offset:10248
v_mfma_f32_16x16x32_bf16 a[116:119], v[36:39], v[44:47], a[116:119]
v_mfma_f32_16x16x32_bf16 a[120:123], v[36:39], v[48:51], a[120:123]
v_mfma_f32_16x16x32_bf16 a[124:127], v[36:39], v[52:55], a[124:127]
s_waitcnt lgkmcnt(4)
buffer_load_dwordx4 v7, s[4:7], s26 offen offset:2048 nt lds
v_mfma_f32_16x16x32_bf16 a[128:131], v[8:11], v[40:43], a[128:131]
ds_read_b64_tr_b16 v[24:25], v86 offset:3072
v_add_u32 v88, s62, v84
v_mfma_f32_16x16x32_bf16 a[132:135], v[8:11], v[44:47], a[132:135]
ds_read_b64_tr_b16 v[26:27], v86 offset:11264
v_add_u32 v89, s62, v85
v_mfma_f32_16x16x32_bf16 a[136:139], v[8:11], v[48:51], a[136:139]
v_mfma_f32_16x16x32_bf16 a[140:143], v[8:11], v[52:55], a[140:143]
ds_read_b64_tr_b16 v[28:29], v86 offset:3080
v_mfma_f32_16x16x32_bf16 a[144:147], v[12:15], v[40:43], a[144:147]
ds_read_b64_tr_b16 v[30:31], v86 offset:11272
v_mfma_f32_16x16x32_bf16 a[148:151], v[12:15], v[44:47], a[148:151]
v_mfma_f32_16x16x32_bf16 a[152:155], v[12:15], v[48:51], a[152:155]
v_mfma_f32_16x16x32_bf16 a[156:159], v[12:15], v[52:55], a[156:159]
s_waitcnt lgkmcnt(4)
v_mfma_f32_16x16x32_bf16 a[160:163], v[16:19], v[40:43], a[160:163]
ds_read_b64_tr_b16 v[32:33], v87 offset:3072
v_mfma_f32_16x16x32_bf16 a[164:167], v[16:19], v[44:47], a[164:167]
ds_read_b64_tr_b16 v[34:35], v87 offset:11264
v_mfma_f32_16x16x32_bf16 a[168:171], v[16:19], v[48:51], a[168:171]
v_mfma_f32_16x16x32_bf16 a[172:175], v[16:19], v[52:55], a[172:175]
ds_read_b64_tr_b16 v[36:37], v87 offset:3080
v_mfma_f32_16x16x32_bf16 a[176:179], v[20:23], v[40:43], a[176:179]
ds_read_b64_tr_b16 v[38:39], v87 offset:11272
v_mfma_f32_16x16x32_bf16 a[180:183], v[20:23], v[44:47], a[180:183]
v_mfma_f32_16x16x32_bf16 a[184:187], v[20:23], v[48:51], a[184:187]
buffer_load_dwordx4 v7, s[4:7], 0 offen offset:3072 nt lds
v_mfma_f32_16x16x32_bf16 a[188:191], v[20:23], v[52:55], a[188:191]
s_waitcnt lgkmcnt(4)
v_mfma_f32_16x16x32_bf16 a[192:195], v[24:27], v[40:43], a[192:195]
s_add_u32 s4, s4, 16384
s_addc_u32 s5, s5, 0
v_mfma_f32_16x16x32_bf16 a[196:199], v[24:27], v[44:47], a[196:199]
v_mfma_f32_16x16x32_bf16 a[200:203], v[24:27], v[48:51], a[200:203]
v_mfma_f32_16x16x32_bf16 a[204:207], v[24:27], v[52:55], a[204:207]
s_mov_b32 s65, s61
s_mov_b32 s61, s62
v_mfma_f32_16x16x32_bf16 a[208:211], v[28:31], v[40:43], a[208:211]
s_mov_b32 s62, s67
s_mov_b32 s67, s65
v_mfma_f32_16x16x32_bf16 a[212:215], v[28:31], v[44:47], a[212:215]
v_mfma_f32_16x16x32_bf16 a[216:219], v[28:31], v[48:51], a[216:219]
v_mfma_f32_16x16x32_bf16 a[220:223], v[28:31], v[52:55], a[220:223]
s_waitcnt vmcnt(11) lgkmcnt(0)
s_barrier
v_mfma_f32_16x16x32_bf16 a[224:227], v[32:35], v[40:43], a[224:227]
ds_read_b64_tr_b16 v[8:9], v88 offset:0
ds_read_b64_tr_b16 v[10:11], v88 offset:8192
v_mfma_f32_16x16x32_bf16 a[228:231], v[32:35], v[44:47], a[228:231]
ds_read_b128 v[60:63], v83 offset:0
ds_read_b64_tr_b16 v[12:13], v88 offset:8
v_mfma_f32_16x16x32_bf16 a[232:235], v[32:35], v[48:51], a[232:235]
ds_read_b128 v[64:67], v83 offset:2048
ds_read_b64_tr_b16 v[14:15], v88 offset:8200
v_mfma_f32_16x16x32_bf16 a[236:239], v[32:35], v[52:55], a[236:239]
ds_read_b128 v[68:71], v83 offset:4096
ds_read_b128 v[72:75], v83 offset:6144
v_mfma_f32_16x16x32_bf16 a[240:243], v[36:39], v[40:43], a[240:243]
ds_read_b64_tr_b16 v[16:17], v89 offset:0
ds_read_b64_tr_b16 v[18:19], v89 offset:8192
v_mfma_f32_16x16x32_bf16 a[244:247], v[36:39], v[44:47], a[244:247]
ds_read_b64_tr_b16 v[20:21], v89 offset:8
v_mfma_f32_16x16x32_bf16 a[248:251], v[36:39], v[48:51], a[248:251]
ds_read_b64_tr_b16 v[22:23], v89 offset:8200
v_mfma_f32_16x16x32_bf16 a[252:255], v[36:39], v[52:55], a[252:255]
s_waitcnt lgkmcnt(4)
v_mfma_f32_16x16x32_bf16 a[0:3], v[8:11], v[60:63], a[0:3]
ds_read_b64_tr_b16 v[24:25], v88 offset:1024
v_mfma_f32_16x16x32_bf16 a[4:7], v[8:11], v[64:67], a[4:7]
ds_read_b64_tr_b16 v[26:27], v88 offset:9216
s_mov_b32 m0, s30
v_mfma_f32_16x16x32_bf16 a[8:11], v[8:11], v[68:71], a[8:11]
s_waitcnt vmcnt(4)
ds_read_b64_tr_b16 v[132:133], v167 offset:0
v_mfma_f32_16x16x32_bf16 a[12:15], v[8:11], v[72:75], a[12:15]
ds_read_b64_tr_b16 v[28:29], v88 offset:1032
buffer_load_dwordx4 v7, s[8:11], s24 offen offset:0 nt lds
v_mfma_f32_16x16x32_bf16 a[16:19], v[12:15], v[60:63], a[16:19]
ds_read_b64_tr_b16 v[30:31], v88 offset:9224
v_mfma_f32_16x16x32_bf16 a[20:23], v[12:15], v[64:67], a[20:23]
ds_read_b64_tr_b16 v[134:135], v167 offset:3584
v_mfma_f32_16x16x32_bf16 a[24:27], v[12:15], v[68:71], a[24:27]
v_mfma_f32_16x16x32_bf16 a[28:31], v[12:15], v[72:75], a[28:31]
s_waitcnt lgkmcnt(6)
v_mfma_f32_16x16x32_bf16 a[32:35], v[16:19], v[60:63], a[32:35]
ds_read_b64_tr_b16 v[32:33], v89 offset:1024
ds_read_b64_tr_b16 v[136:137], v167 offset:32
v_mfma_f32_16x16x32_bf16 a[36:39], v[16:19], v[64:67], a[36:39]
ds_read_b64_tr_b16 v[34:35], v89 offset:9216
v_mfma_f32_16x16x32_bf16 a[40:43], v[16:19], v[68:71], a[40:43]
v_mfma_f32_16x16x32_bf16 a[44:47], v[16:19], v[72:75], a[44:47]
ds_read_b64_tr_b16 v[36:37], v89 offset:1032
ds_read_b64_tr_b16 v[138:139], v167 offset:3616
v_mfma_f32_16x16x32_bf16 a[48:51], v[20:23], v[60:63], a[48:51]
ds_read_b64_tr_b16 v[38:39], v89 offset:9224
v_mfma_f32_16x16x32_bf16 a[52:55], v[20:23], v[64:67], a[52:55]
v_mfma_f32_16x16x32_bf16 a[56:59], v[20:23], v[68:71], a[56:59]
ds_read_b64_tr_b16 v[140:141], v167 offset:64
v_mfma_f32_16x16x32_bf16 a[60:63], v[20:23], v[72:75], a[60:63]
s_waitcnt lgkmcnt(8)
v_mfma_f32_16x16x32_bf16 a[64:67], v[24:27], v[60:63], a[64:67]
ds_read_b64_tr_b16 v[8:9], v88 offset:2048
v_mfma_f32_16x16x32_bf16 a[68:71], v[24:27], v[64:67], a[68:71]
ds_read_b64_tr_b16 v[10:11], v88 offset:10240
buffer_load_dwordx4 v7, s[8:11], s25 offen offset:1024 nt lds
v_mfma_f32_16x16x32_bf16 a[72:75], v[24:27], v[68:71], a[72:75]
ds_read_b64_tr_b16 v[142:143], v167 offset:3648
v_mfma_f32_16x16x32_bf16 a[76:79], v[24:27], v[72:75], a[76:79]
ds_read_b64_tr_b16 v[12:13], v88 offset:2056
v_mfma_f32_16x16x32_bf16 a[80:83], v[28:31], v[60:63], a[80:83]
ds_read_b64_tr_b16 v[14:15], v88 offset:10248
ds_read_b64_tr_b16 v[144:145], v167 offset:96
v_mfma_f32_16x16x32_bf16 a[84:87], v[28:31], v[64:67], a[84:87]
v_mfma_f32_16x16x32_bf16 a[88:91], v[28:31], v[68:71], a[88:91]
v_mfma_f32_16x16x32_bf16 a[92:95], v[28:31], v[72:75], a[92:95]
s_waitcnt lgkmcnt(7)
v_mfma_f32_16x16x32_bf16 a[96:99], v[32:35], v[60:63], a[96:99]
ds_read_b64_tr_b16 v[16:17], v89 offset:2048
ds_read_b64_tr_b16 v[146:147], v167 offset:3680
v_mfma_f32_16x16x32_bf16 a[100:103], v[32:35], v[64:67], a[100:103]
ds_read_b64_tr_b16 v[18:19], v89 offset:10240
v_mfma_f32_16x16x32_bf16 a[104:107], v[32:35], v[68:71], a[104:107]
v_mfma_f32_16x16x32_bf16 a[108:111], v[32:35], v[72:75], a[108:111]
ds_read_b64_tr_b16 v[20:21], v89 offset:2056
ds_read_b64_tr_b16 v[148:149], v167 offset:128
v_mfma_f32_16x16x32_bf16 a[112:115], v[36:39], v[60:63], a[112:115]
ds_read_b64_tr_b16 v[22:23], v89 offset:10248
v_mfma_f32_16x16x32_bf16 a[116:119], v[36:39], v[64:67], a[116:119]
v_mfma_f32_16x16x32_bf16 a[120:123], v[36:39], v[68:71], a[120:123]
ds_read_b64_tr_b16 v[150:151], v167 offset:3712
v_mfma_f32_16x16x32_bf16 a[124:127], v[36:39], v[72:75], a[124:127]
s_waitcnt lgkmcnt(5)
v_mfma_f32_16x16x32_bf16 a[128:131], v[8:11], v[60:63], a[128:131]
ds_read_b64_tr_b16 v[24:25], v88 offset:3072
buffer_load_dwordx4 v7, s[8:11], s26 offen offset:2048 nt lds
v_mfma_f32_16x16x32_bf16 a[132:135], v[8:11], v[64:67], a[132:135]
ds_read_b64_tr_b16 v[26:27], v88 offset:11264
ds_read_b64_tr_b16 v[152:153], v167 offset:160
v_mfma_f32_16x16x32_bf16 a[136:139], v[8:11], v[68:71], a[136:139]
v_mfma_f32_16x16x32_bf16 a[140:143], v[8:11], v[72:75], a[140:143]
ds_read_b64_tr_b16 v[28:29], v88 offset:3080
v_mfma_f32_16x16x32_bf16 a[144:147], v[12:15], v[60:63], a[144:147]
ds_read_b64_tr_b16 v[30:31], v88 offset:11272
ds_read_b64_tr_b16 v[154:155], v167 offset:3744
v_mfma_f32_16x16x32_bf16 a[148:151], v[12:15], v[64:67], a[148:151]
v_mfma_f32_16x16x32_bf16 a[152:155], v[12:15], v[68:71], a[152:155]
v_mfma_f32_16x16x32_bf16 a[156:159], v[12:15], v[72:75], a[156:159]
s_waitcnt lgkmcnt(7)
v_mfma_f32_16x16x32_bf16 a[160:163], v[16:19], v[60:63], a[160:163]
ds_read_b64_tr_b16 v[32:33], v89 offset:3072
ds_read_b64_tr_b16 v[156:157], v167 offset:192
v_mfma_f32_16x16x32_bf16 a[164:167], v[16:19], v[64:67], a[164:167]
ds_read_b64_tr_b16 v[34:35], v89 offset:11264
v_mfma_f32_16x16x32_bf16 a[168:171], v[16:19], v[68:71], a[168:171]
ds_read_b64_tr_b16 v[158:159], v167 offset:3776
v_mfma_f32_16x16x32_bf16 a[172:175], v[16:19], v[72:75], a[172:175]
ds_read_b64_tr_b16 v[36:37], v89 offset:3080
v_mfma_f32_16x16x32_bf16 a[176:179], v[20:23], v[60:63], a[176:179]
ds_read_b64_tr_b16 v[38:39], v89 offset:11272
v_mfma_f32_16x16x32_bf16 a[180:183], v[20:23], v[64:67], a[180:183]
v_mfma_f32_16x16x32_bf16 a[184:187], v[20:23], v[68:71], a[184:187]
buffer_load_dwordx4 v7, s[8:11], 0 offen offset:3072 nt lds
v_mfma_f32_16x16x32_bf16 a[188:191], v[20:23], v[72:75], a[188:191]
s_waitcnt lgkmcnt(7)
v_mfma_f32_16x16x32_bf16 a[192:195], v[24:27], v[60:63], a[192:195]
s_waitcnt lgkmcnt(2)
v_mfma_f32_16x16x32_bf16 a[196:199], v[24:27], v[64:67], a[196:199]
s_add_u32 s8, s8, 16384
s_addc_u32 s9, s9, 0
v_mfma_f32_16x16x32_bf16 a[200:203], v[24:27], v[68:71], a[200:203]
v_mfma_f32_16x16x32_bf16 a[204:207], v[24:27], v[72:75], a[204:207]
v_mfma_f32_16x16x32_bf16 a[208:211], v[28:31], v[60:63], a[208:211]
v_mfma_f32_16x16x32_bf16 a[212:215], v[28:31], v[64:67], a[212:215]
v_mfma_f32_16x16x32_bf16 a[216:219], v[28:31], v[68:71], a[216:219]
v_mfma_f32_16x16x32_bf16 a[220:223], v[28:31], v[72:75], a[220:223]
s_waitcnt lgkmcnt(0)
s_barrier
v_mfma_f32_16x16x32_bf16 a[224:227], v[32:35], v[60:63], a[224:227]
s_add_u32 m0, s29, s71
s_nop 0
v_mfma_f32_16x16x32_bf16 a[228:231], v[32:35], v[64:67], a[228:231]
buffer_load_dwordx4 v7, s[4:7], s24 offen offset:0 nt lds
buffer_load_dwordx4 v7, s[4:7], s25 offen offset:1024 nt lds
v_mfma_f32_16x16x32_bf16 a[232:235], v[32:35], v[68:71], a[232:235]
buffer_load_dwordx4 v7, s[4:7], s26 offen offset:2048 nt lds
buffer_load_dwordx4 v7, s[4:7], 0 offen offset:3072 nt lds
v_mfma_f32_16x16x32_bf16 a[236:239], v[32:35], v[72:75], a[236:239]
s_add_u32 s4, s4, 16384
s_addc_u32 s5, s5, 0
v_mfma_f32_16x16x32_bf16 a[240:243], v[36:39], v[60:63], a[240:243]
v_mfma_f32_16x16x32_bf16 a[244:247], v[36:39], v[64:67], a[244:247]
v_mfma_f32_16x16x32_bf16 a[248:251], v[36:39], v[68:71], a[248:251]
v_mfma_f32_16x16x32_bf16 a[252:255], v[36:39], v[72:75], a[252:255]
s_nop 7
v_mov_b32 v100, 0
v_mov_b32 v101, 0
v_mov_b32 v102, 0
v_mov_b32 v103, 0
v_mov_b32 v104, 0
v_mov_b32 v105, 0
v_mov_b32 v106, 0
v_mov_b32 v107, 0
v_mov_b32 v108, 0
v_mov_b32 v109, 0
v_mov_b32 v110, 0
v_mov_b32 v111, 0
v_mov_b32 v112, 0
v_mov_b32 v113, 0
v_mov_b32 v114, 0
v_mov_b32 v115, 0
v_mov_b32 v56, s39
v_mov_b32 v57, s39
v_accvgpr_read_b32 v40, a224
v_accvgpr_read_b32 v41, a225
v_accvgpr_read_b32 v42, a226
v_accvgpr_read_b32 v43, a227
v_accvgpr_read_b32 v44, a240
v_accvgpr_read_b32 v45, a241
v_accvgpr_read_b32 v46, a242
v_accvgpr_read_b32 v47, a243
buffer_store_dwordx4 v[132:135], v168, s[48:51], 0 offen offset:0 sc0 sc1
v_pk_mul_f32 v[40:41], v[40:41], v[56:57]
v_pk_mul_f32 v[42:43], v[42:43], v[56:57]
v_pk_mul_f32 v[44:45], v[44:45], v[56:57]
v_pk_mul_f32 v[46:47], v[46:47], v[56:57]
v_cvt_pk_bf16_f32 v240, v40, v41
v_cvt_pk_bf16_f32 v241, v42, v43
v_cvt_pk_bf16_f32 v242, v44, v45
v_cvt_pk_bf16_f32 v243, v46, v47
v_accvgpr_read_b32 v48, a228
v_accvgpr_read_b32 v49, a229
v_accvgpr_read_b32 v50, a230
v_accvgpr_read_b32 v51, a231
v_accvgpr_read_b32 v52, a244
v_accvgpr_read_b32 v53, a245
v_accvgpr_read_b32 v54, a246
v_accvgpr_read_b32 v55, a247
v_pk_mul_f32 v[48:49], v[48:49], v[56:57]
v_pk_mul_f32 v[50:51], v[50:51], v[56:57]
v_pk_mul_f32 v[52:53], v[52:53], v[56:57]
v_pk_mul_f32 v[54:55], v[54:55], v[56:57]
v_cvt_pk_bf16_f32 v244, v48, v49
v_cvt_pk_bf16_f32 v245, v50, v51
v_cvt_pk_bf16_f32 v246, v52, v53
v_cvt_pk_bf16_f32 v247, v54, v55
v_accvgpr_read_b32 v40, a232
v_accvgpr_read_b32 v41, a233
v_accvgpr_read_b32 v42, a234
v_accvgpr_read_b32 v43, a235
v_accvgpr_read_b32 v44, a248
v_accvgpr_read_b32 v45, a249
v_accvgpr_read_b32 v46, a250
v_accvgpr_read_b32 v47, a251
v_pk_mul_f32 v[40:41], v[40:41], v[56:57]
v_pk_mul_f32 v[42:43], v[42:43], v[56:57]
v_pk_mul_f32 v[44:45], v[44:45], v[56:57]
v_pk_mul_f32 v[46:47], v[46:47], v[56:57]
v_cvt_pk_bf16_f32 v248, v40, v41
v_cvt_pk_bf16_f32 v249, v42, v43
v_cvt_pk_bf16_f32 v250, v44, v45
v_cvt_pk_bf16_f32 v251, v46, v47
v_accvgpr_read_b32 v48, a236
v_accvgpr_read_b32 v49, a237
v_accvgpr_read_b32 v50, a238
v_accvgpr_read_b32 v51, a239
v_accvgpr_read_b32 v52, a252
v_accvgpr_read_b32 v53, a253
v_accvgpr_read_b32 v54, a254
v_accvgpr_read_b32 v55, a255
buffer_store_dwordx4 v[136:139], v168, s[48:51], 0 offen offset:1024 sc0 sc1
v_pk_mul_f32 v[48:49], v[48:49], v[56:57]
v_pk_mul_f32 v[50:51], v[50:51], v[56:57]
v_pk_mul_f32 v[52:53], v[52:53], v[56:57]
v_pk_mul_f32 v[54:55], v[54:55], v[56:57]
v_cvt_pk_bf16_f32 v252, v48, v49
v_cvt_pk_bf16_f32 v253, v50, v51
v_cvt_pk_bf16_f32 v254, v52, v53
v_cvt_pk_bf16_f32 v255, v54, v55
v_mfma_f32_32x32x16_bf16 a[224:239], v[100:103], v[100:103], 0
v_accvgpr_read_b32 v40, a192
v_accvgpr_read_b32 v41, a193
v_accvgpr_read_b32 v42, a194
v_accvgpr_read_b32 v43, a195
v_accvgpr_read_b32 v44, a208
v_accvgpr_read_b32 v45, a209
v_accvgpr_read_b32 v46, a210
v_accvgpr_read_b32 v47, a211
v_pk_mul_f32 v[40:41], v[40:41], v[56:57]
v_pk_mul_f32 v[42:43], v[42:43], v[56:57]
v_pk_mul_f32 v[44:45], v[44:45], v[56:57]
v_pk_mul_f32 v[46:47], v[46:47], v[56:57]
v_cvt_pk_bf16_f32 v224, v40, v41
v_cvt_pk_bf16_f32 v225, v42, v43
v_cvt_pk_bf16_f32 v226, v44, v45
v_cvt_pk_bf16_f32 v227, v46, v47
v_mfma_f32_32x32x16_bf16 a[240:255], v[100:103], v[100:103], 0
v_accvgpr_read_b32 v48, a196
v_accvgpr_read_b32 v49, a197
v_accvgpr_read_b32 v50, a198
v_accvgpr_read_b32 v51, a199
v_accvgpr_read_b32 v52, a212
v_accvgpr_read_b32 v53, a213
v_accvgpr_read_b32 v54, a214
v_accvgpr_read_b32 v55, a215
v_pk_mul_f32 v[48:49], v[48:49], v[56:57]
v_pk_mul_f32 v[50:51], v[50:51], v[56:57]
v_pk_mul_f32 v[52:53], v[52:53], v[56:57]
v_pk_mul_f32 v[54:55], v[54:55], v[56:57]
v_cvt_pk_bf16_f32 v228, v48, v49
v_cvt_pk_bf16_f32 v229, v50, v51
v_cvt_pk_bf16_f32 v230, v52, v53
v_cvt_pk_bf16_f32 v231, v54, v55
v_accvgpr_read_b32 v40, a200
v_accvgpr_read_b32 v41, a201
v_accvgpr_read_b32 v42, a202
v_accvgpr_read_b32 v43, a203
v_accvgpr_read_b32 v44, a216
v_accvgpr_read_b32 v45, a217
v_accvgpr_read_b32 v46, a218
v_accvgpr_read_b32 v47, a219
buffer_store_dwordx4 v[140:143], v168, s[48:51], 0 offen offset:2048 sc0 sc1
v_pk_mul_f32 v[40:41], v[40:41], v[56:57]
v_pk_mul_f32 v[42:43], v[42:43], v[56:57]
v_pk_mul_f32 v[44:45], v[44:45], v[56:57]
v_pk_mul_f32 v[46:47], v[46:47], v[56:57]
v_cvt_pk_bf16_f32 v232, v40, v41
v_cvt_pk_bf16_f32 v233, v42, v43
v_cvt_pk_bf16_f32 v234, v44, v45
v_cvt_pk_bf16_f32 v235, v46, v47
v_accvgpr_read_b32 v48, a204
v_accvgpr_read_b32 v49, a205
v_accvgpr_read_b32 v50, a206
v_accvgpr_read_b32 v51, a207
v_accvgpr_read_b32 v52, a220
v_accvgpr_read_b32 v53, a221
v_accvgpr_read_b32 v54, a222
v_accvgpr_read_b32 v55, a223
v_pk_mul_f32 v[48:49], v[48:49], v[56:57]
v_pk_mul_f32 v[50:51], v[50:51], v[56:57]
v_pk_mul_f32 v[52:53], v[52:53], v[56:57]
v_pk_mul_f32 v[54:55], v[54:55], v[56:57]
v_cvt_pk_bf16_f32 v236, v48, v49
v_cvt_pk_bf16_f32 v237, v50, v51
v_cvt_pk_bf16_f32 v238, v52, v53
v_cvt_pk_bf16_f32 v239, v54, v55
v_mfma_f32_32x32x16_bf16 a[192:207], v[100:103], v[100:103], 0
v_accvgpr_read_b32 v40, a160
v_accvgpr_read_b32 v41, a161
v_accvgpr_read_b32 v42, a162
v_accvgpr_read_b32 v43, a163
v_accvgpr_read_b32 v44, a176
v_accvgpr_read_b32 v45, a177
v_accvgpr_read_b32 v46, a178
v_accvgpr_read_b32 v47, a179
v_pk_mul_f32 v[40:41], v[40:41], v[56:57]
v_pk_mul_f32 v[42:43], v[42:43], v[56:57]
v_pk_mul_f32 v[44:45], v[44:45], v[56:57]
v_pk_mul_f32 v[46:47], v[46:47], v[56:57]
v_cvt_pk_bf16_f32 v208, v40, v41
v_cvt_pk_bf16_f32 v209, v42, v43
v_cvt_pk_bf16_f32 v210, v44, v45
v_cvt_pk_bf16_f32 v211, v46, v47
v_mfma_f32_32x32x16_bf16 a[208:223], v[100:103], v[100:103], 0
v_accvgpr_read_b32 v48, a164
v_accvgpr_read_b32 v49, a165
v_accvgpr_read_b32 v50, a166
v_accvgpr_read_b32 v51, a167
v_accvgpr_read_b32 v52, a180
v_accvgpr_read_b32 v53, a181
v_accvgpr_read_b32 v54, a182
v_accvgpr_read_b32 v55, a183
buffer_store_dwordx4 v[144:147], v168, s[48:51], 0 offen offset:3072 sc0 sc1
v_pk_mul_f32 v[48:49], v[48:49], v[56:57]
v_pk_mul_f32 v[50:51], v[50:51], v[56:57]
v_pk_mul_f32 v[52:53], v[52:53], v[56:57]
v_pk_mul_f32 v[54:55], v[54:55], v[56:57]
v_cvt_pk_bf16_f32 v212, v48, v49
v_cvt_pk_bf16_f32 v213, v50, v51
v_cvt_pk_bf16_f32 v214, v52, v53
v_cvt_pk_bf16_f32 v215, v54, v55
v_accvgpr_read_b32 v40, a168
v_accvgpr_read_b32 v41, a169
v_accvgpr_read_b32 v42, a170
v_accvgpr_read_b32 v43, a171
v_accvgpr_read_b32 v44, a184
v_accvgpr_read_b32 v45, a185
v_accvgpr_read_b32 v46, a186
v_accvgpr_read_b32 v47, a187
v_pk_mul_f32 v[40:41], v[40:41], v[56:57]
v_pk_mul_f32 v[42:43], v[42:43], v[56:57]
v_pk_mul_f32 v[44:45], v[44:45], v[56:57]
v_pk_mul_f32 v[46:47], v[46:47], v[56:57]
v_cvt_pk_bf16_f32 v216, v40, v41
v_cvt_pk_bf16_f32 v217, v42, v43
v_cvt_pk_bf16_f32 v218, v44, v45
v_cvt_pk_bf16_f32 v219, v46, v47
v_accvgpr_read_b32 v48, a172
v_accvgpr_read_b32 v49, a173
v_accvgpr_read_b32 v50, a174
v_accvgpr_read_b32 v51, a175
v_accvgpr_read_b32 v52, a188
v_accvgpr_read_b32 v53, a189
v_accvgpr_read_b32 v54, a190
v_accvgpr_read_b32 v55, a191
v_pk_mul_f32 v[48:49], v[48:49], v[56:57]
v_pk_mul_f32 v[50:51], v[50:51], v[56:57]
v_pk_mul_f32 v[52:53], v[52:53], v[56:57]
v_pk_mul_f32 v[54:55], v[54:55], v[56:57]
v_cvt_pk_bf16_f32 v220, v48, v49
v_cvt_pk_bf16_f32 v221, v50, v51
v_cvt_pk_bf16_f32 v222, v52, v53
v_cvt_pk_bf16_f32 v223, v54, v55
v_mfma_f32_32x32x16_bf16 a[160:175], v[100:103], v[100:103], 0
v_accvgpr_read_b32 v40, a128
v_accvgpr_read_b32 v41, a129
v_accvgpr_read_b32 v42, a130
v_accvgpr_read_b32 v43, a131
v_accvgpr_read_b32 v44, a144
v_accvgpr_read_b32 v45, a145
v_accvgpr_read_b32 v46, a146
v_accvgpr_read_b32 v47, a147
buffer_store_dwordx4 v[148:151], v168, s[48:51], s73 offen offset:0 sc0 sc1
v_pk_mul_f32 v[40:41], v[40:41], v[56:57]
v_pk_mul_f32 v[42:43], v[42:43], v[56:57]
v_pk_mul_f32 v[44:45], v[44:45], v[56:57]
v_pk_mul_f32 v[46:47], v[46:47], v[56:57]
v_cvt_pk_bf16_f32 v192, v40, v41
v_cvt_pk_bf16_f32 v193, v42, v43
v_cvt_pk_bf16_f32 v194, v44, v45
v_cvt_pk_bf16_f32 v195, v46, v47
v_mfma_f32_32x32x16_bf16 a[176:191], v[100:103], v[100:103], 0
v_accvgpr_read_b32 v48, a132
v_accvgpr_read_b32 v49, a133
v_accvgpr_read_b32 v50, a134
v_accvgpr_read_b32 v51, a135
v_accvgpr_read_b32 v52, a148
v_accvgpr_read_b32 v53, a149
v_accvgpr_read_b32 v54, a150
v_accvgpr_read_b32 v55, a151
v_pk_mul_f32 v[48:49], v[48:49], v[56:57]
v_pk_mul_f32 v[50:51], v[50:51], v[56:57]
v_pk_mul_f32 v[52:53], v[52:53], v[56:57]
v_pk_mul_f32 v[54:55], v[54:55], v[56:57]
v_cvt_pk_bf16_f32 v196, v48, v49
v_cvt_pk_bf16_f32 v197, v50, v51
v_cvt_pk_bf16_f32 v198, v52, v53
v_cvt_pk_bf16_f32 v199, v54, v55
v_accvgpr_read_b32 v40, a136
v_accvgpr_read_b32 v41, a137
v_accvgpr_read_b32 v42, a138
v_accvgpr_read_b32 v43, a139
v_accvgpr_read_b32 v44, a152
v_accvgpr_read_b32 v45, a153
v_accvgpr_read_b32 v46, a154
v_accvgpr_read_b32 v47, a155
v_pk_mul_f32 v[40:41], v[40:41], v[56:57]
v_pk_mul_f32 v[42:43], v[42:43], v[56:57]
v_pk_mul_f32 v[44:45], v[44:45], v[56:57]
v_pk_mul_f32 v[46:47], v[46:47], v[56:57]
v_cvt_pk_bf16_f32 v200, v40, v41
v_cvt_pk_bf16_f32 v201, v42, v43
v_cvt_pk_bf16_f32 v202, v44, v45
v_cvt_pk_bf16_f32 v203, v46, v47
v_accvgpr_read_b32 v48, a140
v_accvgpr_read_b32 v49, a141
v_accvgpr_read_b32 v50, a142
v_accvgpr_read_b32 v51, a143
v_accvgpr_read_b32 v52, a156
v_accvgpr_read_b32 v53, a157
v_accvgpr_read_b32 v54, a158
v_accvgpr_read_b32 v55, a159
buffer_store_dwordx4 v[152:155], v168, s[48:51], s73 offen offset:1024 sc0 sc1
v_pk_mul_f32 v[48:49], v[48:49], v[56:57]
v_pk_mul_f32 v[50:51], v[50:51], v[56:57]
v_pk_mul_f32 v[52:53], v[52:53], v[56:57]
v_pk_mul_f32 v[54:55], v[54:55], v[56:57]
v_cvt_pk_bf16_f32 v204, v48, v49
v_cvt_pk_bf16_f32 v205, v50, v51
v_cvt_pk_bf16_f32 v206, v52, v53
v_cvt_pk_bf16_f32 v207, v54, v55
v_mfma_f32_32x32x16_bf16 a[128:143], v[100:103], v[100:103], 0
v_accvgpr_read_b32 v40, a96
v_accvgpr_read_b32 v41, a97
v_accvgpr_read_b32 v42, a98
v_accvgpr_read_b32 v43, a99
v_accvgpr_read_b32 v44, a112
v_accvgpr_read_b32 v45, a113
v_accvgpr_read_b32 v46, a114
v_accvgpr_read_b32 v47, a115
v_pk_mul_f32 v[40:41], v[40:41], v[56:57]
v_pk_mul_f32 v[42:43], v[42:43], v[56:57]
v_pk_mul_f32 v[44:45], v[44:45], v[56:57]
v_pk_mul_f32 v[46:47], v[46:47], v[56:57]
v_cvt_pk_bf16_f32 v176, v40, v41
v_cvt_pk_bf16_f32 v177, v42, v43
v_cvt_pk_bf16_f32 v178, v44, v45
v_cvt_pk_bf16_f32 v179, v46, v47
v_mfma_f32_32x32x16_bf16 a[144:159], v[100:103], v[100:103], 0
v_accvgpr_read_b32 v48, a100
v_accvgpr_read_b32 v49, a101
v_accvgpr_read_b32 v50, a102
v_accvgpr_read_b32 v51, a103
v_accvgpr_read_b32 v52, a116
v_accvgpr_read_b32 v53, a117
v_accvgpr_read_b32 v54, a118
v_accvgpr_read_b32 v55, a119
v_pk_mul_f32 v[48:49], v[48:49], v[56:57]
v_pk_mul_f32 v[50:51], v[50:51], v[56:57]
v_pk_mul_f32 v[52:53], v[52:53], v[56:57]
v_pk_mul_f32 v[54:55], v[54:55], v[56:57]
v_cvt_pk_bf16_f32 v180, v48, v49
v_cvt_pk_bf16_f32 v181, v50, v51
v_cvt_pk_bf16_f32 v182, v52, v53
v_cvt_pk_bf16_f32 v183, v54, v55
v_accvgpr_read_b32 v40, a104
v_accvgpr_read_b32 v41, a105
v_accvgpr_read_b32 v42, a106
v_accvgpr_read_b32 v43, a107
v_accvgpr_read_b32 v44, a120
v_accvgpr_read_b32 v45, a121
v_accvgpr_read_b32 v46, a122
v_accvgpr_read_b32 v47, a123
buffer_store_dwordx4 v[156:159], v168, s[48:51], s73 offen offset:2048 sc0 sc1
v_pk_mul_f32 v[40:41], v[40:41], v[56:57]
v_pk_mul_f32 v[42:43], v[42:43], v[56:57]
v_pk_mul_f32 v[44:45], v[44:45], v[56:57]
v_pk_mul_f32 v[46:47], v[46:47], v[56:57]
v_cvt_pk_bf16_f32 v184, v40, v41
v_cvt_pk_bf16_f32 v185, v42, v43
v_cvt_pk_bf16_f32 v186, v44, v45
v_cvt_pk_bf16_f32 v187, v46, v47
v_accvgpr_read_b32 v48, a108
v_accvgpr_read_b32 v49, a109
v_accvgpr_read_b32 v50, a110
v_accvgpr_read_b32 v51, a111
v_accvgpr_read_b32 v52, a124
v_accvgpr_read_b32 v53, a125
v_accvgpr_read_b32 v54, a126
v_accvgpr_read_b32 v55, a127
v_pk_mul_f32 v[48:49], v[48:49], v[56:57]
v_pk_mul_f32 v[50:51], v[50:51], v[56:57]
v_pk_mul_f32 v[52:53], v[52:53], v[56:57]
v_pk_mul_f32 v[54:55], v[54:55], v[56:57]
v_cvt_pk_bf16_f32 v188, v48, v49
v_cvt_pk_bf16_f32 v189, v50, v51
v_cvt_pk_bf16_f32 v190, v52, v53
v_cvt_pk_bf16_f32 v191, v54, v55
v_mfma_f32_32x32x16_bf16 a[96:111], v[100:103], v[100:103], 0
v_accvgpr_read_b32 v40, a64
v_accvgpr_read_b32 v41, a65
v_accvgpr_read_b32 v42, a66
v_accvgpr_read_b32 v43, a67
v_accvgpr_read_b32 v44, a80
v_accvgpr_read_b32 v45, a81
v_accvgpr_read_b32 v46, a82
v_accvgpr_read_b32 v47, a83
v_pk_mul_f32 v[40:41], v[40:41], v[56:57]
v_pk_mul_f32 v[42:43], v[42:43], v[56:57]
v_pk_mul_f32 v[44:45], v[44:45], v[56:57]
v_pk_mul_f32 v[46:47], v[46:47], v[56:57]
v_cvt_pk_bf16_f32 v160, v40, v41
v_cvt_pk_bf16_f32 v161, v42, v43
v_cvt_pk_bf16_f32 v162, v44, v45
v_cvt_pk_bf16_f32 v163, v46, v47
v_mfma_f32_32x32x16_bf16 a[112:127], v[100:103], v[100:103], 0
v_accvgpr_read_b32 v48, a68
v_accvgpr_read_b32 v49, a69
v_accvgpr_read_b32 v50, a70
v_accvgpr_read_b32 v51, a71
v_accvgpr_read_b32 v52, a84
v_accvgpr_read_b32 v53, a85
v_accvgpr_read_b32 v54, a86
v_accvgpr_read_b32 v55, a87
v_pk_mul_f32 v[48:49], v[48:49], v[56:57]
v_pk_mul_f32 v[50:51], v[50:51], v[56:57]
v_pk_mul_f32 v[52:53], v[52:53], v[56:57]
v_pk_mul_f32 v[54:55], v[54:55], v[56:57]
v_cvt_pk_bf16_f32 v164, v48, v49
v_cvt_pk_bf16_f32 v165, v50, v51
v_cvt_pk_bf16_f32 v166, v52, v53
v_cvt_pk_bf16_f32 v167, v54, v55
v_accvgpr_read_b32 v40, a72
v_accvgpr_read_b32 v41, a73
v_accvgpr_read_b32 v42, a74
v_accvgpr_read_b32 v43, a75
v_accvgpr_read_b32 v44, a88
v_accvgpr_read_b32 v45, a89
v_accvgpr_read_b32 v46, a90
v_accvgpr_read_b32 v47, a91
v_pk_mul_f32 v[40:41], v[40:41], v[56:57]
v_pk_mul_f32 v[42:43], v[42:43], v[56:57]
v_pk_mul_f32 v[44:45], v[44:45], v[56:57]
v_pk_mul_f32 v[46:47], v[46:47], v[56:57]
v_cvt_pk_bf16_f32 v168, v40, v41
v_cvt_pk_bf16_f32 v169, v42, v43
v_cvt_pk_bf16_f32 v170, v44, v45
v_cvt_pk_bf16_f32 v171, v46, v47
v_accvgpr_read_b32 v48, a76
v_accvgpr_read_b32 v49, a77
v_accvgpr_read_b32 v50, a78
v_accvgpr_read_b32 v51, a79
v_accvgpr_read_b32 v52, a92
v_accvgpr_read_b32 v53, a93
v_accvgpr_read_b32 v54, a94
v_accvgpr_read_b32 v55, a95
v_pk_mul_f32 v[48:49], v[48:49], v[56:57]
v_pk_mul_f32 v[50:51], v[50:51], v[56:57]
v_pk_mul_f32 v[52:53], v[52:53], v[56:57]
v_pk_mul_f32 v[54:55], v[54:55], v[56:57]
v_cvt_pk_bf16_f32 v172, v48, v49
v_cvt_pk_bf16_f32 v173, v50, v51
v_cvt_pk_bf16_f32 v174, v52, v53
v_cvt_pk_bf16_f32 v175, v54, v55
v_mfma_f32_32x32x16_bf16 a[64:79], v[100:103], v[100:103], 0
v_accvgpr_read_b32 v40, a32
v_accvgpr_read_b32 v41, a33
v_accvgpr_read_b32 v42, a34
v_accvgpr_read_b32 v43, a35
v_accvgpr_read_b32 v44, a48
v_accvgpr_read_b32 v45, a49
v_accvgpr_read_b32 v46, a50
v_accvgpr_read_b32 v47, a51
v_pk_mul_f32 v[40:41], v[40:41], v[56:57]
v_pk_mul_f32 v[42:43], v[42:43], v[56:57]
v_pk_mul_f32 v[44:45], v[44:45], v[56:57]
v_pk_mul_f32 v[46:47], v[46:47], v[56:57]
v_cvt_pk_bf16_f32 v144, v40, v41
v_cvt_pk_bf16_f32 v145, v42, v43
v_cvt_pk_bf16_f32 v146, v44, v45
v_cvt_pk_bf16_f32 v147, v46, v47
v_mfma_f32_32x32x16_bf16 a[80:95], v[100:103], v[100:103], 0
v_accvgpr_read_b32 v48, a36
v_accvgpr_read_b32 v49, a37
v_accvgpr_read_b32 v50, a38
v_accvgpr_read_b32 v51, a39
v_accvgpr_read_b32 v52, a52
v_accvgpr_read_b32 v53, a53
v_accvgpr_read_b32 v54, a54
v_accvgpr_read_b32 v55, a55
v_pk_mul_f32 v[48:49], v[48:49], v[56:57]
v_pk_mul_f32 v[50:51], v[50:51], v[56:57]
v_pk_mul_f32 v[52:53], v[52:53], v[56:57]
v_pk_mul_f32 v[54:55], v[54:55], v[56:57]
v_cvt_pk_bf16_f32 v148, v48, v49
v_cvt_pk_bf16_f32 v149, v50, v51
v_cvt_pk_bf16_f32 v150, v52, v53
v_cvt_pk_bf16_f32 v151, v54, v55
v_accvgpr_read_b32 v40, a40
v_accvgpr_read_b32 v41, a41
v_accvgpr_read_b32 v42, a42
v_accvgpr_read_b32 v43, a43
v_accvgpr_read_b32 v44, a56
v_accvgpr_read_b32 v45, a57
v_accvgpr_read_b32 v46, a58
v_accvgpr_read_b32 v47, a59
v_pk_mul_f32 v[40:41], v[40:41], v[56:57]
v_pk_mul_f32 v[42:43], v[42:43], v[56:57]
v_pk_mul_f32 v[44:45], v[44:45], v[56:57]
v_pk_mul_f32 v[46:47], v[46:47], v[56:57]
v_cvt_pk_bf16_f32 v152, v40, v41
v_cvt_pk_bf16_f32 v153, v42, v43
v_cvt_pk_bf16_f32 v154, v44, v45
v_cvt_pk_bf16_f32 v155, v46, v47
v_accvgpr_read_b32 v48, a44
v_accvgpr_read_b32 v49, a45
v_accvgpr_read_b32 v50, a46
v_accvgpr_read_b32 v51, a47
v_accvgpr_read_b32 v52, a60
v_accvgpr_read_b32 v53, a61
v_accvgpr_read_b32 v54, a62
v_accvgpr_read_b32 v55, a63
v_pk_mul_f32 v[48:49], v[48:49], v[56:57]
v_pk_mul_f32 v[50:51], v[50:51], v[56:57]
v_pk_mul_f32 v[52:53], v[52:53], v[56:57]
v_pk_mul_f32 v[54:55], v[54:55], v[56:57]
v_cvt_pk_bf16_f32 v156, v48, v49
v_cvt_pk_bf16_f32 v157, v50, v51
v_cvt_pk_bf16_f32 v158, v52, v53
v_cvt_pk_bf16_f32 v159, v54, v55
v_mfma_f32_32x32x16_bf16 a[32:47], v[100:103], v[100:103], 0
v_accvgpr_read_b32 v40, a0
v_accvgpr_read_b32 v41, a1
v_accvgpr_read_b32 v42, a2
v_accvgpr_read_b32 v43, a3
v_accvgpr_read_b32 v44, a16
v_accvgpr_read_b32 v45, a17
v_accvgpr_read_b32 v46, a18
v_accvgpr_read_b32 v47, a19
v_pk_mul_f32 v[40:41], v[40:41], v[56:57]
v_pk_mul_f32 v[42:43], v[42:43], v[56:57]
v_pk_mul_f32 v[44:45], v[44:45], v[56:57]
v_pk_mul_f32 v[46:47], v[46:47], v[56:57]
v_cvt_pk_bf16_f32 v128, v40, v41
v_cvt_pk_bf16_f32 v129, v42, v43
v_cvt_pk_bf16_f32 v130, v44, v45
v_cvt_pk_bf16_f32 v131, v46, v47
v_mfma_f32_32x32x16_bf16 a[48:63], v[100:103], v[100:103], 0
v_accvgpr_read_b32 v48, a4
v_accvgpr_read_b32 v49, a5
v_accvgpr_read_b32 v50, a6
v_accvgpr_read_b32 v51, a7
v_accvgpr_read_b32 v52, a20
v_accvgpr_read_b32 v53, a21
v_accvgpr_read_b32 v54, a22
v_accvgpr_read_b32 v55, a23
v_pk_mul_f32 v[48:49], v[48:49], v[56:57]
v_pk_mul_f32 v[50:51], v[50:51], v[56:57]
v_pk_mul_f32 v[52:53], v[52:53], v[56:57]
v_pk_mul_f32 v[54:55], v[54:55], v[56:57]
v_cvt_pk_bf16_f32 v132, v48, v49
v_cvt_pk_bf16_f32 v133, v50, v51
v_cvt_pk_bf16_f32 v134, v52, v53
v_cvt_pk_bf16_f32 v135, v54, v55
v_accvgpr_read_b32 v40, a8
v_accvgpr_read_b32 v41, a9
v_accvgpr_read_b32 v42, a10
v_accvgpr_read_b32 v43, a11
v_accvgpr_read_b32 v44, a24
v_accvgpr_read_b32 v45, a25
v_accvgpr_read_b32 v46, a26
v_accvgpr_read_b32 v47, a27
v_pk_mul_f32 v[40:41], v[40:41], v[56:57]
v_pk_mul_f32 v[42:43], v[42:43], v[56:57]
v_pk_mul_f32 v[44:45], v[44:45], v[56:57]
v_pk_mul_f32 v[46:47], v[46:47], v[56:57]
v_cvt_pk_bf16_f32 v136, v40, v41
v_cvt_pk_bf16_f32 v137, v42, v43
v_cvt_pk_bf16_f32 v138, v44, v45
v_cvt_pk_bf16_f32 v139, v46, v47
v_accvgpr_read_b32 v48, a12
v_accvgpr_read_b32 v49, a13
v_accvgpr_read_b32 v50, a14
v_accvgpr_read_b32 v51, a15
v_accvgpr_read_b32 v52, a28
v_accvgpr_read_b32 v53, a29
v_accvgpr_read_b32 v54, a30
v_accvgpr_read_b32 v55, a31
v_pk_mul_f32 v[48:49], v[48:49], v[56:57]
v_pk_mul_f32 v[50:51], v[50:51], v[56:57]
v_pk_mul_f32 v[52:53], v[52:53], v[56:57]
v_pk_mul_f32 v[54:55], v[54:55], v[56:57]
v_cvt_pk_bf16_f32 v140, v48, v49
v_cvt_pk_bf16_f32 v141, v50, v51
v_cvt_pk_bf16_f32 v142, v52, v53
v_cvt_pk_bf16_f32 v143, v54, v55
v_mfma_f32_32x32x16_bf16 a[0:15], v[100:103], v[100:103], 0
v_mfma_f32_32x32x16_bf16 a[16:31], v[100:103], v[100:103], 0
s_waitcnt vmcnt(0) lgkmcnt(0)
s_barrier
s_cmp_lg_u32 s27, 0
s_cbranch_scc1 L_arr_r4
v_mov_b32 v90, 0
v_mov_b32 v91, 1
s_mov_b64 exec, 1
global_atomic_add v90, v91, s[78:79]
s_mov_b64 exec, -1
L_arr_r4:
ds_read_b128 v[8:11], v0 offset:0
ds_read_b128 v[12:15], v0 offset:8192
ds_read_b128 v[16:19], v1 offset:0
ds_read_b128 v[20:23], v1 offset:8192
s_waitcnt lgkmcnt(2)
v_mfma_f32_16x16x32_bf16 v[40:43], v[8:11], v[128:131], v[100:103]
s_nop 0
v_mfma_f32_16x16x32_bf16 v[44:47], v[12:15], v[128:131], v[100:103]
v_mfma_f32_16x16x32_bf16 v[48:51], v[8:11], v[132:135], v[104:107]
v_mfma_f32_16x16x32_bf16 v[52:55], v[12:15], v[132:135], v[104:107]
v_mfma_f32_16x16x32_bf16 v[56:59], v[8:11], v[136:139], v[108:111]
v_mfma_f32_16x16x32_bf16 v[60:63], v[12:15], v[136:139], v[108:111]
v_mfma_f32_16x16x32_bf16 v[64:67], v[8:11], v[140:143], v[112:115]
v_mfma_f32_16x16x32_bf16 v[68:71], v[12:15], v[140:143], v[112:115]
s_waitcnt lgkmcnt(0)
v_mfma_f32_16x16x32_bf16 v[40:43], v[16:19], v[144:147], v[40:43]
s_add_u32 m0, s35, s71
v_mfma_f32_16x16x32_bf16 v[44:47], v[20:23], v[144:147], v[44:47]
ds_read_b128 v[8:11], v0 offset:1024
v_mfma_f32_16x16x32_bf16 v[48:51], v[16:19], v[148:151], v[48:51]
buffer_load_dwordx4 v7, s[4:7], s24 offen offset:0 nt lds
v_mfma_f32_16x16x32_bf16 v[52:55], v[20:23], v[148:151], v[52:55]
ds_read_b128 v[12:15], v0 offset:9216
v_mfma_f32_16x16x32_bf16 v[56:59], v[16:19], v[152:155], v[56:59]
v_mfma_f32_16x16x32_bf16 v[60:63], v[20:23], v[152:155], v[60:63]
v_mfma_f32_16x16x32_bf16 v[64:67], v[16:19], v[156:159], v[64:67]
v_mfma_f32_16x16x32_bf16 v[68:71], v[20:23], v[156:159], v[68:71]
s_waitcnt lgkmcnt(0)
v_mfma_f32_16x16x32_bf16 v[40:43], v[8:11], v[160:163], v[40:43]
v_mfma_f32_16x16x32_bf16 v[44:47], v[12:15], v[160:163], v[44:47]
ds_read_b128 v[16:19], v1 offset:1024
v_mfma_f32_16x16x32_bf16 v[48:51], v[8:11], v[164:167], v[48:51]
v_mfma_f32_16x16x32_bf16 v[52:55], v[12:15], v[164:167], v[52:55]
ds_read_b128 v[20:23], v1 offset:9216
v_mfma_f32_16x16x32_bf16 v[56:59], v[8:11], v[168:171], v[56:59]
v_mfma_f32_16x16x32_bf16 v[60:63], v[12:15], v[168:171], v[60:63]
v_mfma_f32_16x16x32_bf16 v[64:67], v[8:11], v[172:175], v[64:67]
v_mfma_f32_16x16x32_bf16 v[68:71], v[12:15], v[172:175], v[68:71]
s_waitcnt lgkmcnt(0)
v_mfma_f32_16x16x32_bf16 v[40:43], v[16:19], v[176:179], v[40:43]
buffer_load_dwordx4 v7, s[4:7], s25 offen offset:1024 nt lds
v_mfma_f32_16x16x32_bf16 v[44:47], v[20:23], v[176:179], v[44:47]
ds_read_b128 v[8:11], v0 offset:2048
v_mfma_f32_16x16x32_bf16 v[48:51], v[16:19], v[180:183], v[48:51]
v_mfma_f32_16x16x32_bf16 v[52:55], v[20:23], v[180:183], v[52:55]
ds_read_b128 v[12:15], v0 offset:10240
v_mfma_f32_16x16x32_bf16 v[56:59], v[16:19], v[184:187], v[56:59]
v_mfma_f32_16x16x32_bf16 v[60:63], v[20:23], v[184:187], v[60:63]
v_mfma_f32_16x16x32_bf16 v[64:67], v[16:19], v[188:191], v[64:67]
v_mfma_f32_16x16x32_bf16 v[68:71], v[20:23], v[188:191], v[68:71]
s_waitcnt lgkmcnt(0)
v_mfma_f32_16x16x32_bf16 v[40:43], v[8:11], v[192:195], v[40:43]
v_mfma_f32_16x16x32_bf16 v[44:47], v[12:15], v[192:195], v[44:47]
ds_read_b128 v[16:19], v1 offset:2048
v_mfma_f32_16x16x32_bf16 v[48:51], v[8:11], v[196:199], v[48:51]
v_mfma_f32_16x16x32_bf16 v[52:55], v[12:15], v[196:199], v[52:55]
ds_read_b128 v[20:23], v1 offset:10240
v_mfma_f32_16x16x32_bf16 v[56:59], v[8:11], v[200:203], v[56:59]
v_mfma_f32_16x16x32_bf16 v[60:63], v[12:15], v[200:203], v[60:63]
v_mfma_f32_16x16x32_bf16 v[64:67], v[8:11], v[204:207], v[64:67]
buffer_load_dwordx4 v7, s[4:7], s26 offen offset:2048 nt lds
v_mfma_f32_16x16x32_bf16 v[68:71], v[12:15], v[204:207], v[68:71]
s_waitcnt lgkmcnt(0)
v_mfma_f32_16x16x32_bf16 v[40:43], v[16:19], v[208:211], v[40:43]
v_mfma_f32_16x16x32_bf16 v[44:47], v[20:23], v[208:211], v[44:47]
ds_read_b128 v[8:11], v0 offset:3072
v_mfma_f32_16x16x32_bf16 v[48:51], v[16:19], v[212:215], v[48:51]
v_mfma_f32_16x16x32_bf16 v[52:55], v[20:23], v[212:215], v[52:55]
ds_read_b128 v[12:15], v0 offset:11264
v_mfma_f32_16x16x32_bf16 v[56:59], v[16:19], v[216:219], v[56:59]
v_mfma_f32_16x16x32_bf16 v[60:63], v[20:23], v[216:219], v[60:63]
v_mfma_f32_16x16x32_bf16 v[64:67], v[16:19], v[220:223], v[64:67]
v_mfma_f32_16x16x32_bf16 v[68:71], v[20:23], v[220:223], v[68:71]
s_waitcnt lgkmcnt(0)
v_mfma_f32_16x16x32_bf16 v[40:43], v[8:11], v[224:227], v[40:43]
v_mfma_f32_16x16x32_bf16 v[44:47], v[12:15], v[224:227], v[44:47]
ds_read_b128 v[16:19], v1 offset:3072
v_mfma_f32_16x16x32_bf16 v[48:51], v[8:11], v[228:231], v[48:51]
v_mfma_f32_16x16x32_bf16 v[52:55], v[12:15], v[228:231], v[52:55]
ds_read_b128 v[20:23], v1 offset:11264
s_sub_u32 s69, s29, s28
v_mfma_f32_16x16x32_bf16 v[56:59], v[8:11], v[232:235], v[56:59]
buffer_load_dwordx4 v7, s[4:7], 0 offen offset:3072 nt lds
v_add_u32 v0, s69, v0
v_mfma_f32_16x16x32_bf16 v[60:63], v[12:15], v[232:235], v[60:63]
s_add_u32 s4, s4, 16384
s_addc_u32 s5, s5, 0
v_mfma_f32_16x16x32_bf16 v[64:67], v[8:11], v[236:239], v[64:67]
v_add_u32 v1, s69, v1
s_mov_b32 s65, s28
v_mfma_f32_16x16x32_bf16 v[68:71], v[12:15], v[236:239], v[68:71]
s_waitcnt vmcnt(8) lgkmcnt(0)
s_barrier
v_mfma_f32_16x16x32_bf16 v[40:43], v[16:19], v[240:243], v[40:43]
s_mov_b32 s28, s29
s_mov_b32 s29, s35
v_mfma_f32_16x16x32_bf16 v[44:47], v[20:23], v[240:243], v[44:47]
s_mov_b32 s35, s65
v_mfma_f32_16x16x32_bf16 v[48:51], v[16:19], v[244:247], v[48:51]
v_mfma_f32_16x16x32_bf16 v[52:55], v[20:23], v[244:247], v[52:55]
v_mfma_f32_16x16x32_bf16 v[56:59], v[16:19], v[248:251], v[56:59]
v_mfma_f32_16x16x32_bf16 v[60:63], v[20:23], v[248:251], v[60:63]
v_mfma_f32_16x16x32_bf16 v[64:67], v[16:19], v[252:255], v[64:67]
v_mfma_f32_16x16x32_bf16 v[68:71], v[20:23], v[252:255], v[68:71]
ds_read_b128 v[8:11], v0 offset:0
ds_read_b128 v[12:15], v0 offset:8192
ds_read_b128 v[16:19], v1 offset:0
ds_read_b128 v[20:23], v1 offset:8192
s_nop 7
v_max3_f32 v84, v40, v41, v42
v_max3_f32 v84, v84, v43, v44
v_max3_f32 v84, v84, v45, v46
v_max_f32 v84, v84, v47
v_max3_f32 v85, v48, v49, v50
v_max3_f32 v85, v85, v51, v52
v_max3_f32 v85, v85, v53, v54
v_max_f32 v85, v85, v55
v_max3_f32 v86, v56, v57, v58
v_max3_f32 v86, v86, v59, v60
v_max3_f32 v86, v86, v61, v62
v_max_f32 v86, v86, v63
v_max3_f32 v87, v64, v65, v66
v_max3_f32 v87, v87, v67, v68
v_max3_f32 v87, v87, v69, v70
v_max_f32 v87, v87, v71
v_mbcnt_lo_u32_b32 v116, -1, 0
v_mbcnt_hi_u32_b32 v116, -1, v116
v_xor_b32 v117, 32, v116
v_xor_b32 v116, 16, v116
v_lshlrev_b32 v117, 2, v117
v_lshlrev_b32 v116, 2, v116
ds_bpermute_b32 v90, v116, v84
ds_bpermute_b32 v91, v116, v85
ds_bpermute_b32 v92, v116, v86
ds_bpermute_b32 v93, v116, v87
s_waitcnt lgkmcnt(0)
v_max_f32 v84, v84, v90
v_max_f32 v85, v85, v91
v_max_f32 v86, v86, v92
v_max_f32 v87, v87, v93
ds_bpermute_b32 v90, v117, v84
ds_bpermute_b32 v91, v117, v85
ds_bpermute_b32 v92, v117, v86
ds_bpermute_b32 v93, v117, v87
s_waitcnt lgkmcnt(0)
v_max_f32 v84, v84, v90
v_max_f32 v85, v85, v91
v_max_f32 v86, v86, v92
v_max_f32 v87, v87, v93
v_sub_f32 v100, 0, v84
v_sub_f32 v101, 0, v84
v_sub_f32 v102, 0, v84
v_sub_f32 v103, 0, v84
v_sub_f32 v104, 0, v85
v_sub_f32 v105, 0, v85
v_sub_f32 v106, 0, v85
v_sub_f32 v107, 0, v85
v_sub_f32 v108, 0, v86
v_sub_f32 v109, 0, v86
v_sub_f32 v110, 0, v86
v_sub_f32 v111, 0, v86
v_sub_f32 v112, 0, v87
v_sub_f32 v113, 0, v87
v_sub_f32 v114, 0, v87
v_sub_f32 v115, 0, v87
v_sub_f32 v40, v40, v84
v_sub_f32 v41, v41, v84
v_sub_f32 v42, v42, v84
v_sub_f32 v43, v43, v84
v_sub_f32 v44, v44, v84
v_sub_f32 v45, v45, v84
v_sub_f32 v46, v46, v84
v_sub_f32 v47, v47, v84
v_sub_f32 v48, v48, v85
v_sub_f32 v49, v49, v85
v_sub_f32 v50, v50, v85
v_sub_f32 v51, v51, v85
v_sub_f32 v52, v52, v85
v_sub_f32 v53, v53, v85
v_sub_f32 v54, v54, v85
v_sub_f32 v55, v55, v85
v_sub_f32 v56, v56, v86
v_sub_f32 v57, v57, v86
v_sub_f32 v58, v58, v86
v_sub_f32 v59, v59, v86
v_sub_f32 v60, v60, v86
v_sub_f32 v61, v61, v86
v_sub_f32 v62, v62, v86
v_sub_f32 v63, v63, v86
v_sub_f32 v64, v64, v87
v_sub_f32 v65, v65, v87
v_sub_f32 v66, v66, v87
v_sub_f32 v67, v67, v87
v_sub_f32 v68, v68, v87
v_sub_f32 v69, v69, v87
v_sub_f32 v70, v70, v87
v_sub_f32 v71, v71, v87
v_exp_f32 v40, v40
v_exp_f32 v41, v41
v_exp_f32 v42, v42
v_exp_f32 v43, v43
v_exp_f32 v44, v44
v_exp_f32 v45, v45
v_exp_f32 v46, v46
v_exp_f32 v47, v47
v_exp_f32 v48, v48
v_exp_f32 v49, v49
v_exp_f32 v50, v50
v_exp_f32 v51, v51
v_exp_f32 v52, v52
v_exp_f32 v53, v53
v_exp_f32 v54, v54
v_exp_f32 v55, v55
v_exp_f32 v56, v56
v_exp_f32 v57, v57
v_exp_f32 v58, v58
v_exp_f32 v59, v59
v_exp_f32 v60, v60
v_exp_f32 v61, v61
v_exp_f32 v62, v62
v_exp_f32 v63, v63
v_exp_f32 v64, v64
v_exp_f32 v65, v65
v_exp_f32 v66, v66
v_exp_f32 v67, v67
v_exp_f32 v68, v68
v_exp_f32 v69, v69
v_exp_f32 v70, v70
v_exp_f32 v71, v71
s_nop 0
v_mov_b32 v120, v40
v_add_f32 v120, v120, v41
v_add_f32 v120, v120, v42
v_add_f32 v120, v120, v43
v_add_f32 v120, v120, v44
v_add_f32 v120, v120, v45
v_add_f32 v120, v120, v46
v_add_f32 v120, v120, v47
v_mov_b32 v121, v48
v_add_f32 v121, v121, v49
v_add_f32 v121, v121, v50
v_add_f32 v121, v121, v51
v_add_f32 v121, v121, v52
v_add_f32 v121, v121, v53
v_add_f32 v121, v121, v54
v_add_f32 v121, v121, v55
v_mov_b32 v122, v56
v_add_f32 v122, v122, v57
v_add_f32 v122, v122, v58
v_add_f32 v122, v122, v59
v_add_f32 v122, v122, v60
v_add_f32 v122, v122, v61
v_add_f32 v122, v122, v62
v_add_f32 v122, v122, v63
v_mov_b32 v123, v64
v_add_f32 v123, v123, v65
v_add_f32 v123, v123, v66
v_add_f32 v123, v123, v67
v_add_f32 v123, v123, v68
v_add_f32 v123, v123, v69
v_add_f32 v123, v123, v70
v_add_f32 v123, v123, v71
v_cvt_pk_bf16_f32 v80, v40, v41
v_cvt_pk_bf16_f32 v81, v42, v43
v_cvt_pk_bf16_f32 v82, v44, v45
v_cvt_pk_bf16_f32 v83, v46, v47
s_mov_b32 s80, s56
s_mov_b32 s81, s57
s_mov_b32 s44, s40
s_mov_b32 s45, s41
s_and_b32 s58, s2, 7
s_lshr_b32 s64, s58, 2
s_and_b32 s67, s58, 3
s_lshl_b32 s67, s67, 1
s_lshr_b32 s58, s2, 7
s_add_u32 s67, s67, s58
s_lshr_b32 s58, s2, 3
s_and_b32 s58, s58, 15
s_lshr_b32 s60, s58, 2
s_and_b32 s61, s58, 3
s_lshl_b32 s68, s64, 3
s_add_u32 s68, s68, s67
s_lshl_b32 s58, s68, 4
s_lshl_b32 s59, s60, 2
s_add_u32 s58, s58, s59
s_mul_i32 s58, s58, 163840
s_mul_i32 s59, s27, 40960
s_add_u32 s58, s58, s59
s_add_u32 s12, s80, s58
s_addc_u32 s13, s81, 0
s_mov_b32 s14, 655360
s_mov_b32 s15, 0x20000
s_lshl_b32 s58, s64, 7
s_lshl_b32 s59, s60, 5
s_add_u32 s58, s58, s59
s_mul_i32 s58, s58, 28
s_mul_i32 s59, s61, 7
s_add_u32 s58, s58, s59
s_lshl_b32 s58, s58, 10
s_add_u32 s58, s58, 42991616
s_add_u32 s16, s80, s58
s_addc_u32 s17, s81, 0
s_mov_b32 s18, 917504
s_mov_b32 s19, 0x20000
s_mov_b32 s58, s61
s_lshl_b32 s58, s58, 3
s_add_u32 s58, s58, s27
s_mul_i32 s55, s58, 28672
s_cmp_le_u32 s61, 0
s_cselect_b32 s58, 1, 0
s_mul_i32 s52, s58, 163840
s_lshl_b32 s58, s58, 3
s_add_u32 s58, s58, s27
s_mul_i32 s56, s58, 28672
s_cmp_le_u32 s61, 1
s_cselect_b32 s58, 2, 1
s_mul_i32 s53, s58, 163840
s_lshl_b32 s58, s58, 3
s_add_u32 s58, s58, s27
s_mul_i32 s57, s58, 28672
s_cmp_le_u32 s61, 2
s_cselect_b32 s58, 3, 2
s_mul_i32 s54, s58, 163840
s_lshl_b32 s58, s58, 3
s_add_u32 s58, s58, s27
s_mul_i32 s62, s58, 28672
s_mul_i32 s63, s27, 7168
s_add_u32 s63, s63, 32768
s_mul_i32 s58, s67, 544768
s_mul_i32 s59, s60, 143360
s_add_u32 s58, s58, s59
s_mul_i32 s59, s64, 896
s_add_u32 s58, s58, s59
s_mul_i32 s59, s61, 224
s_add_u32 s58, s58, s59
s_add_u32 s44, s44, s58
s_addc_u32 s45, s45, 0
s_sub_u32 s46, 4358144, s58
s_mov_b32 s47, 0x20000
s_lshl_b32 s58, s68, 2
s_add_u32 s58, s58, s61
s_lshl_b32 s70, s58, 2
s_add_u32 s58, s70, s27
s_lshl_b32 s58, s58, 2
s_add_u32 s58, s58, s60
s_mul_i32 s58, s58, 18432
s_add_u32 s58, s58, 58720256
s_add_u32 s48, s80, s58
s_addc_u32 s49, s81, 0
s_mov_b32 s50, 18432
s_mov_b32 s51, 0x20000
s_add_u32 s58, s70, s60
s_lshl_b32 s58, s58, 2
s_mul_i32 s58, s58, 18432
s_add_u32 s70, s58, 58720256
s_mov_b32 s32, 15
s_mov_b32 s34, 0
L_att_r4:
s_cmp_eq_u32 s32, 1
s_cselect_b32 s33, 0, 16384
s_waitcnt lgkmcnt(2)
v_mfma_f32_16x16x32_bf16 v[40:43], v[8:11], v[128:131], v[100:103]
v_cvt_pk_bf16_f32 v84, v48, v49
v_cvt_pk_bf16_f32 v85, v50, v51
v_mfma_f32_16x16x32_bf16 v[44:47], v[12:15], v[128:131], v[100:103]
v_cvt_pk_bf16_f32 v86, v52, v53
v_cvt_pk_bf16_f32 v87, v54, v55
v_mfma_f32_16x16x32_bf16 v[48:51], v[8:11], v[132:135], v[104:107]
v_cvt_pk_bf16_f32 v88, v56, v57
v_cvt_pk_bf16_f32 v89, v58, v59
v_mfma_f32_16x16x32_bf16 v[52:55], v[12:15], v[132:135], v[104:107]
v_cvt_pk_bf16_f32 v90, v60, v61
v_cvt_pk_bf16_f32 v91, v62, v63
v_mfma_f32_16x16x32_bf16 v[56:59], v[8:11], v[136:139], v[108:111]
v_cvt_pk_bf16_f32 v92, v64, v65
v_cvt_pk_bf16_f32 v93, v66, v67
v_mfma_f32_16x16x32_bf16 v[60:63], v[12:15], v[136:139], v[108:111]
v_cvt_pk_bf16_f32 v94, v68, v69
v_cvt_pk_bf16_f32 v95, v70, v71
v_mfma_f32_16x16x32_bf16 v[64:67], v[8:11], v[140:143], v[112:115]
v_mfma_f32_16x16x32_bf16 v[68:71], v[12:15], v[140:143], v[112:115]
s_waitcnt lgkmcnt(0)
v_mfma_f32_16x16x32_bf16 v[40:43], v[16:19], v[144:147], v[40:43]
s_mov_b32 m0, s31
s_add_u32 s34, s34, 16384
v_mfma_f32_16x16x32_bf16 v[44:47], v[20:23], v[144:147], v[44:47]
ds_read_b128 v[8:11], v0 offset:1024
v_mfma_f32_16x16x32_bf16 v[48:51], v[16:19], v[148:151], v[48:51]
buffer_load_dwordx4 v7, s[8:11], s24 offen offset:0 nt lds
v_mfma_f32_16x16x32_bf16 v[52:55], v[20:23], v[148:151], v[52:55]
ds_read_b128 v[12:15], v0 offset:9216
v_mfma_f32_16x16x32_bf16 v[56:59], v[16:19], v[152:155], v[56:59]
v_mfma_f32_16x16x32_bf16 v[60:63], v[20:23], v[152:155], v[60:63]
v_mfma_f32_16x16x32_bf16 v[64:67], v[16:19], v[156:159], v[64:67]
v_mfma_f32_16x16x32_bf16 v[68:71], v[20:23], v[156:159], v[68:71]
s_waitcnt lgkmcnt(0)
v_mfma_f32_16x16x32_bf16 v[40:43], v[8:11], v[160:163], v[40:43]
buffer_load_dwordx4 v7, s[8:11], s25 offen offset:1024 nt lds
v_mfma_f32_16x16x32_bf16 v[44:47], v[12:15], v[160:163], v[44:47]
ds_read_b128 v[16:19], v1 offset:1024
v_mfma_f32_16x16x32_bf16 v[48:51], v[8:11], v[164:167], v[48:51]
v_mfma_f32_16x16x32_bf16 v[52:55], v[12:15], v[164:167], v[52:55]
ds_read_b128 v[20:23], v1 offset:9216
v_mfma_f32_16x16x32_bf16 v[56:59], v[8:11], v[168:171], v[56:59]
v_mfma_f32_16x16x32_bf16 v[60:63], v[12:15], v[168:171], v[60:63]
v_mfma_f32_16x16x32_bf16 v[64:67], v[8:11], v[172:175], v[64:67]
buffer_load_dwordx4 v7, s[8:11], s26 offen offset:2048 nt lds
v_mfma_f32_16x16x32_bf16 v[68:71], v[12:15], v[172:175], v[68:71]
s_waitcnt lgkmcnt(0)
v_mfma_f32_16x16x32_bf16 v[40:43], v[16:19], v[176:179], v[40:43]
v_mfma_f32_16x16x32_bf16 v[44:47], v[20:23], v[176:179], v[44:47]
ds_read_b128 v[8:11], v0 offset:2048
v_mfma_f32_16x16x32_bf16 v[48:51], v[16:19], v[180:183], v[48:51]
v_mfma_f32_16x16x32_bf16 v[52:55], v[20:23], v[180:183], v[52:55]
ds_read_b128 v[12:15], v0 offset:10240
v_mfma_f32_16x16x32_bf16 v[56:59], v[16:19], v[184:187], v[56:59]
buffer_load_dwordx4 v7, s[8:11], 0 offen offset:3072 nt lds
v_mfma_f32_16x16x32_bf16 v[60:63], v[20:23], v[184:187], v[60:63]
s_add_u32 s8, s8, 16384
s_addc_u32 s9, s9, 0
v_mfma_f32_16x16x32_bf16 v[64:67], v[16:19], v[188:191], v[64:67]
v_mfma_f32_16x16x32_bf16 v[68:71], v[20:23], v[188:191], v[68:71]
s_waitcnt lgkmcnt(0)
v_mfma_f32_16x16x32_bf16 v[40:43], v[8:11], v[192:195], v[40:43]
s_add_u32 m0, s35, s71
v_mfma_f32_16x16x32_bf16 v[44:47], v[12:15], v[192:195], v[44:47]
ds_read_b128 v[16:19], v1 offset:2048
v_mfma_f32_16x16x32_bf16 v[48:51], v[8:11], v[196:199], v[48:51]
buffer_load_dwordx4 v7, s[4:7], s24 offen offset:0 nt lds
v_mfma_f32_16x16x32_bf16 v[52:55], v[12:15], v[196:199], v[52:55]
ds_read_b128 v[20:23], v1 offset:10240
v_mfma_f32_16x16x32_bf16 v[56:59], v[8:11], v[200:203], v[56:59]
v_mfma_f32_16x16x32_bf16 v[60:63], v[12:15], v[200:203], v[60:63]
v_mfma_f32_16x16x32_bf16 v[64:67], v[8:11], v[204:207], v[64:67]
v_mfma_f32_16x16x32_bf16 v[68:71], v[12:15], v[204:207], v[68:71]
s_waitcnt lgkmcnt(0)
v_mfma_f32_16x16x32_bf16 v[40:43], v[16:19], v[208:211], v[40:43]
buffer_load_dwordx4 v7, s[4:7], s25 offen offset:1024 nt lds
v_mfma_f32_16x16x32_bf16 v[44:47], v[20:23], v[208:211], v[44:47]
ds_read_b128 v[8:11], v0 offset:3072
v_mfma_f32_16x16x32_bf16 v[48:51], v[16:19], v[212:215], v[48:51]
v_mfma_f32_16x16x32_bf16 v[52:55], v[20:23], v[212:215], v[52:55]
ds_read_b128 v[12:15], v0 offset:11264
v_mfma_f32_16x16x32_bf16 v[56:59], v[16:19], v[216:219], v[56:59]
v_mfma_f32_16x16x32_bf16 v[60:63], v[20:23], v[216:219], v[60:63]
v_mfma_f32_16x16x32_bf16 v[64:67], v[16:19], v[220:223], v[64:67]
buffer_load_dwordx4 v7, s[4:7], s26 offen offset:2048 nt lds
v_mfma_f32_16x16x32_bf16 v[68:71], v[20:23], v[220:223], v[68:71]
s_waitcnt lgkmcnt(0)
v_mfma_f32_16x16x32_bf16 v[40:43], v[8:11], v[224:227], v[40:43]
v_mfma_f32_16x16x32_bf16 v[44:47], v[12:15], v[224:227], v[44:47]
ds_read_b128 v[16:19], v1 offset:3072
v_mfma_f32_16x16x32_bf16 v[48:51], v[8:11], v[228:231], v[48:51]
v_mfma_f32_16x16x32_bf16 v[52:55], v[12:15], v[228:231], v[52:55]
ds_read_b128 v[20:23], v1 offset:11264
s_sub_u32 s69, s29, s28
v_mfma_f32_16x16x32_bf16 v[56:59], v[8:11], v[232:235], v[56:59]
buffer_load_dwordx4 v7, s[4:7], 0 offen offset:3072 nt lds
v_add_u32 v0, s69, v0
v_mfma_f32_16x16x32_bf16 v[60:63], v[12:15], v[232:235], v[60:63]
s_add_u32 s4, s4, s33
s_addc_u32 s5, s5, 0
v_mfma_f32_16x16x32_bf16 v[64:67], v[8:11], v[236:239], v[64:67]
v_add_u32 v1, s69, v1
s_mov_b32 s65, s28
v_mfma_f32_16x16x32_bf16 v[68:71], v[12:15], v[236:239], v[68:71]
s_waitcnt vmcnt(12) lgkmcnt(0)
s_barrier
v_mfma_f32_16x16x32_bf16 v[40:43], v[16:19], v[240:243], v[40:43]
ds_read_b64_tr_b16 v[24:25], v2 offset:0
s_mov_b32 s28, s29
v_mfma_f32_16x16x32_bf16 v[44:47], v[20:23], v[240:243], v[44:47]
ds_read_b64_tr_b16 v[26:27], v2 offset:8192
s_mov_b32 s29, s35
v_mfma_f32_16x16x32_bf16 v[48:51], v[16:19], v[244:247], v[48:51]
s_mov_b32 s35, s65
ds_read_b64_tr_b16 v[28:29], v3 offset:0
v_mfma_f32_16x16x32_bf16 v[52:55], v[20:23], v[244:247], v[52:55]
ds_read_b64_tr_b16 v[30:31], v3 offset:8192
v_mfma_f32_16x16x32_bf16 v[56:59], v[16:19], v[248:251], v[56:59]
ds_read_b64_tr_b16 v[32:33], v4 offset:0
v_mfma_f32_16x16x32_bf16 v[60:63], v[20:23], v[248:251], v[60:63]
ds_read_b64_tr_b16 v[34:35], v4 offset:8192
v_mfma_f32_16x16x32_bf16 v[64:67], v[16:19], v[252:255], v[64:67]
ds_read_b64_tr_b16 v[36:37], v5 offset:0
ds_read_b64_tr_b16 v[38:39], v5 offset:8192
v_mfma_f32_16x16x32_bf16 v[68:71], v[20:23], v[252:255], v[68:71]
s_waitcnt lgkmcnt(4)
v_mfma_f32_16x16x32_bf16 a[0:3], v[24:27], v[80:83], a[0:3]
ds_read_b64_tr_b16 v[16:17], v2 offset:1024
ds_read_b64_tr_b16 v[18:19], v2 offset:9216
v_mfma_f32_16x16x32_bf16 a[4:7], v[24:27], v[84:87], a[4:7]
v_exp_f32 v40, v40
v_mfma_f32_16x16x32_bf16 a[8:11], v[24:27], v[88:91], a[8:11]
ds_read_b64_tr_b16 v[20:21], v3 offset:1024
ds_read_b64_tr_b16 v[22:23], v3 offset:9216
v_mfma_f32_16x16x32_bf16 a[12:15], v[24:27], v[92:95], a[12:15]
v_exp_f32 v41, v41
v_mfma_f32_16x16x32_bf16 a[16:19], v[28:31], v[80:83], a[16:19]
v_exp_f32 v42, v42
v_mfma_f32_16x16x32_bf16 a[20:23], v[28:31], v[84:87], a[20:23]
v_exp_f32 v43, v43
v_mfma_f32_16x16x32_bf16 a[24:27], v[28:31], v[88:91], a[24:27]
v_add_f32 v124, v120, v40
v_add_f32 v124, v124, v41
v_mfma_f32_16x16x32_bf16 a[28:31], v[28:31], v[92:95], a[28:31]
s_waitcnt lgkmcnt(4)
v_add_f32 v124, v124, v42
v_mfma_f32_16x16x32_bf16 a[32:35], v[32:35], v[80:83], a[32:35]
v_exp_f32 v44, v44
v_mfma_f32_16x16x32_bf16 a[36:39], v[32:35], v[84:87], a[36:39]
ds_read_b64_tr_b16 v[24:25], v4 offset:1024
ds_read_b64_tr_b16 v[26:27], v4 offset:9216
v_mfma_f32_16x16x32_bf16 a[40:43], v[32:35], v[88:91], a[40:43]
v_exp_f32 v45, v45
v_mfma_f32_16x16x32_bf16 a[44:47], v[32:35], v[92:95], a[44:47]
ds_read_b64_tr_b16 v[28:29], v5 offset:1024
ds_read_b64_tr_b16 v[30:31], v5 offset:9216
v_mfma_f32_16x16x32_bf16 a[48:51], v[36:39], v[80:83], a[48:51]
v_exp_f32 v46, v46
v_mfma_f32_16x16x32_bf16 a[52:55], v[36:39], v[84:87], a[52:55]
v_add_f32 v124, v124, v43
v_add_f32 v124, v124, v44
v_mfma_f32_16x16x32_bf16 a[56:59], v[36:39], v[88:91], a[56:59]
v_exp_f32 v47, v47
v_mfma_f32_16x16x32_bf16 a[60:63], v[36:39], v[92:95], a[60:63]
s_waitcnt lgkmcnt(4)
v_add_f32 v124, v124, v45
v_mfma_f32_16x16x32_bf16 a[64:67], v[16:19], v[80:83], a[64:67]
v_exp_f32 v48, v48
v_mfma_f32_16x16x32_bf16 a[68:71], v[16:19], v[84:87], a[68:71]
v_exp_f32 v49, v49
v_mfma_f32_16x16x32_bf16 a[72:75], v[16:19], v[88:91], a[72:75]
v_add_f32 v124, v124, v46
ds_read_b64_tr_b16 v[32:33], v2 offset:2048
v_mfma_f32_16x16x32_bf16 a[76:79], v[16:19], v[92:95], a[76:79]
ds_read_b64_tr_b16 v[34:35], v2 offset:10240
ds_read_b64_tr_b16 v[36:37], v3 offset:2048
v_mfma_f32_16x16x32_bf16 a[80:83], v[20:23], v[80:83], a[80:83]
ds_read_b64_tr_b16 v[38:39], v3 offset:10240
v_exp_f32 v50, v50
v_add_f32 v124, v124, v47
v_mfma_f32_16x16x32_bf16 a[84:87], v[20:23], v[84:87], a[84:87]
v_exp_f32 v51, v51
v_mfma_f32_16x16x32_bf16 a[88:91], v[20:23], v[88:91], a[88:91]
v_add_f32 v125, v121, v48
v_add_f32 v125, v125, v49
v_mfma_f32_16x16x32_bf16 a[92:95], v[20:23], v[92:95], a[92:95]
s_waitcnt lgkmcnt(4)
v_add_f32 v125, v125, v50
v_mfma_f32_16x16x32_bf16 a[96:99], v[24:27], v[80:83], a[96:99]
v_exp_f32 v52, v52
v_mfma_f32_16x16x32_bf16 a[100:103], v[24:27], v[84:87], a[100:103]
v_exp_f32 v53, v53
v_mfma_f32_16x16x32_bf16 a[104:107], v[24:27], v[88:91], a[104:107]
ds_read_b64_tr_b16 v[16:17], v4 offset:2048
ds_read_b64_tr_b16 v[18:19], v4 offset:10240
v_mfma_f32_16x16x32_bf16 a[108:111], v[24:27], v[92:95], a[108:111]
v_exp_f32 v54, v54
v_add_f32 v125, v125, v51
v_mfma_f32_16x16x32_bf16 a[112:115], v[28:31], v[80:83], a[112:115]
ds_read_b64_tr_b16 v[20:21], v5 offset:2048
ds_read_b64_tr_b16 v[22:23], v5 offset:10240
v_mfma_f32_16x16x32_bf16 a[116:119], v[28:31], v[84:87], a[116:119]
v_exp_f32 v55, v55
v_add_f32 v125, v125, v52
v_mfma_f32_16x16x32_bf16 a[120:123], v[28:31], v[88:91], a[120:123]
v_add_f32 v125, v125, v53
v_add_f32 v125, v125, v54
v_mfma_f32_16x16x32_bf16 a[124:127], v[28:31], v[92:95], a[124:127]
s_waitcnt lgkmcnt(4)
v_exp_f32 v56, v56
v_mfma_f32_16x16x32_bf16 a[128:131], v[32:35], v[80:83], a[128:131]
v_exp_f32 v57, v57
v_mfma_f32_16x16x32_bf16 a[132:135], v[32:35], v[84:87], a[132:135]
v_exp_f32 v58, v58
v_mfma_f32_16x16x32_bf16 a[136:139], v[32:35], v[88:91], a[136:139]
v_add_f32 v125, v125, v55
ds_read_b64_tr_b16 v[24:25], v2 offset:3072
v_mfma_f32_16x16x32_bf16 a[140:143], v[32:35], v[92:95], a[140:143]
ds_read_b64_tr_b16 v[26:27], v2 offset:11264
ds_read_b64_tr_b16 v[28:29], v3 offset:3072
v_mfma_f32_16x16x32_bf16 a[144:147], v[36:39], v[80:83], a[144:147]
ds_read_b64_tr_b16 v[30:31], v3 offset:11264
v_exp_f32 v59, v59
v_add_f32 v126, v122, v56
v_mfma_f32_16x16x32_bf16 a[148:151], v[36:39], v[84:87], a[148:151]
v_add_f32 v126, v126, v57
v_add_f32 v126, v126, v58
v_mfma_f32_16x16x32_bf16 a[152:155], v[36:39], v[88:91], a[152:155]
v_exp_f32 v60, v60
v_mfma_f32_16x16x32_bf16 a[156:159], v[36:39], v[92:95], a[156:159]
s_waitcnt lgkmcnt(4)
v_exp_f32 v61, v61
v_mfma_f32_16x16x32_bf16 a[160:163], v[16:19], v[80:83], a[160:163]
v_exp_f32 v62, v62
v_mfma_f32_16x16x32_bf16 a[164:167], v[16:19], v[84:87], a[164:167]
v_add_f32 v126, v126, v59
ds_read_b64_tr_b16 v[32:33], v4 offset:3072
v_mfma_f32_16x16x32_bf16 a[168:171], v[16:19], v[88:91], a[168:171]
ds_read_b64_tr_b16 v[34:35], v4 offset:11264
v_add_f32 v126, v126, v60
v_mfma_f32_16x16x32_bf16 a[172:175], v[16:19], v[92:95], a[172:175]
v_exp_f32 v63, v63
v_mfma_f32_16x16x32_bf16 a[176:179], v[20:23], v[80:83], a[176:179]
ds_read_b64_tr_b16 v[36:37], v5 offset:3072
ds_read_b64_tr_b16 v[38:39], v5 offset:11264
v_add_f32 v126, v126, v61
v_mfma_f32_16x16x32_bf16 a[180:183], v[20:23], v[84:87], a[180:183]
v_exp_f32 v64, v64
v_mfma_f32_16x16x32_bf16 a[184:187], v[20:23], v[88:91], a[184:187]
v_exp_f32 v65, v65
v_add_f32 v126, v126, v62
v_mfma_f32_16x16x32_bf16 a[188:191], v[20:23], v[92:95], a[188:191]
s_waitcnt lgkmcnt(4)
v_add_f32 v126, v126, v63
v_mfma_f32_16x16x32_bf16 a[192:195], v[24:27], v[80:83], a[192:195]
v_exp_f32 v66, v66
v_mfma_f32_16x16x32_bf16 a[196:199], v[24:27], v[84:87], a[196:199]
v_exp_f32 v67, v67
v_mfma_f32_16x16x32_bf16 a[200:203], v[24:27], v[88:91], a[200:203]
v_add_f32 v127, v123, v64
v_add_f32 v127, v127, v65
v_mfma_f32_16x16x32_bf16 a[204:207], v[24:27], v[92:95], a[204:207]
v_exp_f32 v68, v68
v_mfma_f32_16x16x32_bf16 a[208:211], v[28:31], v[80:83], a[208:211]
v_exp_f32 v69, v69
v_mfma_f32_16x16x32_bf16 a[212:215], v[28:31], v[84:87], a[212:215]
v_add_f32 v127, v127, v66
v_add_f32 v127, v127, v67
v_mfma_f32_16x16x32_bf16 a[216:219], v[28:31], v[88:91], a[216:219]
v_exp_f32 v70, v70
v_mfma_f32_16x16x32_bf16 a[220:223], v[28:31], v[92:95], a[220:223]
s_waitcnt vmcnt(8) lgkmcnt(0)
s_barrier
v_mfma_f32_16x16x32_bf16 a[224:227], v[32:35], v[80:83], a[224:227]
ds_read_b128 v[8:11], v0 offset:0
ds_read_b128 v[12:15], v0 offset:8192
v_mfma_f32_16x16x32_bf16 a[228:231], v[32:35], v[84:87], a[228:231]
v_exp_f32 v71, v71
v_add_f32 v127, v127, v68
v_mfma_f32_16x16x32_bf16 a[232:235], v[32:35], v[88:91], a[232:235]
ds_read_b128 v[16:19], v1 offset:0
v_add_f32 v127, v127, v69
v_mfma_f32_16x16x32_bf16 a[236:239], v[32:35], v[92:95], a[236:239]
ds_read_b128 v[20:23], v1 offset:8192
v_add_f32 v127, v127, v70
v_mfma_f32_16x16x32_bf16 a[240:243], v[36:39], v[80:83], a[240:243]
v_add_f32 v127, v127, v71
v_max3_f32 v116, v124, v125, v126
v_mfma_f32_16x16x32_bf16 a[244:247], v[36:39], v[84:87], a[244:247]
v_max_f32 v116, v116, v127
v_cmp_nge_f32 vcc, s38, v116
v_mfma_f32_16x16x32_bf16 a[248:251], v[36:39], v[88:91], a[248:251]
v_cvt_pk_bf16_f32 v80, v40, v41
v_cvt_pk_bf16_f32 v81, v42, v43
v_mfma_f32_16x16x32_bf16 a[252:255], v[36:39], v[92:95], a[252:255]
v_cvt_pk_bf16_f32 v82, v44, v45
v_cvt_pk_bf16_f32 v83, v46, v47
s_cbranch_vccnz L_sp1_r4
L_sp1_r4_ret:
s_waitcnt lgkmcnt(2)
v_mfma_f32_16x16x32_bf16 v[40:43], v[8:11], v[128:131], v[100:103]
v_cvt_pk_bf16_f32 v84, v48, v49
v_cvt_pk_bf16_f32 v85, v50, v51
v_mfma_f32_16x16x32_bf16 v[44:47], v[12:15], v[128:131], v[100:103]
v_cvt_pk_bf16_f32 v86, v52, v53
v_cvt_pk_bf16_f32 v87, v54, v55
v_mfma_f32_16x16x32_bf16 v[48:51], v[8:11], v[132:135], v[104:107]
v_cvt_pk_bf16_f32 v88, v56, v57
v_cvt_pk_bf16_f32 v89, v58, v59
v_mfma_f32_16x16x32_bf16 v[52:55], v[12:15], v[132:135], v[104:107]
v_cvt_pk_bf16_f32 v90, v60, v61
v_cvt_pk_bf16_f32 v91, v62, v63
v_mfma_f32_16x16x32_bf16 v[56:59], v[8:11], v[136:139], v[108:111]
v_cvt_pk_bf16_f32 v92, v64, v65
v_cvt_pk_bf16_f32 v93, v66, v67
v_mfma_f32_16x16x32_bf16 v[60:63], v[12:15], v[136:139], v[108:111]
v_cvt_pk_bf16_f32 v94, v68, v69
v_cvt_pk_bf16_f32 v95, v70, v71
v_mfma_f32_16x16x32_bf16 v[64:67], v[8:11], v[140:143], v[112:115]
v_mfma_f32_16x16x32_bf16 v[68:71], v[12:15], v[140:143], v[112:115]
s_waitcnt lgkmcnt(0)
v_mfma_f32_16x16x32_bf16 v[40:43], v[16:19], v[144:147], v[40:43]
s_mov_b32 m0, s30
s_add_u32 s34, s34, 16384
v_mfma_f32_16x16x32_bf16 v[44:47], v[20:23], v[144:147], v[44:47]
ds_read_b128 v[8:11], v0 offset:1024
v_mfma_f32_16x16x32_bf16 v[48:51], v[16:19], v[148:151], v[48:51]
buffer_load_dwordx4 v7, s[8:11], s24 offen offset:0 nt lds
v_mfma_f32_16x16x32_bf16 v[52:55], v[20:23], v[148:151], v[52:55]
ds_read_b128 v[12:15], v0 offset:9216
v_mfma_f32_16x16x32_bf16 v[56:59], v[16:19], v[152:155], v[56:59]
v_mfma_f32_16x16x32_bf16 v[60:63], v[20:23], v[152:155], v[60:63]
v_mfma_f32_16x16x32_bf16 v[64:67], v[16:19], v[156:159], v[64:67]
v_mfma_f32_16x16x32_bf16 v[68:71], v[20:23], v[156:159], v[68:71]
s_waitcnt lgkmcnt(0)
v_mfma_f32_16x16x32_bf16 v[40:43], v[8:11], v[160:163], v[40:43]
buffer_load_dwordx4 v7, s[8:11], s25 offen offset:1024 nt lds
v_mfma_f32_16x16x32_bf16 v[44:47], v[12:15], v[160:163], v[44:47]
ds_read_b128 v[16:19], v1 offset:1024
v_mfma_f32_16x16x32_bf16 v[48:51], v[8:11], v[164:167], v[48:51]
v_mfma_f32_16x16x32_bf16 v[52:55], v[12:15], v[164:167], v[52:55]
ds_read_b128 v[20:23], v1 offset:9216
v_mfma_f32_16x16x32_bf16 v[56:59], v[8:11], v[168:171], v[56:59]
v_mfma_f32_16x16x32_bf16 v[60:63], v[12:15], v[168:171], v[60:63]
v_mfma_f32_16x16x32_bf16 v[64:67], v[8:11], v[172:175], v[64:67]
buffer_load_dwordx4 v7, s[8:11], s26 offen offset:2048 nt lds
v_mfma_f32_16x16x32_bf16 v[68:71], v[12:15], v[172:175], v[68:71]
s_waitcnt lgkmcnt(0)
v_mfma_f32_16x16x32_bf16 v[40:43], v[16:19], v[176:179], v[40:43]
v_mfma_f32_16x16x32_bf16 v[44:47], v[20:23], v[176:179], v[44:47]
ds_read_b128 v[8:11], v0 offset:2048
v_mfma_f32_16x16x32_bf16 v[48:51], v[16:19], v[180:183], v[48:51]
v_mfma_f32_16x16x32_bf16 v[52:55], v[20:23], v[180:183], v[52:55]
ds_read_b128 v[12:15], v0 offset:10240
v_mfma_f32_16x16x32_bf16 v[56:59], v[16:19], v[184:187], v[56:59]
buffer_load_dwordx4 v7, s[8:11], 0 offen offset:3072 nt lds
v_mfma_f32_16x16x32_bf16 v[60:63], v[20:23], v[184:187], v[60:63]
s_add_u32 s8, s8, 16384
s_addc_u32 s9, s9, 0
v_mfma_f32_16x16x32_bf16 v[64:67], v[16:19], v[188:191], v[64:67]
v_mfma_f32_16x16x32_bf16 v[68:71], v[20:23], v[188:191], v[68:71]
s_waitcnt lgkmcnt(0)
v_mfma_f32_16x16x32_bf16 v[40:43], v[8:11], v[192:195], v[40:43]
s_add_u32 m0, s35, s71
v_mfma_f32_16x16x32_bf16 v[44:47], v[12:15], v[192:195], v[44:47]
ds_read_b128 v[16:19], v1 offset:2048
v_mfma_f32_16x16x32_bf16 v[48:51], v[8:11], v[196:199], v[48:51]
buffer_load_dwordx4 v7, s[4:7], s24 offen offset:0 nt lds
v_mfma_f32_16x16x32_bf16 v[52:55], v[12:15], v[196:199], v[52:55]
ds_read_b128 v[20:23], v1 offset:10240
v_mfma_f32_16x16x32_bf16 v[56:59], v[8:11], v[200:203], v[56:59]
v_mfma_f32_16x16x32_bf16 v[60:63], v[12:15], v[200:203], v[60:63]
v_mfma_f32_16x16x32_bf16 v[64:67], v[8:11], v[204:207], v[64:67]
v_mfma_f32_16x16x32_bf16 v[68:71], v[12:15], v[204:207], v[68:71]
s_waitcnt lgkmcnt(0)
v_mfma_f32_16x16x32_bf16 v[40:43], v[16:19], v[208:211], v[40:43]
buffer_load_dwordx4 v7, s[4:7], s25 offen offset:1024 nt lds
v_mfma_f32_16x16x32_bf16 v[44:47], v[20:23], v[208:211], v[44:47]
ds_read_b128 v[8:11], v0 offset:3072
v_mfma_f32_16x16x32_bf16 v[48:51], v[16:19], v[212:215], v[48:51]
v_mfma_f32_16x16x32_bf16 v[52:55], v[20:23], v[212:215], v[52:55]
ds_read_b128 v[12:15], v0 offset:11264
v_mfma_f32_16x16x32_bf16 v[56:59], v[16:19], v[216:219], v[56:59]
v_mfma_f32_16x16x32_bf16 v[60:63], v[20:23], v[216:219], v[60:63]
v_mfma_f32_16x16x32_bf16 v[64:67], v[16:19], v[220:223], v[64:67]
buffer_load_dwordx4 v7, s[4:7], s26 offen offset:2048 nt lds
v_mfma_f32_16x16x32_bf16 v[68:71], v[20:23], v[220:223], v[68:71]
s_waitcnt lgkmcnt(0)
v_mfma_f32_16x16x32_bf16 v[40:43], v[8:11], v[224:227], v[40:43]
v_mfma_f32_16x16x32_bf16 v[44:47], v[12:15], v[224:227], v[44:47]
ds_read_b128 v[16:19], v1 offset:3072
v_mfma_f32_16x16x32_bf16 v[48:51], v[8:11], v[228:231], v[48:51]
v_mfma_f32_16x16x32_bf16 v[52:55], v[12:15], v[228:231], v[52:55]
ds_read_b128 v[20:23], v1 offset:11264
s_sub_u32 s69, s29, s28
v_mfma_f32_16x16x32_bf16 v[56:59], v[8:11], v[232:235], v[56:59]
buffer_load_dwordx4 v7, s[4:7], 0 offen offset:3072 nt lds
v_add_u32 v0, s69, v0
v_mfma_f32_16x16x32_bf16 v[60:63], v[12:15], v[232:235], v[60:63]
s_add_u32 s4, s4, s33
s_addc_u32 s5, s5, 0
v_mfma_f32_16x16x32_bf16 v[64:67], v[8:11], v[236:239], v[64:67]
v_add_u32 v1, s69, v1
s_mov_b32 s65, s28
v_mfma_f32_16x16x32_bf16 v[68:71], v[12:15], v[236:239], v[68:71]
s_waitcnt vmcnt(12) lgkmcnt(0)
s_barrier
v_mfma_f32_16x16x32_bf16 v[40:43], v[16:19], v[240:243], v[40:43]
ds_read_b64_tr_b16 v[24:25], v2 offset:16384
s_mov_b32 s28, s29
v_mfma_f32_16x16x32_bf16 v[44:47], v[20:23], v[240:243], v[44:47]
ds_read_b64_tr_b16 v[26:27], v2 offset:24576
s_mov_b32 s29, s35
v_mfma_f32_16x16x32_bf16 v[48:51], v[16:19], v[244:247], v[48:51]
s_mov_b32 s35, s65
ds_read_b64_tr_b16 v[28:29], v3 offset:16384
v_mfma_f32_16x16x32_bf16 v[52:55], v[20:23], v[244:247], v[52:55]
ds_read_b64_tr_b16 v[30:31], v3 offset:24576
v_mfma_f32_16x16x32_bf16 v[56:59], v[16:19], v[248:251], v[56:59]
ds_read_b64_tr_b16 v[32:33], v4 offset:16384
v_mfma_f32_16x16x32_bf16 v[60:63], v[20:23], v[248:251], v[60:63]
ds_read_b64_tr_b16 v[34:35], v4 offset:24576
v_mfma_f32_16x16x32_bf16 v[64:67], v[16:19], v[252:255], v[64:67]
ds_read_b64_tr_b16 v[36:37], v5 offset:16384
ds_read_b64_tr_b16 v[38:39], v5 offset:24576
v_mfma_f32_16x16x32_bf16 v[68:71], v[20:23], v[252:255], v[68:71]
s_waitcnt lgkmcnt(4)
v_mfma_f32_16x16x32_bf16 a[0:3], v[24:27], v[80:83], a[0:3]
ds_read_b64_tr_b16 v[16:17], v2 offset:17408
ds_read_b64_tr_b16 v[18:19], v2 offset:25600
v_mfma_f32_16x16x32_bf16 a[4:7], v[24:27], v[84:87], a[4:7]
v_exp_f32 v40, v40
v_mfma_f32_16x16x32_bf16 a[8:11], v[24:27], v[88:91], a[8:11]
ds_read_b64_tr_b16 v[20:21], v3 offset:17408
ds_read_b64_tr_b16 v[22:23], v3 offset:25600
v_mfma_f32_16x16x32_bf16 a[12:15], v[24:27], v[92:95], a[12:15]
v_exp_f32 v41, v41
v_mfma_f32_16x16x32_bf16 a[16:19], v[28:31], v[80:83], a[16:19]
v_exp_f32 v42, v42
v_mfma_f32_16x16x32_bf16 a[20:23], v[28:31], v[84:87], a[20:23]
v_exp_f32 v43, v43
v_mfma_f32_16x16x32_bf16 a[24:27], v[28:31], v[88:91], a[24:27]
v_add_f32 v120, v124, v40
v_add_f32 v120, v120, v41
v_mfma_f32_16x16x32_bf16 a[28:31], v[28:31], v[92:95], a[28:31]
s_waitcnt lgkmcnt(4)
v_add_f32 v120, v120, v42
v_mfma_f32_16x16x32_bf16 a[32:35], v[32:35], v[80:83], a[32:35]
v_exp_f32 v44, v44
v_mfma_f32_16x16x32_bf16 a[36:39], v[32:35], v[84:87], a[36:39]
ds_read_b64_tr_b16 v[24:25], v4 offset:17408
ds_read_b64_tr_b16 v[26:27], v4 offset:25600
v_mfma_f32_16x16x32_bf16 a[40:43], v[32:35], v[88:91], a[40:43]
v_exp_f32 v45, v45
v_mfma_f32_16x16x32_bf16 a[44:47], v[32:35], v[92:95], a[44:47]
ds_read_b64_tr_b16 v[28:29], v5 offset:17408
ds_read_b64_tr_b16 v[30:31], v5 offset:25600
v_mfma_f32_16x16x32_bf16 a[48:51], v[36:39], v[80:83], a[48:51]
v_exp_f32 v46, v46
v_mfma_f32_16x16x32_bf16 a[52:55], v[36:39], v[84:87], a[52:55]
v_add_f32 v120, v120, v43
v_add_f32 v120, v120, v44
v_mfma_f32_16x16x32_bf16 a[56:59], v[36:39], v[88:91], a[56:59]
v_exp_f32 v47, v47
v_mfma_f32_16x16x32_bf16 a[60:63], v[36:39], v[92:95], a[60:63]
s_waitcnt lgkmcnt(4)
v_add_f32 v120, v120, v45
v_mfma_f32_16x16x32_bf16 a[64:67], v[16:19], v[80:83], a[64:67]
v_exp_f32 v48, v48
v_mfma_f32_16x16x32_bf16 a[68:71], v[16:19], v[84:87], a[68:71]
v_exp_f32 v49, v49
v_mfma_f32_16x16x32_bf16 a[72:75], v[16:19], v[88:91], a[72:75]
v_add_f32 v120, v120, v46
ds_read_b64_tr_b16 v[32:33], v2 offset:18432
v_mfma_f32_16x16x32_bf16 a[76:79], v[16:19], v[92:95], a[76:79]
ds_read_b64_tr_b16 v[34:35], v2 offset:26624
ds_read_b64_tr_b16 v[36:37], v3 offset:18432
v_mfma_f32_16x16x32_bf16 a[80:83], v[20:23], v[80:83], a[80:83]
ds_read_b64_tr_b16 v[38:39], v3 offset:26624
v_exp_f32 v50, v50
v_add_f32 v120, v120, v47
v_mfma_f32_16x16x32_bf16 a[84:87], v[20:23], v[84:87], a[84:87]
v_exp_f32 v51, v51
v_mfma_f32_16x16x32_bf16 a[88:91], v[20:23], v[88:91], a[88:91]
v_add_f32 v121, v125, v48
v_add_f32 v121, v121, v49
v_mfma_f32_16x16x32_bf16 a[92:95], v[20:23], v[92:95], a[92:95]
s_waitcnt lgkmcnt(4)
v_add_f32 v121, v121, v50
v_mfma_f32_16x16x32_bf16 a[96:99], v[24:27], v[80:83], a[96:99]
v_exp_f32 v52, v52
v_mfma_f32_16x16x32_bf16 a[100:103], v[24:27], v[84:87], a[100:103]
v_exp_f32 v53, v53
v_mfma_f32_16x16x32_bf16 a[104:107], v[24:27], v[88:91], a[104:107]
ds_read_b64_tr_b16 v[16:17], v4 offset:18432
ds_read_b64_tr_b16 v[18:19], v4 offset:26624
v_mfma_f32_16x16x32_bf16 a[108:111], v[24:27], v[92:95], a[108:111]
v_exp_f32 v54, v54
v_add_f32 v121, v121, v51
v_mfma_f32_16x16x32_bf16 a[112:115], v[28:31], v[80:83], a[112:115]
ds_read_b64_tr_b16 v[20:21], v5 offset:18432
ds_read_b64_tr_b16 v[22:23], v5 offset:26624
v_mfma_f32_16x16x32_bf16 a[116:119], v[28:31], v[84:87], a[116:119]
v_exp_f32 v55, v55
v_add_f32 v121, v121, v52
v_mfma_f32_16x16x32_bf16 a[120:123], v[28:31], v[88:91], a[120:123]
v_add_f32 v121, v121, v53
v_add_f32 v121, v121, v54
v_mfma_f32_16x16x32_bf16 a[124:127], v[28:31], v[92:95], a[124:127]
s_waitcnt lgkmcnt(4)
v_exp_f32 v56, v56
v_mfma_f32_16x16x32_bf16 a[128:131], v[32:35], v[80:83], a[128:131]
v_exp_f32 v57, v57
v_mfma_f32_16x16x32_bf16 a[132:135], v[32:35], v[84:87], a[132:135]
v_exp_f32 v58, v58
v_mfma_f32_16x16x32_bf16 a[136:139], v[32:35], v[88:91], a[136:139]
v_add_f32 v121, v121, v55
ds_read_b64_tr_b16 v[24:25], v2 offset:19456
v_mfma_f32_16x16x32_bf16 a[140:143], v[32:35], v[92:95], a[140:143]
ds_read_b64_tr_b16 v[26:27], v2 offset:27648
ds_read_b64_tr_b16 v[28:29], v3 offset:19456
v_mfma_f32_16x16x32_bf16 a[144:147], v[36:39], v[80:83], a[144:147]
ds_read_b64_tr_b16 v[30:31], v3 offset:27648
v_exp_f32 v59, v59
v_add_f32 v122, v126, v56
v_mfma_f32_16x16x32_bf16 a[148:151], v[36:39], v[84:87], a[148:151]
v_add_f32 v122, v122, v57
v_add_f32 v122, v122, v58
v_mfma_f32_16x16x32_bf16 a[152:155], v[36:39], v[88:91], a[152:155]
v_exp_f32 v60, v60
v_mfma_f32_16x16x32_bf16 a[156:159], v[36:39], v[92:95], a[156:159]
s_waitcnt lgkmcnt(4)
v_exp_f32 v61, v61
v_mfma_f32_16x16x32_bf16 a[160:163], v[16:19], v[80:83], a[160:163]
v_exp_f32 v62, v62
v_mfma_f32_16x16x32_bf16 a[164:167], v[16:19], v[84:87], a[164:167]
v_add_f32 v122, v122, v59
ds_read_b64_tr_b16 v[32:33], v4 offset:19456
v_mfma_f32_16x16x32_bf16 a[168:171], v[16:19], v[88:91], a[168:171]
ds_read_b64_tr_b16 v[34:35], v4 offset:27648
v_add_f32 v122, v122, v60
v_mfma_f32_16x16x32_bf16 a[172:175], v[16:19], v[92:95], a[172:175]
v_exp_f32 v63, v63
v_mfma_f32_16x16x32_bf16 a[176:179], v[20:23], v[80:83], a[176:179]
ds_read_b64_tr_b16 v[36:37], v5 offset:19456
ds_read_b64_tr_b16 v[38:39], v5 offset:27648
v_add_f32 v122, v122, v61
v_mfma_f32_16x16x32_bf16 a[180:183], v[20:23], v[84:87], a[180:183]
v_exp_f32 v64, v64
v_mfma_f32_16x16x32_bf16 a[184:187], v[20:23], v[88:91], a[184:187]
v_exp_f32 v65, v65
v_add_f32 v122, v122, v62
v_mfma_f32_16x16x32_bf16 a[188:191], v[20:23], v[92:95], a[188:191]
s_waitcnt lgkmcnt(4)
v_add_f32 v122, v122, v63
v_mfma_f32_16x16x32_bf16 a[192:195], v[24:27], v[80:83], a[192:195]
v_exp_f32 v66, v66
v_mfma_f32_16x16x32_bf16 a[196:199], v[24:27], v[84:87], a[196:199]
v_exp_f32 v67, v67
v_mfma_f32_16x16x32_bf16 a[200:203], v[24:27], v[88:91], a[200:203]
v_add_f32 v123, v127, v64
v_add_f32 v123, v123, v65
v_mfma_f32_16x16x32_bf16 a[204:207], v[24:27], v[92:95], a[204:207]
v_exp_f32 v68, v68
v_mfma_f32_16x16x32_bf16 a[208:211], v[28:31], v[80:83], a[208:211]
v_exp_f32 v69, v69
v_mfma_f32_16x16x32_bf16 a[212:215], v[28:31], v[84:87], a[212:215]
v_add_f32 v123, v123, v66
v_add_f32 v123, v123, v67
v_mfma_f32_16x16x32_bf16 a[216:219], v[28:31], v[88:91], a[216:219]
v_exp_f32 v70, v70
v_mfma_f32_16x16x32_bf16 a[220:223], v[28:31], v[92:95], a[220:223]
s_waitcnt vmcnt(8) lgkmcnt(0)
s_barrier
v_mfma_f32_16x16x32_bf16 a[224:227], v[32:35], v[80:83], a[224:227]
ds_read_b128 v[8:11], v0 offset:0
ds_read_b128 v[12:15], v0 offset:8192
v_mfma_f32_16x16x32_bf16 a[228:231], v[32:35], v[84:87], a[228:231]
v_exp_f32 v71, v71
v_add_f32 v123, v123, v68
v_mfma_f32_16x16x32_bf16 a[232:235], v[32:35], v[88:91], a[232:235]
ds_read_b128 v[16:19], v1 offset:0
v_add_f32 v123, v123, v69
v_mfma_f32_16x16x32_bf16 a[236:239], v[32:35], v[92:95], a[236:239]
ds_read_b128 v[20:23], v1 offset:8192
v_add_f32 v123, v123, v70
v_mfma_f32_16x16x32_bf16 a[240:243], v[36:39], v[80:83], a[240:243]
v_add_f32 v123, v123, v71
v_max3_f32 v116, v120, v121, v122
v_mfma_f32_16x16x32_bf16 a[244:247], v[36:39], v[84:87], a[244:247]
v_max_f32 v116, v116, v123
v_cmp_nge_f32 vcc, s38, v116
v_mfma_f32_16x16x32_bf16 a[248:251], v[36:39], v[88:91], a[248:251]
v_cvt_pk_bf16_f32 v80, v40, v41
v_cvt_pk_bf16_f32 v81, v42, v43
v_mfma_f32_16x16x32_bf16 a[252:255], v[36:39], v[92:95], a[252:255]
v_cvt_pk_bf16_f32 v82, v44, v45
v_cvt_pk_bf16_f32 v83, v46, v47
s_cbranch_vccnz L_sp0_r4
L_sp0_r4_ret:
s_sub_u32 s32, s32, 1
s_cmp_lg_u32 s32, 0
s_cbranch_scc1 L_att_r4
s_waitcnt lgkmcnt(2)
v_mfma_f32_16x16x32_bf16 v[40:43], v[8:11], v[128:131], v[100:103]
v_cvt_pk_bf16_f32 v84, v48, v49
v_cvt_pk_bf16_f32 v85, v50, v51
v_mfma_f32_16x16x32_bf16 v[44:47], v[12:15], v[128:131], v[100:103]
v_cvt_pk_bf16_f32 v86, v52, v53
v_cvt_pk_bf16_f32 v87, v54, v55
v_mfma_f32_16x16x32_bf16 v[48:51], v[8:11], v[132:135], v[104:107]
v_cvt_pk_bf16_f32 v88, v56, v57
v_cvt_pk_bf16_f32 v89, v58, v59
v_mfma_f32_16x16x32_bf16 v[52:55], v[12:15], v[132:135], v[104:107]
v_cvt_pk_bf16_f32 v90, v60, v61
v_cvt_pk_bf16_f32 v91, v62, v63
v_mfma_f32_16x16x32_bf16 v[56:59], v[8:11], v[136:139], v[108:111]
v_cvt_pk_bf16_f32 v92, v64, v65
v_cvt_pk_bf16_f32 v93, v66, v67
v_mfma_f32_16x16x32_bf16 v[60:63], v[12:15], v[136:139], v[108:111]
v_cvt_pk_bf16_f32 v94, v68, v69
v_cvt_pk_bf16_f32 v95, v70, v71
v_mfma_f32_16x16x32_bf16 v[64:67], v[8:11], v[140:143], v[112:115]
v_mfma_f32_16x16x32_bf16 v[68:71], v[12:15], v[140:143], v[112:115]
s_waitcnt lgkmcnt(0)
v_mfma_f32_16x16x32_bf16 v[40:43], v[16:19], v[144:147], v[40:43]
s_mov_b32 m0, s31
s_add_u32 s34, s34, 16384
v_mfma_f32_16x16x32_bf16 v[44:47], v[20:23], v[144:147], v[44:47]
ds_read_b128 v[8:11], v0 offset:1024
v_mfma_f32_16x16x32_bf16 v[48:51], v[16:19], v[148:151], v[48:51]
buffer_load_dwordx4 v7, s[8:11], s24 offen offset:0 nt lds
v_mfma_f32_16x16x32_bf16 v[52:55], v[20:23], v[148:151], v[52:55]
ds_read_b128 v[12:15], v0 offset:9216
v_mfma_f32_16x16x32_bf16 v[56:59], v[16:19], v[152:155], v[56:59]
v_mfma_f32_16x16x32_bf16 v[60:63], v[20:23], v[152:155], v[60:63]
v_mfma_f32_16x16x32_bf16 v[64:67], v[16:19], v[156:159], v[64:67]
v_mfma_f32_16x16x32_bf16 v[68:71], v[20:23], v[156:159], v[68:71]
s_waitcnt lgkmcnt(0)
v_mfma_f32_16x16x32_bf16 v[40:43], v[8:11], v[160:163], v[40:43]
v_mfma_f32_16x16x32_bf16 v[44:47], v[12:15], v[160:163], v[44:47]
ds_read_b128 v[16:19], v1 offset:1024
v_mfma_f32_16x16x32_bf16 v[48:51], v[8:11], v[164:167], v[48:51]
v_mfma_f32_16x16x32_bf16 v[52:55], v[12:15], v[164:167], v[52:55]
ds_read_b128 v[20:23], v1 offset:9216
v_mfma_f32_16x16x32_bf16 v[56:59], v[8:11], v[168:171], v[56:59]
v_mfma_f32_16x16x32_bf16 v[60:63], v[12:15], v[168:171], v[60:63]
v_mfma_f32_16x16x32_bf16 v[64:67], v[8:11], v[172:175], v[64:67]
v_mfma_f32_16x16x32_bf16 v[68:71], v[12:15], v[172:175], v[68:71]
s_waitcnt lgkmcnt(0)
v_mfma_f32_16x16x32_bf16 v[40:43], v[16:19], v[176:179], v[40:43]
buffer_load_dwordx4 v7, s[8:11], s25 offen offset:1024 nt lds
v_mfma_f32_16x16x32_bf16 v[44:47], v[20:23], v[176:179], v[44:47]
ds_read_b128 v[8:11], v0 offset:2048
v_mfma_f32_16x16x32_bf16 v[48:51], v[16:19], v[180:183], v[48:51]
v_mfma_f32_16x16x32_bf16 v[52:55], v[20:23], v[180:183], v[52:55]
ds_read_b128 v[12:15], v0 offset:10240
v_mfma_f32_16x16x32_bf16 v[56:59], v[16:19], v[184:187], v[56:59]
v_mfma_f32_16x16x32_bf16 v[60:63], v[20:23], v[184:187], v[60:63]
v_mfma_f32_16x16x32_bf16 v[64:67], v[16:19], v[188:191], v[64:67]
v_mfma_f32_16x16x32_bf16 v[68:71], v[20:23], v[188:191], v[68:71]
s_waitcnt lgkmcnt(0)
v_mfma_f32_16x16x32_bf16 v[40:43], v[8:11], v[192:195], v[40:43]
v_mfma_f32_16x16x32_bf16 v[44:47], v[12:15], v[192:195], v[44:47]
ds_read_b128 v[16:19], v1 offset:2048
v_mfma_f32_16x16x32_bf16 v[48:51], v[8:11], v[196:199], v[48:51]
v_mfma_f32_16x16x32_bf16 v[52:55], v[12:15], v[196:199], v[52:55]
ds_read_b128 v[20:23], v1 offset:10240
v_mfma_f32_16x16x32_bf16 v[56:59], v[8:11], v[200:203], v[56:59]
v_mfma_f32_16x16x32_bf16 v[60:63], v[12:15], v[200:203], v[60:63]
v_mfma_f32_16x16x32_bf16 v[64:67], v[8:11], v[204:207], v[64:67]
buffer_load_dwordx4 v7, s[8:11], s26 offen offset:2048 nt lds
v_mfma_f32_16x16x32_bf16 v[68:71], v[12:15], v[204:207], v[68:71]
s_waitcnt lgkmcnt(0)
v_mfma_f32_16x16x32_bf16 v[40:43], v[16:19], v[208:211], v[40:43]
v_mfma_f32_16x16x32_bf16 v[44:47], v[20:23], v[208:211], v[44:47]
ds_read_b128 v[8:11], v0 offset:3072
v_mfma_f32_16x16x32_bf16 v[48:51], v[16:19], v[212:215], v[48:51]
v_mfma_f32_16x16x32_bf16 v[52:55], v[20:23], v[212:215], v[52:55]
ds_read_b128 v[12:15], v0 offset:11264
v_mfma_f32_16x16x32_bf16 v[56:59], v[16:19], v[216:219], v[56:59]
v_mfma_f32_16x16x32_bf16 v[60:63], v[20:23], v[216:219], v[60:63]
v_mfma_f32_16x16x32_bf16 v[64:67], v[16:19], v[220:223], v[64:67]
v_mfma_f32_16x16x32_bf16 v[68:71], v[20:23], v[220:223], v[68:71]
s_waitcnt lgkmcnt(0)
v_mfma_f32_16x16x32_bf16 v[40:43], v[8:11], v[224:227], v[40:43]
v_mfma_f32_16x16x32_bf16 v[44:47], v[12:15], v[224:227], v[44:47]
ds_read_b128 v[16:19], v1 offset:3072
v_mfma_f32_16x16x32_bf16 v[48:51], v[8:11], v[228:231], v[48:51]
v_mfma_f32_16x16x32_bf16 v[52:55], v[12:15], v[228:231], v[52:55]
ds_read_b128 v[20:23], v1 offset:11264
s_sub_u32 s69, s29, s28
v_mfma_f32_16x16x32_bf16 v[56:59], v[8:11], v[232:235], v[56:59]
buffer_load_dwordx4 v7, s[8:11], 0 offen offset:3072 nt lds
v_add_u32 v0, s69, v0
v_mfma_f32_16x16x32_bf16 v[60:63], v[12:15], v[232:235], v[60:63]
s_add_u32 s8, s8, 16384
s_addc_u32 s9, s9, 0
v_mfma_f32_16x16x32_bf16 v[64:67], v[8:11], v[236:239], v[64:67]
v_add_u32 v1, s69, v1
s_mov_b32 s65, s28
v_mfma_f32_16x16x32_bf16 v[68:71], v[12:15], v[236:239], v[68:71]
s_waitcnt vmcnt(8) lgkmcnt(0)
s_barrier
v_mfma_f32_16x16x32_bf16 v[40:43], v[16:19], v[240:243], v[40:43]
ds_read_b64_tr_b16 v[24:25], v2 offset:0
s_mov_b32 s28, s29
v_mfma_f32_16x16x32_bf16 v[44:47], v[20:23], v[240:243], v[44:47]
ds_read_b64_tr_b16 v[26:27], v2 offset:8192
s_mov_b32 s29, s35
v_mfma_f32_16x16x32_bf16 v[48:51], v[16:19], v[244:247], v[48:51]
s_mov_b32 s35, s65
ds_read_b64_tr_b16 v[28:29], v3 offset:0
v_mfma_f32_16x16x32_bf16 v[52:55], v[20:23], v[244:247], v[52:55]
ds_read_b64_tr_b16 v[30:31], v3 offset:8192
v_mfma_f32_16x16x32_bf16 v[56:59], v[16:19], v[248:251], v[56:59]
ds_read_b64_tr_b16 v[32:33], v4 offset:0
v_mfma_f32_16x16x32_bf16 v[60:63], v[20:23], v[248:251], v[60:63]
ds_read_b64_tr_b16 v[34:35], v4 offset:8192
v_mfma_f32_16x16x32_bf16 v[64:67], v[16:19], v[252:255], v[64:67]
ds_read_b64_tr_b16 v[36:37], v5 offset:0
ds_read_b64_tr_b16 v[38:39], v5 offset:8192
v_mfma_f32_16x16x32_bf16 v[68:71], v[20:23], v[252:255], v[68:71]
s_waitcnt lgkmcnt(4)
v_mfma_f32_16x16x32_bf16 a[0:3], v[24:27], v[80:83], a[0:3]
ds_read_b64_tr_b16 v[16:17], v2 offset:1024
ds_read_b64_tr_b16 v[18:19], v2 offset:9216
v_mfma_f32_16x16x32_bf16 a[4:7], v[24:27], v[84:87], a[4:7]
v_exp_f32 v40, v40
v_mfma_f32_16x16x32_bf16 a[8:11], v[24:27], v[88:91], a[8:11]
ds_read_b64_tr_b16 v[20:21], v3 offset:1024
ds_read_b64_tr_b16 v[22:23], v3 offset:9216
v_mfma_f32_16x16x32_bf16 a[12:15], v[24:27], v[92:95], a[12:15]
v_exp_f32 v41, v41
v_mfma_f32_16x16x32_bf16 a[16:19], v[28:31], v[80:83], a[16:19]
v_exp_f32 v42, v42
v_mfma_f32_16x16x32_bf16 a[20:23], v[28:31], v[84:87], a[20:23]
v_exp_f32 v43, v43
v_mfma_f32_16x16x32_bf16 a[24:27], v[28:31], v[88:91], a[24:27]
v_add_f32 v124, v120, v40
v_add_f32 v124, v124, v41
v_mfma_f32_16x16x32_bf16 a[28:31], v[28:31], v[92:95], a[28:31]
s_waitcnt lgkmcnt(4)
v_add_f32 v124, v124, v42
v_mfma_f32_16x16x32_bf16 a[32:35], v[32:35], v[80:83], a[32:35]
v_exp_f32 v44, v44
v_mfma_f32_16x16x32_bf16 a[36:39], v[32:35], v[84:87], a[36:39]
ds_read_b64_tr_b16 v[24:25], v4 offset:1024
ds_read_b64_tr_b16 v[26:27], v4 offset:9216
v_mfma_f32_16x16x32_bf16 a[40:43], v[32:35], v[88:91], a[40:43]
v_exp_f32 v45, v45
v_mfma_f32_16x16x32_bf16 a[44:47], v[32:35], v[92:95], a[44:47]
ds_read_b64_tr_b16 v[28:29], v5 offset:1024
ds_read_b64_tr_b16 v[30:31], v5 offset:9216
v_mfma_f32_16x16x32_bf16 a[48:51], v[36:39], v[80:83], a[48:51]
v_exp_f32 v46, v46
v_mfma_f32_16x16x32_bf16 a[52:55], v[36:39], v[84:87], a[52:55]
v_add_f32 v124, v124, v43
v_add_f32 v124, v124, v44
v_mfma_f32_16x16x32_bf16 a[56:59], v[36:39], v[88:91], a[56:59]
v_exp_f32 v47, v47
v_mfma_f32_16x16x32_bf16 a[60:63], v[36:39], v[92:95], a[60:63]
s_waitcnt lgkmcnt(4)
v_add_f32 v124, v124, v45
v_mfma_f32_16x16x32_bf16 a[64:67], v[16:19], v[80:83], a[64:67]
v_exp_f32 v48, v48
v_mfma_f32_16x16x32_bf16 a[68:71], v[16:19], v[84:87], a[68:71]
v_exp_f32 v49, v49
v_mfma_f32_16x16x32_bf16 a[72:75], v[16:19], v[88:91], a[72:75]
v_add_f32 v124, v124, v46
ds_read_b64_tr_b16 v[32:33], v2 offset:2048
v_mfma_f32_16x16x32_bf16 a[76:79], v[16:19], v[92:95], a[76:79]
ds_read_b64_tr_b16 v[34:35], v2 offset:10240
ds_read_b64_tr_b16 v[36:37], v3 offset:2048
v_mfma_f32_16x16x32_bf16 a[80:83], v[20:23], v[80:83], a[80:83]
ds_read_b64_tr_b16 v[38:39], v3 offset:10240
v_exp_f32 v50, v50
v_add_f32 v124, v124, v47
v_mfma_f32_16x16x32_bf16 a[84:87], v[20:23], v[84:87], a[84:87]
v_exp_f32 v51, v51
v_mfma_f32_16x16x32_bf16 a[88:91], v[20:23], v[88:91], a[88:91]
v_add_f32 v125, v121, v48
v_add_f32 v125, v125, v49
v_mfma_f32_16x16x32_bf16 a[92:95], v[20:23], v[92:95], a[92:95]
s_waitcnt lgkmcnt(4)
v_add_f32 v125, v125, v50
v_mfma_f32_16x16x32_bf16 a[96:99], v[24:27], v[80:83], a[96:99]
v_exp_f32 v52, v52
v_mfma_f32_16x16x32_bf16 a[100:103], v[24:27], v[84:87], a[100:103]
v_exp_f32 v53, v53
v_mfma_f32_16x16x32_bf16 a[104:107], v[24:27], v[88:91], a[104:107]
ds_read_b64_tr_b16 v[16:17], v4 offset:2048
ds_read_b64_tr_b16 v[18:19], v4 offset:10240
v_mfma_f32_16x16x32_bf16 a[108:111], v[24:27], v[92:95], a[108:111]
v_exp_f32 v54, v54
v_add_f32 v125, v125, v51
v_mfma_f32_16x16x32_bf16 a[112:115], v[28:31], v[80:83], a[112:115]
ds_read_b64_tr_b16 v[20:21], v5 offset:2048
ds_read_b64_tr_b16 v[22:23], v5 offset:10240
v_mfma_f32_16x16x32_bf16 a[116:119], v[28:31], v[84:87], a[116:119]
v_exp_f32 v55, v55
v_add_f32 v125, v125, v52
v_mfma_f32_16x16x32_bf16 a[120:123], v[28:31], v[88:91], a[120:123]
v_add_f32 v125, v125, v53
v_add_f32 v125, v125, v54
v_mfma_f32_16x16x32_bf16 a[124:127], v[28:31], v[92:95], a[124:127]
s_waitcnt lgkmcnt(4)
v_exp_f32 v56, v56
v_mfma_f32_16x16x32_bf16 a[128:131], v[32:35], v[80:83], a[128:131]
v_exp_f32 v57, v57
v_mfma_f32_16x16x32_bf16 a[132:135], v[32:35], v[84:87], a[132:135]
v_exp_f32 v58, v58
v_mfma_f32_16x16x32_bf16 a[136:139], v[32:35], v[88:91], a[136:139]
v_add_f32 v125, v125, v55
ds_read_b64_tr_b16 v[24:25], v2 offset:3072
v_mfma_f32_16x16x32_bf16 a[140:143], v[32:35], v[92:95], a[140:143]
ds_read_b64_tr_b16 v[26:27], v2 offset:11264
ds_read_b64_tr_b16 v[28:29], v3 offset:3072
v_mfma_f32_16x16x32_bf16 a[144:147], v[36:39], v[80:83], a[144:147]
ds_read_b64_tr_b16 v[30:31], v3 offset:11264
v_exp_f32 v59, v59
v_add_f32 v126, v122, v56
v_mfma_f32_16x16x32_bf16 a[148:151], v[36:39], v[84:87], a[148:151]
v_add_f32 v126, v126, v57
v_add_f32 v126, v126, v58
v_mfma_f32_16x16x32_bf16 a[152:155], v[36:39], v[88:91], a[152:155]
v_exp_f32 v60, v60
v_mfma_f32_16x16x32_bf16 a[156:159], v[36:39], v[92:95], a[156:159]
s_waitcnt lgkmcnt(4)
v_exp_f32 v61, v61
v_mfma_f32_16x16x32_bf16 a[160:163], v[16:19], v[80:83], a[160:163]
v_exp_f32 v62, v62
v_mfma_f32_16x16x32_bf16 a[164:167], v[16:19], v[84:87], a[164:167]
v_add_f32 v126, v126, v59
ds_read_b64_tr_b16 v[32:33], v4 offset:3072
v_mfma_f32_16x16x32_bf16 a[168:171], v[16:19], v[88:91], a[168:171]
ds_read_b64_tr_b16 v[34:35], v4 offset:11264
v_add_f32 v126, v126, v60
v_mfma_f32_16x16x32_bf16 a[172:175], v[16:19], v[92:95], a[172:175]
v_exp_f32 v63, v63
v_mfma_f32_16x16x32_bf16 a[176:179], v[20:23], v[80:83], a[176:179]
ds_read_b64_tr_b16 v[36:37], v5 offset:3072
ds_read_b64_tr_b16 v[38:39], v5 offset:11264
v_add_f32 v126, v126, v61
v_mfma_f32_16x16x32_bf16 a[180:183], v[20:23], v[84:87], a[180:183]
v_exp_f32 v64, v64
v_mfma_f32_16x16x32_bf16 a[184:187], v[20:23], v[88:91], a[184:187]
v_exp_f32 v65, v65
v_add_f32 v126, v126, v62
v_mfma_f32_16x16x32_bf16 a[188:191], v[20:23], v[92:95], a[188:191]
s_waitcnt lgkmcnt(4)
v_add_f32 v126, v126, v63
v_mfma_f32_16x16x32_bf16 a[192:195], v[24:27], v[80:83], a[192:195]
v_exp_f32 v66, v66
v_mfma_f32_16x16x32_bf16 a[196:199], v[24:27], v[84:87], a[196:199]
v_exp_f32 v67, v67
v_mfma_f32_16x16x32_bf16 a[200:203], v[24:27], v[88:91], a[200:203]
v_add_f32 v127, v123, v64
v_add_f32 v127, v127, v65
v_mfma_f32_16x16x32_bf16 a[204:207], v[24:27], v[92:95], a[204:207]
v_exp_f32 v68, v68
v_mfma_f32_16x16x32_bf16 a[208:211], v[28:31], v[80:83], a[208:211]
v_exp_f32 v69, v69
v_mfma_f32_16x16x32_bf16 a[212:215], v[28:31], v[84:87], a[212:215]
v_add_f32 v127, v127, v66
v_add_f32 v127, v127, v67
v_mfma_f32_16x16x32_bf16 a[216:219], v[28:31], v[88:91], a[216:219]
v_exp_f32 v70, v70
v_mfma_f32_16x16x32_bf16 a[220:223], v[28:31], v[92:95], a[220:223]
s_waitcnt vmcnt(0) lgkmcnt(0)
s_barrier
v_mfma_f32_16x16x32_bf16 a[224:227], v[32:35], v[80:83], a[224:227]
ds_read_b64_tr_b16 v[8:9], v2 offset:16384
ds_read_b64_tr_b16 v[10:11], v2 offset:24576
v_mfma_f32_16x16x32_bf16 a[228:231], v[32:35], v[84:87], a[228:231]
ds_read_b64_tr_b16 v[12:13], v3 offset:16384
ds_read_b64_tr_b16 v[14:15], v3 offset:24576
v_exp_f32 v71, v71
v_add_f32 v127, v127, v68
v_mfma_f32_16x16x32_bf16 a[232:235], v[32:35], v[88:91], a[232:235]
ds_read_b64_tr_b16 v[16:17], v4 offset:16384
ds_read_b64_tr_b16 v[18:19], v4 offset:24576
v_add_f32 v127, v127, v69
v_mfma_f32_16x16x32_bf16 a[236:239], v[32:35], v[92:95], a[236:239]
ds_read_b64_tr_b16 v[20:21], v5 offset:16384
ds_read_b64_tr_b16 v[22:23], v5 offset:24576
v_mfma_f32_16x16x32_bf16 a[240:243], v[36:39], v[80:83], a[240:243]
v_add_f32 v127, v127, v70
v_add_f32 v127, v127, v71
v_mfma_f32_16x16x32_bf16 a[244:247], v[36:39], v[84:87], a[244:247]
v_max3_f32 v116, v124, v125, v126
v_max_f32 v116, v116, v127
v_mfma_f32_16x16x32_bf16 a[248:251], v[36:39], v[88:91], a[248:251]
v_cmp_nge_f32 vcc, s38, v116
v_cvt_pk_bf16_f32 v80, v40, v41
v_mfma_f32_16x16x32_bf16 a[252:255], v[36:39], v[92:95], a[252:255]
v_cvt_pk_bf16_f32 v81, v42, v43
v_cvt_pk_bf16_f32 v82, v44, v45
v_cvt_pk_bf16_f32 v83, v46, v47
s_cbranch_vccnz L_sp2_r4
L_sp2_r4_ret:
s_barrier
v_mbcnt_lo_u32_b32 v6, -1, 0
v_mbcnt_hi_u32_b32 v6, -1, v6
v_lshlrev_b32 v6, 4, v6
s_waitcnt lgkmcnt(4)
v_cvt_pk_bf16_f32 v84, v48, v49
v_cvt_pk_bf16_f32 v85, v50, v51
v_cvt_pk_bf16_f32 v86, v52, v53
v_cvt_pk_bf16_f32 v87, v54, v55
v_mfma_f32_16x16x32_bf16 a[0:3], v[8:11], v[80:83], a[0:3]
v_cvt_pk_bf16_f32 v88, v56, v57
v_cvt_pk_bf16_f32 v89, v58, v59
v_cvt_pk_bf16_f32 v90, v60, v61
v_cvt_pk_bf16_f32 v91, v62, v63
v_mfma_f32_16x16x32_bf16 a[4:7], v[8:11], v[84:87], a[4:7]
v_cvt_pk_bf16_f32 v92, v64, v65
v_cvt_pk_bf16_f32 v93, v66, v67
v_cvt_pk_bf16_f32 v94, v68, v69
v_cvt_pk_bf16_f32 v95, v70, v71
v_mfma_f32_16x16x32_bf16 a[8:11], v[8:11], v[88:91], a[8:11]
ds_read_b64_tr_b16 v[24:25], v2 offset:17408
ds_read_b64_tr_b16 v[26:27], v2 offset:25600
v_mfma_f32_16x16x32_bf16 a[12:15], v[8:11], v[92:95], a[12:15]
ds_read_b64_tr_b16 v[28:29], v3 offset:17408
ds_read_b64_tr_b16 v[30:31], v3 offset:25600
v_mfma_f32_16x16x32_bf16 a[16:19], v[12:15], v[80:83], a[16:19]
s_add_u32 m0, s63, 0
s_add_u32 s58, s55, 0
v_mfma_f32_16x16x32_bf16 a[20:23], v[12:15], v[84:87], a[20:23]
v_mfma_f32_16x16x32_bf16 a[24:27], v[12:15], v[88:91], a[24:27]
buffer_load_dwordx4 v6, s[16:19], s58 offen offset:0 sc1 lds
v_mfma_f32_16x16x32_bf16 a[28:31], v[12:15], v[92:95], a[28:31]
s_waitcnt lgkmcnt(4)
buffer_load_dwordx4 v6, s[16:19], s58 offen offset:1024 sc1 lds
v_mfma_f32_16x16x32_bf16 a[32:35], v[16:19], v[80:83], a[32:35]
ds_read_b64_tr_b16 v[8:9], v4 offset:17408
ds_read_b64_tr_b16 v[10:11], v4 offset:25600
v_mfma_f32_16x16x32_bf16 a[36:39], v[16:19], v[84:87], a[36:39]
buffer_load_dwordx4 v6, s[16:19], s58 offen offset:2048 sc1 lds
ds_read_b64_tr_b16 v[12:13], v5 offset:17408
v_mfma_f32_16x16x32_bf16 a[40:43], v[16:19], v[88:91], a[40:43]
ds_read_b64_tr_b16 v[14:15], v5 offset:25600
v_mfma_f32_16x16x32_bf16 a[44:47], v[16:19], v[92:95], a[44:47]
buffer_load_dwordx4 v6, s[16:19], s58 offen offset:3072 sc1 lds
s_add_u32 m0, s63, 4096
v_mfma_f32_16x16x32_bf16 a[48:51], v[20:23], v[80:83], a[48:51]
s_add_u32 s58, s55, 4096
v_mfma_f32_16x16x32_bf16 a[52:55], v[20:23], v[84:87], a[52:55]
buffer_load_dwordx4 v6, s[16:19], s58 offen offset:0 sc1 lds
v_mfma_f32_16x16x32_bf16 a[56:59], v[20:23], v[88:91], a[56:59]
v_mfma_f32_16x16x32_bf16 a[60:63], v[20:23], v[92:95], a[60:63]
s_waitcnt lgkmcnt(4)
buffer_load_dwordx4 v6, s[16:19], s58 offen offset:1024 sc1 lds
v_mfma_f32_16x16x32_bf16 a[64:67], v[24:27], v[80:83], a[64:67]
ds_read_b64_tr_b16 v[16:17], v2 offset:18432
ds_read_b64_tr_b16 v[18:19], v2 offset:26624
v_mfma_f32_16x16x32_bf16 a[68:71], v[24:27], v[84:87], a[68:71]
buffer_load_dwordx4 v6, s[16:19], s58 offen offset:2048 sc1 lds
ds_read_b64_tr_b16 v[20:21], v3 offset:18432
v_mfma_f32_16x16x32_bf16 a[72:75], v[24:27], v[88:91], a[72:75]
ds_read_b64_tr_b16 v[22:23], v3 offset:26624
s_add_u32 m0, s63, 28672
v_mfma_f32_16x16x32_bf16 a[76:79], v[24:27], v[92:95], a[76:79]
s_add_u32 s58, s55, 114688
buffer_load_dwordx4 v6, s[16:19], s58 offen offset:0 sc1 lds
v_mfma_f32_16x16x32_bf16 a[80:83], v[28:31], v[80:83], a[80:83]
v_mfma_f32_16x16x32_bf16 a[84:87], v[28:31], v[84:87], a[84:87]
buffer_load_dwordx4 v6, s[16:19], s58 offen offset:1024 sc1 lds
v_mfma_f32_16x16x32_bf16 a[88:91], v[28:31], v[88:91], a[88:91]
v_mfma_f32_16x16x32_bf16 a[92:95], v[28:31], v[92:95], a[92:95]
s_waitcnt lgkmcnt(4)
buffer_load_dwordx4 v6, s[16:19], s58 offen offset:2048 sc1 lds
v_mfma_f32_16x16x32_bf16 a[96:99], v[8:11], v[80:83], a[96:99]
ds_read_b64_tr_b16 v[24:25], v4 offset:18432
ds_read_b64_tr_b16 v[26:27], v4 offset:26624
v_mfma_f32_16x16x32_bf16 a[100:103], v[8:11], v[84:87], a[100:103]
buffer_load_dwordx4 v6, s[16:19], s58 offen offset:3072 sc1 lds
ds_read_b64_tr_b16 v[28:29], v5 offset:18432
v_mfma_f32_16x16x32_bf16 a[104:107], v[8:11], v[88:91], a[104:107]
ds_read_b64_tr_b16 v[30:31], v5 offset:26624
s_add_u32 m0, s63, 32768
v_mfma_f32_16x16x32_bf16 a[108:111], v[8:11], v[92:95], a[108:111]
s_add_u32 s58, s55, 118784
buffer_load_dwordx4 v6, s[16:19], s58 offen offset:0 sc1 lds
v_mfma_f32_16x16x32_bf16 a[112:115], v[12:15], v[80:83], a[112:115]
v_mfma_f32_16x16x32_bf16 a[116:119], v[12:15], v[84:87], a[116:119]
buffer_load_dwordx4 v6, s[16:19], s58 offen offset:1024 sc1 lds
v_mfma_f32_16x16x32_bf16 a[120:123], v[12:15], v[88:91], a[120:123]
v_mfma_f32_16x16x32_bf16 a[124:127], v[12:15], v[92:95], a[124:127]
s_waitcnt lgkmcnt(4)
buffer_load_dwordx4 v6, s[16:19], s58 offen offset:2048 sc1 lds
v_mfma_f32_16x16x32_bf16 a[128:131], v[16:19], v[80:83], a[128:131]
s_add_u32 m0, s63, 57344
s_add_u32 s58, s56, 0
v_mfma_f32_16x16x32_bf16 a[132:135], v[16:19], v[84:87], a[132:135]
ds_read_b64_tr_b16 v[8:9], v2 offset:19456
ds_read_b64_tr_b16 v[10:11], v2 offset:27648
v_mfma_f32_16x16x32_bf16 a[136:139], v[16:19], v[88:91], a[136:139]
buffer_load_dwordx4 v6, s[16:19], s58 offen offset:0 sc1 lds
ds_read_b64_tr_b16 v[12:13], v3 offset:19456
v_mfma_f32_16x16x32_bf16 a[140:143], v[16:19], v[92:95], a[140:143]
ds_read_b64_tr_b16 v[14:15], v3 offset:27648
buffer_load_dwordx4 v6, s[16:19], s58 offen offset:1024 sc1 lds
v_mfma_f32_16x16x32_bf16 a[144:147], v[20:23], v[80:83], a[144:147]
v_mfma_f32_16x16x32_bf16 a[148:151], v[20:23], v[84:87], a[148:151]
buffer_load_dwordx4 v6, s[16:19], s58 offen offset:2048 sc1 lds
v_mfma_f32_16x16x32_bf16 a[152:155], v[20:23], v[88:91], a[152:155]
v_mfma_f32_16x16x32_bf16 a[156:159], v[20:23], v[92:95], a[156:159]
s_waitcnt lgkmcnt(4)
buffer_load_dwordx4 v6, s[16:19], s58 offen offset:3072 sc1 lds
v_mfma_f32_16x16x32_bf16 a[160:163], v[24:27], v[80:83], a[160:163]
s_add_u32 m0, s63, 61440
s_add_u32 s58, s56, 4096
v_mfma_f32_16x16x32_bf16 a[164:167], v[24:27], v[84:87], a[164:167]
ds_read_b64_tr_b16 v[16:17], v4 offset:19456
ds_read_b64_tr_b16 v[18:19], v4 offset:27648
v_mfma_f32_16x16x32_bf16 a[168:171], v[24:27], v[88:91], a[168:171]
buffer_load_dwordx4 v6, s[16:19], s58 offen offset:0 sc1 lds
ds_read_b64_tr_b16 v[20:21], v5 offset:19456
v_mfma_f32_16x16x32_bf16 a[172:175], v[24:27], v[92:95], a[172:175]
ds_read_b64_tr_b16 v[22:23], v5 offset:27648
buffer_load_dwordx4 v6, s[16:19], s58 offen offset:1024 sc1 lds
v_mfma_f32_16x16x32_bf16 a[176:179], v[28:31], v[80:83], a[176:179]
v_mfma_f32_16x16x32_bf16 a[180:183], v[28:31], v[84:87], a[180:183]
buffer_load_dwordx4 v6, s[16:19], s58 offen offset:2048 sc1 lds
s_add_u32 m0, s63, 86016
v_mfma_f32_16x16x32_bf16 a[184:187], v[28:31], v[88:91], a[184:187]
s_add_u32 s58, s56, 114688
v_mfma_f32_16x16x32_bf16 a[188:191], v[28:31], v[92:95], a[188:191]
s_waitcnt lgkmcnt(4)
buffer_load_dwordx4 v6, s[16:19], s58 offen offset:0 sc1 lds
v_mfma_f32_16x16x32_bf16 a[192:195], v[8:11], v[80:83], a[192:195]
v_mfma_f32_16x16x32_bf16 a[196:199], v[8:11], v[84:87], a[196:199]
buffer_load_dwordx4 v6, s[16:19], s58 offen offset:1024 sc1 lds
v_mfma_f32_16x16x32_bf16 a[200:203], v[8:11], v[88:91], a[200:203]
v_mfma_f32_16x16x32_bf16 a[204:207], v[8:11], v[92:95], a[204:207]
buffer_load_dwordx4 v6, s[16:19], s58 offen offset:2048 sc1 lds
v_mfma_f32_16x16x32_bf16 a[208:211], v[12:15], v[80:83], a[208:211]
v_mfma_f32_16x16x32_bf16 a[212:215], v[12:15], v[84:87], a[212:215]
buffer_load_dwordx4 v6, s[16:19], s58 offen offset:3072 sc1 lds
s_add_u32 m0, s63, 90112
v_mfma_f32_16x16x32_bf16 a[216:219], v[12:15], v[88:91], a[216:219]
s_add_u32 s58, s56, 118784
v_mfma_f32_16x16x32_bf16 a[220:223], v[12:15], v[92:95], a[220:223]
s_waitcnt lgkmcnt(0)
buffer_load_dwordx4 v6, s[16:19], s58 offen offset:0 sc1 lds
v_mfma_f32_16x16x32_bf16 a[224:227], v[16:19], v[80:83], a[224:227]
v_mfma_f32_16x16x32_bf16 a[228:231], v[16:19], v[84:87], a[228:231]
buffer_load_dwordx4 v6, s[16:19], s58 offen offset:1024 sc1 lds
v_mfma_f32_16x16x32_bf16 a[232:235], v[16:19], v[88:91], a[232:235]
v_mfma_f32_16x16x32_bf16 a[236:239], v[16:19], v[92:95], a[236:239]
buffer_load_dwordx4 v6, s[16:19], s58 offen offset:2048 sc1 lds
v_mfma_f32_16x16x32_bf16 a[240:243], v[20:23], v[80:83], a[240:243]
v_mfma_f32_16x16x32_bf16 a[244:247], v[20:23], v[84:87], a[244:247]
v_mfma_f32_16x16x32_bf16 a[248:251], v[20:23], v[88:91], a[248:251]
v_mfma_f32_16x16x32_bf16 a[252:255], v[20:23], v[92:95], a[252:255]
s_nop 7
v_lshrrev_b32 v190, 4, v6
v_xor_b32 v191, 32, v190
v_xor_b32 v190, 16, v190
v_lshlrev_b32 v191, 2, v191
v_lshlrev_b32 v190, 2, v190
ds_bpermute_b32 v168, v190, v124
ds_bpermute_b32 v169, v190, v125
ds_bpermute_b32 v170, v190, v126
ds_bpermute_b32 v171, v190, v127
s_waitcnt lgkmcnt(0)
v_add_f32 v124, v124, v168
v_add_f32 v125, v125, v169
v_add_f32 v126, v126, v170
v_add_f32 v127, v127, v171
ds_bpermute_b32 v168, v191, v124
ds_bpermute_b32 v169, v191, v125
ds_bpermute_b32 v170, v191, v126
ds_bpermute_b32 v171, v191, v127
s_waitcnt lgkmcnt(0)
v_add_f32 v124, v124, v168
v_add_f32 v125, v125, v169
v_add_f32 v126, v126, v170
v_add_f32 v127, v127, v171
v_rcp_f32 v124, v124
v_rcp_f32 v125, v125
v_rcp_f32 v126, v126
v_rcp_f32 v127, v127
v_mov_b32 v176, v124
v_mov_b32 v177, v124
v_mov_b32 v178, v125
v_mov_b32 v179, v125
v_mov_b32 v180, v126
v_mov_b32 v181, v126
v_mov_b32 v182, v127
v_mov_b32 v183, v127
s_mul_i32 s65, s27, 40960
v_add_u32 v190, s65, v6
v_mov_b32 v0, v6
v_add_u32 v1, 8192, v6
v_add_u32 v2, 16384, v6
v_add_u32 v3, 24576, v6
v_add_u32 v4, 32768, v6
v_add_u32 v5, 32768, v6
v_add_u32 v7, 90112, v6
v_accvgpr_read_b32 v168, a0
v_accvgpr_read_b32 v169, a1
v_accvgpr_read_b32 v170, a2
v_accvgpr_read_b32 v171, a3
v_accvgpr_read_b32 v172, a16
v_accvgpr_read_b32 v173, a17
v_accvgpr_read_b32 v174, a18
v_accvgpr_read_b32 v175, a19
v_pk_mul_f32 v[168:169], v[168:169], v[176:177]
v_pk_mul_f32 v[170:171], v[170:171], v[176:177]
v_pk_mul_f32 v[172:173], v[172:173], v[176:177]
v_pk_mul_f32 v[174:175], v[174:175], v[176:177]
v_cvt_pk_bf16_f32 v8, v168, v169
v_cvt_pk_bf16_f32 v9, v170, v171
v_cvt_pk_bf16_f32 v10, v172, v173
v_cvt_pk_bf16_f32 v11, v174, v175
s_mov_b32 s66, 0
buffer_store_dwordx4 v[8:11], v190, s[20:23], s66 offen offset:0 sc0 sc1
v_accvgpr_read_b32 v168, a4
v_accvgpr_read_b32 v169, a5
v_accvgpr_read_b32 v170, a6
v_accvgpr_read_b32 v171, a7
v_accvgpr_read_b32 v172, a20
v_accvgpr_read_b32 v173, a21
v_accvgpr_read_b32 v174, a22
v_accvgpr_read_b32 v175, a23
v_pk_mul_f32 v[168:169], v[168:169], v[178:179]
v_pk_mul_f32 v[170:171], v[170:171], v[178:179]
v_pk_mul_f32 v[172:173], v[172:173], v[178:179]
v_pk_mul_f32 v[174:175], v[174:175], v[178:179]
v_cvt_pk_bf16_f32 v12, v168, v169
v_cvt_pk_bf16_f32 v13, v170, v171
v_cvt_pk_bf16_f32 v14, v172, v173
v_cvt_pk_bf16_f32 v15, v174, v175
s_mov_b32 s66, 8192
buffer_store_dwordx4 v[12:15], v190, s[20:23], s66 offen offset:0 sc0 sc1
v_accvgpr_read_b32 v168, a8
v_accvgpr_read_b32 v169, a9
v_accvgpr_read_b32 v170, a10
v_accvgpr_read_b32 v171, a11
v_accvgpr_read_b32 v172, a24
v_accvgpr_read_b32 v173, a25
v_accvgpr_read_b32 v174, a26
v_accvgpr_read_b32 v175, a27
v_pk_mul_f32 v[168:169], v[168:169], v[180:181]
v_pk_mul_f32 v[170:171], v[170:171], v[180:181]
v_pk_mul_f32 v[172:173], v[172:173], v[180:181]
v_pk_mul_f32 v[174:175], v[174:175], v[180:181]
v_cvt_pk_bf16_f32 v16, v168, v169
v_cvt_pk_bf16_f32 v17, v170, v171
v_cvt_pk_bf16_f32 v18, v172, v173
v_cvt_pk_bf16_f32 v19, v174, v175
s_mov_b32 s66, 16384
buffer_store_dwordx4 v[16:19], v190, s[20:23], s66 offen offset:0 sc0 sc1
v_accvgpr_read_b32 v168, a12
v_accvgpr_read_b32 v169, a13
v_accvgpr_read_b32 v170, a14
v_accvgpr_read_b32 v171, a15
v_accvgpr_read_b32 v172, a28
v_accvgpr_read_b32 v173, a29
v_accvgpr_read_b32 v174, a30
v_accvgpr_read_b32 v175, a31
v_pk_mul_f32 v[168:169], v[168:169], v[182:183]
v_pk_mul_f32 v[170:171], v[170:171], v[182:183]
v_pk_mul_f32 v[172:173], v[172:173], v[182:183]
v_pk_mul_f32 v[174:175], v[174:175], v[182:183]
v_cvt_pk_bf16_f32 v20, v168, v169
v_cvt_pk_bf16_f32 v21, v170, v171
v_cvt_pk_bf16_f32 v22, v172, v173
v_cvt_pk_bf16_f32 v23, v174, v175
s_mov_b32 s66, 24576
buffer_store_dwordx4 v[20:23], v190, s[20:23], s66 offen offset:0 sc0 sc1
v_accvgpr_read_b32 v168, a32
v_accvgpr_read_b32 v169, a33
v_accvgpr_read_b32 v170, a34
v_accvgpr_read_b32 v171, a35
v_accvgpr_read_b32 v172, a48
v_accvgpr_read_b32 v173, a49
v_accvgpr_read_b32 v174, a50
v_accvgpr_read_b32 v175, a51
v_pk_mul_f32 v[168:169], v[168:169], v[176:177]
v_pk_mul_f32 v[170:171], v[170:171], v[176:177]
v_pk_mul_f32 v[172:173], v[172:173], v[176:177]
v_pk_mul_f32 v[174:175], v[174:175], v[176:177]
v_cvt_pk_bf16_f32 v24, v168, v169
v_cvt_pk_bf16_f32 v25, v170, v171
v_cvt_pk_bf16_f32 v26, v172, v173
v_cvt_pk_bf16_f32 v27, v174, v175
s_mov_b32 s66, 0
buffer_store_dwordx4 v[24:27], v190, s[20:23], s66 offen offset:1024 sc0 sc1
v_accvgpr_read_b32 v168, a36
v_accvgpr_read_b32 v169, a37
v_accvgpr_read_b32 v170, a38
v_accvgpr_read_b32 v171, a39
v_accvgpr_read_b32 v172, a52
v_accvgpr_read_b32 v173, a53
v_accvgpr_read_b32 v174, a54
v_accvgpr_read_b32 v175, a55
v_pk_mul_f32 v[168:169], v[168:169], v[178:179]
v_pk_mul_f32 v[170:171], v[170:171], v[178:179]
v_pk_mul_f32 v[172:173], v[172:173], v[178:179]
v_pk_mul_f32 v[174:175], v[174:175], v[178:179]
v_cvt_pk_bf16_f32 v28, v168, v169
v_cvt_pk_bf16_f32 v29, v170, v171
v_cvt_pk_bf16_f32 v30, v172, v173
v_cvt_pk_bf16_f32 v31, v174, v175
s_mov_b32 s66, 8192
buffer_store_dwordx4 v[28:31], v190, s[20:23], s66 offen offset:1024 sc0 sc1
v_accvgpr_read_b32 v168, a40
v_accvgpr_read_b32 v169, a41
v_accvgpr_read_b32 v170, a42
v_accvgpr_read_b32 v171, a43
v_accvgpr_read_b32 v172, a56
v_accvgpr_read_b32 v173, a57
v_accvgpr_read_b32 v174, a58
v_accvgpr_read_b32 v175, a59
v_pk_mul_f32 v[168:169], v[168:169], v[180:181]
v_pk_mul_f32 v[170:171], v[170:171], v[180:181]
v_pk_mul_f32 v[172:173], v[172:173], v[180:181]
v_pk_mul_f32 v[174:175], v[174:175], v[180:181]
v_cvt_pk_bf16_f32 v32, v168, v169
v_cvt_pk_bf16_f32 v33, v170, v171
v_cvt_pk_bf16_f32 v34, v172, v173
v_cvt_pk_bf16_f32 v35, v174, v175
s_mov_b32 s66, 16384
buffer_store_dwordx4 v[32:35], v190, s[20:23], s66 offen offset:1024 sc0 sc1
v_accvgpr_read_b32 v168, a44
v_accvgpr_read_b32 v169, a45
v_accvgpr_read_b32 v170, a46
v_accvgpr_read_b32 v171, a47
v_accvgpr_read_b32 v172, a60
v_accvgpr_read_b32 v173, a61
v_accvgpr_read_b32 v174, a62
v_accvgpr_read_b32 v175, a63
v_pk_mul_f32 v[168:169], v[168:169], v[182:183]
v_pk_mul_f32 v[170:171], v[170:171], v[182:183]
v_pk_mul_f32 v[172:173], v[172:173], v[182:183]
v_pk_mul_f32 v[174:175], v[174:175], v[182:183]
v_cvt_pk_bf16_f32 v36, v168, v169
v_cvt_pk_bf16_f32 v37, v170, v171
v_cvt_pk_bf16_f32 v38, v172, v173
v_cvt_pk_bf16_f32 v39, v174, v175
s_mov_b32 s66, 24576
buffer_store_dwordx4 v[36:39], v190, s[20:23], s66 offen offset:1024 sc0 sc1
v_accvgpr_read_b32 v168, a64
v_accvgpr_read_b32 v169, a65
v_accvgpr_read_b32 v170, a66
v_accvgpr_read_b32 v171, a67
v_accvgpr_read_b32 v172, a80
v_accvgpr_read_b32 v173, a81
v_accvgpr_read_b32 v174, a82
v_accvgpr_read_b32 v175, a83
v_pk_mul_f32 v[168:169], v[168:169], v[176:177]
v_pk_mul_f32 v[170:171], v[170:171], v[176:177]
v_pk_mul_f32 v[172:173], v[172:173], v[176:177]
v_pk_mul_f32 v[174:175], v[174:175], v[176:177]
v_cvt_pk_bf16_f32 v40, v168, v169
v_cvt_pk_bf16_f32 v41, v170, v171
v_cvt_pk_bf16_f32 v42, v172, v173
v_cvt_pk_bf16_f32 v43, v174, v175
s_mov_b32 s66, 0
buffer_store_dwordx4 v[40:43], v190, s[20:23], s66 offen offset:2048 sc0 sc1
v_accvgpr_read_b32 v168, a68
v_accvgpr_read_b32 v169, a69
v_accvgpr_read_b32 v170, a70
v_accvgpr_read_b32 v171, a71
v_accvgpr_read_b32 v172, a84
v_accvgpr_read_b32 v173, a85
v_accvgpr_read_b32 v174, a86
v_accvgpr_read_b32 v175, a87
v_pk_mul_f32 v[168:169], v[168:169], v[178:179]
v_pk_mul_f32 v[170:171], v[170:171], v[178:179]
v_pk_mul_f32 v[172:173], v[172:173], v[178:179]
v_pk_mul_f32 v[174:175], v[174:175], v[178:179]
v_cvt_pk_bf16_f32 v44, v168, v169
v_cvt_pk_bf16_f32 v45, v170, v171
v_cvt_pk_bf16_f32 v46, v172, v173
v_cvt_pk_bf16_f32 v47, v174, v175
s_mov_b32 s66, 8192
buffer_store_dwordx4 v[44:47], v190, s[20:23], s66 offen offset:2048 sc0 sc1
v_accvgpr_read_b32 v168, a72
v_accvgpr_read_b32 v169, a73
v_accvgpr_read_b32 v170, a74
v_accvgpr_read_b32 v171, a75
v_accvgpr_read_b32 v172, a88
v_accvgpr_read_b32 v173, a89
v_accvgpr_read_b32 v174, a90
v_accvgpr_read_b32 v175, a91
v_pk_mul_f32 v[168:169], v[168:169], v[180:181]
v_pk_mul_f32 v[170:171], v[170:171], v[180:181]
v_pk_mul_f32 v[172:173], v[172:173], v[180:181]
v_pk_mul_f32 v[174:175], v[174:175], v[180:181]
v_cvt_pk_bf16_f32 v48, v168, v169
v_cvt_pk_bf16_f32 v49, v170, v171
v_cvt_pk_bf16_f32 v50, v172, v173
v_cvt_pk_bf16_f32 v51, v174, v175
s_mov_b32 s66, 16384
buffer_store_dwordx4 v[48:51], v190, s[20:23], s66 offen offset:2048 sc0 sc1
v_accvgpr_read_b32 v168, a76
v_accvgpr_read_b32 v169, a77
v_accvgpr_read_b32 v170, a78
v_accvgpr_read_b32 v171, a79
v_accvgpr_read_b32 v172, a92
v_accvgpr_read_b32 v173, a93
v_accvgpr_read_b32 v174, a94
v_accvgpr_read_b32 v175, a95
v_pk_mul_f32 v[168:169], v[168:169], v[182:183]
v_pk_mul_f32 v[170:171], v[170:171], v[182:183]
v_pk_mul_f32 v[172:173], v[172:173], v[182:183]
v_pk_mul_f32 v[174:175], v[174:175], v[182:183]
v_cvt_pk_bf16_f32 v52, v168, v169
v_cvt_pk_bf16_f32 v53, v170, v171
v_cvt_pk_bf16_f32 v54, v172, v173
v_cvt_pk_bf16_f32 v55, v174, v175
s_mov_b32 s66, 24576
buffer_store_dwordx4 v[52:55], v190, s[20:23], s66 offen offset:2048 sc0 sc1
v_accvgpr_read_b32 v168, a96
v_accvgpr_read_b32 v169, a97
v_accvgpr_read_b32 v170, a98
v_accvgpr_read_b32 v171, a99
v_accvgpr_read_b32 v172, a112
v_accvgpr_read_b32 v173, a113
v_accvgpr_read_b32 v174, a114
v_accvgpr_read_b32 v175, a115
v_pk_mul_f32 v[168:169], v[168:169], v[176:177]
v_pk_mul_f32 v[170:171], v[170:171], v[176:177]
v_pk_mul_f32 v[172:173], v[172:173], v[176:177]
v_pk_mul_f32 v[174:175], v[174:175], v[176:177]
v_cvt_pk_bf16_f32 v56, v168, v169
v_cvt_pk_bf16_f32 v57, v170, v171
v_cvt_pk_bf16_f32 v58, v172, v173
v_cvt_pk_bf16_f32 v59, v174, v175
s_mov_b32 s66, 0
buffer_store_dwordx4 v[56:59], v190, s[20:23], s66 offen offset:3072 sc0 sc1
v_accvgpr_read_b32 v168, a100
v_accvgpr_read_b32 v169, a101
v_accvgpr_read_b32 v170, a102
v_accvgpr_read_b32 v171, a103
v_accvgpr_read_b32 v172, a116
v_accvgpr_read_b32 v173, a117
v_accvgpr_read_b32 v174, a118
v_accvgpr_read_b32 v175, a119
v_pk_mul_f32 v[168:169], v[168:169], v[178:179]
v_pk_mul_f32 v[170:171], v[170:171], v[178:179]
v_pk_mul_f32 v[172:173], v[172:173], v[178:179]
v_pk_mul_f32 v[174:175], v[174:175], v[178:179]
v_cvt_pk_bf16_f32 v60, v168, v169
v_cvt_pk_bf16_f32 v61, v170, v171
v_cvt_pk_bf16_f32 v62, v172, v173
v_cvt_pk_bf16_f32 v63, v174, v175
s_mov_b32 s66, 8192
buffer_store_dwordx4 v[60:63], v190, s[20:23], s66 offen offset:3072 sc0 sc1
v_accvgpr_read_b32 v168, a104
v_accvgpr_read_b32 v169, a105
v_accvgpr_read_b32 v170, a106
v_accvgpr_read_b32 v171, a107
v_accvgpr_read_b32 v172, a120
v_accvgpr_read_b32 v173, a121
v_accvgpr_read_b32 v174, a122
v_accvgpr_read_b32 v175, a123
v_pk_mul_f32 v[168:169], v[168:169], v[180:181]
v_pk_mul_f32 v[170:171], v[170:171], v[180:181]
v_pk_mul_f32 v[172:173], v[172:173], v[180:181]
v_pk_mul_f32 v[174:175], v[174:175], v[180:181]
v_cvt_pk_bf16_f32 v64, v168, v169
v_cvt_pk_bf16_f32 v65, v170, v171
v_cvt_pk_bf16_f32 v66, v172, v173
v_cvt_pk_bf16_f32 v67, v174, v175
s_mov_b32 s66, 16384
buffer_store_dwordx4 v[64:67], v190, s[20:23], s66 offen offset:3072 sc0 sc1
v_accvgpr_read_b32 v168, a108
v_accvgpr_read_b32 v169, a109
v_accvgpr_read_b32 v170, a110
v_accvgpr_read_b32 v171, a111
v_accvgpr_read_b32 v172, a124
v_accvgpr_read_b32 v173, a125
v_accvgpr_read_b32 v174, a126
v_accvgpr_read_b32 v175, a127
v_pk_mul_f32 v[168:169], v[168:169], v[182:183]
v_pk_mul_f32 v[170:171], v[170:171], v[182:183]
v_pk_mul_f32 v[172:173], v[172:173], v[182:183]
v_pk_mul_f32 v[174:175], v[174:175], v[182:183]
v_cvt_pk_bf16_f32 v68, v168, v169
v_cvt_pk_bf16_f32 v69, v170, v171
v_cvt_pk_bf16_f32 v70, v172, v173
v_cvt_pk_bf16_f32 v71, v174, v175
s_mov_b32 s66, 24576
buffer_store_dwordx4 v[68:71], v190, s[20:23], s66 offen offset:3072 sc0 sc1
s_waitcnt vmcnt(16)
v_accvgpr_read_b32 v168, a128
v_accvgpr_read_b32 v169, a129
v_accvgpr_read_b32 v170, a130
v_accvgpr_read_b32 v171, a131
v_accvgpr_read_b32 v172, a144
v_accvgpr_read_b32 v173, a145
v_accvgpr_read_b32 v174, a146
v_accvgpr_read_b32 v175, a147
v_pk_mul_f32 v[168:169], v[168:169], v[176:177]
v_pk_mul_f32 v[170:171], v[170:171], v[176:177]
v_pk_mul_f32 v[172:173], v[172:173], v[176:177]
v_pk_mul_f32 v[174:175], v[174:175], v[176:177]
v_cvt_pk_bf16_f32 v72, v168, v169
v_cvt_pk_bf16_f32 v73, v170, v171
v_cvt_pk_bf16_f32 v74, v172, v173
v_cvt_pk_bf16_f32 v75, v174, v175
s_mov_b32 s66, 4096
buffer_store_dwordx4 v[72:75], v190, s[20:23], s66 offen offset:0 sc0 sc1
v_accvgpr_read_b32 v168, a132
v_accvgpr_read_b32 v169, a133
v_accvgpr_read_b32 v170, a134
v_accvgpr_read_b32 v171, a135
v_accvgpr_read_b32 v172, a148
v_accvgpr_read_b32 v173, a149
v_accvgpr_read_b32 v174, a150
v_accvgpr_read_b32 v175, a151
v_pk_mul_f32 v[168:169], v[168:169], v[178:179]
v_pk_mul_f32 v[170:171], v[170:171], v[178:179]
v_pk_mul_f32 v[172:173], v[172:173], v[178:179]
v_pk_mul_f32 v[174:175], v[174:175], v[178:179]
v_cvt_pk_bf16_f32 v76, v168, v169
v_cvt_pk_bf16_f32 v77, v170, v171
v_cvt_pk_bf16_f32 v78, v172, v173
v_cvt_pk_bf16_f32 v79, v174, v175
s_mov_b32 s66, 12288
buffer_store_dwordx4 v[76:79], v190, s[20:23], s66 offen offset:0 sc0 sc1
v_accvgpr_read_b32 v168, a136
v_accvgpr_read_b32 v169, a137
v_accvgpr_read_b32 v170, a138
v_accvgpr_read_b32 v171, a139
v_accvgpr_read_b32 v172, a152
v_accvgpr_read_b32 v173, a153
v_accvgpr_read_b32 v174, a154
v_accvgpr_read_b32 v175, a155
v_pk_mul_f32 v[168:169], v[168:169], v[180:181]
v_pk_mul_f32 v[170:171], v[170:171], v[180:181]
v_pk_mul_f32 v[172:173], v[172:173], v[180:181]
v_pk_mul_f32 v[174:175], v[174:175], v[180:181]
v_cvt_pk_bf16_f32 v80, v168, v169
v_cvt_pk_bf16_f32 v81, v170, v171
v_cvt_pk_bf16_f32 v82, v172, v173
v_cvt_pk_bf16_f32 v83, v174, v175
s_mov_b32 s66, 20480
buffer_store_dwordx4 v[80:83], v190, s[20:23], s66 offen offset:0 sc0 sc1
v_accvgpr_read_b32 v168, a140
v_accvgpr_read_b32 v169, a141
v_accvgpr_read_b32 v170, a142
v_accvgpr_read_b32 v171, a143
v_accvgpr_read_b32 v172, a156
v_accvgpr_read_b32 v173, a157
v_accvgpr_read_b32 v174, a158
v_accvgpr_read_b32 v175, a159
v_pk_mul_f32 v[168:169], v[168:169], v[182:183]
v_pk_mul_f32 v[170:171], v[170:171], v[182:183]
v_pk_mul_f32 v[172:173], v[172:173], v[182:183]
v_pk_mul_f32 v[174:175], v[174:175], v[182:183]
v_cvt_pk_bf16_f32 v84, v168, v169
v_cvt_pk_bf16_f32 v85, v170, v171
v_cvt_pk_bf16_f32 v86, v172, v173
v_cvt_pk_bf16_f32 v87, v174, v175
s_mov_b32 s66, 28672
buffer_store_dwordx4 v[84:87], v190, s[20:23], s66 offen offset:0 sc0 sc1
v_accvgpr_read_b32 v168, a160
v_accvgpr_read_b32 v169, a161
v_accvgpr_read_b32 v170, a162
v_accvgpr_read_b32 v171, a163
v_accvgpr_read_b32 v172, a176
v_accvgpr_read_b32 v173, a177
v_accvgpr_read_b32 v174, a178
v_accvgpr_read_b32 v175, a179
v_pk_mul_f32 v[168:169], v[168:169], v[176:177]
v_pk_mul_f32 v[170:171], v[170:171], v[176:177]
v_pk_mul_f32 v[172:173], v[172:173], v[176:177]
v_pk_mul_f32 v[174:175], v[174:175], v[176:177]
v_cvt_pk_bf16_f32 v88, v168, v169
v_cvt_pk_bf16_f32 v89, v170, v171
v_cvt_pk_bf16_f32 v90, v172, v173
v_cvt_pk_bf16_f32 v91, v174, v175
s_mov_b32 s66, 4096
buffer_store_dwordx4 v[88:91], v190, s[20:23], s66 offen offset:1024 sc0 sc1
v_accvgpr_read_b32 v168, a164
v_accvgpr_read_b32 v169, a165
v_accvgpr_read_b32 v170, a166
v_accvgpr_read_b32 v171, a167
v_accvgpr_read_b32 v172, a180
v_accvgpr_read_b32 v173, a181
v_accvgpr_read_b32 v174, a182
v_accvgpr_read_b32 v175, a183
v_pk_mul_f32 v[168:169], v[168:169], v[178:179]
v_pk_mul_f32 v[170:171], v[170:171], v[178:179]
v_pk_mul_f32 v[172:173], v[172:173], v[178:179]
v_pk_mul_f32 v[174:175], v[174:175], v[178:179]
v_cvt_pk_bf16_f32 v92, v168, v169
v_cvt_pk_bf16_f32 v93, v170, v171
v_cvt_pk_bf16_f32 v94, v172, v173
v_cvt_pk_bf16_f32 v95, v174, v175
s_mov_b32 s66, 12288
buffer_store_dwordx4 v[92:95], v190, s[20:23], s66 offen offset:1024 sc0 sc1
v_accvgpr_read_b32 v168, a168
v_accvgpr_read_b32 v169, a169
v_accvgpr_read_b32 v170, a170
v_accvgpr_read_b32 v171, a171
v_accvgpr_read_b32 v172, a184
v_accvgpr_read_b32 v173, a185
v_accvgpr_read_b32 v174, a186
v_accvgpr_read_b32 v175, a187
v_pk_mul_f32 v[168:169], v[168:169], v[180:181]
v_pk_mul_f32 v[170:171], v[170:171], v[180:181]
v_pk_mul_f32 v[172:173], v[172:173], v[180:181]
v_pk_mul_f32 v[174:175], v[174:175], v[180:181]
v_cvt_pk_bf16_f32 v96, v168, v169
v_cvt_pk_bf16_f32 v97, v170, v171
v_cvt_pk_bf16_f32 v98, v172, v173
v_cvt_pk_bf16_f32 v99, v174, v175
s_mov_b32 s66, 20480
buffer_store_dwordx4 v[96:99], v190, s[20:23], s66 offen offset:1024 sc0 sc1
v_accvgpr_read_b32 v168, a172
v_accvgpr_read_b32 v169, a173
v_accvgpr_read_b32 v170, a174
v_accvgpr_read_b32 v171, a175
v_accvgpr_read_b32 v172, a188
v_accvgpr_read_b32 v173, a189
v_accvgpr_read_b32 v174, a190
v_accvgpr_read_b32 v175, a191
v_pk_mul_f32 v[168:169], v[168:169], v[182:183]
v_pk_mul_f32 v[170:171], v[170:171], v[182:183]
v_pk_mul_f32 v[172:173], v[172:173], v[182:183]
v_pk_mul_f32 v[174:175], v[174:175], v[182:183]
v_cvt_pk_bf16_f32 v100, v168, v169
v_cvt_pk_bf16_f32 v101, v170, v171
v_cvt_pk_bf16_f32 v102, v172, v173
v_cvt_pk_bf16_f32 v103, v174, v175
s_mov_b32 s66, 28672
buffer_store_dwordx4 v[100:103], v190, s[20:23], s66 offen offset:1024 sc0 sc1
v_accvgpr_read_b32 v168, a192
v_accvgpr_read_b32 v169, a193
v_accvgpr_read_b32 v170, a194
v_accvgpr_read_b32 v171, a195
v_accvgpr_read_b32 v172, a208
v_accvgpr_read_b32 v173, a209
v_accvgpr_read_b32 v174, a210
v_accvgpr_read_b32 v175, a211
v_pk_mul_f32 v[168:169], v[168:169], v[176:177]
v_pk_mul_f32 v[170:171], v[170:171], v[176:177]
v_pk_mul_f32 v[172:173], v[172:173], v[176:177]
v_pk_mul_f32 v[174:175], v[174:175], v[176:177]
v_cvt_pk_bf16_f32 v104, v168, v169
v_cvt_pk_bf16_f32 v105, v170, v171
v_cvt_pk_bf16_f32 v106, v172, v173
v_cvt_pk_bf16_f32 v107, v174, v175
s_mov_b32 s66, 4096
buffer_store_dwordx4 v[104:107], v190, s[20:23], s66 offen offset:2048 sc0 sc1
v_accvgpr_read_b32 v168, a196
v_accvgpr_read_b32 v169, a197
v_accvgpr_read_b32 v170, a198
v_accvgpr_read_b32 v171, a199
v_accvgpr_read_b32 v172, a212
v_accvgpr_read_b32 v173, a213
v_accvgpr_read_b32 v174, a214
v_accvgpr_read_b32 v175, a215
v_pk_mul_f32 v[168:169], v[168:169], v[178:179]
v_pk_mul_f32 v[170:171], v[170:171], v[178:179]
v_pk_mul_f32 v[172:173], v[172:173], v[178:179]
v_pk_mul_f32 v[174:175], v[174:175], v[178:179]
v_cvt_pk_bf16_f32 v108, v168, v169
v_cvt_pk_bf16_f32 v109, v170, v171
v_cvt_pk_bf16_f32 v110, v172, v173
v_cvt_pk_bf16_f32 v111, v174, v175
s_mov_b32 s66, 12288
buffer_store_dwordx4 v[108:111], v190, s[20:23], s66 offen offset:2048 sc0 sc1
v_accvgpr_read_b32 v168, a200
v_accvgpr_read_b32 v169, a201
v_accvgpr_read_b32 v170, a202
v_accvgpr_read_b32 v171, a203
v_accvgpr_read_b32 v172, a216
v_accvgpr_read_b32 v173, a217
v_accvgpr_read_b32 v174, a218
v_accvgpr_read_b32 v175, a219
v_pk_mul_f32 v[168:169], v[168:169], v[180:181]
v_pk_mul_f32 v[170:171], v[170:171], v[180:181]
v_pk_mul_f32 v[172:173], v[172:173], v[180:181]
v_pk_mul_f32 v[174:175], v[174:175], v[180:181]
v_cvt_pk_bf16_f32 v112, v168, v169
v_cvt_pk_bf16_f32 v113, v170, v171
v_cvt_pk_bf16_f32 v114, v172, v173
v_cvt_pk_bf16_f32 v115, v174, v175
s_mov_b32 s66, 20480
buffer_store_dwordx4 v[112:115], v190, s[20:23], s66 offen offset:2048 sc0 sc1
v_accvgpr_read_b32 v168, a204
v_accvgpr_read_b32 v169, a205
v_accvgpr_read_b32 v170, a206
v_accvgpr_read_b32 v171, a207
v_accvgpr_read_b32 v172, a220
v_accvgpr_read_b32 v173, a221
v_accvgpr_read_b32 v174, a222
v_accvgpr_read_b32 v175, a223
v_pk_mul_f32 v[168:169], v[168:169], v[182:183]
v_pk_mul_f32 v[170:171], v[170:171], v[182:183]
v_pk_mul_f32 v[172:173], v[172:173], v[182:183]
v_pk_mul_f32 v[174:175], v[174:175], v[182:183]
v_cvt_pk_bf16_f32 v116, v168, v169
v_cvt_pk_bf16_f32 v117, v170, v171
v_cvt_pk_bf16_f32 v118, v172, v173
v_cvt_pk_bf16_f32 v119, v174, v175
s_mov_b32 s66, 28672
buffer_store_dwordx4 v[116:119], v190, s[20:23], s66 offen offset:2048 sc0 sc1
v_accvgpr_read_b32 v168, a224
v_accvgpr_read_b32 v169, a225
v_accvgpr_read_b32 v170, a226
v_accvgpr_read_b32 v171, a227
v_accvgpr_read_b32 v172, a240
v_accvgpr_read_b32 v173, a241
v_accvgpr_read_b32 v174, a242
v_accvgpr_read_b32 v175, a243
v_pk_mul_f32 v[168:169], v[168:169], v[176:177]
v_pk_mul_f32 v[170:171], v[170:171], v[176:177]
v_pk_mul_f32 v[172:173], v[172:173], v[176:177]
v_pk_mul_f32 v[174:175], v[174:175], v[176:177]
v_cvt_pk_bf16_f32 v120, v168, v169
v_cvt_pk_bf16_f32 v121, v170, v171
v_cvt_pk_bf16_f32 v122, v172, v173
v_cvt_pk_bf16_f32 v123, v174, v175
s_mov_b32 s66, 4096
buffer_store_dwordx4 v[120:123], v190, s[20:23], s66 offen offset:3072 sc0 sc1
v_accvgpr_read_b32 v168, a228
v_accvgpr_read_b32 v169, a229
v_accvgpr_read_b32 v170, a230
v_accvgpr_read_b32 v171, a231
v_accvgpr_read_b32 v172, a244
v_accvgpr_read_b32 v173, a245
v_accvgpr_read_b32 v174, a246
v_accvgpr_read_b32 v175, a247
v_pk_mul_f32 v[168:169], v[168:169], v[178:179]
v_pk_mul_f32 v[170:171], v[170:171], v[178:179]
v_pk_mul_f32 v[172:173], v[172:173], v[178:179]
v_pk_mul_f32 v[174:175], v[174:175], v[178:179]
v_cvt_pk_bf16_f32 v124, v168, v169
v_cvt_pk_bf16_f32 v125, v170, v171
v_cvt_pk_bf16_f32 v126, v172, v173
v_cvt_pk_bf16_f32 v127, v174, v175
s_mov_b32 s66, 12288
buffer_store_dwordx4 v[124:127], v190, s[20:23], s66 offen offset:3072 sc0 sc1
v_accvgpr_read_b32 v168, a232
v_accvgpr_read_b32 v169, a233
v_accvgpr_read_b32 v170, a234
v_accvgpr_read_b32 v171, a235
v_accvgpr_read_b32 v172, a248
v_accvgpr_read_b32 v173, a249
v_accvgpr_read_b32 v174, a250
v_accvgpr_read_b32 v175, a251
v_pk_mul_f32 v[168:169], v[168:169], v[180:181]
v_pk_mul_f32 v[170:171], v[170:171], v[180:181]
v_pk_mul_f32 v[172:173], v[172:173], v[180:181]
v_pk_mul_f32 v[174:175], v[174:175], v[180:181]
v_cvt_pk_bf16_f32 v128, v168, v169
v_cvt_pk_bf16_f32 v129, v170, v171
v_cvt_pk_bf16_f32 v130, v172, v173
v_cvt_pk_bf16_f32 v131, v174, v175
s_mov_b32 s66, 20480
buffer_store_dwordx4 v[128:131], v190, s[20:23], s66 offen offset:3072 sc0 sc1
v_accvgpr_read_b32 v168, a236
v_accvgpr_read_b32 v169, a237
v_accvgpr_read_b32 v170, a238
v_accvgpr_read_b32 v171, a239
v_accvgpr_read_b32 v172, a252
v_accvgpr_read_b32 v173, a253
v_accvgpr_read_b32 v174, a254
v_accvgpr_read_b32 v175, a255
v_pk_mul_f32 v[168:169], v[168:169], v[182:183]
v_pk_mul_f32 v[170:171], v[170:171], v[182:183]
v_pk_mul_f32 v[172:173], v[172:173], v[182:183]
v_pk_mul_f32 v[174:175], v[174:175], v[182:183]
v_cvt_pk_bf16_f32 v132, v168, v169
v_cvt_pk_bf16_f32 v133, v170, v171
v_cvt_pk_bf16_f32 v134, v172, v173
v_cvt_pk_bf16_f32 v135, v174, v175
s_mov_b32 s66, 28672
buffer_store_dwordx4 v[132:135], v190, s[20:23], s66 offen offset:3072 sc0 sc1
s_waitcnt vmcnt(0)
v_mov_b32 v186, 0
v_mov_b32 v187, 1
s_mov_b64 exec, 1
global_atomic_add v186, v187, s[42:43]
s_mov_b64 exec, -1
s_barrier
ds_read_b128 a[140:143], v5 offset:0
ds_read_b128 a[144:147], v5 offset:1024
ds_read_b128 a[148:151], v5 offset:2048
ds_read_b128 a[152:155], v5 offset:3072
ds_read_b128 a[156:159], v5 offset:4096
ds_read_b128 a[160:163], v5 offset:5120
ds_read_b128 a[164:167], v5 offset:6144
s_waitcnt lgkmcnt(0)
v_mfma_f32_16x16x32_bf16 a[0:3], a[140:143], v[8:11], 0
v_mfma_f32_16x16x32_bf16 a[28:31], a[140:143], v[12:15], 0
ds_read_b128 a[168:171], v5 offset:7168
v_mfma_f32_16x16x32_bf16 a[56:59], a[140:143], v[16:19], 0
v_mfma_f32_16x16x32_bf16 a[84:87], a[140:143], v[20:23], 0
ds_read_b128 a[172:175], v5 offset:8192
v_mfma_f32_16x16x32_bf16 a[4:7], a[144:147], v[8:11], 0
v_mfma_f32_16x16x32_bf16 a[32:35], a[144:147], v[12:15], 0
v_mfma_f32_16x16x32_bf16 a[60:63], a[144:147], v[16:19], 0
ds_read_b128 a[176:179], v5 offset:9216
v_mfma_f32_16x16x32_bf16 a[88:91], a[144:147], v[20:23], 0
v_mfma_f32_16x16x32_bf16 a[8:11], a[148:151], v[8:11], 0
ds_read_b128 a[180:183], v5 offset:10240
v_mfma_f32_16x16x32_bf16 a[36:39], a[148:151], v[12:15], 0
v_mfma_f32_16x16x32_bf16 a[64:67], a[148:151], v[16:19], 0
v_mfma_f32_16x16x32_bf16 a[92:95], a[148:151], v[20:23], 0
ds_read_b128 a[184:187], v5 offset:11264
v_mfma_f32_16x16x32_bf16 a[12:15], a[152:155], v[8:11], 0
v_mfma_f32_16x16x32_bf16 a[40:43], a[152:155], v[12:15], 0
ds_read_b128 a[188:191], v5 offset:12288
v_mfma_f32_16x16x32_bf16 a[68:71], a[152:155], v[16:19], 0
v_mfma_f32_16x16x32_bf16 a[96:99], a[152:155], v[20:23], 0
v_mfma_f32_16x16x32_bf16 a[16:19], a[156:159], v[8:11], 0
ds_read_b128 a[192:195], v5 offset:13312
v_mfma_f32_16x16x32_bf16 a[44:47], a[156:159], v[12:15], 0
v_mfma_f32_16x16x32_bf16 a[72:75], a[156:159], v[16:19], 0
v_mfma_f32_16x16x32_bf16 a[100:103], a[156:159], v[20:23], 0
v_mfma_f32_16x16x32_bf16 a[20:23], a[160:163], v[8:11], 0
v_mfma_f32_16x16x32_bf16 a[48:51], a[160:163], v[12:15], 0
v_mfma_f32_16x16x32_bf16 a[76:79], a[160:163], v[16:19], 0
v_mfma_f32_16x16x32_bf16 a[104:107], a[160:163], v[20:23], 0
v_mfma_f32_16x16x32_bf16 a[24:27], a[164:167], v[8:11], 0
v_mfma_f32_16x16x32_bf16 a[52:55], a[164:167], v[12:15], 0
v_mfma_f32_16x16x32_bf16 a[80:83], a[164:167], v[16:19], 0
v_mfma_f32_16x16x32_bf16 a[108:111], a[164:167], v[20:23], 0
s_waitcnt lgkmcnt(0)
v_mfma_f32_16x16x32_bf16 a[0:3], a[168:171], v[24:27], a[0:3]
v_mfma_f32_16x16x32_bf16 a[28:31], a[168:171], v[28:31], a[28:31]
ds_read_b128 a[140:143], v5 offset:14336
v_mfma_f32_16x16x32_bf16 a[56:59], a[168:171], v[32:35], a[56:59]
v_mfma_f32_16x16x32_bf16 a[84:87], a[168:171], v[36:39], a[84:87]
ds_read_b128 a[144:147], v5 offset:15360
v_mfma_f32_16x16x32_bf16 a[4:7], a[172:175], v[24:27], a[4:7]
v_mfma_f32_16x16x32_bf16 a[32:35], a[172:175], v[28:31], a[32:35]
v_mfma_f32_16x16x32_bf16 a[60:63], a[172:175], v[32:35], a[60:63]
ds_read_b128 a[148:151], v5 offset:16384
v_mfma_f32_16x16x32_bf16 a[88:91], a[172:175], v[36:39], a[88:91]
v_mfma_f32_16x16x32_bf16 a[8:11], a[176:179], v[24:27], a[8:11]
ds_read_b128 a[152:155], v5 offset:17408
v_mfma_f32_16x16x32_bf16 a[36:39], a[176:179], v[28:31], a[36:39]
v_mfma_f32_16x16x32_bf16 a[64:67], a[176:179], v[32:35], a[64:67]
v_mfma_f32_16x16x32_bf16 a[92:95], a[176:179], v[36:39], a[92:95]
ds_read_b128 a[156:159], v5 offset:18432
v_mfma_f32_16x16x32_bf16 a[12:15], a[180:183], v[24:27], a[12:15]
v_mfma_f32_16x16x32_bf16 a[40:43], a[180:183], v[28:31], a[40:43]
ds_read_b128 a[160:163], v5 offset:19456
v_mfma_f32_16x16x32_bf16 a[68:71], a[180:183], v[32:35], a[68:71]
v_mfma_f32_16x16x32_bf16 a[96:99], a[180:183], v[36:39], a[96:99]
v_mfma_f32_16x16x32_bf16 a[16:19], a[184:187], v[24:27], a[16:19]
ds_read_b128 a[164:167], v5 offset:20480
v_mfma_f32_16x16x32_bf16 a[44:47], a[184:187], v[28:31], a[44:47]
v_mfma_f32_16x16x32_bf16 a[72:75], a[184:187], v[32:35], a[72:75]
v_mfma_f32_16x16x32_bf16 a[100:103], a[184:187], v[36:39], a[100:103]
v_mfma_f32_16x16x32_bf16 a[20:23], a[188:191], v[24:27], a[20:23]
v_mfma_f32_16x16x32_bf16 a[48:51], a[188:191], v[28:31], a[48:51]
v_mfma_f32_16x16x32_bf16 a[76:79], a[188:191], v[32:35], a[76:79]
v_mfma_f32_16x16x32_bf16 a[104:107], a[188:191], v[36:39], a[104:107]
v_mfma_f32_16x16x32_bf16 a[24:27], a[192:195], v[24:27], a[24:27]
v_mfma_f32_16x16x32_bf16 a[52:55], a[192:195], v[28:31], a[52:55]
v_mfma_f32_16x16x32_bf16 a[80:83], a[192:195], v[32:35], a[80:83]
v_mfma_f32_16x16x32_bf16 a[108:111], a[192:195], v[36:39], a[108:111]
s_waitcnt lgkmcnt(0)
v_mfma_f32_16x16x32_bf16 a[0:3], a[140:143], v[40:43], a[0:3]
v_mfma_f32_16x16x32_bf16 a[28:31], a[140:143], v[44:47], a[28:31]
ds_read_b128 a[168:171], v5 offset:21504
v_mfma_f32_16x16x32_bf16 a[56:59], a[140:143], v[48:51], a[56:59]
v_mfma_f32_16x16x32_bf16 a[84:87], a[140:143], v[52:55], a[84:87]
ds_read_b128 a[172:175], v5 offset:22528
v_mfma_f32_16x16x32_bf16 a[4:7], a[144:147], v[40:43], a[4:7]
v_mfma_f32_16x16x32_bf16 a[32:35], a[144:147], v[44:47], a[32:35]
v_mfma_f32_16x16x32_bf16 a[60:63], a[144:147], v[48:51], a[60:63]
ds_read_b128 a[176:179], v5 offset:23552
v_mfma_f32_16x16x32_bf16 a[88:91], a[144:147], v[52:55], a[88:91]
v_mfma_f32_16x16x32_bf16 a[8:11], a[148:151], v[40:43], a[8:11]
ds_read_b128 a[180:183], v5 offset:24576
v_mfma_f32_16x16x32_bf16 a[36:39], a[148:151], v[44:47], a[36:39]
v_mfma_f32_16x16x32_bf16 a[64:67], a[148:151], v[48:51], a[64:67]
v_mfma_f32_16x16x32_bf16 a[92:95], a[148:151], v[52:55], a[92:95]
ds_read_b128 a[184:187], v5 offset:25600
v_mfma_f32_16x16x32_bf16 a[12:15], a[152:155], v[40:43], a[12:15]
v_mfma_f32_16x16x32_bf16 a[40:43], a[152:155], v[44:47], a[40:43]
ds_read_b128 a[188:191], v5 offset:26624
v_mfma_f32_16x16x32_bf16 a[68:71], a[152:155], v[48:51], a[68:71]
v_mfma_f32_16x16x32_bf16 a[96:99], a[152:155], v[52:55], a[96:99]
v_mfma_f32_16x16x32_bf16 a[16:19], a[156:159], v[40:43], a[16:19]
ds_read_b128 a[192:195], v5 offset:27648
v_mfma_f32_16x16x32_bf16 a[44:47], a[156:159], v[44:47], a[44:47]
v_mfma_f32_16x16x32_bf16 a[72:75], a[156:159], v[48:51], a[72:75]
v_mfma_f32_16x16x32_bf16 a[100:103], a[156:159], v[52:55], a[100:103]
v_mfma_f32_16x16x32_bf16 a[20:23], a[160:163], v[40:43], a[20:23]
v_mfma_f32_16x16x32_bf16 a[48:51], a[160:163], v[44:47], a[48:51]
v_mfma_f32_16x16x32_bf16 a[76:79], a[160:163], v[48:51], a[76:79]
v_mfma_f32_16x16x32_bf16 a[104:107], a[160:163], v[52:55], a[104:107]
v_mfma_f32_16x16x32_bf16 a[24:27], a[164:167], v[40:43], a[24:27]
v_mfma_f32_16x16x32_bf16 a[52:55], a[164:167], v[44:47], a[52:55]
v_mfma_f32_16x16x32_bf16 a[80:83], a[164:167], v[48:51], a[80:83]
v_mfma_f32_16x16x32_bf16 a[108:111], a[164:167], v[52:55], a[108:111]
s_waitcnt lgkmcnt(0)
v_mfma_f32_16x16x32_bf16 a[0:3], a[168:171], v[56:59], a[0:3]
v_mfma_f32_16x16x32_bf16 a[28:31], a[168:171], v[60:63], a[28:31]
ds_read_b128 a[140:143], v5 offset:28672
v_mfma_f32_16x16x32_bf16 a[56:59], a[168:171], v[64:67], a[56:59]
v_mfma_f32_16x16x32_bf16 a[84:87], a[168:171], v[68:71], a[84:87]
ds_read_b128 a[144:147], v5 offset:29696
v_mfma_f32_16x16x32_bf16 a[4:7], a[172:175], v[56:59], a[4:7]
v_mfma_f32_16x16x32_bf16 a[32:35], a[172:175], v[60:63], a[32:35]
v_mfma_f32_16x16x32_bf16 a[60:63], a[172:175], v[64:67], a[60:63]
ds_read_b128 a[148:151], v5 offset:30720
v_mfma_f32_16x16x32_bf16 a[88:91], a[172:175], v[68:71], a[88:91]
v_mfma_f32_16x16x32_bf16 a[8:11], a[176:179], v[56:59], a[8:11]
ds_read_b128 a[152:155], v5 offset:31744
v_mfma_f32_16x16x32_bf16 a[36:39], a[176:179], v[60:63], a[36:39]
v_mfma_f32_16x16x32_bf16 a[64:67], a[176:179], v[64:67], a[64:67]
v_mfma_f32_16x16x32_bf16 a[92:95], a[176:179], v[68:71], a[92:95]
ds_read_b128 a[156:159], v5 offset:32768
v_mfma_f32_16x16x32_bf16 a[12:15], a[180:183], v[56:59], a[12:15]
v_mfma_f32_16x16x32_bf16 a[40:43], a[180:183], v[60:63], a[40:43]
ds_read_b128 a[160:163], v5 offset:33792
v_mfma_f32_16x16x32_bf16 a[68:71], a[180:183], v[64:67], a[68:71]
v_mfma_f32_16x16x32_bf16 a[96:99], a[180:183], v[68:71], a[96:99]
v_mfma_f32_16x16x32_bf16 a[16:19], a[184:187], v[56:59], a[16:19]
ds_read_b128 a[164:167], v5 offset:34816
v_mfma_f32_16x16x32_bf16 a[44:47], a[184:187], v[60:63], a[44:47]
v_mfma_f32_16x16x32_bf16 a[72:75], a[184:187], v[64:67], a[72:75]
v_mfma_f32_16x16x32_bf16 a[100:103], a[184:187], v[68:71], a[100:103]
v_mfma_f32_16x16x32_bf16 a[20:23], a[188:191], v[56:59], a[20:23]
v_mfma_f32_16x16x32_bf16 a[48:51], a[188:191], v[60:63], a[48:51]
v_mfma_f32_16x16x32_bf16 a[76:79], a[188:191], v[64:67], a[76:79]
v_mfma_f32_16x16x32_bf16 a[104:107], a[188:191], v[68:71], a[104:107]
v_mfma_f32_16x16x32_bf16 a[24:27], a[192:195], v[56:59], a[24:27]
v_mfma_f32_16x16x32_bf16 a[52:55], a[192:195], v[60:63], a[52:55]
v_mfma_f32_16x16x32_bf16 a[80:83], a[192:195], v[64:67], a[80:83]
v_mfma_f32_16x16x32_bf16 a[108:111], a[192:195], v[68:71], a[108:111]
s_waitcnt lgkmcnt(0)
v_mfma_f32_16x16x32_bf16 a[0:3], a[140:143], v[72:75], a[0:3]
v_mfma_f32_16x16x32_bf16 a[28:31], a[140:143], v[76:79], a[28:31]
ds_read_b128 a[168:171], v5 offset:35840
v_mfma_f32_16x16x32_bf16 a[56:59], a[140:143], v[80:83], a[56:59]
v_mfma_f32_16x16x32_bf16 a[84:87], a[140:143], v[84:87], a[84:87]
ds_read_b128 a[172:175], v5 offset:36864
v_mfma_f32_16x16x32_bf16 a[4:7], a[144:147], v[72:75], a[4:7]
v_mfma_f32_16x16x32_bf16 a[32:35], a[144:147], v[76:79], a[32:35]
v_mfma_f32_16x16x32_bf16 a[60:63], a[144:147], v[80:83], a[60:63]
ds_read_b128 a[176:179], v5 offset:37888
v_mfma_f32_16x16x32_bf16 a[88:91], a[144:147], v[84:87], a[88:91]
v_mfma_f32_16x16x32_bf16 a[8:11], a[148:151], v[72:75], a[8:11]
ds_read_b128 a[180:183], v5 offset:38912
v_mfma_f32_16x16x32_bf16 a[36:39], a[148:151], v[76:79], a[36:39]
v_mfma_f32_16x16x32_bf16 a[64:67], a[148:151], v[80:83], a[64:67]
v_mfma_f32_16x16x32_bf16 a[92:95], a[148:151], v[84:87], a[92:95]
ds_read_b128 a[184:187], v5 offset:39936
v_mfma_f32_16x16x32_bf16 a[12:15], a[152:155], v[72:75], a[12:15]
v_mfma_f32_16x16x32_bf16 a[40:43], a[152:155], v[76:79], a[40:43]
ds_read_b128 a[188:191], v5 offset:40960
v_mfma_f32_16x16x32_bf16 a[68:71], a[152:155], v[80:83], a[68:71]
v_mfma_f32_16x16x32_bf16 a[96:99], a[152:155], v[84:87], a[96:99]
v_mfma_f32_16x16x32_bf16 a[16:19], a[156:159], v[72:75], a[16:19]
ds_read_b128 a[192:195], v5 offset:41984
v_mfma_f32_16x16x32_bf16 a[44:47], a[156:159], v[76:79], a[44:47]
v_mfma_f32_16x16x32_bf16 a[72:75], a[156:159], v[80:83], a[72:75]
v_mfma_f32_16x16x32_bf16 a[100:103], a[156:159], v[84:87], a[100:103]
v_mfma_f32_16x16x32_bf16 a[20:23], a[160:163], v[72:75], a[20:23]
v_mfma_f32_16x16x32_bf16 a[48:51], a[160:163], v[76:79], a[48:51]
v_mfma_f32_16x16x32_bf16 a[76:79], a[160:163], v[80:83], a[76:79]
v_mfma_f32_16x16x32_bf16 a[104:107], a[160:163], v[84:87], a[104:107]
v_mfma_f32_16x16x32_bf16 a[24:27], a[164:167], v[72:75], a[24:27]
v_mfma_f32_16x16x32_bf16 a[52:55], a[164:167], v[76:79], a[52:55]
v_mfma_f32_16x16x32_bf16 a[80:83], a[164:167], v[80:83], a[80:83]
v_mfma_f32_16x16x32_bf16 a[108:111], a[164:167], v[84:87], a[108:111]
v_mov_b32 v186, 0
s_mov_b32 s58, 0x20000
L_p1r4:
global_load_dword v187, v186, s[42:43] sc1
s_waitcnt vmcnt(0)
v_readfirstlane_b32 s59, v187
s_nop 3
s_cmp_ge_u32 s59, 4
s_cbranch_scc1 L_pd1r4
s_sub_u32 s58, s58, 1
s_cmp_lg_u32 s58, 0
s_cbranch_scc1 L_p1r4
L_pd1r4:
s_waitcnt vmcnt(0)
buffer_load_dwordx4 v[8:11], v0, s[12:15], s52 offen offset:0 sc1
buffer_load_dwordx4 v[12:15], v1, s[12:15], s52 offen offset:0 sc1
buffer_load_dwordx4 v[16:19], v2, s[12:15], s52 offen offset:0 sc1
buffer_load_dwordx4 v[20:23], v3, s[12:15], s52 offen offset:0 sc1
buffer_load_dwordx4 v[24:27], v0, s[12:15], s52 offen offset:1024 sc1
buffer_load_dwordx4 v[28:31], v1, s[12:15], s52 offen offset:1024 sc1
buffer_load_dwordx4 v[32:35], v2, s[12:15], s52 offen offset:1024 sc1
buffer_load_dwordx4 v[36:39], v3, s[12:15], s52 offen offset:1024 sc1
buffer_load_dwordx4 v[40:43], v0, s[12:15], s52 offen offset:2048 sc1
buffer_load_dwordx4 v[44:47], v1, s[12:15], s52 offen offset:2048 sc1
buffer_load_dwordx4 v[48:51], v2, s[12:15], s52 offen offset:2048 sc1
buffer_load_dwordx4 v[52:55], v3, s[12:15], s52 offen offset:2048 sc1
buffer_load_dwordx4 v[56:59], v0, s[12:15], s52 offen offset:3072 sc1
buffer_load_dwordx4 v[60:63], v1, s[12:15], s52 offen offset:3072 sc1
buffer_load_dwordx4 v[64:67], v2, s[12:15], s52 offen offset:3072 sc1
buffer_load_dwordx4 v[68:71], v3, s[12:15], s52 offen offset:3072 sc1
s_add_u32 s59, s52, 4096
buffer_load_dwordx4 v[72:75], v0, s[12:15], s59 offen offset:0 sc1
buffer_load_dwordx4 v[76:79], v1, s[12:15], s59 offen offset:0 sc1
buffer_load_dwordx4 v[80:83], v2, s[12:15], s59 offen offset:0 sc1
buffer_load_dwordx4 v[84:87], v3, s[12:15], s59 offen offset:0 sc1
s_waitcnt lgkmcnt(0)
v_mfma_f32_16x16x32_bf16 a[0:3], a[168:171], v[88:91], a[0:3]
v_mfma_f32_16x16x32_bf16 a[28:31], a[168:171], v[92:95], a[28:31]
ds_read_b128 a[140:143], v5 offset:43008
v_mfma_f32_16x16x32_bf16 a[56:59], a[168:171], v[96:99], a[56:59]
v_mfma_f32_16x16x32_bf16 a[84:87], a[168:171], v[100:103], a[84:87]
ds_read_b128 a[144:147], v5 offset:44032
v_mfma_f32_16x16x32_bf16 a[4:7], a[172:175], v[88:91], a[4:7]
v_mfma_f32_16x16x32_bf16 a[32:35], a[172:175], v[92:95], a[32:35]
v_mfma_f32_16x16x32_bf16 a[60:63], a[172:175], v[96:99], a[60:63]
ds_read_b128 a[148:151], v5 offset:45056
v_mfma_f32_16x16x32_bf16 a[88:91], a[172:175], v[100:103], a[88:91]
v_mfma_f32_16x16x32_bf16 a[8:11], a[176:179], v[88:91], a[8:11]
ds_read_b128 a[152:155], v5 offset:46080
v_mfma_f32_16x16x32_bf16 a[36:39], a[176:179], v[92:95], a[36:39]
v_mfma_f32_16x16x32_bf16 a[64:67], a[176:179], v[96:99], a[64:67]
v_mfma_f32_16x16x32_bf16 a[92:95], a[176:179], v[100:103], a[92:95]
ds_read_b128 a[156:159], v5 offset:47104
v_mfma_f32_16x16x32_bf16 a[12:15], a[180:183], v[88:91], a[12:15]
v_mfma_f32_16x16x32_bf16 a[40:43], a[180:183], v[92:95], a[40:43]
ds_read_b128 a[160:163], v5 offset:48128
v_mfma_f32_16x16x32_bf16 a[68:71], a[180:183], v[96:99], a[68:71]
v_mfma_f32_16x16x32_bf16 a[96:99], a[180:183], v[100:103], a[96:99]
v_mfma_f32_16x16x32_bf16 a[16:19], a[184:187], v[88:91], a[16:19]
ds_read_b128 a[164:167], v5 offset:49152
v_mfma_f32_16x16x32_bf16 a[44:47], a[184:187], v[92:95], a[44:47]
v_mfma_f32_16x16x32_bf16 a[72:75], a[184:187], v[96:99], a[72:75]
v_mfma_f32_16x16x32_bf16 a[100:103], a[184:187], v[100:103], a[100:103]
v_mfma_f32_16x16x32_bf16 a[20:23], a[188:191], v[88:91], a[20:23]
v_mfma_f32_16x16x32_bf16 a[48:51], a[188:191], v[92:95], a[48:51]
v_mfma_f32_16x16x32_bf16 a[76:79], a[188:191], v[96:99], a[76:79]
v_mfma_f32_16x16x32_bf16 a[104:107], a[188:191], v[100:103], a[104:107]
v_mfma_f32_16x16x32_bf16 a[24:27], a[192:195], v[88:91], a[24:27]
v_mfma_f32_16x16x32_bf16 a[52:55], a[192:195], v[92:95], a[52:55]
v_mfma_f32_16x16x32_bf16 a[80:83], a[192:195], v[96:99], a[80:83]
v_mfma_f32_16x16x32_bf16 a[108:111], a[192:195], v[100:103], a[108:111]
s_waitcnt lgkmcnt(0)
v_mfma_f32_16x16x32_bf16 a[0:3], a[140:143], v[104:107], a[0:3]
s_add_u32 s59, s52, 4096
v_mfma_f32_16x16x32_bf16 a[28:31], a[140:143], v[108:111], a[28:31]
ds_read_b128 a[168:171], v5 offset:50176
v_mfma_f32_16x16x32_bf16 a[56:59], a[140:143], v[112:115], a[56:59]
buffer_load_dwordx4 v[88:91], v0, s[12:15], s59 offen offset:1024 sc1
v_mfma_f32_16x16x32_bf16 a[84:87], a[140:143], v[116:119], a[84:87]
ds_read_b128 a[172:175], v5 offset:51200
v_mfma_f32_16x16x32_bf16 a[4:7], a[144:147], v[104:107], a[4:7]
v_mfma_f32_16x16x32_bf16 a[32:35], a[144:147], v[108:111], a[32:35]
v_mfma_f32_16x16x32_bf16 a[60:63], a[144:147], v[112:115], a[60:63]
ds_read_b128 a[176:179], v5 offset:52224
v_mfma_f32_16x16x32_bf16 a[88:91], a[144:147], v[116:119], a[88:91]
v_mfma_f32_16x16x32_bf16 a[8:11], a[148:151], v[104:107], a[8:11]
ds_read_b128 a[180:183], v5 offset:53248
buffer_load_dwordx4 v[92:95], v1, s[12:15], s59 offen offset:1024 sc1
v_mfma_f32_16x16x32_bf16 a[36:39], a[148:151], v[108:111], a[36:39]
v_mfma_f32_16x16x32_bf16 a[64:67], a[148:151], v[112:115], a[64:67]
v_mfma_f32_16x16x32_bf16 a[92:95], a[148:151], v[116:119], a[92:95]
ds_read_b128 a[184:187], v5 offset:54272
v_mfma_f32_16x16x32_bf16 a[12:15], a[152:155], v[104:107], a[12:15]
v_mfma_f32_16x16x32_bf16 a[40:43], a[152:155], v[108:111], a[40:43]
ds_read_b128 a[188:191], v5 offset:55296
v_mfma_f32_16x16x32_bf16 a[68:71], a[152:155], v[112:115], a[68:71]
buffer_load_dwordx4 v[96:99], v2, s[12:15], s59 offen offset:1024 sc1
v_mfma_f32_16x16x32_bf16 a[96:99], a[152:155], v[116:119], a[96:99]
v_mfma_f32_16x16x32_bf16 a[16:19], a[156:159], v[104:107], a[16:19]
ds_read_b128 a[192:195], v5 offset:56320
v_mfma_f32_16x16x32_bf16 a[44:47], a[156:159], v[108:111], a[44:47]
v_mfma_f32_16x16x32_bf16 a[72:75], a[156:159], v[112:115], a[72:75]
v_mfma_f32_16x16x32_bf16 a[100:103], a[156:159], v[116:119], a[100:103]
v_mfma_f32_16x16x32_bf16 a[20:23], a[160:163], v[104:107], a[20:23]
buffer_load_dwordx4 v[100:103], v3, s[12:15], s59 offen offset:1024 sc1
v_mfma_f32_16x16x32_bf16 a[48:51], a[160:163], v[108:111], a[48:51]
v_mfma_f32_16x16x32_bf16 a[76:79], a[160:163], v[112:115], a[76:79]
v_mfma_f32_16x16x32_bf16 a[104:107], a[160:163], v[116:119], a[104:107]
v_mfma_f32_16x16x32_bf16 a[24:27], a[164:167], v[104:107], a[24:27]
v_mfma_f32_16x16x32_bf16 a[52:55], a[164:167], v[108:111], a[52:55]
v_mfma_f32_16x16x32_bf16 a[80:83], a[164:167], v[112:115], a[80:83]
v_mfma_f32_16x16x32_bf16 a[108:111], a[164:167], v[116:119], a[108:111]
s_waitcnt lgkmcnt(0)
v_mfma_f32_16x16x32_bf16 a[0:3], a[168:171], v[120:123], a[0:3]
s_add_u32 s59, s52, 4096
v_mfma_f32_16x16x32_bf16 a[28:31], a[168:171], v[124:127], a[28:31]
ds_read_b128 a[140:143], v7 offset:0
v_mfma_f32_16x16x32_bf16 a[56:59], a[168:171], v[128:131], a[56:59]
buffer_load_dwordx4 v[104:107], v0, s[12:15], s59 offen offset:2048 sc1
v_mfma_f32_16x16x32_bf16 a[84:87], a[168:171], v[132:135], a[84:87]
ds_read_b128 a[144:147], v7 offset:1024
v_mfma_f32_16x16x32_bf16 a[4:7], a[172:175], v[120:123], a[4:7]
v_mfma_f32_16x16x32_bf16 a[32:35], a[172:175], v[124:127], a[32:35]
v_mfma_f32_16x16x32_bf16 a[60:63], a[172:175], v[128:131], a[60:63]
ds_read_b128 a[148:151], v7 offset:2048
v_mfma_f32_16x16x32_bf16 a[88:91], a[172:175], v[132:135], a[88:91]
v_mfma_f32_16x16x32_bf16 a[8:11], a[176:179], v[120:123], a[8:11]
ds_read_b128 a[152:155], v7 offset:3072
buffer_load_dwordx4 v[108:111], v1, s[12:15], s59 offen offset:2048 sc1
v_mfma_f32_16x16x32_bf16 a[36:39], a[176:179], v[124:127], a[36:39]
v_mfma_f32_16x16x32_bf16 a[64:67], a[176:179], v[128:131], a[64:67]
v_mfma_f32_16x16x32_bf16 a[92:95], a[176:179], v[132:135], a[92:95]
ds_read_b128 a[156:159], v7 offset:4096
v_mfma_f32_16x16x32_bf16 a[12:15], a[180:183], v[120:123], a[12:15]
v_mfma_f32_16x16x32_bf16 a[40:43], a[180:183], v[124:127], a[40:43]
ds_read_b128 a[160:163], v7 offset:5120
v_mfma_f32_16x16x32_bf16 a[68:71], a[180:183], v[128:131], a[68:71]
buffer_load_dwordx4 v[112:115], v2, s[12:15], s59 offen offset:2048 sc1
v_mfma_f32_16x16x32_bf16 a[96:99], a[180:183], v[132:135], a[96:99]
v_mfma_f32_16x16x32_bf16 a[16:19], a[184:187], v[120:123], a[16:19]
ds_read_b128 a[164:167], v7 offset:6144
v_mfma_f32_16x16x32_bf16 a[44:47], a[184:187], v[124:127], a[44:47]
v_mfma_f32_16x16x32_bf16 a[72:75], a[184:187], v[128:131], a[72:75]
v_mfma_f32_16x16x32_bf16 a[100:103], a[184:187], v[132:135], a[100:103]
v_mfma_f32_16x16x32_bf16 a[20:23], a[188:191], v[120:123], a[20:23]
buffer_load_dwordx4 v[116:119], v3, s[12:15], s59 offen offset:2048 sc1
v_mfma_f32_16x16x32_bf16 a[48:51], a[188:191], v[124:127], a[48:51]
v_mfma_f32_16x16x32_bf16 a[76:79], a[188:191], v[128:131], a[76:79]
v_mfma_f32_16x16x32_bf16 a[104:107], a[188:191], v[132:135], a[104:107]
v_mfma_f32_16x16x32_bf16 a[24:27], a[192:195], v[120:123], a[24:27]
v_mfma_f32_16x16x32_bf16 a[52:55], a[192:195], v[124:127], a[52:55]
v_mfma_f32_16x16x32_bf16 a[80:83], a[192:195], v[128:131], a[80:83]
v_mfma_f32_16x16x32_bf16 a[108:111], a[192:195], v[132:135], a[108:111]
s_waitcnt vmcnt(24) lgkmcnt(0)
v_mfma_f32_16x16x32_bf16 a[0:3], a[140:143], v[8:11], a[0:3]
s_barrier
s_add_u32 s59, s52, 4096
v_mfma_f32_16x16x32_bf16 a[28:31], a[140:143], v[12:15], a[28:31]
ds_read_b128 a[168:171], v7 offset:7168
v_mfma_f32_16x16x32_bf16 a[56:59], a[140:143], v[16:19], a[56:59]
buffer_load_dwordx4 v[120:123], v0, s[12:15], s59 offen offset:3072 sc1
v_mfma_f32_16x16x32_bf16 a[84:87], a[140:143], v[20:23], a[84:87]
ds_read_b128 a[172:175], v7 offset:8192
v_mfma_f32_16x16x32_bf16 a[4:7], a[144:147], v[8:11], a[4:7]
v_mfma_f32_16x16x32_bf16 a[32:35], a[144:147], v[12:15], a[32:35]
buffer_load_dwordx4 v[124:127], v1, s[12:15], s59 offen offset:3072 sc1
v_mfma_f32_16x16x32_bf16 a[60:63], a[144:147], v[16:19], a[60:63]
ds_read_b128 a[176:179], v7 offset:9216
v_mfma_f32_16x16x32_bf16 a[88:91], a[144:147], v[20:23], a[88:91]
v_mfma_f32_16x16x32_bf16 a[8:11], a[148:151], v[8:11], a[8:11]
ds_read_b128 a[180:183], v7 offset:10240
buffer_load_dwordx4 v[128:131], v2, s[12:15], s59 offen offset:3072 sc1
v_mfma_f32_16x16x32_bf16 a[36:39], a[148:151], v[12:15], a[36:39]
v_mfma_f32_16x16x32_bf16 a[64:67], a[148:151], v[16:19], a[64:67]
v_mfma_f32_16x16x32_bf16 a[92:95], a[148:151], v[20:23], a[92:95]
ds_read_b128 a[184:187], v7 offset:11264
buffer_load_dwordx4 v[132:135], v3, s[12:15], s59 offen offset:3072 sc1
v_mfma_f32_16x16x32_bf16 a[12:15], a[152:155], v[8:11], a[12:15]
s_add_u32 m0, s63, 0
s_add_u32 s58, s57, 0
v_mfma_f32_16x16x32_bf16 a[40:43], a[152:155], v[12:15], a[40:43]
ds_read_b128 a[188:191], v7 offset:12288
v_mfma_f32_16x16x32_bf16 a[68:71], a[152:155], v[16:19], a[68:71]
buffer_load_dwordx4 v6, s[16:19], s58 offen offset:0 sc1 lds
v_mfma_f32_16x16x32_bf16 a[96:99], a[152:155], v[20:23], a[96:99]
v_mfma_f32_16x16x32_bf16 a[16:19], a[156:159], v[8:11], a[16:19]
ds_read_b128 a[192:195], v7 offset:13312
v_mfma_f32_16x16x32_bf16 a[44:47], a[156:159], v[12:15], a[44:47]
buffer_load_dwordx4 v6, s[16:19], s58 offen offset:1024 sc1 lds
v_mfma_f32_16x16x32_bf16 a[72:75], a[156:159], v[16:19], a[72:75]
v_mfma_f32_16x16x32_bf16 a[100:103], a[156:159], v[20:23], a[100:103]
v_mfma_f32_16x16x32_bf16 a[20:23], a[160:163], v[8:11], a[20:23]
buffer_load_dwordx4 v6, s[16:19], s58 offen offset:2048 sc1 lds
v_mfma_f32_16x16x32_bf16 a[48:51], a[160:163], v[12:15], a[48:51]
v_mfma_f32_16x16x32_bf16 a[76:79], a[160:163], v[16:19], a[76:79]
v_mfma_f32_16x16x32_bf16 a[104:107], a[160:163], v[20:23], a[104:107]
buffer_load_dwordx4 v6, s[16:19], s58 offen offset:3072 sc1 lds
v_mfma_f32_16x16x32_bf16 a[24:27], a[164:167], v[8:11], a[24:27]
v_mfma_f32_16x16x32_bf16 a[52:55], a[164:167], v[12:15], a[52:55]
v_mfma_f32_16x16x32_bf16 a[80:83], a[164:167], v[16:19], a[80:83]
v_mfma_f32_16x16x32_bf16 a[108:111], a[164:167], v[20:23], a[108:111]
s_waitcnt vmcnt(28) lgkmcnt(0)
v_mfma_f32_16x16x32_bf16 a[0:3], a[168:171], v[24:27], a[0:3]
v_mfma_f32_16x16x32_bf16 a[28:31], a[168:171], v[28:31], a[28:31]
ds_read_b128 a[140:143], v7 offset:14336
v_mfma_f32_16x16x32_bf16 a[56:59], a[168:171], v[32:35], a[56:59]
buffer_load_dwordx4 v[8:11], v0, s[12:15], s53 offen offset:0 sc1
v_mfma_f32_16x16x32_bf16 a[84:87], a[168:171], v[36:39], a[84:87]
ds_read_b128 a[144:147], v7 offset:15360
v_mfma_f32_16x16x32_bf16 a[4:7], a[172:175], v[24:27], a[4:7]
v_mfma_f32_16x16x32_bf16 a[32:35], a[172:175], v[28:31], a[32:35]
buffer_load_dwordx4 v[12:15], v1, s[12:15], s53 offen offset:0 sc1
v_mfma_f32_16x16x32_bf16 a[60:63], a[172:175], v[32:35], a[60:63]
ds_read_b128 a[148:151], v7 offset:16384
v_mfma_f32_16x16x32_bf16 a[88:91], a[172:175], v[36:39], a[88:91]
v_mfma_f32_16x16x32_bf16 a[8:11], a[176:179], v[24:27], a[8:11]
ds_read_b128 a[152:155], v7 offset:17408
buffer_load_dwordx4 v[16:19], v2, s[12:15], s53 offen offset:0 sc1
v_mfma_f32_16x16x32_bf16 a[36:39], a[176:179], v[28:31], a[36:39]
v_mfma_f32_16x16x32_bf16 a[64:67], a[176:179], v[32:35], a[64:67]
v_mfma_f32_16x16x32_bf16 a[92:95], a[176:179], v[36:39], a[92:95]
ds_read_b128 a[156:159], v7 offset:18432
v_mfma_f32_16x16x32_bf16 a[12:15], a[180:183], v[24:27], a[12:15]
buffer_load_dwordx4 v[20:23], v3, s[12:15], s53 offen offset:0 sc1
v_mfma_f32_16x16x32_bf16 a[40:43], a[180:183], v[28:31], a[40:43]
ds_read_b128 a[160:163], v7 offset:19456
s_add_u32 m0, s63, 4096
v_mfma_f32_16x16x32_bf16 a[68:71], a[180:183], v[32:35], a[68:71]
s_add_u32 s58, s57, 4096
v_mfma_f32_16x16x32_bf16 a[96:99], a[180:183], v[36:39], a[96:99]
buffer_load_dwordx4 v6, s[16:19], s58 offen offset:0 sc1 lds
v_mfma_f32_16x16x32_bf16 a[16:19], a[184:187], v[24:27], a[16:19]
ds_read_b128 a[164:167], v7 offset:20480
v_mfma_f32_16x16x32_bf16 a[44:47], a[184:187], v[28:31], a[44:47]
v_mfma_f32_16x16x32_bf16 a[72:75], a[184:187], v[32:35], a[72:75]
v_mfma_f32_16x16x32_bf16 a[100:103], a[184:187], v[36:39], a[100:103]
buffer_load_dwordx4 v6, s[16:19], s58 offen offset:1024 sc1 lds
v_mfma_f32_16x16x32_bf16 a[20:23], a[188:191], v[24:27], a[20:23]
v_mfma_f32_16x16x32_bf16 a[48:51], a[188:191], v[28:31], a[48:51]
v_mfma_f32_16x16x32_bf16 a[76:79], a[188:191], v[32:35], a[76:79]
buffer_load_dwordx4 v6, s[16:19], s58 offen offset:2048 sc1 lds
v_mfma_f32_16x16x32_bf16 a[104:107], a[188:191], v[36:39], a[104:107]
v_mfma_f32_16x16x32_bf16 a[24:27], a[192:195], v[24:27], a[24:27]
v_mfma_f32_16x16x32_bf16 a[52:55], a[192:195], v[28:31], a[52:55]
v_mfma_f32_16x16x32_bf16 a[80:83], a[192:195], v[32:35], a[80:83]
v_mfma_f32_16x16x32_bf16 a[108:111], a[192:195], v[36:39], a[108:111]
s_waitcnt vmcnt(31) lgkmcnt(0)
v_mfma_f32_16x16x32_bf16 a[0:3], a[140:143], v[40:43], a[0:3]
v_mfma_f32_16x16x32_bf16 a[28:31], a[140:143], v[44:47], a[28:31]
ds_read_b128 a[168:171], v7 offset:21504
v_mfma_f32_16x16x32_bf16 a[56:59], a[140:143], v[48:51], a[56:59]
buffer_load_dwordx4 v[24:27], v0, s[12:15], s53 offen offset:1024 sc1
v_mfma_f32_16x16x32_bf16 a[84:87], a[140:143], v[52:55], a[84:87]
ds_read_b128 a[172:175], v7 offset:22528
v_mfma_f32_16x16x32_bf16 a[4:7], a[144:147], v[40:43], a[4:7]
v_mfma_f32_16x16x32_bf16 a[32:35], a[144:147], v[44:47], a[32:35]
buffer_load_dwordx4 v[28:31], v1, s[12:15], s53 offen offset:1024 sc1
v_mfma_f32_16x16x32_bf16 a[60:63], a[144:147], v[48:51], a[60:63]
ds_read_b128 a[176:179], v7 offset:23552
v_mfma_f32_16x16x32_bf16 a[88:91], a[144:147], v[52:55], a[88:91]
v_mfma_f32_16x16x32_bf16 a[8:11], a[148:151], v[40:43], a[8:11]
ds_read_b128 a[180:183], v7 offset:24576
buffer_load_dwordx4 v[32:35], v2, s[12:15], s53 offen offset:1024 sc1
v_mfma_f32_16x16x32_bf16 a[36:39], a[148:151], v[44:47], a[36:39]
v_mfma_f32_16x16x32_bf16 a[64:67], a[148:151], v[48:51], a[64:67]
v_mfma_f32_16x16x32_bf16 a[92:95], a[148:151], v[52:55], a[92:95]
ds_read_b128 a[184:187], v7 offset:25600
buffer_load_dwordx4 v[36:39], v3, s[12:15], s53 offen offset:1024 sc1
v_mfma_f32_16x16x32_bf16 a[12:15], a[152:155], v[40:43], a[12:15]
s_add_u32 m0, s63, 28672
s_add_u32 s58, s57, 114688
v_mfma_f32_16x16x32_bf16 a[40:43], a[152:155], v[44:47], a[40:43]
ds_read_b128 a[188:191], v7 offset:26624
v_mfma_f32_16x16x32_bf16 a[68:71], a[152:155], v[48:51], a[68:71]
buffer_load_dwordx4 v6, s[16:19], s58 offen offset:0 sc1 lds
v_mfma_f32_16x16x32_bf16 a[96:99], a[152:155], v[52:55], a[96:99]
v_mfma_f32_16x16x32_bf16 a[16:19], a[156:159], v[40:43], a[16:19]
ds_read_b128 a[192:195], v7 offset:27648
v_mfma_f32_16x16x32_bf16 a[44:47], a[156:159], v[44:47], a[44:47]
buffer_load_dwordx4 v6, s[16:19], s58 offen offset:1024 sc1 lds
v_mfma_f32_16x16x32_bf16 a[72:75], a[156:159], v[48:51], a[72:75]
v_mfma_f32_16x16x32_bf16 a[100:103], a[156:159], v[52:55], a[100:103]
v_mfma_f32_16x16x32_bf16 a[20:23], a[160:163], v[40:43], a[20:23]
buffer_load_dwordx4 v6, s[16:19], s58 offen offset:2048 sc1 lds
v_mfma_f32_16x16x32_bf16 a[48:51], a[160:163], v[44:47], a[48:51]
v_mfma_f32_16x16x32_bf16 a[76:79], a[160:163], v[48:51], a[76:79]
v_mfma_f32_16x16x32_bf16 a[104:107], a[160:163], v[52:55], a[104:107]
buffer_load_dwordx4 v6, s[16:19], s58 offen offset:3072 sc1 lds
v_mfma_f32_16x16x32_bf16 a[24:27], a[164:167], v[40:43], a[24:27]
v_mfma_f32_16x16x32_bf16 a[52:55], a[164:167], v[44:47], a[52:55]
v_mfma_f32_16x16x32_bf16 a[80:83], a[164:167], v[48:51], a[80:83]
v_mfma_f32_16x16x32_bf16 a[108:111], a[164:167], v[52:55], a[108:111]
s_waitcnt vmcnt(35) lgkmcnt(0)
v_mfma_f32_16x16x32_bf16 a[0:3], a[168:171], v[56:59], a[0:3]
v_mfma_f32_16x16x32_bf16 a[28:31], a[168:171], v[60:63], a[28:31]
ds_read_b128 a[140:143], v7 offset:28672
v_mfma_f32_16x16x32_bf16 a[56:59], a[168:171], v[64:67], a[56:59]
buffer_load_dwordx4 v[40:43], v0, s[12:15], s53 offen offset:2048 sc1
v_mfma_f32_16x16x32_bf16 a[84:87], a[168:171], v[68:71], a[84:87]
ds_read_b128 a[144:147], v7 offset:29696
v_mfma_f32_16x16x32_bf16 a[4:7], a[172:175], v[56:59], a[4:7]
v_mfma_f32_16x16x32_bf16 a[32:35], a[172:175], v[60:63], a[32:35]
buffer_load_dwordx4 v[44:47], v1, s[12:15], s53 offen offset:2048 sc1
v_mfma_f32_16x16x32_bf16 a[60:63], a[172:175], v[64:67], a[60:63]
ds_read_b128 a[148:151], v7 offset:30720
v_mfma_f32_16x16x32_bf16 a[88:91], a[172:175], v[68:71], a[88:91]
v_mfma_f32_16x16x32_bf16 a[8:11], a[176:179], v[56:59], a[8:11]
ds_read_b128 a[152:155], v7 offset:31744
buffer_load_dwordx4 v[48:51], v2, s[12:15], s53 offen offset:2048 sc1
v_mfma_f32_16x16x32_bf16 a[36:39], a[176:179], v[60:63], a[36:39]
v_mfma_f32_16x16x32_bf16 a[64:67], a[176:179], v[64:67], a[64:67]
v_mfma_f32_16x16x32_bf16 a[92:95], a[176:179], v[68:71], a[92:95]
ds_read_b128 a[156:159], v7 offset:32768
v_mfma_f32_16x16x32_bf16 a[12:15], a[180:183], v[56:59], a[12:15]
buffer_load_dwordx4 v[52:55], v3, s[12:15], s53 offen offset:2048 sc1
v_mfma_f32_16x16x32_bf16 a[40:43], a[180:183], v[60:63], a[40:43]
ds_read_b128 a[160:163], v7 offset:33792
s_add_u32 m0, s63, 32768
v_mfma_f32_16x16x32_bf16 a[68:71], a[180:183], v[64:67], a[68:71]
s_add_u32 s58, s57, 118784
v_mfma_f32_16x16x32_bf16 a[96:99], a[180:183], v[68:71], a[96:99]
buffer_load_dwordx4 v6, s[16:19], s58 offen offset:0 sc1 lds
v_mfma_f32_16x16x32_bf16 a[16:19], a[184:187], v[56:59], a[16:19]
ds_read_b128 a[164:167], v7 offset:34816
v_mfma_f32_16x16x32_bf16 a[44:47], a[184:187], v[60:63], a[44:47]
v_mfma_f32_16x16x32_bf16 a[72:75], a[184:187], v[64:67], a[72:75]
v_mfma_f32_16x16x32_bf16 a[100:103], a[184:187], v[68:71], a[100:103]
buffer_load_dwordx4 v6, s[16:19], s58 offen offset:1024 sc1 lds
v_mfma_f32_16x16x32_bf16 a[20:23], a[188:191], v[56:59], a[20:23]
v_mfma_f32_16x16x32_bf16 a[48:51], a[188:191], v[60:63], a[48:51]
v_mfma_f32_16x16x32_bf16 a[76:79], a[188:191], v[64:67], a[76:79]
buffer_load_dwordx4 v6, s[16:19], s58 offen offset:2048 sc1 lds
v_mfma_f32_16x16x32_bf16 a[104:107], a[188:191], v[68:71], a[104:107]
v_mfma_f32_16x16x32_bf16 a[24:27], a[192:195], v[56:59], a[24:27]
v_mfma_f32_16x16x32_bf16 a[52:55], a[192:195], v[60:63], a[52:55]
v_mfma_f32_16x16x32_bf16 a[80:83], a[192:195], v[64:67], a[80:83]
v_mfma_f32_16x16x32_bf16 a[108:111], a[192:195], v[68:71], a[108:111]
s_waitcnt vmcnt(38) lgkmcnt(0)
v_mfma_f32_16x16x32_bf16 a[0:3], a[140:143], v[72:75], a[0:3]
v_mfma_f32_16x16x32_bf16 a[28:31], a[140:143], v[76:79], a[28:31]
ds_read_b128 a[168:171], v7 offset:35840
v_mfma_f32_16x16x32_bf16 a[56:59], a[140:143], v[80:83], a[56:59]
buffer_load_dwordx4 v[56:59], v0, s[12:15], s53 offen offset:3072 sc1
v_mfma_f32_16x16x32_bf16 a[84:87], a[140:143], v[84:87], a[84:87]
ds_read_b128 a[172:175], v7 offset:36864
v_mfma_f32_16x16x32_bf16 a[4:7], a[144:147], v[72:75], a[4:7]
v_mfma_f32_16x16x32_bf16 a[32:35], a[144:147], v[76:79], a[32:35]
v_mfma_f32_16x16x32_bf16 a[60:63], a[144:147], v[80:83], a[60:63]
ds_read_b128 a[176:179], v7 offset:37888
v_mfma_f32_16x16x32_bf16 a[88:91], a[144:147], v[84:87], a[88:91]
v_mfma_f32_16x16x32_bf16 a[8:11], a[148:151], v[72:75], a[8:11]
ds_read_b128 a[180:183], v7 offset:38912
buffer_load_dwordx4 v[60:63], v1, s[12:15], s53 offen offset:3072 sc1
v_mfma_f32_16x16x32_bf16 a[36:39], a[148:151], v[76:79], a[36:39]
v_mfma_f32_16x16x32_bf16 a[64:67], a[148:151], v[80:83], a[64:67]
v_mfma_f32_16x16x32_bf16 a[92:95], a[148:151], v[84:87], a[92:95]
ds_read_b128 a[184:187], v7 offset:39936
v_mfma_f32_16x16x32_bf16 a[12:15], a[152:155], v[72:75], a[12:15]
v_mfma_f32_16x16x32_bf16 a[40:43], a[152:155], v[76:79], a[40:43]
ds_read_b128 a[188:191], v7 offset:40960
v_mfma_f32_16x16x32_bf16 a[68:71], a[152:155], v[80:83], a[68:71]
buffer_load_dwordx4 v[64:67], v2, s[12:15], s53 offen offset:3072 sc1
v_mfma_f32_16x16x32_bf16 a[96:99], a[152:155], v[84:87], a[96:99]
v_mfma_f32_16x16x32_bf16 a[16:19], a[156:159], v[72:75], a[16:19]
ds_read_b128 a[192:195], v7 offset:41984
v_mfma_f32_16x16x32_bf16 a[44:47], a[156:159], v[76:79], a[44:47]
v_mfma_f32_16x16x32_bf16 a[72:75], a[156:159], v[80:83], a[72:75]
v_mfma_f32_16x16x32_bf16 a[100:103], a[156:159], v[84:87], a[100:103]
v_mfma_f32_16x16x32_bf16 a[20:23], a[160:163], v[72:75], a[20:23]
buffer_load_dwordx4 v[68:71], v3, s[12:15], s53 offen offset:3072 sc1
v_mfma_f32_16x16x32_bf16 a[48:51], a[160:163], v[76:79], a[48:51]
v_mfma_f32_16x16x32_bf16 a[76:79], a[160:163], v[80:83], a[76:79]
v_mfma_f32_16x16x32_bf16 a[104:107], a[160:163], v[84:87], a[104:107]
v_mfma_f32_16x16x32_bf16 a[24:27], a[164:167], v[72:75], a[24:27]
v_mfma_f32_16x16x32_bf16 a[52:55], a[164:167], v[76:79], a[52:55]
v_mfma_f32_16x16x32_bf16 a[80:83], a[164:167], v[80:83], a[80:83]
v_mfma_f32_16x16x32_bf16 a[108:111], a[164:167], v[84:87], a[108:111]
s_waitcnt vmcnt(38) lgkmcnt(0)
v_mfma_f32_16x16x32_bf16 a[0:3], a[168:171], v[88:91], a[0:3]
s_add_u32 s59, s53, 4096
v_mfma_f32_16x16x32_bf16 a[28:31], a[168:171], v[92:95], a[28:31]
ds_read_b128 a[140:143], v7 offset:43008
v_mfma_f32_16x16x32_bf16 a[56:59], a[168:171], v[96:99], a[56:59]
buffer_load_dwordx4 v[72:75], v0, s[12:15], s59 offen offset:0 sc1
v_mfma_f32_16x16x32_bf16 a[84:87], a[168:171], v[100:103], a[84:87]
ds_read_b128 a[144:147], v7 offset:44032
v_mfma_f32_16x16x32_bf16 a[4:7], a[172:175], v[88:91], a[4:7]
v_mfma_f32_16x16x32_bf16 a[32:35], a[172:175], v[92:95], a[32:35]
v_mfma_f32_16x16x32_bf16 a[60:63], a[172:175], v[96:99], a[60:63]
ds_read_b128 a[148:151], v7 offset:45056
v_mfma_f32_16x16x32_bf16 a[88:91], a[172:175], v[100:103], a[88:91]
v_mfma_f32_16x16x32_bf16 a[8:11], a[176:179], v[88:91], a[8:11]
ds_read_b128 a[152:155], v7 offset:46080
buffer_load_dwordx4 v[76:79], v1, s[12:15], s59 offen offset:0 sc1
v_mfma_f32_16x16x32_bf16 a[36:39], a[176:179], v[92:95], a[36:39]
v_mfma_f32_16x16x32_bf16 a[64:67], a[176:179], v[96:99], a[64:67]
v_mfma_f32_16x16x32_bf16 a[92:95], a[176:179], v[100:103], a[92:95]
ds_read_b128 a[156:159], v7 offset:47104
v_mfma_f32_16x16x32_bf16 a[12:15], a[180:183], v[88:91], a[12:15]
v_mfma_f32_16x16x32_bf16 a[40:43], a[180:183], v[92:95], a[40:43]
ds_read_b128 a[160:163], v7 offset:48128
v_mfma_f32_16x16x32_bf16 a[68:71], a[180:183], v[96:99], a[68:71]
buffer_load_dwordx4 v[80:83], v2, s[12:15], s59 offen offset:0 sc1
v_mfma_f32_16x16x32_bf16 a[96:99], a[180:183], v[100:103], a[96:99]
v_mfma_f32_16x16x32_bf16 a[16:19], a[184:187], v[88:91], a[16:19]
ds_read_b128 a[164:167], v7 offset:49152
v_mfma_f32_16x16x32_bf16 a[44:47], a[184:187], v[92:95], a[44:47]
v_mfma_f32_16x16x32_bf16 a[72:75], a[184:187], v[96:99], a[72:75]
v_mfma_f32_16x16x32_bf16 a[100:103], a[184:187], v[100:103], a[100:103]
v_mfma_f32_16x16x32_bf16 a[20:23], a[188:191], v[88:91], a[20:23]
buffer_load_dwordx4 v[84:87], v3, s[12:15], s59 offen offset:0 sc1
v_mfma_f32_16x16x32_bf16 a[48:51], a[188:191], v[92:95], a[48:51]
v_mfma_f32_16x16x32_bf16 a[76:79], a[188:191], v[96:99], a[76:79]
v_mfma_f32_16x16x32_bf16 a[104:107], a[188:191], v[100:103], a[104:107]
v_mfma_f32_16x16x32_bf16 a[24:27], a[192:195], v[88:91], a[24:27]
v_mfma_f32_16x16x32_bf16 a[52:55], a[192:195], v[92:95], a[52:55]
v_mfma_f32_16x16x32_bf16 a[80:83], a[192:195], v[96:99], a[80:83]
v_mfma_f32_16x16x32_bf16 a[108:111], a[192:195], v[100:103], a[108:111]
s_waitcnt vmcnt(38) lgkmcnt(0)
v_mfma_f32_16x16x32_bf16 a[0:3], a[140:143], v[104:107], a[0:3]
s_add_u32 s59, s53, 4096
v_mfma_f32_16x16x32_bf16 a[28:31], a[140:143], v[108:111], a[28:31]
ds_read_b128 a[168:171], v7 offset:50176
v_mfma_f32_16x16x32_bf16 a[56:59], a[140:143], v[112:115], a[56:59]
buffer_load_dwordx4 v[88:91], v0, s[12:15], s59 offen offset:1024 sc1
v_mfma_f32_16x16x32_bf16 a[84:87], a[140:143], v[116:119], a[84:87]
ds_read_b128 a[172:175], v7 offset:51200
v_mfma_f32_16x16x32_bf16 a[4:7], a[144:147], v[104:107], a[4:7]
v_mfma_f32_16x16x32_bf16 a[32:35], a[144:147], v[108:111], a[32:35]
v_mfma_f32_16x16x32_bf16 a[60:63], a[144:147], v[112:115], a[60:63]
ds_read_b128 a[176:179], v7 offset:52224
v_mfma_f32_16x16x32_bf16 a[88:91], a[144:147], v[116:119], a[88:91]
v_mfma_f32_16x16x32_bf16 a[8:11], a[148:151], v[104:107], a[8:11]
ds_read_b128 a[180:183], v7 offset:53248
buffer_load_dwordx4 v[92:95], v1, s[12:15], s59 offen offset:1024 sc1
v_mfma_f32_16x16x32_bf16 a[36:39], a[148:151], v[108:111], a[36:39]
v_mfma_f32_16x16x32_bf16 a[64:67], a[148:151], v[112:115], a[64:67]
v_mfma_f32_16x16x32_bf16 a[92:95], a[148:151], v[116:119], a[92:95]
ds_read_b128 a[184:187], v7 offset:54272
v_mfma_f32_16x16x32_bf16 a[12:15], a[152:155], v[104:107], a[12:15]
v_mfma_f32_16x16x32_bf16 a[40:43], a[152:155], v[108:111], a[40:43]
ds_read_b128 a[188:191], v7 offset:55296
v_mfma_f32_16x16x32_bf16 a[68:71], a[152:155], v[112:115], a[68:71]
buffer_load_dwordx4 v[96:99], v2, s[12:15], s59 offen offset:1024 sc1
v_mfma_f32_16x16x32_bf16 a[96:99], a[152:155], v[116:119], a[96:99]
v_mfma_f32_16x16x32_bf16 a[16:19], a[156:159], v[104:107], a[16:19]
ds_read_b128 a[192:195], v7 offset:56320
v_mfma_f32_16x16x32_bf16 a[44:47], a[156:159], v[108:111], a[44:47]
v_mfma_f32_16x16x32_bf16 a[72:75], a[156:159], v[112:115], a[72:75]
v_mfma_f32_16x16x32_bf16 a[100:103], a[156:159], v[116:119], a[100:103]
v_mfma_f32_16x16x32_bf16 a[20:23], a[160:163], v[104:107], a[20:23]
buffer_load_dwordx4 v[100:103], v3, s[12:15], s59 offen offset:1024 sc1
v_mfma_f32_16x16x32_bf16 a[48:51], a[160:163], v[108:111], a[48:51]
v_mfma_f32_16x16x32_bf16 a[76:79], a[160:163], v[112:115], a[76:79]
v_mfma_f32_16x16x32_bf16 a[104:107], a[160:163], v[116:119], a[104:107]
v_mfma_f32_16x16x32_bf16 a[24:27], a[164:167], v[104:107], a[24:27]
v_mfma_f32_16x16x32_bf16 a[52:55], a[164:167], v[108:111], a[52:55]
v_mfma_f32_16x16x32_bf16 a[80:83], a[164:167], v[112:115], a[80:83]
v_mfma_f32_16x16x32_bf16 a[108:111], a[164:167], v[116:119], a[108:111]
s_waitcnt vmcnt(38) lgkmcnt(0)
v_mfma_f32_16x16x32_bf16 a[0:3], a[168:171], v[120:123], a[0:3]
s_waitcnt vmcnt(12)
s_barrier
v_mfma_f32_16x16x32_bf16 a[28:31], a[168:171], v[124:127], a[28:31]
ds_read_b128 a[140:143], v5 offset:0
s_add_u32 s59, s53, 4096
v_mfma_f32_16x16x32_bf16 a[56:59], a[168:171], v[128:131], a[56:59]
buffer_load_dwordx4 v[104:107], v0, s[12:15], s59 offen offset:2048 sc1
v_mfma_f32_16x16x32_bf16 a[84:87], a[168:171], v[132:135], a[84:87]
ds_read_b128 a[144:147], v5 offset:1024
v_mfma_f32_16x16x32_bf16 a[4:7], a[172:175], v[120:123], a[4:7]
v_mfma_f32_16x16x32_bf16 a[32:35], a[172:175], v[124:127], a[32:35]
buffer_load_dwordx4 v[108:111], v1, s[12:15], s59 offen offset:2048 sc1
v_mfma_f32_16x16x32_bf16 a[60:63], a[172:175], v[128:131], a[60:63]
ds_read_b128 a[148:151], v5 offset:2048
v_mfma_f32_16x16x32_bf16 a[88:91], a[172:175], v[132:135], a[88:91]
v_mfma_f32_16x16x32_bf16 a[8:11], a[176:179], v[120:123], a[8:11]
ds_read_b128 a[152:155], v5 offset:3072
buffer_load_dwordx4 v[112:115], v2, s[12:15], s59 offen offset:2048 sc1
v_mfma_f32_16x16x32_bf16 a[36:39], a[176:179], v[124:127], a[36:39]
v_mfma_f32_16x16x32_bf16 a[64:67], a[176:179], v[128:131], a[64:67]
v_mfma_f32_16x16x32_bf16 a[92:95], a[176:179], v[132:135], a[92:95]
ds_read_b128 a[156:159], v5 offset:4096
buffer_load_dwordx4 v[116:119], v3, s[12:15], s59 offen offset:2048 sc1
v_mfma_f32_16x16x32_bf16 a[12:15], a[180:183], v[120:123], a[12:15]
s_add_u32 m0, s63, 57344
s_add_u32 s58, s62, 0
v_mfma_f32_16x16x32_bf16 a[40:43], a[180:183], v[124:127], a[40:43]
ds_read_b128 a[160:163], v5 offset:5120
v_mfma_f32_16x16x32_bf16 a[68:71], a[180:183], v[128:131], a[68:71]
buffer_load_dwordx4 v6, s[16:19], s58 offen offset:0 sc1 lds
v_mfma_f32_16x16x32_bf16 a[96:99], a[180:183], v[132:135], a[96:99]
v_mfma_f32_16x16x32_bf16 a[16:19], a[184:187], v[120:123], a[16:19]
ds_read_b128 a[164:167], v5 offset:6144
v_mfma_f32_16x16x32_bf16 a[44:47], a[184:187], v[124:127], a[44:47]
buffer_load_dwordx4 v6, s[16:19], s58 offen offset:1024 sc1 lds
v_mfma_f32_16x16x32_bf16 a[72:75], a[184:187], v[128:131], a[72:75]
v_mfma_f32_16x16x32_bf16 a[100:103], a[184:187], v[132:135], a[100:103]
v_mfma_f32_16x16x32_bf16 a[20:23], a[188:191], v[120:123], a[20:23]
buffer_load_dwordx4 v6, s[16:19], s58 offen offset:2048 sc1 lds
v_mfma_f32_16x16x32_bf16 a[48:51], a[188:191], v[124:127], a[48:51]
v_mfma_f32_16x16x32_bf16 a[76:79], a[188:191], v[128:131], a[76:79]
v_mfma_f32_16x16x32_bf16 a[104:107], a[188:191], v[132:135], a[104:107]
buffer_load_dwordx4 v6, s[16:19], s58 offen offset:3072 sc1 lds
v_mfma_f32_16x16x32_bf16 a[24:27], a[192:195], v[120:123], a[24:27]
v_mfma_f32_16x16x32_bf16 a[52:55], a[192:195], v[124:127], a[52:55]
v_mfma_f32_16x16x32_bf16 a[80:83], a[192:195], v[128:131], a[80:83]
v_mfma_f32_16x16x32_bf16 a[108:111], a[192:195], v[132:135], a[108:111]
s_waitcnt vmcnt(63) lgkmcnt(0)
v_mfma_f32_16x16x32_bf16 a[0:3], a[140:143], v[8:11], a[0:3]
s_add_u32 s59, s53, 4096
v_mfma_f32_16x16x32_bf16 a[28:31], a[140:143], v[12:15], a[28:31]
ds_read_b128 a[168:171], v5 offset:7168
v_mfma_f32_16x16x32_bf16 a[56:59], a[140:143], v[16:19], a[56:59]
buffer_load_dwordx4 v[120:123], v0, s[12:15], s59 offen offset:3072 sc1
v_mfma_f32_16x16x32_bf16 a[84:87], a[140:143], v[20:23], a[84:87]
ds_read_b128 a[172:175], v5 offset:8192
v_mfma_f32_16x16x32_bf16 a[4:7], a[144:147], v[8:11], a[4:7]
v_mfma_f32_16x16x32_bf16 a[32:35], a[144:147], v[12:15], a[32:35]
buffer_load_dwordx4 v[124:127], v1, s[12:15], s59 offen offset:3072 sc1
v_mfma_f32_16x16x32_bf16 a[60:63], a[144:147], v[16:19], a[60:63]
ds_read_b128 a[176:179], v5 offset:9216
v_mfma_f32_16x16x32_bf16 a[88:91], a[144:147], v[20:23], a[88:91]
v_mfma_f32_16x16x32_bf16 a[8:11], a[148:151], v[8:11], a[8:11]
ds_read_b128 a[180:183], v5 offset:10240
buffer_load_dwordx4 v[128:131], v2, s[12:15], s59 offen offset:3072 sc1
v_mfma_f32_16x16x32_bf16 a[36:39], a[148:151], v[12:15], a[36:39]
v_mfma_f32_16x16x32_bf16 a[64:67], a[148:151], v[16:19], a[64:67]
v_mfma_f32_16x16x32_bf16 a[92:95], a[148:151], v[20:23], a[92:95]
ds_read_b128 a[184:187], v5 offset:11264
v_mfma_f32_16x16x32_bf16 a[12:15], a[152:155], v[8:11], a[12:15]
buffer_load_dwordx4 v[132:135], v3, s[12:15], s59 offen offset:3072 sc1
v_mfma_f32_16x16x32_bf16 a[40:43], a[152:155], v[12:15], a[40:43]
ds_read_b128 a[188:191], v5 offset:12288
s_add_u32 m0, s63, 61440
v_mfma_f32_16x16x32_bf16 a[68:71], a[152:155], v[16:19], a[68:71]
s_add_u32 s58, s62, 4096
v_mfma_f32_16x16x32_bf16 a[96:99], a[152:155], v[20:23], a[96:99]
buffer_load_dwordx4 v6, s[16:19], s58 offen offset:0 sc1 lds
v_mfma_f32_16x16x32_bf16 a[16:19], a[156:159], v[8:11], a[16:19]
ds_read_b128 a[192:195], v5 offset:13312
v_mfma_f32_16x16x32_bf16 a[44:47], a[156:159], v[12:15], a[44:47]
v_mfma_f32_16x16x32_bf16 a[72:75], a[156:159], v[16:19], a[72:75]
v_mfma_f32_16x16x32_bf16 a[100:103], a[156:159], v[20:23], a[100:103]
buffer_load_dwordx4 v6, s[16:19], s58 offen offset:1024 sc1 lds
v_mfma_f32_16x16x32_bf16 a[20:23], a[160:163], v[8:11], a[20:23]
v_mfma_f32_16x16x32_bf16 a[48:51], a[160:163], v[12:15], a[48:51]
v_mfma_f32_16x16x32_bf16 a[76:79], a[160:163], v[16:19], a[76:79]
buffer_load_dwordx4 v6, s[16:19], s58 offen offset:2048 sc1 lds
v_mfma_f32_16x16x32_bf16 a[104:107], a[160:163], v[20:23], a[104:107]
v_mfma_f32_16x16x32_bf16 a[24:27], a[164:167], v[8:11], a[24:27]
v_mfma_f32_16x16x32_bf16 a[52:55], a[164:167], v[12:15], a[52:55]
v_mfma_f32_16x16x32_bf16 a[80:83], a[164:167], v[16:19], a[80:83]
v_mfma_f32_16x16x32_bf16 a[108:111], a[164:167], v[20:23], a[108:111]
s_waitcnt vmcnt(63) lgkmcnt(0)
v_mfma_f32_16x16x32_bf16 a[0:3], a[168:171], v[24:27], a[0:3]
v_mfma_f32_16x16x32_bf16 a[28:31], a[168:171], v[28:31], a[28:31]
ds_read_b128 a[140:143], v5 offset:14336
v_mfma_f32_16x16x32_bf16 a[56:59], a[168:171], v[32:35], a[56:59]
buffer_load_dwordx4 v[8:11], v0, s[12:15], s54 offen offset:0 sc1
v_mfma_f32_16x16x32_bf16 a[84:87], a[168:171], v[36:39], a[84:87]
ds_read_b128 a[144:147], v5 offset:15360
v_mfma_f32_16x16x32_bf16 a[4:7], a[172:175], v[24:27], a[4:7]
v_mfma_f32_16x16x32_bf16 a[32:35], a[172:175], v[28:31], a[32:35]
buffer_load_dwordx4 v[12:15], v1, s[12:15], s54 offen offset:0 sc1
v_mfma_f32_16x16x32_bf16 a[60:63], a[172:175], v[32:35], a[60:63]
ds_read_b128 a[148:151], v5 offset:16384
v_mfma_f32_16x16x32_bf16 a[88:91], a[172:175], v[36:39], a[88:91]
v_mfma_f32_16x16x32_bf16 a[8:11], a[176:179], v[24:27], a[8:11]
ds_read_b128 a[152:155], v5 offset:17408
buffer_load_dwordx4 v[16:19], v2, s[12:15], s54 offen offset:0 sc1
v_mfma_f32_16x16x32_bf16 a[36:39], a[176:179], v[28:31], a[36:39]
v_mfma_f32_16x16x32_bf16 a[64:67], a[176:179], v[32:35], a[64:67]
v_mfma_f32_16x16x32_bf16 a[92:95], a[176:179], v[36:39], a[92:95]
ds_read_b128 a[156:159], v5 offset:18432
buffer_load_dwordx4 v[20:23], v3, s[12:15], s54 offen offset:0 sc1
v_mfma_f32_16x16x32_bf16 a[12:15], a[180:183], v[24:27], a[12:15]
s_add_u32 m0, s63, 86016
s_add_u32 s58, s62, 114688
v_mfma_f32_16x16x32_bf16 a[40:43], a[180:183], v[28:31], a[40:43]
ds_read_b128 a[160:163], v5 offset:19456
v_mfma_f32_16x16x32_bf16 a[68:71], a[180:183], v[32:35], a[68:71]
buffer_load_dwordx4 v6, s[16:19], s58 offen offset:0 sc1 lds
v_mfma_f32_16x16x32_bf16 a[96:99], a[180:183], v[36:39], a[96:99]
v_mfma_f32_16x16x32_bf16 a[16:19], a[184:187], v[24:27], a[16:19]
ds_read_b128 a[164:167], v5 offset:20480
v_mfma_f32_16x16x32_bf16 a[44:47], a[184:187], v[28:31], a[44:47]
buffer_load_dwordx4 v6, s[16:19], s58 offen offset:1024 sc1 lds
v_mfma_f32_16x16x32_bf16 a[72:75], a[184:187], v[32:35], a[72:75]
v_mfma_f32_16x16x32_bf16 a[100:103], a[184:187], v[36:39], a[100:103]
v_mfma_f32_16x16x32_bf16 a[20:23], a[188:191], v[24:27], a[20:23]
buffer_load_dwordx4 v6, s[16:19], s58 offen offset:2048 sc1 lds
v_mfma_f32_16x16x32_bf16 a[48:51], a[188:191], v[28:31], a[48:51]
v_mfma_f32_16x16x32_bf16 a[76:79], a[188:191], v[32:35], a[76:79]
v_mfma_f32_16x16x32_bf16 a[104:107], a[188:191], v[36:39], a[104:107]
buffer_load_dwordx4 v6, s[16:19], s58 offen offset:3072 sc1 lds
v_mfma_f32_16x16x32_bf16 a[24:27], a[192:195], v[24:27], a[24:27]
v_mfma_f32_16x16x32_bf16 a[52:55], a[192:195], v[28:31], a[52:55]
v_mfma_f32_16x16x32_bf16 a[80:83], a[192:195], v[32:35], a[80:83]
v_mfma_f32_16x16x32_bf16 a[108:111], a[192:195], v[36:39], a[108:111]
s_waitcnt vmcnt(63) lgkmcnt(0)
v_mfma_f32_16x16x32_bf16 a[0:3], a[140:143], v[40:43], a[0:3]
v_mfma_f32_16x16x32_bf16 a[28:31], a[140:143], v[44:47], a[28:31]
ds_read_b128 a[168:171], v5 offset:21504
v_mfma_f32_16x16x32_bf16 a[56:59], a[140:143], v[48:51], a[56:59]
buffer_load_dwordx4 v[24:27], v0, s[12:15], s54 offen offset:1024 sc1
v_mfma_f32_16x16x32_bf16 a[84:87], a[140:143], v[52:55], a[84:87]
ds_read_b128 a[172:175], v5 offset:22528
v_mfma_f32_16x16x32_bf16 a[4:7], a[144:147], v[40:43], a[4:7]
v_mfma_f32_16x16x32_bf16 a[32:35], a[144:147], v[44:47], a[32:35]
buffer_load_dwordx4 v[28:31], v1, s[12:15], s54 offen offset:1024 sc1
v_mfma_f32_16x16x32_bf16 a[60:63], a[144:147], v[48:51], a[60:63]
ds_read_b128 a[176:179], v5 offset:23552
v_mfma_f32_16x16x32_bf16 a[88:91], a[144:147], v[52:55], a[88:91]
v_mfma_f32_16x16x32_bf16 a[8:11], a[148:151], v[40:43], a[8:11]
ds_read_b128 a[180:183], v5 offset:24576
buffer_load_dwordx4 v[32:35], v2, s[12:15], s54 offen offset:1024 sc1
v_mfma_f32_16x16x32_bf16 a[36:39], a[148:151], v[44:47], a[36:39]
v_mfma_f32_16x16x32_bf16 a[64:67], a[148:151], v[48:51], a[64:67]
v_mfma_f32_16x16x32_bf16 a[92:95], a[148:151], v[52:55], a[92:95]
ds_read_b128 a[184:187], v5 offset:25600
v_mfma_f32_16x16x32_bf16 a[12:15], a[152:155], v[40:43], a[12:15]
buffer_load_dwordx4 v[36:39], v3, s[12:15], s54 offen offset:1024 sc1
v_mfma_f32_16x16x32_bf16 a[40:43], a[152:155], v[44:47], a[40:43]
ds_read_b128 a[188:191], v5 offset:26624
s_add_u32 m0, s63, 90112
v_mfma_f32_16x16x32_bf16 a[68:71], a[152:155], v[48:51], a[68:71]
s_add_u32 s58, s62, 118784
v_mfma_f32_16x16x32_bf16 a[96:99], a[152:155], v[52:55], a[96:99]
buffer_load_dwordx4 v6, s[16:19], s58 offen offset:0 sc1 lds
v_mfma_f32_16x16x32_bf16 a[16:19], a[156:159], v[40:43], a[16:19]
ds_read_b128 a[192:195], v5 offset:27648
v_mfma_f32_16x16x32_bf16 a[44:47], a[156:159], v[44:47], a[44:47]
v_mfma_f32_16x16x32_bf16 a[72:75], a[156:159], v[48:51], a[72:75]
v_mfma_f32_16x16x32_bf16 a[100:103], a[156:159], v[52:55], a[100:103]
buffer_load_dwordx4 v6, s[16:19], s58 offen offset:1024 sc1 lds
v_mfma_f32_16x16x32_bf16 a[20:23], a[160:163], v[40:43], a[20:23]
v_mfma_f32_16x16x32_bf16 a[48:51], a[160:163], v[44:47], a[48:51]
v_mfma_f32_16x16x32_bf16 a[76:79], a[160:163], v[48:51], a[76:79]
buffer_load_dwordx4 v6, s[16:19], s58 offen offset:2048 sc1 lds
v_mfma_f32_16x16x32_bf16 a[104:107], a[160:163], v[52:55], a[104:107]
v_mfma_f32_16x16x32_bf16 a[24:27], a[164:167], v[40:43], a[24:27]
v_mfma_f32_16x16x32_bf16 a[52:55], a[164:167], v[44:47], a[52:55]
v_mfma_f32_16x16x32_bf16 a[80:83], a[164:167], v[48:51], a[80:83]
v_mfma_f32_16x16x32_bf16 a[108:111], a[164:167], v[52:55], a[108:111]
s_waitcnt vmcnt(38) lgkmcnt(0)
v_mfma_f32_16x16x32_bf16 a[0:3], a[168:171], v[56:59], a[0:3]
v_mfma_f32_16x16x32_bf16 a[28:31], a[168:171], v[60:63], a[28:31]
ds_read_b128 a[140:143], v5 offset:28672
v_mfma_f32_16x16x32_bf16 a[56:59], a[168:171], v[64:67], a[56:59]
buffer_load_dwordx4 v[40:43], v0, s[12:15], s54 offen offset:2048 sc1
v_mfma_f32_16x16x32_bf16 a[84:87], a[168:171], v[68:71], a[84:87]
ds_read_b128 a[144:147], v5 offset:29696
v_mfma_f32_16x16x32_bf16 a[4:7], a[172:175], v[56:59], a[4:7]
v_mfma_f32_16x16x32_bf16 a[32:35], a[172:175], v[60:63], a[32:35]
v_mfma_f32_16x16x32_bf16 a[60:63], a[172:175], v[64:67], a[60:63]
ds_read_b128 a[148:151], v5 offset:30720
v_mfma_f32_16x16x32_bf16 a[88:91], a[172:175], v[68:71], a[88:91]
v_mfma_f32_16x16x32_bf16 a[8:11], a[176:179], v[56:59], a[8:11]
ds_read_b128 a[152:155], v5 offset:31744
buffer_load_dwordx4 v[44:47], v1, s[12:15], s54 offen offset:2048 sc1
v_mfma_f32_16x16x32_bf16 a[36:39], a[176:179], v[60:63], a[36:39]
v_mfma_f32_16x16x32_bf16 a[64:67], a[176:179], v[64:67], a[64:67]
v_mfma_f32_16x16x32_bf16 a[92:95], a[176:179], v[68:71], a[92:95]
ds_read_b128 a[156:159], v5 offset:32768
v_mfma_f32_16x16x32_bf16 a[12:15], a[180:183], v[56:59], a[12:15]
v_mfma_f32_16x16x32_bf16 a[40:43], a[180:183], v[60:63], a[40:43]
ds_read_b128 a[160:163], v5 offset:33792
v_mfma_f32_16x16x32_bf16 a[68:71], a[180:183], v[64:67], a[68:71]
buffer_load_dwordx4 v[48:51], v2, s[12:15], s54 offen offset:2048 sc1
v_mfma_f32_16x16x32_bf16 a[96:99], a[180:183], v[68:71], a[96:99]
v_mfma_f32_16x16x32_bf16 a[16:19], a[184:187], v[56:59], a[16:19]
ds_read_b128 a[164:167], v5 offset:34816
v_mfma_f32_16x16x32_bf16 a[44:47], a[184:187], v[60:63], a[44:47]
v_mfma_f32_16x16x32_bf16 a[72:75], a[184:187], v[64:67], a[72:75]
v_mfma_f32_16x16x32_bf16 a[100:103], a[184:187], v[68:71], a[100:103]
v_mfma_f32_16x16x32_bf16 a[20:23], a[188:191], v[56:59], a[20:23]
buffer_load_dwordx4 v[52:55], v3, s[12:15], s54 offen offset:2048 sc1
v_mfma_f32_16x16x32_bf16 a[48:51], a[188:191], v[60:63], a[48:51]
v_mfma_f32_16x16x32_bf16 a[76:79], a[188:191], v[64:67], a[76:79]
v_mfma_f32_16x16x32_bf16 a[104:107], a[188:191], v[68:71], a[104:107]
v_mfma_f32_16x16x32_bf16 a[24:27], a[192:195], v[56:59], a[24:27]
v_mfma_f32_16x16x32_bf16 a[52:55], a[192:195], v[60:63], a[52:55]
v_mfma_f32_16x16x32_bf16 a[80:83], a[192:195], v[64:67], a[80:83]
v_mfma_f32_16x16x32_bf16 a[108:111], a[192:195], v[68:71], a[108:111]
s_waitcnt vmcnt(38) lgkmcnt(0)
v_mfma_f32_16x16x32_bf16 a[0:3], a[140:143], v[72:75], a[0:3]
v_mfma_f32_16x16x32_bf16 a[28:31], a[140:143], v[76:79], a[28:31]
ds_read_b128 a[168:171], v5 offset:35840
v_mfma_f32_16x16x32_bf16 a[56:59], a[140:143], v[80:83], a[56:59]
buffer_load_dwordx4 v[56:59], v0, s[12:15], s54 offen offset:3072 sc1
v_mfma_f32_16x16x32_bf16 a[84:87], a[140:143], v[84:87], a[84:87]
ds_read_b128 a[172:175], v5 offset:36864
v_mfma_f32_16x16x32_bf16 a[4:7], a[144:147], v[72:75], a[4:7]
v_mfma_f32_16x16x32_bf16 a[32:35], a[144:147], v[76:79], a[32:35]
v_mfma_f32_16x16x32_bf16 a[60:63], a[144:147], v[80:83], a[60:63]
ds_read_b128 a[176:179], v5 offset:37888
v_mfma_f32_16x16x32_bf16 a[88:91], a[144:147], v[84:87], a[88:91]
v_mfma_f32_16x16x32_bf16 a[8:11], a[148:151], v[72:75], a[8:11]
ds_read_b128 a[180:183], v5 offset:38912
buffer_load_dwordx4 v[60:63], v1, s[12:15], s54 offen offset:3072 sc1
v_mfma_f32_16x16x32_bf16 a[36:39], a[148:151], v[76:79], a[36:39]
v_mfma_f32_16x16x32_bf16 a[64:67], a[148:151], v[80:83], a[64:67]
v_mfma_f32_16x16x32_bf16 a[92:95], a[148:151], v[84:87], a[92:95]
ds_read_b128 a[184:187], v5 offset:39936
v_mfma_f32_16x16x32_bf16 a[12:15], a[152:155], v[72:75], a[12:15]
v_mfma_f32_16x16x32_bf16 a[40:43], a[152:155], v[76:79], a[40:43]
ds_read_b128 a[188:191], v5 offset:40960
v_mfma_f32_16x16x32_bf16 a[68:71], a[152:155], v[80:83], a[68:71]
buffer_load_dwordx4 v[64:67], v2, s[12:15], s54 offen offset:3072 sc1
v_mfma_f32_16x16x32_bf16 a[96:99], a[152:155], v[84:87], a[96:99]
v_mfma_f32_16x16x32_bf16 a[16:19], a[156:159], v[72:75], a[16:19]
ds_read_b128 a[192:195], v5 offset:41984
v_mfma_f32_16x16x32_bf16 a[44:47], a[156:159], v[76:79], a[44:47]
v_mfma_f32_16x16x32_bf16 a[72:75], a[156:159], v[80:83], a[72:75]
v_mfma_f32_16x16x32_bf16 a[100:103], a[156:159], v[84:87], a[100:103]
v_mfma_f32_16x16x32_bf16 a[20:23], a[160:163], v[72:75], a[20:23]
buffer_load_dwordx4 v[68:71], v3, s[12:15], s54 offen offset:3072 sc1
v_mfma_f32_16x16x32_bf16 a[48:51], a[160:163], v[76:79], a[48:51]
v_mfma_f32_16x16x32_bf16 a[76:79], a[160:163], v[80:83], a[76:79]
v_mfma_f32_16x16x32_bf16 a[104:107], a[160:163], v[84:87], a[104:107]
v_mfma_f32_16x16x32_bf16 a[24:27], a[164:167], v[72:75], a[24:27]
v_mfma_f32_16x16x32_bf16 a[52:55], a[164:167], v[76:79], a[52:55]
v_mfma_f32_16x16x32_bf16 a[80:83], a[164:167], v[80:83], a[80:83]
v_mfma_f32_16x16x32_bf16 a[108:111], a[164:167], v[84:87], a[108:111]
s_waitcnt vmcnt(38) lgkmcnt(0)
v_mfma_f32_16x16x32_bf16 a[0:3], a[168:171], v[88:91], a[0:3]
s_add_u32 s59, s54, 4096
v_mfma_f32_16x16x32_bf16 a[28:31], a[168:171], v[92:95], a[28:31]
ds_read_b128 a[140:143], v5 offset:43008
v_mfma_f32_16x16x32_bf16 a[56:59], a[168:171], v[96:99], a[56:59]
buffer_load_dwordx4 v[72:75], v0, s[12:15], s59 offen offset:0 sc1
v_mfma_f32_16x16x32_bf16 a[84:87], a[168:171], v[100:103], a[84:87]
ds_read_b128 a[144:147], v5 offset:44032
v_mfma_f32_16x16x32_bf16 a[4:7], a[172:175], v[88:91], a[4:7]
v_mfma_f32_16x16x32_bf16 a[32:35], a[172:175], v[92:95], a[32:35]
v_mfma_f32_16x16x32_bf16 a[60:63], a[172:175], v[96:99], a[60:63]
ds_read_b128 a[148:151], v5 offset:45056
v_mfma_f32_16x16x32_bf16 a[88:91], a[172:175], v[100:103], a[88:91]
v_mfma_f32_16x16x32_bf16 a[8:11], a[176:179], v[88:91], a[8:11]
ds_read_b128 a[152:155], v5 offset:46080
buffer_load_dwordx4 v[76:79], v1, s[12:15], s59 offen offset:0 sc1
v_mfma_f32_16x16x32_bf16 a[36:39], a[176:179], v[92:95], a[36:39]
v_mfma_f32_16x16x32_bf16 a[64:67], a[176:179], v[96:99], a[64:67]
v_mfma_f32_16x16x32_bf16 a[92:95], a[176:179], v[100:103], a[92:95]
ds_read_b128 a[156:159], v5 offset:47104
v_mfma_f32_16x16x32_bf16 a[12:15], a[180:183], v[88:91], a[12:15]
v_mfma_f32_16x16x32_bf16 a[40:43], a[180:183], v[92:95], a[40:43]
ds_read_b128 a[160:163], v5 offset:48128
v_mfma_f32_16x16x32_bf16 a[68:71], a[180:183], v[96:99], a[68:71]
buffer_load_dwordx4 v[80:83], v2, s[12:15], s59 offen offset:0 sc1
v_mfma_f32_16x16x32_bf16 a[96:99], a[180:183], v[100:103], a[96:99]
v_mfma_f32_16x16x32_bf16 a[16:19], a[184:187], v[88:91], a[16:19]
ds_read_b128 a[164:167], v5 offset:49152
v_mfma_f32_16x16x32_bf16 a[44:47], a[184:187], v[92:95], a[44:47]
v_mfma_f32_16x16x32_bf16 a[72:75], a[184:187], v[96:99], a[72:75]
v_mfma_f32_16x16x32_bf16 a[100:103], a[184:187], v[100:103], a[100:103]
v_mfma_f32_16x16x32_bf16 a[20:23], a[188:191], v[88:91], a[20:23]
buffer_load_dwordx4 v[84:87], v3, s[12:15], s59 offen offset:0 sc1
v_mfma_f32_16x16x32_bf16 a[48:51], a[188:191], v[92:95], a[48:51]
v_mfma_f32_16x16x32_bf16 a[76:79], a[188:191], v[96:99], a[76:79]
v_mfma_f32_16x16x32_bf16 a[104:107], a[188:191], v[100:103], a[104:107]
v_mfma_f32_16x16x32_bf16 a[24:27], a[192:195], v[88:91], a[24:27]
v_mfma_f32_16x16x32_bf16 a[52:55], a[192:195], v[92:95], a[52:55]
v_mfma_f32_16x16x32_bf16 a[80:83], a[192:195], v[96:99], a[80:83]
v_mfma_f32_16x16x32_bf16 a[108:111], a[192:195], v[100:103], a[108:111]
s_waitcnt vmcnt(38) lgkmcnt(0)
v_mfma_f32_16x16x32_bf16 a[0:3], a[140:143], v[104:107], a[0:3]
s_add_u32 s59, s54, 4096
v_mfma_f32_16x16x32_bf16 a[28:31], a[140:143], v[108:111], a[28:31]
ds_read_b128 a[168:171], v5 offset:50176
v_mfma_f32_16x16x32_bf16 a[56:59], a[140:143], v[112:115], a[56:59]
buffer_load_dwordx4 v[88:91], v0, s[12:15], s59 offen offset:1024 sc1
v_mfma_f32_16x16x32_bf16 a[84:87], a[140:143], v[116:119], a[84:87]
ds_read_b128 a[172:175], v5 offset:51200
v_mfma_f32_16x16x32_bf16 a[4:7], a[144:147], v[104:107], a[4:7]
v_mfma_f32_16x16x32_bf16 a[32:35], a[144:147], v[108:111], a[32:35]
v_mfma_f32_16x16x32_bf16 a[60:63], a[144:147], v[112:115], a[60:63]
ds_read_b128 a[176:179], v5 offset:52224
v_mfma_f32_16x16x32_bf16 a[88:91], a[144:147], v[116:119], a[88:91]
v_mfma_f32_16x16x32_bf16 a[8:11], a[148:151], v[104:107], a[8:11]
ds_read_b128 a[180:183], v5 offset:53248
buffer_load_dwordx4 v[92:95], v1, s[12:15], s59 offen offset:1024 sc1
v_mfma_f32_16x16x32_bf16 a[36:39], a[148:151], v[108:111], a[36:39]
v_mfma_f32_16x16x32_bf16 a[64:67], a[148:151], v[112:115], a[64:67]
v_mfma_f32_16x16x32_bf16 a[92:95], a[148:151], v[116:119], a[92:95]
ds_read_b128 a[184:187], v5 offset:54272
v_mfma_f32_16x16x32_bf16 a[12:15], a[152:155], v[104:107], a[12:15]
v_mfma_f32_16x16x32_bf16 a[40:43], a[152:155], v[108:111], a[40:43]
ds_read_b128 a[188:191], v5 offset:55296
v_mfma_f32_16x16x32_bf16 a[68:71], a[152:155], v[112:115], a[68:71]
buffer_load_dwordx4 v[96:99], v2, s[12:15], s59 offen offset:1024 sc1
v_mfma_f32_16x16x32_bf16 a[96:99], a[152:155], v[116:119], a[96:99]
v_mfma_f32_16x16x32_bf16 a[16:19], a[156:159], v[104:107], a[16:19]
ds_read_b128 a[192:195], v5 offset:56320
v_mfma_f32_16x16x32_bf16 a[44:47], a[156:159], v[108:111], a[44:47]
v_mfma_f32_16x16x32_bf16 a[72:75], a[156:159], v[112:115], a[72:75]
v_mfma_f32_16x16x32_bf16 a[100:103], a[156:159], v[116:119], a[100:103]
v_mfma_f32_16x16x32_bf16 a[20:23], a[160:163], v[104:107], a[20:23]
buffer_load_dwordx4 v[100:103], v3, s[12:15], s59 offen offset:1024 sc1
v_mfma_f32_16x16x32_bf16 a[48:51], a[160:163], v[108:111], a[48:51]
v_mfma_f32_16x16x32_bf16 a[76:79], a[160:163], v[112:115], a[76:79]
v_mfma_f32_16x16x32_bf16 a[104:107], a[160:163], v[116:119], a[104:107]
v_mfma_f32_16x16x32_bf16 a[24:27], a[164:167], v[104:107], a[24:27]
v_mfma_f32_16x16x32_bf16 a[52:55], a[164:167], v[108:111], a[52:55]
v_mfma_f32_16x16x32_bf16 a[80:83], a[164:167], v[112:115], a[80:83]
v_mfma_f32_16x16x32_bf16 a[108:111], a[164:167], v[116:119], a[108:111]
s_waitcnt vmcnt(34) lgkmcnt(0)
v_mfma_f32_16x16x32_bf16 a[0:3], a[168:171], v[120:123], a[0:3]
s_waitcnt vmcnt(16)
s_barrier
v_mfma_f32_16x16x32_bf16 a[28:31], a[168:171], v[124:127], a[28:31]
ds_read_b128 a[140:143], v7 offset:0
s_add_u32 s59, s54, 4096
v_mfma_f32_16x16x32_bf16 a[56:59], a[168:171], v[128:131], a[56:59]
buffer_load_dwordx4 v[104:107], v0, s[12:15], s59 offen offset:2048 sc1
v_mfma_f32_16x16x32_bf16 a[84:87], a[168:171], v[132:135], a[84:87]
v_mfma_f32_16x16x32_bf16 a[4:7], a[172:175], v[120:123], a[4:7]
v_mfma_f32_16x16x32_bf16 a[32:35], a[172:175], v[124:127], a[32:35]
ds_read_b128 a[144:147], v7 offset:1024
v_mfma_f32_16x16x32_bf16 a[60:63], a[172:175], v[128:131], a[60:63]
v_mfma_f32_16x16x32_bf16 a[88:91], a[172:175], v[132:135], a[88:91]
v_mfma_f32_16x16x32_bf16 a[8:11], a[176:179], v[120:123], a[8:11]
buffer_load_dwordx4 v[108:111], v1, s[12:15], s59 offen offset:2048 sc1
v_mfma_f32_16x16x32_bf16 a[36:39], a[176:179], v[124:127], a[36:39]
v_mfma_f32_16x16x32_bf16 a[64:67], a[176:179], v[128:131], a[64:67]
ds_read_b128 a[148:151], v7 offset:2048
v_mfma_f32_16x16x32_bf16 a[92:95], a[176:179], v[132:135], a[92:95]
v_mfma_f32_16x16x32_bf16 a[12:15], a[180:183], v[120:123], a[12:15]
v_mfma_f32_16x16x32_bf16 a[40:43], a[180:183], v[124:127], a[40:43]
v_mfma_f32_16x16x32_bf16 a[68:71], a[180:183], v[128:131], a[68:71]
ds_read_b128 a[152:155], v7 offset:3072
buffer_load_dwordx4 v[112:115], v2, s[12:15], s59 offen offset:2048 sc1
v_mfma_f32_16x16x32_bf16 a[96:99], a[180:183], v[132:135], a[96:99]
v_mfma_f32_16x16x32_bf16 a[16:19], a[184:187], v[120:123], a[16:19]
v_mfma_f32_16x16x32_bf16 a[44:47], a[184:187], v[124:127], a[44:47]
v_mfma_f32_16x16x32_bf16 a[72:75], a[184:187], v[128:131], a[72:75]
v_mfma_f32_16x16x32_bf16 a[100:103], a[184:187], v[132:135], a[100:103]
v_mfma_f32_16x16x32_bf16 a[20:23], a[188:191], v[120:123], a[20:23]
buffer_load_dwordx4 v[116:119], v3, s[12:15], s59 offen offset:2048 sc1
v_mfma_f32_16x16x32_bf16 a[48:51], a[188:191], v[124:127], a[48:51]
v_mfma_f32_16x16x32_bf16 a[76:79], a[188:191], v[128:131], a[76:79]
v_mfma_f32_16x16x32_bf16 a[104:107], a[188:191], v[132:135], a[104:107]
v_mfma_f32_16x16x32_bf16 a[24:27], a[192:195], v[120:123], a[24:27]
v_mfma_f32_16x16x32_bf16 a[52:55], a[192:195], v[124:127], a[52:55]
v_mfma_f32_16x16x32_bf16 a[80:83], a[192:195], v[128:131], a[80:83]
v_mfma_f32_16x16x32_bf16 a[108:111], a[192:195], v[132:135], a[108:111]
s_waitcnt vmcnt(63) lgkmcnt(0)
v_mfma_f32_16x16x32_bf16 a[0:3], a[140:143], v[8:11], a[0:3]
s_add_u32 s59, s54, 4096
v_mfma_f32_16x16x32_bf16 a[28:31], a[140:143], v[12:15], a[28:31]
ds_read_b128 a[168:171], v7 offset:7168
v_mfma_f32_16x16x32_bf16 a[56:59], a[140:143], v[16:19], a[56:59]
ds_read_b128 a[172:175], v7 offset:8192
buffer_load_dwordx4 v[120:123], v0, s[12:15], s59 offen offset:3072 sc1
v_mfma_f32_16x16x32_bf16 a[84:87], a[140:143], v[20:23], a[84:87]
v_mfma_f32_16x16x32_bf16 a[4:7], a[144:147], v[8:11], a[4:7]
ds_read_b128 a[176:179], v7 offset:9216
v_mfma_f32_16x16x32_bf16 a[32:35], a[144:147], v[12:15], a[32:35]
ds_read_b128 a[180:183], v7 offset:10240
buffer_load_dwordx4 v[124:127], v1, s[12:15], s59 offen offset:3072 sc1
v_mfma_f32_16x16x32_bf16 a[60:63], a[144:147], v[16:19], a[60:63]
v_mfma_f32_16x16x32_bf16 a[88:91], a[144:147], v[20:23], a[88:91]
v_mfma_f32_16x16x32_bf16 a[8:11], a[148:151], v[8:11], a[8:11]
buffer_load_dwordx4 v[128:131], v2, s[12:15], s59 offen offset:3072 sc1
v_mfma_f32_16x16x32_bf16 a[36:39], a[148:151], v[12:15], a[36:39]
v_mfma_f32_16x16x32_bf16 a[64:67], a[148:151], v[16:19], a[64:67]
v_mfma_f32_16x16x32_bf16 a[92:95], a[148:151], v[20:23], a[92:95]
buffer_load_dwordx4 v[132:135], v3, s[12:15], s59 offen offset:3072 sc1
v_mfma_f32_16x16x32_bf16 a[12:15], a[152:155], v[8:11], a[12:15]
v_mfma_f32_16x16x32_bf16 a[40:43], a[152:155], v[12:15], a[40:43]
v_mfma_f32_16x16x32_bf16 a[68:71], a[152:155], v[16:19], a[68:71]
v_mfma_f32_16x16x32_bf16 a[96:99], a[152:155], v[20:23], a[96:99]
s_waitcnt vmcnt(63) lgkmcnt(0)
v_mfma_f32_16x16x32_bf16 a[0:3], a[168:171], v[24:27], a[0:3]
v_mfma_f32_16x16x32_bf16 a[28:31], a[168:171], v[28:31], a[28:31]
ds_read_b128 a[140:143], v7 offset:14336
v_mfma_f32_16x16x32_bf16 a[56:59], a[168:171], v[32:35], a[56:59]
ds_read_b128 a[144:147], v7 offset:15360
v_mfma_f32_16x16x32_bf16 a[84:87], a[168:171], v[36:39], a[84:87]
v_mfma_f32_16x16x32_bf16 a[4:7], a[172:175], v[24:27], a[4:7]
ds_read_b128 a[148:151], v7 offset:16384
v_mfma_f32_16x16x32_bf16 a[32:35], a[172:175], v[28:31], a[32:35]
ds_read_b128 a[152:155], v7 offset:17408
v_mfma_f32_16x16x32_bf16 a[60:63], a[172:175], v[32:35], a[60:63]
v_mfma_f32_16x16x32_bf16 a[88:91], a[172:175], v[36:39], a[88:91]
v_mfma_f32_16x16x32_bf16 a[8:11], a[176:179], v[24:27], a[8:11]
v_mfma_f32_16x16x32_bf16 a[36:39], a[176:179], v[28:31], a[36:39]
v_mfma_f32_16x16x32_bf16 a[64:67], a[176:179], v[32:35], a[64:67]
v_mfma_f32_16x16x32_bf16 a[92:95], a[176:179], v[36:39], a[92:95]
v_mfma_f32_16x16x32_bf16 a[12:15], a[180:183], v[24:27], a[12:15]
v_mfma_f32_16x16x32_bf16 a[40:43], a[180:183], v[28:31], a[40:43]
v_mfma_f32_16x16x32_bf16 a[68:71], a[180:183], v[32:35], a[68:71]
v_mfma_f32_16x16x32_bf16 a[96:99], a[180:183], v[36:39], a[96:99]
s_waitcnt vmcnt(20) lgkmcnt(0)
v_mfma_f32_16x16x32_bf16 a[0:3], a[140:143], v[40:43], a[0:3]
v_mfma_f32_16x16x32_bf16 a[28:31], a[140:143], v[44:47], a[28:31]
ds_read_b128 a[168:171], v7 offset:21504
v_mfma_f32_16x16x32_bf16 a[56:59], a[140:143], v[48:51], a[56:59]
ds_read_b128 a[172:175], v7 offset:22528
v_mfma_f32_16x16x32_bf16 a[84:87], a[140:143], v[52:55], a[84:87]
v_mfma_f32_16x16x32_bf16 a[4:7], a[144:147], v[40:43], a[4:7]
ds_read_b128 a[176:179], v7 offset:23552
v_mfma_f32_16x16x32_bf16 a[32:35], a[144:147], v[44:47], a[32:35]
ds_read_b128 a[180:183], v7 offset:24576
v_mfma_f32_16x16x32_bf16 a[60:63], a[144:147], v[48:51], a[60:63]
v_mfma_f32_16x16x32_bf16 a[88:91], a[144:147], v[52:55], a[88:91]
v_mfma_f32_16x16x32_bf16 a[8:11], a[148:151], v[40:43], a[8:11]
v_mfma_f32_16x16x32_bf16 a[36:39], a[148:151], v[44:47], a[36:39]
v_mfma_f32_16x16x32_bf16 a[64:67], a[148:151], v[48:51], a[64:67]
v_mfma_f32_16x16x32_bf16 a[92:95], a[148:151], v[52:55], a[92:95]
v_mfma_f32_16x16x32_bf16 a[12:15], a[152:155], v[40:43], a[12:15]
v_mfma_f32_16x16x32_bf16 a[40:43], a[152:155], v[44:47], a[40:43]
v_mfma_f32_16x16x32_bf16 a[68:71], a[152:155], v[48:51], a[68:71]
v_mfma_f32_16x16x32_bf16 a[96:99], a[152:155], v[52:55], a[96:99]
s_waitcnt vmcnt(16) lgkmcnt(0)
v_mfma_f32_16x16x32_bf16 a[0:3], a[168:171], v[56:59], a[0:3]
v_mfma_f32_16x16x32_bf16 a[28:31], a[168:171], v[60:63], a[28:31]
ds_read_b128 a[140:143], v7 offset:28672
v_mfma_f32_16x16x32_bf16 a[56:59], a[168:171], v[64:67], a[56:59]
ds_read_b128 a[144:147], v7 offset:29696
v_mfma_f32_16x16x32_bf16 a[84:87], a[168:171], v[68:71], a[84:87]
v_mfma_f32_16x16x32_bf16 a[4:7], a[172:175], v[56:59], a[4:7]
ds_read_b128 a[148:151], v7 offset:30720
v_mfma_f32_16x16x32_bf16 a[32:35], a[172:175], v[60:63], a[32:35]
ds_read_b128 a[152:155], v7 offset:31744
v_mfma_f32_16x16x32_bf16 a[60:63], a[172:175], v[64:67], a[60:63]
v_mfma_f32_16x16x32_bf16 a[88:91], a[172:175], v[68:71], a[88:91]
v_mfma_f32_16x16x32_bf16 a[8:11], a[176:179], v[56:59], a[8:11]
v_mfma_f32_16x16x32_bf16 a[36:39], a[176:179], v[60:63], a[36:39]
v_mfma_f32_16x16x32_bf16 a[64:67], a[176:179], v[64:67], a[64:67]
v_mfma_f32_16x16x32_bf16 a[92:95], a[176:179], v[68:71], a[92:95]
v_mfma_f32_16x16x32_bf16 a[12:15], a[180:183], v[56:59], a[12:15]
v_mfma_f32_16x16x32_bf16 a[40:43], a[180:183], v[60:63], a[40:43]
v_mfma_f32_16x16x32_bf16 a[68:71], a[180:183], v[64:67], a[68:71]
v_mfma_f32_16x16x32_bf16 a[96:99], a[180:183], v[68:71], a[96:99]
s_waitcnt vmcnt(12) lgkmcnt(0)
v_mfma_f32_16x16x32_bf16 a[0:3], a[140:143], v[72:75], a[0:3]
v_mfma_f32_16x16x32_bf16 a[28:31], a[140:143], v[76:79], a[28:31]
ds_read_b128 a[168:171], v7 offset:35840
v_mfma_f32_16x16x32_bf16 a[56:59], a[140:143], v[80:83], a[56:59]
ds_read_b128 a[172:175], v7 offset:36864
v_mfma_f32_16x16x32_bf16 a[84:87], a[140:143], v[84:87], a[84:87]
v_mfma_f32_16x16x32_bf16 a[4:7], a[144:147], v[72:75], a[4:7]
ds_read_b128 a[176:179], v7 offset:37888
v_mfma_f32_16x16x32_bf16 a[32:35], a[144:147], v[76:79], a[32:35]
ds_read_b128 a[180:183], v7 offset:38912
v_mfma_f32_16x16x32_bf16 a[60:63], a[144:147], v[80:83], a[60:63]
v_mfma_f32_16x16x32_bf16 a[88:91], a[144:147], v[84:87], a[88:91]
v_mfma_f32_16x16x32_bf16 a[8:11], a[148:151], v[72:75], a[8:11]
v_mfma_f32_16x16x32_bf16 a[36:39], a[148:151], v[76:79], a[36:39]
v_mfma_f32_16x16x32_bf16 a[64:67], a[148:151], v[80:83], a[64:67]
v_mfma_f32_16x16x32_bf16 a[92:95], a[148:151], v[84:87], a[92:95]
v_mfma_f32_16x16x32_bf16 a[12:15], a[152:155], v[72:75], a[12:15]
v_mfma_f32_16x16x32_bf16 a[40:43], a[152:155], v[76:79], a[40:43]
v_mfma_f32_16x16x32_bf16 a[68:71], a[152:155], v[80:83], a[68:71]
v_mfma_f32_16x16x32_bf16 a[96:99], a[152:155], v[84:87], a[96:99]
s_waitcnt vmcnt(8) lgkmcnt(0)
v_mfma_f32_16x16x32_bf16 a[0:3], a[168:171], v[88:91], a[0:3]
v_mfma_f32_16x16x32_bf16 a[28:31], a[168:171], v[92:95], a[28:31]
ds_read_b128 a[140:143], v7 offset:43008
v_mfma_f32_16x16x32_bf16 a[56:59], a[168:171], v[96:99], a[56:59]
ds_read_b128 a[144:147], v7 offset:44032
v_mfma_f32_16x16x32_bf16 a[84:87], a[168:171], v[100:103], a[84:87]
v_mfma_f32_16x16x32_bf16 a[4:7], a[172:175], v[88:91], a[4:7]
ds_read_b128 a[148:151], v7 offset:45056
v_mfma_f32_16x16x32_bf16 a[32:35], a[172:175], v[92:95], a[32:35]
ds_read_b128 a[152:155], v7 offset:46080
v_mfma_f32_16x16x32_bf16 a[60:63], a[172:175], v[96:99], a[60:63]
v_mfma_f32_16x16x32_bf16 a[88:91], a[172:175], v[100:103], a[88:91]
v_mfma_f32_16x16x32_bf16 a[8:11], a[176:179], v[88:91], a[8:11]
v_mfma_f32_16x16x32_bf16 a[36:39], a[176:179], v[92:95], a[36:39]
v_mfma_f32_16x16x32_bf16 a[64:67], a[176:179], v[96:99], a[64:67]
v_mfma_f32_16x16x32_bf16 a[92:95], a[176:179], v[100:103], a[92:95]
v_mfma_f32_16x16x32_bf16 a[12:15], a[180:183], v[88:91], a[12:15]
v_mfma_f32_16x16x32_bf16 a[40:43], a[180:183], v[92:95], a[40:43]
v_mfma_f32_16x16x32_bf16 a[68:71], a[180:183], v[96:99], a[68:71]
v_mfma_f32_16x16x32_bf16 a[96:99], a[180:183], v[100:103], a[96:99]
s_waitcnt vmcnt(4) lgkmcnt(0)
v_mfma_f32_16x16x32_bf16 a[0:3], a[140:143], v[104:107], a[0:3]
v_mfma_f32_16x16x32_bf16 a[28:31], a[140:143], v[108:111], a[28:31]
ds_read_b128 a[168:171], v7 offset:50176
v_mfma_f32_16x16x32_bf16 a[56:59], a[140:143], v[112:115], a[56:59]
ds_read_b128 a[172:175], v7 offset:51200
v_mfma_f32_16x16x32_bf16 a[84:87], a[140:143], v[116:119], a[84:87]
v_mfma_f32_16x16x32_bf16 a[4:7], a[144:147], v[104:107], a[4:7]
ds_read_b128 a[176:179], v7 offset:52224
v_mfma_f32_16x16x32_bf16 a[32:35], a[144:147], v[108:111], a[32:35]
ds_read_b128 a[180:183], v7 offset:53248
v_mfma_f32_16x16x32_bf16 a[60:63], a[144:147], v[112:115], a[60:63]
v_mfma_f32_16x16x32_bf16 a[88:91], a[144:147], v[116:119], a[88:91]
v_mfma_f32_16x16x32_bf16 a[8:11], a[148:151], v[104:107], a[8:11]
v_mfma_f32_16x16x32_bf16 a[36:39], a[148:151], v[108:111], a[36:39]
v_mfma_f32_16x16x32_bf16 a[64:67], a[148:151], v[112:115], a[64:67]
v_mfma_f32_16x16x32_bf16 a[92:95], a[148:151], v[116:119], a[92:95]
v_mfma_f32_16x16x32_bf16 a[12:15], a[152:155], v[104:107], a[12:15]
v_mfma_f32_16x16x32_bf16 a[40:43], a[152:155], v[108:111], a[40:43]
v_mfma_f32_16x16x32_bf16 a[68:71], a[152:155], v[112:115], a[68:71]
v_mfma_f32_16x16x32_bf16 a[96:99], a[152:155], v[116:119], a[96:99]
s_waitcnt vmcnt(0) lgkmcnt(0)
v_mfma_f32_16x16x32_bf16 a[0:3], a[168:171], v[120:123], a[0:3]
v_mfma_f32_16x16x32_bf16 a[28:31], a[168:171], v[124:127], a[28:31]
ds_read_b128 a[156:159], v7 offset:4096
v_mfma_f32_16x16x32_bf16 a[56:59], a[168:171], v[128:131], a[56:59]
v_mfma_f32_16x16x32_bf16 a[84:87], a[168:171], v[132:135], a[84:87]
ds_read_b128 a[160:163], v7 offset:5120
v_mfma_f32_16x16x32_bf16 a[4:7], a[172:175], v[120:123], a[4:7]
v_mfma_f32_16x16x32_bf16 a[32:35], a[172:175], v[124:127], a[32:35]
ds_read_b128 a[164:167], v7 offset:6144
v_mfma_f32_16x16x32_bf16 a[60:63], a[172:175], v[128:131], a[60:63]
v_mfma_f32_16x16x32_bf16 a[88:91], a[172:175], v[132:135], a[88:91]
v_mfma_f32_16x16x32_bf16 a[8:11], a[176:179], v[120:123], a[8:11]
v_mfma_f32_16x16x32_bf16 a[36:39], a[176:179], v[124:127], a[36:39]
v_mfma_f32_16x16x32_bf16 a[64:67], a[176:179], v[128:131], a[64:67]
v_mfma_f32_16x16x32_bf16 a[92:95], a[176:179], v[132:135], a[92:95]
v_mfma_f32_16x16x32_bf16 a[12:15], a[180:183], v[120:123], a[12:15]
v_mfma_f32_16x16x32_bf16 a[40:43], a[180:183], v[124:127], a[40:43]
v_mfma_f32_16x16x32_bf16 a[68:71], a[180:183], v[128:131], a[68:71]
v_mfma_f32_16x16x32_bf16 a[96:99], a[180:183], v[132:135], a[96:99]
s_nop 3
s_waitcnt lgkmcnt(0)
v_mfma_f32_16x16x32_bf16 a[16:19], a[156:159], v[8:11], a[16:19]
v_mfma_f32_16x16x32_bf16 a[44:47], a[156:159], v[12:15], a[44:47]
ds_read_b128 a[184:187], v7 offset:11264
ds_read_b128 a[188:191], v7 offset:12288
v_mfma_f32_16x16x32_bf16 a[72:75], a[156:159], v[16:19], a[72:75]
ds_read_b128 a[192:195], v7 offset:13312
v_mfma_f32_16x16x32_bf16 a[100:103], a[156:159], v[20:23], a[100:103]
v_mfma_f32_16x16x32_bf16 a[20:23], a[160:163], v[8:11], a[20:23]
v_mfma_f32_16x16x32_bf16 a[48:51], a[160:163], v[12:15], a[48:51]
v_mfma_f32_16x16x32_bf16 a[76:79], a[160:163], v[16:19], a[76:79]
v_mfma_f32_16x16x32_bf16 a[104:107], a[160:163], v[20:23], a[104:107]
v_mfma_f32_16x16x32_bf16 a[24:27], a[164:167], v[8:11], a[24:27]
v_mfma_f32_16x16x32_bf16 a[52:55], a[164:167], v[12:15], a[52:55]
v_mfma_f32_16x16x32_bf16 a[80:83], a[164:167], v[16:19], a[80:83]
v_mfma_f32_16x16x32_bf16 a[108:111], a[164:167], v[20:23], a[108:111]
s_waitcnt lgkmcnt(0)
v_mfma_f32_16x16x32_bf16 a[16:19], a[184:187], v[24:27], a[16:19]
v_accvgpr_read_b32 v192, a0
v_accvgpr_read_b32 v193, a1
v_mfma_f32_16x16x32_bf16 a[44:47], a[184:187], v[28:31], a[44:47]
ds_read_b128 a[156:159], v7 offset:18432
ds_read_b128 a[160:163], v7 offset:19456
v_mfma_f32_16x16x32_bf16 a[72:75], a[184:187], v[32:35], a[72:75]
ds_read_b128 a[164:167], v7 offset:20480
v_accvgpr_read_b32 v194, a2
v_mfma_f32_16x16x32_bf16 a[100:103], a[184:187], v[36:39], a[100:103]
v_accvgpr_read_b32 v195, a3
v_accvgpr_read_b32 v196, a4
v_mfma_f32_16x16x32_bf16 a[20:23], a[188:191], v[24:27], a[20:23]
v_accvgpr_read_b32 v197, a5
v_accvgpr_read_b32 v198, a6
v_mfma_f32_16x16x32_bf16 a[48:51], a[188:191], v[28:31], a[48:51]
v_accvgpr_read_b32 v199, a7
v_cvt_pk_bf16_f32 v208, v192, v193
v_mfma_f32_16x16x32_bf16 a[76:79], a[188:191], v[32:35], a[76:79]
v_cvt_pk_bf16_f32 v209, v194, v195
v_cvt_pk_bf16_f32 v210, v196, v197
v_mfma_f32_16x16x32_bf16 a[104:107], a[188:191], v[36:39], a[104:107]
v_cvt_pk_bf16_f32 v211, v198, v199
s_mov_b32 s66, 0
v_mfma_f32_16x16x32_bf16 a[24:27], a[192:195], v[24:27], a[24:27]
buffer_store_dwordx4 v[208:211], v6, s[48:51], s66 offen offset:0 sc0 sc1
v_accvgpr_read_b32 v200, a8
v_mfma_f32_16x16x32_bf16 a[52:55], a[192:195], v[28:31], a[52:55]
v_accvgpr_read_b32 v201, a9
v_accvgpr_read_b32 v202, a10
v_mfma_f32_16x16x32_bf16 a[80:83], a[192:195], v[32:35], a[80:83]
v_accvgpr_read_b32 v203, a11
v_accvgpr_read_b32 v204, a12
v_mfma_f32_16x16x32_bf16 a[108:111], a[192:195], v[36:39], a[108:111]
v_accvgpr_read_b32 v205, a13
v_accvgpr_read_b32 v206, a14
v_accvgpr_read_b32 v207, a15
v_cvt_pk_bf16_f32 v212, v200, v201
v_cvt_pk_bf16_f32 v213, v202, v203
v_cvt_pk_bf16_f32 v214, v204, v205
v_cvt_pk_bf16_f32 v215, v206, v207
s_mov_b32 s66, 0
buffer_store_dwordx4 v[212:215], v6, s[48:51], s66 offen offset:1024 sc0 sc1
s_waitcnt lgkmcnt(0)
v_mfma_f32_16x16x32_bf16 a[16:19], a[156:159], v[40:43], a[16:19]
v_accvgpr_read_b32 v192, a28
v_accvgpr_read_b32 v193, a29
v_mfma_f32_16x16x32_bf16 a[44:47], a[156:159], v[44:47], a[44:47]
ds_read_b128 a[184:187], v7 offset:25600
ds_read_b128 a[188:191], v7 offset:26624
v_mfma_f32_16x16x32_bf16 a[72:75], a[156:159], v[48:51], a[72:75]
ds_read_b128 a[192:195], v7 offset:27648
v_accvgpr_read_b32 v194, a30
v_mfma_f32_16x16x32_bf16 a[100:103], a[156:159], v[52:55], a[100:103]
v_accvgpr_read_b32 v195, a31
v_accvgpr_read_b32 v196, a32
v_mfma_f32_16x16x32_bf16 a[20:23], a[160:163], v[40:43], a[20:23]
v_accvgpr_read_b32 v197, a33
v_accvgpr_read_b32 v198, a34
v_mfma_f32_16x16x32_bf16 a[48:51], a[160:163], v[44:47], a[48:51]
v_accvgpr_read_b32 v199, a35
v_cvt_pk_bf16_f32 v216, v192, v193
v_mfma_f32_16x16x32_bf16 a[76:79], a[160:163], v[48:51], a[76:79]
v_cvt_pk_bf16_f32 v217, v194, v195
v_cvt_pk_bf16_f32 v218, v196, v197
v_mfma_f32_16x16x32_bf16 a[104:107], a[160:163], v[52:55], a[104:107]
v_cvt_pk_bf16_f32 v219, v198, v199
s_mov_b32 s66, 0
v_mfma_f32_16x16x32_bf16 a[24:27], a[164:167], v[40:43], a[24:27]
buffer_store_dwordx4 v[216:219], v6, s[48:51], s66 offen offset:2048 sc0 sc1
v_accvgpr_read_b32 v200, a36
v_mfma_f32_16x16x32_bf16 a[52:55], a[164:167], v[44:47], a[52:55]
v_accvgpr_read_b32 v201, a37
v_accvgpr_read_b32 v202, a38
v_mfma_f32_16x16x32_bf16 a[80:83], a[164:167], v[48:51], a[80:83]
v_accvgpr_read_b32 v203, a39
v_accvgpr_read_b32 v204, a40
v_mfma_f32_16x16x32_bf16 a[108:111], a[164:167], v[52:55], a[108:111]
v_accvgpr_read_b32 v205, a41
v_accvgpr_read_b32 v206, a42
v_accvgpr_read_b32 v207, a43
v_cvt_pk_bf16_f32 v220, v200, v201
v_cvt_pk_bf16_f32 v221, v202, v203
v_cvt_pk_bf16_f32 v222, v204, v205
v_cvt_pk_bf16_f32 v223, v206, v207
s_mov_b32 s66, 0
buffer_store_dwordx4 v[220:223], v6, s[48:51], s66 offen offset:3072 sc0 sc1
s_waitcnt lgkmcnt(0)
v_mfma_f32_16x16x32_bf16 a[16:19], a[184:187], v[56:59], a[16:19]
v_accvgpr_read_b32 v192, a56
v_accvgpr_read_b32 v193, a57
v_mfma_f32_16x16x32_bf16 a[44:47], a[184:187], v[60:63], a[44:47]
ds_read_b128 a[156:159], v7 offset:32768
ds_read_b128 a[160:163], v7 offset:33792
v_mfma_f32_16x16x32_bf16 a[72:75], a[184:187], v[64:67], a[72:75]
ds_read_b128 a[164:167], v7 offset:34816
v_accvgpr_read_b32 v194, a58
v_mfma_f32_16x16x32_bf16 a[100:103], a[184:187], v[68:71], a[100:103]
v_accvgpr_read_b32 v195, a59
v_accvgpr_read_b32 v196, a60
v_mfma_f32_16x16x32_bf16 a[20:23], a[188:191], v[56:59], a[20:23]
v_accvgpr_read_b32 v197, a61
v_accvgpr_read_b32 v198, a62
v_mfma_f32_16x16x32_bf16 a[48:51], a[188:191], v[60:63], a[48:51]
v_accvgpr_read_b32 v199, a63
v_cvt_pk_bf16_f32 v208, v192, v193
v_mfma_f32_16x16x32_bf16 a[76:79], a[188:191], v[64:67], a[76:79]
v_cvt_pk_bf16_f32 v209, v194, v195
v_cvt_pk_bf16_f32 v210, v196, v197
v_mfma_f32_16x16x32_bf16 a[104:107], a[188:191], v[68:71], a[104:107]
v_cvt_pk_bf16_f32 v211, v198, v199
s_mov_b32 s66, 4096
v_mfma_f32_16x16x32_bf16 a[24:27], a[192:195], v[56:59], a[24:27]
buffer_store_dwordx4 v[208:211], v6, s[48:51], s66 offen offset:0 sc0 sc1
v_accvgpr_read_b32 v200, a64
v_mfma_f32_16x16x32_bf16 a[52:55], a[192:195], v[60:63], a[52:55]
v_accvgpr_read_b32 v201, a65
v_accvgpr_read_b32 v202, a66
v_mfma_f32_16x16x32_bf16 a[80:83], a[192:195], v[64:67], a[80:83]
v_accvgpr_read_b32 v203, a67
v_accvgpr_read_b32 v204, a68
v_mfma_f32_16x16x32_bf16 a[108:111], a[192:195], v[68:71], a[108:111]
v_accvgpr_read_b32 v205, a69
v_accvgpr_read_b32 v206, a70
v_accvgpr_read_b32 v207, a71
v_cvt_pk_bf16_f32 v212, v200, v201
v_cvt_pk_bf16_f32 v213, v202, v203
v_cvt_pk_bf16_f32 v214, v204, v205
v_cvt_pk_bf16_f32 v215, v206, v207
s_mov_b32 s66, 4096
buffer_store_dwordx4 v[212:215], v6, s[48:51], s66 offen offset:1024 sc0 sc1
s_waitcnt lgkmcnt(0)
v_mfma_f32_16x16x32_bf16 a[16:19], a[156:159], v[72:75], a[16:19]
v_accvgpr_read_b32 v192, a84
v_accvgpr_read_b32 v193, a85
v_mfma_f32_16x16x32_bf16 a[44:47], a[156:159], v[76:79], a[44:47]
ds_read_b128 a[184:187], v7 offset:39936
ds_read_b128 a[188:191], v7 offset:40960
v_mfma_f32_16x16x32_bf16 a[72:75], a[156:159], v[80:83], a[72:75]
ds_read_b128 a[192:195], v7 offset:41984
v_accvgpr_read_b32 v194, a86
v_mfma_f32_16x16x32_bf16 a[100:103], a[156:159], v[84:87], a[100:103]
v_accvgpr_read_b32 v195, a87
v_accvgpr_read_b32 v196, a88
v_mfma_f32_16x16x32_bf16 a[20:23], a[160:163], v[72:75], a[20:23]
v_accvgpr_read_b32 v197, a89
v_accvgpr_read_b32 v198, a90
v_mfma_f32_16x16x32_bf16 a[48:51], a[160:163], v[76:79], a[48:51]
v_accvgpr_read_b32 v199, a91
v_cvt_pk_bf16_f32 v216, v192, v193
v_mfma_f32_16x16x32_bf16 a[76:79], a[160:163], v[80:83], a[76:79]
v_cvt_pk_bf16_f32 v217, v194, v195
v_cvt_pk_bf16_f32 v218, v196, v197
v_mfma_f32_16x16x32_bf16 a[104:107], a[160:163], v[84:87], a[104:107]
v_cvt_pk_bf16_f32 v219, v198, v199
s_mov_b32 s66, 4096
v_mfma_f32_16x16x32_bf16 a[24:27], a[164:167], v[72:75], a[24:27]
buffer_store_dwordx4 v[216:219], v6, s[48:51], s66 offen offset:2048 sc0 sc1
v_accvgpr_read_b32 v200, a92
v_mfma_f32_16x16x32_bf16 a[52:55], a[164:167], v[76:79], a[52:55]
v_accvgpr_read_b32 v201, a93
v_accvgpr_read_b32 v202, a94
v_mfma_f32_16x16x32_bf16 a[80:83], a[164:167], v[80:83], a[80:83]
v_accvgpr_read_b32 v203, a95
v_accvgpr_read_b32 v204, a96
v_mfma_f32_16x16x32_bf16 a[108:111], a[164:167], v[84:87], a[108:111]
v_accvgpr_read_b32 v205, a97
v_accvgpr_read_b32 v206, a98
v_accvgpr_read_b32 v207, a99
v_cvt_pk_bf16_f32 v220, v200, v201
v_cvt_pk_bf16_f32 v221, v202, v203
v_cvt_pk_bf16_f32 v222, v204, v205
v_cvt_pk_bf16_f32 v223, v206, v207
s_mov_b32 s66, 4096
buffer_store_dwordx4 v[220:223], v6, s[48:51], s66 offen offset:3072 sc0 sc1
s_waitcnt lgkmcnt(0)
v_mfma_f32_16x16x32_bf16 a[16:19], a[184:187], v[88:91], a[16:19]
v_mfma_f32_16x16x32_bf16 a[44:47], a[184:187], v[92:95], a[44:47]
ds_read_b128 a[156:159], v7 offset:47104
ds_read_b128 a[160:163], v7 offset:48128
v_mfma_f32_16x16x32_bf16 a[72:75], a[184:187], v[96:99], a[72:75]
ds_read_b128 a[164:167], v7 offset:49152
v_mfma_f32_16x16x32_bf16 a[100:103], a[184:187], v[100:103], a[100:103]
v_mfma_f32_16x16x32_bf16 a[20:23], a[188:191], v[88:91], a[20:23]
v_mfma_f32_16x16x32_bf16 a[48:51], a[188:191], v[92:95], a[48:51]
v_mfma_f32_16x16x32_bf16 a[76:79], a[188:191], v[96:99], a[76:79]
v_mfma_f32_16x16x32_bf16 a[104:107], a[188:191], v[100:103], a[104:107]
v_mfma_f32_16x16x32_bf16 a[24:27], a[192:195], v[88:91], a[24:27]
v_mfma_f32_16x16x32_bf16 a[52:55], a[192:195], v[92:95], a[52:55]
v_mfma_f32_16x16x32_bf16 a[80:83], a[192:195], v[96:99], a[80:83]
v_mfma_f32_16x16x32_bf16 a[108:111], a[192:195], v[100:103], a[108:111]
s_waitcnt lgkmcnt(0)
v_mfma_f32_16x16x32_bf16 a[16:19], a[156:159], v[104:107], a[16:19]
v_mfma_f32_16x16x32_bf16 a[44:47], a[156:159], v[108:111], a[44:47]
ds_read_b128 a[184:187], v7 offset:54272
ds_read_b128 a[188:191], v7 offset:55296
v_mfma_f32_16x16x32_bf16 a[72:75], a[156:159], v[112:115], a[72:75]
ds_read_b128 a[192:195], v7 offset:56320
v_mfma_f32_16x16x32_bf16 a[100:103], a[156:159], v[116:119], a[100:103]
v_mfma_f32_16x16x32_bf16 a[20:23], a[160:163], v[104:107], a[20:23]
v_mfma_f32_16x16x32_bf16 a[48:51], a[160:163], v[108:111], a[48:51]
v_mfma_f32_16x16x32_bf16 a[76:79], a[160:163], v[112:115], a[76:79]
v_mfma_f32_16x16x32_bf16 a[104:107], a[160:163], v[116:119], a[104:107]
v_mfma_f32_16x16x32_bf16 a[24:27], a[164:167], v[104:107], a[24:27]
v_mfma_f32_16x16x32_bf16 a[52:55], a[164:167], v[108:111], a[52:55]
v_mfma_f32_16x16x32_bf16 a[80:83], a[164:167], v[112:115], a[80:83]
v_mfma_f32_16x16x32_bf16 a[108:111], a[164:167], v[116:119], a[108:111]
s_waitcnt lgkmcnt(0)
v_mfma_f32_16x16x32_bf16 a[16:19], a[184:187], v[120:123], a[16:19]
v_mfma_f32_16x16x32_bf16 a[44:47], a[184:187], v[124:127], a[44:47]
v_mfma_f32_16x16x32_bf16 a[72:75], a[184:187], v[128:131], a[72:75]
v_mfma_f32_16x16x32_bf16 a[100:103], a[184:187], v[132:135], a[100:103]
v_mfma_f32_16x16x32_bf16 a[20:23], a[188:191], v[120:123], a[20:23]
v_mfma_f32_16x16x32_bf16 a[48:51], a[188:191], v[124:127], a[48:51]
v_mfma_f32_16x16x32_bf16 a[76:79], a[188:191], v[128:131], a[76:79]
v_mfma_f32_16x16x32_bf16 a[104:107], a[188:191], v[132:135], a[104:107]
v_mfma_f32_16x16x32_bf16 a[24:27], a[192:195], v[120:123], a[24:27]
v_mfma_f32_16x16x32_bf16 a[52:55], a[192:195], v[124:127], a[52:55]
v_mfma_f32_16x16x32_bf16 a[80:83], a[192:195], v[128:131], a[80:83]
v_mfma_f32_16x16x32_bf16 a[108:111], a[192:195], v[132:135], a[108:111]
s_nop 7
v_accvgpr_read_b32 v192, a16
v_accvgpr_read_b32 v193, a17
v_accvgpr_read_b32 v194, a18
v_accvgpr_read_b32 v195, a19
v_accvgpr_read_b32 v196, a20
v_accvgpr_read_b32 v197, a21
v_accvgpr_read_b32 v198, a22
v_accvgpr_read_b32 v199, a23
v_cvt_pk_bf16_f32 v208, v192, v193
v_cvt_pk_bf16_f32 v209, v194, v195
v_cvt_pk_bf16_f32 v210, v196, v197
v_cvt_pk_bf16_f32 v211, v198, v199
s_mov_b32 s66, 8192
buffer_store_dwordx4 v[208:211], v6, s[48:51], s66 offen offset:0 sc0 sc1
v_accvgpr_read_b32 v200, a44
v_accvgpr_read_b32 v201, a45
v_accvgpr_read_b32 v202, a46
v_accvgpr_read_b32 v203, a47
v_accvgpr_read_b32 v204, a48
v_accvgpr_read_b32 v205, a49
v_accvgpr_read_b32 v206, a50
v_accvgpr_read_b32 v207, a51
v_cvt_pk_bf16_f32 v212, v200, v201
v_cvt_pk_bf16_f32 v213, v202, v203
v_cvt_pk_bf16_f32 v214, v204, v205
v_cvt_pk_bf16_f32 v215, v206, v207
s_mov_b32 s66, 8192
buffer_store_dwordx4 v[212:215], v6, s[48:51], s66 offen offset:1024 sc0 sc1
v_accvgpr_read_b32 v192, a72
v_accvgpr_read_b32 v193, a73
v_accvgpr_read_b32 v194, a74
v_accvgpr_read_b32 v195, a75
v_accvgpr_read_b32 v196, a76
v_accvgpr_read_b32 v197, a77
v_accvgpr_read_b32 v198, a78
v_accvgpr_read_b32 v199, a79
v_cvt_pk_bf16_f32 v216, v192, v193
v_cvt_pk_bf16_f32 v217, v194, v195
v_cvt_pk_bf16_f32 v218, v196, v197
v_cvt_pk_bf16_f32 v219, v198, v199
s_mov_b32 s66, 8192
buffer_store_dwordx4 v[216:219], v6, s[48:51], s66 offen offset:2048 sc0 sc1
v_accvgpr_read_b32 v200, a100
v_accvgpr_read_b32 v201, a101
v_accvgpr_read_b32 v202, a102
v_accvgpr_read_b32 v203, a103
v_accvgpr_read_b32 v204, a104
v_accvgpr_read_b32 v205, a105
v_accvgpr_read_b32 v206, a106
v_accvgpr_read_b32 v207, a107
v_cvt_pk_bf16_f32 v220, v200, v201
v_cvt_pk_bf16_f32 v221, v202, v203
v_cvt_pk_bf16_f32 v222, v204, v205
v_cvt_pk_bf16_f32 v223, v206, v207
s_mov_b32 s66, 8192
buffer_store_dwordx4 v[220:223], v6, s[48:51], s66 offen offset:3072 sc0 sc1
v_accvgpr_read_b32 v192, a24
v_accvgpr_read_b32 v193, a25
v_accvgpr_read_b32 v194, a26
v_accvgpr_read_b32 v195, a27
v_accvgpr_read_b32 v196, a52
v_accvgpr_read_b32 v197, a53
v_accvgpr_read_b32 v198, a54
v_accvgpr_read_b32 v199, a55
v_cvt_pk_bf16_f32 v208, v192, v193
v_cvt_pk_bf16_f32 v209, v194, v195
v_cvt_pk_bf16_f32 v210, v196, v197
v_cvt_pk_bf16_f32 v211, v198, v199
s_mov_b32 s66, 12288
buffer_store_dwordx4 v[208:211], v6, s[48:51], s66 offen offset:0 sc0 sc1
v_accvgpr_read_b32 v200, a80
v_accvgpr_read_b32 v201, a81
v_accvgpr_read_b32 v202, a82
v_accvgpr_read_b32 v203, a83
v_accvgpr_read_b32 v204, a108
v_accvgpr_read_b32 v205, a109
v_accvgpr_read_b32 v206, a110
v_accvgpr_read_b32 v207, a111
v_cvt_pk_bf16_f32 v212, v200, v201
v_cvt_pk_bf16_f32 v213, v202, v203
v_cvt_pk_bf16_f32 v214, v204, v205
v_cvt_pk_bf16_f32 v215, v206, v207
s_mov_b32 s66, 12288
buffer_store_dwordx4 v[212:215], v6, s[48:51], s66 offen offset:1024 sc0 sc1
s_add_u32 s20, s80, s70
s_addc_u32 s21, s81, 0
s_mov_b32 s22, 73728
s_mov_b32 s23, 0x20000
s_cmp_eq_u32 s60, 3
s_cselect_b32 s64, 4, 5
s_cselect_b32 s65, 14, 18
v_lshrrev_b32 v40, 4, v6
v_and_b32 v41, 15, v40
v_lshrrev_b32 v42, 4, v40
v_mul_u32_u24 v41, 1792, v41
v_lshlrev_b32 v42, 3, v42
v_add_u32 v43, v41, v42
v_and_b32 v134, 15, v40
v_lshrrev_b32 v135, 4, v40
v_lshlrev_b32 v135, 2, v135
v_sub_u32 v134, v134, v135
s_mov_b32 s52, 0x3f80
s_mov_b32 s53, 0x3f800000
v_mov_b32 v130, 0
v_mov_b32 v136, s52
v_cmp_eq_u32 vcc, 0, v134
s_nop 1
v_cndmask_b32 v130, v130, v136, vcc
v_mov_b32 v136, s53
v_cmp_eq_u32 vcc, 1, v134
s_nop 1
v_cndmask_b32 v130, v130, v136, vcc
v_mov_b32 v131, 0
v_mov_b32 v136, s52
v_cmp_eq_u32 vcc, 2, v134
s_nop 1
v_cndmask_b32 v131, v131, v136, vcc
v_mov_b32 v136, s53
v_cmp_eq_u32 vcc, 3, v134
s_nop 1
v_cndmask_b32 v131, v131, v136, vcc
v_mov_b32 v128, 0
v_mov_b32 v129, 0
v_mov_b32 v132, 0
v_mov_b32 v133, 0
s_lshl_b32 s54, s64, 1
s_mul_i32 s55, s64, 3
s_add_u32 s66, s27, 0
s_sub_u32 s58, s66, s54
s_sub_u32 s59, s66, s55
s_lshl_b32 s59, s59, 1
s_cmp_lt_u32 s66, s55
s_cselect_b32 s67, s58, s59
s_cselect_b32 s68, 4, 6
s_cselect_b32 s62, 0, 1
s_cselect_b32 s63, 1, 0
s_lshr_b32 s58, s66, 1
s_and_b32 s59, s66, 1
s_lshl_b32 s59, s59, 1
s_cmp_lt_u32 s66, s54
s_cselect_b32 s67, s58, s67
s_cselect_b32 s68, s59, s68
s_cselect_b32 s62, 0, s62
s_cselect_b32 s63, 1, s63
s_mul_i32 s58, s67, 28672
s_lshl_b32 s59, s68, 5
s_add_u32 s4, s58, s59
s_add_u32 s14, s67, s62
s_add_u32 s68, s68, s63
s_mul_i32 s58, s14, 28672
s_lshl_b32 s59, s68, 5
s_add_u32 s9, s58, s59
s_add_u32 s66, s27, 4
s_sub_u32 s58, s66, s54
s_sub_u32 s59, s66, s55
s_lshl_b32 s59, s59, 1
s_cmp_lt_u32 s66, s55
s_cselect_b32 s67, s58, s59
s_cselect_b32 s68, 4, 6
s_cselect_b32 s62, 0, 1
s_cselect_b32 s63, 1, 0
s_lshr_b32 s58, s66, 1
s_and_b32 s59, s66, 1
s_lshl_b32 s59, s59, 1
s_cmp_lt_u32 s66, s54
s_cselect_b32 s67, s58, s67
s_cselect_b32 s68, s59, s68
s_cselect_b32 s62, 0, s62
s_cselect_b32 s63, 1, s63
s_mul_i32 s58, s67, 28672
s_lshl_b32 s59, s68, 5
s_add_u32 s5, s58, s59
s_add_u32 s15, s67, s62
s_add_u32 s68, s68, s63
s_mul_i32 s58, s15, 28672
s_lshl_b32 s59, s68, 5
s_add_u32 s10, s58, s59
s_add_u32 s66, s27, 8
s_sub_u32 s58, s66, s54
s_sub_u32 s59, s66, s55
s_lshl_b32 s59, s59, 1
s_cmp_lt_u32 s66, s55
s_cselect_b32 s67, s58, s59
s_cselect_b32 s68, 4, 6
s_cselect_b32 s62, 0, 1
s_cselect_b32 s63, 1, 0
s_lshr_b32 s58, s66, 1
s_and_b32 s59, s66, 1
s_lshl_b32 s59, s59, 1
s_cmp_lt_u32 s66, s54
s_cselect_b32 s67, s58, s67
s_cselect_b32 s68, s59, s68
s_cselect_b32 s62, 0, s62
s_cselect_b32 s63, 1, s63
s_mul_i32 s58, s67, 28672
s_lshl_b32 s59, s68, 5
s_add_u32 s6, s58, s59
s_add_u32 s16, s67, s62
s_add_u32 s68, s68, s63
s_mul_i32 s58, s16, 28672
s_lshl_b32 s59, s68, 5
s_add_u32 s11, s58, s59
s_add_u32 s66, s27, 12
s_sub_u32 s58, s66, s54
s_sub_u32 s59, s66, s55
s_lshl_b32 s59, s59, 1
s_cmp_lt_u32 s66, s55
s_cselect_b32 s67, s58, s59
s_cselect_b32 s68, 4, 6
s_cselect_b32 s62, 0, 1
s_cselect_b32 s63, 1, 0
s_lshr_b32 s58, s66, 1
s_and_b32 s59, s66, 1
s_lshl_b32 s59, s59, 1
s_cmp_lt_u32 s66, s54
s_cselect_b32 s67, s58, s67
s_cselect_b32 s68, s59, s68
s_cselect_b32 s62, 0, s62
s_cselect_b32 s63, 1, s63
s_mul_i32 s58, s67, 28672
s_lshl_b32 s59, s68, 5
s_add_u32 s7, s58, s59
s_add_u32 s17, s67, s62
s_add_u32 s68, s68, s63
s_mul_i32 s58, s17, 28672
s_lshl_b32 s59, s68, 5
s_add_u32 s12, s58, s59
s_add_u32 s66, s27, 16
s_sub_u32 s58, s66, s54
s_sub_u32 s59, s66, s55
s_lshl_b32 s59, s59, 1
s_cmp_lt_u32 s66, s55
s_cselect_b32 s67, s58, s59
s_cselect_b32 s68, 4, 6
s_cselect_b32 s62, 0, 1
s_cselect_b32 s63, 1, 0
s_lshr_b32 s58, s66, 1
s_and_b32 s59, s66, 1
s_lshl_b32 s59, s59, 1
s_cmp_lt_u32 s66, s54
s_cselect_b32 s67, s58, s67
s_cselect_b32 s68, s59, s68
s_cselect_b32 s62, 0, s62
s_cselect_b32 s63, 1, s63
s_mul_i32 s58, s67, 28672
s_lshl_b32 s59, s68, 5
s_add_u32 s8, s58, s59
s_add_u32 s18, s67, s62
s_add_u32 s68, s68, s63
s_mul_i32 s58, s18, 28672
s_lshl_b32 s59, s68, 5
s_add_u32 s13, s58, s59
s_waitcnt vmcnt(0)
v_mov_b32 v186, 0
v_mov_b32 v187, 1
s_mov_b64 exec, 1
global_atomic_add v186, v187, s[76:77]
s_mov_b64 exec, -1
s_add_u32 s76, s80, s3
s_addc_u32 s77, s81, 0
v_mov_b32 v186, 0
s_mov_b32 s58, 0x20000
L_p2r4:
global_load_dword v187, v186, s[76:77] sc1
s_waitcnt vmcnt(0)
v_readfirstlane_b32 s59, v187
s_nop 3
s_cmp_ge_u32 s59, 4
s_cbranch_scc1 L_pd2r4
s_sub_u32 s58, s58, 1
s_cmp_lg_u32 s58, 0
s_cbranch_scc1 L_p2r4
L_pd2r4:
s_waitcnt vmcnt(0)
s_add_u32 s58, s27, 0
s_lshl_b32 s58, s58, 10
buffer_load_dwordx4 v[48:51], v6, s[20:23], s58 offen sc1
s_add_u32 s58, s58, 18432
buffer_load_dwordx4 v[52:55], v6, s[20:23], s58 offen sc1
s_add_u32 s58, s58, 18432
buffer_load_dwordx4 v[56:59], v6, s[20:23], s58 offen sc1
s_add_u32 s58, s58, 18432
buffer_load_dwordx4 v[60:63], v6, s[20:23], s58 offen sc1
s_add_u32 s58, s27, 4
s_lshl_b32 s58, s58, 10
buffer_load_dwordx4 v[64:67], v6, s[20:23], s58 offen sc1
s_add_u32 s58, s58, 18432
buffer_load_dwordx4 v[68:71], v6, s[20:23], s58 offen sc1
s_add_u32 s58, s58, 18432
buffer_load_dwordx4 v[72:75], v6, s[20:23], s58 offen sc1
s_add_u32 s58, s58, 18432
buffer_load_dwordx4 v[76:79], v6, s[20:23], s58 offen sc1
s_add_u32 s58, s27, 8
s_lshl_b32 s58, s58, 10
buffer_load_dwordx4 v[80:83], v6, s[20:23], s58 offen sc1
s_add_u32 s58, s58, 18432
buffer_load_dwordx4 v[84:87], v6, s[20:23], s58 offen sc1
s_add_u32 s58, s58, 18432
buffer_load_dwordx4 v[88:91], v6, s[20:23], s58 offen sc1
s_add_u32 s58, s58, 18432
buffer_load_dwordx4 v[92:95], v6, s[20:23], s58 offen sc1
s_add_u32 s58, s27, 12
s_lshl_b32 s58, s58, 10
buffer_load_dwordx4 v[96:99], v6, s[20:23], s58 offen sc1
s_add_u32 s58, s58, 18432
buffer_load_dwordx4 v[100:103], v6, s[20:23], s58 offen sc1
s_add_u32 s58, s58, 18432
buffer_load_dwordx4 v[104:107], v6, s[20:23], s58 offen sc1
s_add_u32 s58, s58, 18432
buffer_load_dwordx4 v[108:111], v6, s[20:23], s58 offen sc1
s_add_u32 s58, s27, 16
s_lshl_b32 s58, s58, 10
buffer_load_dwordx4 v[112:115], v6, s[20:23], s58 offen sc1
s_add_u32 s58, s58, 18432
buffer_load_dwordx4 v[116:119], v6, s[20:23], s58 offen sc1
s_add_u32 s58, s58, 18432
buffer_load_dwordx4 v[120:123], v6, s[20:23], s58 offen sc1
s_add_u32 s58, s58, 18432
buffer_load_dwordx4 v[124:127], v6, s[20:23], s58 offen sc1
s_add_u32 s66, s27, 0
s_waitcnt vmcnt(16)
s_cmp_ge_u32 s66, s65
s_cbranch_scc1 L_fin_r4_0
v_mfma_f32_16x16x32_bf16 v[140:143], v[130:133], v[48:51], 0
v_mfma_f32_16x16x32_bf16 v[144:147], v[128:131], v[48:51], 0
v_mfma_f32_16x16x32_bf16 v[140:143], v[130:133], v[52:55], v[140:143]
v_mfma_f32_16x16x32_bf16 v[144:147], v[128:131], v[52:55], v[144:147]
v_mfma_f32_16x16x32_bf16 v[140:143], v[130:133], v[56:59], v[140:143]
v_mfma_f32_16x16x32_bf16 v[144:147], v[128:131], v[56:59], v[144:147]
v_mfma_f32_16x16x32_bf16 v[140:143], v[130:133], v[60:63], v[140:143]
v_mfma_f32_16x16x32_bf16 v[144:147], v[128:131], v[60:63], v[144:147]
s_nop 7
v_cvt_pk_bf16_f32 v156, v140, v141
v_cvt_pk_bf16_f32 v157, v142, v143
v_cvt_pk_bf16_f32 v158, v144, v145
v_cvt_pk_bf16_f32 v159, v146, v147
buffer_store_dwordx2 v[156:157], v43, s[44:47], s4 offen
s_cmp_ge_u32 s14, s64
s_cbranch_scc1 L_fin_r4_0
buffer_store_dwordx2 v[158:159], v43, s[44:47], s9 offen
L_fin_r4_0:
s_add_u32 s66, s27, 4
s_waitcnt vmcnt(14)
s_cmp_ge_u32 s66, s65
s_cbranch_scc1 L_fin_r4_1
v_mfma_f32_16x16x32_bf16 v[148:151], v[130:133], v[64:67], 0
v_mfma_f32_16x16x32_bf16 v[152:155], v[128:131], v[64:67], 0
v_mfma_f32_16x16x32_bf16 v[148:151], v[130:133], v[68:71], v[148:151]
v_mfma_f32_16x16x32_bf16 v[152:155], v[128:131], v[68:71], v[152:155]
v_mfma_f32_16x16x32_bf16 v[148:151], v[130:133], v[72:75], v[148:151]
v_mfma_f32_16x16x32_bf16 v[152:155], v[128:131], v[72:75], v[152:155]
v_mfma_f32_16x16x32_bf16 v[148:151], v[130:133], v[76:79], v[148:151]
v_mfma_f32_16x16x32_bf16 v[152:155], v[128:131], v[76:79], v[152:155]
s_nop 7
v_cvt_pk_bf16_f32 v160, v148, v149
v_cvt_pk_bf16_f32 v161, v150, v151
v_cvt_pk_bf16_f32 v162, v152, v153
v_cvt_pk_bf16_f32 v163, v154, v155
buffer_store_dwordx2 v[160:161], v43, s[44:47], s5 offen
s_cmp_ge_u32 s15, s64
s_cbranch_scc1 L_fin_r4_1
buffer_store_dwordx2 v[162:163], v43, s[44:47], s10 offen
L_fin_r4_1:
s_add_u32 s66, s27, 8
s_waitcnt vmcnt(12)
s_cmp_ge_u32 s66, s65
s_cbranch_scc1 L_fin_r4_2
v_mfma_f32_16x16x32_bf16 v[140:143], v[130:133], v[80:83], 0
v_mfma_f32_16x16x32_bf16 v[144:147], v[128:131], v[80:83], 0
v_mfma_f32_16x16x32_bf16 v[140:143], v[130:133], v[84:87], v[140:143]
v_mfma_f32_16x16x32_bf16 v[144:147], v[128:131], v[84:87], v[144:147]
v_mfma_f32_16x16x32_bf16 v[140:143], v[130:133], v[88:91], v[140:143]
v_mfma_f32_16x16x32_bf16 v[144:147], v[128:131], v[88:91], v[144:147]
v_mfma_f32_16x16x32_bf16 v[140:143], v[130:133], v[92:95], v[140:143]
v_mfma_f32_16x16x32_bf16 v[144:147], v[128:131], v[92:95], v[144:147]
s_nop 7
v_cvt_pk_bf16_f32 v156, v140, v141
v_cvt_pk_bf16_f32 v157, v142, v143
v_cvt_pk_bf16_f32 v158, v144, v145
v_cvt_pk_bf16_f32 v159, v146, v147
buffer_store_dwordx2 v[156:157], v43, s[44:47], s6 offen
s_cmp_ge_u32 s16, s64
s_cbranch_scc1 L_fin_r4_2
buffer_store_dwordx2 v[158:159], v43, s[44:47], s11 offen
L_fin_r4_2:
s_add_u32 s66, s27, 12
s_waitcnt vmcnt(10)
s_cmp_ge_u32 s66, s65
s_cbranch_scc1 L_fin_r4_3
v_mfma_f32_16x16x32_bf16 v[148:151], v[130:133], v[96:99], 0
v_mfma_f32_16x16x32_bf16 v[152:155], v[128:131], v[96:99], 0
v_mfma_f32_16x16x32_bf16 v[148:151], v[130:133], v[100:103], v[148:151]
v_mfma_f32_16x16x32_bf16 v[152:155], v[128:131], v[100:103], v[152:155]
v_mfma_f32_16x16x32_bf16 v[148:151], v[130:133], v[104:107], v[148:151]
v_mfma_f32_16x16x32_bf16 v[152:155], v[128:131], v[104:107], v[152:155]
v_mfma_f32_16x16x32_bf16 v[148:151], v[130:133], v[108:111], v[148:151]
v_mfma_f32_16x16x32_bf16 v[152:155], v[128:131], v[108:111], v[152:155]
s_nop 7
v_cvt_pk_bf16_f32 v160, v148, v149
v_cvt_pk_bf16_f32 v161, v150, v151
v_cvt_pk_bf16_f32 v162, v152, v153
v_cvt_pk_bf16_f32 v163, v154, v155
buffer_store_dwordx2 v[160:161], v43, s[44:47], s7 offen
s_cmp_ge_u32 s17, s64
s_cbranch_scc1 L_fin_r4_3
buffer_store_dwordx2 v[162:163], v43, s[44:47], s12 offen
L_fin_r4_3:
s_add_u32 s66, s27, 16
s_waitcnt vmcnt(8)
s_cmp_ge_u32 s66, s65
s_cbranch_scc1 L_fin_r4_4
v_mfma_f32_16x16x32_bf16 v[140:143], v[130:133], v[112:115], 0
v_mfma_f32_16x16x32_bf16 v[144:147], v[128:131], v[112:115], 0
v_mfma_f32_16x16x32_bf16 v[140:143], v[130:133], v[116:119], v[140:143]
v_mfma_f32_16x16x32_bf16 v[144:147], v[128:131], v[116:119], v[144:147]
v_mfma_f32_16x16x32_bf16 v[140:143], v[130:133], v[120:123], v[140:143]
v_mfma_f32_16x16x32_bf16 v[144:147], v[128:131], v[120:123], v[144:147]
v_mfma_f32_16x16x32_bf16 v[140:143], v[130:133], v[124:127], v[140:143]
v_mfma_f32_16x16x32_bf16 v[144:147], v[128:131], v[124:127], v[144:147]
s_nop 7
v_cvt_pk_bf16_f32 v156, v140, v141
v_cvt_pk_bf16_f32 v157, v142, v143
v_cvt_pk_bf16_f32 v158, v144, v145
v_cvt_pk_bf16_f32 v159, v146, v147
buffer_store_dwordx2 v[156:157], v43, s[44:47], s8 offen
s_cmp_ge_u32 s18, s64
s_cbranch_scc1 L_fin_r4_4
buffer_store_dwordx2 v[158:159], v43, s[44:47], s13 offen
L_fin_r4_4:
s_endpgm
L_k1_end:
s_endpgm
L_k1_hot_end:
L_sp1_r5:
s_waitcnt lgkmcnt(0)
s_nop 7
s_nop 7
v_mbcnt_lo_u32_b32 v191, -1, 0
v_mbcnt_hi_u32_b32 v191, -1, v191
v_and_b32 v190, 15, v191
v_lshlrev_b32 v190, 9, v190
v_lshrrev_b32 v191, 4, v191
v_lshlrev_b32 v191, 4, v191
v_add_u32 v190, v190, v191
v_add_u32 v190, s34, v190
global_load_dwordx4 v[24:27], v190, s[36:37] offset:0
v_add_u32 v191, 8192, v190
global_load_dwordx4 v[28:31], v191, s[36:37] offset:0
s_waitcnt vmcnt(0)
v_mfma_f32_16x16x32_bf16 v[40:43], v[24:27], v[130:133], v[100:103]
v_mfma_f32_16x16x32_bf16 v[44:47], v[28:31], v[130:133], v[100:103]
v_mfma_f32_16x16x32_bf16 v[48:51], v[24:27], v[134:137], v[104:107]
v_mfma_f32_16x16x32_bf16 v[52:55], v[28:31], v[134:137], v[104:107]
v_mfma_f32_16x16x32_bf16 v[56:59], v[24:27], v[138:141], v[108:111]
v_mfma_f32_16x16x32_bf16 v[60:63], v[28:31], v[138:141], v[108:111]
v_mfma_f32_16x16x32_bf16 v[64:67], v[24:27], v[142:145], v[112:115]
v_mfma_f32_16x16x32_bf16 v[68:71], v[28:31], v[142:145], v[112:115]
v_mfma_f32_16x16x32_bf16 v[72:75], v[24:27], v[146:149], v[116:119]
v_mfma_f32_16x16x32_bf16 v[76:79], v[28:31], v[146:149], v[116:119]
s_nop 7
global_load_dwordx4 v[24:27], v190, s[36:37] offset:64
v_add_u32 v191, 8192, v190
global_load_dwordx4 v[28:31], v191, s[36:37] offset:64
s_waitcnt vmcnt(0)
v_mfma_f32_16x16x32_bf16 v[40:43], v[24:27], v[150:153], v[40:43]
v_mfma_f32_16x16x32_bf16 v[44:47], v[28:31], v[150:153], v[44:47]
v_mfma_f32_16x16x32_bf16 v[48:51], v[24:27], v[154:157], v[48:51]
v_mfma_f32_16x16x32_bf16 v[52:55], v[28:31], v[154:157], v[52:55]
v_mfma_f32_16x16x32_bf16 v[56:59], v[24:27], v[158:161], v[56:59]
v_mfma_f32_16x16x32_bf16 v[60:63], v[28:31], v[158:161], v[60:63]
v_mfma_f32_16x16x32_bf16 v[64:67], v[24:27], v[162:165], v[64:67]
v_mfma_f32_16x16x32_bf16 v[68:71], v[28:31], v[162:165], v[68:71]
v_mfma_f32_16x16x32_bf16 v[72:75], v[24:27], v[166:169], v[72:75]
v_mfma_f32_16x16x32_bf16 v[76:79], v[28:31], v[166:169], v[76:79]
s_nop 7
global_load_dwordx4 v[24:27], v190, s[36:37] offset:128
v_add_u32 v191, 8192, v190
global_load_dwordx4 v[28:31], v191, s[36:37] offset:128
s_waitcnt vmcnt(0)
ds_read_b128 v[32:35], v6 offset:0
s_waitcnt lgkmcnt(0)
v_mfma_f32_16x16x32_bf16 v[40:43], v[24:27], v[32:35], v[40:43]
v_mfma_f32_16x16x32_bf16 v[44:47], v[28:31], v[32:35], v[44:47]
s_nop 7
ds_read_b128 v[32:35], v6 offset:1024
s_waitcnt lgkmcnt(0)
v_mfma_f32_16x16x32_bf16 v[48:51], v[24:27], v[32:35], v[48:51]
v_mfma_f32_16x16x32_bf16 v[52:55], v[28:31], v[32:35], v[52:55]
s_nop 7
ds_read_b128 v[32:35], v6 offset:2048
s_waitcnt lgkmcnt(0)
v_mfma_f32_16x16x32_bf16 v[56:59], v[24:27], v[32:35], v[56:59]
v_mfma_f32_16x16x32_bf16 v[60:63], v[28:31], v[32:35], v[60:63]
s_nop 7
ds_read_b128 v[32:35], v6 offset:3072
s_waitcnt lgkmcnt(0)
v_mfma_f32_16x16x32_bf16 v[64:67], v[24:27], v[32:35], v[64:67]
v_mfma_f32_16x16x32_bf16 v[68:71], v[28:31], v[32:35], v[68:71]
s_nop 7
ds_read_b128 v[32:35], v6 offset:4096
s_waitcnt lgkmcnt(0)
v_mfma_f32_16x16x32_bf16 v[72:75], v[24:27], v[32:35], v[72:75]
v_mfma_f32_16x16x32_bf16 v[76:79], v[28:31], v[32:35], v[76:79]
s_nop 7
s_nop 7
global_load_dwordx4 v[24:27], v190, s[36:37] offset:192
v_add_u32 v191, 8192, v190
global_load_dwordx4 v[28:31], v191, s[36:37] offset:192
s_waitcnt vmcnt(0)
ds_read_b128 v[32:35], v6 offset:5120
s_waitcnt lgkmcnt(0)
v_mfma_f32_16x16x32_bf16 v[40:43], v[24:27], v[32:35], v[40:43]
v_mfma_f32_16x16x32_bf16 v[44:47], v[28:31], v[32:35], v[44:47]
s_nop 7
ds_read_b128 v[32:35], v6 offset:6144
s_waitcnt lgkmcnt(0)
v_mfma_f32_16x16x32_bf16 v[48:51], v[24:27], v[32:35], v[48:51]
v_mfma_f32_16x16x32_bf16 v[52:55], v[28:31], v[32:35], v[52:55]
s_nop 7
ds_read_b128 v[32:35], v6 offset:7168
s_waitcnt lgkmcnt(0)
v_mfma_f32_16x16x32_bf16 v[56:59], v[24:27], v[32:35], v[56:59]
v_mfma_f32_16x16x32_bf16 v[60:63], v[28:31], v[32:35], v[60:63]
s_nop 7
ds_read_b128 v[32:35], v6 offset:8192
s_waitcnt lgkmcnt(0)
v_mfma_f32_16x16x32_bf16 v[64:67], v[24:27], v[32:35], v[64:67]
v_mfma_f32_16x16x32_bf16 v[68:71], v[28:31], v[32:35], v[68:71]
s_nop 7
ds_read_b128 v[32:35], v6 offset:9216
s_waitcnt lgkmcnt(0)
v_mfma_f32_16x16x32_bf16 v[72:75], v[24:27], v[32:35], v[72:75]
v_mfma_f32_16x16x32_bf16 v[76:79], v[28:31], v[32:35], v[76:79]
s_nop 7
s_nop 7
global_load_dwordx4 v[24:27], v190, s[36:37] offset:256
v_add_u32 v191, 8192, v190
global_load_dwordx4 v[28:31], v191, s[36:37] offset:256
s_waitcnt vmcnt(0)
ds_read_b128 v[32:35], v6 offset:10240
s_waitcnt lgkmcnt(0)
v_mfma_f32_16x16x32_bf16 v[40:43], v[24:27], v[32:35], v[40:43]
v_mfma_f32_16x16x32_bf16 v[44:47], v[28:31], v[32:35], v[44:47]
s_nop 7
ds_read_b128 v[32:35], v6 offset:11264
s_waitcnt lgkmcnt(0)
v_mfma_f32_16x16x32_bf16 v[48:51], v[24:27], v[32:35], v[48:51]
v_mfma_f32_16x16x32_bf16 v[52:55], v[28:31], v[32:35], v[52:55]
s_nop 7
ds_read_b128 v[32:35], v6 offset:12288
s_waitcnt lgkmcnt(0)
v_mfma_f32_16x16x32_bf16 v[56:59], v[24:27], v[32:35], v[56:59]
v_mfma_f32_16x16x32_bf16 v[60:63], v[28:31], v[32:35], v[60:63]
s_nop 7
ds_read_b128 v[32:35], v6 offset:13312
s_waitcnt lgkmcnt(0)
v_mfma_f32_16x16x32_bf16 v[64:67], v[24:27], v[32:35], v[64:67]
v_mfma_f32_16x16x32_bf16 v[68:71], v[28:31], v[32:35], v[68:71]
s_nop 7
ds_read_b128 v[32:35], v6 offset:14336
s_waitcnt lgkmcnt(0)
v_mfma_f32_16x16x32_bf16 v[72:75], v[24:27], v[32:35], v[72:75]
v_mfma_f32_16x16x32_bf16 v[76:79], v[28:31], v[32:35], v[76:79]
s_nop 7
s_nop 7
global_load_dwordx4 v[24:27], v190, s[36:37] offset:320
v_add_u32 v191, 8192, v190
global_load_dwordx4 v[28:31], v191, s[36:37] offset:320
s_waitcnt vmcnt(0)
ds_read_b128 v[32:35], v6 offset:15360
s_waitcnt lgkmcnt(0)
v_mfma_f32_16x16x32_bf16 v[40:43], v[24:27], v[32:35], v[40:43]
v_mfma_f32_16x16x32_bf16 v[44:47], v[28:31], v[32:35], v[44:47]
s_nop 7
ds_read_b128 v[32:35], v6 offset:16384
s_waitcnt lgkmcnt(0)
v_mfma_f32_16x16x32_bf16 v[48:51], v[24:27], v[32:35], v[48:51]
v_mfma_f32_16x16x32_bf16 v[52:55], v[28:31], v[32:35], v[52:55]
s_nop 7
ds_read_b128 v[32:35], v6 offset:17408
s_waitcnt lgkmcnt(0)
v_mfma_f32_16x16x32_bf16 v[56:59], v[24:27], v[32:35], v[56:59]
v_mfma_f32_16x16x32_bf16 v[60:63], v[28:31], v[32:35], v[60:63]
s_nop 7
ds_read_b128 v[32:35], v6 offset:18432
s_waitcnt lgkmcnt(0)
v_mfma_f32_16x16x32_bf16 v[64:67], v[24:27], v[32:35], v[64:67]
v_mfma_f32_16x16x32_bf16 v[68:71], v[28:31], v[32:35], v[68:71]
s_nop 7
ds_read_b128 v[32:35], v6 offset:19456
s_waitcnt lgkmcnt(0)
v_mfma_f32_16x16x32_bf16 v[72:75], v[24:27], v[32:35], v[72:75]
v_mfma_f32_16x16x32_bf16 v[76:79], v[28:31], v[32:35], v[76:79]
s_nop 7
s_nop 7
global_load_dwordx4 v[24:27], v190, s[36:37] offset:384
v_add_u32 v191, 8192, v190
global_load_dwordx4 v[28:31], v191, s[36:37] offset:384
s_waitcnt vmcnt(0)
ds_read_b128 v[32:35], v6 offset:20480
s_waitcnt lgkmcnt(0)
v_mfma_f32_16x16x32_bf16 v[40:43], v[24:27], v[32:35], v[40:43]
v_mfma_f32_16x16x32_bf16 v[44:47], v[28:31], v[32:35], v[44:47]
s_nop 7
ds_read_b128 v[32:35], v6 offset:21504
s_waitcnt lgkmcnt(0)
v_mfma_f32_16x16x32_bf16 v[48:51], v[24:27], v[32:35], v[48:51]
v_mfma_f32_16x16x32_bf16 v[52:55], v[28:31], v[32:35], v[52:55]
s_nop 7
ds_read_b128 v[32:35], v6 offset:22528
s_waitcnt lgkmcnt(0)
v_mfma_f32_16x16x32_bf16 v[56:59], v[24:27], v[32:35], v[56:59]
v_mfma_f32_16x16x32_bf16 v[60:63], v[28:31], v[32:35], v[60:63]
s_nop 7
ds_read_b128 v[32:35], v6 offset:23552
s_waitcnt lgkmcnt(0)
v_mfma_f32_16x16x32_bf16 v[64:67], v[24:27], v[32:35], v[64:67]
v_mfma_f32_16x16x32_bf16 v[68:71], v[28:31], v[32:35], v[68:71]
s_nop 7
ds_read_b128 v[32:35], v6 offset:24576
s_waitcnt lgkmcnt(0)
v_mfma_f32_16x16x32_bf16 v[72:75], v[24:27], v[32:35], v[72:75]
v_mfma_f32_16x16x32_bf16 v[76:79], v[28:31], v[32:35], v[76:79]
s_nop 7
s_nop 7
global_load_dwordx4 v[24:27], v190, s[36:37] offset:448
v_add_u32 v191, 8192, v190
global_load_dwordx4 v[28:31], v191, s[36:37] offset:448
s_waitcnt vmcnt(0)
v_mfma_f32_16x16x32_bf16 v[40:43], v[24:27], v[170:173], v[40:43]
v_mfma_f32_16x16x32_bf16 v[44:47], v[28:31], v[170:173], v[44:47]
v_mfma_f32_16x16x32_bf16 v[48:51], v[24:27], v[174:177], v[48:51]
v_mfma_f32_16x16x32_bf16 v[52:55], v[28:31], v[174:177], v[52:55]
v_mfma_f32_16x16x32_bf16 v[56:59], v[24:27], v[178:181], v[56:59]
v_mfma_f32_16x16x32_bf16 v[60:63], v[28:31], v[178:181], v[60:63]
v_mfma_f32_16x16x32_bf16 v[64:67], v[24:27], v[182:185], v[64:67]
v_mfma_f32_16x16x32_bf16 v[68:71], v[28:31], v[182:185], v[68:71]
v_mfma_f32_16x16x32_bf16 v[72:75], v[24:27], v[186:189], v[72:75]
v_mfma_f32_16x16x32_bf16 v[76:79], v[28:31], v[186:189], v[76:79]
s_nop 7
s_nop 7
v_max3_f32 v84, v40, v41, v42
v_max3_f32 v84, v84, v43, v44
v_max3_f32 v84, v84, v45, v46
v_max_f32 v84, v84, v47
v_max3_f32 v85, v48, v49, v50
v_max3_f32 v85, v85, v51, v52
v_max3_f32 v85, v85, v53, v54
v_max_f32 v85, v85, v55
v_max3_f32 v86, v56, v57, v58
v_max3_f32 v86, v86, v59, v60
v_max3_f32 v86, v86, v61, v62
v_max_f32 v86, v86, v63
v_max3_f32 v87, v64, v65, v66
v_max3_f32 v87, v87, v67, v68
v_max3_f32 v87, v87, v69, v70
v_max_f32 v87, v87, v71
v_max3_f32 v88, v72, v73, v74
v_max3_f32 v88, v88, v75, v76
v_max3_f32 v88, v88, v77, v78
v_max_f32 v88, v88, v79
v_mbcnt_lo_u32_b32 v190, -1, 0
v_mbcnt_hi_u32_b32 v190, -1, v190
v_xor_b32 v191, 32, v190
v_xor_b32 v190, 16, v190
v_lshlrev_b32 v191, 2, v191
v_lshlrev_b32 v190, 2, v190
ds_bpermute_b32 v90, v190, v84
ds_bpermute_b32 v91, v190, v85
ds_bpermute_b32 v92, v190, v86
ds_bpermute_b32 v93, v190, v87
ds_bpermute_b32 v94, v190, v88
s_waitcnt lgkmcnt(0)
v_max_f32 v84, v84, v90
v_max_f32 v85, v85, v91
v_max_f32 v86, v86, v92
v_max_f32 v87, v87, v93
v_max_f32 v88, v88, v94
ds_bpermute_b32 v90, v191, v84
ds_bpermute_b32 v91, v191, v85
ds_bpermute_b32 v92, v191, v86
ds_bpermute_b32 v93, v191, v87
ds_bpermute_b32 v94, v191, v88
s_waitcnt lgkmcnt(0)
v_max_f32 v84, v84, v90
v_max_f32 v85, v85, v91
v_max_f32 v86, v86, v92
v_max_f32 v87, v87, v93
v_max_f32 v88, v88, v94
v_max_f32 v84, 0, v84
v_max_f32 v85, 0, v85
v_max_f32 v86, 0, v86
v_max_f32 v87, 0, v87
v_max_f32 v88, 0, v88
v_sub_f32 v90, 0, v84
v_sub_f32 v91, 0, v85
v_sub_f32 v92, 0, v86
v_sub_f32 v93, 0, v87
v_sub_f32 v94, 0, v88
v_exp_f32 v90, v90
v_exp_f32 v91, v91
v_exp_f32 v92, v92
v_exp_f32 v93, v93
v_exp_f32 v94, v94
s_nop 0
v_sub_f32 v100, v100, v84
v_sub_f32 v101, v101, v84
v_sub_f32 v102, v102, v84
v_sub_f32 v103, v103, v84
v_mul_f32 v120, v120, v90
v_accvgpr_read_b32 v190, a0
v_mul_f32 v190, v190, v90
v_accvgpr_write_b32 a0, v190
v_accvgpr_read_b32 v190, a1
v_mul_f32 v190, v190, v90
v_accvgpr_write_b32 a1, v190
v_accvgpr_read_b32 v190, a2
v_mul_f32 v190, v190, v90
v_accvgpr_write_b32 a2, v190
v_accvgpr_read_b32 v190, a3
v_mul_f32 v190, v190, v90
v_accvgpr_write_b32 a3, v190
v_accvgpr_read_b32 v190, a16
v_mul_f32 v190, v190, v90
v_accvgpr_write_b32 a16, v190
v_accvgpr_read_b32 v190, a17
v_mul_f32 v190, v190, v90
v_accvgpr_write_b32 a17, v190
v_accvgpr_read_b32 v190, a18
v_mul_f32 v190, v190, v90
v_accvgpr_write_b32 a18, v190
v_accvgpr_read_b32 v190, a19
v_mul_f32 v190, v190, v90
v_accvgpr_write_b32 a19, v190
v_accvgpr_read_b32 v190, a32
v_mul_f32 v190, v190, v90
v_accvgpr_write_b32 a32, v190
v_accvgpr_read_b32 v190, a33
v_mul_f32 v190, v190, v90
v_accvgpr_write_b32 a33, v190
v_accvgpr_read_b32 v190, a34
v_mul_f32 v190, v190, v90
v_accvgpr_write_b32 a34, v190
v_accvgpr_read_b32 v190, a35
v_mul_f32 v190, v190, v90
v_accvgpr_write_b32 a35, v190
v_accvgpr_read_b32 v190, a48
v_mul_f32 v190, v190, v90
v_accvgpr_write_b32 a48, v190
v_accvgpr_read_b32 v190, a49
v_mul_f32 v190, v190, v90
v_accvgpr_write_b32 a49, v190
v_accvgpr_read_b32 v190, a50
v_mul_f32 v190, v190, v90
v_accvgpr_write_b32 a50, v190
v_accvgpr_read_b32 v190, a51
v_mul_f32 v190, v190, v90
v_accvgpr_write_b32 a51, v190
v_accvgpr_read_b32 v190, a64
v_mul_f32 v190, v190, v90
v_accvgpr_write_b32 a64, v190
v_accvgpr_read_b32 v190, a65
v_mul_f32 v190, v190, v90
v_accvgpr_write_b32 a65, v190
v_accvgpr_read_b32 v190, a66
v_mul_f32 v190, v190, v90
v_accvgpr_write_b32 a66, v190
v_accvgpr_read_b32 v190, a67
v_mul_f32 v190, v190, v90
v_accvgpr_write_b32 a67, v190
v_accvgpr_read_b32 v190, a80
v_mul_f32 v190, v190, v90
v_accvgpr_write_b32 a80, v190
v_accvgpr_read_b32 v190, a81
v_mul_f32 v190, v190, v90
v_accvgpr_write_b32 a81, v190
v_accvgpr_read_b32 v190, a82
v_mul_f32 v190, v190, v90
v_accvgpr_write_b32 a82, v190
v_accvgpr_read_b32 v190, a83
v_mul_f32 v190, v190, v90
v_accvgpr_write_b32 a83, v190
v_accvgpr_read_b32 v190, a96
v_mul_f32 v190, v190, v90
v_accvgpr_write_b32 a96, v190
v_accvgpr_read_b32 v190, a97
v_mul_f32 v190, v190, v90
v_accvgpr_write_b32 a97, v190
v_accvgpr_read_b32 v190, a98
v_mul_f32 v190, v190, v90
v_accvgpr_write_b32 a98, v190
v_accvgpr_read_b32 v190, a99
v_mul_f32 v190, v190, v90
v_accvgpr_write_b32 a99, v190
v_accvgpr_read_b32 v190, a112
v_mul_f32 v190, v190, v90
v_accvgpr_write_b32 a112, v190
v_accvgpr_read_b32 v190, a113
v_mul_f32 v190, v190, v90
v_accvgpr_write_b32 a113, v190
v_accvgpr_read_b32 v190, a114
v_mul_f32 v190, v190, v90
v_accvgpr_write_b32 a114, v190
v_accvgpr_read_b32 v190, a115
v_mul_f32 v190, v190, v90
v_accvgpr_write_b32 a115, v190
v_accvgpr_read_b32 v190, a128
v_mul_f32 v190, v190, v90
v_accvgpr_write_b32 a128, v190
v_accvgpr_read_b32 v190, a129
v_mul_f32 v190, v190, v90
v_accvgpr_write_b32 a129, v190
v_accvgpr_read_b32 v190, a130
v_mul_f32 v190, v190, v90
v_accvgpr_write_b32 a130, v190
v_accvgpr_read_b32 v190, a131
v_mul_f32 v190, v190, v90
v_accvgpr_write_b32 a131, v190
v_accvgpr_read_b32 v190, a144
v_mul_f32 v190, v190, v90
v_accvgpr_write_b32 a144, v190
v_accvgpr_read_b32 v190, a145
v_mul_f32 v190, v190, v90
v_accvgpr_write_b32 a145, v190
v_accvgpr_read_b32 v190, a146
v_mul_f32 v190, v190, v90
v_accvgpr_write_b32 a146, v190
v_accvgpr_read_b32 v190, a147
v_mul_f32 v190, v190, v90
v_accvgpr_write_b32 a147, v190
v_accvgpr_read_b32 v190, a160
v_mul_f32 v190, v190, v90
v_accvgpr_write_b32 a160, v190
v_accvgpr_read_b32 v190, a161
v_mul_f32 v190, v190, v90
v_accvgpr_write_b32 a161, v190
v_accvgpr_read_b32 v190, a162
v_mul_f32 v190, v190, v90
v_accvgpr_write_b32 a162, v190
v_accvgpr_read_b32 v190, a163
v_mul_f32 v190, v190, v90
v_accvgpr_write_b32 a163, v190
v_accvgpr_read_b32 v190, a176
v_mul_f32 v190, v190, v90
v_accvgpr_write_b32 a176, v190
v_accvgpr_read_b32 v190, a177
v_mul_f32 v190, v190, v90
v_accvgpr_write_b32 a177, v190
v_accvgpr_read_b32 v190, a178
v_mul_f32 v190, v190, v90
v_accvgpr_write_b32 a178, v190
v_accvgpr_read_b32 v190, a179
v_mul_f32 v190, v190, v90
v_accvgpr_write_b32 a179, v190
v_accvgpr_read_b32 v190, a192
v_mul_f32 v190, v190, v90
v_accvgpr_write_b32 a192, v190
v_accvgpr_read_b32 v190, a193
v_mul_f32 v190, v190, v90
v_accvgpr_write_b32 a193, v190
v_accvgpr_read_b32 v190, a194
v_mul_f32 v190, v190, v90
v_accvgpr_write_b32 a194, v190
v_accvgpr_read_b32 v190, a195
v_mul_f32 v190, v190, v90
v_accvgpr_write_b32 a195, v190
v_accvgpr_read_b32 v190, a208
v_mul_f32 v190, v190, v90
v_accvgpr_write_b32 a208, v190
v_accvgpr_read_b32 v190, a209
v_mul_f32 v190, v190, v90
v_accvgpr_write_b32 a209, v190
v_accvgpr_read_b32 v190, a210
v_mul_f32 v190, v190, v90
v_accvgpr_write_b32 a210, v190
v_accvgpr_read_b32 v190, a211
v_mul_f32 v190, v190, v90
v_accvgpr_write_b32 a211, v190
v_accvgpr_read_b32 v190, a224
v_mul_f32 v190, v190, v90
v_accvgpr_write_b32 a224, v190
v_accvgpr_read_b32 v190, a225
v_mul_f32 v190, v190, v90
v_accvgpr_write_b32 a225, v190
v_accvgpr_read_b32 v190, a226
v_mul_f32 v190, v190, v90
v_accvgpr_write_b32 a226, v190
v_accvgpr_read_b32 v190, a227
v_mul_f32 v190, v190, v90
v_accvgpr_write_b32 a227, v190
v_accvgpr_read_b32 v190, a240
v_mul_f32 v190, v190, v90
v_accvgpr_write_b32 a240, v190
v_accvgpr_read_b32 v190, a241
v_mul_f32 v190, v190, v90
v_accvgpr_write_b32 a241, v190
v_accvgpr_read_b32 v190, a242
v_mul_f32 v190, v190, v90
v_accvgpr_write_b32 a242, v190
v_accvgpr_read_b32 v190, a243
v_mul_f32 v190, v190, v90
v_accvgpr_write_b32 a243, v190
v_sub_f32 v104, v104, v85
v_sub_f32 v105, v105, v85
v_sub_f32 v106, v106, v85
v_sub_f32 v107, v107, v85
v_mul_f32 v121, v121, v91
v_accvgpr_read_b32 v190, a4
v_mul_f32 v190, v190, v91
v_accvgpr_write_b32 a4, v190
v_accvgpr_read_b32 v190, a5
v_mul_f32 v190, v190, v91
v_accvgpr_write_b32 a5, v190
v_accvgpr_read_b32 v190, a6
v_mul_f32 v190, v190, v91
v_accvgpr_write_b32 a6, v190
v_accvgpr_read_b32 v190, a7
v_mul_f32 v190, v190, v91
v_accvgpr_write_b32 a7, v190
v_accvgpr_read_b32 v190, a20
v_mul_f32 v190, v190, v91
v_accvgpr_write_b32 a20, v190
v_accvgpr_read_b32 v190, a21
v_mul_f32 v190, v190, v91
v_accvgpr_write_b32 a21, v190
v_accvgpr_read_b32 v190, a22
v_mul_f32 v190, v190, v91
v_accvgpr_write_b32 a22, v190
v_accvgpr_read_b32 v190, a23
v_mul_f32 v190, v190, v91
v_accvgpr_write_b32 a23, v190
v_accvgpr_read_b32 v190, a36
v_mul_f32 v190, v190, v91
v_accvgpr_write_b32 a36, v190
v_accvgpr_read_b32 v190, a37
v_mul_f32 v190, v190, v91
v_accvgpr_write_b32 a37, v190
v_accvgpr_read_b32 v190, a38
v_mul_f32 v190, v190, v91
v_accvgpr_write_b32 a38, v190
v_accvgpr_read_b32 v190, a39
v_mul_f32 v190, v190, v91
v_accvgpr_write_b32 a39, v190
v_accvgpr_read_b32 v190, a52
v_mul_f32 v190, v190, v91
v_accvgpr_write_b32 a52, v190
v_accvgpr_read_b32 v190, a53
v_mul_f32 v190, v190, v91
v_accvgpr_write_b32 a53, v190
v_accvgpr_read_b32 v190, a54
v_mul_f32 v190, v190, v91
v_accvgpr_write_b32 a54, v190
v_accvgpr_read_b32 v190, a55
v_mul_f32 v190, v190, v91
v_accvgpr_write_b32 a55, v190
v_accvgpr_read_b32 v190, a68
v_mul_f32 v190, v190, v91
v_accvgpr_write_b32 a68, v190
v_accvgpr_read_b32 v190, a69
v_mul_f32 v190, v190, v91
v_accvgpr_write_b32 a69, v190
v_accvgpr_read_b32 v190, a70
v_mul_f32 v190, v190, v91
v_accvgpr_write_b32 a70, v190
v_accvgpr_read_b32 v190, a71
v_mul_f32 v190, v190, v91
v_accvgpr_write_b32 a71, v190
v_accvgpr_read_b32 v190, a84
v_mul_f32 v190, v190, v91
v_accvgpr_write_b32 a84, v190
v_accvgpr_read_b32 v190, a85
v_mul_f32 v190, v190, v91
v_accvgpr_write_b32 a85, v190
v_accvgpr_read_b32 v190, a86
v_mul_f32 v190, v190, v91
v_accvgpr_write_b32 a86, v190
v_accvgpr_read_b32 v190, a87
v_mul_f32 v190, v190, v91
v_accvgpr_write_b32 a87, v190
v_accvgpr_read_b32 v190, a100
v_mul_f32 v190, v190, v91
v_accvgpr_write_b32 a100, v190
v_accvgpr_read_b32 v190, a101
v_mul_f32 v190, v190, v91
v_accvgpr_write_b32 a101, v190
v_accvgpr_read_b32 v190, a102
v_mul_f32 v190, v190, v91
v_accvgpr_write_b32 a102, v190
v_accvgpr_read_b32 v190, a103
v_mul_f32 v190, v190, v91
v_accvgpr_write_b32 a103, v190
v_accvgpr_read_b32 v190, a116
v_mul_f32 v190, v190, v91
v_accvgpr_write_b32 a116, v190
v_accvgpr_read_b32 v190, a117
v_mul_f32 v190, v190, v91
v_accvgpr_write_b32 a117, v190
v_accvgpr_read_b32 v190, a118
v_mul_f32 v190, v190, v91
v_accvgpr_write_b32 a118, v190
v_accvgpr_read_b32 v190, a119
v_mul_f32 v190, v190, v91
v_accvgpr_write_b32 a119, v190
v_accvgpr_read_b32 v190, a132
v_mul_f32 v190, v190, v91
v_accvgpr_write_b32 a132, v190
v_accvgpr_read_b32 v190, a133
v_mul_f32 v190, v190, v91
v_accvgpr_write_b32 a133, v190
v_accvgpr_read_b32 v190, a134
v_mul_f32 v190, v190, v91
v_accvgpr_write_b32 a134, v190
v_accvgpr_read_b32 v190, a135
v_mul_f32 v190, v190, v91
v_accvgpr_write_b32 a135, v190
v_accvgpr_read_b32 v190, a148
v_mul_f32 v190, v190, v91
v_accvgpr_write_b32 a148, v190
v_accvgpr_read_b32 v190, a149
v_mul_f32 v190, v190, v91
v_accvgpr_write_b32 a149, v190
v_accvgpr_read_b32 v190, a150
v_mul_f32 v190, v190, v91
v_accvgpr_write_b32 a150, v190
v_accvgpr_read_b32 v190, a151
v_mul_f32 v190, v190, v91
v_accvgpr_write_b32 a151, v190
v_accvgpr_read_b32 v190, a164
v_mul_f32 v190, v190, v91
v_accvgpr_write_b32 a164, v190
v_accvgpr_read_b32 v190, a165
v_mul_f32 v190, v190, v91
v_accvgpr_write_b32 a165, v190
v_accvgpr_read_b32 v190, a166
v_mul_f32 v190, v190, v91
v_accvgpr_write_b32 a166, v190
v_accvgpr_read_b32 v190, a167
v_mul_f32 v190, v190, v91
v_accvgpr_write_b32 a167, v190
v_accvgpr_read_b32 v190, a180
v_mul_f32 v190, v190, v91
v_accvgpr_write_b32 a180, v190
v_accvgpr_read_b32 v190, a181
v_mul_f32 v190, v190, v91
v_accvgpr_write_b32 a181, v190
v_accvgpr_read_b32 v190, a182
v_mul_f32 v190, v190, v91
v_accvgpr_write_b32 a182, v190
v_accvgpr_read_b32 v190, a183
v_mul_f32 v190, v190, v91
v_accvgpr_write_b32 a183, v190
v_accvgpr_read_b32 v190, a196
v_mul_f32 v190, v190, v91
v_accvgpr_write_b32 a196, v190
v_accvgpr_read_b32 v190, a197
v_mul_f32 v190, v190, v91
v_accvgpr_write_b32 a197, v190
v_accvgpr_read_b32 v190, a198
v_mul_f32 v190, v190, v91
v_accvgpr_write_b32 a198, v190
v_accvgpr_read_b32 v190, a199
v_mul_f32 v190, v190, v91
v_accvgpr_write_b32 a199, v190
v_accvgpr_read_b32 v190, a212
v_mul_f32 v190, v190, v91
v_accvgpr_write_b32 a212, v190
v_accvgpr_read_b32 v190, a213
v_mul_f32 v190, v190, v91
v_accvgpr_write_b32 a213, v190
v_accvgpr_read_b32 v190, a214
v_mul_f32 v190, v190, v91
v_accvgpr_write_b32 a214, v190
v_accvgpr_read_b32 v190, a215
v_mul_f32 v190, v190, v91
v_accvgpr_write_b32 a215, v190
v_accvgpr_read_b32 v190, a228
v_mul_f32 v190, v190, v91
v_accvgpr_write_b32 a228, v190
v_accvgpr_read_b32 v190, a229
v_mul_f32 v190, v190, v91
v_accvgpr_write_b32 a229, v190
v_accvgpr_read_b32 v190, a230
v_mul_f32 v190, v190, v91
v_accvgpr_write_b32 a230, v190
v_accvgpr_read_b32 v190, a231
v_mul_f32 v190, v190, v91
v_accvgpr_write_b32 a231, v190
v_accvgpr_read_b32 v190, a244
v_mul_f32 v190, v190, v91
v_accvgpr_write_b32 a244, v190
v_accvgpr_read_b32 v190, a245
v_mul_f32 v190, v190, v91
v_accvgpr_write_b32 a245, v190
v_accvgpr_read_b32 v190, a246
v_mul_f32 v190, v190, v91
v_accvgpr_write_b32 a246, v190
v_accvgpr_read_b32 v190, a247
v_mul_f32 v190, v190, v91
v_accvgpr_write_b32 a247, v190
v_sub_f32 v108, v108, v86
v_sub_f32 v109, v109, v86
v_sub_f32 v110, v110, v86
v_sub_f32 v111, v111, v86
v_mul_f32 v122, v122, v92
v_accvgpr_read_b32 v190, a8
v_mul_f32 v190, v190, v92
v_accvgpr_write_b32 a8, v190
v_accvgpr_read_b32 v190, a9
v_mul_f32 v190, v190, v92
v_accvgpr_write_b32 a9, v190
v_accvgpr_read_b32 v190, a10
v_mul_f32 v190, v190, v92
v_accvgpr_write_b32 a10, v190
v_accvgpr_read_b32 v190, a11
v_mul_f32 v190, v190, v92
v_accvgpr_write_b32 a11, v190
v_accvgpr_read_b32 v190, a24
v_mul_f32 v190, v190, v92
v_accvgpr_write_b32 a24, v190
v_accvgpr_read_b32 v190, a25
v_mul_f32 v190, v190, v92
v_accvgpr_write_b32 a25, v190
v_accvgpr_read_b32 v190, a26
v_mul_f32 v190, v190, v92
v_accvgpr_write_b32 a26, v190
v_accvgpr_read_b32 v190, a27
v_mul_f32 v190, v190, v92
v_accvgpr_write_b32 a27, v190
v_accvgpr_read_b32 v190, a40
v_mul_f32 v190, v190, v92
v_accvgpr_write_b32 a40, v190
v_accvgpr_read_b32 v190, a41
v_mul_f32 v190, v190, v92
v_accvgpr_write_b32 a41, v190
v_accvgpr_read_b32 v190, a42
v_mul_f32 v190, v190, v92
v_accvgpr_write_b32 a42, v190
v_accvgpr_read_b32 v190, a43
v_mul_f32 v190, v190, v92
v_accvgpr_write_b32 a43, v190
v_accvgpr_read_b32 v190, a56
v_mul_f32 v190, v190, v92
v_accvgpr_write_b32 a56, v190
v_accvgpr_read_b32 v190, a57
v_mul_f32 v190, v190, v92
v_accvgpr_write_b32 a57, v190
v_accvgpr_read_b32 v190, a58
v_mul_f32 v190, v190, v92
v_accvgpr_write_b32 a58, v190
v_accvgpr_read_b32 v190, a59
v_mul_f32 v190, v190, v92
v_accvgpr_write_b32 a59, v190
v_accvgpr_read_b32 v190, a72
v_mul_f32 v190, v190, v92
v_accvgpr_write_b32 a72, v190
v_accvgpr_read_b32 v190, a73
v_mul_f32 v190, v190, v92
v_accvgpr_write_b32 a73, v190
v_accvgpr_read_b32 v190, a74
v_mul_f32 v190, v190, v92
v_accvgpr_write_b32 a74, v190
v_accvgpr_read_b32 v190, a75
v_mul_f32 v190, v190, v92
v_accvgpr_write_b32 a75, v190
v_accvgpr_read_b32 v190, a88
v_mul_f32 v190, v190, v92
v_accvgpr_write_b32 a88, v190
v_accvgpr_read_b32 v190, a89
v_mul_f32 v190, v190, v92
v_accvgpr_write_b32 a89, v190
v_accvgpr_read_b32 v190, a90
v_mul_f32 v190, v190, v92
v_accvgpr_write_b32 a90, v190
v_accvgpr_read_b32 v190, a91
v_mul_f32 v190, v190, v92
v_accvgpr_write_b32 a91, v190
v_accvgpr_read_b32 v190, a104
v_mul_f32 v190, v190, v92
v_accvgpr_write_b32 a104, v190
v_accvgpr_read_b32 v190, a105
v_mul_f32 v190, v190, v92
v_accvgpr_write_b32 a105, v190
v_accvgpr_read_b32 v190, a106
v_mul_f32 v190, v190, v92
v_accvgpr_write_b32 a106, v190
v_accvgpr_read_b32 v190, a107
v_mul_f32 v190, v190, v92
v_accvgpr_write_b32 a107, v190
v_accvgpr_read_b32 v190, a120
v_mul_f32 v190, v190, v92
v_accvgpr_write_b32 a120, v190
v_accvgpr_read_b32 v190, a121
v_mul_f32 v190, v190, v92
v_accvgpr_write_b32 a121, v190
v_accvgpr_read_b32 v190, a122
v_mul_f32 v190, v190, v92
v_accvgpr_write_b32 a122, v190
v_accvgpr_read_b32 v190, a123
v_mul_f32 v190, v190, v92
v_accvgpr_write_b32 a123, v190
v_accvgpr_read_b32 v190, a136
v_mul_f32 v190, v190, v92
v_accvgpr_write_b32 a136, v190
v_accvgpr_read_b32 v190, a137
v_mul_f32 v190, v190, v92
v_accvgpr_write_b32 a137, v190
v_accvgpr_read_b32 v190, a138
v_mul_f32 v190, v190, v92
v_accvgpr_write_b32 a138, v190
v_accvgpr_read_b32 v190, a139
v_mul_f32 v190, v190, v92
v_accvgpr_write_b32 a139, v190
v_accvgpr_read_b32 v190, a152
v_mul_f32 v190, v190, v92
v_accvgpr_write_b32 a152, v190
v_accvgpr_read_b32 v190, a153
v_mul_f32 v190, v190, v92
v_accvgpr_write_b32 a153, v190
v_accvgpr_read_b32 v190, a154
v_mul_f32 v190, v190, v92
v_accvgpr_write_b32 a154, v190
v_accvgpr_read_b32 v190, a155
v_mul_f32 v190, v190, v92
v_accvgpr_write_b32 a155, v190
v_accvgpr_read_b32 v190, a168
v_mul_f32 v190, v190, v92
v_accvgpr_write_b32 a168, v190
v_accvgpr_read_b32 v190, a169
v_mul_f32 v190, v190, v92
v_accvgpr_write_b32 a169, v190
v_accvgpr_read_b32 v190, a170
v_mul_f32 v190, v190, v92
v_accvgpr_write_b32 a170, v190
v_accvgpr_read_b32 v190, a171
v_mul_f32 v190, v190, v92
v_accvgpr_write_b32 a171, v190
v_accvgpr_read_b32 v190, a184
v_mul_f32 v190, v190, v92
v_accvgpr_write_b32 a184, v190
v_accvgpr_read_b32 v190, a185
v_mul_f32 v190, v190, v92
v_accvgpr_write_b32 a185, v190
v_accvgpr_read_b32 v190, a186
v_mul_f32 v190, v190, v92
v_accvgpr_write_b32 a186, v190
v_accvgpr_read_b32 v190, a187
v_mul_f32 v190, v190, v92
v_accvgpr_write_b32 a187, v190
v_accvgpr_read_b32 v190, a200
v_mul_f32 v190, v190, v92
v_accvgpr_write_b32 a200, v190
v_accvgpr_read_b32 v190, a201
v_mul_f32 v190, v190, v92
v_accvgpr_write_b32 a201, v190
v_accvgpr_read_b32 v190, a202
v_mul_f32 v190, v190, v92
v_accvgpr_write_b32 a202, v190
v_accvgpr_read_b32 v190, a203
v_mul_f32 v190, v190, v92
v_accvgpr_write_b32 a203, v190
v_accvgpr_read_b32 v190, a216
v_mul_f32 v190, v190, v92
v_accvgpr_write_b32 a216, v190
v_accvgpr_read_b32 v190, a217
v_mul_f32 v190, v190, v92
v_accvgpr_write_b32 a217, v190
v_accvgpr_read_b32 v190, a218
v_mul_f32 v190, v190, v92
v_accvgpr_write_b32 a218, v190
v_accvgpr_read_b32 v190, a219
v_mul_f32 v190, v190, v92
v_accvgpr_write_b32 a219, v190
v_accvgpr_read_b32 v190, a232
v_mul_f32 v190, v190, v92
v_accvgpr_write_b32 a232, v190
v_accvgpr_read_b32 v190, a233
v_mul_f32 v190, v190, v92
v_accvgpr_write_b32 a233, v190
v_accvgpr_read_b32 v190, a234
v_mul_f32 v190, v190, v92
v_accvgpr_write_b32 a234, v190
v_accvgpr_read_b32 v190, a235
v_mul_f32 v190, v190, v92
v_accvgpr_write_b32 a235, v190
v_accvgpr_read_b32 v190, a248
v_mul_f32 v190, v190, v92
v_accvgpr_write_b32 a248, v190
v_accvgpr_read_b32 v190, a249
v_mul_f32 v190, v190, v92
v_accvgpr_write_b32 a249, v190
v_accvgpr_read_b32 v190, a250
v_mul_f32 v190, v190, v92
v_accvgpr_write_b32 a250, v190
v_accvgpr_read_b32 v190, a251
v_mul_f32 v190, v190, v92
v_accvgpr_write_b32 a251, v190
v_sub_f32 v112, v112, v87
v_sub_f32 v113, v113, v87
v_sub_f32 v114, v114, v87
v_sub_f32 v115, v115, v87
v_mul_f32 v123, v123, v93
v_accvgpr_read_b32 v190, a12
v_mul_f32 v190, v190, v93
v_accvgpr_write_b32 a12, v190
v_accvgpr_read_b32 v190, a13
v_mul_f32 v190, v190, v93
v_accvgpr_write_b32 a13, v190
v_accvgpr_read_b32 v190, a14
v_mul_f32 v190, v190, v93
v_accvgpr_write_b32 a14, v190
v_accvgpr_read_b32 v190, a15
v_mul_f32 v190, v190, v93
v_accvgpr_write_b32 a15, v190
v_accvgpr_read_b32 v190, a28
v_mul_f32 v190, v190, v93
v_accvgpr_write_b32 a28, v190
v_accvgpr_read_b32 v190, a29
v_mul_f32 v190, v190, v93
v_accvgpr_write_b32 a29, v190
v_accvgpr_read_b32 v190, a30
v_mul_f32 v190, v190, v93
v_accvgpr_write_b32 a30, v190
v_accvgpr_read_b32 v190, a31
v_mul_f32 v190, v190, v93
v_accvgpr_write_b32 a31, v190
v_accvgpr_read_b32 v190, a44
v_mul_f32 v190, v190, v93
v_accvgpr_write_b32 a44, v190
v_accvgpr_read_b32 v190, a45
v_mul_f32 v190, v190, v93
v_accvgpr_write_b32 a45, v190
v_accvgpr_read_b32 v190, a46
v_mul_f32 v190, v190, v93
v_accvgpr_write_b32 a46, v190
v_accvgpr_read_b32 v190, a47
v_mul_f32 v190, v190, v93
v_accvgpr_write_b32 a47, v190
v_accvgpr_read_b32 v190, a60
v_mul_f32 v190, v190, v93
v_accvgpr_write_b32 a60, v190
v_accvgpr_read_b32 v190, a61
v_mul_f32 v190, v190, v93
v_accvgpr_write_b32 a61, v190
v_accvgpr_read_b32 v190, a62
v_mul_f32 v190, v190, v93
v_accvgpr_write_b32 a62, v190
v_accvgpr_read_b32 v190, a63
v_mul_f32 v190, v190, v93
v_accvgpr_write_b32 a63, v190
v_accvgpr_read_b32 v190, a76
v_mul_f32 v190, v190, v93
v_accvgpr_write_b32 a76, v190
v_accvgpr_read_b32 v190, a77
v_mul_f32 v190, v190, v93
v_accvgpr_write_b32 a77, v190
v_accvgpr_read_b32 v190, a78
v_mul_f32 v190, v190, v93
v_accvgpr_write_b32 a78, v190
v_accvgpr_read_b32 v190, a79
v_mul_f32 v190, v190, v93
v_accvgpr_write_b32 a79, v190
v_accvgpr_read_b32 v190, a92
v_mul_f32 v190, v190, v93
v_accvgpr_write_b32 a92, v190
v_accvgpr_read_b32 v190, a93
v_mul_f32 v190, v190, v93
v_accvgpr_write_b32 a93, v190
v_accvgpr_read_b32 v190, a94
v_mul_f32 v190, v190, v93
v_accvgpr_write_b32 a94, v190
v_accvgpr_read_b32 v190, a95
v_mul_f32 v190, v190, v93
v_accvgpr_write_b32 a95, v190
v_accvgpr_read_b32 v190, a108
v_mul_f32 v190, v190, v93
v_accvgpr_write_b32 a108, v190
v_accvgpr_read_b32 v190, a109
v_mul_f32 v190, v190, v93
v_accvgpr_write_b32 a109, v190
v_accvgpr_read_b32 v190, a110
v_mul_f32 v190, v190, v93
v_accvgpr_write_b32 a110, v190
v_accvgpr_read_b32 v190, a111
v_mul_f32 v190, v190, v93
v_accvgpr_write_b32 a111, v190
v_accvgpr_read_b32 v190, a124
v_mul_f32 v190, v190, v93
v_accvgpr_write_b32 a124, v190
v_accvgpr_read_b32 v190, a125
v_mul_f32 v190, v190, v93
v_accvgpr_write_b32 a125, v190
v_accvgpr_read_b32 v190, a126
v_mul_f32 v190, v190, v93
v_accvgpr_write_b32 a126, v190
v_accvgpr_read_b32 v190, a127
v_mul_f32 v190, v190, v93
v_accvgpr_write_b32 a127, v190
v_accvgpr_read_b32 v190, a140
v_mul_f32 v190, v190, v93
v_accvgpr_write_b32 a140, v190
v_accvgpr_read_b32 v190, a141
v_mul_f32 v190, v190, v93
v_accvgpr_write_b32 a141, v190
v_accvgpr_read_b32 v190, a142
v_mul_f32 v190, v190, v93
v_accvgpr_write_b32 a142, v190
v_accvgpr_read_b32 v190, a143
v_mul_f32 v190, v190, v93
v_accvgpr_write_b32 a143, v190
v_accvgpr_read_b32 v190, a156
v_mul_f32 v190, v190, v93
v_accvgpr_write_b32 a156, v190
v_accvgpr_read_b32 v190, a157
v_mul_f32 v190, v190, v93
v_accvgpr_write_b32 a157, v190
v_accvgpr_read_b32 v190, a158
v_mul_f32 v190, v190, v93
v_accvgpr_write_b32 a158, v190
v_accvgpr_read_b32 v190, a159
v_mul_f32 v190, v190, v93
v_accvgpr_write_b32 a159, v190
v_accvgpr_read_b32 v190, a172
v_mul_f32 v190, v190, v93
v_accvgpr_write_b32 a172, v190
v_accvgpr_read_b32 v190, a173
v_mul_f32 v190, v190, v93
v_accvgpr_write_b32 a173, v190
v_accvgpr_read_b32 v190, a174
v_mul_f32 v190, v190, v93
v_accvgpr_write_b32 a174, v190
v_accvgpr_read_b32 v190, a175
v_mul_f32 v190, v190, v93
v_accvgpr_write_b32 a175, v190
v_accvgpr_read_b32 v190, a188
v_mul_f32 v190, v190, v93
v_accvgpr_write_b32 a188, v190
v_accvgpr_read_b32 v190, a189
v_mul_f32 v190, v190, v93
v_accvgpr_write_b32 a189, v190
v_accvgpr_read_b32 v190, a190
v_mul_f32 v190, v190, v93
v_accvgpr_write_b32 a190, v190
v_accvgpr_read_b32 v190, a191
v_mul_f32 v190, v190, v93
v_accvgpr_write_b32 a191, v190
v_accvgpr_read_b32 v190, a204
v_mul_f32 v190, v190, v93
v_accvgpr_write_b32 a204, v190
v_accvgpr_read_b32 v190, a205
v_mul_f32 v190, v190, v93
v_accvgpr_write_b32 a205, v190
v_accvgpr_read_b32 v190, a206
v_mul_f32 v190, v190, v93
v_accvgpr_write_b32 a206, v190
v_accvgpr_read_b32 v190, a207
v_mul_f32 v190, v190, v93
v_accvgpr_write_b32 a207, v190
v_accvgpr_read_b32 v190, a220
v_mul_f32 v190, v190, v93
v_accvgpr_write_b32 a220, v190
v_accvgpr_read_b32 v190, a221
v_mul_f32 v190, v190, v93
v_accvgpr_write_b32 a221, v190
v_accvgpr_read_b32 v190, a222
v_mul_f32 v190, v190, v93
v_accvgpr_write_b32 a222, v190
v_accvgpr_read_b32 v190, a223
v_mul_f32 v190, v190, v93
v_accvgpr_write_b32 a223, v190
v_accvgpr_read_b32 v190, a236
v_mul_f32 v190, v190, v93
v_accvgpr_write_b32 a236, v190
v_accvgpr_read_b32 v190, a237
v_mul_f32 v190, v190, v93
v_accvgpr_write_b32 a237, v190
v_accvgpr_read_b32 v190, a238
v_mul_f32 v190, v190, v93
v_accvgpr_write_b32 a238, v190
v_accvgpr_read_b32 v190, a239
v_mul_f32 v190, v190, v93
v_accvgpr_write_b32 a239, v190
v_accvgpr_read_b32 v190, a252
v_mul_f32 v190, v190, v93
v_accvgpr_write_b32 a252, v190
v_accvgpr_read_b32 v190, a253
v_mul_f32 v190, v190, v93
v_accvgpr_write_b32 a253, v190
v_accvgpr_read_b32 v190, a254
v_mul_f32 v190, v190, v93
v_accvgpr_write_b32 a254, v190
v_accvgpr_read_b32 v190, a255
v_mul_f32 v190, v190, v93
v_accvgpr_write_b32 a255, v190
v_sub_f32 v116, v116, v88
v_sub_f32 v117, v117, v88
v_sub_f32 v118, v118, v88
v_sub_f32 v119, v119, v88
v_mul_f32 v124, v124, v94
v_mul_f32 v192, v192, v94
v_mul_f32 v193, v193, v94
v_mul_f32 v194, v194, v94
v_mul_f32 v195, v195, v94
v_mul_f32 v196, v196, v94
v_mul_f32 v197, v197, v94
v_mul_f32 v198, v198, v94
v_mul_f32 v199, v199, v94
v_mul_f32 v200, v200, v94
v_mul_f32 v201, v201, v94
v_mul_f32 v202, v202, v94
v_mul_f32 v203, v203, v94
v_mul_f32 v204, v204, v94
v_mul_f32 v205, v205, v94
v_mul_f32 v206, v206, v94
v_mul_f32 v207, v207, v94
v_mul_f32 v208, v208, v94
v_mul_f32 v209, v209, v94
v_mul_f32 v210, v210, v94
v_mul_f32 v211, v211, v94
v_mul_f32 v212, v212, v94
v_mul_f32 v213, v213, v94
v_mul_f32 v214, v214, v94
v_mul_f32 v215, v215, v94
v_mul_f32 v216, v216, v94
v_mul_f32 v217, v217, v94
v_mul_f32 v218, v218, v94
v_mul_f32 v219, v219, v94
v_mul_f32 v220, v220, v94
v_mul_f32 v221, v221, v94
v_mul_f32 v222, v222, v94
v_mul_f32 v223, v223, v94
v_mul_f32 v224, v224, v94
v_mul_f32 v225, v225, v94
v_mul_f32 v226, v226, v94
v_mul_f32 v227, v227, v94
v_mul_f32 v228, v228, v94
v_mul_f32 v229, v229, v94
v_mul_f32 v230, v230, v94
v_mul_f32 v231, v231, v94
v_mul_f32 v232, v232, v94
v_mul_f32 v233, v233, v94
v_mul_f32 v234, v234, v94
v_mul_f32 v235, v235, v94
v_mul_f32 v236, v236, v94
v_mul_f32 v237, v237, v94
v_mul_f32 v238, v238, v94
v_mul_f32 v239, v239, v94
v_mul_f32 v240, v240, v94
v_mul_f32 v241, v241, v94
v_mul_f32 v242, v242, v94
v_mul_f32 v243, v243, v94
v_mul_f32 v244, v244, v94
v_mul_f32 v245, v245, v94
v_mul_f32 v246, v246, v94
v_mul_f32 v247, v247, v94
v_mul_f32 v248, v248, v94
v_mul_f32 v249, v249, v94
v_mul_f32 v250, v250, v94
v_mul_f32 v251, v251, v94
v_mul_f32 v252, v252, v94
v_mul_f32 v253, v253, v94
v_mul_f32 v254, v254, v94
v_mul_f32 v255, v255, v94
v_sub_f32 v40, v40, v84
v_sub_f32 v41, v41, v84
v_sub_f32 v42, v42, v84
v_sub_f32 v43, v43, v84
v_sub_f32 v44, v44, v84
v_sub_f32 v45, v45, v84
v_sub_f32 v46, v46, v84
v_sub_f32 v47, v47, v84
v_sub_f32 v48, v48, v85
v_sub_f32 v49, v49, v85
v_sub_f32 v50, v50, v85
v_sub_f32 v51, v51, v85
v_sub_f32 v52, v52, v85
v_sub_f32 v53, v53, v85
v_sub_f32 v54, v54, v85
v_sub_f32 v55, v55, v85
v_sub_f32 v56, v56, v86
v_sub_f32 v57, v57, v86
v_sub_f32 v58, v58, v86
v_sub_f32 v59, v59, v86
v_sub_f32 v60, v60, v86
v_sub_f32 v61, v61, v86
v_sub_f32 v62, v62, v86
v_sub_f32 v63, v63, v86
v_sub_f32 v64, v64, v87
v_sub_f32 v65, v65, v87
v_sub_f32 v66, v66, v87
v_sub_f32 v67, v67, v87
v_sub_f32 v68, v68, v87
v_sub_f32 v69, v69, v87
v_sub_f32 v70, v70, v87
v_sub_f32 v71, v71, v87
v_sub_f32 v72, v72, v88
v_sub_f32 v73, v73, v88
v_sub_f32 v74, v74, v88
v_sub_f32 v75, v75, v88
v_sub_f32 v76, v76, v88
v_sub_f32 v77, v77, v88
v_sub_f32 v78, v78, v88
v_sub_f32 v79, v79, v88
v_exp_f32 v40, v40
v_exp_f32 v41, v41
v_exp_f32 v42, v42
v_exp_f32 v43, v43
v_exp_f32 v44, v44
v_exp_f32 v45, v45
v_exp_f32 v46, v46
v_exp_f32 v47, v47
v_exp_f32 v48, v48
v_exp_f32 v49, v49
v_exp_f32 v50, v50
v_exp_f32 v51, v51
v_exp_f32 v52, v52
v_exp_f32 v53, v53
v_exp_f32 v54, v54
v_exp_f32 v55, v55
v_exp_f32 v56, v56
v_exp_f32 v57, v57
v_exp_f32 v58, v58
v_exp_f32 v59, v59
v_exp_f32 v60, v60
v_exp_f32 v61, v61
v_exp_f32 v62, v62
v_exp_f32 v63, v63
v_exp_f32 v64, v64
v_exp_f32 v65, v65
v_exp_f32 v66, v66
v_exp_f32 v67, v67
v_exp_f32 v68, v68
v_exp_f32 v69, v69
v_exp_f32 v70, v70
v_exp_f32 v71, v71
v_exp_f32 v72, v72
v_exp_f32 v73, v73
v_exp_f32 v74, v74
v_exp_f32 v75, v75
v_exp_f32 v76, v76
v_exp_f32 v77, v77
v_exp_f32 v78, v78
v_exp_f32 v79, v79
s_nop 0
v_add_f32 v125, v120, v40
v_add_f32 v125, v125, v41
v_add_f32 v125, v125, v42
v_add_f32 v125, v125, v43
v_add_f32 v125, v125, v44
v_add_f32 v125, v125, v45
v_add_f32 v125, v125, v46
v_add_f32 v125, v125, v47
v_add_f32 v126, v121, v48
v_add_f32 v126, v126, v49
v_add_f32 v126, v126, v50
v_add_f32 v126, v126, v51
v_add_f32 v126, v126, v52
v_add_f32 v126, v126, v53
v_add_f32 v126, v126, v54
v_add_f32 v126, v126, v55
v_add_f32 v127, v122, v56
v_add_f32 v127, v127, v57
v_add_f32 v127, v127, v58
v_add_f32 v127, v127, v59
v_add_f32 v127, v127, v60
v_add_f32 v127, v127, v61
v_add_f32 v127, v127, v62
v_add_f32 v127, v127, v63
v_add_f32 v128, v123, v64
v_add_f32 v128, v128, v65
v_add_f32 v128, v128, v66
v_add_f32 v128, v128, v67
v_add_f32 v128, v128, v68
v_add_f32 v128, v128, v69
v_add_f32 v128, v128, v70
v_add_f32 v128, v128, v71
v_add_f32 v129, v124, v72
v_add_f32 v129, v129, v73
v_add_f32 v129, v129, v74
v_add_f32 v129, v129, v75
v_add_f32 v129, v129, v76
v_add_f32 v129, v129, v77
v_add_f32 v129, v129, v78
v_add_f32 v129, v129, v79
v_cvt_pk_bf16_f32 v80, v40, v41
v_cvt_pk_bf16_f32 v81, v42, v43
v_cvt_pk_bf16_f32 v82, v44, v45
v_cvt_pk_bf16_f32 v83, v46, v47
s_nop 1
s_branch L_sp1_r5_ret
L_sp0_r5:
s_waitcnt lgkmcnt(0)
s_nop 7
s_nop 7
v_mbcnt_lo_u32_b32 v191, -1, 0
v_mbcnt_hi_u32_b32 v191, -1, v191
v_and_b32 v190, 15, v191
v_lshlrev_b32 v190, 9, v190
v_lshrrev_b32 v191, 4, v191
v_lshlrev_b32 v191, 4, v191
v_add_u32 v190, v190, v191
v_add_u32 v190, s34, v190
global_load_dwordx4 v[24:27], v190, s[36:37] offset:0
v_add_u32 v191, 8192, v190
global_load_dwordx4 v[28:31], v191, s[36:37] offset:0
s_waitcnt vmcnt(0)
v_mfma_f32_16x16x32_bf16 v[40:43], v[24:27], v[130:133], v[100:103]
v_mfma_f32_16x16x32_bf16 v[44:47], v[28:31], v[130:133], v[100:103]
v_mfma_f32_16x16x32_bf16 v[48:51], v[24:27], v[134:137], v[104:107]
v_mfma_f32_16x16x32_bf16 v[52:55], v[28:31], v[134:137], v[104:107]
v_mfma_f32_16x16x32_bf16 v[56:59], v[24:27], v[138:141], v[108:111]
v_mfma_f32_16x16x32_bf16 v[60:63], v[28:31], v[138:141], v[108:111]
v_mfma_f32_16x16x32_bf16 v[64:67], v[24:27], v[142:145], v[112:115]
v_mfma_f32_16x16x32_bf16 v[68:71], v[28:31], v[142:145], v[112:115]
v_mfma_f32_16x16x32_bf16 v[72:75], v[24:27], v[146:149], v[116:119]
v_mfma_f32_16x16x32_bf16 v[76:79], v[28:31], v[146:149], v[116:119]
s_nop 7
global_load_dwordx4 v[24:27], v190, s[36:37] offset:64
v_add_u32 v191, 8192, v190
global_load_dwordx4 v[28:31], v191, s[36:37] offset:64
s_waitcnt vmcnt(0)
v_mfma_f32_16x16x32_bf16 v[40:43], v[24:27], v[150:153], v[40:43]
v_mfma_f32_16x16x32_bf16 v[44:47], v[28:31], v[150:153], v[44:47]
v_mfma_f32_16x16x32_bf16 v[48:51], v[24:27], v[154:157], v[48:51]
v_mfma_f32_16x16x32_bf16 v[52:55], v[28:31], v[154:157], v[52:55]
v_mfma_f32_16x16x32_bf16 v[56:59], v[24:27], v[158:161], v[56:59]
v_mfma_f32_16x16x32_bf16 v[60:63], v[28:31], v[158:161], v[60:63]
v_mfma_f32_16x16x32_bf16 v[64:67], v[24:27], v[162:165], v[64:67]
v_mfma_f32_16x16x32_bf16 v[68:71], v[28:31], v[162:165], v[68:71]
v_mfma_f32_16x16x32_bf16 v[72:75], v[24:27], v[166:169], v[72:75]
v_mfma_f32_16x16x32_bf16 v[76:79], v[28:31], v[166:169], v[76:79]
s_nop 7
global_load_dwordx4 v[24:27], v190, s[36:37] offset:128
v_add_u32 v191, 8192, v190
global_load_dwordx4 v[28:31], v191, s[36:37] offset:128
s_waitcnt vmcnt(0)
ds_read_b128 v[32:35], v6 offset:0
s_waitcnt lgkmcnt(0)
v_mfma_f32_16x16x32_bf16 v[40:43], v[24:27], v[32:35], v[40:43]
v_mfma_f32_16x16x32_bf16 v[44:47], v[28:31], v[32:35], v[44:47]
s_nop 7
ds_read_b128 v[32:35], v6 offset:1024
s_waitcnt lgkmcnt(0)
v_mfma_f32_16x16x32_bf16 v[48:51], v[24:27], v[32:35], v[48:51]
v_mfma_f32_16x16x32_bf16 v[52:55], v[28:31], v[32:35], v[52:55]
s_nop 7
ds_read_b128 v[32:35], v6 offset:2048
s_waitcnt lgkmcnt(0)
v_mfma_f32_16x16x32_bf16 v[56:59], v[24:27], v[32:35], v[56:59]
v_mfma_f32_16x16x32_bf16 v[60:63], v[28:31], v[32:35], v[60:63]
s_nop 7
ds_read_b128 v[32:35], v6 offset:3072
s_waitcnt lgkmcnt(0)
v_mfma_f32_16x16x32_bf16 v[64:67], v[24:27], v[32:35], v[64:67]
v_mfma_f32_16x16x32_bf16 v[68:71], v[28:31], v[32:35], v[68:71]
s_nop 7
ds_read_b128 v[32:35], v6 offset:4096
s_waitcnt lgkmcnt(0)
v_mfma_f32_16x16x32_bf16 v[72:75], v[24:27], v[32:35], v[72:75]
v_mfma_f32_16x16x32_bf16 v[76:79], v[28:31], v[32:35], v[76:79]
s_nop 7
s_nop 7
global_load_dwordx4 v[24:27], v190, s[36:37] offset:192
v_add_u32 v191, 8192, v190
global_load_dwordx4 v[28:31], v191, s[36:37] offset:192
s_waitcnt vmcnt(0)
ds_read_b128 v[32:35], v6 offset:5120
s_waitcnt lgkmcnt(0)
v_mfma_f32_16x16x32_bf16 v[40:43], v[24:27], v[32:35], v[40:43]
v_mfma_f32_16x16x32_bf16 v[44:47], v[28:31], v[32:35], v[44:47]
s_nop 7
ds_read_b128 v[32:35], v6 offset:6144
s_waitcnt lgkmcnt(0)
v_mfma_f32_16x16x32_bf16 v[48:51], v[24:27], v[32:35], v[48:51]
v_mfma_f32_16x16x32_bf16 v[52:55], v[28:31], v[32:35], v[52:55]
s_nop 7
ds_read_b128 v[32:35], v6 offset:7168
s_waitcnt lgkmcnt(0)
v_mfma_f32_16x16x32_bf16 v[56:59], v[24:27], v[32:35], v[56:59]
v_mfma_f32_16x16x32_bf16 v[60:63], v[28:31], v[32:35], v[60:63]
s_nop 7
ds_read_b128 v[32:35], v6 offset:8192
s_waitcnt lgkmcnt(0)
v_mfma_f32_16x16x32_bf16 v[64:67], v[24:27], v[32:35], v[64:67]
v_mfma_f32_16x16x32_bf16 v[68:71], v[28:31], v[32:35], v[68:71]
s_nop 7
ds_read_b128 v[32:35], v6 offset:9216
s_waitcnt lgkmcnt(0)
v_mfma_f32_16x16x32_bf16 v[72:75], v[24:27], v[32:35], v[72:75]
v_mfma_f32_16x16x32_bf16 v[76:79], v[28:31], v[32:35], v[76:79]
s_nop 7
s_nop 7
global_load_dwordx4 v[24:27], v190, s[36:37] offset:256
v_add_u32 v191, 8192, v190
global_load_dwordx4 v[28:31], v191, s[36:37] offset:256
s_waitcnt vmcnt(0)
ds_read_b128 v[32:35], v6 offset:10240
s_waitcnt lgkmcnt(0)
v_mfma_f32_16x16x32_bf16 v[40:43], v[24:27], v[32:35], v[40:43]
v_mfma_f32_16x16x32_bf16 v[44:47], v[28:31], v[32:35], v[44:47]
s_nop 7
ds_read_b128 v[32:35], v6 offset:11264
s_waitcnt lgkmcnt(0)
v_mfma_f32_16x16x32_bf16 v[48:51], v[24:27], v[32:35], v[48:51]
v_mfma_f32_16x16x32_bf16 v[52:55], v[28:31], v[32:35], v[52:55]
s_nop 7
ds_read_b128 v[32:35], v6 offset:12288
s_waitcnt lgkmcnt(0)
v_mfma_f32_16x16x32_bf16 v[56:59], v[24:27], v[32:35], v[56:59]
v_mfma_f32_16x16x32_bf16 v[60:63], v[28:31], v[32:35], v[60:63]
s_nop 7
ds_read_b128 v[32:35], v6 offset:13312
s_waitcnt lgkmcnt(0)
v_mfma_f32_16x16x32_bf16 v[64:67], v[24:27], v[32:35], v[64:67]
v_mfma_f32_16x16x32_bf16 v[68:71], v[28:31], v[32:35], v[68:71]
s_nop 7
ds_read_b128 v[32:35], v6 offset:14336
s_waitcnt lgkmcnt(0)
v_mfma_f32_16x16x32_bf16 v[72:75], v[24:27], v[32:35], v[72:75]
v_mfma_f32_16x16x32_bf16 v[76:79], v[28:31], v[32:35], v[76:79]
s_nop 7
s_nop 7
global_load_dwordx4 v[24:27], v190, s[36:37] offset:320
v_add_u32 v191, 8192, v190
global_load_dwordx4 v[28:31], v191, s[36:37] offset:320
s_waitcnt vmcnt(0)
ds_read_b128 v[32:35], v6 offset:15360
s_waitcnt lgkmcnt(0)
v_mfma_f32_16x16x32_bf16 v[40:43], v[24:27], v[32:35], v[40:43]
v_mfma_f32_16x16x32_bf16 v[44:47], v[28:31], v[32:35], v[44:47]
s_nop 7
ds_read_b128 v[32:35], v6 offset:16384
s_waitcnt lgkmcnt(0)
v_mfma_f32_16x16x32_bf16 v[48:51], v[24:27], v[32:35], v[48:51]
v_mfma_f32_16x16x32_bf16 v[52:55], v[28:31], v[32:35], v[52:55]
s_nop 7
ds_read_b128 v[32:35], v6 offset:17408
s_waitcnt lgkmcnt(0)
v_mfma_f32_16x16x32_bf16 v[56:59], v[24:27], v[32:35], v[56:59]
v_mfma_f32_16x16x32_bf16 v[60:63], v[28:31], v[32:35], v[60:63]
s_nop 7
ds_read_b128 v[32:35], v6 offset:18432
s_waitcnt lgkmcnt(0)
v_mfma_f32_16x16x32_bf16 v[64:67], v[24:27], v[32:35], v[64:67]
v_mfma_f32_16x16x32_bf16 v[68:71], v[28:31], v[32:35], v[68:71]
s_nop 7
ds_read_b128 v[32:35], v6 offset:19456
s_waitcnt lgkmcnt(0)
v_mfma_f32_16x16x32_bf16 v[72:75], v[24:27], v[32:35], v[72:75]
v_mfma_f32_16x16x32_bf16 v[76:79], v[28:31], v[32:35], v[76:79]
s_nop 7
s_nop 7
global_load_dwordx4 v[24:27], v190, s[36:37] offset:384
v_add_u32 v191, 8192, v190
global_load_dwordx4 v[28:31], v191, s[36:37] offset:384
s_waitcnt vmcnt(0)
ds_read_b128 v[32:35], v6 offset:20480
s_waitcnt lgkmcnt(0)
v_mfma_f32_16x16x32_bf16 v[40:43], v[24:27], v[32:35], v[40:43]
v_mfma_f32_16x16x32_bf16 v[44:47], v[28:31], v[32:35], v[44:47]
s_nop 7
ds_read_b128 v[32:35], v6 offset:21504
s_waitcnt lgkmcnt(0)
v_mfma_f32_16x16x32_bf16 v[48:51], v[24:27], v[32:35], v[48:51]
v_mfma_f32_16x16x32_bf16 v[52:55], v[28:31], v[32:35], v[52:55]
s_nop 7
ds_read_b128 v[32:35], v6 offset:22528
s_waitcnt lgkmcnt(0)
v_mfma_f32_16x16x32_bf16 v[56:59], v[24:27], v[32:35], v[56:59]
v_mfma_f32_16x16x32_bf16 v[60:63], v[28:31], v[32:35], v[60:63]
s_nop 7
ds_read_b128 v[32:35], v6 offset:23552
s_waitcnt lgkmcnt(0)
v_mfma_f32_16x16x32_bf16 v[64:67], v[24:27], v[32:35], v[64:67]
v_mfma_f32_16x16x32_bf16 v[68:71], v[28:31], v[32:35], v[68:71]
s_nop 7
ds_read_b128 v[32:35], v6 offset:24576
s_waitcnt lgkmcnt(0)
v_mfma_f32_16x16x32_bf16 v[72:75], v[24:27], v[32:35], v[72:75]
v_mfma_f32_16x16x32_bf16 v[76:79], v[28:31], v[32:35], v[76:79]
s_nop 7
s_nop 7
global_load_dwordx4 v[24:27], v190, s[36:37] offset:448
v_add_u32 v191, 8192, v190
global_load_dwordx4 v[28:31], v191, s[36:37] offset:448
s_waitcnt vmcnt(0)
v_mfma_f32_16x16x32_bf16 v[40:43], v[24:27], v[170:173], v[40:43]
v_mfma_f32_16x16x32_bf16 v[44:47], v[28:31], v[170:173], v[44:47]
v_mfma_f32_16x16x32_bf16 v[48:51], v[24:27], v[174:177], v[48:51]
v_mfma_f32_16x16x32_bf16 v[52:55], v[28:31], v[174:177], v[52:55]
v_mfma_f32_16x16x32_bf16 v[56:59], v[24:27], v[178:181], v[56:59]
v_mfma_f32_16x16x32_bf16 v[60:63], v[28:31], v[178:181], v[60:63]
v_mfma_f32_16x16x32_bf16 v[64:67], v[24:27], v[182:185], v[64:67]
v_mfma_f32_16x16x32_bf16 v[68:71], v[28:31], v[182:185], v[68:71]
v_mfma_f32_16x16x32_bf16 v[72:75], v[24:27], v[186:189], v[72:75]
v_mfma_f32_16x16x32_bf16 v[76:79], v[28:31], v[186:189], v[76:79]
s_nop 7
s_nop 7
v_max3_f32 v84, v40, v41, v42
v_max3_f32 v84, v84, v43, v44
v_max3_f32 v84, v84, v45, v46
v_max_f32 v84, v84, v47
v_max3_f32 v85, v48, v49, v50
v_max3_f32 v85, v85, v51, v52
v_max3_f32 v85, v85, v53, v54
v_max_f32 v85, v85, v55
v_max3_f32 v86, v56, v57, v58
v_max3_f32 v86, v86, v59, v60
v_max3_f32 v86, v86, v61, v62
v_max_f32 v86, v86, v63
v_max3_f32 v87, v64, v65, v66
v_max3_f32 v87, v87, v67, v68
v_max3_f32 v87, v87, v69, v70
v_max_f32 v87, v87, v71
v_max3_f32 v88, v72, v73, v74
v_max3_f32 v88, v88, v75, v76
v_max3_f32 v88, v88, v77, v78
v_max_f32 v88, v88, v79
v_mbcnt_lo_u32_b32 v190, -1, 0
v_mbcnt_hi_u32_b32 v190, -1, v190
v_xor_b32 v191, 32, v190
v_xor_b32 v190, 16, v190
v_lshlrev_b32 v191, 2, v191
v_lshlrev_b32 v190, 2, v190
ds_bpermute_b32 v90, v190, v84
ds_bpermute_b32 v91, v190, v85
ds_bpermute_b32 v92, v190, v86
ds_bpermute_b32 v93, v190, v87
ds_bpermute_b32 v94, v190, v88
s_waitcnt lgkmcnt(0)
v_max_f32 v84, v84, v90
v_max_f32 v85, v85, v91
v_max_f32 v86, v86, v92
v_max_f32 v87, v87, v93
v_max_f32 v88, v88, v94
ds_bpermute_b32 v90, v191, v84
ds_bpermute_b32 v91, v191, v85
ds_bpermute_b32 v92, v191, v86
ds_bpermute_b32 v93, v191, v87
ds_bpermute_b32 v94, v191, v88
s_waitcnt lgkmcnt(0)
v_max_f32 v84, v84, v90
v_max_f32 v85, v85, v91
v_max_f32 v86, v86, v92
v_max_f32 v87, v87, v93
v_max_f32 v88, v88, v94
v_max_f32 v84, 0, v84
v_max_f32 v85, 0, v85
v_max_f32 v86, 0, v86
v_max_f32 v87, 0, v87
v_max_f32 v88, 0, v88
v_sub_f32 v90, 0, v84
v_sub_f32 v91, 0, v85
v_sub_f32 v92, 0, v86
v_sub_f32 v93, 0, v87
v_sub_f32 v94, 0, v88
v_exp_f32 v90, v90
v_exp_f32 v91, v91
v_exp_f32 v92, v92
v_exp_f32 v93, v93
v_exp_f32 v94, v94
s_nop 0
v_sub_f32 v100, v100, v84
v_sub_f32 v101, v101, v84
v_sub_f32 v102, v102, v84
v_sub_f32 v103, v103, v84
v_mul_f32 v125, v125, v90
v_accvgpr_read_b32 v190, a0
v_mul_f32 v190, v190, v90
v_accvgpr_write_b32 a0, v190
v_accvgpr_read_b32 v190, a1
v_mul_f32 v190, v190, v90
v_accvgpr_write_b32 a1, v190
v_accvgpr_read_b32 v190, a2
v_mul_f32 v190, v190, v90
v_accvgpr_write_b32 a2, v190
v_accvgpr_read_b32 v190, a3
v_mul_f32 v190, v190, v90
v_accvgpr_write_b32 a3, v190
v_accvgpr_read_b32 v190, a16
v_mul_f32 v190, v190, v90
v_accvgpr_write_b32 a16, v190
v_accvgpr_read_b32 v190, a17
v_mul_f32 v190, v190, v90
v_accvgpr_write_b32 a17, v190
v_accvgpr_read_b32 v190, a18
v_mul_f32 v190, v190, v90
v_accvgpr_write_b32 a18, v190
v_accvgpr_read_b32 v190, a19
v_mul_f32 v190, v190, v90
v_accvgpr_write_b32 a19, v190
v_accvgpr_read_b32 v190, a32
v_mul_f32 v190, v190, v90
v_accvgpr_write_b32 a32, v190
v_accvgpr_read_b32 v190, a33
v_mul_f32 v190, v190, v90
v_accvgpr_write_b32 a33, v190
v_accvgpr_read_b32 v190, a34
v_mul_f32 v190, v190, v90
v_accvgpr_write_b32 a34, v190
v_accvgpr_read_b32 v190, a35
v_mul_f32 v190, v190, v90
v_accvgpr_write_b32 a35, v190
v_accvgpr_read_b32 v190, a48
v_mul_f32 v190, v190, v90
v_accvgpr_write_b32 a48, v190
v_accvgpr_read_b32 v190, a49
v_mul_f32 v190, v190, v90
v_accvgpr_write_b32 a49, v190
v_accvgpr_read_b32 v190, a50
v_mul_f32 v190, v190, v90
v_accvgpr_write_b32 a50, v190
v_accvgpr_read_b32 v190, a51
v_mul_f32 v190, v190, v90
v_accvgpr_write_b32 a51, v190
v_accvgpr_read_b32 v190, a64
v_mul_f32 v190, v190, v90
v_accvgpr_write_b32 a64, v190
v_accvgpr_read_b32 v190, a65
v_mul_f32 v190, v190, v90
v_accvgpr_write_b32 a65, v190
v_accvgpr_read_b32 v190, a66
v_mul_f32 v190, v190, v90
v_accvgpr_write_b32 a66, v190
v_accvgpr_read_b32 v190, a67
v_mul_f32 v190, v190, v90
v_accvgpr_write_b32 a67, v190
v_accvgpr_read_b32 v190, a80
v_mul_f32 v190, v190, v90
v_accvgpr_write_b32 a80, v190
v_accvgpr_read_b32 v190, a81
v_mul_f32 v190, v190, v90
v_accvgpr_write_b32 a81, v190
v_accvgpr_read_b32 v190, a82
v_mul_f32 v190, v190, v90
v_accvgpr_write_b32 a82, v190
v_accvgpr_read_b32 v190, a83
v_mul_f32 v190, v190, v90
v_accvgpr_write_b32 a83, v190
v_accvgpr_read_b32 v190, a96
v_mul_f32 v190, v190, v90
v_accvgpr_write_b32 a96, v190
v_accvgpr_read_b32 v190, a97
v_mul_f32 v190, v190, v90
v_accvgpr_write_b32 a97, v190
v_accvgpr_read_b32 v190, a98
v_mul_f32 v190, v190, v90
v_accvgpr_write_b32 a98, v190
v_accvgpr_read_b32 v190, a99
v_mul_f32 v190, v190, v90
v_accvgpr_write_b32 a99, v190
v_accvgpr_read_b32 v190, a112
v_mul_f32 v190, v190, v90
v_accvgpr_write_b32 a112, v190
v_accvgpr_read_b32 v190, a113
v_mul_f32 v190, v190, v90
v_accvgpr_write_b32 a113, v190
v_accvgpr_read_b32 v190, a114
v_mul_f32 v190, v190, v90
v_accvgpr_write_b32 a114, v190
v_accvgpr_read_b32 v190, a115
v_mul_f32 v190, v190, v90
v_accvgpr_write_b32 a115, v190
v_accvgpr_read_b32 v190, a128
v_mul_f32 v190, v190, v90
v_accvgpr_write_b32 a128, v190
v_accvgpr_read_b32 v190, a129
v_mul_f32 v190, v190, v90
v_accvgpr_write_b32 a129, v190
v_accvgpr_read_b32 v190, a130
v_mul_f32 v190, v190, v90
v_accvgpr_write_b32 a130, v190
v_accvgpr_read_b32 v190, a131
v_mul_f32 v190, v190, v90
v_accvgpr_write_b32 a131, v190
v_accvgpr_read_b32 v190, a144
v_mul_f32 v190, v190, v90
v_accvgpr_write_b32 a144, v190
v_accvgpr_read_b32 v190, a145
v_mul_f32 v190, v190, v90
v_accvgpr_write_b32 a145, v190
v_accvgpr_read_b32 v190, a146
v_mul_f32 v190, v190, v90
v_accvgpr_write_b32 a146, v190
v_accvgpr_read_b32 v190, a147
v_mul_f32 v190, v190, v90
v_accvgpr_write_b32 a147, v190
v_accvgpr_read_b32 v190, a160
v_mul_f32 v190, v190, v90
v_accvgpr_write_b32 a160, v190
v_accvgpr_read_b32 v190, a161
v_mul_f32 v190, v190, v90
v_accvgpr_write_b32 a161, v190
v_accvgpr_read_b32 v190, a162
v_mul_f32 v190, v190, v90
v_accvgpr_write_b32 a162, v190
v_accvgpr_read_b32 v190, a163
v_mul_f32 v190, v190, v90
v_accvgpr_write_b32 a163, v190
v_accvgpr_read_b32 v190, a176
v_mul_f32 v190, v190, v90
v_accvgpr_write_b32 a176, v190
v_accvgpr_read_b32 v190, a177
v_mul_f32 v190, v190, v90
v_accvgpr_write_b32 a177, v190
v_accvgpr_read_b32 v190, a178
v_mul_f32 v190, v190, v90
v_accvgpr_write_b32 a178, v190
v_accvgpr_read_b32 v190, a179
v_mul_f32 v190, v190, v90
v_accvgpr_write_b32 a179, v190
v_accvgpr_read_b32 v190, a192
v_mul_f32 v190, v190, v90
v_accvgpr_write_b32 a192, v190
v_accvgpr_read_b32 v190, a193
v_mul_f32 v190, v190, v90
v_accvgpr_write_b32 a193, v190
v_accvgpr_read_b32 v190, a194
v_mul_f32 v190, v190, v90
v_accvgpr_write_b32 a194, v190
v_accvgpr_read_b32 v190, a195
v_mul_f32 v190, v190, v90
v_accvgpr_write_b32 a195, v190
v_accvgpr_read_b32 v190, a208
v_mul_f32 v190, v190, v90
v_accvgpr_write_b32 a208, v190
v_accvgpr_read_b32 v190, a209
v_mul_f32 v190, v190, v90
v_accvgpr_write_b32 a209, v190
v_accvgpr_read_b32 v190, a210
v_mul_f32 v190, v190, v90
v_accvgpr_write_b32 a210, v190
v_accvgpr_read_b32 v190, a211
v_mul_f32 v190, v190, v90
v_accvgpr_write_b32 a211, v190
v_accvgpr_read_b32 v190, a224
v_mul_f32 v190, v190, v90
v_accvgpr_write_b32 a224, v190
v_accvgpr_read_b32 v190, a225
v_mul_f32 v190, v190, v90
v_accvgpr_write_b32 a225, v190
v_accvgpr_read_b32 v190, a226
v_mul_f32 v190, v190, v90
v_accvgpr_write_b32 a226, v190
v_accvgpr_read_b32 v190, a227
v_mul_f32 v190, v190, v90
v_accvgpr_write_b32 a227, v190
v_accvgpr_read_b32 v190, a240
v_mul_f32 v190, v190, v90
v_accvgpr_write_b32 a240, v190
v_accvgpr_read_b32 v190, a241
v_mul_f32 v190, v190, v90
v_accvgpr_write_b32 a241, v190
v_accvgpr_read_b32 v190, a242
v_mul_f32 v190, v190, v90
v_accvgpr_write_b32 a242, v190
v_accvgpr_read_b32 v190, a243
v_mul_f32 v190, v190, v90
v_accvgpr_write_b32 a243, v190
v_sub_f32 v104, v104, v85
v_sub_f32 v105, v105, v85
v_sub_f32 v106, v106, v85
v_sub_f32 v107, v107, v85
v_mul_f32 v126, v126, v91
v_accvgpr_read_b32 v190, a4
v_mul_f32 v190, v190, v91
v_accvgpr_write_b32 a4, v190
v_accvgpr_read_b32 v190, a5
v_mul_f32 v190, v190, v91
v_accvgpr_write_b32 a5, v190
v_accvgpr_read_b32 v190, a6
v_mul_f32 v190, v190, v91
v_accvgpr_write_b32 a6, v190
v_accvgpr_read_b32 v190, a7
v_mul_f32 v190, v190, v91
v_accvgpr_write_b32 a7, v190
v_accvgpr_read_b32 v190, a20
v_mul_f32 v190, v190, v91
v_accvgpr_write_b32 a20, v190
v_accvgpr_read_b32 v190, a21
v_mul_f32 v190, v190, v91
v_accvgpr_write_b32 a21, v190
v_accvgpr_read_b32 v190, a22
v_mul_f32 v190, v190, v91
v_accvgpr_write_b32 a22, v190
v_accvgpr_read_b32 v190, a23
v_mul_f32 v190, v190, v91
v_accvgpr_write_b32 a23, v190
v_accvgpr_read_b32 v190, a36
v_mul_f32 v190, v190, v91
v_accvgpr_write_b32 a36, v190
v_accvgpr_read_b32 v190, a37
v_mul_f32 v190, v190, v91
v_accvgpr_write_b32 a37, v190
v_accvgpr_read_b32 v190, a38
v_mul_f32 v190, v190, v91
v_accvgpr_write_b32 a38, v190
v_accvgpr_read_b32 v190, a39
v_mul_f32 v190, v190, v91
v_accvgpr_write_b32 a39, v190
v_accvgpr_read_b32 v190, a52
v_mul_f32 v190, v190, v91
v_accvgpr_write_b32 a52, v190
v_accvgpr_read_b32 v190, a53
v_mul_f32 v190, v190, v91
v_accvgpr_write_b32 a53, v190
v_accvgpr_read_b32 v190, a54
v_mul_f32 v190, v190, v91
v_accvgpr_write_b32 a54, v190
v_accvgpr_read_b32 v190, a55
v_mul_f32 v190, v190, v91
v_accvgpr_write_b32 a55, v190
v_accvgpr_read_b32 v190, a68
v_mul_f32 v190, v190, v91
v_accvgpr_write_b32 a68, v190
v_accvgpr_read_b32 v190, a69
v_mul_f32 v190, v190, v91
v_accvgpr_write_b32 a69, v190
v_accvgpr_read_b32 v190, a70
v_mul_f32 v190, v190, v91
v_accvgpr_write_b32 a70, v190
v_accvgpr_read_b32 v190, a71
v_mul_f32 v190, v190, v91
v_accvgpr_write_b32 a71, v190
v_accvgpr_read_b32 v190, a84
v_mul_f32 v190, v190, v91
v_accvgpr_write_b32 a84, v190
v_accvgpr_read_b32 v190, a85
v_mul_f32 v190, v190, v91
v_accvgpr_write_b32 a85, v190
v_accvgpr_read_b32 v190, a86
v_mul_f32 v190, v190, v91
v_accvgpr_write_b32 a86, v190
v_accvgpr_read_b32 v190, a87
v_mul_f32 v190, v190, v91
v_accvgpr_write_b32 a87, v190
v_accvgpr_read_b32 v190, a100
v_mul_f32 v190, v190, v91
v_accvgpr_write_b32 a100, v190
v_accvgpr_read_b32 v190, a101
v_mul_f32 v190, v190, v91
v_accvgpr_write_b32 a101, v190
v_accvgpr_read_b32 v190, a102
v_mul_f32 v190, v190, v91
v_accvgpr_write_b32 a102, v190
v_accvgpr_read_b32 v190, a103
v_mul_f32 v190, v190, v91
v_accvgpr_write_b32 a103, v190
v_accvgpr_read_b32 v190, a116
v_mul_f32 v190, v190, v91
v_accvgpr_write_b32 a116, v190
v_accvgpr_read_b32 v190, a117
v_mul_f32 v190, v190, v91
v_accvgpr_write_b32 a117, v190
v_accvgpr_read_b32 v190, a118
v_mul_f32 v190, v190, v91
v_accvgpr_write_b32 a118, v190
v_accvgpr_read_b32 v190, a119
v_mul_f32 v190, v190, v91
v_accvgpr_write_b32 a119, v190
v_accvgpr_read_b32 v190, a132
v_mul_f32 v190, v190, v91
v_accvgpr_write_b32 a132, v190
v_accvgpr_read_b32 v190, a133
v_mul_f32 v190, v190, v91
v_accvgpr_write_b32 a133, v190
v_accvgpr_read_b32 v190, a134
v_mul_f32 v190, v190, v91
v_accvgpr_write_b32 a134, v190
v_accvgpr_read_b32 v190, a135
v_mul_f32 v190, v190, v91
v_accvgpr_write_b32 a135, v190
v_accvgpr_read_b32 v190, a148
v_mul_f32 v190, v190, v91
v_accvgpr_write_b32 a148, v190
v_accvgpr_read_b32 v190, a149
v_mul_f32 v190, v190, v91
v_accvgpr_write_b32 a149, v190
v_accvgpr_read_b32 v190, a150
v_mul_f32 v190, v190, v91
v_accvgpr_write_b32 a150, v190
v_accvgpr_read_b32 v190, a151
v_mul_f32 v190, v190, v91
v_accvgpr_write_b32 a151, v190
v_accvgpr_read_b32 v190, a164
v_mul_f32 v190, v190, v91
v_accvgpr_write_b32 a164, v190
v_accvgpr_read_b32 v190, a165
v_mul_f32 v190, v190, v91
v_accvgpr_write_b32 a165, v190
v_accvgpr_read_b32 v190, a166
v_mul_f32 v190, v190, v91
v_accvgpr_write_b32 a166, v190
v_accvgpr_read_b32 v190, a167
v_mul_f32 v190, v190, v91
v_accvgpr_write_b32 a167, v190
v_accvgpr_read_b32 v190, a180
v_mul_f32 v190, v190, v91
v_accvgpr_write_b32 a180, v190
v_accvgpr_read_b32 v190, a181
v_mul_f32 v190, v190, v91
v_accvgpr_write_b32 a181, v190
v_accvgpr_read_b32 v190, a182
v_mul_f32 v190, v190, v91
v_accvgpr_write_b32 a182, v190
v_accvgpr_read_b32 v190, a183
v_mul_f32 v190, v190, v91
v_accvgpr_write_b32 a183, v190
v_accvgpr_read_b32 v190, a196
v_mul_f32 v190, v190, v91
v_accvgpr_write_b32 a196, v190
v_accvgpr_read_b32 v190, a197
v_mul_f32 v190, v190, v91
v_accvgpr_write_b32 a197, v190
v_accvgpr_read_b32 v190, a198
v_mul_f32 v190, v190, v91
v_accvgpr_write_b32 a198, v190
v_accvgpr_read_b32 v190, a199
v_mul_f32 v190, v190, v91
v_accvgpr_write_b32 a199, v190
v_accvgpr_read_b32 v190, a212
v_mul_f32 v190, v190, v91
v_accvgpr_write_b32 a212, v190
v_accvgpr_read_b32 v190, a213
v_mul_f32 v190, v190, v91
v_accvgpr_write_b32 a213, v190
v_accvgpr_read_b32 v190, a214
v_mul_f32 v190, v190, v91
v_accvgpr_write_b32 a214, v190
v_accvgpr_read_b32 v190, a215
v_mul_f32 v190, v190, v91
v_accvgpr_write_b32 a215, v190
v_accvgpr_read_b32 v190, a228
v_mul_f32 v190, v190, v91
v_accvgpr_write_b32 a228, v190
v_accvgpr_read_b32 v190, a229
v_mul_f32 v190, v190, v91
v_accvgpr_write_b32 a229, v190
v_accvgpr_read_b32 v190, a230
v_mul_f32 v190, v190, v91
v_accvgpr_write_b32 a230, v190
v_accvgpr_read_b32 v190, a231
v_mul_f32 v190, v190, v91
v_accvgpr_write_b32 a231, v190
v_accvgpr_read_b32 v190, a244
v_mul_f32 v190, v190, v91
v_accvgpr_write_b32 a244, v190
v_accvgpr_read_b32 v190, a245
v_mul_f32 v190, v190, v91
v_accvgpr_write_b32 a245, v190
v_accvgpr_read_b32 v190, a246
v_mul_f32 v190, v190, v91
v_accvgpr_write_b32 a246, v190
v_accvgpr_read_b32 v190, a247
v_mul_f32 v190, v190, v91
v_accvgpr_write_b32 a247, v190
v_sub_f32 v108, v108, v86
v_sub_f32 v109, v109, v86
v_sub_f32 v110, v110, v86
v_sub_f32 v111, v111, v86
v_mul_f32 v127, v127, v92
v_accvgpr_read_b32 v190, a8
v_mul_f32 v190, v190, v92
v_accvgpr_write_b32 a8, v190
v_accvgpr_read_b32 v190, a9
v_mul_f32 v190, v190, v92
v_accvgpr_write_b32 a9, v190
v_accvgpr_read_b32 v190, a10
v_mul_f32 v190, v190, v92
v_accvgpr_write_b32 a10, v190
v_accvgpr_read_b32 v190, a11
v_mul_f32 v190, v190, v92
v_accvgpr_write_b32 a11, v190
v_accvgpr_read_b32 v190, a24
v_mul_f32 v190, v190, v92
v_accvgpr_write_b32 a24, v190
v_accvgpr_read_b32 v190, a25
v_mul_f32 v190, v190, v92
v_accvgpr_write_b32 a25, v190
v_accvgpr_read_b32 v190, a26
v_mul_f32 v190, v190, v92
v_accvgpr_write_b32 a26, v190
v_accvgpr_read_b32 v190, a27
v_mul_f32 v190, v190, v92
v_accvgpr_write_b32 a27, v190
v_accvgpr_read_b32 v190, a40
v_mul_f32 v190, v190, v92
v_accvgpr_write_b32 a40, v190
v_accvgpr_read_b32 v190, a41
v_mul_f32 v190, v190, v92
v_accvgpr_write_b32 a41, v190
v_accvgpr_read_b32 v190, a42
v_mul_f32 v190, v190, v92
v_accvgpr_write_b32 a42, v190
v_accvgpr_read_b32 v190, a43
v_mul_f32 v190, v190, v92
v_accvgpr_write_b32 a43, v190
v_accvgpr_read_b32 v190, a56
v_mul_f32 v190, v190, v92
v_accvgpr_write_b32 a56, v190
v_accvgpr_read_b32 v190, a57
v_mul_f32 v190, v190, v92
v_accvgpr_write_b32 a57, v190
v_accvgpr_read_b32 v190, a58
v_mul_f32 v190, v190, v92
v_accvgpr_write_b32 a58, v190
v_accvgpr_read_b32 v190, a59
v_mul_f32 v190, v190, v92
v_accvgpr_write_b32 a59, v190
v_accvgpr_read_b32 v190, a72
v_mul_f32 v190, v190, v92
v_accvgpr_write_b32 a72, v190
v_accvgpr_read_b32 v190, a73
v_mul_f32 v190, v190, v92
v_accvgpr_write_b32 a73, v190
v_accvgpr_read_b32 v190, a74
v_mul_f32 v190, v190, v92
v_accvgpr_write_b32 a74, v190
v_accvgpr_read_b32 v190, a75
v_mul_f32 v190, v190, v92
v_accvgpr_write_b32 a75, v190
v_accvgpr_read_b32 v190, a88
v_mul_f32 v190, v190, v92
v_accvgpr_write_b32 a88, v190
v_accvgpr_read_b32 v190, a89
v_mul_f32 v190, v190, v92
v_accvgpr_write_b32 a89, v190
v_accvgpr_read_b32 v190, a90
v_mul_f32 v190, v190, v92
v_accvgpr_write_b32 a90, v190
v_accvgpr_read_b32 v190, a91
v_mul_f32 v190, v190, v92
v_accvgpr_write_b32 a91, v190
v_accvgpr_read_b32 v190, a104
v_mul_f32 v190, v190, v92
v_accvgpr_write_b32 a104, v190
v_accvgpr_read_b32 v190, a105
v_mul_f32 v190, v190, v92
v_accvgpr_write_b32 a105, v190
v_accvgpr_read_b32 v190, a106
v_mul_f32 v190, v190, v92
v_accvgpr_write_b32 a106, v190
v_accvgpr_read_b32 v190, a107
v_mul_f32 v190, v190, v92
v_accvgpr_write_b32 a107, v190
v_accvgpr_read_b32 v190, a120
v_mul_f32 v190, v190, v92
v_accvgpr_write_b32 a120, v190
v_accvgpr_read_b32 v190, a121
v_mul_f32 v190, v190, v92
v_accvgpr_write_b32 a121, v190
v_accvgpr_read_b32 v190, a122
v_mul_f32 v190, v190, v92
v_accvgpr_write_b32 a122, v190
v_accvgpr_read_b32 v190, a123
v_mul_f32 v190, v190, v92
v_accvgpr_write_b32 a123, v190
v_accvgpr_read_b32 v190, a136
v_mul_f32 v190, v190, v92
v_accvgpr_write_b32 a136, v190
v_accvgpr_read_b32 v190, a137
v_mul_f32 v190, v190, v92
v_accvgpr_write_b32 a137, v190
v_accvgpr_read_b32 v190, a138
v_mul_f32 v190, v190, v92
v_accvgpr_write_b32 a138, v190
v_accvgpr_read_b32 v190, a139
v_mul_f32 v190, v190, v92
v_accvgpr_write_b32 a139, v190
v_accvgpr_read_b32 v190, a152
v_mul_f32 v190, v190, v92
v_accvgpr_write_b32 a152, v190
v_accvgpr_read_b32 v190, a153
v_mul_f32 v190, v190, v92
v_accvgpr_write_b32 a153, v190
v_accvgpr_read_b32 v190, a154
v_mul_f32 v190, v190, v92
v_accvgpr_write_b32 a154, v190
v_accvgpr_read_b32 v190, a155
v_mul_f32 v190, v190, v92
v_accvgpr_write_b32 a155, v190
v_accvgpr_read_b32 v190, a168
v_mul_f32 v190, v190, v92
v_accvgpr_write_b32 a168, v190
v_accvgpr_read_b32 v190, a169
v_mul_f32 v190, v190, v92
v_accvgpr_write_b32 a169, v190
v_accvgpr_read_b32 v190, a170
v_mul_f32 v190, v190, v92
v_accvgpr_write_b32 a170, v190
v_accvgpr_read_b32 v190, a171
v_mul_f32 v190, v190, v92
v_accvgpr_write_b32 a171, v190
v_accvgpr_read_b32 v190, a184
v_mul_f32 v190, v190, v92
v_accvgpr_write_b32 a184, v190
v_accvgpr_read_b32 v190, a185
v_mul_f32 v190, v190, v92
v_accvgpr_write_b32 a185, v190
v_accvgpr_read_b32 v190, a186
v_mul_f32 v190, v190, v92
v_accvgpr_write_b32 a186, v190
v_accvgpr_read_b32 v190, a187
v_mul_f32 v190, v190, v92
v_accvgpr_write_b32 a187, v190
v_accvgpr_read_b32 v190, a200
v_mul_f32 v190, v190, v92
v_accvgpr_write_b32 a200, v190
v_accvgpr_read_b32 v190, a201
v_mul_f32 v190, v190, v92
v_accvgpr_write_b32 a201, v190
v_accvgpr_read_b32 v190, a202
v_mul_f32 v190, v190, v92
v_accvgpr_write_b32 a202, v190
v_accvgpr_read_b32 v190, a203
v_mul_f32 v190, v190, v92
v_accvgpr_write_b32 a203, v190
v_accvgpr_read_b32 v190, a216
v_mul_f32 v190, v190, v92
v_accvgpr_write_b32 a216, v190
v_accvgpr_read_b32 v190, a217
v_mul_f32 v190, v190, v92
v_accvgpr_write_b32 a217, v190
v_accvgpr_read_b32 v190, a218
v_mul_f32 v190, v190, v92
v_accvgpr_write_b32 a218, v190
v_accvgpr_read_b32 v190, a219
v_mul_f32 v190, v190, v92
v_accvgpr_write_b32 a219, v190
v_accvgpr_read_b32 v190, a232
v_mul_f32 v190, v190, v92
v_accvgpr_write_b32 a232, v190
v_accvgpr_read_b32 v190, a233
v_mul_f32 v190, v190, v92
v_accvgpr_write_b32 a233, v190
v_accvgpr_read_b32 v190, a234
v_mul_f32 v190, v190, v92
v_accvgpr_write_b32 a234, v190
v_accvgpr_read_b32 v190, a235
v_mul_f32 v190, v190, v92
v_accvgpr_write_b32 a235, v190
v_accvgpr_read_b32 v190, a248
v_mul_f32 v190, v190, v92
v_accvgpr_write_b32 a248, v190
v_accvgpr_read_b32 v190, a249
v_mul_f32 v190, v190, v92
v_accvgpr_write_b32 a249, v190
v_accvgpr_read_b32 v190, a250
v_mul_f32 v190, v190, v92
v_accvgpr_write_b32 a250, v190
v_accvgpr_read_b32 v190, a251
v_mul_f32 v190, v190, v92
v_accvgpr_write_b32 a251, v190
v_sub_f32 v112, v112, v87
v_sub_f32 v113, v113, v87
v_sub_f32 v114, v114, v87
v_sub_f32 v115, v115, v87
v_mul_f32 v128, v128, v93
v_accvgpr_read_b32 v190, a12
v_mul_f32 v190, v190, v93
v_accvgpr_write_b32 a12, v190
v_accvgpr_read_b32 v190, a13
v_mul_f32 v190, v190, v93
v_accvgpr_write_b32 a13, v190
v_accvgpr_read_b32 v190, a14
v_mul_f32 v190, v190, v93
v_accvgpr_write_b32 a14, v190
v_accvgpr_read_b32 v190, a15
v_mul_f32 v190, v190, v93
v_accvgpr_write_b32 a15, v190
v_accvgpr_read_b32 v190, a28
v_mul_f32 v190, v190, v93
v_accvgpr_write_b32 a28, v190
v_accvgpr_read_b32 v190, a29
v_mul_f32 v190, v190, v93
v_accvgpr_write_b32 a29, v190
v_accvgpr_read_b32 v190, a30
v_mul_f32 v190, v190, v93
v_accvgpr_write_b32 a30, v190
v_accvgpr_read_b32 v190, a31
v_mul_f32 v190, v190, v93
v_accvgpr_write_b32 a31, v190
v_accvgpr_read_b32 v190, a44
v_mul_f32 v190, v190, v93
v_accvgpr_write_b32 a44, v190
v_accvgpr_read_b32 v190, a45
v_mul_f32 v190, v190, v93
v_accvgpr_write_b32 a45, v190
v_accvgpr_read_b32 v190, a46
v_mul_f32 v190, v190, v93
v_accvgpr_write_b32 a46, v190
v_accvgpr_read_b32 v190, a47
v_mul_f32 v190, v190, v93
v_accvgpr_write_b32 a47, v190
v_accvgpr_read_b32 v190, a60
v_mul_f32 v190, v190, v93
v_accvgpr_write_b32 a60, v190
v_accvgpr_read_b32 v190, a61
v_mul_f32 v190, v190, v93
v_accvgpr_write_b32 a61, v190
v_accvgpr_read_b32 v190, a62
v_mul_f32 v190, v190, v93
v_accvgpr_write_b32 a62, v190
v_accvgpr_read_b32 v190, a63
v_mul_f32 v190, v190, v93
v_accvgpr_write_b32 a63, v190
v_accvgpr_read_b32 v190, a76
v_mul_f32 v190, v190, v93
v_accvgpr_write_b32 a76, v190
v_accvgpr_read_b32 v190, a77
v_mul_f32 v190, v190, v93
v_accvgpr_write_b32 a77, v190
v_accvgpr_read_b32 v190, a78
v_mul_f32 v190, v190, v93
v_accvgpr_write_b32 a78, v190
v_accvgpr_read_b32 v190, a79
v_mul_f32 v190, v190, v93
v_accvgpr_write_b32 a79, v190
v_accvgpr_read_b32 v190, a92
v_mul_f32 v190, v190, v93
v_accvgpr_write_b32 a92, v190
v_accvgpr_read_b32 v190, a93
v_mul_f32 v190, v190, v93
v_accvgpr_write_b32 a93, v190
v_accvgpr_read_b32 v190, a94
v_mul_f32 v190, v190, v93
v_accvgpr_write_b32 a94, v190
v_accvgpr_read_b32 v190, a95
v_mul_f32 v190, v190, v93
v_accvgpr_write_b32 a95, v190
v_accvgpr_read_b32 v190, a108
v_mul_f32 v190, v190, v93
v_accvgpr_write_b32 a108, v190
v_accvgpr_read_b32 v190, a109
v_mul_f32 v190, v190, v93
v_accvgpr_write_b32 a109, v190
v_accvgpr_read_b32 v190, a110
v_mul_f32 v190, v190, v93
v_accvgpr_write_b32 a110, v190
v_accvgpr_read_b32 v190, a111
v_mul_f32 v190, v190, v93
v_accvgpr_write_b32 a111, v190
v_accvgpr_read_b32 v190, a124
v_mul_f32 v190, v190, v93
v_accvgpr_write_b32 a124, v190
v_accvgpr_read_b32 v190, a125
v_mul_f32 v190, v190, v93
v_accvgpr_write_b32 a125, v190
v_accvgpr_read_b32 v190, a126
v_mul_f32 v190, v190, v93
v_accvgpr_write_b32 a126, v190
v_accvgpr_read_b32 v190, a127
v_mul_f32 v190, v190, v93
v_accvgpr_write_b32 a127, v190
v_accvgpr_read_b32 v190, a140
v_mul_f32 v190, v190, v93
v_accvgpr_write_b32 a140, v190
v_accvgpr_read_b32 v190, a141
v_mul_f32 v190, v190, v93
v_accvgpr_write_b32 a141, v190
v_accvgpr_read_b32 v190, a142
v_mul_f32 v190, v190, v93
v_accvgpr_write_b32 a142, v190
v_accvgpr_read_b32 v190, a143
v_mul_f32 v190, v190, v93
v_accvgpr_write_b32 a143, v190
v_accvgpr_read_b32 v190, a156
v_mul_f32 v190, v190, v93
v_accvgpr_write_b32 a156, v190
v_accvgpr_read_b32 v190, a157
v_mul_f32 v190, v190, v93
v_accvgpr_write_b32 a157, v190
v_accvgpr_read_b32 v190, a158
v_mul_f32 v190, v190, v93
v_accvgpr_write_b32 a158, v190
v_accvgpr_read_b32 v190, a159
v_mul_f32 v190, v190, v93
v_accvgpr_write_b32 a159, v190
v_accvgpr_read_b32 v190, a172
v_mul_f32 v190, v190, v93
v_accvgpr_write_b32 a172, v190
v_accvgpr_read_b32 v190, a173
v_mul_f32 v190, v190, v93
v_accvgpr_write_b32 a173, v190
v_accvgpr_read_b32 v190, a174
v_mul_f32 v190, v190, v93
v_accvgpr_write_b32 a174, v190
v_accvgpr_read_b32 v190, a175
v_mul_f32 v190, v190, v93
v_accvgpr_write_b32 a175, v190
v_accvgpr_read_b32 v190, a188
v_mul_f32 v190, v190, v93
v_accvgpr_write_b32 a188, v190
v_accvgpr_read_b32 v190, a189
v_mul_f32 v190, v190, v93
v_accvgpr_write_b32 a189, v190
v_accvgpr_read_b32 v190, a190
v_mul_f32 v190, v190, v93
v_accvgpr_write_b32 a190, v190
v_accvgpr_read_b32 v190, a191
v_mul_f32 v190, v190, v93
v_accvgpr_write_b32 a191, v190
v_accvgpr_read_b32 v190, a204
v_mul_f32 v190, v190, v93
v_accvgpr_write_b32 a204, v190
v_accvgpr_read_b32 v190, a205
v_mul_f32 v190, v190, v93
v_accvgpr_write_b32 a205, v190
v_accvgpr_read_b32 v190, a206
v_mul_f32 v190, v190, v93
v_accvgpr_write_b32 a206, v190
v_accvgpr_read_b32 v190, a207
v_mul_f32 v190, v190, v93
v_accvgpr_write_b32 a207, v190
v_accvgpr_read_b32 v190, a220
v_mul_f32 v190, v190, v93
v_accvgpr_write_b32 a220, v190
v_accvgpr_read_b32 v190, a221
v_mul_f32 v190, v190, v93
v_accvgpr_write_b32 a221, v190
v_accvgpr_read_b32 v190, a222
v_mul_f32 v190, v190, v93
v_accvgpr_write_b32 a222, v190
v_accvgpr_read_b32 v190, a223
v_mul_f32 v190, v190, v93
v_accvgpr_write_b32 a223, v190
v_accvgpr_read_b32 v190, a236
v_mul_f32 v190, v190, v93
v_accvgpr_write_b32 a236, v190
v_accvgpr_read_b32 v190, a237
v_mul_f32 v190, v190, v93
v_accvgpr_write_b32 a237, v190
v_accvgpr_read_b32 v190, a238
v_mul_f32 v190, v190, v93
v_accvgpr_write_b32 a238, v190
v_accvgpr_read_b32 v190, a239
v_mul_f32 v190, v190, v93
v_accvgpr_write_b32 a239, v190
v_accvgpr_read_b32 v190, a252
v_mul_f32 v190, v190, v93
v_accvgpr_write_b32 a252, v190
v_accvgpr_read_b32 v190, a253
v_mul_f32 v190, v190, v93
v_accvgpr_write_b32 a253, v190
v_accvgpr_read_b32 v190, a254
v_mul_f32 v190, v190, v93
v_accvgpr_write_b32 a254, v190
v_accvgpr_read_b32 v190, a255
v_mul_f32 v190, v190, v93
v_accvgpr_write_b32 a255, v190
v_sub_f32 v116, v116, v88
v_sub_f32 v117, v117, v88
v_sub_f32 v118, v118, v88
v_sub_f32 v119, v119, v88
v_mul_f32 v129, v129, v94
v_mul_f32 v192, v192, v94
v_mul_f32 v193, v193, v94
v_mul_f32 v194, v194, v94
v_mul_f32 v195, v195, v94
v_mul_f32 v196, v196, v94
v_mul_f32 v197, v197, v94
v_mul_f32 v198, v198, v94
v_mul_f32 v199, v199, v94
v_mul_f32 v200, v200, v94
v_mul_f32 v201, v201, v94
v_mul_f32 v202, v202, v94
v_mul_f32 v203, v203, v94
v_mul_f32 v204, v204, v94
v_mul_f32 v205, v205, v94
v_mul_f32 v206, v206, v94
v_mul_f32 v207, v207, v94
v_mul_f32 v208, v208, v94
v_mul_f32 v209, v209, v94
v_mul_f32 v210, v210, v94
v_mul_f32 v211, v211, v94
v_mul_f32 v212, v212, v94
v_mul_f32 v213, v213, v94
v_mul_f32 v214, v214, v94
v_mul_f32 v215, v215, v94
v_mul_f32 v216, v216, v94
v_mul_f32 v217, v217, v94
v_mul_f32 v218, v218, v94
v_mul_f32 v219, v219, v94
v_mul_f32 v220, v220, v94
v_mul_f32 v221, v221, v94
v_mul_f32 v222, v222, v94
v_mul_f32 v223, v223, v94
v_mul_f32 v224, v224, v94
v_mul_f32 v225, v225, v94
v_mul_f32 v226, v226, v94
v_mul_f32 v227, v227, v94
v_mul_f32 v228, v228, v94
v_mul_f32 v229, v229, v94
v_mul_f32 v230, v230, v94
v_mul_f32 v231, v231, v94
v_mul_f32 v232, v232, v94
v_mul_f32 v233, v233, v94
v_mul_f32 v234, v234, v94
v_mul_f32 v235, v235, v94
v_mul_f32 v236, v236, v94
v_mul_f32 v237, v237, v94
v_mul_f32 v238, v238, v94
v_mul_f32 v239, v239, v94
v_mul_f32 v240, v240, v94
v_mul_f32 v241, v241, v94
v_mul_f32 v242, v242, v94
v_mul_f32 v243, v243, v94
v_mul_f32 v244, v244, v94
v_mul_f32 v245, v245, v94
v_mul_f32 v246, v246, v94
v_mul_f32 v247, v247, v94
v_mul_f32 v248, v248, v94
v_mul_f32 v249, v249, v94
v_mul_f32 v250, v250, v94
v_mul_f32 v251, v251, v94
v_mul_f32 v252, v252, v94
v_mul_f32 v253, v253, v94
v_mul_f32 v254, v254, v94
v_mul_f32 v255, v255, v94
v_sub_f32 v40, v40, v84
v_sub_f32 v41, v41, v84
v_sub_f32 v42, v42, v84
v_sub_f32 v43, v43, v84
v_sub_f32 v44, v44, v84
v_sub_f32 v45, v45, v84
v_sub_f32 v46, v46, v84
v_sub_f32 v47, v47, v84
v_sub_f32 v48, v48, v85
v_sub_f32 v49, v49, v85
v_sub_f32 v50, v50, v85
v_sub_f32 v51, v51, v85
v_sub_f32 v52, v52, v85
v_sub_f32 v53, v53, v85
v_sub_f32 v54, v54, v85
v_sub_f32 v55, v55, v85
v_sub_f32 v56, v56, v86
v_sub_f32 v57, v57, v86
v_sub_f32 v58, v58, v86
v_sub_f32 v59, v59, v86
v_sub_f32 v60, v60, v86
v_sub_f32 v61, v61, v86
v_sub_f32 v62, v62, v86
v_sub_f32 v63, v63, v86
v_sub_f32 v64, v64, v87
v_sub_f32 v65, v65, v87
v_sub_f32 v66, v66, v87
v_sub_f32 v67, v67, v87
v_sub_f32 v68, v68, v87
v_sub_f32 v69, v69, v87
v_sub_f32 v70, v70, v87
v_sub_f32 v71, v71, v87
v_sub_f32 v72, v72, v88
v_sub_f32 v73, v73, v88
v_sub_f32 v74, v74, v88
v_sub_f32 v75, v75, v88
v_sub_f32 v76, v76, v88
v_sub_f32 v77, v77, v88
v_sub_f32 v78, v78, v88
v_sub_f32 v79, v79, v88
v_exp_f32 v40, v40
v_exp_f32 v41, v41
v_exp_f32 v42, v42
v_exp_f32 v43, v43
v_exp_f32 v44, v44
v_exp_f32 v45, v45
v_exp_f32 v46, v46
v_exp_f32 v47, v47
v_exp_f32 v48, v48
v_exp_f32 v49, v49
v_exp_f32 v50, v50
v_exp_f32 v51, v51
v_exp_f32 v52, v52
v_exp_f32 v53, v53
v_exp_f32 v54, v54
v_exp_f32 v55, v55
v_exp_f32 v56, v56
v_exp_f32 v57, v57
v_exp_f32 v58, v58
v_exp_f32 v59, v59
v_exp_f32 v60, v60
v_exp_f32 v61, v61
v_exp_f32 v62, v62
v_exp_f32 v63, v63
v_exp_f32 v64, v64
v_exp_f32 v65, v65
v_exp_f32 v66, v66
v_exp_f32 v67, v67
v_exp_f32 v68, v68
v_exp_f32 v69, v69
v_exp_f32 v70, v70
v_exp_f32 v71, v71
v_exp_f32 v72, v72
v_exp_f32 v73, v73
v_exp_f32 v74, v74
v_exp_f32 v75, v75
v_exp_f32 v76, v76
v_exp_f32 v77, v77
v_exp_f32 v78, v78
v_exp_f32 v79, v79
s_nop 0
v_add_f32 v120, v125, v40
v_add_f32 v120, v120, v41
v_add_f32 v120, v120, v42
v_add_f32 v120, v120, v43
v_add_f32 v120, v120, v44
v_add_f32 v120, v120, v45
v_add_f32 v120, v120, v46
v_add_f32 v120, v120, v47
v_add_f32 v121, v126, v48
v_add_f32 v121, v121, v49
v_add_f32 v121, v121, v50
v_add_f32 v121, v121, v51
v_add_f32 v121, v121, v52
v_add_f32 v121, v121, v53
v_add_f32 v121, v121, v54
v_add_f32 v121, v121, v55
v_add_f32 v122, v127, v56
v_add_f32 v122, v122, v57
v_add_f32 v122, v122, v58
v_add_f32 v122, v122, v59
v_add_f32 v122, v122, v60
v_add_f32 v122, v122, v61
v_add_f32 v122, v122, v62
v_add_f32 v122, v122, v63
v_add_f32 v123, v128, v64
v_add_f32 v123, v123, v65
v_add_f32 v123, v123, v66
v_add_f32 v123, v123, v67
v_add_f32 v123, v123, v68
v_add_f32 v123, v123, v69
v_add_f32 v123, v123, v70
v_add_f32 v123, v123, v71
v_add_f32 v124, v129, v72
v_add_f32 v124, v124, v73
v_add_f32 v124, v124, v74
v_add_f32 v124, v124, v75
v_add_f32 v124, v124, v76
v_add_f32 v124, v124, v77
v_add_f32 v124, v124, v78
v_add_f32 v124, v124, v79
v_cvt_pk_bf16_f32 v80, v40, v41
v_cvt_pk_bf16_f32 v81, v42, v43
v_cvt_pk_bf16_f32 v82, v44, v45
v_cvt_pk_bf16_f32 v83, v46, v47
s_nop 1
s_branch L_sp0_r5_ret
L_sp2_r5:
s_waitcnt lgkmcnt(0)
s_nop 7
s_nop 7
v_mbcnt_lo_u32_b32 v191, -1, 0
v_mbcnt_hi_u32_b32 v191, -1, v191
v_and_b32 v190, 15, v191
v_lshlrev_b32 v190, 9, v190
v_lshrrev_b32 v191, 4, v191
v_lshlrev_b32 v191, 4, v191
v_add_u32 v190, v190, v191
v_add_u32 v190, s34, v190
global_load_dwordx4 v[24:27], v190, s[36:37] offset:0
v_add_u32 v191, 8192, v190
global_load_dwordx4 v[28:31], v191, s[36:37] offset:0
s_waitcnt vmcnt(0)
v_mfma_f32_16x16x32_bf16 v[40:43], v[24:27], v[130:133], v[100:103]
v_mfma_f32_16x16x32_bf16 v[44:47], v[28:31], v[130:133], v[100:103]
v_mfma_f32_16x16x32_bf16 v[48:51], v[24:27], v[134:137], v[104:107]
v_mfma_f32_16x16x32_bf16 v[52:55], v[28:31], v[134:137], v[104:107]
v_mfma_f32_16x16x32_bf16 v[56:59], v[24:27], v[138:141], v[108:111]
v_mfma_f32_16x16x32_bf16 v[60:63], v[28:31], v[138:141], v[108:111]
v_mfma_f32_16x16x32_bf16 v[64:67], v[24:27], v[142:145], v[112:115]
v_mfma_f32_16x16x32_bf16 v[68:71], v[28:31], v[142:145], v[112:115]
v_mfma_f32_16x16x32_bf16 v[72:75], v[24:27], v[146:149], v[116:119]
v_mfma_f32_16x16x32_bf16 v[76:79], v[28:31], v[146:149], v[116:119]
s_nop 7
global_load_dwordx4 v[24:27], v190, s[36:37] offset:64
v_add_u32 v191, 8192, v190
global_load_dwordx4 v[28:31], v191, s[36:37] offset:64
s_waitcnt vmcnt(0)
v_mfma_f32_16x16x32_bf16 v[40:43], v[24:27], v[150:153], v[40:43]
v_mfma_f32_16x16x32_bf16 v[44:47], v[28:31], v[150:153], v[44:47]
v_mfma_f32_16x16x32_bf16 v[48:51], v[24:27], v[154:157], v[48:51]
v_mfma_f32_16x16x32_bf16 v[52:55], v[28:31], v[154:157], v[52:55]
v_mfma_f32_16x16x32_bf16 v[56:59], v[24:27], v[158:161], v[56:59]
v_mfma_f32_16x16x32_bf16 v[60:63], v[28:31], v[158:161], v[60:63]
v_mfma_f32_16x16x32_bf16 v[64:67], v[24:27], v[162:165], v[64:67]
v_mfma_f32_16x16x32_bf16 v[68:71], v[28:31], v[162:165], v[68:71]
v_mfma_f32_16x16x32_bf16 v[72:75], v[24:27], v[166:169], v[72:75]
v_mfma_f32_16x16x32_bf16 v[76:79], v[28:31], v[166:169], v[76:79]
s_nop 7
global_load_dwordx4 v[24:27], v190, s[36:37] offset:128
v_add_u32 v191, 8192, v190
global_load_dwordx4 v[28:31], v191, s[36:37] offset:128
s_waitcnt vmcnt(0)
ds_read_b128 v[32:35], v6 offset:0
s_waitcnt lgkmcnt(0)
v_mfma_f32_16x16x32_bf16 v[40:43], v[24:27], v[32:35], v[40:43]
v_mfma_f32_16x16x32_bf16 v[44:47], v[28:31], v[32:35], v[44:47]
s_nop 7
ds_read_b128 v[32:35], v6 offset:1024
s_waitcnt lgkmcnt(0)
v_mfma_f32_16x16x32_bf16 v[48:51], v[24:27], v[32:35], v[48:51]
v_mfma_f32_16x16x32_bf16 v[52:55], v[28:31], v[32:35], v[52:55]
s_nop 7
ds_read_b128 v[32:35], v6 offset:2048
s_waitcnt lgkmcnt(0)
v_mfma_f32_16x16x32_bf16 v[56:59], v[24:27], v[32:35], v[56:59]
v_mfma_f32_16x16x32_bf16 v[60:63], v[28:31], v[32:35], v[60:63]
s_nop 7
ds_read_b128 v[32:35], v6 offset:3072
s_waitcnt lgkmcnt(0)
v_mfma_f32_16x16x32_bf16 v[64:67], v[24:27], v[32:35], v[64:67]
v_mfma_f32_16x16x32_bf16 v[68:71], v[28:31], v[32:35], v[68:71]
s_nop 7
ds_read_b128 v[32:35], v6 offset:4096
s_waitcnt lgkmcnt(0)
v_mfma_f32_16x16x32_bf16 v[72:75], v[24:27], v[32:35], v[72:75]
v_mfma_f32_16x16x32_bf16 v[76:79], v[28:31], v[32:35], v[76:79]
s_nop 7
s_nop 7
global_load_dwordx4 v[24:27], v190, s[36:37] offset:192
v_add_u32 v191, 8192, v190
global_load_dwordx4 v[28:31], v191, s[36:37] offset:192
s_waitcnt vmcnt(0)
ds_read_b128 v[32:35], v6 offset:5120
s_waitcnt lgkmcnt(0)
v_mfma_f32_16x16x32_bf16 v[40:43], v[24:27], v[32:35], v[40:43]
v_mfma_f32_16x16x32_bf16 v[44:47], v[28:31], v[32:35], v[44:47]
s_nop 7
ds_read_b128 v[32:35], v6 offset:6144
s_waitcnt lgkmcnt(0)
v_mfma_f32_16x16x32_bf16 v[48:51], v[24:27], v[32:35], v[48:51]
v_mfma_f32_16x16x32_bf16 v[52:55], v[28:31], v[32:35], v[52:55]
s_nop 7
ds_read_b128 v[32:35], v6 offset:7168
s_waitcnt lgkmcnt(0)
v_mfma_f32_16x16x32_bf16 v[56:59], v[24:27], v[32:35], v[56:59]
v_mfma_f32_16x16x32_bf16 v[60:63], v[28:31], v[32:35], v[60:63]
s_nop 7
ds_read_b128 v[32:35], v6 offset:8192
s_waitcnt lgkmcnt(0)
v_mfma_f32_16x16x32_bf16 v[64:67], v[24:27], v[32:35], v[64:67]
v_mfma_f32_16x16x32_bf16 v[68:71], v[28:31], v[32:35], v[68:71]
s_nop 7
ds_read_b128 v[32:35], v6 offset:9216
s_waitcnt lgkmcnt(0)
v_mfma_f32_16x16x32_bf16 v[72:75], v[24:27], v[32:35], v[72:75]
v_mfma_f32_16x16x32_bf16 v[76:79], v[28:31], v[32:35], v[76:79]
s_nop 7
s_nop 7
global_load_dwordx4 v[24:27], v190, s[36:37] offset:256
v_add_u32 v191, 8192, v190
global_load_dwordx4 v[28:31], v191, s[36:37] offset:256
s_waitcnt vmcnt(0)
ds_read_b128 v[32:35], v6 offset:10240
s_waitcnt lgkmcnt(0)
v_mfma_f32_16x16x32_bf16 v[40:43], v[24:27], v[32:35], v[40:43]
v_mfma_f32_16x16x32_bf16 v[44:47], v[28:31], v[32:35], v[44:47]
s_nop 7
ds_read_b128 v[32:35], v6 offset:11264
s_waitcnt lgkmcnt(0)
v_mfma_f32_16x16x32_bf16 v[48:51], v[24:27], v[32:35], v[48:51]
v_mfma_f32_16x16x32_bf16 v[52:55], v[28:31], v[32:35], v[52:55]
s_nop 7
ds_read_b128 v[32:35], v6 offset:12288
s_waitcnt lgkmcnt(0)
v_mfma_f32_16x16x32_bf16 v[56:59], v[24:27], v[32:35], v[56:59]
v_mfma_f32_16x16x32_bf16 v[60:63], v[28:31], v[32:35], v[60:63]
s_nop 7
ds_read_b128 v[32:35], v6 offset:13312
s_waitcnt lgkmcnt(0)
v_mfma_f32_16x16x32_bf16 v[64:67], v[24:27], v[32:35], v[64:67]
v_mfma_f32_16x16x32_bf16 v[68:71], v[28:31], v[32:35], v[68:71]
s_nop 7
ds_read_b128 v[32:35], v6 offset:14336
s_waitcnt lgkmcnt(0)
v_mfma_f32_16x16x32_bf16 v[72:75], v[24:27], v[32:35], v[72:75]
v_mfma_f32_16x16x32_bf16 v[76:79], v[28:31], v[32:35], v[76:79]
s_nop 7
s_nop 7
global_load_dwordx4 v[24:27], v190, s[36:37] offset:320
v_add_u32 v191, 8192, v190
global_load_dwordx4 v[28:31], v191, s[36:37] offset:320
s_waitcnt vmcnt(0)
ds_read_b128 v[32:35], v6 offset:15360
s_waitcnt lgkmcnt(0)
v_mfma_f32_16x16x32_bf16 v[40:43], v[24:27], v[32:35], v[40:43]
v_mfma_f32_16x16x32_bf16 v[44:47], v[28:31], v[32:35], v[44:47]
s_nop 7
ds_read_b128 v[32:35], v6 offset:16384
s_waitcnt lgkmcnt(0)
v_mfma_f32_16x16x32_bf16 v[48:51], v[24:27], v[32:35], v[48:51]
v_mfma_f32_16x16x32_bf16 v[52:55], v[28:31], v[32:35], v[52:55]
s_nop 7
ds_read_b128 v[32:35], v6 offset:17408
s_waitcnt lgkmcnt(0)
v_mfma_f32_16x16x32_bf16 v[56:59], v[24:27], v[32:35], v[56:59]
v_mfma_f32_16x16x32_bf16 v[60:63], v[28:31], v[32:35], v[60:63]
s_nop 7
ds_read_b128 v[32:35], v6 offset:18432
s_waitcnt lgkmcnt(0)
v_mfma_f32_16x16x32_bf16 v[64:67], v[24:27], v[32:35], v[64:67]
v_mfma_f32_16x16x32_bf16 v[68:71], v[28:31], v[32:35], v[68:71]
s_nop 7
ds_read_b128 v[32:35], v6 offset:19456
s_waitcnt lgkmcnt(0)
v_mfma_f32_16x16x32_bf16 v[72:75], v[24:27], v[32:35], v[72:75]
v_mfma_f32_16x16x32_bf16 v[76:79], v[28:31], v[32:35], v[76:79]
s_nop 7
s_nop 7
global_load_dwordx4 v[24:27], v190, s[36:37] offset:384
v_add_u32 v191, 8192, v190
global_load_dwordx4 v[28:31], v191, s[36:37] offset:384
s_waitcnt vmcnt(0)
ds_read_b128 v[32:35], v6 offset:20480
s_waitcnt lgkmcnt(0)
v_mfma_f32_16x16x32_bf16 v[40:43], v[24:27], v[32:35], v[40:43]
v_mfma_f32_16x16x32_bf16 v[44:47], v[28:31], v[32:35], v[44:47]
s_nop 7
ds_read_b128 v[32:35], v6 offset:21504
s_waitcnt lgkmcnt(0)
v_mfma_f32_16x16x32_bf16 v[48:51], v[24:27], v[32:35], v[48:51]
v_mfma_f32_16x16x32_bf16 v[52:55], v[28:31], v[32:35], v[52:55]
s_nop 7
ds_read_b128 v[32:35], v6 offset:22528
s_waitcnt lgkmcnt(0)
v_mfma_f32_16x16x32_bf16 v[56:59], v[24:27], v[32:35], v[56:59]
v_mfma_f32_16x16x32_bf16 v[60:63], v[28:31], v[32:35], v[60:63]
s_nop 7
ds_read_b128 v[32:35], v6 offset:23552
s_waitcnt lgkmcnt(0)
v_mfma_f32_16x16x32_bf16 v[64:67], v[24:27], v[32:35], v[64:67]
v_mfma_f32_16x16x32_bf16 v[68:71], v[28:31], v[32:35], v[68:71]
s_nop 7
ds_read_b128 v[32:35], v6 offset:24576
s_waitcnt lgkmcnt(0)
v_mfma_f32_16x16x32_bf16 v[72:75], v[24:27], v[32:35], v[72:75]
v_mfma_f32_16x16x32_bf16 v[76:79], v[28:31], v[32:35], v[76:79]
s_nop 7
s_nop 7
global_load_dwordx4 v[24:27], v190, s[36:37] offset:448
v_add_u32 v191, 8192, v190
global_load_dwordx4 v[28:31], v191, s[36:37] offset:448
s_waitcnt vmcnt(0)
v_mfma_f32_16x16x32_bf16 v[40:43], v[24:27], v[170:173], v[40:43]
v_mfma_f32_16x16x32_bf16 v[44:47], v[28:31], v[170:173], v[44:47]
v_mfma_f32_16x16x32_bf16 v[48:51], v[24:27], v[174:177], v[48:51]
v_mfma_f32_16x16x32_bf16 v[52:55], v[28:31], v[174:177], v[52:55]
v_mfma_f32_16x16x32_bf16 v[56:59], v[24:27], v[178:181], v[56:59]
v_mfma_f32_16x16x32_bf16 v[60:63], v[28:31], v[178:181], v[60:63]
v_mfma_f32_16x16x32_bf16 v[64:67], v[24:27], v[182:185], v[64:67]
v_mfma_f32_16x16x32_bf16 v[68:71], v[28:31], v[182:185], v[68:71]
v_mfma_f32_16x16x32_bf16 v[72:75], v[24:27], v[186:189], v[72:75]
v_mfma_f32_16x16x32_bf16 v[76:79], v[28:31], v[186:189], v[76:79]
s_nop 7
s_nop 7
v_max3_f32 v84, v40, v41, v42
v_max3_f32 v84, v84, v43, v44
v_max3_f32 v84, v84, v45, v46
v_max_f32 v84, v84, v47
v_max3_f32 v85, v48, v49, v50
v_max3_f32 v85, v85, v51, v52
v_max3_f32 v85, v85, v53, v54
v_max_f32 v85, v85, v55
v_max3_f32 v86, v56, v57, v58
v_max3_f32 v86, v86, v59, v60
v_max3_f32 v86, v86, v61, v62
v_max_f32 v86, v86, v63
v_max3_f32 v87, v64, v65, v66
v_max3_f32 v87, v87, v67, v68
v_max3_f32 v87, v87, v69, v70
v_max_f32 v87, v87, v71
v_max3_f32 v88, v72, v73, v74
v_max3_f32 v88, v88, v75, v76
v_max3_f32 v88, v88, v77, v78
v_max_f32 v88, v88, v79
v_mbcnt_lo_u32_b32 v190, -1, 0
v_mbcnt_hi_u32_b32 v190, -1, v190
v_xor_b32 v191, 32, v190
v_xor_b32 v190, 16, v190
v_lshlrev_b32 v191, 2, v191
v_lshlrev_b32 v190, 2, v190
ds_bpermute_b32 v90, v190, v84
ds_bpermute_b32 v91, v190, v85
ds_bpermute_b32 v92, v190, v86
ds_bpermute_b32 v93, v190, v87
ds_bpermute_b32 v94, v190, v88
s_waitcnt lgkmcnt(0)
v_max_f32 v84, v84, v90
v_max_f32 v85, v85, v91
v_max_f32 v86, v86, v92
v_max_f32 v87, v87, v93
v_max_f32 v88, v88, v94
ds_bpermute_b32 v90, v191, v84
ds_bpermute_b32 v91, v191, v85
ds_bpermute_b32 v92, v191, v86
ds_bpermute_b32 v93, v191, v87
ds_bpermute_b32 v94, v191, v88
s_waitcnt lgkmcnt(0)
v_max_f32 v84, v84, v90
v_max_f32 v85, v85, v91
v_max_f32 v86, v86, v92
v_max_f32 v87, v87, v93
v_max_f32 v88, v88, v94
v_max_f32 v84, 0, v84
v_max_f32 v85, 0, v85
v_max_f32 v86, 0, v86
v_max_f32 v87, 0, v87
v_max_f32 v88, 0, v88
v_sub_f32 v90, 0, v84
v_sub_f32 v91, 0, v85
v_sub_f32 v92, 0, v86
v_sub_f32 v93, 0, v87
v_sub_f32 v94, 0, v88
v_exp_f32 v90, v90
v_exp_f32 v91, v91
v_exp_f32 v92, v92
v_exp_f32 v93, v93
v_exp_f32 v94, v94
s_nop 0
v_sub_f32 v100, v100, v84
v_sub_f32 v101, v101, v84
v_sub_f32 v102, v102, v84
v_sub_f32 v103, v103, v84
v_mul_f32 v120, v120, v90
v_accvgpr_read_b32 v190, a0
v_mul_f32 v190, v190, v90
v_accvgpr_write_b32 a0, v190
v_accvgpr_read_b32 v190, a1
v_mul_f32 v190, v190, v90
v_accvgpr_write_b32 a1, v190
v_accvgpr_read_b32 v190, a2
v_mul_f32 v190, v190, v90
v_accvgpr_write_b32 a2, v190
v_accvgpr_read_b32 v190, a3
v_mul_f32 v190, v190, v90
v_accvgpr_write_b32 a3, v190
v_accvgpr_read_b32 v190, a16
v_mul_f32 v190, v190, v90
v_accvgpr_write_b32 a16, v190
v_accvgpr_read_b32 v190, a17
v_mul_f32 v190, v190, v90
v_accvgpr_write_b32 a17, v190
v_accvgpr_read_b32 v190, a18
v_mul_f32 v190, v190, v90
v_accvgpr_write_b32 a18, v190
v_accvgpr_read_b32 v190, a19
v_mul_f32 v190, v190, v90
v_accvgpr_write_b32 a19, v190
v_accvgpr_read_b32 v190, a32
v_mul_f32 v190, v190, v90
v_accvgpr_write_b32 a32, v190
v_accvgpr_read_b32 v190, a33
v_mul_f32 v190, v190, v90
v_accvgpr_write_b32 a33, v190
v_accvgpr_read_b32 v190, a34
v_mul_f32 v190, v190, v90
v_accvgpr_write_b32 a34, v190
v_accvgpr_read_b32 v190, a35
v_mul_f32 v190, v190, v90
v_accvgpr_write_b32 a35, v190
v_accvgpr_read_b32 v190, a48
v_mul_f32 v190, v190, v90
v_accvgpr_write_b32 a48, v190
v_accvgpr_read_b32 v190, a49
v_mul_f32 v190, v190, v90
v_accvgpr_write_b32 a49, v190
v_accvgpr_read_b32 v190, a50
v_mul_f32 v190, v190, v90
v_accvgpr_write_b32 a50, v190
v_accvgpr_read_b32 v190, a51
v_mul_f32 v190, v190, v90
v_accvgpr_write_b32 a51, v190
v_accvgpr_read_b32 v190, a64
v_mul_f32 v190, v190, v90
v_accvgpr_write_b32 a64, v190
v_accvgpr_read_b32 v190, a65
v_mul_f32 v190, v190, v90
v_accvgpr_write_b32 a65, v190
v_accvgpr_read_b32 v190, a66
v_mul_f32 v190, v190, v90
v_accvgpr_write_b32 a66, v190
v_accvgpr_read_b32 v190, a67
v_mul_f32 v190, v190, v90
v_accvgpr_write_b32 a67, v190
v_accvgpr_read_b32 v190, a80
v_mul_f32 v190, v190, v90
v_accvgpr_write_b32 a80, v190
v_accvgpr_read_b32 v190, a81
v_mul_f32 v190, v190, v90
v_accvgpr_write_b32 a81, v190
v_accvgpr_read_b32 v190, a82
v_mul_f32 v190, v190, v90
v_accvgpr_write_b32 a82, v190
v_accvgpr_read_b32 v190, a83
v_mul_f32 v190, v190, v90
v_accvgpr_write_b32 a83, v190
v_accvgpr_read_b32 v190, a96
v_mul_f32 v190, v190, v90
v_accvgpr_write_b32 a96, v190
v_accvgpr_read_b32 v190, a97
v_mul_f32 v190, v190, v90
v_accvgpr_write_b32 a97, v190
v_accvgpr_read_b32 v190, a98
v_mul_f32 v190, v190, v90
v_accvgpr_write_b32 a98, v190
v_accvgpr_read_b32 v190, a99
v_mul_f32 v190, v190, v90
v_accvgpr_write_b32 a99, v190
v_accvgpr_read_b32 v190, a112
v_mul_f32 v190, v190, v90
v_accvgpr_write_b32 a112, v190
v_accvgpr_read_b32 v190, a113
v_mul_f32 v190, v190, v90
v_accvgpr_write_b32 a113, v190
v_accvgpr_read_b32 v190, a114
v_mul_f32 v190, v190, v90
v_accvgpr_write_b32 a114, v190
v_accvgpr_read_b32 v190, a115
v_mul_f32 v190, v190, v90
v_accvgpr_write_b32 a115, v190
v_accvgpr_read_b32 v190, a128
v_mul_f32 v190, v190, v90
v_accvgpr_write_b32 a128, v190
v_accvgpr_read_b32 v190, a129
v_mul_f32 v190, v190, v90
v_accvgpr_write_b32 a129, v190
v_accvgpr_read_b32 v190, a130
v_mul_f32 v190, v190, v90
v_accvgpr_write_b32 a130, v190
v_accvgpr_read_b32 v190, a131
v_mul_f32 v190, v190, v90
v_accvgpr_write_b32 a131, v190
v_accvgpr_read_b32 v190, a144
v_mul_f32 v190, v190, v90
v_accvgpr_write_b32 a144, v190
v_accvgpr_read_b32 v190, a145
v_mul_f32 v190, v190, v90
v_accvgpr_write_b32 a145, v190
v_accvgpr_read_b32 v190, a146
v_mul_f32 v190, v190, v90
v_accvgpr_write_b32 a146, v190
v_accvgpr_read_b32 v190, a147
v_mul_f32 v190, v190, v90
v_accvgpr_write_b32 a147, v190
v_accvgpr_read_b32 v190, a160
v_mul_f32 v190, v190, v90
v_accvgpr_write_b32 a160, v190
v_accvgpr_read_b32 v190, a161
v_mul_f32 v190, v190, v90
v_accvgpr_write_b32 a161, v190
v_accvgpr_read_b32 v190, a162
v_mul_f32 v190, v190, v90
v_accvgpr_write_b32 a162, v190
v_accvgpr_read_b32 v190, a163
v_mul_f32 v190, v190, v90
v_accvgpr_write_b32 a163, v190
v_accvgpr_read_b32 v190, a176
v_mul_f32 v190, v190, v90
v_accvgpr_write_b32 a176, v190
v_accvgpr_read_b32 v190, a177
v_mul_f32 v190, v190, v90
v_accvgpr_write_b32 a177, v190
v_accvgpr_read_b32 v190, a178
v_mul_f32 v190, v190, v90
v_accvgpr_write_b32 a178, v190
v_accvgpr_read_b32 v190, a179
v_mul_f32 v190, v190, v90
v_accvgpr_write_b32 a179, v190
v_accvgpr_read_b32 v190, a192
v_mul_f32 v190, v190, v90
v_accvgpr_write_b32 a192, v190
v_accvgpr_read_b32 v190, a193
v_mul_f32 v190, v190, v90
v_accvgpr_write_b32 a193, v190
v_accvgpr_read_b32 v190, a194
v_mul_f32 v190, v190, v90
v_accvgpr_write_b32 a194, v190
v_accvgpr_read_b32 v190, a195
v_mul_f32 v190, v190, v90
v_accvgpr_write_b32 a195, v190
v_accvgpr_read_b32 v190, a208
v_mul_f32 v190, v190, v90
v_accvgpr_write_b32 a208, v190
v_accvgpr_read_b32 v190, a209
v_mul_f32 v190, v190, v90
v_accvgpr_write_b32 a209, v190
v_accvgpr_read_b32 v190, a210
v_mul_f32 v190, v190, v90
v_accvgpr_write_b32 a210, v190
v_accvgpr_read_b32 v190, a211
v_mul_f32 v190, v190, v90
v_accvgpr_write_b32 a211, v190
v_accvgpr_read_b32 v190, a224
v_mul_f32 v190, v190, v90
v_accvgpr_write_b32 a224, v190
v_accvgpr_read_b32 v190, a225
v_mul_f32 v190, v190, v90
v_accvgpr_write_b32 a225, v190
v_accvgpr_read_b32 v190, a226
v_mul_f32 v190, v190, v90
v_accvgpr_write_b32 a226, v190
v_accvgpr_read_b32 v190, a227
v_mul_f32 v190, v190, v90
v_accvgpr_write_b32 a227, v190
v_accvgpr_read_b32 v190, a240
v_mul_f32 v190, v190, v90
v_accvgpr_write_b32 a240, v190
v_accvgpr_read_b32 v190, a241
v_mul_f32 v190, v190, v90
v_accvgpr_write_b32 a241, v190
v_accvgpr_read_b32 v190, a242
v_mul_f32 v190, v190, v90
v_accvgpr_write_b32 a242, v190
v_accvgpr_read_b32 v190, a243
v_mul_f32 v190, v190, v90
v_accvgpr_write_b32 a243, v190
v_sub_f32 v104, v104, v85
v_sub_f32 v105, v105, v85
v_sub_f32 v106, v106, v85
v_sub_f32 v107, v107, v85
v_mul_f32 v121, v121, v91
v_accvgpr_read_b32 v190, a4
v_mul_f32 v190, v190, v91
v_accvgpr_write_b32 a4, v190
v_accvgpr_read_b32 v190, a5
v_mul_f32 v190, v190, v91
v_accvgpr_write_b32 a5, v190
v_accvgpr_read_b32 v190, a6
v_mul_f32 v190, v190, v91
v_accvgpr_write_b32 a6, v190
v_accvgpr_read_b32 v190, a7
v_mul_f32 v190, v190, v91
v_accvgpr_write_b32 a7, v190
v_accvgpr_read_b32 v190, a20
v_mul_f32 v190, v190, v91
v_accvgpr_write_b32 a20, v190
v_accvgpr_read_b32 v190, a21
v_mul_f32 v190, v190, v91
v_accvgpr_write_b32 a21, v190
v_accvgpr_read_b32 v190, a22
v_mul_f32 v190, v190, v91
v_accvgpr_write_b32 a22, v190
v_accvgpr_read_b32 v190, a23
v_mul_f32 v190, v190, v91
v_accvgpr_write_b32 a23, v190
v_accvgpr_read_b32 v190, a36
v_mul_f32 v190, v190, v91
v_accvgpr_write_b32 a36, v190
v_accvgpr_read_b32 v190, a37
v_mul_f32 v190, v190, v91
v_accvgpr_write_b32 a37, v190
v_accvgpr_read_b32 v190, a38
v_mul_f32 v190, v190, v91
v_accvgpr_write_b32 a38, v190
v_accvgpr_read_b32 v190, a39
v_mul_f32 v190, v190, v91
v_accvgpr_write_b32 a39, v190
v_accvgpr_read_b32 v190, a52
v_mul_f32 v190, v190, v91
v_accvgpr_write_b32 a52, v190
v_accvgpr_read_b32 v190, a53
v_mul_f32 v190, v190, v91
v_accvgpr_write_b32 a53, v190
v_accvgpr_read_b32 v190, a54
v_mul_f32 v190, v190, v91
v_accvgpr_write_b32 a54, v190
v_accvgpr_read_b32 v190, a55
v_mul_f32 v190, v190, v91
v_accvgpr_write_b32 a55, v190
v_accvgpr_read_b32 v190, a68
v_mul_f32 v190, v190, v91
v_accvgpr_write_b32 a68, v190
v_accvgpr_read_b32 v190, a69
v_mul_f32 v190, v190, v91
v_accvgpr_write_b32 a69, v190
v_accvgpr_read_b32 v190, a70
v_mul_f32 v190, v190, v91
v_accvgpr_write_b32 a70, v190
v_accvgpr_read_b32 v190, a71
v_mul_f32 v190, v190, v91
v_accvgpr_write_b32 a71, v190
v_accvgpr_read_b32 v190, a84
v_mul_f32 v190, v190, v91
v_accvgpr_write_b32 a84, v190
v_accvgpr_read_b32 v190, a85
v_mul_f32 v190, v190, v91
v_accvgpr_write_b32 a85, v190
v_accvgpr_read_b32 v190, a86
v_mul_f32 v190, v190, v91
v_accvgpr_write_b32 a86, v190
v_accvgpr_read_b32 v190, a87
v_mul_f32 v190, v190, v91
v_accvgpr_write_b32 a87, v190
v_accvgpr_read_b32 v190, a100
v_mul_f32 v190, v190, v91
v_accvgpr_write_b32 a100, v190
v_accvgpr_read_b32 v190, a101
v_mul_f32 v190, v190, v91
v_accvgpr_write_b32 a101, v190
v_accvgpr_read_b32 v190, a102
v_mul_f32 v190, v190, v91
v_accvgpr_write_b32 a102, v190
v_accvgpr_read_b32 v190, a103
v_mul_f32 v190, v190, v91
v_accvgpr_write_b32 a103, v190
v_accvgpr_read_b32 v190, a116
v_mul_f32 v190, v190, v91
v_accvgpr_write_b32 a116, v190
v_accvgpr_read_b32 v190, a117
v_mul_f32 v190, v190, v91
v_accvgpr_write_b32 a117, v190
v_accvgpr_read_b32 v190, a118
v_mul_f32 v190, v190, v91
v_accvgpr_write_b32 a118, v190
v_accvgpr_read_b32 v190, a119
v_mul_f32 v190, v190, v91
v_accvgpr_write_b32 a119, v190
v_accvgpr_read_b32 v190, a132
v_mul_f32 v190, v190, v91
v_accvgpr_write_b32 a132, v190
v_accvgpr_read_b32 v190, a133
v_mul_f32 v190, v190, v91
v_accvgpr_write_b32 a133, v190
v_accvgpr_read_b32 v190, a134
v_mul_f32 v190, v190, v91
v_accvgpr_write_b32 a134, v190
v_accvgpr_read_b32 v190, a135
v_mul_f32 v190, v190, v91
v_accvgpr_write_b32 a135, v190
v_accvgpr_read_b32 v190, a148
v_mul_f32 v190, v190, v91
v_accvgpr_write_b32 a148, v190
v_accvgpr_read_b32 v190, a149
v_mul_f32 v190, v190, v91
v_accvgpr_write_b32 a149, v190
v_accvgpr_read_b32 v190, a150
v_mul_f32 v190, v190, v91
v_accvgpr_write_b32 a150, v190
v_accvgpr_read_b32 v190, a151
v_mul_f32 v190, v190, v91
v_accvgpr_write_b32 a151, v190
v_accvgpr_read_b32 v190, a164
v_mul_f32 v190, v190, v91
v_accvgpr_write_b32 a164, v190
v_accvgpr_read_b32 v190, a165
v_mul_f32 v190, v190, v91
v_accvgpr_write_b32 a165, v190
v_accvgpr_read_b32 v190, a166
v_mul_f32 v190, v190, v91
v_accvgpr_write_b32 a166, v190
v_accvgpr_read_b32 v190, a167
v_mul_f32 v190, v190, v91
v_accvgpr_write_b32 a167, v190
v_accvgpr_read_b32 v190, a180
v_mul_f32 v190, v190, v91
v_accvgpr_write_b32 a180, v190
v_accvgpr_read_b32 v190, a181
v_mul_f32 v190, v190, v91
v_accvgpr_write_b32 a181, v190
v_accvgpr_read_b32 v190, a182
v_mul_f32 v190, v190, v91
v_accvgpr_write_b32 a182, v190
v_accvgpr_read_b32 v190, a183
v_mul_f32 v190, v190, v91
v_accvgpr_write_b32 a183, v190
v_accvgpr_read_b32 v190, a196
v_mul_f32 v190, v190, v91
v_accvgpr_write_b32 a196, v190
v_accvgpr_read_b32 v190, a197
v_mul_f32 v190, v190, v91
v_accvgpr_write_b32 a197, v190
v_accvgpr_read_b32 v190, a198
v_mul_f32 v190, v190, v91
v_accvgpr_write_b32 a198, v190
v_accvgpr_read_b32 v190, a199
v_mul_f32 v190, v190, v91
v_accvgpr_write_b32 a199, v190
v_accvgpr_read_b32 v190, a212
v_mul_f32 v190, v190, v91
v_accvgpr_write_b32 a212, v190
v_accvgpr_read_b32 v190, a213
v_mul_f32 v190, v190, v91
v_accvgpr_write_b32 a213, v190
v_accvgpr_read_b32 v190, a214
v_mul_f32 v190, v190, v91
v_accvgpr_write_b32 a214, v190
v_accvgpr_read_b32 v190, a215
v_mul_f32 v190, v190, v91
v_accvgpr_write_b32 a215, v190
v_accvgpr_read_b32 v190, a228
v_mul_f32 v190, v190, v91
v_accvgpr_write_b32 a228, v190
v_accvgpr_read_b32 v190, a229
v_mul_f32 v190, v190, v91
v_accvgpr_write_b32 a229, v190
v_accvgpr_read_b32 v190, a230
v_mul_f32 v190, v190, v91
v_accvgpr_write_b32 a230, v190
v_accvgpr_read_b32 v190, a231
v_mul_f32 v190, v190, v91
v_accvgpr_write_b32 a231, v190
v_accvgpr_read_b32 v190, a244
v_mul_f32 v190, v190, v91
v_accvgpr_write_b32 a244, v190
v_accvgpr_read_b32 v190, a245
v_mul_f32 v190, v190, v91
v_accvgpr_write_b32 a245, v190
v_accvgpr_read_b32 v190, a246
v_mul_f32 v190, v190, v91
v_accvgpr_write_b32 a246, v190
v_accvgpr_read_b32 v190, a247
v_mul_f32 v190, v190, v91
v_accvgpr_write_b32 a247, v190
v_sub_f32 v108, v108, v86
v_sub_f32 v109, v109, v86
v_sub_f32 v110, v110, v86
v_sub_f32 v111, v111, v86
v_mul_f32 v122, v122, v92
v_accvgpr_read_b32 v190, a8
v_mul_f32 v190, v190, v92
v_accvgpr_write_b32 a8, v190
v_accvgpr_read_b32 v190, a9
v_mul_f32 v190, v190, v92
v_accvgpr_write_b32 a9, v190
v_accvgpr_read_b32 v190, a10
v_mul_f32 v190, v190, v92
v_accvgpr_write_b32 a10, v190
v_accvgpr_read_b32 v190, a11
v_mul_f32 v190, v190, v92
v_accvgpr_write_b32 a11, v190
v_accvgpr_read_b32 v190, a24
v_mul_f32 v190, v190, v92
v_accvgpr_write_b32 a24, v190
v_accvgpr_read_b32 v190, a25
v_mul_f32 v190, v190, v92
v_accvgpr_write_b32 a25, v190
v_accvgpr_read_b32 v190, a26
v_mul_f32 v190, v190, v92
v_accvgpr_write_b32 a26, v190
v_accvgpr_read_b32 v190, a27
v_mul_f32 v190, v190, v92
v_accvgpr_write_b32 a27, v190
v_accvgpr_read_b32 v190, a40
v_mul_f32 v190, v190, v92
v_accvgpr_write_b32 a40, v190
v_accvgpr_read_b32 v190, a41
v_mul_f32 v190, v190, v92
v_accvgpr_write_b32 a41, v190
v_accvgpr_read_b32 v190, a42
v_mul_f32 v190, v190, v92
v_accvgpr_write_b32 a42, v190
v_accvgpr_read_b32 v190, a43
v_mul_f32 v190, v190, v92
v_accvgpr_write_b32 a43, v190
v_accvgpr_read_b32 v190, a56
v_mul_f32 v190, v190, v92
v_accvgpr_write_b32 a56, v190
v_accvgpr_read_b32 v190, a57
v_mul_f32 v190, v190, v92
v_accvgpr_write_b32 a57, v190
v_accvgpr_read_b32 v190, a58
v_mul_f32 v190, v190, v92
v_accvgpr_write_b32 a58, v190
v_accvgpr_read_b32 v190, a59
v_mul_f32 v190, v190, v92
v_accvgpr_write_b32 a59, v190
v_accvgpr_read_b32 v190, a72
v_mul_f32 v190, v190, v92
v_accvgpr_write_b32 a72, v190
v_accvgpr_read_b32 v190, a73
v_mul_f32 v190, v190, v92
v_accvgpr_write_b32 a73, v190
v_accvgpr_read_b32 v190, a74
v_mul_f32 v190, v190, v92
v_accvgpr_write_b32 a74, v190
v_accvgpr_read_b32 v190, a75
v_mul_f32 v190, v190, v92
v_accvgpr_write_b32 a75, v190
v_accvgpr_read_b32 v190, a88
v_mul_f32 v190, v190, v92
v_accvgpr_write_b32 a88, v190
v_accvgpr_read_b32 v190, a89
v_mul_f32 v190, v190, v92
v_accvgpr_write_b32 a89, v190
v_accvgpr_read_b32 v190, a90
v_mul_f32 v190, v190, v92
v_accvgpr_write_b32 a90, v190
v_accvgpr_read_b32 v190, a91
v_mul_f32 v190, v190, v92
v_accvgpr_write_b32 a91, v190
v_accvgpr_read_b32 v190, a104
v_mul_f32 v190, v190, v92
v_accvgpr_write_b32 a104, v190
v_accvgpr_read_b32 v190, a105
v_mul_f32 v190, v190, v92
v_accvgpr_write_b32 a105, v190
v_accvgpr_read_b32 v190, a106
v_mul_f32 v190, v190, v92
v_accvgpr_write_b32 a106, v190
v_accvgpr_read_b32 v190, a107
v_mul_f32 v190, v190, v92
v_accvgpr_write_b32 a107, v190
v_accvgpr_read_b32 v190, a120
v_mul_f32 v190, v190, v92
v_accvgpr_write_b32 a120, v190
v_accvgpr_read_b32 v190, a121
v_mul_f32 v190, v190, v92
v_accvgpr_write_b32 a121, v190
v_accvgpr_read_b32 v190, a122
v_mul_f32 v190, v190, v92
v_accvgpr_write_b32 a122, v190
v_accvgpr_read_b32 v190, a123
v_mul_f32 v190, v190, v92
v_accvgpr_write_b32 a123, v190
v_accvgpr_read_b32 v190, a136
v_mul_f32 v190, v190, v92
v_accvgpr_write_b32 a136, v190
v_accvgpr_read_b32 v190, a137
v_mul_f32 v190, v190, v92
v_accvgpr_write_b32 a137, v190
v_accvgpr_read_b32 v190, a138
v_mul_f32 v190, v190, v92
v_accvgpr_write_b32 a138, v190
v_accvgpr_read_b32 v190, a139
v_mul_f32 v190, v190, v92
v_accvgpr_write_b32 a139, v190
v_accvgpr_read_b32 v190, a152
v_mul_f32 v190, v190, v92
v_accvgpr_write_b32 a152, v190
v_accvgpr_read_b32 v190, a153
v_mul_f32 v190, v190, v92
v_accvgpr_write_b32 a153, v190
v_accvgpr_read_b32 v190, a154
v_mul_f32 v190, v190, v92
v_accvgpr_write_b32 a154, v190
v_accvgpr_read_b32 v190, a155
v_mul_f32 v190, v190, v92
v_accvgpr_write_b32 a155, v190
v_accvgpr_read_b32 v190, a168
v_mul_f32 v190, v190, v92
v_accvgpr_write_b32 a168, v190
v_accvgpr_read_b32 v190, a169
v_mul_f32 v190, v190, v92
v_accvgpr_write_b32 a169, v190
v_accvgpr_read_b32 v190, a170
v_mul_f32 v190, v190, v92
v_accvgpr_write_b32 a170, v190
v_accvgpr_read_b32 v190, a171
v_mul_f32 v190, v190, v92
v_accvgpr_write_b32 a171, v190
v_accvgpr_read_b32 v190, a184
v_mul_f32 v190, v190, v92
v_accvgpr_write_b32 a184, v190
v_accvgpr_read_b32 v190, a185
v_mul_f32 v190, v190, v92
v_accvgpr_write_b32 a185, v190
v_accvgpr_read_b32 v190, a186
v_mul_f32 v190, v190, v92
v_accvgpr_write_b32 a186, v190
v_accvgpr_read_b32 v190, a187
v_mul_f32 v190, v190, v92
v_accvgpr_write_b32 a187, v190
v_accvgpr_read_b32 v190, a200
v_mul_f32 v190, v190, v92
v_accvgpr_write_b32 a200, v190
v_accvgpr_read_b32 v190, a201
v_mul_f32 v190, v190, v92
v_accvgpr_write_b32 a201, v190
v_accvgpr_read_b32 v190, a202
v_mul_f32 v190, v190, v92
v_accvgpr_write_b32 a202, v190
v_accvgpr_read_b32 v190, a203
v_mul_f32 v190, v190, v92
v_accvgpr_write_b32 a203, v190
v_accvgpr_read_b32 v190, a216
v_mul_f32 v190, v190, v92
v_accvgpr_write_b32 a216, v190
v_accvgpr_read_b32 v190, a217
v_mul_f32 v190, v190, v92
v_accvgpr_write_b32 a217, v190
v_accvgpr_read_b32 v190, a218
v_mul_f32 v190, v190, v92
v_accvgpr_write_b32 a218, v190
v_accvgpr_read_b32 v190, a219
v_mul_f32 v190, v190, v92
v_accvgpr_write_b32 a219, v190
v_accvgpr_read_b32 v190, a232
v_mul_f32 v190, v190, v92
v_accvgpr_write_b32 a232, v190
v_accvgpr_read_b32 v190, a233
v_mul_f32 v190, v190, v92
v_accvgpr_write_b32 a233, v190
v_accvgpr_read_b32 v190, a234
v_mul_f32 v190, v190, v92
v_accvgpr_write_b32 a234, v190
v_accvgpr_read_b32 v190, a235
v_mul_f32 v190, v190, v92
v_accvgpr_write_b32 a235, v190
v_accvgpr_read_b32 v190, a248
v_mul_f32 v190, v190, v92
v_accvgpr_write_b32 a248, v190
v_accvgpr_read_b32 v190, a249
v_mul_f32 v190, v190, v92
v_accvgpr_write_b32 a249, v190
v_accvgpr_read_b32 v190, a250
v_mul_f32 v190, v190, v92
v_accvgpr_write_b32 a250, v190
v_accvgpr_read_b32 v190, a251
v_mul_f32 v190, v190, v92
v_accvgpr_write_b32 a251, v190
v_sub_f32 v112, v112, v87
v_sub_f32 v113, v113, v87
v_sub_f32 v114, v114, v87
v_sub_f32 v115, v115, v87
v_mul_f32 v123, v123, v93
v_accvgpr_read_b32 v190, a12
v_mul_f32 v190, v190, v93
v_accvgpr_write_b32 a12, v190
v_accvgpr_read_b32 v190, a13
v_mul_f32 v190, v190, v93
v_accvgpr_write_b32 a13, v190
v_accvgpr_read_b32 v190, a14
v_mul_f32 v190, v190, v93
v_accvgpr_write_b32 a14, v190
v_accvgpr_read_b32 v190, a15
v_mul_f32 v190, v190, v93
v_accvgpr_write_b32 a15, v190
v_accvgpr_read_b32 v190, a28
v_mul_f32 v190, v190, v93
v_accvgpr_write_b32 a28, v190
v_accvgpr_read_b32 v190, a29
v_mul_f32 v190, v190, v93
v_accvgpr_write_b32 a29, v190
v_accvgpr_read_b32 v190, a30
v_mul_f32 v190, v190, v93
v_accvgpr_write_b32 a30, v190
v_accvgpr_read_b32 v190, a31
v_mul_f32 v190, v190, v93
v_accvgpr_write_b32 a31, v190
v_accvgpr_read_b32 v190, a44
v_mul_f32 v190, v190, v93
v_accvgpr_write_b32 a44, v190
v_accvgpr_read_b32 v190, a45
v_mul_f32 v190, v190, v93
v_accvgpr_write_b32 a45, v190
v_accvgpr_read_b32 v190, a46
v_mul_f32 v190, v190, v93
v_accvgpr_write_b32 a46, v190
v_accvgpr_read_b32 v190, a47
v_mul_f32 v190, v190, v93
v_accvgpr_write_b32 a47, v190
v_accvgpr_read_b32 v190, a60
v_mul_f32 v190, v190, v93
v_accvgpr_write_b32 a60, v190
v_accvgpr_read_b32 v190, a61
v_mul_f32 v190, v190, v93
v_accvgpr_write_b32 a61, v190
v_accvgpr_read_b32 v190, a62
v_mul_f32 v190, v190, v93
v_accvgpr_write_b32 a62, v190
v_accvgpr_read_b32 v190, a63
v_mul_f32 v190, v190, v93
v_accvgpr_write_b32 a63, v190
v_accvgpr_read_b32 v190, a76
v_mul_f32 v190, v190, v93
v_accvgpr_write_b32 a76, v190
v_accvgpr_read_b32 v190, a77
v_mul_f32 v190, v190, v93
v_accvgpr_write_b32 a77, v190
v_accvgpr_read_b32 v190, a78
v_mul_f32 v190, v190, v93
v_accvgpr_write_b32 a78, v190
v_accvgpr_read_b32 v190, a79
v_mul_f32 v190, v190, v93
v_accvgpr_write_b32 a79, v190
v_accvgpr_read_b32 v190, a92
v_mul_f32 v190, v190, v93
v_accvgpr_write_b32 a92, v190
v_accvgpr_read_b32 v190, a93
v_mul_f32 v190, v190, v93
v_accvgpr_write_b32 a93, v190
v_accvgpr_read_b32 v190, a94
v_mul_f32 v190, v190, v93
v_accvgpr_write_b32 a94, v190
v_accvgpr_read_b32 v190, a95
v_mul_f32 v190, v190, v93
v_accvgpr_write_b32 a95, v190
v_accvgpr_read_b32 v190, a108
v_mul_f32 v190, v190, v93
v_accvgpr_write_b32 a108, v190
v_accvgpr_read_b32 v190, a109
v_mul_f32 v190, v190, v93
v_accvgpr_write_b32 a109, v190
v_accvgpr_read_b32 v190, a110
v_mul_f32 v190, v190, v93
v_accvgpr_write_b32 a110, v190
v_accvgpr_read_b32 v190, a111
v_mul_f32 v190, v190, v93
v_accvgpr_write_b32 a111, v190
v_accvgpr_read_b32 v190, a124
v_mul_f32 v190, v190, v93
v_accvgpr_write_b32 a124, v190
v_accvgpr_read_b32 v190, a125
v_mul_f32 v190, v190, v93
v_accvgpr_write_b32 a125, v190
v_accvgpr_read_b32 v190, a126
v_mul_f32 v190, v190, v93
v_accvgpr_write_b32 a126, v190
v_accvgpr_read_b32 v190, a127
v_mul_f32 v190, v190, v93
v_accvgpr_write_b32 a127, v190
v_accvgpr_read_b32 v190, a140
v_mul_f32 v190, v190, v93
v_accvgpr_write_b32 a140, v190
v_accvgpr_read_b32 v190, a141
v_mul_f32 v190, v190, v93
v_accvgpr_write_b32 a141, v190
v_accvgpr_read_b32 v190, a142
v_mul_f32 v190, v190, v93
v_accvgpr_write_b32 a142, v190
v_accvgpr_read_b32 v190, a143
v_mul_f32 v190, v190, v93
v_accvgpr_write_b32 a143, v190
v_accvgpr_read_b32 v190, a156
v_mul_f32 v190, v190, v93
v_accvgpr_write_b32 a156, v190
v_accvgpr_read_b32 v190, a157
v_mul_f32 v190, v190, v93
v_accvgpr_write_b32 a157, v190
v_accvgpr_read_b32 v190, a158
v_mul_f32 v190, v190, v93
v_accvgpr_write_b32 a158, v190
v_accvgpr_read_b32 v190, a159
v_mul_f32 v190, v190, v93
v_accvgpr_write_b32 a159, v190
v_accvgpr_read_b32 v190, a172
v_mul_f32 v190, v190, v93
v_accvgpr_write_b32 a172, v190
v_accvgpr_read_b32 v190, a173
v_mul_f32 v190, v190, v93
v_accvgpr_write_b32 a173, v190
v_accvgpr_read_b32 v190, a174
v_mul_f32 v190, v190, v93
v_accvgpr_write_b32 a174, v190
v_accvgpr_read_b32 v190, a175
v_mul_f32 v190, v190, v93
v_accvgpr_write_b32 a175, v190
v_accvgpr_read_b32 v190, a188
v_mul_f32 v190, v190, v93
v_accvgpr_write_b32 a188, v190
v_accvgpr_read_b32 v190, a189
v_mul_f32 v190, v190, v93
v_accvgpr_write_b32 a189, v190
v_accvgpr_read_b32 v190, a190
v_mul_f32 v190, v190, v93
v_accvgpr_write_b32 a190, v190
v_accvgpr_read_b32 v190, a191
v_mul_f32 v190, v190, v93
v_accvgpr_write_b32 a191, v190
v_accvgpr_read_b32 v190, a204
v_mul_f32 v190, v190, v93
v_accvgpr_write_b32 a204, v190
v_accvgpr_read_b32 v190, a205
v_mul_f32 v190, v190, v93
v_accvgpr_write_b32 a205, v190
v_accvgpr_read_b32 v190, a206
v_mul_f32 v190, v190, v93
v_accvgpr_write_b32 a206, v190
v_accvgpr_read_b32 v190, a207
v_mul_f32 v190, v190, v93
v_accvgpr_write_b32 a207, v190
v_accvgpr_read_b32 v190, a220
v_mul_f32 v190, v190, v93
v_accvgpr_write_b32 a220, v190
v_accvgpr_read_b32 v190, a221
v_mul_f32 v190, v190, v93
v_accvgpr_write_b32 a221, v190
v_accvgpr_read_b32 v190, a222
v_mul_f32 v190, v190, v93
v_accvgpr_write_b32 a222, v190
v_accvgpr_read_b32 v190, a223
v_mul_f32 v190, v190, v93
v_accvgpr_write_b32 a223, v190
v_accvgpr_read_b32 v190, a236
v_mul_f32 v190, v190, v93
v_accvgpr_write_b32 a236, v190
v_accvgpr_read_b32 v190, a237
v_mul_f32 v190, v190, v93
v_accvgpr_write_b32 a237, v190
v_accvgpr_read_b32 v190, a238
v_mul_f32 v190, v190, v93
v_accvgpr_write_b32 a238, v190
v_accvgpr_read_b32 v190, a239
v_mul_f32 v190, v190, v93
v_accvgpr_write_b32 a239, v190
v_accvgpr_read_b32 v190, a252
v_mul_f32 v190, v190, v93
v_accvgpr_write_b32 a252, v190
v_accvgpr_read_b32 v190, a253
v_mul_f32 v190, v190, v93
v_accvgpr_write_b32 a253, v190
v_accvgpr_read_b32 v190, a254
v_mul_f32 v190, v190, v93
v_accvgpr_write_b32 a254, v190
v_accvgpr_read_b32 v190, a255
v_mul_f32 v190, v190, v93
v_accvgpr_write_b32 a255, v190
v_sub_f32 v116, v116, v88
v_sub_f32 v117, v117, v88
v_sub_f32 v118, v118, v88
v_sub_f32 v119, v119, v88
v_mul_f32 v124, v124, v94
v_mul_f32 v192, v192, v94
v_mul_f32 v193, v193, v94
v_mul_f32 v194, v194, v94
v_mul_f32 v195, v195, v94
v_mul_f32 v196, v196, v94
v_mul_f32 v197, v197, v94
v_mul_f32 v198, v198, v94
v_mul_f32 v199, v199, v94
v_mul_f32 v200, v200, v94
v_mul_f32 v201, v201, v94
v_mul_f32 v202, v202, v94
v_mul_f32 v203, v203, v94
v_mul_f32 v204, v204, v94
v_mul_f32 v205, v205, v94
v_mul_f32 v206, v206, v94
v_mul_f32 v207, v207, v94
v_mul_f32 v208, v208, v94
v_mul_f32 v209, v209, v94
v_mul_f32 v210, v210, v94
v_mul_f32 v211, v211, v94
v_mul_f32 v212, v212, v94
v_mul_f32 v213, v213, v94
v_mul_f32 v214, v214, v94
v_mul_f32 v215, v215, v94
v_mul_f32 v216, v216, v94
v_mul_f32 v217, v217, v94
v_mul_f32 v218, v218, v94
v_mul_f32 v219, v219, v94
v_mul_f32 v220, v220, v94
v_mul_f32 v221, v221, v94
v_mul_f32 v222, v222, v94
v_mul_f32 v223, v223, v94
v_mul_f32 v224, v224, v94
v_mul_f32 v225, v225, v94
v_mul_f32 v226, v226, v94
v_mul_f32 v227, v227, v94
v_mul_f32 v228, v228, v94
v_mul_f32 v229, v229, v94
v_mul_f32 v230, v230, v94
v_mul_f32 v231, v231, v94
v_mul_f32 v232, v232, v94
v_mul_f32 v233, v233, v94
v_mul_f32 v234, v234, v94
v_mul_f32 v235, v235, v94
v_mul_f32 v236, v236, v94
v_mul_f32 v237, v237, v94
v_mul_f32 v238, v238, v94
v_mul_f32 v239, v239, v94
v_mul_f32 v240, v240, v94
v_mul_f32 v241, v241, v94
v_mul_f32 v242, v242, v94
v_mul_f32 v243, v243, v94
v_mul_f32 v244, v244, v94
v_mul_f32 v245, v245, v94
v_mul_f32 v246, v246, v94
v_mul_f32 v247, v247, v94
v_mul_f32 v248, v248, v94
v_mul_f32 v249, v249, v94
v_mul_f32 v250, v250, v94
v_mul_f32 v251, v251, v94
v_mul_f32 v252, v252, v94
v_mul_f32 v253, v253, v94
v_mul_f32 v254, v254, v94
v_mul_f32 v255, v255, v94
v_sub_f32 v40, v40, v84
v_sub_f32 v41, v41, v84
v_sub_f32 v42, v42, v84
v_sub_f32 v43, v43, v84
v_sub_f32 v44, v44, v84
v_sub_f32 v45, v45, v84
v_sub_f32 v46, v46, v84
v_sub_f32 v47, v47, v84
v_sub_f32 v48, v48, v85
v_sub_f32 v49, v49, v85
v_sub_f32 v50, v50, v85
v_sub_f32 v51, v51, v85
v_sub_f32 v52, v52, v85
v_sub_f32 v53, v53, v85
v_sub_f32 v54, v54, v85
v_sub_f32 v55, v55, v85
v_sub_f32 v56, v56, v86
v_sub_f32 v57, v57, v86
v_sub_f32 v58, v58, v86
v_sub_f32 v59, v59, v86
v_sub_f32 v60, v60, v86
v_sub_f32 v61, v61, v86
v_sub_f32 v62, v62, v86
v_sub_f32 v63, v63, v86
v_sub_f32 v64, v64, v87
v_sub_f32 v65, v65, v87
v_sub_f32 v66, v66, v87
v_sub_f32 v67, v67, v87
v_sub_f32 v68, v68, v87
v_sub_f32 v69, v69, v87
v_sub_f32 v70, v70, v87
v_sub_f32 v71, v71, v87
v_sub_f32 v72, v72, v88
v_sub_f32 v73, v73, v88
v_sub_f32 v74, v74, v88
v_sub_f32 v75, v75, v88
v_sub_f32 v76, v76, v88
v_sub_f32 v77, v77, v88
v_sub_f32 v78, v78, v88
v_sub_f32 v79, v79, v88
v_exp_f32 v40, v40
v_exp_f32 v41, v41
v_exp_f32 v42, v42
v_exp_f32 v43, v43
v_exp_f32 v44, v44
v_exp_f32 v45, v45
v_exp_f32 v46, v46
v_exp_f32 v47, v47
v_exp_f32 v48, v48
v_exp_f32 v49, v49
v_exp_f32 v50, v50
v_exp_f32 v51, v51
v_exp_f32 v52, v52
v_exp_f32 v53, v53
v_exp_f32 v54, v54
v_exp_f32 v55, v55
v_exp_f32 v56, v56
v_exp_f32 v57, v57
v_exp_f32 v58, v58
v_exp_f32 v59, v59
v_exp_f32 v60, v60
v_exp_f32 v61, v61
v_exp_f32 v62, v62
v_exp_f32 v63, v63
v_exp_f32 v64, v64
v_exp_f32 v65, v65
v_exp_f32 v66, v66
v_exp_f32 v67, v67
v_exp_f32 v68, v68
v_exp_f32 v69, v69
v_exp_f32 v70, v70
v_exp_f32 v71, v71
v_exp_f32 v72, v72
v_exp_f32 v73, v73
v_exp_f32 v74, v74
v_exp_f32 v75, v75
v_exp_f32 v76, v76
v_exp_f32 v77, v77
v_exp_f32 v78, v78
v_exp_f32 v79, v79
s_nop 0
v_add_f32 v125, v120, v40
v_add_f32 v125, v125, v41
v_add_f32 v125, v125, v42
v_add_f32 v125, v125, v43
v_add_f32 v125, v125, v44
v_add_f32 v125, v125, v45
v_add_f32 v125, v125, v46
v_add_f32 v125, v125, v47
v_add_f32 v126, v121, v48
v_add_f32 v126, v126, v49
v_add_f32 v126, v126, v50
v_add_f32 v126, v126, v51
v_add_f32 v126, v126, v52
v_add_f32 v126, v126, v53
v_add_f32 v126, v126, v54
v_add_f32 v126, v126, v55
v_add_f32 v127, v122, v56
v_add_f32 v127, v127, v57
v_add_f32 v127, v127, v58
v_add_f32 v127, v127, v59
v_add_f32 v127, v127, v60
v_add_f32 v127, v127, v61
v_add_f32 v127, v127, v62
v_add_f32 v127, v127, v63
v_add_f32 v128, v123, v64
v_add_f32 v128, v128, v65
v_add_f32 v128, v128, v66
v_add_f32 v128, v128, v67
v_add_f32 v128, v128, v68
v_add_f32 v128, v128, v69
v_add_f32 v128, v128, v70
v_add_f32 v128, v128, v71
v_add_f32 v129, v124, v72
v_add_f32 v129, v129, v73
v_add_f32 v129, v129, v74
v_add_f32 v129, v129, v75
v_add_f32 v129, v129, v76
v_add_f32 v129, v129, v77
v_add_f32 v129, v129, v78
v_add_f32 v129, v129, v79
v_cvt_pk_bf16_f32 v80, v40, v41
v_cvt_pk_bf16_f32 v81, v42, v43
v_cvt_pk_bf16_f32 v82, v44, v45
v_cvt_pk_bf16_f32 v83, v46, v47
s_nop 1
s_branch L_sp2_r5_ret
L_sp1_r4:
s_waitcnt lgkmcnt(0)
s_nop 7
s_nop 7
v_mbcnt_lo_u32_b32 v117, -1, 0
v_mbcnt_hi_u32_b32 v117, -1, v117
v_and_b32 v116, 15, v117
v_lshlrev_b32 v116, 9, v116
v_lshrrev_b32 v117, 4, v117
v_lshlrev_b32 v117, 4, v117
v_add_u32 v116, v116, v117
v_add_u32 v116, s34, v116
global_load_dwordx4 v[24:27], v116, s[36:37] offset:0
v_add_u32 v117, 8192, v116
global_load_dwordx4 v[28:31], v117, s[36:37] offset:0
s_waitcnt vmcnt(0)
v_mfma_f32_16x16x32_bf16 v[40:43], v[24:27], v[128:131], v[100:103]
v_mfma_f32_16x16x32_bf16 v[44:47], v[28:31], v[128:131], v[100:103]
v_mfma_f32_16x16x32_bf16 v[48:51], v[24:27], v[132:135], v[104:107]
v_mfma_f32_16x16x32_bf16 v[52:55], v[28:31], v[132:135], v[104:107]
v_mfma_f32_16x16x32_bf16 v[56:59], v[24:27], v[136:139], v[108:111]
v_mfma_f32_16x16x32_bf16 v[60:63], v[28:31], v[136:139], v[108:111]
v_mfma_f32_16x16x32_bf16 v[64:67], v[24:27], v[140:143], v[112:115]
v_mfma_f32_16x16x32_bf16 v[68:71], v[28:31], v[140:143], v[112:115]
s_nop 7
global_load_dwordx4 v[24:27], v116, s[36:37] offset:64
v_add_u32 v117, 8192, v116
global_load_dwordx4 v[28:31], v117, s[36:37] offset:64
s_waitcnt vmcnt(0)
v_mfma_f32_16x16x32_bf16 v[40:43], v[24:27], v[144:147], v[40:43]
v_mfma_f32_16x16x32_bf16 v[44:47], v[28:31], v[144:147], v[44:47]
v_mfma_f32_16x16x32_bf16 v[48:51], v[24:27], v[148:151], v[48:51]
v_mfma_f32_16x16x32_bf16 v[52:55], v[28:31], v[148:151], v[52:55]
v_mfma_f32_16x16x32_bf16 v[56:59], v[24:27], v[152:155], v[56:59]
v_mfma_f32_16x16x32_bf16 v[60:63], v[28:31], v[152:155], v[60:63]
v_mfma_f32_16x16x32_bf16 v[64:67], v[24:27], v[156:159], v[64:67]
v_mfma_f32_16x16x32_bf16 v[68:71], v[28:31], v[156:159], v[68:71]
s_nop 7
global_load_dwordx4 v[24:27], v116, s[36:37] offset:128
v_add_u32 v117, 8192, v116
global_load_dwordx4 v[28:31], v117, s[36:37] offset:128
s_waitcnt vmcnt(0)
v_mfma_f32_16x16x32_bf16 v[40:43], v[24:27], v[160:163], v[40:43]
v_mfma_f32_16x16x32_bf16 v[44:47], v[28:31], v[160:163], v[44:47]
v_mfma_f32_16x16x32_bf16 v[48:51], v[24:27], v[164:167], v[48:51]
v_mfma_f32_16x16x32_bf16 v[52:55], v[28:31], v[164:167], v[52:55]
v_mfma_f32_16x16x32_bf16 v[56:59], v[24:27], v[168:171], v[56:59]
v_mfma_f32_16x16x32_bf16 v[60:63], v[28:31], v[168:171], v[60:63]
v_mfma_f32_16x16x32_bf16 v[64:67], v[24:27], v[172:175], v[64:67]
v_mfma_f32_16x16x32_bf16 v[68:71], v[28:31], v[172:175], v[68:71]
s_nop 7
global_load_dwordx4 v[24:27], v116, s[36:37] offset:192
v_add_u32 v117, 8192, v116
global_load_dwordx4 v[28:31], v117, s[36:37] offset:192
s_waitcnt vmcnt(0)
v_mfma_f32_16x16x32_bf16 v[40:43], v[24:27], v[176:179], v[40:43]
v_mfma_f32_16x16x32_bf16 v[44:47], v[28:31], v[176:179], v[44:47]
v_mfma_f32_16x16x32_bf16 v[48:51], v[24:27], v[180:183], v[48:51]
v_mfma_f32_16x16x32_bf16 v[52:55], v[28:31], v[180:183], v[52:55]
v_mfma_f32_16x16x32_bf16 v[56:59], v[24:27], v[184:187], v[56:59]
v_mfma_f32_16x16x32_bf16 v[60:63], v[28:31], v[184:187], v[60:63]
v_mfma_f32_16x16x32_bf16 v[64:67], v[24:27], v[188:191], v[64:67]
v_mfma_f32_16x16x32_bf16 v[68:71], v[28:31], v[188:191], v[68:71]
s_nop 7
global_load_dwordx4 v[24:27], v116, s[36:37] offset:256
v_add_u32 v117, 8192, v116
global_load_dwordx4 v[28:31], v117, s[36:37] offset:256
s_waitcnt vmcnt(0)
v_mfma_f32_16x16x32_bf16 v[40:43], v[24:27], v[192:195], v[40:43]
v_mfma_f32_16x16x32_bf16 v[44:47], v[28:31], v[192:195], v[44:47]
v_mfma_f32_16x16x32_bf16 v[48:51], v[24:27], v[196:199], v[48:51]
v_mfma_f32_16x16x32_bf16 v[52:55], v[28:31], v[196:199], v[52:55]
v_mfma_f32_16x16x32_bf16 v[56:59], v[24:27], v[200:203], v[56:59]
v_mfma_f32_16x16x32_bf16 v[60:63], v[28:31], v[200:203], v[60:63]
v_mfma_f32_16x16x32_bf16 v[64:67], v[24:27], v[204:207], v[64:67]
v_mfma_f32_16x16x32_bf16 v[68:71], v[28:31], v[204:207], v[68:71]
s_nop 7
global_load_dwordx4 v[24:27], v116, s[36:37] offset:320
v_add_u32 v117, 8192, v116
global_load_dwordx4 v[28:31], v117, s[36:37] offset:320
s_waitcnt vmcnt(0)
v_mfma_f32_16x16x32_bf16 v[40:43], v[24:27], v[208:211], v[40:43]
v_mfma_f32_16x16x32_bf16 v[44:47], v[28:31], v[208:211], v[44:47]
v_mfma_f32_16x16x32_bf16 v[48:51], v[24:27], v[212:215], v[48:51]
v_mfma_f32_16x16x32_bf16 v[52:55], v[28:31], v[212:215], v[52:55]
v_mfma_f32_16x16x32_bf16 v[56:59], v[24:27], v[216:219], v[56:59]
v_mfma_f32_16x16x32_bf16 v[60:63], v[28:31], v[216:219], v[60:63]
v_mfma_f32_16x16x32_bf16 v[64:67], v[24:27], v[220:223], v[64:67]
v_mfma_f32_16x16x32_bf16 v[68:71], v[28:31], v[220:223], v[68:71]
s_nop 7
global_load_dwordx4 v[24:27], v116, s[36:37] offset:384
v_add_u32 v117, 8192, v116
global_load_dwordx4 v[28:31], v117, s[36:37] offset:384
s_waitcnt vmcnt(0)
v_mfma_f32_16x16x32_bf16 v[40:43], v[24:27], v[224:227], v[40:43]
v_mfma_f32_16x16x32_bf16 v[44:47], v[28:31], v[224:227], v[44:47]
v_mfma_f32_16x16x32_bf16 v[48:51], v[24:27], v[228:231], v[48:51]
v_mfma_f32_16x16x32_bf16 v[52:55], v[28:31], v[228:231], v[52:55]
v_mfma_f32_16x16x32_bf16 v[56:59], v[24:27], v[232:235], v[56:59]
v_mfma_f32_16x16x32_bf16 v[60:63], v[28:31], v[232:235], v[60:63]
v_mfma_f32_16x16x32_bf16 v[64:67], v[24:27], v[236:239], v[64:67]
v_mfma_f32_16x16x32_bf16 v[68:71], v[28:31], v[236:239], v[68:71]
s_nop 7
global_load_dwordx4 v[24:27], v116, s[36:37] offset:448
v_add_u32 v117, 8192, v116
global_load_dwordx4 v[28:31], v117, s[36:37] offset:448
s_waitcnt vmcnt(0)
v_mfma_f32_16x16x32_bf16 v[40:43], v[24:27], v[240:243], v[40:43]
v_mfma_f32_16x16x32_bf16 v[44:47], v[28:31], v[240:243], v[44:47]
v_mfma_f32_16x16x32_bf16 v[48:51], v[24:27], v[244:247], v[48:51]
v_mfma_f32_16x16x32_bf16 v[52:55], v[28:31], v[244:247], v[52:55]
v_mfma_f32_16x16x32_bf16 v[56:59], v[24:27], v[248:251], v[56:59]
v_mfma_f32_16x16x32_bf16 v[60:63], v[28:31], v[248:251], v[60:63]
v_mfma_f32_16x16x32_bf16 v[64:67], v[24:27], v[252:255], v[64:67]
v_mfma_f32_16x16x32_bf16 v[68:71], v[28:31], v[252:255], v[68:71]
s_nop 7
s_nop 7
v_max3_f32 v84, v40, v41, v42
v_max3_f32 v84, v84, v43, v44
v_max3_f32 v84, v84, v45, v46
v_max_f32 v84, v84, v47
v_max3_f32 v85, v48, v49, v50
v_max3_f32 v85, v85, v51, v52
v_max3_f32 v85, v85, v53, v54
v_max_f32 v85, v85, v55
v_max3_f32 v86, v56, v57, v58
v_max3_f32 v86, v86, v59, v60
v_max3_f32 v86, v86, v61, v62
v_max_f32 v86, v86, v63
v_max3_f32 v87, v64, v65, v66
v_max3_f32 v87, v87, v67, v68
v_max3_f32 v87, v87, v69, v70
v_max_f32 v87, v87, v71
v_mbcnt_lo_u32_b32 v116, -1, 0
v_mbcnt_hi_u32_b32 v116, -1, v116
v_xor_b32 v117, 32, v116
v_xor_b32 v116, 16, v116
v_lshlrev_b32 v117, 2, v117
v_lshlrev_b32 v116, 2, v116
ds_bpermute_b32 v90, v116, v84
ds_bpermute_b32 v91, v116, v85
ds_bpermute_b32 v92, v116, v86
ds_bpermute_b32 v93, v116, v87
s_waitcnt lgkmcnt(0)
v_max_f32 v84, v84, v90
v_max_f32 v85, v85, v91
v_max_f32 v86, v86, v92
v_max_f32 v87, v87, v93
ds_bpermute_b32 v90, v117, v84
ds_bpermute_b32 v91, v117, v85
ds_bpermute_b32 v92, v117, v86
ds_bpermute_b32 v93, v117, v87
s_waitcnt lgkmcnt(0)
v_max_f32 v84, v84, v90
v_max_f32 v85, v85, v91
v_max_f32 v86, v86, v92
v_max_f32 v87, v87, v93
v_max_f32 v84, 0, v84
v_max_f32 v85, 0, v85
v_max_f32 v86, 0, v86
v_max_f32 v87, 0, v87
v_sub_f32 v90, 0, v84
v_sub_f32 v91, 0, v85
v_sub_f32 v92, 0, v86
v_sub_f32 v93, 0, v87
v_exp_f32 v90, v90
v_exp_f32 v91, v91
v_exp_f32 v92, v92
v_exp_f32 v93, v93
s_nop 0
v_sub_f32 v100, v100, v84
v_sub_f32 v101, v101, v84
v_sub_f32 v102, v102, v84
v_sub_f32 v103, v103, v84
v_mul_f32 v120, v120, v90
v_accvgpr_read_b32 v116, a0
v_mul_f32 v116, v116, v90
v_accvgpr_write_b32 a0, v116
v_accvgpr_read_b32 v116, a1
v_mul_f32 v116, v116, v90
v_accvgpr_write_b32 a1, v116
v_accvgpr_read_b32 v116, a2
v_mul_f32 v116, v116, v90
v_accvgpr_write_b32 a2, v116
v_accvgpr_read_b32 v116, a3
v_mul_f32 v116, v116, v90
v_accvgpr_write_b32 a3, v116
v_accvgpr_read_b32 v116, a16
v_mul_f32 v116, v116, v90
v_accvgpr_write_b32 a16, v116
v_accvgpr_read_b32 v116, a17
v_mul_f32 v116, v116, v90
v_accvgpr_write_b32 a17, v116
v_accvgpr_read_b32 v116, a18
v_mul_f32 v116, v116, v90
v_accvgpr_write_b32 a18, v116
v_accvgpr_read_b32 v116, a19
v_mul_f32 v116, v116, v90
v_accvgpr_write_b32 a19, v116
v_accvgpr_read_b32 v116, a32
v_mul_f32 v116, v116, v90
v_accvgpr_write_b32 a32, v116
v_accvgpr_read_b32 v116, a33
v_mul_f32 v116, v116, v90
v_accvgpr_write_b32 a33, v116
v_accvgpr_read_b32 v116, a34
v_mul_f32 v116, v116, v90
v_accvgpr_write_b32 a34, v116
v_accvgpr_read_b32 v116, a35
v_mul_f32 v116, v116, v90
v_accvgpr_write_b32 a35, v116
v_accvgpr_read_b32 v116, a48
v_mul_f32 v116, v116, v90
v_accvgpr_write_b32 a48, v116
v_accvgpr_read_b32 v116, a49
v_mul_f32 v116, v116, v90
v_accvgpr_write_b32 a49, v116
v_accvgpr_read_b32 v116, a50
v_mul_f32 v116, v116, v90
v_accvgpr_write_b32 a50, v116
v_accvgpr_read_b32 v116, a51
v_mul_f32 v116, v116, v90
v_accvgpr_write_b32 a51, v116
v_accvgpr_read_b32 v116, a64
v_mul_f32 v116, v116, v90
v_accvgpr_write_b32 a64, v116
v_accvgpr_read_b32 v116, a65
v_mul_f32 v116, v116, v90
v_accvgpr_write_b32 a65, v116
v_accvgpr_read_b32 v116, a66
v_mul_f32 v116, v116, v90
v_accvgpr_write_b32 a66, v116
v_accvgpr_read_b32 v116, a67
v_mul_f32 v116, v116, v90
v_accvgpr_write_b32 a67, v116
v_accvgpr_read_b32 v116, a80
v_mul_f32 v116, v116, v90
v_accvgpr_write_b32 a80, v116
v_accvgpr_read_b32 v116, a81
v_mul_f32 v116, v116, v90
v_accvgpr_write_b32 a81, v116
v_accvgpr_read_b32 v116, a82
v_mul_f32 v116, v116, v90
v_accvgpr_write_b32 a82, v116
v_accvgpr_read_b32 v116, a83
v_mul_f32 v116, v116, v90
v_accvgpr_write_b32 a83, v116
v_accvgpr_read_b32 v116, a96
v_mul_f32 v116, v116, v90
v_accvgpr_write_b32 a96, v116
v_accvgpr_read_b32 v116, a97
v_mul_f32 v116, v116, v90
v_accvgpr_write_b32 a97, v116
v_accvgpr_read_b32 v116, a98
v_mul_f32 v116, v116, v90
v_accvgpr_write_b32 a98, v116
v_accvgpr_read_b32 v116, a99
v_mul_f32 v116, v116, v90
v_accvgpr_write_b32 a99, v116
v_accvgpr_read_b32 v116, a112
v_mul_f32 v116, v116, v90
v_accvgpr_write_b32 a112, v116
v_accvgpr_read_b32 v116, a113
v_mul_f32 v116, v116, v90
v_accvgpr_write_b32 a113, v116
v_accvgpr_read_b32 v116, a114
v_mul_f32 v116, v116, v90
v_accvgpr_write_b32 a114, v116
v_accvgpr_read_b32 v116, a115
v_mul_f32 v116, v116, v90
v_accvgpr_write_b32 a115, v116
v_accvgpr_read_b32 v116, a128
v_mul_f32 v116, v116, v90
v_accvgpr_write_b32 a128, v116
v_accvgpr_read_b32 v116, a129
v_mul_f32 v116, v116, v90
v_accvgpr_write_b32 a129, v116
v_accvgpr_read_b32 v116, a130
v_mul_f32 v116, v116, v90
v_accvgpr_write_b32 a130, v116
v_accvgpr_read_b32 v116, a131
v_mul_f32 v116, v116, v90
v_accvgpr_write_b32 a131, v116
v_accvgpr_read_b32 v116, a144
v_mul_f32 v116, v116, v90
v_accvgpr_write_b32 a144, v116
v_accvgpr_read_b32 v116, a145
v_mul_f32 v116, v116, v90
v_accvgpr_write_b32 a145, v116
v_accvgpr_read_b32 v116, a146
v_mul_f32 v116, v116, v90
v_accvgpr_write_b32 a146, v116
v_accvgpr_read_b32 v116, a147
v_mul_f32 v116, v116, v90
v_accvgpr_write_b32 a147, v116
v_accvgpr_read_b32 v116, a160
v_mul_f32 v116, v116, v90
v_accvgpr_write_b32 a160, v116
v_accvgpr_read_b32 v116, a161
v_mul_f32 v116, v116, v90
v_accvgpr_write_b32 a161, v116
v_accvgpr_read_b32 v116, a162
v_mul_f32 v116, v116, v90
v_accvgpr_write_b32 a162, v116
v_accvgpr_read_b32 v116, a163
v_mul_f32 v116, v116, v90
v_accvgpr_write_b32 a163, v116
v_accvgpr_read_b32 v116, a176
v_mul_f32 v116, v116, v90
v_accvgpr_write_b32 a176, v116
v_accvgpr_read_b32 v116, a177
v_mul_f32 v116, v116, v90
v_accvgpr_write_b32 a177, v116
v_accvgpr_read_b32 v116, a178
v_mul_f32 v116, v116, v90
v_accvgpr_write_b32 a178, v116
v_accvgpr_read_b32 v116, a179
v_mul_f32 v116, v116, v90
v_accvgpr_write_b32 a179, v116
v_accvgpr_read_b32 v116, a192
v_mul_f32 v116, v116, v90
v_accvgpr_write_b32 a192, v116
v_accvgpr_read_b32 v116, a193
v_mul_f32 v116, v116, v90
v_accvgpr_write_b32 a193, v116
v_accvgpr_read_b32 v116, a194
v_mul_f32 v116, v116, v90
v_accvgpr_write_b32 a194, v116
v_accvgpr_read_b32 v116, a195
v_mul_f32 v116, v116, v90
v_accvgpr_write_b32 a195, v116
v_accvgpr_read_b32 v116, a208
v_mul_f32 v116, v116, v90
v_accvgpr_write_b32 a208, v116
v_accvgpr_read_b32 v116, a209
v_mul_f32 v116, v116, v90
v_accvgpr_write_b32 a209, v116
v_accvgpr_read_b32 v116, a210
v_mul_f32 v116, v116, v90
v_accvgpr_write_b32 a210, v116
v_accvgpr_read_b32 v116, a211
v_mul_f32 v116, v116, v90
v_accvgpr_write_b32 a211, v116
v_accvgpr_read_b32 v116, a224
v_mul_f32 v116, v116, v90
v_accvgpr_write_b32 a224, v116
v_accvgpr_read_b32 v116, a225
v_mul_f32 v116, v116, v90
v_accvgpr_write_b32 a225, v116
v_accvgpr_read_b32 v116, a226
v_mul_f32 v116, v116, v90
v_accvgpr_write_b32 a226, v116
v_accvgpr_read_b32 v116, a227
v_mul_f32 v116, v116, v90
v_accvgpr_write_b32 a227, v116
v_accvgpr_read_b32 v116, a240
v_mul_f32 v116, v116, v90
v_accvgpr_write_b32 a240, v116
v_accvgpr_read_b32 v116, a241
v_mul_f32 v116, v116, v90
v_accvgpr_write_b32 a241, v116
v_accvgpr_read_b32 v116, a242
v_mul_f32 v116, v116, v90
v_accvgpr_write_b32 a242, v116
v_accvgpr_read_b32 v116, a243
v_mul_f32 v116, v116, v90
v_accvgpr_write_b32 a243, v116
v_sub_f32 v104, v104, v85
v_sub_f32 v105, v105, v85
v_sub_f32 v106, v106, v85
v_sub_f32 v107, v107, v85
v_mul_f32 v121, v121, v91
v_accvgpr_read_b32 v116, a4
v_mul_f32 v116, v116, v91
v_accvgpr_write_b32 a4, v116
v_accvgpr_read_b32 v116, a5
v_mul_f32 v116, v116, v91
v_accvgpr_write_b32 a5, v116
v_accvgpr_read_b32 v116, a6
v_mul_f32 v116, v116, v91
v_accvgpr_write_b32 a6, v116
v_accvgpr_read_b32 v116, a7
v_mul_f32 v116, v116, v91
v_accvgpr_write_b32 a7, v116
v_accvgpr_read_b32 v116, a20
v_mul_f32 v116, v116, v91
v_accvgpr_write_b32 a20, v116
v_accvgpr_read_b32 v116, a21
v_mul_f32 v116, v116, v91
v_accvgpr_write_b32 a21, v116
v_accvgpr_read_b32 v116, a22
v_mul_f32 v116, v116, v91
v_accvgpr_write_b32 a22, v116
v_accvgpr_read_b32 v116, a23
v_mul_f32 v116, v116, v91
v_accvgpr_write_b32 a23, v116
v_accvgpr_read_b32 v116, a36
v_mul_f32 v116, v116, v91
v_accvgpr_write_b32 a36, v116
v_accvgpr_read_b32 v116, a37
v_mul_f32 v116, v116, v91
v_accvgpr_write_b32 a37, v116
v_accvgpr_read_b32 v116, a38
v_mul_f32 v116, v116, v91
v_accvgpr_write_b32 a38, v116
v_accvgpr_read_b32 v116, a39
v_mul_f32 v116, v116, v91
v_accvgpr_write_b32 a39, v116
v_accvgpr_read_b32 v116, a52
v_mul_f32 v116, v116, v91
v_accvgpr_write_b32 a52, v116
v_accvgpr_read_b32 v116, a53
v_mul_f32 v116, v116, v91
v_accvgpr_write_b32 a53, v116
v_accvgpr_read_b32 v116, a54
v_mul_f32 v116, v116, v91
v_accvgpr_write_b32 a54, v116
v_accvgpr_read_b32 v116, a55
v_mul_f32 v116, v116, v91
v_accvgpr_write_b32 a55, v116
v_accvgpr_read_b32 v116, a68
v_mul_f32 v116, v116, v91
v_accvgpr_write_b32 a68, v116
v_accvgpr_read_b32 v116, a69
v_mul_f32 v116, v116, v91
v_accvgpr_write_b32 a69, v116
v_accvgpr_read_b32 v116, a70
v_mul_f32 v116, v116, v91
v_accvgpr_write_b32 a70, v116
v_accvgpr_read_b32 v116, a71
v_mul_f32 v116, v116, v91
v_accvgpr_write_b32 a71, v116
v_accvgpr_read_b32 v116, a84
v_mul_f32 v116, v116, v91
v_accvgpr_write_b32 a84, v116
v_accvgpr_read_b32 v116, a85
v_mul_f32 v116, v116, v91
v_accvgpr_write_b32 a85, v116
v_accvgpr_read_b32 v116, a86
v_mul_f32 v116, v116, v91
v_accvgpr_write_b32 a86, v116
v_accvgpr_read_b32 v116, a87
v_mul_f32 v116, v116, v91
v_accvgpr_write_b32 a87, v116
v_accvgpr_read_b32 v116, a100
v_mul_f32 v116, v116, v91
v_accvgpr_write_b32 a100, v116
v_accvgpr_read_b32 v116, a101
v_mul_f32 v116, v116, v91
v_accvgpr_write_b32 a101, v116
v_accvgpr_read_b32 v116, a102
v_mul_f32 v116, v116, v91
v_accvgpr_write_b32 a102, v116
v_accvgpr_read_b32 v116, a103
v_mul_f32 v116, v116, v91
v_accvgpr_write_b32 a103, v116
v_accvgpr_read_b32 v116, a116
v_mul_f32 v116, v116, v91
v_accvgpr_write_b32 a116, v116
v_accvgpr_read_b32 v116, a117
v_mul_f32 v116, v116, v91
v_accvgpr_write_b32 a117, v116
v_accvgpr_read_b32 v116, a118
v_mul_f32 v116, v116, v91
v_accvgpr_write_b32 a118, v116
v_accvgpr_read_b32 v116, a119
v_mul_f32 v116, v116, v91
v_accvgpr_write_b32 a119, v116
v_accvgpr_read_b32 v116, a132
v_mul_f32 v116, v116, v91
v_accvgpr_write_b32 a132, v116
v_accvgpr_read_b32 v116, a133
v_mul_f32 v116, v116, v91
v_accvgpr_write_b32 a133, v116
v_accvgpr_read_b32 v116, a134
v_mul_f32 v116, v116, v91
v_accvgpr_write_b32 a134, v116
v_accvgpr_read_b32 v116, a135
v_mul_f32 v116, v116, v91
v_accvgpr_write_b32 a135, v116
v_accvgpr_read_b32 v116, a148
v_mul_f32 v116, v116, v91
v_accvgpr_write_b32 a148, v116
v_accvgpr_read_b32 v116, a149
v_mul_f32 v116, v116, v91
v_accvgpr_write_b32 a149, v116
v_accvgpr_read_b32 v116, a150
v_mul_f32 v116, v116, v91
v_accvgpr_write_b32 a150, v116
v_accvgpr_read_b32 v116, a151
v_mul_f32 v116, v116, v91
v_accvgpr_write_b32 a151, v116
v_accvgpr_read_b32 v116, a164
v_mul_f32 v116, v116, v91
v_accvgpr_write_b32 a164, v116
v_accvgpr_read_b32 v116, a165
v_mul_f32 v116, v116, v91
v_accvgpr_write_b32 a165, v116
v_accvgpr_read_b32 v116, a166
v_mul_f32 v116, v116, v91
v_accvgpr_write_b32 a166, v116
v_accvgpr_read_b32 v116, a167
v_mul_f32 v116, v116, v91
v_accvgpr_write_b32 a167, v116
v_accvgpr_read_b32 v116, a180
v_mul_f32 v116, v116, v91
v_accvgpr_write_b32 a180, v116
v_accvgpr_read_b32 v116, a181
v_mul_f32 v116, v116, v91
v_accvgpr_write_b32 a181, v116
v_accvgpr_read_b32 v116, a182
v_mul_f32 v116, v116, v91
v_accvgpr_write_b32 a182, v116
v_accvgpr_read_b32 v116, a183
v_mul_f32 v116, v116, v91
v_accvgpr_write_b32 a183, v116
v_accvgpr_read_b32 v116, a196
v_mul_f32 v116, v116, v91
v_accvgpr_write_b32 a196, v116
v_accvgpr_read_b32 v116, a197
v_mul_f32 v116, v116, v91
v_accvgpr_write_b32 a197, v116
v_accvgpr_read_b32 v116, a198
v_mul_f32 v116, v116, v91
v_accvgpr_write_b32 a198, v116
v_accvgpr_read_b32 v116, a199
v_mul_f32 v116, v116, v91
v_accvgpr_write_b32 a199, v116
v_accvgpr_read_b32 v116, a212
v_mul_f32 v116, v116, v91
v_accvgpr_write_b32 a212, v116
v_accvgpr_read_b32 v116, a213
v_mul_f32 v116, v116, v91
v_accvgpr_write_b32 a213, v116
v_accvgpr_read_b32 v116, a214
v_mul_f32 v116, v116, v91
v_accvgpr_write_b32 a214, v116
v_accvgpr_read_b32 v116, a215
v_mul_f32 v116, v116, v91
v_accvgpr_write_b32 a215, v116
v_accvgpr_read_b32 v116, a228
v_mul_f32 v116, v116, v91
v_accvgpr_write_b32 a228, v116
v_accvgpr_read_b32 v116, a229
v_mul_f32 v116, v116, v91
v_accvgpr_write_b32 a229, v116
v_accvgpr_read_b32 v116, a230
v_mul_f32 v116, v116, v91
v_accvgpr_write_b32 a230, v116
v_accvgpr_read_b32 v116, a231
v_mul_f32 v116, v116, v91
v_accvgpr_write_b32 a231, v116
v_accvgpr_read_b32 v116, a244
v_mul_f32 v116, v116, v91
v_accvgpr_write_b32 a244, v116
v_accvgpr_read_b32 v116, a245
v_mul_f32 v116, v116, v91
v_accvgpr_write_b32 a245, v116
v_accvgpr_read_b32 v116, a246
v_mul_f32 v116, v116, v91
v_accvgpr_write_b32 a246, v116
v_accvgpr_read_b32 v116, a247
v_mul_f32 v116, v116, v91
v_accvgpr_write_b32 a247, v116
v_sub_f32 v108, v108, v86
v_sub_f32 v109, v109, v86
v_sub_f32 v110, v110, v86
v_sub_f32 v111, v111, v86
v_mul_f32 v122, v122, v92
v_accvgpr_read_b32 v116, a8
v_mul_f32 v116, v116, v92
v_accvgpr_write_b32 a8, v116
v_accvgpr_read_b32 v116, a9
v_mul_f32 v116, v116, v92
v_accvgpr_write_b32 a9, v116
v_accvgpr_read_b32 v116, a10
v_mul_f32 v116, v116, v92
v_accvgpr_write_b32 a10, v116
v_accvgpr_read_b32 v116, a11
v_mul_f32 v116, v116, v92
v_accvgpr_write_b32 a11, v116
v_accvgpr_read_b32 v116, a24
v_mul_f32 v116, v116, v92
v_accvgpr_write_b32 a24, v116
v_accvgpr_read_b32 v116, a25
v_mul_f32 v116, v116, v92
v_accvgpr_write_b32 a25, v116
v_accvgpr_read_b32 v116, a26
v_mul_f32 v116, v116, v92
v_accvgpr_write_b32 a26, v116
v_accvgpr_read_b32 v116, a27
v_mul_f32 v116, v116, v92
v_accvgpr_write_b32 a27, v116
v_accvgpr_read_b32 v116, a40
v_mul_f32 v116, v116, v92
v_accvgpr_write_b32 a40, v116
v_accvgpr_read_b32 v116, a41
v_mul_f32 v116, v116, v92
v_accvgpr_write_b32 a41, v116
v_accvgpr_read_b32 v116, a42
v_mul_f32 v116, v116, v92
v_accvgpr_write_b32 a42, v116
v_accvgpr_read_b32 v116, a43
v_mul_f32 v116, v116, v92
v_accvgpr_write_b32 a43, v116
v_accvgpr_read_b32 v116, a56
v_mul_f32 v116, v116, v92
v_accvgpr_write_b32 a56, v116
v_accvgpr_read_b32 v116, a57
v_mul_f32 v116, v116, v92
v_accvgpr_write_b32 a57, v116
v_accvgpr_read_b32 v116, a58
v_mul_f32 v116, v116, v92
v_accvgpr_write_b32 a58, v116
v_accvgpr_read_b32 v116, a59
v_mul_f32 v116, v116, v92
v_accvgpr_write_b32 a59, v116
v_accvgpr_read_b32 v116, a72
v_mul_f32 v116, v116, v92
v_accvgpr_write_b32 a72, v116
v_accvgpr_read_b32 v116, a73
v_mul_f32 v116, v116, v92
v_accvgpr_write_b32 a73, v116
v_accvgpr_read_b32 v116, a74
v_mul_f32 v116, v116, v92
v_accvgpr_write_b32 a74, v116
v_accvgpr_read_b32 v116, a75
v_mul_f32 v116, v116, v92
v_accvgpr_write_b32 a75, v116
v_accvgpr_read_b32 v116, a88
v_mul_f32 v116, v116, v92
v_accvgpr_write_b32 a88, v116
v_accvgpr_read_b32 v116, a89
v_mul_f32 v116, v116, v92
v_accvgpr_write_b32 a89, v116
v_accvgpr_read_b32 v116, a90
v_mul_f32 v116, v116, v92
v_accvgpr_write_b32 a90, v116
v_accvgpr_read_b32 v116, a91
v_mul_f32 v116, v116, v92
v_accvgpr_write_b32 a91, v116
v_accvgpr_read_b32 v116, a104
v_mul_f32 v116, v116, v92
v_accvgpr_write_b32 a104, v116
v_accvgpr_read_b32 v116, a105
v_mul_f32 v116, v116, v92
v_accvgpr_write_b32 a105, v116
v_accvgpr_read_b32 v116, a106
v_mul_f32 v116, v116, v92
v_accvgpr_write_b32 a106, v116
v_accvgpr_read_b32 v116, a107
v_mul_f32 v116, v116, v92
v_accvgpr_write_b32 a107, v116
v_accvgpr_read_b32 v116, a120
v_mul_f32 v116, v116, v92
v_accvgpr_write_b32 a120, v116
v_accvgpr_read_b32 v116, a121
v_mul_f32 v116, v116, v92
v_accvgpr_write_b32 a121, v116
v_accvgpr_read_b32 v116, a122
v_mul_f32 v116, v116, v92
v_accvgpr_write_b32 a122, v116
v_accvgpr_read_b32 v116, a123
v_mul_f32 v116, v116, v92
v_accvgpr_write_b32 a123, v116
v_accvgpr_read_b32 v116, a136
v_mul_f32 v116, v116, v92
v_accvgpr_write_b32 a136, v116
v_accvgpr_read_b32 v116, a137
v_mul_f32 v116, v116, v92
v_accvgpr_write_b32 a137, v116
v_accvgpr_read_b32 v116, a138
v_mul_f32 v116, v116, v92
v_accvgpr_write_b32 a138, v116
v_accvgpr_read_b32 v116, a139
v_mul_f32 v116, v116, v92
v_accvgpr_write_b32 a139, v116
v_accvgpr_read_b32 v116, a152
v_mul_f32 v116, v116, v92
v_accvgpr_write_b32 a152, v116
v_accvgpr_read_b32 v116, a153
v_mul_f32 v116, v116, v92
v_accvgpr_write_b32 a153, v116
v_accvgpr_read_b32 v116, a154
v_mul_f32 v116, v116, v92
v_accvgpr_write_b32 a154, v116
v_accvgpr_read_b32 v116, a155
v_mul_f32 v116, v116, v92
v_accvgpr_write_b32 a155, v116
v_accvgpr_read_b32 v116, a168
v_mul_f32 v116, v116, v92
v_accvgpr_write_b32 a168, v116
v_accvgpr_read_b32 v116, a169
v_mul_f32 v116, v116, v92
v_accvgpr_write_b32 a169, v116
v_accvgpr_read_b32 v116, a170
v_mul_f32 v116, v116, v92
v_accvgpr_write_b32 a170, v116
v_accvgpr_read_b32 v116, a171
v_mul_f32 v116, v116, v92
v_accvgpr_write_b32 a171, v116
v_accvgpr_read_b32 v116, a184
v_mul_f32 v116, v116, v92
v_accvgpr_write_b32 a184, v116
v_accvgpr_read_b32 v116, a185
v_mul_f32 v116, v116, v92
v_accvgpr_write_b32 a185, v116
v_accvgpr_read_b32 v116, a186
v_mul_f32 v116, v116, v92
v_accvgpr_write_b32 a186, v116
v_accvgpr_read_b32 v116, a187
v_mul_f32 v116, v116, v92
v_accvgpr_write_b32 a187, v116
v_accvgpr_read_b32 v116, a200
v_mul_f32 v116, v116, v92
v_accvgpr_write_b32 a200, v116
v_accvgpr_read_b32 v116, a201
v_mul_f32 v116, v116, v92
v_accvgpr_write_b32 a201, v116
v_accvgpr_read_b32 v116, a202
v_mul_f32 v116, v116, v92
v_accvgpr_write_b32 a202, v116
v_accvgpr_read_b32 v116, a203
v_mul_f32 v116, v116, v92
v_accvgpr_write_b32 a203, v116
v_accvgpr_read_b32 v116, a216
v_mul_f32 v116, v116, v92
v_accvgpr_write_b32 a216, v116
v_accvgpr_read_b32 v116, a217
v_mul_f32 v116, v116, v92
v_accvgpr_write_b32 a217, v116
v_accvgpr_read_b32 v116, a218
v_mul_f32 v116, v116, v92
v_accvgpr_write_b32 a218, v116
v_accvgpr_read_b32 v116, a219
v_mul_f32 v116, v116, v92
v_accvgpr_write_b32 a219, v116
v_accvgpr_read_b32 v116, a232
v_mul_f32 v116, v116, v92
v_accvgpr_write_b32 a232, v116
v_accvgpr_read_b32 v116, a233
v_mul_f32 v116, v116, v92
v_accvgpr_write_b32 a233, v116
v_accvgpr_read_b32 v116, a234
v_mul_f32 v116, v116, v92
v_accvgpr_write_b32 a234, v116
v_accvgpr_read_b32 v116, a235
v_mul_f32 v116, v116, v92
v_accvgpr_write_b32 a235, v116
v_accvgpr_read_b32 v116, a248
v_mul_f32 v116, v116, v92
v_accvgpr_write_b32 a248, v116
v_accvgpr_read_b32 v116, a249
v_mul_f32 v116, v116, v92
v_accvgpr_write_b32 a249, v116
v_accvgpr_read_b32 v116, a250
v_mul_f32 v116, v116, v92
v_accvgpr_write_b32 a250, v116
v_accvgpr_read_b32 v116, a251
v_mul_f32 v116, v116, v92
v_accvgpr_write_b32 a251, v116
v_sub_f32 v112, v112, v87
v_sub_f32 v113, v113, v87
v_sub_f32 v114, v114, v87
v_sub_f32 v115, v115, v87
v_mul_f32 v123, v123, v93
v_accvgpr_read_b32 v116, a12
v_mul_f32 v116, v116, v93
v_accvgpr_write_b32 a12, v116
v_accvgpr_read_b32 v116, a13
v_mul_f32 v116, v116, v93
v_accvgpr_write_b32 a13, v116
v_accvgpr_read_b32 v116, a14
v_mul_f32 v116, v116, v93
v_accvgpr_write_b32 a14, v116
v_accvgpr_read_b32 v116, a15
v_mul_f32 v116, v116, v93
v_accvgpr_write_b32 a15, v116
v_accvgpr_read_b32 v116, a28
v_mul_f32 v116, v116, v93
v_accvgpr_write_b32 a28, v116
v_accvgpr_read_b32 v116, a29
v_mul_f32 v116, v116, v93
v_accvgpr_write_b32 a29, v116
v_accvgpr_read_b32 v116, a30
v_mul_f32 v116, v116, v93
v_accvgpr_write_b32 a30, v116
v_accvgpr_read_b32 v116, a31
v_mul_f32 v116, v116, v93
v_accvgpr_write_b32 a31, v116
v_accvgpr_read_b32 v116, a44
v_mul_f32 v116, v116, v93
v_accvgpr_write_b32 a44, v116
v_accvgpr_read_b32 v116, a45
v_mul_f32 v116, v116, v93
v_accvgpr_write_b32 a45, v116
v_accvgpr_read_b32 v116, a46
v_mul_f32 v116, v116, v93
v_accvgpr_write_b32 a46, v116
v_accvgpr_read_b32 v116, a47
v_mul_f32 v116, v116, v93
v_accvgpr_write_b32 a47, v116
v_accvgpr_read_b32 v116, a60
v_mul_f32 v116, v116, v93
v_accvgpr_write_b32 a60, v116
v_accvgpr_read_b32 v116, a61
v_mul_f32 v116, v116, v93
v_accvgpr_write_b32 a61, v116
v_accvgpr_read_b32 v116, a62
v_mul_f32 v116, v116, v93
v_accvgpr_write_b32 a62, v116
v_accvgpr_read_b32 v116, a63
v_mul_f32 v116, v116, v93
v_accvgpr_write_b32 a63, v116
v_accvgpr_read_b32 v116, a76
v_mul_f32 v116, v116, v93
v_accvgpr_write_b32 a76, v116
v_accvgpr_read_b32 v116, a77
v_mul_f32 v116, v116, v93
v_accvgpr_write_b32 a77, v116
v_accvgpr_read_b32 v116, a78
v_mul_f32 v116, v116, v93
v_accvgpr_write_b32 a78, v116
v_accvgpr_read_b32 v116, a79
v_mul_f32 v116, v116, v93
v_accvgpr_write_b32 a79, v116
v_accvgpr_read_b32 v116, a92
v_mul_f32 v116, v116, v93
v_accvgpr_write_b32 a92, v116
v_accvgpr_read_b32 v116, a93
v_mul_f32 v116, v116, v93
v_accvgpr_write_b32 a93, v116
v_accvgpr_read_b32 v116, a94
v_mul_f32 v116, v116, v93
v_accvgpr_write_b32 a94, v116
v_accvgpr_read_b32 v116, a95
v_mul_f32 v116, v116, v93
v_accvgpr_write_b32 a95, v116
v_accvgpr_read_b32 v116, a108
v_mul_f32 v116, v116, v93
v_accvgpr_write_b32 a108, v116
v_accvgpr_read_b32 v116, a109
v_mul_f32 v116, v116, v93
v_accvgpr_write_b32 a109, v116
v_accvgpr_read_b32 v116, a110
v_mul_f32 v116, v116, v93
v_accvgpr_write_b32 a110, v116
v_accvgpr_read_b32 v116, a111
v_mul_f32 v116, v116, v93
v_accvgpr_write_b32 a111, v116
v_accvgpr_read_b32 v116, a124
v_mul_f32 v116, v116, v93
v_accvgpr_write_b32 a124, v116
v_accvgpr_read_b32 v116, a125
v_mul_f32 v116, v116, v93
v_accvgpr_write_b32 a125, v116
v_accvgpr_read_b32 v116, a126
v_mul_f32 v116, v116, v93
v_accvgpr_write_b32 a126, v116
v_accvgpr_read_b32 v116, a127
v_mul_f32 v116, v116, v93
v_accvgpr_write_b32 a127, v116
v_accvgpr_read_b32 v116, a140
v_mul_f32 v116, v116, v93
v_accvgpr_write_b32 a140, v116
v_accvgpr_read_b32 v116, a141
v_mul_f32 v116, v116, v93
v_accvgpr_write_b32 a141, v116
v_accvgpr_read_b32 v116, a142
v_mul_f32 v116, v116, v93
v_accvgpr_write_b32 a142, v116
v_accvgpr_read_b32 v116, a143
v_mul_f32 v116, v116, v93
v_accvgpr_write_b32 a143, v116
v_accvgpr_read_b32 v116, a156
v_mul_f32 v116, v116, v93
v_accvgpr_write_b32 a156, v116
v_accvgpr_read_b32 v116, a157
v_mul_f32 v116, v116, v93
v_accvgpr_write_b32 a157, v116
v_accvgpr_read_b32 v116, a158
v_mul_f32 v116, v116, v93
v_accvgpr_write_b32 a158, v116
v_accvgpr_read_b32 v116, a159
v_mul_f32 v116, v116, v93
v_accvgpr_write_b32 a159, v116
v_accvgpr_read_b32 v116, a172
v_mul_f32 v116, v116, v93
v_accvgpr_write_b32 a172, v116
v_accvgpr_read_b32 v116, a173
v_mul_f32 v116, v116, v93
v_accvgpr_write_b32 a173, v116
v_accvgpr_read_b32 v116, a174
v_mul_f32 v116, v116, v93
v_accvgpr_write_b32 a174, v116
v_accvgpr_read_b32 v116, a175
v_mul_f32 v116, v116, v93
v_accvgpr_write_b32 a175, v116
v_accvgpr_read_b32 v116, a188
v_mul_f32 v116, v116, v93
v_accvgpr_write_b32 a188, v116
v_accvgpr_read_b32 v116, a189
v_mul_f32 v116, v116, v93
v_accvgpr_write_b32 a189, v116
v_accvgpr_read_b32 v116, a190
v_mul_f32 v116, v116, v93
v_accvgpr_write_b32 a190, v116
v_accvgpr_read_b32 v116, a191
v_mul_f32 v116, v116, v93
v_accvgpr_write_b32 a191, v116
v_accvgpr_read_b32 v116, a204
v_mul_f32 v116, v116, v93
v_accvgpr_write_b32 a204, v116
v_accvgpr_read_b32 v116, a205
v_mul_f32 v116, v116, v93
v_accvgpr_write_b32 a205, v116
v_accvgpr_read_b32 v116, a206
v_mul_f32 v116, v116, v93
v_accvgpr_write_b32 a206, v116
v_accvgpr_read_b32 v116, a207
v_mul_f32 v116, v116, v93
v_accvgpr_write_b32 a207, v116
v_accvgpr_read_b32 v116, a220
v_mul_f32 v116, v116, v93
v_accvgpr_write_b32 a220, v116
v_accvgpr_read_b32 v116, a221
v_mul_f32 v116, v116, v93
v_accvgpr_write_b32 a221, v116
v_accvgpr_read_b32 v116, a222
v_mul_f32 v116, v116, v93
v_accvgpr_write_b32 a222, v116
v_accvgpr_read_b32 v116, a223
v_mul_f32 v116, v116, v93
v_accvgpr_write_b32 a223, v116
v_accvgpr_read_b32 v116, a236
v_mul_f32 v116, v116, v93
v_accvgpr_write_b32 a236, v116
v_accvgpr_read_b32 v116, a237
v_mul_f32 v116, v116, v93
v_accvgpr_write_b32 a237, v116
v_accvgpr_read_b32 v116, a238
v_mul_f32 v116, v116, v93
v_accvgpr_write_b32 a238, v116
v_accvgpr_read_b32 v116, a239
v_mul_f32 v116, v116, v93
v_accvgpr_write_b32 a239, v116
v_accvgpr_read_b32 v116, a252
v_mul_f32 v116, v116, v93
v_accvgpr_write_b32 a252, v116
v_accvgpr_read_b32 v116, a253
v_mul_f32 v116, v116, v93
v_accvgpr_write_b32 a253, v116
v_accvgpr_read_b32 v116, a254
v_mul_f32 v116, v116, v93
v_accvgpr_write_b32 a254, v116
v_accvgpr_read_b32 v116, a255
v_mul_f32 v116, v116, v93
v_accvgpr_write_b32 a255, v116
v_sub_f32 v40, v40, v84
v_sub_f32 v41, v41, v84
v_sub_f32 v42, v42, v84
v_sub_f32 v43, v43, v84
v_sub_f32 v44, v44, v84
v_sub_f32 v45, v45, v84
v_sub_f32 v46, v46, v84
v_sub_f32 v47, v47, v84
v_sub_f32 v48, v48, v85
v_sub_f32 v49, v49, v85
v_sub_f32 v50, v50, v85
v_sub_f32 v51, v51, v85
v_sub_f32 v52, v52, v85
v_sub_f32 v53, v53, v85
v_sub_f32 v54, v54, v85
v_sub_f32 v55, v55, v85
v_sub_f32 v56, v56, v86
v_sub_f32 v57, v57, v86
v_sub_f32 v58, v58, v86
v_sub_f32 v59, v59, v86
v_sub_f32 v60, v60, v86
v_sub_f32 v61, v61, v86
v_sub_f32 v62, v62, v86
v_sub_f32 v63, v63, v86
v_sub_f32 v64, v64, v87
v_sub_f32 v65, v65, v87
v_sub_f32 v66, v66, v87
v_sub_f32 v67, v67, v87
v_sub_f32 v68, v68, v87
v_sub_f32 v69, v69, v87
v_sub_f32 v70, v70, v87
v_sub_f32 v71, v71, v87
v_exp_f32 v40, v40
v_exp_f32 v41, v41
v_exp_f32 v42, v42
v_exp_f32 v43, v43
v_exp_f32 v44, v44
v_exp_f32 v45, v45
v_exp_f32 v46, v46
v_exp_f32 v47, v47
v_exp_f32 v48, v48
v_exp_f32 v49, v49
v_exp_f32 v50, v50
v_exp_f32 v51, v51
v_exp_f32 v52, v52
v_exp_f32 v53, v53
v_exp_f32 v54, v54
v_exp_f32 v55, v55
v_exp_f32 v56, v56
v_exp_f32 v57, v57
v_exp_f32 v58, v58
v_exp_f32 v59, v59
v_exp_f32 v60, v60
v_exp_f32 v61, v61
v_exp_f32 v62, v62
v_exp_f32 v63, v63
v_exp_f32 v64, v64
v_exp_f32 v65, v65
v_exp_f32 v66, v66
v_exp_f32 v67, v67
v_exp_f32 v68, v68
v_exp_f32 v69, v69
v_exp_f32 v70, v70
v_exp_f32 v71, v71
s_nop 0
v_add_f32 v124, v120, v40
v_add_f32 v124, v124, v41
v_add_f32 v124, v124, v42
v_add_f32 v124, v124, v43
v_add_f32 v124, v124, v44
v_add_f32 v124, v124, v45
v_add_f32 v124, v124, v46
v_add_f32 v124, v124, v47
v_add_f32 v125, v121, v48
v_add_f32 v125, v125, v49
v_add_f32 v125, v125, v50
v_add_f32 v125, v125, v51
v_add_f32 v125, v125, v52
v_add_f32 v125, v125, v53
v_add_f32 v125, v125, v54
v_add_f32 v125, v125, v55
v_add_f32 v126, v122, v56
v_add_f32 v126, v126, v57
v_add_f32 v126, v126, v58
v_add_f32 v126, v126, v59
v_add_f32 v126, v126, v60
v_add_f32 v126, v126, v61
v_add_f32 v126, v126, v62
v_add_f32 v126, v126, v63
v_add_f32 v127, v123, v64
v_add_f32 v127, v127, v65
v_add_f32 v127, v127, v66
v_add_f32 v127, v127, v67
v_add_f32 v127, v127, v68
v_add_f32 v127, v127, v69
v_add_f32 v127, v127, v70
v_add_f32 v127, v127, v71
v_cvt_pk_bf16_f32 v80, v40, v41
v_cvt_pk_bf16_f32 v81, v42, v43
v_cvt_pk_bf16_f32 v82, v44, v45
v_cvt_pk_bf16_f32 v83, v46, v47
s_nop 1
s_branch L_sp1_r4_ret
L_sp0_r4:
s_waitcnt lgkmcnt(0)
s_nop 7
s_nop 7
v_mbcnt_lo_u32_b32 v117, -1, 0
v_mbcnt_hi_u32_b32 v117, -1, v117
v_and_b32 v116, 15, v117
v_lshlrev_b32 v116, 9, v116
v_lshrrev_b32 v117, 4, v117
v_lshlrev_b32 v117, 4, v117
v_add_u32 v116, v116, v117
v_add_u32 v116, s34, v116
global_load_dwordx4 v[24:27], v116, s[36:37] offset:0
v_add_u32 v117, 8192, v116
global_load_dwordx4 v[28:31], v117, s[36:37] offset:0
s_waitcnt vmcnt(0)
v_mfma_f32_16x16x32_bf16 v[40:43], v[24:27], v[128:131], v[100:103]
v_mfma_f32_16x16x32_bf16 v[44:47], v[28:31], v[128:131], v[100:103]
v_mfma_f32_16x16x32_bf16 v[48:51], v[24:27], v[132:135], v[104:107]
v_mfma_f32_16x16x32_bf16 v[52:55], v[28:31], v[132:135], v[104:107]
v_mfma_f32_16x16x32_bf16 v[56:59], v[24:27], v[136:139], v[108:111]
v_mfma_f32_16x16x32_bf16 v[60:63], v[28:31], v[136:139], v[108:111]
v_mfma_f32_16x16x32_bf16 v[64:67], v[24:27], v[140:143], v[112:115]
v_mfma_f32_16x16x32_bf16 v[68:71], v[28:31], v[140:143], v[112:115]
s_nop 7
global_load_dwordx4 v[24:27], v116, s[36:37] offset:64
v_add_u32 v117, 8192, v116
global_load_dwordx4 v[28:31], v117, s[36:37] offset:64
s_waitcnt vmcnt(0)
v_mfma_f32_16x16x32_bf16 v[40:43], v[24:27], v[144:147], v[40:43]
v_mfma_f32_16x16x32_bf16 v[44:47], v[28:31], v[144:147], v[44:47]
v_mfma_f32_16x16x32_bf16 v[48:51], v[24:27], v[148:151], v[48:51]
v_mfma_f32_16x16x32_bf16 v[52:55], v[28:31], v[148:151], v[52:55]
v_mfma_f32_16x16x32_bf16 v[56:59], v[24:27], v[152:155], v[56:59]
v_mfma_f32_16x16x32_bf16 v[60:63], v[28:31], v[152:155], v[60:63]
v_mfma_f32_16x16x32_bf16 v[64:67], v[24:27], v[156:159], v[64:67]
v_mfma_f32_16x16x32_bf16 v[68:71], v[28:31], v[156:159], v[68:71]
s_nop 7
global_load_dwordx4 v[24:27], v116, s[36:37] offset:128
v_add_u32 v117, 8192, v116
global_load_dwordx4 v[28:31], v117, s[36:37] offset:128
s_waitcnt vmcnt(0)
v_mfma_f32_16x16x32_bf16 v[40:43], v[24:27], v[160:163], v[40:43]
v_mfma_f32_16x16x32_bf16 v[44:47], v[28:31], v[160:163], v[44:47]
v_mfma_f32_16x16x32_bf16 v[48:51], v[24:27], v[164:167], v[48:51]
v_mfma_f32_16x16x32_bf16 v[52:55], v[28:31], v[164:167], v[52:55]
v_mfma_f32_16x16x32_bf16 v[56:59], v[24:27], v[168:171], v[56:59]
v_mfma_f32_16x16x32_bf16 v[60:63], v[28:31], v[168:171], v[60:63]
v_mfma_f32_16x16x32_bf16 v[64:67], v[24:27], v[172:175], v[64:67]
v_mfma_f32_16x16x32_bf16 v[68:71], v[28:31], v[172:175], v[68:71]
s_nop 7
global_load_dwordx4 v[24:27], v116, s[36:37] offset:192
v_add_u32 v117, 8192, v116
global_load_dwordx4 v[28:31], v117, s[36:37] offset:192
s_waitcnt vmcnt(0)
v_mfma_f32_16x16x32_bf16 v[40:43], v[24:27], v[176:179], v[40:43]
v_mfma_f32_16x16x32_bf16 v[44:47], v[28:31], v[176:179], v[44:47]
v_mfma_f32_16x16x32_bf16 v[48:51], v[24:27], v[180:183], v[48:51]
v_mfma_f32_16x16x32_bf16 v[52:55], v[28:31], v[180:183], v[52:55]
v_mfma_f32_16x16x32_bf16 v[56:59], v[24:27], v[184:187], v[56:59]
v_mfma_f32_16x16x32_bf16 v[60:63], v[28:31], v[184:187], v[60:63]
v_mfma_f32_16x16x32_bf16 v[64:67], v[24:27], v[188:191], v[64:67]
v_mfma_f32_16x16x32_bf16 v[68:71], v[28:31], v[188:191], v[68:71]
s_nop 7
global_load_dwordx4 v[24:27], v116, s[36:37] offset:256
v_add_u32 v117, 8192, v116
global_load_dwordx4 v[28:31], v117, s[36:37] offset:256
s_waitcnt vmcnt(0)
v_mfma_f32_16x16x32_bf16 v[40:43], v[24:27], v[192:195], v[40:43]
v_mfma_f32_16x16x32_bf16 v[44:47], v[28:31], v[192:195], v[44:47]
v_mfma_f32_16x16x32_bf16 v[48:51], v[24:27], v[196:199], v[48:51]
v_mfma_f32_16x16x32_bf16 v[52:55], v[28:31], v[196:199], v[52:55]
v_mfma_f32_16x16x32_bf16 v[56:59], v[24:27], v[200:203], v[56:59]
v_mfma_f32_16x16x32_bf16 v[60:63], v[28:31], v[200:203], v[60:63]
v_mfma_f32_16x16x32_bf16 v[64:67], v[24:27], v[204:207], v[64:67]
v_mfma_f32_16x16x32_bf16 v[68:71], v[28:31], v[204:207], v[68:71]
s_nop 7
global_load_dwordx4 v[24:27], v116, s[36:37] offset:320
v_add_u32 v117, 8192, v116
global_load_dwordx4 v[28:31], v117, s[36:37] offset:320
s_waitcnt vmcnt(0)
v_mfma_f32_16x16x32_bf16 v[40:43], v[24:27], v[208:211], v[40:43]
v_mfma_f32_16x16x32_bf16 v[44:47], v[28:31], v[208:211], v[44:47]
v_mfma_f32_16x16x32_bf16 v[48:51], v[24:27], v[212:215], v[48:51]
v_mfma_f32_16x16x32_bf16 v[52:55], v[28:31], v[212:215], v[52:55]
v_mfma_f32_16x16x32_bf16 v[56:59], v[24:27], v[216:219], v[56:59]
v_mfma_f32_16x16x32_bf16 v[60:63], v[28:31], v[216:219], v[60:63]
v_mfma_f32_16x16x32_bf16 v[64:67], v[24:27], v[220:223], v[64:67]
v_mfma_f32_16x16x32_bf16 v[68:71], v[28:31], v[220:223], v[68:71]
s_nop 7
global_load_dwordx4 v[24:27], v116, s[36:37] offset:384
v_add_u32 v117, 8192, v116
global_load_dwordx4 v[28:31], v117, s[36:37] offset:384
s_waitcnt vmcnt(0)
v_mfma_f32_16x16x32_bf16 v[40:43], v[24:27], v[224:227], v[40:43]
v_mfma_f32_16x16x32_bf16 v[44:47], v[28:31], v[224:227], v[44:47]
v_mfma_f32_16x16x32_bf16 v[48:51], v[24:27], v[228:231], v[48:51]
v_mfma_f32_16x16x32_bf16 v[52:55], v[28:31], v[228:231], v[52:55]
v_mfma_f32_16x16x32_bf16 v[56:59], v[24:27], v[232:235], v[56:59]
v_mfma_f32_16x16x32_bf16 v[60:63], v[28:31], v[232:235], v[60:63]
v_mfma_f32_16x16x32_bf16 v[64:67], v[24:27], v[236:239], v[64:67]
v_mfma_f32_16x16x32_bf16 v[68:71], v[28:31], v[236:239], v[68:71]
s_nop 7
global_load_dwordx4 v[24:27], v116, s[36:37] offset:448
v_add_u32 v117, 8192, v116
global_load_dwordx4 v[28:31], v117, s[36:37] offset:448
s_waitcnt vmcnt(0)
v_mfma_f32_16x16x32_bf16 v[40:43], v[24:27], v[240:243], v[40:43]
v_mfma_f32_16x16x32_bf16 v[44:47], v[28:31], v[240:243], v[44:47]
v_mfma_f32_16x16x32_bf16 v[48:51], v[24:27], v[244:247], v[48:51]
v_mfma_f32_16x16x32_bf16 v[52:55], v[28:31], v[244:247], v[52:55]
v_mfma_f32_16x16x32_bf16 v[56:59], v[24:27], v[248:251], v[56:59]
v_mfma_f32_16x16x32_bf16 v[60:63], v[28:31], v[248:251], v[60:63]
v_mfma_f32_16x16x32_bf16 v[64:67], v[24:27], v[252:255], v[64:67]
v_mfma_f32_16x16x32_bf16 v[68:71], v[28:31], v[252:255], v[68:71]
s_nop 7
s_nop 7
v_max3_f32 v84, v40, v41, v42
v_max3_f32 v84, v84, v43, v44
v_max3_f32 v84, v84, v45, v46
v_max_f32 v84, v84, v47
v_max3_f32 v85, v48, v49, v50
v_max3_f32 v85, v85, v51, v52
v_max3_f32 v85, v85, v53, v54
v_max_f32 v85, v85, v55
v_max3_f32 v86, v56, v57, v58
v_max3_f32 v86, v86, v59, v60
v_max3_f32 v86, v86, v61, v62
v_max_f32 v86, v86, v63
v_max3_f32 v87, v64, v65, v66
v_max3_f32 v87, v87, v67, v68
v_max3_f32 v87, v87, v69, v70
v_max_f32 v87, v87, v71
v_mbcnt_lo_u32_b32 v116, -1, 0
v_mbcnt_hi_u32_b32 v116, -1, v116
v_xor_b32 v117, 32, v116
v_xor_b32 v116, 16, v116
v_lshlrev_b32 v117, 2, v117
v_lshlrev_b32 v116, 2, v116
ds_bpermute_b32 v90, v116, v84
ds_bpermute_b32 v91, v116, v85
ds_bpermute_b32 v92, v116, v86
ds_bpermute_b32 v93, v116, v87
s_waitcnt lgkmcnt(0)
v_max_f32 v84, v84, v90
v_max_f32 v85, v85, v91
v_max_f32 v86, v86, v92
v_max_f32 v87, v87, v93
ds_bpermute_b32 v90, v117, v84
ds_bpermute_b32 v91, v117, v85
ds_bpermute_b32 v92, v117, v86
ds_bpermute_b32 v93, v117, v87
s_waitcnt lgkmcnt(0)
v_max_f32 v84, v84, v90
v_max_f32 v85, v85, v91
v_max_f32 v86, v86, v92
v_max_f32 v87, v87, v93
v_max_f32 v84, 0, v84
v_max_f32 v85, 0, v85
v_max_f32 v86, 0, v86
v_max_f32 v87, 0, v87
v_sub_f32 v90, 0, v84
v_sub_f32 v91, 0, v85
v_sub_f32 v92, 0, v86
v_sub_f32 v93, 0, v87
v_exp_f32 v90, v90
v_exp_f32 v91, v91
v_exp_f32 v92, v92
v_exp_f32 v93, v93
s_nop 0
v_sub_f32 v100, v100, v84
v_sub_f32 v101, v101, v84
v_sub_f32 v102, v102, v84
v_sub_f32 v103, v103, v84
v_mul_f32 v124, v124, v90
v_accvgpr_read_b32 v116, a0
v_mul_f32 v116, v116, v90
v_accvgpr_write_b32 a0, v116
v_accvgpr_read_b32 v116, a1
v_mul_f32 v116, v116, v90
v_accvgpr_write_b32 a1, v116
v_accvgpr_read_b32 v116, a2
v_mul_f32 v116, v116, v90
v_accvgpr_write_b32 a2, v116
v_accvgpr_read_b32 v116, a3
v_mul_f32 v116, v116, v90
v_accvgpr_write_b32 a3, v116
v_accvgpr_read_b32 v116, a16
v_mul_f32 v116, v116, v90
v_accvgpr_write_b32 a16, v116
v_accvgpr_read_b32 v116, a17
v_mul_f32 v116, v116, v90
v_accvgpr_write_b32 a17, v116
v_accvgpr_read_b32 v116, a18
v_mul_f32 v116, v116, v90
v_accvgpr_write_b32 a18, v116
v_accvgpr_read_b32 v116, a19
v_mul_f32 v116, v116, v90
v_accvgpr_write_b32 a19, v116
v_accvgpr_read_b32 v116, a32
v_mul_f32 v116, v116, v90
v_accvgpr_write_b32 a32, v116
v_accvgpr_read_b32 v116, a33
v_mul_f32 v116, v116, v90
v_accvgpr_write_b32 a33, v116
v_accvgpr_read_b32 v116, a34
v_mul_f32 v116, v116, v90
v_accvgpr_write_b32 a34, v116
v_accvgpr_read_b32 v116, a35
v_mul_f32 v116, v116, v90
v_accvgpr_write_b32 a35, v116
v_accvgpr_read_b32 v116, a48
v_mul_f32 v116, v116, v90
v_accvgpr_write_b32 a48, v116
v_accvgpr_read_b32 v116, a49
v_mul_f32 v116, v116, v90
v_accvgpr_write_b32 a49, v116
v_accvgpr_read_b32 v116, a50
v_mul_f32 v116, v116, v90
v_accvgpr_write_b32 a50, v116
v_accvgpr_read_b32 v116, a51
v_mul_f32 v116, v116, v90
v_accvgpr_write_b32 a51, v116
v_accvgpr_read_b32 v116, a64
v_mul_f32 v116, v116, v90
v_accvgpr_write_b32 a64, v116
v_accvgpr_read_b32 v116, a65
v_mul_f32 v116, v116, v90
v_accvgpr_write_b32 a65, v116
v_accvgpr_read_b32 v116, a66
v_mul_f32 v116, v116, v90
v_accvgpr_write_b32 a66, v116
v_accvgpr_read_b32 v116, a67
v_mul_f32 v116, v116, v90
v_accvgpr_write_b32 a67, v116
v_accvgpr_read_b32 v116, a80
v_mul_f32 v116, v116, v90
v_accvgpr_write_b32 a80, v116
v_accvgpr_read_b32 v116, a81
v_mul_f32 v116, v116, v90
v_accvgpr_write_b32 a81, v116
v_accvgpr_read_b32 v116, a82
v_mul_f32 v116, v116, v90
v_accvgpr_write_b32 a82, v116
v_accvgpr_read_b32 v116, a83
v_mul_f32 v116, v116, v90
v_accvgpr_write_b32 a83, v116
v_accvgpr_read_b32 v116, a96
v_mul_f32 v116, v116, v90
v_accvgpr_write_b32 a96, v116
v_accvgpr_read_b32 v116, a97
v_mul_f32 v116, v116, v90
v_accvgpr_write_b32 a97, v116
v_accvgpr_read_b32 v116, a98
v_mul_f32 v116, v116, v90
v_accvgpr_write_b32 a98, v116
v_accvgpr_read_b32 v116, a99
v_mul_f32 v116, v116, v90
v_accvgpr_write_b32 a99, v116
v_accvgpr_read_b32 v116, a112
v_mul_f32 v116, v116, v90
v_accvgpr_write_b32 a112, v116
v_accvgpr_read_b32 v116, a113
v_mul_f32 v116, v116, v90
v_accvgpr_write_b32 a113, v116
v_accvgpr_read_b32 v116, a114
v_mul_f32 v116, v116, v90
v_accvgpr_write_b32 a114, v116
v_accvgpr_read_b32 v116, a115
v_mul_f32 v116, v116, v90
v_accvgpr_write_b32 a115, v116
v_accvgpr_read_b32 v116, a128
v_mul_f32 v116, v116, v90
v_accvgpr_write_b32 a128, v116
v_accvgpr_read_b32 v116, a129
v_mul_f32 v116, v116, v90
v_accvgpr_write_b32 a129, v116
v_accvgpr_read_b32 v116, a130
v_mul_f32 v116, v116, v90
v_accvgpr_write_b32 a130, v116
v_accvgpr_read_b32 v116, a131
v_mul_f32 v116, v116, v90
v_accvgpr_write_b32 a131, v116
v_accvgpr_read_b32 v116, a144
v_mul_f32 v116, v116, v90
v_accvgpr_write_b32 a144, v116
v_accvgpr_read_b32 v116, a145
v_mul_f32 v116, v116, v90
v_accvgpr_write_b32 a145, v116
v_accvgpr_read_b32 v116, a146
v_mul_f32 v116, v116, v90
v_accvgpr_write_b32 a146, v116
v_accvgpr_read_b32 v116, a147
v_mul_f32 v116, v116, v90
v_accvgpr_write_b32 a147, v116
v_accvgpr_read_b32 v116, a160
v_mul_f32 v116, v116, v90
v_accvgpr_write_b32 a160, v116
v_accvgpr_read_b32 v116, a161
v_mul_f32 v116, v116, v90
v_accvgpr_write_b32 a161, v116
v_accvgpr_read_b32 v116, a162
v_mul_f32 v116, v116, v90
v_accvgpr_write_b32 a162, v116
v_accvgpr_read_b32 v116, a163
v_mul_f32 v116, v116, v90
v_accvgpr_write_b32 a163, v116
v_accvgpr_read_b32 v116, a176
v_mul_f32 v116, v116, v90
v_accvgpr_write_b32 a176, v116
v_accvgpr_read_b32 v116, a177
v_mul_f32 v116, v116, v90
v_accvgpr_write_b32 a177, v116
v_accvgpr_read_b32 v116, a178
v_mul_f32 v116, v116, v90
v_accvgpr_write_b32 a178, v116
v_accvgpr_read_b32 v116, a179
v_mul_f32 v116, v116, v90
v_accvgpr_write_b32 a179, v116
v_accvgpr_read_b32 v116, a192
v_mul_f32 v116, v116, v90
v_accvgpr_write_b32 a192, v116
v_accvgpr_read_b32 v116, a193
v_mul_f32 v116, v116, v90
v_accvgpr_write_b32 a193, v116
v_accvgpr_read_b32 v116, a194
v_mul_f32 v116, v116, v90
v_accvgpr_write_b32 a194, v116
v_accvgpr_read_b32 v116, a195
v_mul_f32 v116, v116, v90
v_accvgpr_write_b32 a195, v116
v_accvgpr_read_b32 v116, a208
v_mul_f32 v116, v116, v90
v_accvgpr_write_b32 a208, v116
v_accvgpr_read_b32 v116, a209
v_mul_f32 v116, v116, v90
v_accvgpr_write_b32 a209, v116
v_accvgpr_read_b32 v116, a210
v_mul_f32 v116, v116, v90
v_accvgpr_write_b32 a210, v116
v_accvgpr_read_b32 v116, a211
v_mul_f32 v116, v116, v90
v_accvgpr_write_b32 a211, v116
v_accvgpr_read_b32 v116, a224
v_mul_f32 v116, v116, v90
v_accvgpr_write_b32 a224, v116
v_accvgpr_read_b32 v116, a225
v_mul_f32 v116, v116, v90
v_accvgpr_write_b32 a225, v116
v_accvgpr_read_b32 v116, a226
v_mul_f32 v116, v116, v90
v_accvgpr_write_b32 a226, v116
v_accvgpr_read_b32 v116, a227
v_mul_f32 v116, v116, v90
v_accvgpr_write_b32 a227, v116
v_accvgpr_read_b32 v116, a240
v_mul_f32 v116, v116, v90
v_accvgpr_write_b32 a240, v116
v_accvgpr_read_b32 v116, a241
v_mul_f32 v116, v116, v90
v_accvgpr_write_b32 a241, v116
v_accvgpr_read_b32 v116, a242
v_mul_f32 v116, v116, v90
v_accvgpr_write_b32 a242, v116
v_accvgpr_read_b32 v116, a243
v_mul_f32 v116, v116, v90
v_accvgpr_write_b32 a243, v116
v_sub_f32 v104, v104, v85
v_sub_f32 v105, v105, v85
v_sub_f32 v106, v106, v85
v_sub_f32 v107, v107, v85
v_mul_f32 v125, v125, v91
v_accvgpr_read_b32 v116, a4
v_mul_f32 v116, v116, v91
v_accvgpr_write_b32 a4, v116
v_accvgpr_read_b32 v116, a5
v_mul_f32 v116, v116, v91
v_accvgpr_write_b32 a5, v116
v_accvgpr_read_b32 v116, a6
v_mul_f32 v116, v116, v91
v_accvgpr_write_b32 a6, v116
v_accvgpr_read_b32 v116, a7
v_mul_f32 v116, v116, v91
v_accvgpr_write_b32 a7, v116
v_accvgpr_read_b32 v116, a20
v_mul_f32 v116, v116, v91
v_accvgpr_write_b32 a20, v116
v_accvgpr_read_b32 v116, a21
v_mul_f32 v116, v116, v91
v_accvgpr_write_b32 a21, v116
v_accvgpr_read_b32 v116, a22
v_mul_f32 v116, v116, v91
v_accvgpr_write_b32 a22, v116
v_accvgpr_read_b32 v116, a23
v_mul_f32 v116, v116, v91
v_accvgpr_write_b32 a23, v116
v_accvgpr_read_b32 v116, a36
v_mul_f32 v116, v116, v91
v_accvgpr_write_b32 a36, v116
v_accvgpr_read_b32 v116, a37
v_mul_f32 v116, v116, v91
v_accvgpr_write_b32 a37, v116
v_accvgpr_read_b32 v116, a38
v_mul_f32 v116, v116, v91
v_accvgpr_write_b32 a38, v116
v_accvgpr_read_b32 v116, a39
v_mul_f32 v116, v116, v91
v_accvgpr_write_b32 a39, v116
v_accvgpr_read_b32 v116, a52
v_mul_f32 v116, v116, v91
v_accvgpr_write_b32 a52, v116
v_accvgpr_read_b32 v116, a53
v_mul_f32 v116, v116, v91
v_accvgpr_write_b32 a53, v116
v_accvgpr_read_b32 v116, a54
v_mul_f32 v116, v116, v91
v_accvgpr_write_b32 a54, v116
v_accvgpr_read_b32 v116, a55
v_mul_f32 v116, v116, v91
v_accvgpr_write_b32 a55, v116
v_accvgpr_read_b32 v116, a68
v_mul_f32 v116, v116, v91
v_accvgpr_write_b32 a68, v116
v_accvgpr_read_b32 v116, a69
v_mul_f32 v116, v116, v91
v_accvgpr_write_b32 a69, v116
v_accvgpr_read_b32 v116, a70
v_mul_f32 v116, v116, v91
v_accvgpr_write_b32 a70, v116
v_accvgpr_read_b32 v116, a71
v_mul_f32 v116, v116, v91
v_accvgpr_write_b32 a71, v116
v_accvgpr_read_b32 v116, a84
v_mul_f32 v116, v116, v91
v_accvgpr_write_b32 a84, v116
v_accvgpr_read_b32 v116, a85
v_mul_f32 v116, v116, v91
v_accvgpr_write_b32 a85, v116
v_accvgpr_read_b32 v116, a86
v_mul_f32 v116, v116, v91
v_accvgpr_write_b32 a86, v116
v_accvgpr_read_b32 v116, a87
v_mul_f32 v116, v116, v91
v_accvgpr_write_b32 a87, v116
v_accvgpr_read_b32 v116, a100
v_mul_f32 v116, v116, v91
v_accvgpr_write_b32 a100, v116
v_accvgpr_read_b32 v116, a101
v_mul_f32 v116, v116, v91
v_accvgpr_write_b32 a101, v116
v_accvgpr_read_b32 v116, a102
v_mul_f32 v116, v116, v91
v_accvgpr_write_b32 a102, v116
v_accvgpr_read_b32 v116, a103
v_mul_f32 v116, v116, v91
v_accvgpr_write_b32 a103, v116
v_accvgpr_read_b32 v116, a116
v_mul_f32 v116, v116, v91
v_accvgpr_write_b32 a116, v116
v_accvgpr_read_b32 v116, a117
v_mul_f32 v116, v116, v91
v_accvgpr_write_b32 a117, v116
v_accvgpr_read_b32 v116, a118
v_mul_f32 v116, v116, v91
v_accvgpr_write_b32 a118, v116
v_accvgpr_read_b32 v116, a119
v_mul_f32 v116, v116, v91
v_accvgpr_write_b32 a119, v116
v_accvgpr_read_b32 v116, a132
v_mul_f32 v116, v116, v91
v_accvgpr_write_b32 a132, v116
v_accvgpr_read_b32 v116, a133
v_mul_f32 v116, v116, v91
v_accvgpr_write_b32 a133, v116
v_accvgpr_read_b32 v116, a134
v_mul_f32 v116, v116, v91
v_accvgpr_write_b32 a134, v116
v_accvgpr_read_b32 v116, a135
v_mul_f32 v116, v116, v91
v_accvgpr_write_b32 a135, v116
v_accvgpr_read_b32 v116, a148
v_mul_f32 v116, v116, v91
v_accvgpr_write_b32 a148, v116
v_accvgpr_read_b32 v116, a149
v_mul_f32 v116, v116, v91
v_accvgpr_write_b32 a149, v116
v_accvgpr_read_b32 v116, a150
v_mul_f32 v116, v116, v91
v_accvgpr_write_b32 a150, v116
v_accvgpr_read_b32 v116, a151
v_mul_f32 v116, v116, v91
v_accvgpr_write_b32 a151, v116
v_accvgpr_read_b32 v116, a164
v_mul_f32 v116, v116, v91
v_accvgpr_write_b32 a164, v116
v_accvgpr_read_b32 v116, a165
v_mul_f32 v116, v116, v91
v_accvgpr_write_b32 a165, v116
v_accvgpr_read_b32 v116, a166
v_mul_f32 v116, v116, v91
v_accvgpr_write_b32 a166, v116
v_accvgpr_read_b32 v116, a167
v_mul_f32 v116, v116, v91
v_accvgpr_write_b32 a167, v116
v_accvgpr_read_b32 v116, a180
v_mul_f32 v116, v116, v91
v_accvgpr_write_b32 a180, v116
v_accvgpr_read_b32 v116, a181
v_mul_f32 v116, v116, v91
v_accvgpr_write_b32 a181, v116
v_accvgpr_read_b32 v116, a182
v_mul_f32 v116, v116, v91
v_accvgpr_write_b32 a182, v116
v_accvgpr_read_b32 v116, a183
v_mul_f32 v116, v116, v91
v_accvgpr_write_b32 a183, v116
v_accvgpr_read_b32 v116, a196
v_mul_f32 v116, v116, v91
v_accvgpr_write_b32 a196, v116
v_accvgpr_read_b32 v116, a197
v_mul_f32 v116, v116, v91
v_accvgpr_write_b32 a197, v116
v_accvgpr_read_b32 v116, a198
v_mul_f32 v116, v116, v91
v_accvgpr_write_b32 a198, v116
v_accvgpr_read_b32 v116, a199
v_mul_f32 v116, v116, v91
v_accvgpr_write_b32 a199, v116
v_accvgpr_read_b32 v116, a212
v_mul_f32 v116, v116, v91
v_accvgpr_write_b32 a212, v116
v_accvgpr_read_b32 v116, a213
v_mul_f32 v116, v116, v91
v_accvgpr_write_b32 a213, v116
v_accvgpr_read_b32 v116, a214
v_mul_f32 v116, v116, v91
v_accvgpr_write_b32 a214, v116
v_accvgpr_read_b32 v116, a215
v_mul_f32 v116, v116, v91
v_accvgpr_write_b32 a215, v116
v_accvgpr_read_b32 v116, a228
v_mul_f32 v116, v116, v91
v_accvgpr_write_b32 a228, v116
v_accvgpr_read_b32 v116, a229
v_mul_f32 v116, v116, v91
v_accvgpr_write_b32 a229, v116
v_accvgpr_read_b32 v116, a230
v_mul_f32 v116, v116, v91
v_accvgpr_write_b32 a230, v116
v_accvgpr_read_b32 v116, a231
v_mul_f32 v116, v116, v91
v_accvgpr_write_b32 a231, v116
v_accvgpr_read_b32 v116, a244
v_mul_f32 v116, v116, v91
v_accvgpr_write_b32 a244, v116
v_accvgpr_read_b32 v116, a245
v_mul_f32 v116, v116, v91
v_accvgpr_write_b32 a245, v116
v_accvgpr_read_b32 v116, a246
v_mul_f32 v116, v116, v91
v_accvgpr_write_b32 a246, v116
v_accvgpr_read_b32 v116, a247
v_mul_f32 v116, v116, v91
v_accvgpr_write_b32 a247, v116
v_sub_f32 v108, v108, v86
v_sub_f32 v109, v109, v86
v_sub_f32 v110, v110, v86
v_sub_f32 v111, v111, v86
v_mul_f32 v126, v126, v92
v_accvgpr_read_b32 v116, a8
v_mul_f32 v116, v116, v92
v_accvgpr_write_b32 a8, v116
v_accvgpr_read_b32 v116, a9
v_mul_f32 v116, v116, v92
v_accvgpr_write_b32 a9, v116
v_accvgpr_read_b32 v116, a10
v_mul_f32 v116, v116, v92
v_accvgpr_write_b32 a10, v116
v_accvgpr_read_b32 v116, a11
v_mul_f32 v116, v116, v92
v_accvgpr_write_b32 a11, v116
v_accvgpr_read_b32 v116, a24
v_mul_f32 v116, v116, v92
v_accvgpr_write_b32 a24, v116
v_accvgpr_read_b32 v116, a25
v_mul_f32 v116, v116, v92
v_accvgpr_write_b32 a25, v116
v_accvgpr_read_b32 v116, a26
v_mul_f32 v116, v116, v92
v_accvgpr_write_b32 a26, v116
v_accvgpr_read_b32 v116, a27
v_mul_f32 v116, v116, v92
v_accvgpr_write_b32 a27, v116
v_accvgpr_read_b32 v116, a40
v_mul_f32 v116, v116, v92
v_accvgpr_write_b32 a40, v116
v_accvgpr_read_b32 v116, a41
v_mul_f32 v116, v116, v92
v_accvgpr_write_b32 a41, v116
v_accvgpr_read_b32 v116, a42
v_mul_f32 v116, v116, v92
v_accvgpr_write_b32 a42, v116
v_accvgpr_read_b32 v116, a43
v_mul_f32 v116, v116, v92
v_accvgpr_write_b32 a43, v116
v_accvgpr_read_b32 v116, a56
v_mul_f32 v116, v116, v92
v_accvgpr_write_b32 a56, v116
v_accvgpr_read_b32 v116, a57
v_mul_f32 v116, v116, v92
v_accvgpr_write_b32 a57, v116
v_accvgpr_read_b32 v116, a58
v_mul_f32 v116, v116, v92
v_accvgpr_write_b32 a58, v116
v_accvgpr_read_b32 v116, a59
v_mul_f32 v116, v116, v92
v_accvgpr_write_b32 a59, v116
v_accvgpr_read_b32 v116, a72
v_mul_f32 v116, v116, v92
v_accvgpr_write_b32 a72, v116
v_accvgpr_read_b32 v116, a73
v_mul_f32 v116, v116, v92
v_accvgpr_write_b32 a73, v116
v_accvgpr_read_b32 v116, a74
v_mul_f32 v116, v116, v92
v_accvgpr_write_b32 a74, v116
v_accvgpr_read_b32 v116, a75
v_mul_f32 v116, v116, v92
v_accvgpr_write_b32 a75, v116
v_accvgpr_read_b32 v116, a88
v_mul_f32 v116, v116, v92
v_accvgpr_write_b32 a88, v116
v_accvgpr_read_b32 v116, a89
v_mul_f32 v116, v116, v92
v_accvgpr_write_b32 a89, v116
v_accvgpr_read_b32 v116, a90
v_mul_f32 v116, v116, v92
v_accvgpr_write_b32 a90, v116
v_accvgpr_read_b32 v116, a91
v_mul_f32 v116, v116, v92
v_accvgpr_write_b32 a91, v116
v_accvgpr_read_b32 v116, a104
v_mul_f32 v116, v116, v92
v_accvgpr_write_b32 a104, v116
v_accvgpr_read_b32 v116, a105
v_mul_f32 v116, v116, v92
v_accvgpr_write_b32 a105, v116
v_accvgpr_read_b32 v116, a106
v_mul_f32 v116, v116, v92
v_accvgpr_write_b32 a106, v116
v_accvgpr_read_b32 v116, a107
v_mul_f32 v116, v116, v92
v_accvgpr_write_b32 a107, v116
v_accvgpr_read_b32 v116, a120
v_mul_f32 v116, v116, v92
v_accvgpr_write_b32 a120, v116
v_accvgpr_read_b32 v116, a121
v_mul_f32 v116, v116, v92
v_accvgpr_write_b32 a121, v116
v_accvgpr_read_b32 v116, a122
v_mul_f32 v116, v116, v92
v_accvgpr_write_b32 a122, v116
v_accvgpr_read_b32 v116, a123
v_mul_f32 v116, v116, v92
v_accvgpr_write_b32 a123, v116
v_accvgpr_read_b32 v116, a136
v_mul_f32 v116, v116, v92
v_accvgpr_write_b32 a136, v116
v_accvgpr_read_b32 v116, a137
v_mul_f32 v116, v116, v92
v_accvgpr_write_b32 a137, v116
v_accvgpr_read_b32 v116, a138
v_mul_f32 v116, v116, v92
v_accvgpr_write_b32 a138, v116
v_accvgpr_read_b32 v116, a139
v_mul_f32 v116, v116, v92
v_accvgpr_write_b32 a139, v116
v_accvgpr_read_b32 v116, a152
v_mul_f32 v116, v116, v92
v_accvgpr_write_b32 a152, v116
v_accvgpr_read_b32 v116, a153
v_mul_f32 v116, v116, v92
v_accvgpr_write_b32 a153, v116
v_accvgpr_read_b32 v116, a154
v_mul_f32 v116, v116, v92
v_accvgpr_write_b32 a154, v116
v_accvgpr_read_b32 v116, a155
v_mul_f32 v116, v116, v92
v_accvgpr_write_b32 a155, v116
v_accvgpr_read_b32 v116, a168
v_mul_f32 v116, v116, v92
v_accvgpr_write_b32 a168, v116
v_accvgpr_read_b32 v116, a169
v_mul_f32 v116, v116, v92
v_accvgpr_write_b32 a169, v116
v_accvgpr_read_b32 v116, a170
v_mul_f32 v116, v116, v92
v_accvgpr_write_b32 a170, v116
v_accvgpr_read_b32 v116, a171
v_mul_f32 v116, v116, v92
v_accvgpr_write_b32 a171, v116
v_accvgpr_read_b32 v116, a184
v_mul_f32 v116, v116, v92
v_accvgpr_write_b32 a184, v116
v_accvgpr_read_b32 v116, a185
v_mul_f32 v116, v116, v92
v_accvgpr_write_b32 a185, v116
v_accvgpr_read_b32 v116, a186
v_mul_f32 v116, v116, v92
v_accvgpr_write_b32 a186, v116
v_accvgpr_read_b32 v116, a187
v_mul_f32 v116, v116, v92
v_accvgpr_write_b32 a187, v116
v_accvgpr_read_b32 v116, a200
v_mul_f32 v116, v116, v92
v_accvgpr_write_b32 a200, v116
v_accvgpr_read_b32 v116, a201
v_mul_f32 v116, v116, v92
v_accvgpr_write_b32 a201, v116
v_accvgpr_read_b32 v116, a202
v_mul_f32 v116, v116, v92
v_accvgpr_write_b32 a202, v116
v_accvgpr_read_b32 v116, a203
v_mul_f32 v116, v116, v92
v_accvgpr_write_b32 a203, v116
v_accvgpr_read_b32 v116, a216
v_mul_f32 v116, v116, v92
v_accvgpr_write_b32 a216, v116
v_accvgpr_read_b32 v116, a217
v_mul_f32 v116, v116, v92
v_accvgpr_write_b32 a217, v116
v_accvgpr_read_b32 v116, a218
v_mul_f32 v116, v116, v92
v_accvgpr_write_b32 a218, v116
v_accvgpr_read_b32 v116, a219
v_mul_f32 v116, v116, v92
v_accvgpr_write_b32 a219, v116
v_accvgpr_read_b32 v116, a232
v_mul_f32 v116, v116, v92
v_accvgpr_write_b32 a232, v116
v_accvgpr_read_b32 v116, a233
v_mul_f32 v116, v116, v92
v_accvgpr_write_b32 a233, v116
v_accvgpr_read_b32 v116, a234
v_mul_f32 v116, v116, v92
v_accvgpr_write_b32 a234, v116
v_accvgpr_read_b32 v116, a235
v_mul_f32 v116, v116, v92
v_accvgpr_write_b32 a235, v116
v_accvgpr_read_b32 v116, a248
v_mul_f32 v116, v116, v92
v_accvgpr_write_b32 a248, v116
v_accvgpr_read_b32 v116, a249
v_mul_f32 v116, v116, v92
v_accvgpr_write_b32 a249, v116
v_accvgpr_read_b32 v116, a250
v_mul_f32 v116, v116, v92
v_accvgpr_write_b32 a250, v116
v_accvgpr_read_b32 v116, a251
v_mul_f32 v116, v116, v92
v_accvgpr_write_b32 a251, v116
v_sub_f32 v112, v112, v87
v_sub_f32 v113, v113, v87
v_sub_f32 v114, v114, v87
v_sub_f32 v115, v115, v87
v_mul_f32 v127, v127, v93
v_accvgpr_read_b32 v116, a12
v_mul_f32 v116, v116, v93
v_accvgpr_write_b32 a12, v116
v_accvgpr_read_b32 v116, a13
v_mul_f32 v116, v116, v93
v_accvgpr_write_b32 a13, v116
v_accvgpr_read_b32 v116, a14
v_mul_f32 v116, v116, v93
v_accvgpr_write_b32 a14, v116
v_accvgpr_read_b32 v116, a15
v_mul_f32 v116, v116, v93
v_accvgpr_write_b32 a15, v116
v_accvgpr_read_b32 v116, a28
v_mul_f32 v116, v116, v93
v_accvgpr_write_b32 a28, v116
v_accvgpr_read_b32 v116, a29
v_mul_f32 v116, v116, v93
v_accvgpr_write_b32 a29, v116
v_accvgpr_read_b32 v116, a30
v_mul_f32 v116, v116, v93
v_accvgpr_write_b32 a30, v116
v_accvgpr_read_b32 v116, a31
v_mul_f32 v116, v116, v93
v_accvgpr_write_b32 a31, v116
v_accvgpr_read_b32 v116, a44
v_mul_f32 v116, v116, v93
v_accvgpr_write_b32 a44, v116
v_accvgpr_read_b32 v116, a45
v_mul_f32 v116, v116, v93
v_accvgpr_write_b32 a45, v116
v_accvgpr_read_b32 v116, a46
v_mul_f32 v116, v116, v93
v_accvgpr_write_b32 a46, v116
v_accvgpr_read_b32 v116, a47
v_mul_f32 v116, v116, v93
v_accvgpr_write_b32 a47, v116
v_accvgpr_read_b32 v116, a60
v_mul_f32 v116, v116, v93
v_accvgpr_write_b32 a60, v116
v_accvgpr_read_b32 v116, a61
v_mul_f32 v116, v116, v93
v_accvgpr_write_b32 a61, v116
v_accvgpr_read_b32 v116, a62
v_mul_f32 v116, v116, v93
v_accvgpr_write_b32 a62, v116
v_accvgpr_read_b32 v116, a63
v_mul_f32 v116, v116, v93
v_accvgpr_write_b32 a63, v116
v_accvgpr_read_b32 v116, a76
v_mul_f32 v116, v116, v93
v_accvgpr_write_b32 a76, v116
v_accvgpr_read_b32 v116, a77
v_mul_f32 v116, v116, v93
v_accvgpr_write_b32 a77, v116
v_accvgpr_read_b32 v116, a78
v_mul_f32 v116, v116, v93
v_accvgpr_write_b32 a78, v116
v_accvgpr_read_b32 v116, a79
v_mul_f32 v116, v116, v93
v_accvgpr_write_b32 a79, v116
v_accvgpr_read_b32 v116, a92
v_mul_f32 v116, v116, v93
v_accvgpr_write_b32 a92, v116
v_accvgpr_read_b32 v116, a93
v_mul_f32 v116, v116, v93
v_accvgpr_write_b32 a93, v116
v_accvgpr_read_b32 v116, a94
v_mul_f32 v116, v116, v93
v_accvgpr_write_b32 a94, v116
v_accvgpr_read_b32 v116, a95
v_mul_f32 v116, v116, v93
v_accvgpr_write_b32 a95, v116
v_accvgpr_read_b32 v116, a108
v_mul_f32 v116, v116, v93
v_accvgpr_write_b32 a108, v116
v_accvgpr_read_b32 v116, a109
v_mul_f32 v116, v116, v93
v_accvgpr_write_b32 a109, v116
v_accvgpr_read_b32 v116, a110
v_mul_f32 v116, v116, v93
v_accvgpr_write_b32 a110, v116
v_accvgpr_read_b32 v116, a111
v_mul_f32 v116, v116, v93
v_accvgpr_write_b32 a111, v116
v_accvgpr_read_b32 v116, a124
v_mul_f32 v116, v116, v93
v_accvgpr_write_b32 a124, v116
v_accvgpr_read_b32 v116, a125
v_mul_f32 v116, v116, v93
v_accvgpr_write_b32 a125, v116
v_accvgpr_read_b32 v116, a126
v_mul_f32 v116, v116, v93
v_accvgpr_write_b32 a126, v116
v_accvgpr_read_b32 v116, a127
v_mul_f32 v116, v116, v93
v_accvgpr_write_b32 a127, v116
v_accvgpr_read_b32 v116, a140
v_mul_f32 v116, v116, v93
v_accvgpr_write_b32 a140, v116
v_accvgpr_read_b32 v116, a141
v_mul_f32 v116, v116, v93
v_accvgpr_write_b32 a141, v116
v_accvgpr_read_b32 v116, a142
v_mul_f32 v116, v116, v93
v_accvgpr_write_b32 a142, v116
v_accvgpr_read_b32 v116, a143
v_mul_f32 v116, v116, v93
v_accvgpr_write_b32 a143, v116
v_accvgpr_read_b32 v116, a156
v_mul_f32 v116, v116, v93
v_accvgpr_write_b32 a156, v116
v_accvgpr_read_b32 v116, a157
v_mul_f32 v116, v116, v93
v_accvgpr_write_b32 a157, v116
v_accvgpr_read_b32 v116, a158
v_mul_f32 v116, v116, v93
v_accvgpr_write_b32 a158, v116
v_accvgpr_read_b32 v116, a159
v_mul_f32 v116, v116, v93
v_accvgpr_write_b32 a159, v116
v_accvgpr_read_b32 v116, a172
v_mul_f32 v116, v116, v93
v_accvgpr_write_b32 a172, v116
v_accvgpr_read_b32 v116, a173
v_mul_f32 v116, v116, v93
v_accvgpr_write_b32 a173, v116
v_accvgpr_read_b32 v116, a174
v_mul_f32 v116, v116, v93
v_accvgpr_write_b32 a174, v116
v_accvgpr_read_b32 v116, a175
v_mul_f32 v116, v116, v93
v_accvgpr_write_b32 a175, v116
v_accvgpr_read_b32 v116, a188
v_mul_f32 v116, v116, v93
v_accvgpr_write_b32 a188, v116
v_accvgpr_read_b32 v116, a189
v_mul_f32 v116, v116, v93
v_accvgpr_write_b32 a189, v116
v_accvgpr_read_b32 v116, a190
v_mul_f32 v116, v116, v93
v_accvgpr_write_b32 a190, v116
v_accvgpr_read_b32 v116, a191
v_mul_f32 v116, v116, v93
v_accvgpr_write_b32 a191, v116
v_accvgpr_read_b32 v116, a204
v_mul_f32 v116, v116, v93
v_accvgpr_write_b32 a204, v116
v_accvgpr_read_b32 v116, a205
v_mul_f32 v116, v116, v93
v_accvgpr_write_b32 a205, v116
v_accvgpr_read_b32 v116, a206
v_mul_f32 v116, v116, v93
v_accvgpr_write_b32 a206, v116
v_accvgpr_read_b32 v116, a207
v_mul_f32 v116, v116, v93
v_accvgpr_write_b32 a207, v116
v_accvgpr_read_b32 v116, a220
v_mul_f32 v116, v116, v93
v_accvgpr_write_b32 a220, v116
v_accvgpr_read_b32 v116, a221
v_mul_f32 v116, v116, v93
v_accvgpr_write_b32 a221, v116
v_accvgpr_read_b32 v116, a222
v_mul_f32 v116, v116, v93
v_accvgpr_write_b32 a222, v116
v_accvgpr_read_b32 v116, a223
v_mul_f32 v116, v116, v93
v_accvgpr_write_b32 a223, v116
v_accvgpr_read_b32 v116, a236
v_mul_f32 v116, v116, v93
v_accvgpr_write_b32 a236, v116
v_accvgpr_read_b32 v116, a237
v_mul_f32 v116, v116, v93
v_accvgpr_write_b32 a237, v116
v_accvgpr_read_b32 v116, a238
v_mul_f32 v116, v116, v93
v_accvgpr_write_b32 a238, v116
v_accvgpr_read_b32 v116, a239
v_mul_f32 v116, v116, v93
v_accvgpr_write_b32 a239, v116
v_accvgpr_read_b32 v116, a252
v_mul_f32 v116, v116, v93
v_accvgpr_write_b32 a252, v116
v_accvgpr_read_b32 v116, a253
v_mul_f32 v116, v116, v93
v_accvgpr_write_b32 a253, v116
v_accvgpr_read_b32 v116, a254
v_mul_f32 v116, v116, v93
v_accvgpr_write_b32 a254, v116
v_accvgpr_read_b32 v116, a255
v_mul_f32 v116, v116, v93
v_accvgpr_write_b32 a255, v116
v_sub_f32 v40, v40, v84
v_sub_f32 v41, v41, v84
v_sub_f32 v42, v42, v84
v_sub_f32 v43, v43, v84
v_sub_f32 v44, v44, v84
v_sub_f32 v45, v45, v84
v_sub_f32 v46, v46, v84
v_sub_f32 v47, v47, v84
v_sub_f32 v48, v48, v85
v_sub_f32 v49, v49, v85
v_sub_f32 v50, v50, v85
v_sub_f32 v51, v51, v85
v_sub_f32 v52, v52, v85
v_sub_f32 v53, v53, v85
v_sub_f32 v54, v54, v85
v_sub_f32 v55, v55, v85
v_sub_f32 v56, v56, v86
v_sub_f32 v57, v57, v86
v_sub_f32 v58, v58, v86
v_sub_f32 v59, v59, v86
v_sub_f32 v60, v60, v86
v_sub_f32 v61, v61, v86
v_sub_f32 v62, v62, v86
v_sub_f32 v63, v63, v86
v_sub_f32 v64, v64, v87
v_sub_f32 v65, v65, v87
v_sub_f32 v66, v66, v87
v_sub_f32 v67, v67, v87
v_sub_f32 v68, v68, v87
v_sub_f32 v69, v69, v87
v_sub_f32 v70, v70, v87
v_sub_f32 v71, v71, v87
v_exp_f32 v40, v40
v_exp_f32 v41, v41
v_exp_f32 v42, v42
v_exp_f32 v43, v43
v_exp_f32 v44, v44
v_exp_f32 v45, v45
v_exp_f32 v46, v46
v_exp_f32 v47, v47
v_exp_f32 v48, v48
v_exp_f32 v49, v49
v_exp_f32 v50, v50
v_exp_f32 v51, v51
v_exp_f32 v52, v52
v_exp_f32 v53, v53
v_exp_f32 v54, v54
v_exp_f32 v55, v55
v_exp_f32 v56, v56
v_exp_f32 v57, v57
v_exp_f32 v58, v58
v_exp_f32 v59, v59
v_exp_f32 v60, v60
v_exp_f32 v61, v61
v_exp_f32 v62, v62
v_exp_f32 v63, v63
v_exp_f32 v64, v64
v_exp_f32 v65, v65
v_exp_f32 v66, v66
v_exp_f32 v67, v67
v_exp_f32 v68, v68
v_exp_f32 v69, v69
v_exp_f32 v70, v70
v_exp_f32 v71, v71
s_nop 0
v_add_f32 v120, v124, v40
v_add_f32 v120, v120, v41
v_add_f32 v120, v120, v42
v_add_f32 v120, v120, v43
v_add_f32 v120, v120, v44
v_add_f32 v120, v120, v45
v_add_f32 v120, v120, v46
v_add_f32 v120, v120, v47
v_add_f32 v121, v125, v48
v_add_f32 v121, v121, v49
v_add_f32 v121, v121, v50
v_add_f32 v121, v121, v51
v_add_f32 v121, v121, v52
v_add_f32 v121, v121, v53
v_add_f32 v121, v121, v54
v_add_f32 v121, v121, v55
v_add_f32 v122, v126, v56
v_add_f32 v122, v122, v57
v_add_f32 v122, v122, v58
v_add_f32 v122, v122, v59
v_add_f32 v122, v122, v60
v_add_f32 v122, v122, v61
v_add_f32 v122, v122, v62
v_add_f32 v122, v122, v63
v_add_f32 v123, v127, v64
v_add_f32 v123, v123, v65
v_add_f32 v123, v123, v66
v_add_f32 v123, v123, v67
v_add_f32 v123, v123, v68
v_add_f32 v123, v123, v69
v_add_f32 v123, v123, v70
v_add_f32 v123, v123, v71
v_cvt_pk_bf16_f32 v80, v40, v41
v_cvt_pk_bf16_f32 v81, v42, v43
v_cvt_pk_bf16_f32 v82, v44, v45
v_cvt_pk_bf16_f32 v83, v46, v47
s_nop 1
s_branch L_sp0_r4_ret
L_sp2_r4:
s_waitcnt lgkmcnt(0)
s_nop 7
s_nop 7
v_mbcnt_lo_u32_b32 v117, -1, 0
v_mbcnt_hi_u32_b32 v117, -1, v117
v_and_b32 v116, 15, v117
v_lshlrev_b32 v116, 9, v116
v_lshrrev_b32 v117, 4, v117
v_lshlrev_b32 v117, 4, v117
v_add_u32 v116, v116, v117
v_add_u32 v116, s34, v116
global_load_dwordx4 v[24:27], v116, s[36:37] offset:0
v_add_u32 v117, 8192, v116
global_load_dwordx4 v[28:31], v117, s[36:37] offset:0
s_waitcnt vmcnt(0)
v_mfma_f32_16x16x32_bf16 v[40:43], v[24:27], v[128:131], v[100:103]
v_mfma_f32_16x16x32_bf16 v[44:47], v[28:31], v[128:131], v[100:103]
v_mfma_f32_16x16x32_bf16 v[48:51], v[24:27], v[132:135], v[104:107]
v_mfma_f32_16x16x32_bf16 v[52:55], v[28:31], v[132:135], v[104:107]
v_mfma_f32_16x16x32_bf16 v[56:59], v[24:27], v[136:139], v[108:111]
v_mfma_f32_16x16x32_bf16 v[60:63], v[28:31], v[136:139], v[108:111]
v_mfma_f32_16x16x32_bf16 v[64:67], v[24:27], v[140:143], v[112:115]
v_mfma_f32_16x16x32_bf16 v[68:71], v[28:31], v[140:143], v[112:115]
s_nop 7
global_load_dwordx4 v[24:27], v116, s[36:37] offset:64
v_add_u32 v117, 8192, v116
global_load_dwordx4 v[28:31], v117, s[36:37] offset:64
s_waitcnt vmcnt(0)
v_mfma_f32_16x16x32_bf16 v[40:43], v[24:27], v[144:147], v[40:43]
v_mfma_f32_16x16x32_bf16 v[44:47], v[28:31], v[144:147], v[44:47]
v_mfma_f32_16x16x32_bf16 v[48:51], v[24:27], v[148:151], v[48:51]
v_mfma_f32_16x16x32_bf16 v[52:55], v[28:31], v[148:151], v[52:55]
v_mfma_f32_16x16x32_bf16 v[56:59], v[24:27], v[152:155], v[56:59]
v_mfma_f32_16x16x32_bf16 v[60:63], v[28:31], v[152:155], v[60:63]
v_mfma_f32_16x16x32_bf16 v[64:67], v[24:27], v[156:159], v[64:67]
v_mfma_f32_16x16x32_bf16 v[68:71], v[28:31], v[156:159], v[68:71]
s_nop 7
global_load_dwordx4 v[24:27], v116, s[36:37] offset:128
v_add_u32 v117, 8192, v116
global_load_dwordx4 v[28:31], v117, s[36:37] offset:128
s_waitcnt vmcnt(0)
v_mfma_f32_16x16x32_bf16 v[40:43], v[24:27], v[160:163], v[40:43]
v_mfma_f32_16x16x32_bf16 v[44:47], v[28:31], v[160:163], v[44:47]
v_mfma_f32_16x16x32_bf16 v[48:51], v[24:27], v[164:167], v[48:51]
v_mfma_f32_16x16x32_bf16 v[52:55], v[28:31], v[164:167], v[52:55]
v_mfma_f32_16x16x32_bf16 v[56:59], v[24:27], v[168:171], v[56:59]
v_mfma_f32_16x16x32_bf16 v[60:63], v[28:31], v[168:171], v[60:63]
v_mfma_f32_16x16x32_bf16 v[64:67], v[24:27], v[172:175], v[64:67]
v_mfma_f32_16x16x32_bf16 v[68:71], v[28:31], v[172:175], v[68:71]
s_nop 7
global_load_dwordx4 v[24:27], v116, s[36:37] offset:192
v_add_u32 v117, 8192, v116
global_load_dwordx4 v[28:31], v117, s[36:37] offset:192
s_waitcnt vmcnt(0)
v_mfma_f32_16x16x32_bf16 v[40:43], v[24:27], v[176:179], v[40:43]
v_mfma_f32_16x16x32_bf16 v[44:47], v[28:31], v[176:179], v[44:47]
v_mfma_f32_16x16x32_bf16 v[48:51], v[24:27], v[180:183], v[48:51]
v_mfma_f32_16x16x32_bf16 v[52:55], v[28:31], v[180:183], v[52:55]
v_mfma_f32_16x16x32_bf16 v[56:59], v[24:27], v[184:187], v[56:59]
v_mfma_f32_16x16x32_bf16 v[60:63], v[28:31], v[184:187], v[60:63]
v_mfma_f32_16x16x32_bf16 v[64:67], v[24:27], v[188:191], v[64:67]
v_mfma_f32_16x16x32_bf16 v[68:71], v[28:31], v[188:191], v[68:71]
s_nop 7
global_load_dwordx4 v[24:27], v116, s[36:37] offset:256
v_add_u32 v117, 8192, v116
global_load_dwordx4 v[28:31], v117, s[36:37] offset:256
s_waitcnt vmcnt(0)
v_mfma_f32_16x16x32_bf16 v[40:43], v[24:27], v[192:195], v[40:43]
v_mfma_f32_16x16x32_bf16 v[44:47], v[28:31], v[192:195], v[44:47]
v_mfma_f32_16x16x32_bf16 v[48:51], v[24:27], v[196:199], v[48:51]
v_mfma_f32_16x16x32_bf16 v[52:55], v[28:31], v[196:199], v[52:55]
v_mfma_f32_16x16x32_bf16 v[56:59], v[24:27], v[200:203], v[56:59]
v_mfma_f32_16x16x32_bf16 v[60:63], v[28:31], v[200:203], v[60:63]
v_mfma_f32_16x16x32_bf16 v[64:67], v[24:27], v[204:207], v[64:67]
v_mfma_f32_16x16x32_bf16 v[68:71], v[28:31], v[204:207], v[68:71]
s_nop 7
global_load_dwordx4 v[24:27], v116, s[36:37] offset:320
v_add_u32 v117, 8192, v116
global_load_dwordx4 v[28:31], v117, s[36:37] offset:320
s_waitcnt vmcnt(0)
v_mfma_f32_16x16x32_bf16 v[40:43], v[24:27], v[208:211], v[40:43]
v_mfma_f32_16x16x32_bf16 v[44:47], v[28:31], v[208:211], v[44:47]
v_mfma_f32_16x16x32_bf16 v[48:51], v[24:27], v[212:215], v[48:51]
v_mfma_f32_16x16x32_bf16 v[52:55], v[28:31], v[212:215], v[52:55]
v_mfma_f32_16x16x32_bf16 v[56:59], v[24:27], v[216:219], v[56:59]
v_mfma_f32_16x16x32_bf16 v[60:63], v[28:31], v[216:219], v[60:63]
v_mfma_f32_16x16x32_bf16 v[64:67], v[24:27], v[220:223], v[64:67]
v_mfma_f32_16x16x32_bf16 v[68:71], v[28:31], v[220:223], v[68:71]
s_nop 7
global_load_dwordx4 v[24:27], v116, s[36:37] offset:384
v_add_u32 v117, 8192, v116
global_load_dwordx4 v[28:31], v117, s[36:37] offset:384
s_waitcnt vmcnt(0)
v_mfma_f32_16x16x32_bf16 v[40:43], v[24:27], v[224:227], v[40:43]
v_mfma_f32_16x16x32_bf16 v[44:47], v[28:31], v[224:227], v[44:47]
v_mfma_f32_16x16x32_bf16 v[48:51], v[24:27], v[228:231], v[48:51]
v_mfma_f32_16x16x32_bf16 v[52:55], v[28:31], v[228:231], v[52:55]
v_mfma_f32_16x16x32_bf16 v[56:59], v[24:27], v[232:235], v[56:59]
v_mfma_f32_16x16x32_bf16 v[60:63], v[28:31], v[232:235], v[60:63]
v_mfma_f32_16x16x32_bf16 v[64:67], v[24:27], v[236:239], v[64:67]
v_mfma_f32_16x16x32_bf16 v[68:71], v[28:31], v[236:239], v[68:71]
s_nop 7
global_load_dwordx4 v[24:27], v116, s[36:37] offset:448
v_add_u32 v117, 8192, v116
global_load_dwordx4 v[28:31], v117, s[36:37] offset:448
s_waitcnt vmcnt(0)
v_mfma_f32_16x16x32_bf16 v[40:43], v[24:27], v[240:243], v[40:43]
v_mfma_f32_16x16x32_bf16 v[44:47], v[28:31], v[240:243], v[44:47]
v_mfma_f32_16x16x32_bf16 v[48:51], v[24:27], v[244:247], v[48:51]
v_mfma_f32_16x16x32_bf16 v[52:55], v[28:31], v[244:247], v[52:55]
v_mfma_f32_16x16x32_bf16 v[56:59], v[24:27], v[248:251], v[56:59]
v_mfma_f32_16x16x32_bf16 v[60:63], v[28:31], v[248:251], v[60:63]
v_mfma_f32_16x16x32_bf16 v[64:67], v[24:27], v[252:255], v[64:67]
v_mfma_f32_16x16x32_bf16 v[68:71], v[28:31], v[252:255], v[68:71]
s_nop 7
s_nop 7
v_max3_f32 v84, v40, v41, v42
v_max3_f32 v84, v84, v43, v44
v_max3_f32 v84, v84, v45, v46
v_max_f32 v84, v84, v47
v_max3_f32 v85, v48, v49, v50
v_max3_f32 v85, v85, v51, v52
v_max3_f32 v85, v85, v53, v54
v_max_f32 v85, v85, v55
v_max3_f32 v86, v56, v57, v58
v_max3_f32 v86, v86, v59, v60
v_max3_f32 v86, v86, v61, v62
v_max_f32 v86, v86, v63
v_max3_f32 v87, v64, v65, v66
v_max3_f32 v87, v87, v67, v68
v_max3_f32 v87, v87, v69, v70
v_max_f32 v87, v87, v71
v_mbcnt_lo_u32_b32 v116, -1, 0
v_mbcnt_hi_u32_b32 v116, -1, v116
v_xor_b32 v117, 32, v116
v_xor_b32 v116, 16, v116
v_lshlrev_b32 v117, 2, v117
v_lshlrev_b32 v116, 2, v116
ds_bpermute_b32 v90, v116, v84
ds_bpermute_b32 v91, v116, v85
ds_bpermute_b32 v92, v116, v86
ds_bpermute_b32 v93, v116, v87
s_waitcnt lgkmcnt(0)
v_max_f32 v84, v84, v90
v_max_f32 v85, v85, v91
v_max_f32 v86, v86, v92
v_max_f32 v87, v87, v93
ds_bpermute_b32 v90, v117, v84
ds_bpermute_b32 v91, v117, v85
ds_bpermute_b32 v92, v117, v86
ds_bpermute_b32 v93, v117, v87
s_waitcnt lgkmcnt(0)
v_max_f32 v84, v84, v90
v_max_f32 v85, v85, v91
v_max_f32 v86, v86, v92
v_max_f32 v87, v87, v93
v_max_f32 v84, 0, v84
v_max_f32 v85, 0, v85
v_max_f32 v86, 0, v86
v_max_f32 v87, 0, v87
v_sub_f32 v90, 0, v84
v_sub_f32 v91, 0, v85
v_sub_f32 v92, 0, v86
v_sub_f32 v93, 0, v87
v_exp_f32 v90, v90
v_exp_f32 v91, v91
v_exp_f32 v92, v92
v_exp_f32 v93, v93
s_nop 0
v_sub_f32 v100, v100, v84
v_sub_f32 v101, v101, v84
v_sub_f32 v102, v102, v84
v_sub_f32 v103, v103, v84
v_mul_f32 v120, v120, v90
v_accvgpr_read_b32 v116, a0
v_mul_f32 v116, v116, v90
v_accvgpr_write_b32 a0, v116
v_accvgpr_read_b32 v116, a1
v_mul_f32 v116, v116, v90
v_accvgpr_write_b32 a1, v116
v_accvgpr_read_b32 v116, a2
v_mul_f32 v116, v116, v90
v_accvgpr_write_b32 a2, v116
v_accvgpr_read_b32 v116, a3
v_mul_f32 v116, v116, v90
v_accvgpr_write_b32 a3, v116
v_accvgpr_read_b32 v116, a16
v_mul_f32 v116, v116, v90
v_accvgpr_write_b32 a16, v116
v_accvgpr_read_b32 v116, a17
v_mul_f32 v116, v116, v90
v_accvgpr_write_b32 a17, v116
v_accvgpr_read_b32 v116, a18
v_mul_f32 v116, v116, v90
v_accvgpr_write_b32 a18, v116
v_accvgpr_read_b32 v116, a19
v_mul_f32 v116, v116, v90
v_accvgpr_write_b32 a19, v116
v_accvgpr_read_b32 v116, a32
v_mul_f32 v116, v116, v90
v_accvgpr_write_b32 a32, v116
v_accvgpr_read_b32 v116, a33
v_mul_f32 v116, v116, v90
v_accvgpr_write_b32 a33, v116
v_accvgpr_read_b32 v116, a34
v_mul_f32 v116, v116, v90
v_accvgpr_write_b32 a34, v116
v_accvgpr_read_b32 v116, a35
v_mul_f32 v116, v116, v90
v_accvgpr_write_b32 a35, v116
v_accvgpr_read_b32 v116, a48
v_mul_f32 v116, v116, v90
v_accvgpr_write_b32 a48, v116
v_accvgpr_read_b32 v116, a49
v_mul_f32 v116, v116, v90
v_accvgpr_write_b32 a49, v116
v_accvgpr_read_b32 v116, a50
v_mul_f32 v116, v116, v90
v_accvgpr_write_b32 a50, v116
v_accvgpr_read_b32 v116, a51
v_mul_f32 v116, v116, v90
v_accvgpr_write_b32 a51, v116
v_accvgpr_read_b32 v116, a64
v_mul_f32 v116, v116, v90
v_accvgpr_write_b32 a64, v116
v_accvgpr_read_b32 v116, a65
v_mul_f32 v116, v116, v90
v_accvgpr_write_b32 a65, v116
v_accvgpr_read_b32 v116, a66
v_mul_f32 v116, v116, v90
v_accvgpr_write_b32 a66, v116
v_accvgpr_read_b32 v116, a67
v_mul_f32 v116, v116, v90
v_accvgpr_write_b32 a67, v116
v_accvgpr_read_b32 v116, a80
v_mul_f32 v116, v116, v90
v_accvgpr_write_b32 a80, v116
v_accvgpr_read_b32 v116, a81
v_mul_f32 v116, v116, v90
v_accvgpr_write_b32 a81, v116
v_accvgpr_read_b32 v116, a82
v_mul_f32 v116, v116, v90
v_accvgpr_write_b32 a82, v116
v_accvgpr_read_b32 v116, a83
v_mul_f32 v116, v116, v90
v_accvgpr_write_b32 a83, v116
v_accvgpr_read_b32 v116, a96
v_mul_f32 v116, v116, v90
v_accvgpr_write_b32 a96, v116
v_accvgpr_read_b32 v116, a97
v_mul_f32 v116, v116, v90
v_accvgpr_write_b32 a97, v116
v_accvgpr_read_b32 v116, a98
v_mul_f32 v116, v116, v90
v_accvgpr_write_b32 a98, v116
v_accvgpr_read_b32 v116, a99
v_mul_f32 v116, v116, v90
v_accvgpr_write_b32 a99, v116
v_accvgpr_read_b32 v116, a112
v_mul_f32 v116, v116, v90
v_accvgpr_write_b32 a112, v116
v_accvgpr_read_b32 v116, a113
v_mul_f32 v116, v116, v90
v_accvgpr_write_b32 a113, v116
v_accvgpr_read_b32 v116, a114
v_mul_f32 v116, v116, v90
v_accvgpr_write_b32 a114, v116
v_accvgpr_read_b32 v116, a115
v_mul_f32 v116, v116, v90
v_accvgpr_write_b32 a115, v116
v_accvgpr_read_b32 v116, a128
v_mul_f32 v116, v116, v90
v_accvgpr_write_b32 a128, v116
v_accvgpr_read_b32 v116, a129
v_mul_f32 v116, v116, v90
v_accvgpr_write_b32 a129, v116
v_accvgpr_read_b32 v116, a130
v_mul_f32 v116, v116, v90
v_accvgpr_write_b32 a130, v116
v_accvgpr_read_b32 v116, a131
v_mul_f32 v116, v116, v90
v_accvgpr_write_b32 a131, v116
v_accvgpr_read_b32 v116, a144
v_mul_f32 v116, v116, v90
v_accvgpr_write_b32 a144, v116
v_accvgpr_read_b32 v116, a145
v_mul_f32 v116, v116, v90
v_accvgpr_write_b32 a145, v116
v_accvgpr_read_b32 v116, a146
v_mul_f32 v116, v116, v90
v_accvgpr_write_b32 a146, v116
v_accvgpr_read_b32 v116, a147
v_mul_f32 v116, v116, v90
v_accvgpr_write_b32 a147, v116
v_accvgpr_read_b32 v116, a160
v_mul_f32 v116, v116, v90
v_accvgpr_write_b32 a160, v116
v_accvgpr_read_b32 v116, a161
v_mul_f32 v116, v116, v90
v_accvgpr_write_b32 a161, v116
v_accvgpr_read_b32 v116, a162
v_mul_f32 v116, v116, v90
v_accvgpr_write_b32 a162, v116
v_accvgpr_read_b32 v116, a163
v_mul_f32 v116, v116, v90
v_accvgpr_write_b32 a163, v116
v_accvgpr_read_b32 v116, a176
v_mul_f32 v116, v116, v90
v_accvgpr_write_b32 a176, v116
v_accvgpr_read_b32 v116, a177
v_mul_f32 v116, v116, v90
v_accvgpr_write_b32 a177, v116
v_accvgpr_read_b32 v116, a178
v_mul_f32 v116, v116, v90
v_accvgpr_write_b32 a178, v116
v_accvgpr_read_b32 v116, a179
v_mul_f32 v116, v116, v90
v_accvgpr_write_b32 a179, v116
v_accvgpr_read_b32 v116, a192
v_mul_f32 v116, v116, v90
v_accvgpr_write_b32 a192, v116
v_accvgpr_read_b32 v116, a193
v_mul_f32 v116, v116, v90
v_accvgpr_write_b32 a193, v116
v_accvgpr_read_b32 v116, a194
v_mul_f32 v116, v116, v90
v_accvgpr_write_b32 a194, v116
v_accvgpr_read_b32 v116, a195
v_mul_f32 v116, v116, v90
v_accvgpr_write_b32 a195, v116
v_accvgpr_read_b32 v116, a208
v_mul_f32 v116, v116, v90
v_accvgpr_write_b32 a208, v116
v_accvgpr_read_b32 v116, a209
v_mul_f32 v116, v116, v90
v_accvgpr_write_b32 a209, v116
v_accvgpr_read_b32 v116, a210
v_mul_f32 v116, v116, v90
v_accvgpr_write_b32 a210, v116
v_accvgpr_read_b32 v116, a211
v_mul_f32 v116, v116, v90
v_accvgpr_write_b32 a211, v116
v_accvgpr_read_b32 v116, a224
v_mul_f32 v116, v116, v90
v_accvgpr_write_b32 a224, v116
v_accvgpr_read_b32 v116, a225
v_mul_f32 v116, v116, v90
v_accvgpr_write_b32 a225, v116
v_accvgpr_read_b32 v116, a226
v_mul_f32 v116, v116, v90
v_accvgpr_write_b32 a226, v116
v_accvgpr_read_b32 v116, a227
v_mul_f32 v116, v116, v90
v_accvgpr_write_b32 a227, v116
v_accvgpr_read_b32 v116, a240
v_mul_f32 v116, v116, v90
v_accvgpr_write_b32 a240, v116
v_accvgpr_read_b32 v116, a241
v_mul_f32 v116, v116, v90
v_accvgpr_write_b32 a241, v116
v_accvgpr_read_b32 v116, a242
v_mul_f32 v116, v116, v90
v_accvgpr_write_b32 a242, v116
v_accvgpr_read_b32 v116, a243
v_mul_f32 v116, v116, v90
v_accvgpr_write_b32 a243, v116
v_sub_f32 v104, v104, v85
v_sub_f32 v105, v105, v85
v_sub_f32 v106, v106, v85
v_sub_f32 v107, v107, v85
v_mul_f32 v121, v121, v91
v_accvgpr_read_b32 v116, a4
v_mul_f32 v116, v116, v91
v_accvgpr_write_b32 a4, v116
v_accvgpr_read_b32 v116, a5
v_mul_f32 v116, v116, v91
v_accvgpr_write_b32 a5, v116
v_accvgpr_read_b32 v116, a6
v_mul_f32 v116, v116, v91
v_accvgpr_write_b32 a6, v116
v_accvgpr_read_b32 v116, a7
v_mul_f32 v116, v116, v91
v_accvgpr_write_b32 a7, v116
v_accvgpr_read_b32 v116, a20
v_mul_f32 v116, v116, v91
v_accvgpr_write_b32 a20, v116
v_accvgpr_read_b32 v116, a21
v_mul_f32 v116, v116, v91
v_accvgpr_write_b32 a21, v116
v_accvgpr_read_b32 v116, a22
v_mul_f32 v116, v116, v91
v_accvgpr_write_b32 a22, v116
v_accvgpr_read_b32 v116, a23
v_mul_f32 v116, v116, v91
v_accvgpr_write_b32 a23, v116
v_accvgpr_read_b32 v116, a36
v_mul_f32 v116, v116, v91
v_accvgpr_write_b32 a36, v116
v_accvgpr_read_b32 v116, a37
v_mul_f32 v116, v116, v91
v_accvgpr_write_b32 a37, v116
v_accvgpr_read_b32 v116, a38
v_mul_f32 v116, v116, v91
v_accvgpr_write_b32 a38, v116
v_accvgpr_read_b32 v116, a39
v_mul_f32 v116, v116, v91
v_accvgpr_write_b32 a39, v116
v_accvgpr_read_b32 v116, a52
v_mul_f32 v116, v116, v91
v_accvgpr_write_b32 a52, v116
v_accvgpr_read_b32 v116, a53
v_mul_f32 v116, v116, v91
v_accvgpr_write_b32 a53, v116
v_accvgpr_read_b32 v116, a54
v_mul_f32 v116, v116, v91
v_accvgpr_write_b32 a54, v116
v_accvgpr_read_b32 v116, a55
v_mul_f32 v116, v116, v91
v_accvgpr_write_b32 a55, v116
v_accvgpr_read_b32 v116, a68
v_mul_f32 v116, v116, v91
v_accvgpr_write_b32 a68, v116
v_accvgpr_read_b32 v116, a69
v_mul_f32 v116, v116, v91
v_accvgpr_write_b32 a69, v116
v_accvgpr_read_b32 v116, a70
v_mul_f32 v116, v116, v91
v_accvgpr_write_b32 a70, v116
v_accvgpr_read_b32 v116, a71
v_mul_f32 v116, v116, v91
v_accvgpr_write_b32 a71, v116
v_accvgpr_read_b32 v116, a84
v_mul_f32 v116, v116, v91
v_accvgpr_write_b32 a84, v116
v_accvgpr_read_b32 v116, a85
v_mul_f32 v116, v116, v91
v_accvgpr_write_b32 a85, v116
v_accvgpr_read_b32 v116, a86
v_mul_f32 v116, v116, v91
v_accvgpr_write_b32 a86, v116
v_accvgpr_read_b32 v116, a87
v_mul_f32 v116, v116, v91
v_accvgpr_write_b32 a87, v116
v_accvgpr_read_b32 v116, a100
v_mul_f32 v116, v116, v91
v_accvgpr_write_b32 a100, v116
v_accvgpr_read_b32 v116, a101
v_mul_f32 v116, v116, v91
v_accvgpr_write_b32 a101, v116
v_accvgpr_read_b32 v116, a102
v_mul_f32 v116, v116, v91
v_accvgpr_write_b32 a102, v116
v_accvgpr_read_b32 v116, a103
v_mul_f32 v116, v116, v91
v_accvgpr_write_b32 a103, v116
v_accvgpr_read_b32 v116, a116
v_mul_f32 v116, v116, v91
v_accvgpr_write_b32 a116, v116
v_accvgpr_read_b32 v116, a117
v_mul_f32 v116, v116, v91
v_accvgpr_write_b32 a117, v116
v_accvgpr_read_b32 v116, a118
v_mul_f32 v116, v116, v91
v_accvgpr_write_b32 a118, v116
v_accvgpr_read_b32 v116, a119
v_mul_f32 v116, v116, v91
v_accvgpr_write_b32 a119, v116
v_accvgpr_read_b32 v116, a132
v_mul_f32 v116, v116, v91
v_accvgpr_write_b32 a132, v116
v_accvgpr_read_b32 v116, a133
v_mul_f32 v116, v116, v91
v_accvgpr_write_b32 a133, v116
v_accvgpr_read_b32 v116, a134
v_mul_f32 v116, v116, v91
v_accvgpr_write_b32 a134, v116
v_accvgpr_read_b32 v116, a135
v_mul_f32 v116, v116, v91
v_accvgpr_write_b32 a135, v116
v_accvgpr_read_b32 v116, a148
v_mul_f32 v116, v116, v91
v_accvgpr_write_b32 a148, v116
v_accvgpr_read_b32 v116, a149
v_mul_f32 v116, v116, v91
v_accvgpr_write_b32 a149, v116
v_accvgpr_read_b32 v116, a150
v_mul_f32 v116, v116, v91
v_accvgpr_write_b32 a150, v116
v_accvgpr_read_b32 v116, a151
v_mul_f32 v116, v116, v91
v_accvgpr_write_b32 a151, v116
v_accvgpr_read_b32 v116, a164
v_mul_f32 v116, v116, v91
v_accvgpr_write_b32 a164, v116
v_accvgpr_read_b32 v116, a165
v_mul_f32 v116, v116, v91
v_accvgpr_write_b32 a165, v116
v_accvgpr_read_b32 v116, a166
v_mul_f32 v116, v116, v91
v_accvgpr_write_b32 a166, v116
v_accvgpr_read_b32 v116, a167
v_mul_f32 v116, v116, v91
v_accvgpr_write_b32 a167, v116
v_accvgpr_read_b32 v116, a180
v_mul_f32 v116, v116, v91
v_accvgpr_write_b32 a180, v116
v_accvgpr_read_b32 v116, a181
v_mul_f32 v116, v116, v91
v_accvgpr_write_b32 a181, v116
v_accvgpr_read_b32 v116, a182
v_mul_f32 v116, v116, v91
v_accvgpr_write_b32 a182, v116
v_accvgpr_read_b32 v116, a183
v_mul_f32 v116, v116, v91
v_accvgpr_write_b32 a183, v116
v_accvgpr_read_b32 v116, a196
v_mul_f32 v116, v116, v91
v_accvgpr_write_b32 a196, v116
v_accvgpr_read_b32 v116, a197
v_mul_f32 v116, v116, v91
v_accvgpr_write_b32 a197, v116
v_accvgpr_read_b32 v116, a198
v_mul_f32 v116, v116, v91
v_accvgpr_write_b32 a198, v116
v_accvgpr_read_b32 v116, a199
v_mul_f32 v116, v116, v91
v_accvgpr_write_b32 a199, v116
v_accvgpr_read_b32 v116, a212
v_mul_f32 v116, v116, v91
v_accvgpr_write_b32 a212, v116
v_accvgpr_read_b32 v116, a213
v_mul_f32 v116, v116, v91
v_accvgpr_write_b32 a213, v116
v_accvgpr_read_b32 v116, a214
v_mul_f32 v116, v116, v91
v_accvgpr_write_b32 a214, v116
v_accvgpr_read_b32 v116, a215
v_mul_f32 v116, v116, v91
v_accvgpr_write_b32 a215, v116
v_accvgpr_read_b32 v116, a228
v_mul_f32 v116, v116, v91
v_accvgpr_write_b32 a228, v116
v_accvgpr_read_b32 v116, a229
v_mul_f32 v116, v116, v91
v_accvgpr_write_b32 a229, v116
v_accvgpr_read_b32 v116, a230
v_mul_f32 v116, v116, v91
v_accvgpr_write_b32 a230, v116
v_accvgpr_read_b32 v116, a231
v_mul_f32 v116, v116, v91
v_accvgpr_write_b32 a231, v116
v_accvgpr_read_b32 v116, a244
v_mul_f32 v116, v116, v91
v_accvgpr_write_b32 a244, v116
v_accvgpr_read_b32 v116, a245
v_mul_f32 v116, v116, v91
v_accvgpr_write_b32 a245, v116
v_accvgpr_read_b32 v116, a246
v_mul_f32 v116, v116, v91
v_accvgpr_write_b32 a246, v116
v_accvgpr_read_b32 v116, a247
v_mul_f32 v116, v116, v91
v_accvgpr_write_b32 a247, v116
v_sub_f32 v108, v108, v86
v_sub_f32 v109, v109, v86
v_sub_f32 v110, v110, v86
v_sub_f32 v111, v111, v86
v_mul_f32 v122, v122, v92
v_accvgpr_read_b32 v116, a8
v_mul_f32 v116, v116, v92
v_accvgpr_write_b32 a8, v116
v_accvgpr_read_b32 v116, a9
v_mul_f32 v116, v116, v92
v_accvgpr_write_b32 a9, v116
v_accvgpr_read_b32 v116, a10
v_mul_f32 v116, v116, v92
v_accvgpr_write_b32 a10, v116
v_accvgpr_read_b32 v116, a11
v_mul_f32 v116, v116, v92
v_accvgpr_write_b32 a11, v116
v_accvgpr_read_b32 v116, a24
v_mul_f32 v116, v116, v92
v_accvgpr_write_b32 a24, v116
v_accvgpr_read_b32 v116, a25
v_mul_f32 v116, v116, v92
v_accvgpr_write_b32 a25, v116
v_accvgpr_read_b32 v116, a26
v_mul_f32 v116, v116, v92
v_accvgpr_write_b32 a26, v116
v_accvgpr_read_b32 v116, a27
v_mul_f32 v116, v116, v92
v_accvgpr_write_b32 a27, v116
v_accvgpr_read_b32 v116, a40
v_mul_f32 v116, v116, v92
v_accvgpr_write_b32 a40, v116
v_accvgpr_read_b32 v116, a41
v_mul_f32 v116, v116, v92
v_accvgpr_write_b32 a41, v116
v_accvgpr_read_b32 v116, a42
v_mul_f32 v116, v116, v92
v_accvgpr_write_b32 a42, v116
v_accvgpr_read_b32 v116, a43
v_mul_f32 v116, v116, v92
v_accvgpr_write_b32 a43, v116
v_accvgpr_read_b32 v116, a56
v_mul_f32 v116, v116, v92
v_accvgpr_write_b32 a56, v116
v_accvgpr_read_b32 v116, a57
v_mul_f32 v116, v116, v92
v_accvgpr_write_b32 a57, v116
v_accvgpr_read_b32 v116, a58
v_mul_f32 v116, v116, v92
v_accvgpr_write_b32 a58, v116
v_accvgpr_read_b32 v116, a59
v_mul_f32 v116, v116, v92
v_accvgpr_write_b32 a59, v116
v_accvgpr_read_b32 v116, a72
v_mul_f32 v116, v116, v92
v_accvgpr_write_b32 a72, v116
v_accvgpr_read_b32 v116, a73
v_mul_f32 v116, v116, v92
v_accvgpr_write_b32 a73, v116
v_accvgpr_read_b32 v116, a74
v_mul_f32 v116, v116, v92
v_accvgpr_write_b32 a74, v116
v_accvgpr_read_b32 v116, a75
v_mul_f32 v116, v116, v92
v_accvgpr_write_b32 a75, v116
v_accvgpr_read_b32 v116, a88
v_mul_f32 v116, v116, v92
v_accvgpr_write_b32 a88, v116
v_accvgpr_read_b32 v116, a89
v_mul_f32 v116, v116, v92
v_accvgpr_write_b32 a89, v116
v_accvgpr_read_b32 v116, a90
v_mul_f32 v116, v116, v92
v_accvgpr_write_b32 a90, v116
v_accvgpr_read_b32 v116, a91
v_mul_f32 v116, v116, v92
v_accvgpr_write_b32 a91, v116
v_accvgpr_read_b32 v116, a104
v_mul_f32 v116, v116, v92
v_accvgpr_write_b32 a104, v116
v_accvgpr_read_b32 v116, a105
v_mul_f32 v116, v116, v92
v_accvgpr_write_b32 a105, v116
v_accvgpr_read_b32 v116, a106
v_mul_f32 v116, v116, v92
v_accvgpr_write_b32 a106, v116
v_accvgpr_read_b32 v116, a107
v_mul_f32 v116, v116, v92
v_accvgpr_write_b32 a107, v116
v_accvgpr_read_b32 v116, a120
v_mul_f32 v116, v116, v92
v_accvgpr_write_b32 a120, v116
v_accvgpr_read_b32 v116, a121
v_mul_f32 v116, v116, v92
v_accvgpr_write_b32 a121, v116
v_accvgpr_read_b32 v116, a122
v_mul_f32 v116, v116, v92
v_accvgpr_write_b32 a122, v116
v_accvgpr_read_b32 v116, a123
v_mul_f32 v116, v116, v92
v_accvgpr_write_b32 a123, v116
v_accvgpr_read_b32 v116, a136
v_mul_f32 v116, v116, v92
v_accvgpr_write_b32 a136, v116
v_accvgpr_read_b32 v116, a137
v_mul_f32 v116, v116, v92
v_accvgpr_write_b32 a137, v116
v_accvgpr_read_b32 v116, a138
v_mul_f32 v116, v116, v92
v_accvgpr_write_b32 a138, v116
v_accvgpr_read_b32 v116, a139
v_mul_f32 v116, v116, v92
v_accvgpr_write_b32 a139, v116
v_accvgpr_read_b32 v116, a152
v_mul_f32 v116, v116, v92
v_accvgpr_write_b32 a152, v116
v_accvgpr_read_b32 v116, a153
v_mul_f32 v116, v116, v92
v_accvgpr_write_b32 a153, v116
v_accvgpr_read_b32 v116, a154
v_mul_f32 v116, v116, v92
v_accvgpr_write_b32 a154, v116
v_accvgpr_read_b32 v116, a155
v_mul_f32 v116, v116, v92
v_accvgpr_write_b32 a155, v116
v_accvgpr_read_b32 v116, a168
v_mul_f32 v116, v116, v92
v_accvgpr_write_b32 a168, v116
v_accvgpr_read_b32 v116, a169
v_mul_f32 v116, v116, v92
v_accvgpr_write_b32 a169, v116
v_accvgpr_read_b32 v116, a170
v_mul_f32 v116, v116, v92
v_accvgpr_write_b32 a170, v116
v_accvgpr_read_b32 v116, a171
v_mul_f32 v116, v116, v92
v_accvgpr_write_b32 a171, v116
v_accvgpr_read_b32 v116, a184
v_mul_f32 v116, v116, v92
v_accvgpr_write_b32 a184, v116
v_accvgpr_read_b32 v116, a185
v_mul_f32 v116, v116, v92
v_accvgpr_write_b32 a185, v116
v_accvgpr_read_b32 v116, a186
v_mul_f32 v116, v116, v92
v_accvgpr_write_b32 a186, v116
v_accvgpr_read_b32 v116, a187
v_mul_f32 v116, v116, v92
v_accvgpr_write_b32 a187, v116
v_accvgpr_read_b32 v116, a200
v_mul_f32 v116, v116, v92
v_accvgpr_write_b32 a200, v116
v_accvgpr_read_b32 v116, a201
v_mul_f32 v116, v116, v92
v_accvgpr_write_b32 a201, v116
v_accvgpr_read_b32 v116, a202
v_mul_f32 v116, v116, v92
v_accvgpr_write_b32 a202, v116
v_accvgpr_read_b32 v116, a203
v_mul_f32 v116, v116, v92
v_accvgpr_write_b32 a203, v116
v_accvgpr_read_b32 v116, a216
v_mul_f32 v116, v116, v92
v_accvgpr_write_b32 a216, v116
v_accvgpr_read_b32 v116, a217
v_mul_f32 v116, v116, v92
v_accvgpr_write_b32 a217, v116
v_accvgpr_read_b32 v116, a218
v_mul_f32 v116, v116, v92
v_accvgpr_write_b32 a218, v116
v_accvgpr_read_b32 v116, a219
v_mul_f32 v116, v116, v92
v_accvgpr_write_b32 a219, v116
v_accvgpr_read_b32 v116, a232
v_mul_f32 v116, v116, v92
v_accvgpr_write_b32 a232, v116
v_accvgpr_read_b32 v116, a233
v_mul_f32 v116, v116, v92
v_accvgpr_write_b32 a233, v116
v_accvgpr_read_b32 v116, a234
v_mul_f32 v116, v116, v92
v_accvgpr_write_b32 a234, v116
v_accvgpr_read_b32 v116, a235
v_mul_f32 v116, v116, v92
v_accvgpr_write_b32 a235, v116
v_accvgpr_read_b32 v116, a248
v_mul_f32 v116, v116, v92
v_accvgpr_write_b32 a248, v116
v_accvgpr_read_b32 v116, a249
v_mul_f32 v116, v116, v92
v_accvgpr_write_b32 a249, v116
v_accvgpr_read_b32 v116, a250
v_mul_f32 v116, v116, v92
v_accvgpr_write_b32 a250, v116
v_accvgpr_read_b32 v116, a251
v_mul_f32 v116, v116, v92
v_accvgpr_write_b32 a251, v116
v_sub_f32 v112, v112, v87
v_sub_f32 v113, v113, v87
v_sub_f32 v114, v114, v87
v_sub_f32 v115, v115, v87
v_mul_f32 v123, v123, v93
v_accvgpr_read_b32 v116, a12
v_mul_f32 v116, v116, v93
v_accvgpr_write_b32 a12, v116
v_accvgpr_read_b32 v116, a13
v_mul_f32 v116, v116, v93
v_accvgpr_write_b32 a13, v116
v_accvgpr_read_b32 v116, a14
v_mul_f32 v116, v116, v93
v_accvgpr_write_b32 a14, v116
v_accvgpr_read_b32 v116, a15
v_mul_f32 v116, v116, v93
v_accvgpr_write_b32 a15, v116
v_accvgpr_read_b32 v116, a28
v_mul_f32 v116, v116, v93
v_accvgpr_write_b32 a28, v116
v_accvgpr_read_b32 v116, a29
v_mul_f32 v116, v116, v93
v_accvgpr_write_b32 a29, v116
v_accvgpr_read_b32 v116, a30
v_mul_f32 v116, v116, v93
v_accvgpr_write_b32 a30, v116
v_accvgpr_read_b32 v116, a31
v_mul_f32 v116, v116, v93
v_accvgpr_write_b32 a31, v116
v_accvgpr_read_b32 v116, a44
v_mul_f32 v116, v116, v93
v_accvgpr_write_b32 a44, v116
v_accvgpr_read_b32 v116, a45
v_mul_f32 v116, v116, v93
v_accvgpr_write_b32 a45, v116
v_accvgpr_read_b32 v116, a46
v_mul_f32 v116, v116, v93
v_accvgpr_write_b32 a46, v116
v_accvgpr_read_b32 v116, a47
v_mul_f32 v116, v116, v93
v_accvgpr_write_b32 a47, v116
v_accvgpr_read_b32 v116, a60
v_mul_f32 v116, v116, v93
v_accvgpr_write_b32 a60, v116
v_accvgpr_read_b32 v116, a61
v_mul_f32 v116, v116, v93
v_accvgpr_write_b32 a61, v116
v_accvgpr_read_b32 v116, a62
v_mul_f32 v116, v116, v93
v_accvgpr_write_b32 a62, v116
v_accvgpr_read_b32 v116, a63
v_mul_f32 v116, v116, v93
v_accvgpr_write_b32 a63, v116
v_accvgpr_read_b32 v116, a76
v_mul_f32 v116, v116, v93
v_accvgpr_write_b32 a76, v116
v_accvgpr_read_b32 v116, a77
v_mul_f32 v116, v116, v93
v_accvgpr_write_b32 a77, v116
v_accvgpr_read_b32 v116, a78
v_mul_f32 v116, v116, v93
v_accvgpr_write_b32 a78, v116
v_accvgpr_read_b32 v116, a79
v_mul_f32 v116, v116, v93
v_accvgpr_write_b32 a79, v116
v_accvgpr_read_b32 v116, a92
v_mul_f32 v116, v116, v93
v_accvgpr_write_b32 a92, v116
v_accvgpr_read_b32 v116, a93
v_mul_f32 v116, v116, v93
v_accvgpr_write_b32 a93, v116
v_accvgpr_read_b32 v116, a94
v_mul_f32 v116, v116, v93
v_accvgpr_write_b32 a94, v116
v_accvgpr_read_b32 v116, a95
v_mul_f32 v116, v116, v93
v_accvgpr_write_b32 a95, v116
v_accvgpr_read_b32 v116, a108
v_mul_f32 v116, v116, v93
v_accvgpr_write_b32 a108, v116
v_accvgpr_read_b32 v116, a109
v_mul_f32 v116, v116, v93
v_accvgpr_write_b32 a109, v116
v_accvgpr_read_b32 v116, a110
v_mul_f32 v116, v116, v93
v_accvgpr_write_b32 a110, v116
v_accvgpr_read_b32 v116, a111
v_mul_f32 v116, v116, v93
v_accvgpr_write_b32 a111, v116
v_accvgpr_read_b32 v116, a124
v_mul_f32 v116, v116, v93
v_accvgpr_write_b32 a124, v116
v_accvgpr_read_b32 v116, a125
v_mul_f32 v116, v116, v93
v_accvgpr_write_b32 a125, v116
v_accvgpr_read_b32 v116, a126
v_mul_f32 v116, v116, v93
v_accvgpr_write_b32 a126, v116
v_accvgpr_read_b32 v116, a127
v_mul_f32 v116, v116, v93
v_accvgpr_write_b32 a127, v116
v_accvgpr_read_b32 v116, a140
v_mul_f32 v116, v116, v93
v_accvgpr_write_b32 a140, v116
v_accvgpr_read_b32 v116, a141
v_mul_f32 v116, v116, v93
v_accvgpr_write_b32 a141, v116
v_accvgpr_read_b32 v116, a142
v_mul_f32 v116, v116, v93
v_accvgpr_write_b32 a142, v116
v_accvgpr_read_b32 v116, a143
v_mul_f32 v116, v116, v93
v_accvgpr_write_b32 a143, v116
v_accvgpr_read_b32 v116, a156
v_mul_f32 v116, v116, v93
v_accvgpr_write_b32 a156, v116
v_accvgpr_read_b32 v116, a157
v_mul_f32 v116, v116, v93
v_accvgpr_write_b32 a157, v116
v_accvgpr_read_b32 v116, a158
v_mul_f32 v116, v116, v93
v_accvgpr_write_b32 a158, v116
v_accvgpr_read_b32 v116, a159
v_mul_f32 v116, v116, v93
v_accvgpr_write_b32 a159, v116
v_accvgpr_read_b32 v116, a172
v_mul_f32 v116, v116, v93
v_accvgpr_write_b32 a172, v116
v_accvgpr_read_b32 v116, a173
v_mul_f32 v116, v116, v93
v_accvgpr_write_b32 a173, v116
v_accvgpr_read_b32 v116, a174
v_mul_f32 v116, v116, v93
v_accvgpr_write_b32 a174, v116
v_accvgpr_read_b32 v116, a175
v_mul_f32 v116, v116, v93
v_accvgpr_write_b32 a175, v116
v_accvgpr_read_b32 v116, a188
v_mul_f32 v116, v116, v93
v_accvgpr_write_b32 a188, v116
v_accvgpr_read_b32 v116, a189
v_mul_f32 v116, v116, v93
v_accvgpr_write_b32 a189, v116
v_accvgpr_read_b32 v116, a190
v_mul_f32 v116, v116, v93
v_accvgpr_write_b32 a190, v116
v_accvgpr_read_b32 v116, a191
v_mul_f32 v116, v116, v93
v_accvgpr_write_b32 a191, v116
v_accvgpr_read_b32 v116, a204
v_mul_f32 v116, v116, v93
v_accvgpr_write_b32 a204, v116
v_accvgpr_read_b32 v116, a205
v_mul_f32 v116, v116, v93
v_accvgpr_write_b32 a205, v116
v_accvgpr_read_b32 v116, a206
v_mul_f32 v116, v116, v93
v_accvgpr_write_b32 a206, v116
v_accvgpr_read_b32 v116, a207
v_mul_f32 v116, v116, v93
v_accvgpr_write_b32 a207, v116
v_accvgpr_read_b32 v116, a220
v_mul_f32 v116, v116, v93
v_accvgpr_write_b32 a220, v116
v_accvgpr_read_b32 v116, a221
v_mul_f32 v116, v116, v93
v_accvgpr_write_b32 a221, v116
v_accvgpr_read_b32 v116, a222
v_mul_f32 v116, v116, v93
v_accvgpr_write_b32 a222, v116
v_accvgpr_read_b32 v116, a223
v_mul_f32 v116, v116, v93
v_accvgpr_write_b32 a223, v116
v_accvgpr_read_b32 v116, a236
v_mul_f32 v116, v116, v93
v_accvgpr_write_b32 a236, v116
v_accvgpr_read_b32 v116, a237
v_mul_f32 v116, v116, v93
v_accvgpr_write_b32 a237, v116
v_accvgpr_read_b32 v116, a238
v_mul_f32 v116, v116, v93
v_accvgpr_write_b32 a238, v116
v_accvgpr_read_b32 v116, a239
v_mul_f32 v116, v116, v93
v_accvgpr_write_b32 a239, v116
v_accvgpr_read_b32 v116, a252
v_mul_f32 v116, v116, v93
v_accvgpr_write_b32 a252, v116
v_accvgpr_read_b32 v116, a253
v_mul_f32 v116, v116, v93
v_accvgpr_write_b32 a253, v116
v_accvgpr_read_b32 v116, a254
v_mul_f32 v116, v116, v93
v_accvgpr_write_b32 a254, v116
v_accvgpr_read_b32 v116, a255
v_mul_f32 v116, v116, v93
v_accvgpr_write_b32 a255, v116
v_sub_f32 v40, v40, v84
v_sub_f32 v41, v41, v84
v_sub_f32 v42, v42, v84
v_sub_f32 v43, v43, v84
v_sub_f32 v44, v44, v84
v_sub_f32 v45, v45, v84
v_sub_f32 v46, v46, v84
v_sub_f32 v47, v47, v84
v_sub_f32 v48, v48, v85
v_sub_f32 v49, v49, v85
v_sub_f32 v50, v50, v85
v_sub_f32 v51, v51, v85
v_sub_f32 v52, v52, v85
v_sub_f32 v53, v53, v85
v_sub_f32 v54, v54, v85
v_sub_f32 v55, v55, v85
v_sub_f32 v56, v56, v86
v_sub_f32 v57, v57, v86
v_sub_f32 v58, v58, v86
v_sub_f32 v59, v59, v86
v_sub_f32 v60, v60, v86
v_sub_f32 v61, v61, v86
v_sub_f32 v62, v62, v86
v_sub_f32 v63, v63, v86
v_sub_f32 v64, v64, v87
v_sub_f32 v65, v65, v87
v_sub_f32 v66, v66, v87
v_sub_f32 v67, v67, v87
v_sub_f32 v68, v68, v87
v_sub_f32 v69, v69, v87
v_sub_f32 v70, v70, v87
v_sub_f32 v71, v71, v87
v_exp_f32 v40, v40
v_exp_f32 v41, v41
v_exp_f32 v42, v42
v_exp_f32 v43, v43
v_exp_f32 v44, v44
v_exp_f32 v45, v45
v_exp_f32 v46, v46
v_exp_f32 v47, v47
v_exp_f32 v48, v48
v_exp_f32 v49, v49
v_exp_f32 v50, v50
v_exp_f32 v51, v51
v_exp_f32 v52, v52
v_exp_f32 v53, v53
v_exp_f32 v54, v54
v_exp_f32 v55, v55
v_exp_f32 v56, v56
v_exp_f32 v57, v57
v_exp_f32 v58, v58
v_exp_f32 v59, v59
v_exp_f32 v60, v60
v_exp_f32 v61, v61
v_exp_f32 v62, v62
v_exp_f32 v63, v63
v_exp_f32 v64, v64
v_exp_f32 v65, v65
v_exp_f32 v66, v66
v_exp_f32 v67, v67
v_exp_f32 v68, v68
v_exp_f32 v69, v69
v_exp_f32 v70, v70
v_exp_f32 v71, v71
s_nop 0
v_add_f32 v124, v120, v40
v_add_f32 v124, v124, v41
v_add_f32 v124, v124, v42
v_add_f32 v124, v124, v43
v_add_f32 v124, v124, v44
v_add_f32 v124, v124, v45
v_add_f32 v124, v124, v46
v_add_f32 v124, v124, v47
v_add_f32 v125, v121, v48
v_add_f32 v125, v125, v49
v_add_f32 v125, v125, v50
v_add_f32 v125, v125, v51
v_add_f32 v125, v125, v52
v_add_f32 v125, v125, v53
v_add_f32 v125, v125, v54
v_add_f32 v125, v125, v55
v_add_f32 v126, v122, v56
v_add_f32 v126, v126, v57
v_add_f32 v126, v126, v58
v_add_f32 v126, v126, v59
v_add_f32 v126, v126, v60
v_add_f32 v126, v126, v61
v_add_f32 v126, v126, v62
v_add_f32 v126, v126, v63
v_add_f32 v127, v123, v64
v_add_f32 v127, v127, v65
v_add_f32 v127, v127, v66
v_add_f32 v127, v127, v67
v_add_f32 v127, v127, v68
v_add_f32 v127, v127, v69
v_add_f32 v127, v127, v70
v_add_f32 v127, v127, v71
v_cvt_pk_bf16_f32 v80, v40, v41
v_cvt_pk_bf16_f32 v81, v42, v43
v_cvt_pk_bf16_f32 v82, v44, v45
v_cvt_pk_bf16_f32 v83, v46, v47
s_nop 1
s_branch L_sp2_r4_ret
.section .rodata,"a"
.p2align 6
.amdhsa_kernel concat_heads__mha_block_cached__mha_block_cached__near_ridge_kernel
  .amdhsa_next_free_vgpr 512
  .amdhsa_next_free_sgpr 102
  .amdhsa_accum_offset 256
  .amdhsa_group_segment_fixed_size 0
  .amdhsa_kernarg_size 104
  .amdhsa_user_sgpr_count 2
  .amdhsa_user_sgpr_kernarg_segment_ptr 1
  .amdhsa_system_sgpr_workgroup_id_x 1
.end_amdhsa_kernel
.text
```
